```python
import torch

def _softmax(x, axis=-1):
    return torch.softmax(x, dim=axis)

def _gelu(x):
    return torch.nn.functional.gelu(x, approximate='tanh')

def _silu(x):
    return torch.nn.functional.silu(x)

def _sigmoid(x):
    return torch.sigmoid(x)

def _layernorm(x, axis=-1, eps=1e-05):
    m = x.mean(dim=axis, keepdim=True)
    v = x.var(dim=axis, keepdim=True, unbiased=False)
    return (x - m) / torch.sqrt(v + eps)

def _scatter_add(tgt, idx, src, axis=0):
    return tgt.clone().index_add_(axis, idx, src)

def _segment_sum(src, seg, n):
    out = torch.zeros((n,) + src.shape[1:], dtype=src.dtype)
    return out.index_add_(0, seg, src)

def _pad(x, pw):
    flat = tuple((v for pair in reversed(pw) for v in pair))
    return torch.nn.functional.pad(x, flat)
kernel_name = 'interleave_layers__memory_aug_recurrent_mem_tr__mixer_s_mlp__prompt'

def setup_inputs():

    _w = lambda a: (lambda t: t.to(torch.bfloat16) if t.is_floating_point() else t)(torch.as_tensor(a))

    def _A_setup():
        B, S, Dm = (1, 2048, 640)
        H, Dh = (32, 128)
        M, seg = (8, 32)
        seg = min(seg, S)
        S = S // seg * seg
        return {'x': _w((lambda *s: torch.randn(*s, dtype=torch.bfloat16) * 0.05)(B, S, Dm)), 'mem0': _w((lambda *s: torch.randn(*s, dtype=torch.bfloat16) * 0.8)(B, M, Dm)), 'Wq': _w((lambda *s: torch.randn(*s, dtype=torch.bfloat16) * 0.8)(Dm, H, Dh) * Dm ** (-0.5)), 'Wk': _w((lambda *s: torch.randn(*s, dtype=torch.bfloat16) * 0.8)(Dm, H, Dh) * Dm ** (-0.5)), 'Wv': _w((lambda *s: torch.randn(*s, dtype=torch.bfloat16) * 0.8)(Dm, H, Dh) * Dm ** (-0.5)), 'Wo': _w((lambda *s: torch.randn(*s, dtype=torch.bfloat16) * 0.8)(H, Dh, Dm) * (H * Dh) ** (-0.5)), 'seg_len': seg}
    _A_in = _A_setup()

    def _B_setup():
        B, S, D, F = (1, 2048, 640, 1728)
        return {'x': _w((lambda *s: torch.randn(*s, dtype=torch.bfloat16) * 0.05)(B, S, D)), 'w1': _w((lambda *s: torch.randn(*s, dtype=torch.bfloat16) * 0.8)(D, D) * D ** (-0.5)), 'w2': _w((lambda *s: torch.randn(*s, dtype=torch.bfloat16) * 0.8)(D, D) * D ** (-0.5)), 'w3': _w((lambda *s: torch.randn(*s, dtype=torch.bfloat16) * 0.8)(D, F) * D ** (-0.5)), 'w4': _w((lambda *s: torch.randn(*s, dtype=torch.bfloat16) * 0.8)(F, D) * F ** (-0.5))}
    _B_in = _B_setup()
    return {'A_x': _A_in['x'], 'A_mem0': _A_in['mem0'], 'A_Wq': _A_in['Wq'], 'A_Wk': _A_in['Wk'], 'A_Wv': _A_in['Wv'], 'A_Wo': _A_in['Wo'], 'A_seg_len': _A_in['seg_len'], 'B_x': _B_in['x'], 'B_w1': _B_in['w1'], 'B_w2': _B_in['w2'], 'B_w3': _B_in['w3'], 'B_w4': _B_in['w4']}

def reference(A_x, A_mem0, A_Wq, A_Wk, A_Wv, A_Wo, A_seg_len, B_x, B_w1, B_w2, B_w3, B_w4):

    def _A_ref(x, mem0, Wq, Wk, Wv, Wo, seg_len):
        B, S, Dm = x.shape
        H, Dh = (Wq.shape[1], Wq.shape[2])
        M = mem0.shape[1]
        scale = Dh ** (-0.5)
        n_seg = S // seg_len
        L = M + seg_len
        idx = torch.arange(L)
        mask = (idx[:, None] < M) | (idx[:, None] >= idx[None, :])
        mem = mem0
        outs = []
        for s in range(n_seg):
            xs = x[:, s * seg_len:(s + 1) * seg_len, :].clone()
            h = torch.concatenate([mem, xs], axis=1)
            q = torch.einsum('btd,dhe->bhte', h, Wq)
            k = torch.einsum('btd,dhe->bhte', h, Wk)
            v = torch.einsum('btd,dhe->bhte', h, Wv)
            scores = torch.einsum('bhqe,bhke->bhqk', q, k) * scale
            scores = torch.where(mask[None, None], scores, -1000000000.0)
            p = _softmax(scores, axis=-1)
            o = torch.einsum('bhqk,bhke->bhqe', p, v)
            o = torch.einsum('bhte,hed->btd', o, Wo)
            mem = o[:, :M, :].clone()
            outs.append(o[:, M:, :])
        return torch.concatenate(outs, axis=1)

    def _B_ref(x, w1, w2, w3, w4):
        B, S, D = x.shape
        h = _gelu(_layernorm(x, axis=-1) @ w1)
        c = D // 4
        g0 = _pad(h[:, :, 0 * c:1 * c], ((0, 0), (1, 0), (0, 0)))[:, :S, :]
        g1 = _pad(h[:, :, 1 * c:2 * c], ((0, 0), (0, 1), (0, 0)))[:, 1:, :]
        g2 = _pad(h[:, :, 2 * c:3 * c], ((0, 0), (2, 0), (0, 0)))[:, :S, :]
        g3 = _pad(h[:, :, 3 * c:], ((0, 0), (0, 2), (0, 0)))[:, 2:, :]
        hs = torch.concatenate([g0, g1, g2, g3], axis=-1) @ w2
        x1 = x + hs
        h2 = _gelu(_layernorm(x1, axis=-1) @ w3) @ w4
        return x1 + h2
    x = A_x
    x = x + _A_ref(_layernorm(x, axis=-1), A_mem0, A_Wq, A_Wk, A_Wv, A_Wo, A_seg_len)
    x = x + _B_ref(_layernorm(x, axis=-1), B_w1, B_w2, B_w3, B_w4)
    x = x + _A_ref(_layernorm(x, axis=-1), A_mem0, A_Wq, A_Wk, A_Wv, A_Wo, A_seg_len)
    x = x + _B_ref(_layernorm(x, axis=-1), B_w1, B_w2, B_w3, B_w4)
    return x
```

```asm
; @launch grid=(256,1,1) block=(256,1,1) lds=163840
.amdgcn_target "amdgcn-amd-amdhsa--gfx950"
.text
R_chain:
s_lshr_b32 s39,s2,5
s_and_b32 s41,s2,31
CL_beg:
s_load_dwordx4 s[64:67],s[0:1],16
s_load_dwordx4 s[68:71],s[0:1],32
s_mul_i32 s42,s39,0x300000
s_add_u32 s42,s42,0xdab0000
s_lshl_b32 s61,s41,2
s_add_u32 s61,s61,s3
s_mul_i32 s62,s61,24576
s_add_u32 s42,s42,s62
s_lshl_b32 s61,s41,8
s_lshl_b32 s60,s3,17
s_add_u32 s61,s61,s60
s_mul_i32 s62,s41,163840
s_lshl_b32 s63,s3,8
s_add_u32 s63,s63,s62
s_lshl_b32 s60,s3,6
s_add_u32 s62,s62,s60
s_add_u32 s62,s62,1024
s_mul_i32 s22,s3,36864
s_mov_b32 s20,0x05040100
s_mov_b32 s21,0x07060302
v_lshlrev_b32 v1,4,v0
v_lshrrev_b32 v10,2,v0
v_and_b32 v11,3,v0
v_mul_u32_u24 v3,1280,v10
v_lshl_add_u32 v3,v11,4,v3
v_lshrrev_b32 v10,3,v0
v_mul_u32_u24 v4,1280,v10
v_and_b32 v10,7,v0
v_lshl_add_u32 v4,v10,4,v4
v_and_b32 v10,15,v0
v_bfe_u32 v12,v0,4,1
v_lshrrev_b32 v13,5,v0
v_lshrrev_b32 v2,4,v0
v_lshlrev_b32 v2,13,v2
v_lshl_add_u32 v2,v10,4,v2
v_mul_u32_u24 v5,36864,v13
v_lshl_add_u32 v5,v12,10,v5
s_lshl_b32 s60,s3,6
v_add_u32 v5,s60,v5
v_lshl_add_u32 v6,v11,3,v5
v_bfe_u32 v14,v0,2,1
v_lshl_add_u32 v6,v14,8,v6
v_bfe_u32 v14,v0,3,1
v_lshl_add_u32 v6,v14,11,v6
v_lshl_add_u32 v5,v10,2,v5
v_add_u32 v48,73728,v5
v_add_u32 v49,73728,v6
v_lshlrev_b32 v8,10,v12
v_lshl_add_u32 v8,v13,9,v8
v_lshl_add_u32 v8,v10,2,v8
v_lshlrev_b32 v7,1,v8
v_add_u32 v8,s22,v8
v_add_u32 v7,s22,v7
v_add_u32 v9,s22,v1
s_waitcnt lgkmcnt(0)
s_mov_b32 s72,s64
s_and_b32 s73,s65,0xffff
s_mov_b32 s74,0x500000
s_mov_b32 s75,0x20000
s_mov_b32 s76,s66
s_and_b32 s77,s67,0xffff
s_mov_b32 s78,0x500000
s_mov_b32 s79,0x20000
s_mov_b32 s80,s68
s_and_b32 s81,s69,0xffff
s_mov_b32 s82,0x500000
s_mov_b32 s83,0x20000
s_mov_b32 s84,s70
s_and_b32 s85,s71,0xffff
s_mov_b32 s86,0x500000
s_mov_b32 s87,0x20000
v_lshrrev_b32 v10,3,v0
v_mul_u32_u24 v10,1280,v10
v_and_b32 v11,7,v0
v_lshlrev_b32 v12,2,v12
v_xor_b32 v11,v11,v12
v_lshl_add_u32 v10,v11,4,v10
s_add_u32 s60,s3,0
s_min_u32 s60,s60,9
s_lshl_b32 s23,s60,10
s_add_u32 s23,s23,147456
s_mov_b32 m0,s23
s_lshl_b32 s60,s60,7
buffer_load_dwordx4 v10,s[16:19],s60 offen lds
s_add_u32 s60,s3,4
s_min_u32 s60,s60,9
s_lshl_b32 s23,s60,10
s_add_u32 s23,s23,147456
s_mov_b32 m0,s23
s_lshl_b32 s60,s60,7
buffer_load_dwordx4 v10,s[16:19],s60 offen lds
s_add_u32 s60,s3,8
s_min_u32 s60,s60,9
s_lshl_b32 s23,s60,10
s_add_u32 s23,s23,147456
s_mov_b32 m0,s23
s_lshl_b32 s60,s60,7
buffer_load_dwordx4 v10,s[16:19],s60 offen lds
s_mul_i32 s60,s39,144
v_mov_b32 v50,72
v_mov_b32 v11,s60
v_and_b32 v52,1,v0
v_cmp_eq_u32 vcc,1,v52
s_nop 1
v_cndmask_b32 v50,v50,v11,vcc
v_mul_u32_u24 v52,96,v52
s_add_u32 s23,s22,20480
s_mov_b32 m0,s23
s_add_u32 s23,s63,0
buffer_load_dwordx4 v4,s[84:87],s23 offen nt lds
s_add_u32 s23,s22,21504
s_mov_b32 m0,s23
s_add_u32 s23,s63,10240
buffer_load_dwordx4 v4,s[84:87],s23 offen nt lds
s_add_u32 s23,s22,22528
s_mov_b32 m0,s23
s_add_u32 s23,s63,20480
buffer_load_dwordx4 v4,s[84:87],s23 offen nt lds
s_add_u32 s23,s22,23552
s_mov_b32 m0,s23
s_add_u32 s23,s63,30720
buffer_load_dwordx4 v4,s[84:87],s23 offen nt lds
s_add_u32 s23,s22,24576
s_mov_b32 m0,s23
s_add_u32 s23,s63,128
buffer_load_dwordx4 v4,s[84:87],s23 offen nt lds
s_add_u32 s23,s22,25600
s_mov_b32 m0,s23
s_add_u32 s23,s63,10368
buffer_load_dwordx4 v4,s[84:87],s23 offen nt lds
s_add_u32 s23,s22,26624
s_mov_b32 m0,s23
s_add_u32 s23,s63,20608
buffer_load_dwordx4 v4,s[84:87],s23 offen nt lds
s_add_u32 s23,s22,27648
s_mov_b32 m0,s23
s_add_u32 s23,s63,30848
buffer_load_dwordx4 v4,s[84:87],s23 offen nt lds
s_add_u32 s23,s22,28672
s_mov_b32 m0,s23
s_add_u32 s23,s63,40960
buffer_load_dwordx4 v4,s[84:87],s23 offen nt lds
s_add_u32 s23,s22,29696
s_mov_b32 m0,s23
s_add_u32 s23,s63,51200
buffer_load_dwordx4 v4,s[84:87],s23 offen nt lds
s_add_u32 s23,s22,30720
s_mov_b32 m0,s23
s_add_u32 s23,s63,61440
buffer_load_dwordx4 v4,s[84:87],s23 offen nt lds
s_add_u32 s23,s22,31744
s_mov_b32 m0,s23
s_add_u32 s23,s63,71680
buffer_load_dwordx4 v4,s[84:87],s23 offen nt lds
s_add_u32 s23,s22,32768
s_mov_b32 m0,s23
s_add_u32 s23,s63,41088
buffer_load_dwordx4 v4,s[84:87],s23 offen nt lds
s_add_u32 s23,s22,33792
s_mov_b32 m0,s23
s_add_u32 s23,s63,51328
buffer_load_dwordx4 v4,s[84:87],s23 offen nt lds
s_add_u32 s23,s22,34816
s_mov_b32 m0,s23
s_add_u32 s23,s63,61568
buffer_load_dwordx4 v4,s[84:87],s23 offen nt lds
s_add_u32 s23,s22,35840
s_mov_b32 m0,s23
s_add_u32 s23,s63,71808
buffer_load_dwordx4 v4,s[84:87],s23 offen nt lds
s_add_u32 s23,s22,0
s_mov_b32 m0,s23
s_add_u32 s23,s63,81920
buffer_load_dwordx4 v4,s[84:87],s23 offen nt lds
s_add_u32 s23,s22,1024
s_mov_b32 m0,s23
s_add_u32 s23,s63,92160
buffer_load_dwordx4 v4,s[84:87],s23 offen nt lds
s_add_u32 s23,s22,2048
s_mov_b32 m0,s23
s_add_u32 s23,s63,102400
buffer_load_dwordx4 v4,s[84:87],s23 offen nt lds
s_add_u32 s23,s22,3072
s_mov_b32 m0,s23
s_add_u32 s23,s63,112640
buffer_load_dwordx4 v4,s[84:87],s23 offen nt lds
s_add_u32 s23,s22,4096
s_mov_b32 m0,s23
s_add_u32 s23,s63,82048
buffer_load_dwordx4 v4,s[84:87],s23 offen nt lds
s_add_u32 s23,s22,5120
s_mov_b32 m0,s23
s_add_u32 s23,s63,92288
buffer_load_dwordx4 v4,s[84:87],s23 offen nt lds
s_add_u32 s23,s22,6144
s_mov_b32 m0,s23
s_add_u32 s23,s63,102528
buffer_load_dwordx4 v4,s[84:87],s23 offen nt lds
s_add_u32 s23,s22,7168
s_mov_b32 m0,s23
s_add_u32 s23,s63,112768
buffer_load_dwordx4 v4,s[84:87],s23 offen nt lds
s_add_u32 s23,s22,8192
s_mov_b32 m0,s23
s_add_u32 s23,s63,122880
buffer_load_dwordx4 v4,s[84:87],s23 offen nt lds
s_add_u32 s23,s22,9216
s_mov_b32 m0,s23
s_add_u32 s23,s63,133120
buffer_load_dwordx4 v4,s[84:87],s23 offen nt lds
s_add_u32 s23,s22,10240
s_mov_b32 m0,s23
s_add_u32 s23,s63,143360
buffer_load_dwordx4 v4,s[84:87],s23 offen nt lds
s_add_u32 s23,s22,11264
s_mov_b32 m0,s23
s_add_u32 s23,s63,153600
buffer_load_dwordx4 v4,s[84:87],s23 offen nt lds
s_add_u32 s23,s22,12288
s_mov_b32 m0,s23
s_add_u32 s23,s63,123008
buffer_load_dwordx4 v4,s[84:87],s23 offen nt lds
s_add_u32 s23,s22,13312
s_mov_b32 m0,s23
s_add_u32 s23,s63,133248
buffer_load_dwordx4 v4,s[84:87],s23 offen nt lds
s_add_u32 s23,s22,14336
s_mov_b32 m0,s23
s_add_u32 s23,s63,143488
buffer_load_dwordx4 v4,s[84:87],s23 offen nt lds
s_add_u32 s23,s22,15360
s_mov_b32 m0,s23
s_add_u32 s23,s63,153728
buffer_load_dwordx4 v4,s[84:87],s23 offen nt lds
s_add_u32 s23,s22,16384
s_mov_b32 m0,s23
s_add_u32 s23,s62,0
buffer_load_dwordx4 v3,s[84:87],s23 offen nt lds
s_add_u32 s23,s22,17408
s_mov_b32 m0,s23
s_add_u32 s23,s62,20480
buffer_load_dwordx4 v3,s[84:87],s23 offen nt lds
s_add_u32 s23,s22,18432
s_mov_b32 m0,s23
s_add_u32 s23,s62,40960
buffer_load_dwordx4 v3,s[84:87],s23 offen nt lds
s_add_u32 s23,s22,19456
s_mov_b32 m0,s23
s_add_u32 s23,s62,61440
buffer_load_dwordx4 v3,s[84:87],s23 offen nt lds
s_waitcnt vmcnt(32)
s_barrier
ds_read_b64 v[16:17],v7 offset:20480
ds_read_b64 v[18:19],v7 offset:20608
ds_read_b64 v[20:21],v7 offset:20992
ds_read_b64 v[22:23],v7 offset:21120
ds_read_b64 v[24:25],v7 offset:20736
ds_read_b64 v[26:27],v7 offset:20864
ds_read_b64 v[28:29],v7 offset:21248
ds_read_b64 v[30:31],v7 offset:21376
s_waitcnt lgkmcnt(0)
v_perm_b32 v144,v18,v16,s20
v_perm_b32 v145,v22,v20,s20
v_perm_b32 v146,v26,v24,s20
v_perm_b32 v147,v30,v28,s20
v_perm_b32 v160,v18,v16,s21
v_perm_b32 v161,v22,v20,s21
v_perm_b32 v162,v26,v24,s21
v_perm_b32 v163,v30,v28,s21
v_perm_b32 v176,v19,v17,s20
v_perm_b32 v177,v23,v21,s20
v_perm_b32 v178,v27,v25,s20
v_perm_b32 v179,v31,v29,s20
v_perm_b32 v192,v19,v17,s21
v_perm_b32 v193,v23,v21,s21
v_perm_b32 v194,v27,v25,s21
v_perm_b32 v195,v31,v29,s21
s_waitcnt vmcnt(28)
s_barrier
s_add_u32 s23,s22,20480
s_mov_b32 m0,s23
s_add_u32 s23,s62,81920
buffer_load_dwordx4 v3,s[84:87],s23 offen nt lds
s_add_u32 s23,s22,21504
s_mov_b32 m0,s23
s_add_u32 s23,s62,102400
buffer_load_dwordx4 v3,s[84:87],s23 offen nt lds
s_add_u32 s23,s22,22528
s_mov_b32 m0,s23
s_add_u32 s23,s62,122880
buffer_load_dwordx4 v3,s[84:87],s23 offen nt lds
s_add_u32 s23,s22,23552
s_mov_b32 m0,s23
s_add_u32 s23,s62,143360
buffer_load_dwordx4 v3,s[84:87],s23 offen nt lds
ds_read_b64 v[32:33],v7 offset:24576
ds_read_b64 v[34:35],v7 offset:24704
ds_read_b64 v[36:37],v7 offset:25088
ds_read_b64 v[38:39],v7 offset:25216
ds_read_b64 v[40:41],v7 offset:24832
ds_read_b64 v[42:43],v7 offset:24960
ds_read_b64 v[44:45],v7 offset:25344
ds_read_b64 v[46:47],v7 offset:25472
s_waitcnt lgkmcnt(0)
v_perm_b32 v208,v34,v32,s20
v_perm_b32 v209,v38,v36,s20
v_perm_b32 v210,v42,v40,s20
v_perm_b32 v211,v46,v44,s20
v_perm_b32 v224,v34,v32,s21
v_perm_b32 v225,v38,v36,s21
v_perm_b32 v226,v42,v40,s21
v_perm_b32 v227,v46,v44,s21
v_perm_b32 v240,v35,v33,s20
v_perm_b32 v241,v39,v37,s20
v_perm_b32 v242,v43,v41,s20
v_perm_b32 v243,v47,v45,s20
v_perm_b32 v68,v35,v33,s21
v_perm_b32 v69,v39,v37,s21
v_perm_b32 v70,v43,v41,s21
v_perm_b32 v71,v47,v45,s21
s_add_u32 s23,s42,20480
buffer_store_dwordx4 v[68:71],v1,s[4:7],s23 offen
s_waitcnt vmcnt(29)
s_barrier
s_add_u32 s23,s22,24576
s_mov_b32 m0,s23
s_add_u32 s23,s61,0
buffer_load_dwordx4 v2,s[72:75],s23 offen nt lds
s_add_u32 s23,s22,25600
s_mov_b32 m0,s23
s_add_u32 s23,s61,32768
buffer_load_dwordx4 v2,s[72:75],s23 offen nt lds
s_add_u32 s23,s22,26624
s_mov_b32 m0,s23
s_add_u32 s23,s61,65536
buffer_load_dwordx4 v2,s[72:75],s23 offen nt lds
s_add_u32 s23,s22,27648
s_mov_b32 m0,s23
s_add_u32 s23,s61,98304
buffer_load_dwordx4 v2,s[72:75],s23 offen nt lds
ds_read_b64 v[16:17],v7 offset:28672
ds_read_b64 v[18:19],v7 offset:28800
ds_read_b64 v[20:21],v7 offset:29184
ds_read_b64 v[22:23],v7 offset:29312
ds_read_b64 v[24:25],v7 offset:28928
ds_read_b64 v[26:27],v7 offset:29056
ds_read_b64 v[28:29],v7 offset:29440
ds_read_b64 v[30:31],v7 offset:29568
s_waitcnt lgkmcnt(0)
v_perm_b32 v148,v18,v16,s20
v_perm_b32 v149,v22,v20,s20
v_perm_b32 v150,v26,v24,s20
v_perm_b32 v151,v30,v28,s20
v_perm_b32 v164,v18,v16,s21
v_perm_b32 v165,v22,v20,s21
v_perm_b32 v166,v26,v24,s21
v_perm_b32 v167,v30,v28,s21
v_perm_b32 v180,v19,v17,s20
v_perm_b32 v181,v23,v21,s20
v_perm_b32 v182,v27,v25,s20
v_perm_b32 v183,v31,v29,s20
v_perm_b32 v196,v19,v17,s21
v_perm_b32 v197,v23,v21,s21
v_perm_b32 v198,v27,v25,s21
v_perm_b32 v199,v31,v29,s21
s_waitcnt vmcnt(29)
s_barrier
s_add_u32 s23,s22,28672
s_mov_b32 m0,s23
s_add_u32 s23,s61,0
buffer_load_dwordx4 v2,s[76:79],s23 offen nt lds
s_add_u32 s23,s22,29696
s_mov_b32 m0,s23
s_add_u32 s23,s61,32768
buffer_load_dwordx4 v2,s[76:79],s23 offen nt lds
s_add_u32 s23,s22,30720
s_mov_b32 m0,s23
s_add_u32 s23,s61,65536
buffer_load_dwordx4 v2,s[76:79],s23 offen nt lds
s_add_u32 s23,s22,31744
s_mov_b32 m0,s23
s_add_u32 s23,s61,98304
buffer_load_dwordx4 v2,s[76:79],s23 offen nt lds
ds_read_b64 v[32:33],v7 offset:32768
ds_read_b64 v[34:35],v7 offset:32896
ds_read_b64 v[36:37],v7 offset:33280
ds_read_b64 v[38:39],v7 offset:33408
ds_read_b64 v[40:41],v7 offset:33024
ds_read_b64 v[42:43],v7 offset:33152
ds_read_b64 v[44:45],v7 offset:33536
ds_read_b64 v[46:47],v7 offset:33664
s_waitcnt lgkmcnt(0)
v_perm_b32 v212,v34,v32,s20
v_perm_b32 v213,v38,v36,s20
v_perm_b32 v214,v42,v40,s20
v_perm_b32 v215,v46,v44,s20
v_perm_b32 v228,v34,v32,s21
v_perm_b32 v229,v38,v36,s21
v_perm_b32 v230,v42,v40,s21
v_perm_b32 v231,v46,v44,s21
v_perm_b32 v244,v35,v33,s20
v_perm_b32 v245,v39,v37,s20
v_perm_b32 v246,v43,v41,s20
v_perm_b32 v247,v47,v45,s20
v_perm_b32 v68,v35,v33,s21
v_perm_b32 v69,v39,v37,s21
v_perm_b32 v70,v43,v41,s21
v_perm_b32 v71,v47,v45,s21
s_add_u32 s23,s42,21504
buffer_store_dwordx4 v[68:71],v1,s[4:7],s23 offen
s_waitcnt vmcnt(30)
s_barrier
s_add_u32 s23,s22,32768
s_mov_b32 m0,s23
s_add_u32 s23,s61,524288
buffer_load_dwordx4 v2,s[72:75],s23 offen nt lds
s_add_u32 s23,s22,33792
s_mov_b32 m0,s23
s_add_u32 s23,s61,557056
buffer_load_dwordx4 v2,s[72:75],s23 offen nt lds
s_add_u32 s23,s22,34816
s_mov_b32 m0,s23
s_add_u32 s23,s61,589824
buffer_load_dwordx4 v2,s[72:75],s23 offen nt lds
s_add_u32 s23,s22,35840
s_mov_b32 m0,s23
s_add_u32 s23,s61,622592
buffer_load_dwordx4 v2,s[72:75],s23 offen nt lds
ds_read_b64 v[16:17],v7
ds_read_b64 v[18:19],v7 offset:128
ds_read_b64 v[20:21],v7 offset:512
ds_read_b64 v[22:23],v7 offset:640
ds_read_b64 v[24:25],v7 offset:256
ds_read_b64 v[26:27],v7 offset:384
ds_read_b64 v[28:29],v7 offset:768
ds_read_b64 v[30:31],v7 offset:896
s_waitcnt lgkmcnt(0)
v_perm_b32 v152,v18,v16,s20
v_perm_b32 v153,v22,v20,s20
v_perm_b32 v154,v26,v24,s20
v_perm_b32 v155,v30,v28,s20
v_perm_b32 v168,v18,v16,s21
v_perm_b32 v169,v22,v20,s21
v_perm_b32 v170,v26,v24,s21
v_perm_b32 v171,v30,v28,s21
v_perm_b32 v184,v19,v17,s20
v_perm_b32 v185,v23,v21,s20
v_perm_b32 v186,v27,v25,s20
v_perm_b32 v187,v31,v29,s20
v_perm_b32 v200,v19,v17,s21
v_perm_b32 v201,v23,v21,s21
v_perm_b32 v202,v27,v25,s21
v_perm_b32 v203,v31,v29,s21
s_waitcnt vmcnt(30)
s_barrier
s_add_u32 s23,s22,0
s_mov_b32 m0,s23
s_add_u32 s23,s61,524288
buffer_load_dwordx4 v2,s[76:79],s23 offen nt lds
s_add_u32 s23,s22,1024
s_mov_b32 m0,s23
s_add_u32 s23,s61,557056
buffer_load_dwordx4 v2,s[76:79],s23 offen nt lds
s_add_u32 s23,s22,2048
s_mov_b32 m0,s23
s_add_u32 s23,s61,589824
buffer_load_dwordx4 v2,s[76:79],s23 offen nt lds
s_add_u32 s23,s22,3072
s_mov_b32 m0,s23
s_add_u32 s23,s61,622592
buffer_load_dwordx4 v2,s[76:79],s23 offen nt lds
ds_read_b64 v[32:33],v7 offset:4096
ds_read_b64 v[34:35],v7 offset:4224
ds_read_b64 v[36:37],v7 offset:4608
ds_read_b64 v[38:39],v7 offset:4736
ds_read_b64 v[40:41],v7 offset:4352
ds_read_b64 v[42:43],v7 offset:4480
ds_read_b64 v[44:45],v7 offset:4864
ds_read_b64 v[46:47],v7 offset:4992
s_waitcnt lgkmcnt(0)
v_perm_b32 v216,v34,v32,s20
v_perm_b32 v217,v38,v36,s20
v_perm_b32 v218,v42,v40,s20
v_perm_b32 v219,v46,v44,s20
v_perm_b32 v232,v34,v32,s21
v_perm_b32 v233,v38,v36,s21
v_perm_b32 v234,v42,v40,s21
v_perm_b32 v235,v46,v44,s21
v_perm_b32 v248,v35,v33,s20
v_perm_b32 v249,v39,v37,s20
v_perm_b32 v250,v43,v41,s20
v_perm_b32 v251,v47,v45,s20
v_perm_b32 v68,v35,v33,s21
v_perm_b32 v69,v39,v37,s21
v_perm_b32 v70,v43,v41,s21
v_perm_b32 v71,v47,v45,s21
s_add_u32 s23,s42,22528
buffer_store_dwordx4 v[68:71],v1,s[4:7],s23 offen
s_waitcnt vmcnt(31)
s_barrier
s_add_u32 s23,s22,4096
s_mov_b32 m0,s23
s_add_u32 s23,s61,1048576
buffer_load_dwordx4 v2,s[72:75],s23 offen nt lds
s_add_u32 s23,s22,5120
s_mov_b32 m0,s23
s_add_u32 s23,s61,1081344
buffer_load_dwordx4 v2,s[72:75],s23 offen nt lds
s_add_u32 s23,s22,6144
s_mov_b32 m0,s23
s_add_u32 s23,s61,1114112
buffer_load_dwordx4 v2,s[72:75],s23 offen nt lds
s_add_u32 s23,s22,7168
s_mov_b32 m0,s23
s_add_u32 s23,s61,1146880
buffer_load_dwordx4 v2,s[72:75],s23 offen nt lds
ds_read_b64 v[16:17],v7 offset:8192
ds_read_b64 v[18:19],v7 offset:8320
ds_read_b64 v[20:21],v7 offset:8704
ds_read_b64 v[22:23],v7 offset:8832
ds_read_b64 v[24:25],v7 offset:8448
ds_read_b64 v[26:27],v7 offset:8576
ds_read_b64 v[28:29],v7 offset:8960
ds_read_b64 v[30:31],v7 offset:9088
s_waitcnt lgkmcnt(0)
v_perm_b32 v156,v18,v16,s20
v_perm_b32 v157,v22,v20,s20
v_perm_b32 v158,v26,v24,s20
v_perm_b32 v159,v30,v28,s20
v_perm_b32 v172,v18,v16,s21
v_perm_b32 v173,v22,v20,s21
v_perm_b32 v174,v26,v24,s21
v_perm_b32 v175,v30,v28,s21
v_perm_b32 v188,v19,v17,s20
v_perm_b32 v189,v23,v21,s20
v_perm_b32 v190,v27,v25,s20
v_perm_b32 v191,v31,v29,s20
v_perm_b32 v204,v19,v17,s21
v_perm_b32 v205,v23,v21,s21
v_perm_b32 v206,v27,v25,s21
v_perm_b32 v207,v31,v29,s21
s_waitcnt vmcnt(31)
s_barrier
s_add_u32 s23,s22,8192
s_mov_b32 m0,s23
s_add_u32 s23,s61,1048576
buffer_load_dwordx4 v2,s[76:79],s23 offen nt lds
s_add_u32 s23,s22,9216
s_mov_b32 m0,s23
s_add_u32 s23,s61,1081344
buffer_load_dwordx4 v2,s[76:79],s23 offen nt lds
s_add_u32 s23,s22,10240
s_mov_b32 m0,s23
s_add_u32 s23,s61,1114112
buffer_load_dwordx4 v2,s[76:79],s23 offen nt lds
s_add_u32 s23,s22,11264
s_mov_b32 m0,s23
s_add_u32 s23,s61,1146880
buffer_load_dwordx4 v2,s[76:79],s23 offen nt lds
ds_read_b64 v[32:33],v7 offset:12288
ds_read_b64 v[34:35],v7 offset:12416
ds_read_b64 v[36:37],v7 offset:12800
ds_read_b64 v[38:39],v7 offset:12928
ds_read_b64 v[40:41],v7 offset:12544
ds_read_b64 v[42:43],v7 offset:12672
ds_read_b64 v[44:45],v7 offset:13056
ds_read_b64 v[46:47],v7 offset:13184
s_waitcnt lgkmcnt(0)
v_perm_b32 v220,v34,v32,s20
v_perm_b32 v221,v38,v36,s20
v_perm_b32 v222,v42,v40,s20
v_perm_b32 v223,v46,v44,s20
v_perm_b32 v236,v34,v32,s21
v_perm_b32 v237,v38,v36,s21
v_perm_b32 v238,v42,v40,s21
v_perm_b32 v239,v46,v44,s21
v_perm_b32 v252,v35,v33,s20
v_perm_b32 v253,v39,v37,s20
v_perm_b32 v254,v43,v41,s20
v_perm_b32 v255,v47,v45,s20
v_perm_b32 v68,v35,v33,s21
v_perm_b32 v69,v39,v37,s21
v_perm_b32 v70,v43,v41,s21
v_perm_b32 v71,v47,v45,s21
s_add_u32 s23,s42,23552
buffer_store_dwordx4 v[68:71],v1,s[4:7],s23 offen
s_waitcnt vmcnt(32)
s_barrier
s_add_u32 s23,s22,12288
s_mov_b32 m0,s23
s_add_u32 s23,s61,1572864
buffer_load_dwordx4 v2,s[72:75],s23 offen nt lds
s_add_u32 s23,s22,13312
s_mov_b32 m0,s23
s_add_u32 s23,s61,1605632
buffer_load_dwordx4 v2,s[72:75],s23 offen nt lds
s_add_u32 s23,s22,14336
s_mov_b32 m0,s23
s_add_u32 s23,s61,1638400
buffer_load_dwordx4 v2,s[72:75],s23 offen nt lds
s_add_u32 s23,s22,15360
s_mov_b32 m0,s23
s_add_u32 s23,s61,1671168
buffer_load_dwordx4 v2,s[72:75],s23 offen nt lds
ds_read_b32 v16,v8 offset:16384
ds_read_b32 v17,v8 offset:16448
ds_read_b32 v18,v8 offset:16640
ds_read_b32 v19,v8 offset:16704
ds_read_b32 v20,v8 offset:16512
ds_read_b32 v21,v8 offset:16576
ds_read_b32 v22,v8 offset:16768
ds_read_b32 v23,v8 offset:16832
s_waitcnt lgkmcnt(4)
ds_read_b32 v24,v8 offset:18432
ds_read_b32 v25,v8 offset:18496
ds_read_b32 v26,v8 offset:18688
ds_read_b32 v27,v8 offset:18752
ds_read_b32 v28,v8 offset:18560
ds_read_b32 v29,v8 offset:18624
ds_read_b32 v30,v8 offset:18816
ds_read_b32 v31,v8 offset:18880
s_waitcnt lgkmcnt(0)
v_perm_b32 v56,v17,v16,s20
v_perm_b32 v57,v19,v18,s20
v_perm_b32 v58,v21,v20,s20
v_perm_b32 v59,v23,v22,s20
s_add_u32 s23,s42,12288
buffer_store_dwordx4 v[56:59],v1,s[4:7],s23 offen
v_perm_b32 v60,v25,v24,s20
v_perm_b32 v61,v27,v26,s20
v_perm_b32 v62,v29,v28,s20
v_perm_b32 v63,v31,v30,s20
s_add_u32 s23,s42,13312
buffer_store_dwordx4 v[60:63],v1,s[4:7],s23 offen
v_perm_b32 v64,v17,v16,s21
v_perm_b32 v65,v19,v18,s21
v_perm_b32 v66,v21,v20,s21
v_perm_b32 v67,v23,v22,s21
s_add_u32 s23,s42,16384
buffer_store_dwordx4 v[64:67],v1,s[4:7],s23 offen
v_perm_b32 v68,v25,v24,s21
v_perm_b32 v69,v27,v26,s21
v_perm_b32 v70,v29,v28,s21
v_perm_b32 v71,v31,v30,s21
s_add_u32 s23,s42,17408
buffer_store_dwordx4 v[68:71],v1,s[4:7],s23 offen
s_waitcnt vmcnt(36)
s_barrier
s_add_u32 s23,s22,16384
s_mov_b32 m0,s23
s_add_u32 s23,s61,1572864
buffer_load_dwordx4 v2,s[76:79],s23 offen nt lds
s_add_u32 s23,s22,17408
s_mov_b32 m0,s23
s_add_u32 s23,s61,1605632
buffer_load_dwordx4 v2,s[76:79],s23 offen nt lds
s_add_u32 s23,s22,18432
s_mov_b32 m0,s23
s_add_u32 s23,s61,1638400
buffer_load_dwordx4 v2,s[76:79],s23 offen nt lds
s_add_u32 s23,s22,19456
s_mov_b32 m0,s23
s_add_u32 s23,s61,1671168
buffer_load_dwordx4 v2,s[76:79],s23 offen nt lds
ds_read_b32 v32,v8 offset:20480
ds_read_b32 v33,v8 offset:20544
ds_read_b32 v34,v8 offset:20736
ds_read_b32 v35,v8 offset:20800
ds_read_b32 v36,v8 offset:20608
ds_read_b32 v37,v8 offset:20672
ds_read_b32 v38,v8 offset:20864
ds_read_b32 v39,v8 offset:20928
s_waitcnt lgkmcnt(4)
ds_read_b32 v40,v8 offset:22528
ds_read_b32 v41,v8 offset:22592
ds_read_b32 v42,v8 offset:22784
ds_read_b32 v43,v8 offset:22848
ds_read_b32 v44,v8 offset:22656
ds_read_b32 v45,v8 offset:22720
ds_read_b32 v46,v8 offset:22912
ds_read_b32 v47,v8 offset:22976
s_waitcnt lgkmcnt(0)
v_perm_b32 v56,v33,v32,s20
v_perm_b32 v57,v35,v34,s20
v_perm_b32 v58,v37,v36,s20
v_perm_b32 v59,v39,v38,s20
s_add_u32 s23,s42,14336
buffer_store_dwordx4 v[56:59],v1,s[4:7],s23 offen
v_perm_b32 v60,v41,v40,s20
v_perm_b32 v61,v43,v42,s20
v_perm_b32 v62,v45,v44,s20
v_perm_b32 v63,v47,v46,s20
s_add_u32 s23,s42,15360
buffer_store_dwordx4 v[60:63],v1,s[4:7],s23 offen
v_perm_b32 v64,v33,v32,s21
v_perm_b32 v65,v35,v34,s21
v_perm_b32 v66,v37,v36,s21
v_perm_b32 v67,v39,v38,s21
s_add_u32 s23,s42,18432
buffer_store_dwordx4 v[64:67],v1,s[4:7],s23 offen
v_perm_b32 v68,v41,v40,s21
v_perm_b32 v69,v43,v42,s21
v_perm_b32 v70,v45,v44,s21
v_perm_b32 v71,v47,v46,s21
s_add_u32 s23,s42,19456
buffer_store_dwordx4 v[68:71],v1,s[4:7],s23 offen
s_waitcnt vmcnt(39)
s_barrier
s_add_u32 s23,s22,20480
s_mov_b32 m0,s23
s_add_u32 s23,s61,2097152
buffer_load_dwordx4 v2,s[72:75],s23 offen nt lds
s_add_u32 s23,s22,21504
s_mov_b32 m0,s23
s_add_u32 s23,s61,2129920
buffer_load_dwordx4 v2,s[72:75],s23 offen nt lds
s_add_u32 s23,s22,22528
s_mov_b32 m0,s23
s_add_u32 s23,s61,2162688
buffer_load_dwordx4 v2,s[72:75],s23 offen nt lds
s_add_u32 s23,s22,23552
s_mov_b32 m0,s23
s_add_u32 s23,s61,2195456
buffer_load_dwordx4 v2,s[72:75],s23 offen nt lds
ds_read_b32 v16,v5 offset:24576
ds_read_b32 v17,v5 offset:24832
ds_read_b32 v18,v5 offset:26624
ds_read_b32 v19,v5 offset:26880
ds_read_b32 v20,v5 offset:25088
ds_read_b32 v21,v5 offset:25344
ds_read_b32 v22,v5 offset:27136
ds_read_b32 v23,v5 offset:27392
s_waitcnt lgkmcnt(4)
ds_read_b32 v24,v48 offset:24576
ds_read_b32 v25,v48 offset:24832
ds_read_b32 v26,v48 offset:26624
ds_read_b32 v27,v48 offset:26880
ds_read_b32 v28,v48 offset:25088
ds_read_b32 v29,v48 offset:25344
ds_read_b32 v30,v48 offset:27136
ds_read_b32 v31,v48 offset:27392
s_waitcnt lgkmcnt(0)
v_perm_b32 v96,v17,v16,s20
v_perm_b32 v97,v19,v18,s20
v_perm_b32 v98,v21,v20,s20
v_perm_b32 v99,v23,v22,s20
s_add_u32 s23,s42,0
buffer_store_dwordx4 v[96:99],v1,s[4:7],s23 offen
v_perm_b32 v100,v25,v24,s20
v_perm_b32 v101,v27,v26,s20
v_perm_b32 v102,v29,v28,s20
v_perm_b32 v103,v31,v30,s20
s_add_u32 s23,s42,1024
buffer_store_dwordx4 v[100:103],v1,s[4:7],s23 offen
v_perm_b32 v104,v17,v16,s21
v_perm_b32 v105,v19,v18,s21
v_perm_b32 v106,v21,v20,s21
v_perm_b32 v107,v23,v22,s21
s_add_u32 s23,s42,2048
buffer_store_dwordx4 v[104:107],v1,s[4:7],s23 offen
v_perm_b32 v108,v25,v24,s21
v_perm_b32 v109,v27,v26,s21
v_perm_b32 v110,v29,v28,s21
v_perm_b32 v111,v31,v30,s21
s_add_u32 s23,s42,3072
buffer_store_dwordx4 v[108:111],v1,s[4:7],s23 offen
s_waitcnt vmcnt(43)
s_barrier
s_add_u32 s23,s22,24576
s_mov_b32 m0,s23
s_add_u32 s23,s61,2097152
buffer_load_dwordx4 v2,s[76:79],s23 offen nt lds
s_add_u32 s23,s22,25600
s_mov_b32 m0,s23
s_add_u32 s23,s61,2129920
buffer_load_dwordx4 v2,s[76:79],s23 offen nt lds
s_add_u32 s23,s22,26624
s_mov_b32 m0,s23
s_add_u32 s23,s61,2162688
buffer_load_dwordx4 v2,s[76:79],s23 offen nt lds
s_add_u32 s23,s22,27648
s_mov_b32 m0,s23
s_add_u32 s23,s61,2195456
buffer_load_dwordx4 v2,s[76:79],s23 offen nt lds
ds_read_b32 v32,v5 offset:28672
ds_read_b32 v33,v5 offset:28928
ds_read_b32 v34,v5 offset:30720
ds_read_b32 v35,v5 offset:30976
ds_read_b32 v36,v5 offset:29184
ds_read_b32 v37,v5 offset:29440
ds_read_b32 v38,v5 offset:31232
ds_read_b32 v39,v5 offset:31488
s_waitcnt lgkmcnt(4)
ds_read_b32 v40,v48 offset:28672
ds_read_b32 v41,v48 offset:28928
ds_read_b32 v42,v48 offset:30720
ds_read_b32 v43,v48 offset:30976
ds_read_b32 v44,v48 offset:29184
ds_read_b32 v45,v48 offset:29440
ds_read_b32 v46,v48 offset:31232
ds_read_b32 v47,v48 offset:31488
s_waitcnt lgkmcnt(0)
v_perm_b32 v56,v33,v32,s20
v_perm_b32 v57,v35,v34,s20
v_perm_b32 v58,v37,v36,s20
v_perm_b32 v59,v39,v38,s20
v_accvgpr_write_b32 a120,v56
v_accvgpr_write_b32 a121,v57
v_accvgpr_write_b32 a122,v58
v_accvgpr_write_b32 a123,v59
v_perm_b32 v60,v41,v40,s20
v_perm_b32 v61,v43,v42,s20
v_perm_b32 v62,v45,v44,s20
v_perm_b32 v63,v47,v46,s20
v_accvgpr_write_b32 a124,v60
v_accvgpr_write_b32 a125,v61
v_accvgpr_write_b32 a126,v62
v_accvgpr_write_b32 a127,v63
v_perm_b32 v64,v33,v32,s21
v_perm_b32 v65,v35,v34,s21
v_perm_b32 v66,v37,v36,s21
v_perm_b32 v67,v39,v38,s21
v_accvgpr_write_b32 a192,v64
v_accvgpr_write_b32 a193,v65
v_accvgpr_write_b32 a194,v66
v_accvgpr_write_b32 a195,v67
v_perm_b32 v68,v41,v40,s21
v_perm_b32 v69,v43,v42,s21
v_perm_b32 v70,v45,v44,s21
v_perm_b32 v71,v47,v46,s21
v_accvgpr_write_b32 a196,v68
v_accvgpr_write_b32 a197,v69
v_accvgpr_write_b32 a198,v70
v_accvgpr_write_b32 a199,v71
s_waitcnt vmcnt(42)
s_barrier
s_add_u32 s23,s22,28672
s_mov_b32 m0,s23
s_add_u32 s23,s61,2621440
buffer_load_dwordx4 v2,s[72:75],s23 offen nt lds
s_add_u32 s23,s22,29696
s_mov_b32 m0,s23
s_add_u32 s23,s61,2654208
buffer_load_dwordx4 v2,s[72:75],s23 offen nt lds
s_add_u32 s23,s22,30720
s_mov_b32 m0,s23
s_add_u32 s23,s61,2686976
buffer_load_dwordx4 v2,s[72:75],s23 offen nt lds
s_add_u32 s23,s22,31744
s_mov_b32 m0,s23
s_add_u32 s23,s61,2719744
buffer_load_dwordx4 v2,s[72:75],s23 offen nt lds
ds_read_b32 v16,v5 offset:32768
ds_read_b32 v17,v5 offset:33024
ds_read_b32 v18,v5 offset:34816
ds_read_b32 v19,v5 offset:35072
ds_read_b32 v20,v5 offset:33280
ds_read_b32 v21,v5 offset:33536
ds_read_b32 v22,v5 offset:35328
ds_read_b32 v23,v5 offset:35584
s_waitcnt lgkmcnt(4)
ds_read_b32 v24,v48 offset:32768
ds_read_b32 v25,v48 offset:33024
ds_read_b32 v26,v48 offset:34816
ds_read_b32 v27,v48 offset:35072
ds_read_b32 v28,v48 offset:33280
ds_read_b32 v29,v48 offset:33536
ds_read_b32 v30,v48 offset:35328
ds_read_b32 v31,v48 offset:35584
s_waitcnt lgkmcnt(0)
v_perm_b32 v72,v17,v16,s20
v_perm_b32 v73,v19,v18,s20
v_perm_b32 v74,v21,v20,s20
v_perm_b32 v75,v23,v22,s20
s_add_u32 s23,s42,4096
buffer_store_dwordx4 v[72:75],v1,s[4:7],s23 offen
v_perm_b32 v76,v25,v24,s20
v_perm_b32 v77,v27,v26,s20
v_perm_b32 v78,v29,v28,s20
v_perm_b32 v79,v31,v30,s20
s_add_u32 s23,s42,5120
buffer_store_dwordx4 v[76:79],v1,s[4:7],s23 offen
v_perm_b32 v80,v17,v16,s21
v_perm_b32 v81,v19,v18,s21
v_perm_b32 v82,v21,v20,s21
v_perm_b32 v83,v23,v22,s21
s_add_u32 s23,s42,6144
buffer_store_dwordx4 v[80:83],v1,s[4:7],s23 offen
v_perm_b32 v84,v25,v24,s21
v_perm_b32 v85,v27,v26,s21
v_perm_b32 v86,v29,v28,s21
v_perm_b32 v87,v31,v30,s21
s_add_u32 s23,s42,7168
buffer_store_dwordx4 v[84:87],v1,s[4:7],s23 offen
s_waitcnt vmcnt(46)
s_barrier
s_add_u32 s23,s22,32768
s_mov_b32 m0,s23
s_add_u32 s23,s61,2621440
buffer_load_dwordx4 v2,s[76:79],s23 offen nt lds
s_add_u32 s23,s22,33792
s_mov_b32 m0,s23
s_add_u32 s23,s61,2654208
buffer_load_dwordx4 v2,s[76:79],s23 offen nt lds
s_add_u32 s23,s22,34816
s_mov_b32 m0,s23
s_add_u32 s23,s61,2686976
buffer_load_dwordx4 v2,s[76:79],s23 offen nt lds
s_add_u32 s23,s22,35840
s_mov_b32 m0,s23
s_add_u32 s23,s61,2719744
buffer_load_dwordx4 v2,s[76:79],s23 offen nt lds
ds_read_b32 v32,v5
ds_read_b32 v33,v5 offset:256
ds_read_b32 v34,v5 offset:2048
ds_read_b32 v35,v5 offset:2304
ds_read_b32 v36,v5 offset:512
ds_read_b32 v37,v5 offset:768
ds_read_b32 v38,v5 offset:2560
ds_read_b32 v39,v5 offset:2816
s_waitcnt lgkmcnt(4)
ds_read_b32 v40,v48
ds_read_b32 v41,v48 offset:256
ds_read_b32 v42,v48 offset:2048
ds_read_b32 v43,v48 offset:2304
ds_read_b32 v44,v48 offset:512
ds_read_b32 v45,v48 offset:768
ds_read_b32 v46,v48 offset:2560
ds_read_b32 v47,v48 offset:2816
s_waitcnt lgkmcnt(0)
v_perm_b32 v88,v33,v32,s20
v_perm_b32 v89,v35,v34,s20
v_perm_b32 v90,v37,v36,s20
v_perm_b32 v91,v39,v38,s20
s_add_u32 s23,s42,8192
buffer_store_dwordx4 v[88:91],v1,s[4:7],s23 offen
v_perm_b32 v92,v41,v40,s20
v_perm_b32 v93,v43,v42,s20
v_perm_b32 v94,v45,v44,s20
v_perm_b32 v95,v47,v46,s20
s_add_u32 s23,s42,9216
buffer_store_dwordx4 v[92:95],v1,s[4:7],s23 offen
v_perm_b32 v64,v33,v32,s21
v_perm_b32 v65,v35,v34,s21
v_perm_b32 v66,v37,v36,s21
v_perm_b32 v67,v39,v38,s21
v_accvgpr_write_b32 a200,v64
v_accvgpr_write_b32 a201,v65
v_accvgpr_write_b32 a202,v66
v_accvgpr_write_b32 a203,v67
v_perm_b32 v68,v41,v40,s21
v_perm_b32 v69,v43,v42,s21
v_perm_b32 v70,v45,v44,s21
v_perm_b32 v71,v47,v46,s21
v_accvgpr_write_b32 a204,v68
v_accvgpr_write_b32 a205,v69
v_accvgpr_write_b32 a206,v70
v_accvgpr_write_b32 a207,v71
s_waitcnt vmcnt(47)
s_barrier
s_add_u32 s23,s22,0
s_mov_b32 m0,s23
s_add_u32 s23,s61,3145728
buffer_load_dwordx4 v2,s[72:75],s23 offen nt lds
s_add_u32 s23,s22,1024
s_mov_b32 m0,s23
s_add_u32 s23,s61,3178496
buffer_load_dwordx4 v2,s[72:75],s23 offen nt lds
s_add_u32 s23,s22,2048
s_mov_b32 m0,s23
s_add_u32 s23,s61,3211264
buffer_load_dwordx4 v2,s[72:75],s23 offen nt lds
s_add_u32 s23,s22,3072
s_mov_b32 m0,s23
s_add_u32 s23,s61,3244032
buffer_load_dwordx4 v2,s[72:75],s23 offen nt lds
ds_read_b32 v16,v5 offset:4096
ds_read_b32 v17,v5 offset:4352
ds_read_b32 v18,v5 offset:6144
ds_read_b32 v19,v5 offset:6400
ds_read_b32 v20,v5 offset:4608
ds_read_b32 v21,v5 offset:4864
ds_read_b32 v22,v5 offset:6656
ds_read_b32 v23,v5 offset:6912
s_waitcnt lgkmcnt(4)
ds_read_b32 v24,v48 offset:4096
ds_read_b32 v25,v48 offset:4352
ds_read_b32 v26,v48 offset:6144
ds_read_b32 v27,v48 offset:6400
ds_read_b32 v28,v48 offset:4608
ds_read_b32 v29,v48 offset:4864
ds_read_b32 v30,v48 offset:6656
ds_read_b32 v31,v48 offset:6912
s_waitcnt lgkmcnt(0)
v_perm_b32 v56,v17,v16,s20
v_perm_b32 v57,v19,v18,s20
v_perm_b32 v58,v21,v20,s20
v_perm_b32 v59,v23,v22,s20
v_accvgpr_write_b32 a0,v56
v_accvgpr_write_b32 a1,v57
v_accvgpr_write_b32 a2,v58
v_accvgpr_write_b32 a3,v59
v_perm_b32 v60,v25,v24,s20
v_perm_b32 v61,v27,v26,s20
v_perm_b32 v62,v29,v28,s20
v_perm_b32 v63,v31,v30,s20
v_accvgpr_write_b32 a4,v60
v_accvgpr_write_b32 a5,v61
v_accvgpr_write_b32 a6,v62
v_accvgpr_write_b32 a7,v63
v_perm_b32 v64,v17,v16,s21
v_perm_b32 v65,v19,v18,s21
v_perm_b32 v66,v21,v20,s21
v_perm_b32 v67,v23,v22,s21
v_accvgpr_write_b32 a56,v64
v_accvgpr_write_b32 a57,v65
v_accvgpr_write_b32 a58,v66
v_accvgpr_write_b32 a59,v67
v_perm_b32 v68,v25,v24,s21
v_perm_b32 v69,v27,v26,s21
v_perm_b32 v70,v29,v28,s21
v_perm_b32 v71,v31,v30,s21
v_accvgpr_write_b32 a60,v68
v_accvgpr_write_b32 a61,v69
v_accvgpr_write_b32 a62,v70
v_accvgpr_write_b32 a63,v71
s_waitcnt vmcnt(47)
s_barrier
s_add_u32 s23,s22,4096
s_mov_b32 m0,s23
s_add_u32 s23,s61,3145728
buffer_load_dwordx4 v2,s[76:79],s23 offen nt lds
s_add_u32 s23,s22,5120
s_mov_b32 m0,s23
s_add_u32 s23,s61,3178496
buffer_load_dwordx4 v2,s[76:79],s23 offen nt lds
s_add_u32 s23,s22,6144
s_mov_b32 m0,s23
s_add_u32 s23,s61,3211264
buffer_load_dwordx4 v2,s[76:79],s23 offen nt lds
s_add_u32 s23,s22,7168
s_mov_b32 m0,s23
s_add_u32 s23,s61,3244032
buffer_load_dwordx4 v2,s[76:79],s23 offen nt lds
ds_read_b32 v32,v5 offset:8192
ds_read_b32 v33,v5 offset:8448
ds_read_b32 v34,v5 offset:10240
ds_read_b32 v35,v5 offset:10496
ds_read_b32 v36,v5 offset:8704
ds_read_b32 v37,v5 offset:8960
ds_read_b32 v38,v5 offset:10752
ds_read_b32 v39,v5 offset:11008
s_waitcnt lgkmcnt(4)
ds_read_b32 v40,v48 offset:8192
ds_read_b32 v41,v48 offset:8448
ds_read_b32 v42,v48 offset:10240
ds_read_b32 v43,v48 offset:10496
ds_read_b32 v44,v48 offset:8704
ds_read_b32 v45,v48 offset:8960
ds_read_b32 v46,v48 offset:10752
ds_read_b32 v47,v48 offset:11008
s_waitcnt lgkmcnt(0)
v_perm_b32 v56,v33,v32,s20
v_perm_b32 v57,v35,v34,s20
v_perm_b32 v58,v37,v36,s20
v_perm_b32 v59,v39,v38,s20
v_accvgpr_write_b32 a128,v56
v_accvgpr_write_b32 a129,v57
v_accvgpr_write_b32 a130,v58
v_accvgpr_write_b32 a131,v59
v_perm_b32 v60,v41,v40,s20
v_perm_b32 v61,v43,v42,s20
v_perm_b32 v62,v45,v44,s20
v_perm_b32 v63,v47,v46,s20
v_accvgpr_write_b32 a132,v60
v_accvgpr_write_b32 a133,v61
v_accvgpr_write_b32 a134,v62
v_accvgpr_write_b32 a135,v63
v_perm_b32 v64,v33,v32,s21
v_perm_b32 v65,v35,v34,s21
v_perm_b32 v66,v37,v36,s21
v_perm_b32 v67,v39,v38,s21
v_accvgpr_write_b32 a208,v64
v_accvgpr_write_b32 a209,v65
v_accvgpr_write_b32 a210,v66
v_accvgpr_write_b32 a211,v67
v_perm_b32 v68,v41,v40,s21
v_perm_b32 v69,v43,v42,s21
v_perm_b32 v70,v45,v44,s21
v_perm_b32 v71,v47,v46,s21
v_accvgpr_write_b32 a212,v68
v_accvgpr_write_b32 a213,v69
v_accvgpr_write_b32 a214,v70
v_accvgpr_write_b32 a215,v71
s_waitcnt vmcnt(46)
s_barrier
s_add_u32 s23,s22,8192
s_mov_b32 m0,s23
s_add_u32 s23,s61,3670016
buffer_load_dwordx4 v2,s[72:75],s23 offen nt lds
s_add_u32 s23,s22,9216
s_mov_b32 m0,s23
s_add_u32 s23,s61,3702784
buffer_load_dwordx4 v2,s[72:75],s23 offen nt lds
s_add_u32 s23,s22,10240
s_mov_b32 m0,s23
s_add_u32 s23,s61,3735552
buffer_load_dwordx4 v2,s[72:75],s23 offen nt lds
s_add_u32 s23,s22,11264
s_mov_b32 m0,s23
s_add_u32 s23,s61,3768320
buffer_load_dwordx4 v2,s[72:75],s23 offen nt lds
ds_read_b32 v16,v5 offset:12288
ds_read_b32 v17,v5 offset:12544
ds_read_b32 v18,v5 offset:14336
ds_read_b32 v19,v5 offset:14592
ds_read_b32 v20,v5 offset:12800
ds_read_b32 v21,v5 offset:13056
ds_read_b32 v22,v5 offset:14848
ds_read_b32 v23,v5 offset:15104
s_waitcnt lgkmcnt(4)
ds_read_b32 v24,v48 offset:12288
ds_read_b32 v25,v48 offset:12544
ds_read_b32 v26,v48 offset:14336
ds_read_b32 v27,v48 offset:14592
ds_read_b32 v28,v48 offset:12800
ds_read_b32 v29,v48 offset:13056
ds_read_b32 v30,v48 offset:14848
ds_read_b32 v31,v48 offset:15104
s_waitcnt lgkmcnt(0)
v_perm_b32 v56,v17,v16,s20
v_perm_b32 v57,v19,v18,s20
v_perm_b32 v58,v21,v20,s20
v_perm_b32 v59,v23,v22,s20
v_accvgpr_write_b32 a8,v56
v_accvgpr_write_b32 a9,v57
v_accvgpr_write_b32 a10,v58
v_accvgpr_write_b32 a11,v59
v_perm_b32 v60,v25,v24,s20
v_perm_b32 v61,v27,v26,s20
v_perm_b32 v62,v29,v28,s20
v_perm_b32 v63,v31,v30,s20
v_accvgpr_write_b32 a12,v60
v_accvgpr_write_b32 a13,v61
v_accvgpr_write_b32 a14,v62
v_accvgpr_write_b32 a15,v63
v_perm_b32 v64,v17,v16,s21
v_perm_b32 v65,v19,v18,s21
v_perm_b32 v66,v21,v20,s21
v_perm_b32 v67,v23,v22,s21
v_accvgpr_write_b32 a64,v64
v_accvgpr_write_b32 a65,v65
v_accvgpr_write_b32 a66,v66
v_accvgpr_write_b32 a67,v67
v_perm_b32 v68,v25,v24,s21
v_perm_b32 v69,v27,v26,s21
v_perm_b32 v70,v29,v28,s21
v_perm_b32 v71,v31,v30,s21
v_accvgpr_write_b32 a68,v68
v_accvgpr_write_b32 a69,v69
v_accvgpr_write_b32 a70,v70
v_accvgpr_write_b32 a71,v71
s_waitcnt vmcnt(42)
s_barrier
s_add_u32 s23,s22,12288
s_mov_b32 m0,s23
s_add_u32 s23,s61,3670016
buffer_load_dwordx4 v2,s[76:79],s23 offen nt lds
s_add_u32 s23,s22,13312
s_mov_b32 m0,s23
s_add_u32 s23,s61,3702784
buffer_load_dwordx4 v2,s[76:79],s23 offen nt lds
s_add_u32 s23,s22,14336
s_mov_b32 m0,s23
s_add_u32 s23,s61,3735552
buffer_load_dwordx4 v2,s[76:79],s23 offen nt lds
s_add_u32 s23,s22,15360
s_mov_b32 m0,s23
s_add_u32 s23,s61,3768320
buffer_load_dwordx4 v2,s[76:79],s23 offen nt lds
ds_read_b32 v32,v5 offset:16384
ds_read_b32 v33,v5 offset:16640
ds_read_b32 v34,v5 offset:18432
ds_read_b32 v35,v5 offset:18688
ds_read_b32 v36,v5 offset:16896
ds_read_b32 v37,v5 offset:17152
ds_read_b32 v38,v5 offset:18944
ds_read_b32 v39,v5 offset:19200
s_waitcnt lgkmcnt(4)
ds_read_b32 v40,v48 offset:16384
ds_read_b32 v41,v48 offset:16640
ds_read_b32 v42,v48 offset:18432
ds_read_b32 v43,v48 offset:18688
ds_read_b32 v44,v48 offset:16896
ds_read_b32 v45,v48 offset:17152
ds_read_b32 v46,v48 offset:18944
ds_read_b32 v47,v48 offset:19200
s_waitcnt lgkmcnt(0)
v_perm_b32 v56,v33,v32,s20
v_perm_b32 v57,v35,v34,s20
v_perm_b32 v58,v37,v36,s20
v_perm_b32 v59,v39,v38,s20
v_accvgpr_write_b32 a136,v56
v_accvgpr_write_b32 a137,v57
v_accvgpr_write_b32 a138,v58
v_accvgpr_write_b32 a139,v59
v_perm_b32 v60,v41,v40,s20
v_perm_b32 v61,v43,v42,s20
v_perm_b32 v62,v45,v44,s20
v_perm_b32 v63,v47,v46,s20
v_accvgpr_write_b32 a140,v60
v_accvgpr_write_b32 a141,v61
v_accvgpr_write_b32 a142,v62
v_accvgpr_write_b32 a143,v63
v_perm_b32 v64,v33,v32,s21
v_perm_b32 v65,v35,v34,s21
v_perm_b32 v66,v37,v36,s21
v_perm_b32 v67,v39,v38,s21
v_accvgpr_write_b32 a216,v64
v_accvgpr_write_b32 a217,v65
v_accvgpr_write_b32 a218,v66
v_accvgpr_write_b32 a219,v67
v_perm_b32 v68,v41,v40,s21
v_perm_b32 v69,v43,v42,s21
v_perm_b32 v70,v45,v44,s21
v_perm_b32 v71,v47,v46,s21
v_accvgpr_write_b32 a220,v68
v_accvgpr_write_b32 a221,v69
v_accvgpr_write_b32 a222,v70
v_accvgpr_write_b32 a223,v71
s_waitcnt vmcnt(38)
s_barrier
s_add_u32 s23,s22,16384
s_mov_b32 m0,s23
s_add_u32 s23,s61,4194304
buffer_load_dwordx4 v2,s[72:75],s23 offen nt lds
s_add_u32 s23,s22,17408
s_mov_b32 m0,s23
s_add_u32 s23,s61,4227072
buffer_load_dwordx4 v2,s[72:75],s23 offen nt lds
s_add_u32 s23,s22,18432
s_mov_b32 m0,s23
s_add_u32 s23,s61,4259840
buffer_load_dwordx4 v2,s[72:75],s23 offen nt lds
s_add_u32 s23,s22,19456
s_mov_b32 m0,s23
s_add_u32 s23,s61,4292608
buffer_load_dwordx4 v2,s[72:75],s23 offen nt lds
ds_read_b32 v16,v5 offset:20480
ds_read_b32 v17,v5 offset:20736
ds_read_b32 v18,v5 offset:22528
ds_read_b32 v19,v5 offset:22784
ds_read_b32 v20,v5 offset:20992
ds_read_b32 v21,v5 offset:21248
ds_read_b32 v22,v5 offset:23040
ds_read_b32 v23,v5 offset:23296
s_waitcnt lgkmcnt(4)
ds_read_b32 v24,v48 offset:20480
ds_read_b32 v25,v48 offset:20736
ds_read_b32 v26,v48 offset:22528
ds_read_b32 v27,v48 offset:22784
ds_read_b32 v28,v48 offset:20992
ds_read_b32 v29,v48 offset:21248
ds_read_b32 v30,v48 offset:23040
ds_read_b32 v31,v48 offset:23296
s_waitcnt lgkmcnt(0)
v_perm_b32 v56,v17,v16,s20
v_perm_b32 v57,v19,v18,s20
v_perm_b32 v58,v21,v20,s20
v_perm_b32 v59,v23,v22,s20
v_accvgpr_write_b32 a16,v56
v_accvgpr_write_b32 a17,v57
v_accvgpr_write_b32 a18,v58
v_accvgpr_write_b32 a19,v59
v_perm_b32 v60,v25,v24,s20
v_perm_b32 v61,v27,v26,s20
v_perm_b32 v62,v29,v28,s20
v_perm_b32 v63,v31,v30,s20
v_accvgpr_write_b32 a20,v60
v_accvgpr_write_b32 a21,v61
v_accvgpr_write_b32 a22,v62
v_accvgpr_write_b32 a23,v63
v_perm_b32 v64,v17,v16,s21
v_perm_b32 v65,v19,v18,s21
v_perm_b32 v66,v21,v20,s21
v_perm_b32 v67,v23,v22,s21
v_accvgpr_write_b32 a72,v64
v_accvgpr_write_b32 a73,v65
v_accvgpr_write_b32 a74,v66
v_accvgpr_write_b32 a75,v67
v_perm_b32 v68,v25,v24,s21
v_perm_b32 v69,v27,v26,s21
v_perm_b32 v70,v29,v28,s21
v_perm_b32 v71,v31,v30,s21
v_accvgpr_write_b32 a76,v68
v_accvgpr_write_b32 a77,v69
v_accvgpr_write_b32 a78,v70
v_accvgpr_write_b32 a79,v71
s_waitcnt vmcnt(34)
s_barrier
s_add_u32 s23,s22,20480
s_mov_b32 m0,s23
s_add_u32 s23,s61,4194304
buffer_load_dwordx4 v2,s[76:79],s23 offen nt lds
s_add_u32 s23,s22,21504
s_mov_b32 m0,s23
s_add_u32 s23,s61,4227072
buffer_load_dwordx4 v2,s[76:79],s23 offen nt lds
s_add_u32 s23,s22,22528
s_mov_b32 m0,s23
s_add_u32 s23,s61,4259840
buffer_load_dwordx4 v2,s[76:79],s23 offen nt lds
s_add_u32 s23,s22,23552
s_mov_b32 m0,s23
s_add_u32 s23,s61,4292608
buffer_load_dwordx4 v2,s[76:79],s23 offen nt lds
ds_read_b32 v32,v5 offset:24576
ds_read_b32 v33,v5 offset:24832
ds_read_b32 v34,v5 offset:26624
ds_read_b32 v35,v5 offset:26880
ds_read_b32 v36,v5 offset:25088
ds_read_b32 v37,v5 offset:25344
ds_read_b32 v38,v5 offset:27136
ds_read_b32 v39,v5 offset:27392
s_waitcnt lgkmcnt(4)
ds_read_b32 v40,v48 offset:24576
ds_read_b32 v41,v48 offset:24832
ds_read_b32 v42,v48 offset:26624
ds_read_b32 v43,v48 offset:26880
ds_read_b32 v44,v48 offset:25088
ds_read_b32 v45,v48 offset:25344
ds_read_b32 v46,v48 offset:27136
ds_read_b32 v47,v48 offset:27392
s_waitcnt lgkmcnt(0)
v_perm_b32 v56,v33,v32,s20
v_perm_b32 v57,v35,v34,s20
v_perm_b32 v58,v37,v36,s20
v_perm_b32 v59,v39,v38,s20
v_accvgpr_write_b32 a144,v56
v_accvgpr_write_b32 a145,v57
v_accvgpr_write_b32 a146,v58
v_accvgpr_write_b32 a147,v59
v_perm_b32 v60,v41,v40,s20
v_perm_b32 v61,v43,v42,s20
v_perm_b32 v62,v45,v44,s20
v_perm_b32 v63,v47,v46,s20
v_accvgpr_write_b32 a148,v60
v_accvgpr_write_b32 a149,v61
v_accvgpr_write_b32 a150,v62
v_accvgpr_write_b32 a151,v63
v_perm_b32 v64,v33,v32,s21
v_perm_b32 v65,v35,v34,s21
v_perm_b32 v66,v37,v36,s21
v_perm_b32 v67,v39,v38,s21
v_accvgpr_write_b32 a224,v64
v_accvgpr_write_b32 a225,v65
v_accvgpr_write_b32 a226,v66
v_accvgpr_write_b32 a227,v67
v_perm_b32 v68,v41,v40,s21
v_perm_b32 v69,v43,v42,s21
v_perm_b32 v70,v45,v44,s21
v_perm_b32 v71,v47,v46,s21
v_accvgpr_write_b32 a228,v68
v_accvgpr_write_b32 a229,v69
v_accvgpr_write_b32 a230,v70
v_accvgpr_write_b32 a231,v71
s_waitcnt vmcnt(34)
s_barrier
s_add_u32 s23,s22,24576
s_mov_b32 m0,s23
s_add_u32 s23,s61,4718592
buffer_load_dwordx4 v2,s[72:75],s23 offen nt lds
s_add_u32 s23,s22,25600
s_mov_b32 m0,s23
s_add_u32 s23,s61,4751360
buffer_load_dwordx4 v2,s[72:75],s23 offen nt lds
s_add_u32 s23,s22,26624
s_mov_b32 m0,s23
s_add_u32 s23,s61,4784128
buffer_load_dwordx4 v2,s[72:75],s23 offen nt lds
s_add_u32 s23,s22,27648
s_mov_b32 m0,s23
s_add_u32 s23,s61,4816896
buffer_load_dwordx4 v2,s[72:75],s23 offen nt lds
ds_read_b32 v16,v5 offset:28672
ds_read_b32 v17,v5 offset:28928
ds_read_b32 v18,v5 offset:30720
ds_read_b32 v19,v5 offset:30976
ds_read_b32 v20,v5 offset:29184
ds_read_b32 v21,v5 offset:29440
ds_read_b32 v22,v5 offset:31232
ds_read_b32 v23,v5 offset:31488
s_waitcnt lgkmcnt(4)
ds_read_b32 v24,v48 offset:28672
ds_read_b32 v25,v48 offset:28928
ds_read_b32 v26,v48 offset:30720
ds_read_b32 v27,v48 offset:30976
ds_read_b32 v28,v48 offset:29184
ds_read_b32 v29,v48 offset:29440
ds_read_b32 v30,v48 offset:31232
ds_read_b32 v31,v48 offset:31488
s_waitcnt lgkmcnt(0)
v_perm_b32 v56,v17,v16,s20
v_perm_b32 v57,v19,v18,s20
v_perm_b32 v58,v21,v20,s20
v_perm_b32 v59,v23,v22,s20
v_accvgpr_write_b32 a24,v56
v_accvgpr_write_b32 a25,v57
v_accvgpr_write_b32 a26,v58
v_accvgpr_write_b32 a27,v59
v_perm_b32 v60,v25,v24,s20
v_perm_b32 v61,v27,v26,s20
v_perm_b32 v62,v29,v28,s20
v_perm_b32 v63,v31,v30,s20
v_accvgpr_write_b32 a28,v60
v_accvgpr_write_b32 a29,v61
v_accvgpr_write_b32 a30,v62
v_accvgpr_write_b32 a31,v63
v_perm_b32 v64,v17,v16,s21
v_perm_b32 v65,v19,v18,s21
v_perm_b32 v66,v21,v20,s21
v_perm_b32 v67,v23,v22,s21
v_accvgpr_write_b32 a80,v64
v_accvgpr_write_b32 a81,v65
v_accvgpr_write_b32 a82,v66
v_accvgpr_write_b32 a83,v67
v_perm_b32 v68,v25,v24,s21
v_perm_b32 v69,v27,v26,s21
v_perm_b32 v70,v29,v28,s21
v_perm_b32 v71,v31,v30,s21
v_accvgpr_write_b32 a84,v68
v_accvgpr_write_b32 a85,v69
v_accvgpr_write_b32 a86,v70
v_accvgpr_write_b32 a87,v71
s_waitcnt vmcnt(30)
s_barrier
s_add_u32 s23,s22,28672
s_mov_b32 m0,s23
s_add_u32 s23,s61,4718592
buffer_load_dwordx4 v2,s[76:79],s23 offen nt lds
s_add_u32 s23,s22,29696
s_mov_b32 m0,s23
s_add_u32 s23,s61,4751360
buffer_load_dwordx4 v2,s[76:79],s23 offen nt lds
s_add_u32 s23,s22,30720
s_mov_b32 m0,s23
s_add_u32 s23,s61,4784128
buffer_load_dwordx4 v2,s[76:79],s23 offen nt lds
s_add_u32 s23,s22,31744
s_mov_b32 m0,s23
s_add_u32 s23,s61,4816896
buffer_load_dwordx4 v2,s[76:79],s23 offen nt lds
ds_read_b32 v32,v5 offset:32768
ds_read_b32 v33,v5 offset:33024
ds_read_b32 v34,v5 offset:34816
ds_read_b32 v35,v5 offset:35072
ds_read_b32 v36,v5 offset:33280
ds_read_b32 v37,v5 offset:33536
ds_read_b32 v38,v5 offset:35328
ds_read_b32 v39,v5 offset:35584
s_waitcnt lgkmcnt(4)
ds_read_b32 v40,v48 offset:32768
ds_read_b32 v41,v48 offset:33024
ds_read_b32 v42,v48 offset:34816
ds_read_b32 v43,v48 offset:35072
ds_read_b32 v44,v48 offset:33280
ds_read_b32 v45,v48 offset:33536
ds_read_b32 v46,v48 offset:35328
ds_read_b32 v47,v48 offset:35584
s_waitcnt lgkmcnt(0)
v_perm_b32 v56,v33,v32,s20
v_perm_b32 v57,v35,v34,s20
v_perm_b32 v58,v37,v36,s20
v_perm_b32 v59,v39,v38,s20
v_accvgpr_write_b32 a152,v56
v_accvgpr_write_b32 a153,v57
v_accvgpr_write_b32 a154,v58
v_accvgpr_write_b32 a155,v59
v_perm_b32 v60,v41,v40,s20
v_perm_b32 v61,v43,v42,s20
v_perm_b32 v62,v45,v44,s20
v_perm_b32 v63,v47,v46,s20
v_accvgpr_write_b32 a156,v60
v_accvgpr_write_b32 a157,v61
v_accvgpr_write_b32 a158,v62
v_accvgpr_write_b32 a159,v63
v_perm_b32 v64,v33,v32,s21
v_perm_b32 v65,v35,v34,s21
v_perm_b32 v66,v37,v36,s21
v_perm_b32 v67,v39,v38,s21
v_accvgpr_write_b32 a232,v64
v_accvgpr_write_b32 a233,v65
v_accvgpr_write_b32 a234,v66
v_accvgpr_write_b32 a235,v67
v_perm_b32 v68,v41,v40,s21
v_perm_b32 v69,v43,v42,s21
v_perm_b32 v70,v45,v44,s21
v_perm_b32 v71,v47,v46,s21
v_accvgpr_write_b32 a236,v68
v_accvgpr_write_b32 a237,v69
v_accvgpr_write_b32 a238,v70
v_accvgpr_write_b32 a239,v71
s_waitcnt vmcnt(28)
s_barrier
s_add_u32 s23,s22,32768
s_mov_b32 m0,s23
s_add_u32 s23,s61,4718592
buffer_load_dwordx4 v2,s[80:83],s23 offen nt lds
s_add_u32 s23,s22,33792
s_mov_b32 m0,s23
s_add_u32 s23,s61,4751360
buffer_load_dwordx4 v2,s[80:83],s23 offen nt lds
s_add_u32 s23,s22,34816
s_mov_b32 m0,s23
s_add_u32 s23,s61,4784128
buffer_load_dwordx4 v2,s[80:83],s23 offen nt lds
s_add_u32 s23,s22,35840
s_mov_b32 m0,s23
s_add_u32 s23,s61,4816896
buffer_load_dwordx4 v2,s[80:83],s23 offen nt lds
ds_read_b32 v16,v5
ds_read_b32 v17,v5 offset:256
ds_read_b32 v18,v5 offset:2048
ds_read_b32 v19,v5 offset:2304
ds_read_b32 v20,v5 offset:512
ds_read_b32 v21,v5 offset:768
ds_read_b32 v22,v5 offset:2560
ds_read_b32 v23,v5 offset:2816
s_waitcnt lgkmcnt(4)
ds_read_b32 v24,v48
ds_read_b32 v25,v48 offset:256
ds_read_b32 v26,v48 offset:2048
ds_read_b32 v27,v48 offset:2304
ds_read_b32 v28,v48 offset:512
ds_read_b32 v29,v48 offset:768
ds_read_b32 v30,v48 offset:2560
ds_read_b32 v31,v48 offset:2816
s_waitcnt lgkmcnt(0)
v_perm_b32 v56,v17,v16,s20
v_perm_b32 v57,v19,v18,s20
v_perm_b32 v58,v21,v20,s20
v_perm_b32 v59,v23,v22,s20
v_accvgpr_write_b32 a32,v56
v_accvgpr_write_b32 a33,v57
v_accvgpr_write_b32 a34,v58
v_accvgpr_write_b32 a35,v59
v_perm_b32 v60,v25,v24,s20
v_perm_b32 v61,v27,v26,s20
v_perm_b32 v62,v29,v28,s20
v_perm_b32 v63,v31,v30,s20
v_accvgpr_write_b32 a36,v60
v_accvgpr_write_b32 a37,v61
v_accvgpr_write_b32 a38,v62
v_accvgpr_write_b32 a39,v63
v_perm_b32 v64,v17,v16,s21
v_perm_b32 v65,v19,v18,s21
v_perm_b32 v66,v21,v20,s21
v_perm_b32 v67,v23,v22,s21
v_accvgpr_write_b32 a88,v64
v_accvgpr_write_b32 a89,v65
v_accvgpr_write_b32 a90,v66
v_accvgpr_write_b32 a91,v67
v_perm_b32 v68,v25,v24,s21
v_perm_b32 v69,v27,v26,s21
v_perm_b32 v70,v29,v28,s21
v_perm_b32 v71,v31,v30,s21
v_accvgpr_write_b32 a92,v68
v_accvgpr_write_b32 a93,v69
v_accvgpr_write_b32 a94,v70
v_accvgpr_write_b32 a95,v71
s_waitcnt vmcnt(28)
s_barrier
s_add_u32 s23,s22,0
s_mov_b32 m0,s23
s_add_u32 s23,s61,0
buffer_load_dwordx4 v2,s[80:83],s23 offen nt lds
s_add_u32 s23,s22,1024
s_mov_b32 m0,s23
s_add_u32 s23,s61,32768
buffer_load_dwordx4 v2,s[80:83],s23 offen nt lds
s_add_u32 s23,s22,2048
s_mov_b32 m0,s23
s_add_u32 s23,s61,65536
buffer_load_dwordx4 v2,s[80:83],s23 offen nt lds
s_add_u32 s23,s22,3072
s_mov_b32 m0,s23
s_add_u32 s23,s61,98304
buffer_load_dwordx4 v2,s[80:83],s23 offen nt lds
ds_read_b32 v32,v5 offset:4096
ds_read_b32 v33,v5 offset:4352
ds_read_b32 v34,v5 offset:6144
ds_read_b32 v35,v5 offset:6400
ds_read_b32 v36,v5 offset:4608
ds_read_b32 v37,v5 offset:4864
ds_read_b32 v38,v5 offset:6656
ds_read_b32 v39,v5 offset:6912
s_waitcnt lgkmcnt(4)
ds_read_b32 v40,v48 offset:4096
ds_read_b32 v41,v48 offset:4352
ds_read_b32 v42,v48 offset:6144
ds_read_b32 v43,v48 offset:6400
ds_read_b32 v44,v48 offset:4608
ds_read_b32 v45,v48 offset:4864
ds_read_b32 v46,v48 offset:6656
ds_read_b32 v47,v48 offset:6912
s_waitcnt lgkmcnt(0)
v_perm_b32 v56,v33,v32,s20
v_perm_b32 v57,v35,v34,s20
v_perm_b32 v58,v37,v36,s20
v_perm_b32 v59,v39,v38,s20
v_accvgpr_write_b32 a160,v56
v_accvgpr_write_b32 a161,v57
v_accvgpr_write_b32 a162,v58
v_accvgpr_write_b32 a163,v59
v_perm_b32 v60,v41,v40,s20
v_perm_b32 v61,v43,v42,s20
v_perm_b32 v62,v45,v44,s20
v_perm_b32 v63,v47,v46,s20
v_accvgpr_write_b32 a164,v60
v_accvgpr_write_b32 a165,v61
v_accvgpr_write_b32 a166,v62
v_accvgpr_write_b32 a167,v63
v_perm_b32 v64,v33,v32,s21
v_perm_b32 v65,v35,v34,s21
v_perm_b32 v66,v37,v36,s21
v_perm_b32 v67,v39,v38,s21
v_accvgpr_write_b32 a240,v64
v_accvgpr_write_b32 a241,v65
v_accvgpr_write_b32 a242,v66
v_accvgpr_write_b32 a243,v67
v_perm_b32 v68,v41,v40,s21
v_perm_b32 v69,v43,v42,s21
v_perm_b32 v70,v45,v44,s21
v_perm_b32 v71,v47,v46,s21
v_accvgpr_write_b32 a244,v68
v_accvgpr_write_b32 a245,v69
v_accvgpr_write_b32 a246,v70
v_accvgpr_write_b32 a247,v71
s_waitcnt vmcnt(28)
s_barrier
s_add_u32 s23,s22,4096
s_mov_b32 m0,s23
s_add_u32 s23,s61,524288
buffer_load_dwordx4 v2,s[80:83],s23 offen nt lds
s_add_u32 s23,s22,5120
s_mov_b32 m0,s23
s_add_u32 s23,s61,557056
buffer_load_dwordx4 v2,s[80:83],s23 offen nt lds
s_add_u32 s23,s22,6144
s_mov_b32 m0,s23
s_add_u32 s23,s61,589824
buffer_load_dwordx4 v2,s[80:83],s23 offen nt lds
s_add_u32 s23,s22,7168
s_mov_b32 m0,s23
s_add_u32 s23,s61,622592
buffer_load_dwordx4 v2,s[80:83],s23 offen nt lds
ds_read_b32 v16,v5 offset:8192
ds_read_b32 v17,v5 offset:8448
ds_read_b32 v18,v5 offset:10240
ds_read_b32 v19,v5 offset:10496
ds_read_b32 v20,v5 offset:8704
ds_read_b32 v21,v5 offset:8960
ds_read_b32 v22,v5 offset:10752
ds_read_b32 v23,v5 offset:11008
s_waitcnt lgkmcnt(4)
ds_read_b32 v24,v48 offset:8192
ds_read_b32 v25,v48 offset:8448
ds_read_b32 v26,v48 offset:10240
ds_read_b32 v27,v48 offset:10496
ds_read_b32 v28,v48 offset:8704
ds_read_b32 v29,v48 offset:8960
ds_read_b32 v30,v48 offset:10752
ds_read_b32 v31,v48 offset:11008
s_waitcnt lgkmcnt(0)
v_perm_b32 v56,v17,v16,s20
v_perm_b32 v57,v19,v18,s20
v_perm_b32 v58,v21,v20,s20
v_perm_b32 v59,v23,v22,s20
v_accvgpr_write_b32 a40,v56
v_accvgpr_write_b32 a41,v57
v_accvgpr_write_b32 a42,v58
v_accvgpr_write_b32 a43,v59
v_perm_b32 v60,v25,v24,s20
v_perm_b32 v61,v27,v26,s20
v_perm_b32 v62,v29,v28,s20
v_perm_b32 v63,v31,v30,s20
v_accvgpr_write_b32 a44,v60
v_accvgpr_write_b32 a45,v61
v_accvgpr_write_b32 a46,v62
v_accvgpr_write_b32 a47,v63
v_perm_b32 v64,v17,v16,s21
v_perm_b32 v65,v19,v18,s21
v_perm_b32 v66,v21,v20,s21
v_perm_b32 v67,v23,v22,s21
v_accvgpr_write_b32 a96,v64
v_accvgpr_write_b32 a97,v65
v_accvgpr_write_b32 a98,v66
v_accvgpr_write_b32 a99,v67
v_perm_b32 v68,v25,v24,s21
v_perm_b32 v69,v27,v26,s21
v_perm_b32 v70,v29,v28,s21
v_perm_b32 v71,v31,v30,s21
v_accvgpr_write_b32 a100,v68
v_accvgpr_write_b32 a101,v69
v_accvgpr_write_b32 a102,v70
v_accvgpr_write_b32 a103,v71
s_waitcnt vmcnt(28)
s_barrier
s_add_u32 s23,s22,8192
s_mov_b32 m0,s23
s_add_u32 s23,s61,1048576
buffer_load_dwordx4 v2,s[80:83],s23 offen nt lds
s_add_u32 s23,s22,9216
s_mov_b32 m0,s23
s_add_u32 s23,s61,1081344
buffer_load_dwordx4 v2,s[80:83],s23 offen nt lds
s_add_u32 s23,s22,10240
s_mov_b32 m0,s23
s_add_u32 s23,s61,1114112
buffer_load_dwordx4 v2,s[80:83],s23 offen nt lds
s_add_u32 s23,s22,11264
s_mov_b32 m0,s23
s_add_u32 s23,s61,1146880
buffer_load_dwordx4 v2,s[80:83],s23 offen nt lds
ds_read_b32 v32,v5 offset:12288
ds_read_b32 v33,v5 offset:12544
ds_read_b32 v34,v5 offset:14336
ds_read_b32 v35,v5 offset:14592
ds_read_b32 v36,v5 offset:12800
ds_read_b32 v37,v5 offset:13056
ds_read_b32 v38,v5 offset:14848
ds_read_b32 v39,v5 offset:15104
s_waitcnt lgkmcnt(4)
ds_read_b32 v40,v48 offset:12288
ds_read_b32 v41,v48 offset:12544
ds_read_b32 v42,v48 offset:14336
ds_read_b32 v43,v48 offset:14592
ds_read_b32 v44,v48 offset:12800
ds_read_b32 v45,v48 offset:13056
ds_read_b32 v46,v48 offset:14848
ds_read_b32 v47,v48 offset:15104
s_waitcnt lgkmcnt(0)
v_perm_b32 v56,v33,v32,s20
v_perm_b32 v57,v35,v34,s20
v_perm_b32 v58,v37,v36,s20
v_perm_b32 v59,v39,v38,s20
v_accvgpr_write_b32 a168,v56
v_accvgpr_write_b32 a169,v57
v_accvgpr_write_b32 a170,v58
v_accvgpr_write_b32 a171,v59
v_perm_b32 v60,v41,v40,s20
v_perm_b32 v61,v43,v42,s20
v_perm_b32 v62,v45,v44,s20
v_perm_b32 v63,v47,v46,s20
v_accvgpr_write_b32 a172,v60
v_accvgpr_write_b32 a173,v61
v_accvgpr_write_b32 a174,v62
v_accvgpr_write_b32 a175,v63
v_perm_b32 v64,v33,v32,s21
v_perm_b32 v65,v35,v34,s21
v_perm_b32 v66,v37,v36,s21
v_perm_b32 v67,v39,v38,s21
v_accvgpr_write_b32 a248,v64
v_accvgpr_write_b32 a249,v65
v_accvgpr_write_b32 a250,v66
v_accvgpr_write_b32 a251,v67
v_perm_b32 v68,v41,v40,s21
v_perm_b32 v69,v43,v42,s21
v_perm_b32 v70,v45,v44,s21
v_perm_b32 v71,v47,v46,s21
v_accvgpr_write_b32 a252,v68
v_accvgpr_write_b32 a253,v69
v_accvgpr_write_b32 a254,v70
v_accvgpr_write_b32 a255,v71
s_waitcnt vmcnt(28)
s_barrier
s_add_u32 s23,s22,12288
s_mov_b32 m0,s23
s_add_u32 s23,s61,1572864
buffer_load_dwordx4 v2,s[80:83],s23 offen nt lds
s_add_u32 s23,s22,13312
s_mov_b32 m0,s23
s_add_u32 s23,s61,1605632
buffer_load_dwordx4 v2,s[80:83],s23 offen nt lds
s_add_u32 s23,s22,14336
s_mov_b32 m0,s23
s_add_u32 s23,s61,1638400
buffer_load_dwordx4 v2,s[80:83],s23 offen nt lds
s_add_u32 s23,s22,15360
s_mov_b32 m0,s23
s_add_u32 s23,s61,1671168
buffer_load_dwordx4 v2,s[80:83],s23 offen nt lds
s_add_u32 s23,s2,s3
s_cmp_lg_u32 s23,0
s_cbranch_scc1 ch_nl_1
s_mov_b32 s23,132
v_mov_b32 v51,1
s_mov_b64 exec,1
buffer_store_dword v51,off,s[12:15],s23 sc1
s_mov_b64 exec,-1
ch_nl_1:
ds_read_b32 v16,v5 offset:16384
ds_read_b32 v17,v5 offset:16640
ds_read_b32 v18,v5 offset:18432
ds_read_b32 v19,v5 offset:18688
ds_read_b32 v20,v5 offset:16896
ds_read_b32 v21,v5 offset:17152
ds_read_b32 v22,v5 offset:18944
ds_read_b32 v23,v5 offset:19200
s_waitcnt lgkmcnt(4)
ds_read_b32 v24,v48 offset:16384
ds_read_b32 v25,v48 offset:16640
ds_read_b32 v26,v48 offset:18432
ds_read_b32 v27,v48 offset:18688
ds_read_b32 v28,v48 offset:16896
ds_read_b32 v29,v48 offset:17152
ds_read_b32 v30,v48 offset:18944
ds_read_b32 v31,v48 offset:19200
s_waitcnt lgkmcnt(0)
v_perm_b32 v56,v17,v16,s20
v_perm_b32 v57,v19,v18,s20
v_perm_b32 v58,v21,v20,s20
v_perm_b32 v59,v23,v22,s20
s_add_u32 s23,s42,10240
buffer_store_dwordx4 v[56:59],v1,s[4:7],s23 offen
v_perm_b32 v60,v25,v24,s20
v_perm_b32 v61,v27,v26,s20
v_perm_b32 v62,v29,v28,s20
v_perm_b32 v63,v31,v30,s20
s_add_u32 s23,s42,11264
buffer_store_dwordx4 v[60:63],v1,s[4:7],s23 offen
v_perm_b32 v64,v17,v16,s21
v_perm_b32 v65,v19,v18,s21
v_perm_b32 v66,v21,v20,s21
v_perm_b32 v67,v23,v22,s21
v_accvgpr_write_b32 a104,v64
v_accvgpr_write_b32 a105,v65
v_accvgpr_write_b32 a106,v66
v_accvgpr_write_b32 a107,v67
v_perm_b32 v68,v25,v24,s21
v_perm_b32 v69,v27,v26,s21
v_perm_b32 v70,v29,v28,s21
v_perm_b32 v71,v31,v30,s21
v_accvgpr_write_b32 a108,v68
v_accvgpr_write_b32 a109,v69
v_accvgpr_write_b32 a110,v70
v_accvgpr_write_b32 a111,v71
s_waitcnt vmcnt(30)
s_barrier
s_add_u32 s23,s22,16384
s_mov_b32 m0,s23
s_add_u32 s23,s61,2097152
buffer_load_dwordx4 v2,s[80:83],s23 offen nt lds
s_add_u32 s23,s22,17408
s_mov_b32 m0,s23
s_add_u32 s23,s61,2129920
buffer_load_dwordx4 v2,s[80:83],s23 offen nt lds
s_add_u32 s23,s22,18432
s_mov_b32 m0,s23
s_add_u32 s23,s61,2162688
buffer_load_dwordx4 v2,s[80:83],s23 offen nt lds
s_add_u32 s23,s22,19456
s_mov_b32 m0,s23
s_add_u32 s23,s61,2195456
buffer_load_dwordx4 v2,s[80:83],s23 offen nt lds
ds_read_b32 v32,v5 offset:20480
ds_read_b32 v33,v5 offset:20736
ds_read_b32 v34,v5 offset:22528
ds_read_b32 v35,v5 offset:22784
ds_read_b32 v36,v5 offset:20992
ds_read_b32 v37,v5 offset:21248
ds_read_b32 v38,v5 offset:23040
ds_read_b32 v39,v5 offset:23296
s_waitcnt lgkmcnt(4)
ds_read_b32 v40,v48 offset:20480
ds_read_b32 v41,v48 offset:20736
ds_read_b32 v42,v48 offset:22528
ds_read_b32 v43,v48 offset:22784
ds_read_b32 v44,v48 offset:20992
ds_read_b32 v45,v48 offset:21248
ds_read_b32 v46,v48 offset:23040
ds_read_b32 v47,v48 offset:23296
s_waitcnt lgkmcnt(0)
v_perm_b32 v56,v33,v32,s20
v_perm_b32 v57,v35,v34,s20
v_perm_b32 v58,v37,v36,s20
v_perm_b32 v59,v39,v38,s20
v_accvgpr_write_b32 a176,v56
v_accvgpr_write_b32 a177,v57
v_accvgpr_write_b32 a178,v58
v_accvgpr_write_b32 a179,v59
v_perm_b32 v60,v41,v40,s20
v_perm_b32 v61,v43,v42,s20
v_perm_b32 v62,v45,v44,s20
v_perm_b32 v63,v47,v46,s20
v_accvgpr_write_b32 a180,v60
v_accvgpr_write_b32 a181,v61
v_accvgpr_write_b32 a182,v62
v_accvgpr_write_b32 a183,v63
v_perm_b32 v112,v33,v32,s21
v_perm_b32 v113,v35,v34,s21
v_perm_b32 v114,v37,v36,s21
v_perm_b32 v115,v39,v38,s21
v_perm_b32 v116,v41,v40,s21
v_perm_b32 v117,v43,v42,s21
v_perm_b32 v118,v45,v44,s21
v_perm_b32 v119,v47,v46,s21
s_waitcnt vmcnt(30)
s_barrier
s_add_u32 s23,s22,20480
s_mov_b32 m0,s23
s_add_u32 s23,s61,2621440
buffer_load_dwordx4 v2,s[80:83],s23 offen nt lds
s_add_u32 s23,s22,21504
s_mov_b32 m0,s23
s_add_u32 s23,s61,2654208
buffer_load_dwordx4 v2,s[80:83],s23 offen nt lds
s_add_u32 s23,s22,22528
s_mov_b32 m0,s23
s_add_u32 s23,s61,2686976
buffer_load_dwordx4 v2,s[80:83],s23 offen nt lds
s_add_u32 s23,s22,23552
s_mov_b32 m0,s23
s_add_u32 s23,s61,2719744
buffer_load_dwordx4 v2,s[80:83],s23 offen nt lds
ds_read_b32 v16,v5 offset:24576
ds_read_b32 v17,v5 offset:24832
ds_read_b32 v18,v5 offset:26624
ds_read_b32 v19,v5 offset:26880
ds_read_b32 v20,v5 offset:25088
ds_read_b32 v21,v5 offset:25344
ds_read_b32 v22,v5 offset:27136
ds_read_b32 v23,v5 offset:27392
s_waitcnt lgkmcnt(4)
ds_read_b32 v24,v48 offset:24576
ds_read_b32 v25,v48 offset:24832
ds_read_b32 v26,v48 offset:26624
ds_read_b32 v27,v48 offset:26880
ds_read_b32 v28,v48 offset:25088
ds_read_b32 v29,v48 offset:25344
ds_read_b32 v30,v48 offset:27136
ds_read_b32 v31,v48 offset:27392
s_waitcnt lgkmcnt(0)
v_perm_b32 v56,v17,v16,s20
v_perm_b32 v57,v19,v18,s20
v_perm_b32 v58,v21,v20,s20
v_perm_b32 v59,v23,v22,s20
v_accvgpr_write_b32 a48,v56
v_accvgpr_write_b32 a49,v57
v_accvgpr_write_b32 a50,v58
v_accvgpr_write_b32 a51,v59
v_perm_b32 v60,v25,v24,s20
v_perm_b32 v61,v27,v26,s20
v_perm_b32 v62,v29,v28,s20
v_perm_b32 v63,v31,v30,s20
v_accvgpr_write_b32 a52,v60
v_accvgpr_write_b32 a53,v61
v_accvgpr_write_b32 a54,v62
v_accvgpr_write_b32 a55,v63
v_perm_b32 v64,v17,v16,s21
v_perm_b32 v65,v19,v18,s21
v_perm_b32 v66,v21,v20,s21
v_perm_b32 v67,v23,v22,s21
v_accvgpr_write_b32 a112,v64
v_accvgpr_write_b32 a113,v65
v_accvgpr_write_b32 a114,v66
v_accvgpr_write_b32 a115,v67
v_perm_b32 v68,v25,v24,s21
v_perm_b32 v69,v27,v26,s21
v_perm_b32 v70,v29,v28,s21
v_perm_b32 v71,v31,v30,s21
v_accvgpr_write_b32 a116,v68
v_accvgpr_write_b32 a117,v69
v_accvgpr_write_b32 a118,v70
v_accvgpr_write_b32 a119,v71
s_waitcnt vmcnt(30)
s_barrier
s_add_u32 s23,s22,24576
s_mov_b32 m0,s23
s_add_u32 s23,s61,3145728
buffer_load_dwordx4 v2,s[80:83],s23 offen nt lds
s_add_u32 s23,s22,25600
s_mov_b32 m0,s23
s_add_u32 s23,s61,3178496
buffer_load_dwordx4 v2,s[80:83],s23 offen nt lds
s_add_u32 s23,s22,26624
s_mov_b32 m0,s23
s_add_u32 s23,s61,3211264
buffer_load_dwordx4 v2,s[80:83],s23 offen nt lds
s_add_u32 s23,s22,27648
s_mov_b32 m0,s23
s_add_u32 s23,s61,3244032
buffer_load_dwordx4 v2,s[80:83],s23 offen nt lds
ds_read_b32 v32,v5 offset:28672
ds_read_b32 v33,v5 offset:28928
ds_read_b32 v34,v5 offset:30720
ds_read_b32 v35,v5 offset:30976
ds_read_b32 v36,v5 offset:29184
ds_read_b32 v37,v5 offset:29440
ds_read_b32 v38,v5 offset:31232
ds_read_b32 v39,v5 offset:31488
s_waitcnt lgkmcnt(4)
ds_read_b32 v40,v48 offset:28672
ds_read_b32 v41,v48 offset:28928
ds_read_b32 v42,v48 offset:30720
ds_read_b32 v43,v48 offset:30976
ds_read_b32 v44,v48 offset:29184
ds_read_b32 v45,v48 offset:29440
ds_read_b32 v46,v48 offset:31232
ds_read_b32 v47,v48 offset:31488
s_waitcnt lgkmcnt(0)
v_perm_b32 v56,v33,v32,s20
v_perm_b32 v57,v35,v34,s20
v_perm_b32 v58,v37,v36,s20
v_perm_b32 v59,v39,v38,s20
v_accvgpr_write_b32 a184,v56
v_accvgpr_write_b32 a185,v57
v_accvgpr_write_b32 a186,v58
v_accvgpr_write_b32 a187,v59
v_perm_b32 v60,v41,v40,s20
v_perm_b32 v61,v43,v42,s20
v_perm_b32 v62,v45,v44,s20
v_perm_b32 v63,v47,v46,s20
v_accvgpr_write_b32 a188,v60
v_accvgpr_write_b32 a189,v61
v_accvgpr_write_b32 a190,v62
v_accvgpr_write_b32 a191,v63
v_perm_b32 v120,v33,v32,s21
v_perm_b32 v121,v35,v34,s21
v_perm_b32 v122,v37,v36,s21
v_perm_b32 v123,v39,v38,s21
v_perm_b32 v124,v41,v40,s21
v_perm_b32 v125,v43,v42,s21
v_perm_b32 v126,v45,v44,s21
v_perm_b32 v127,v47,v46,s21
s_waitcnt vmcnt(30)
s_barrier
s_add_u32 s23,s22,28672
s_mov_b32 m0,s23
s_add_u32 s23,s61,3670016
buffer_load_dwordx4 v2,s[80:83],s23 offen nt lds
s_add_u32 s23,s22,29696
s_mov_b32 m0,s23
s_add_u32 s23,s61,3702784
buffer_load_dwordx4 v2,s[80:83],s23 offen nt lds
s_add_u32 s23,s22,30720
s_mov_b32 m0,s23
s_add_u32 s23,s61,3735552
buffer_load_dwordx4 v2,s[80:83],s23 offen nt lds
s_add_u32 s23,s22,31744
s_mov_b32 m0,s23
s_add_u32 s23,s61,3768320
buffer_load_dwordx4 v2,s[80:83],s23 offen nt lds
ds_read_b64_tr_b16 v[128:129],v6 offset:32768
ds_read_b64_tr_b16 v[130:131],v6 offset:33280
ds_read_b64_tr_b16 v[132:133],v49 offset:32768
ds_read_b64_tr_b16 v[134:135],v49 offset:33280
ds_read_b64_tr_b16 v[136:137],v6 offset:32800
ds_read_b64_tr_b16 v[138:139],v6 offset:33312
ds_read_b64_tr_b16 v[140:141],v49 offset:32800
ds_read_b64_tr_b16 v[142:143],v49 offset:33312
s_waitcnt lgkmcnt(0)
s_waitcnt vmcnt(30)
s_barrier
s_add_u32 s23,s22,32768
s_mov_b32 m0,s23
s_add_u32 s23,s61,4194304
buffer_load_dwordx4 v2,s[80:83],s23 offen nt lds
s_add_u32 s23,s22,33792
s_mov_b32 m0,s23
s_add_u32 s23,s61,4227072
buffer_load_dwordx4 v2,s[80:83],s23 offen nt lds
s_add_u32 s23,s22,34816
s_mov_b32 m0,s23
s_add_u32 s23,s61,4259840
buffer_load_dwordx4 v2,s[80:83],s23 offen nt lds
s_add_u32 s23,s22,35840
s_mov_b32 m0,s23
s_add_u32 s23,s61,4292608
buffer_load_dwordx4 v2,s[80:83],s23 offen nt lds
buffer_load_dword v51,v50,s[12:15],0 offen sc1
ds_read_b64_tr_b16 v[32:33],v6
ds_read_b64_tr_b16 v[34:35],v6 offset:512
ds_read_b64_tr_b16 v[36:37],v49
ds_read_b64_tr_b16 v[38:39],v49 offset:512
ds_read_b64_tr_b16 v[40:41],v6 offset:32
ds_read_b64_tr_b16 v[42:43],v6 offset:544
ds_read_b64_tr_b16 v[44:45],v49 offset:32
ds_read_b64_tr_b16 v[46:47],v49 offset:544
s_waitcnt lgkmcnt(0)
s_waitcnt vmcnt(31)
s_barrier
ds_write_b128 v9,v[32:35]
ds_write_b128 v9,v[36:39] offset:1024
ds_write_b128 v9,v[40:43] offset:2048
ds_write_b128 v9,v[44:47] offset:3072
ds_read_b64_tr_b16 v[16:17],v6 offset:4096
ds_read_b64_tr_b16 v[18:19],v6 offset:4608
ds_read_b64_tr_b16 v[20:21],v49 offset:4096
ds_read_b64_tr_b16 v[22:23],v49 offset:4608
ds_read_b64_tr_b16 v[24:25],v6 offset:4128
ds_read_b64_tr_b16 v[26:27],v6 offset:4640
ds_read_b64_tr_b16 v[28:29],v49 offset:4128
ds_read_b64_tr_b16 v[30:31],v49 offset:4640
s_waitcnt lgkmcnt(0)
s_waitcnt vmcnt(27)
s_barrier
ds_write_b128 v9,v[16:19] offset:4096
ds_write_b128 v9,v[20:23] offset:5120
ds_write_b128 v9,v[24:27] offset:6144
ds_write_b128 v9,v[28:31] offset:7168
ds_read_b64_tr_b16 v[32:33],v6 offset:8192
ds_read_b64_tr_b16 v[34:35],v6 offset:8704
ds_read_b64_tr_b16 v[36:37],v49 offset:8192
ds_read_b64_tr_b16 v[38:39],v49 offset:8704
ds_read_b64_tr_b16 v[40:41],v6 offset:8224
ds_read_b64_tr_b16 v[42:43],v6 offset:8736
ds_read_b64_tr_b16 v[44:45],v49 offset:8224
ds_read_b64_tr_b16 v[46:47],v49 offset:8736
s_waitcnt lgkmcnt(0)
s_waitcnt vmcnt(23)
s_barrier
ds_write_b128 v9,v[32:35] offset:8192
ds_write_b128 v9,v[36:39] offset:9216
ds_write_b128 v9,v[40:43] offset:10240
ds_write_b128 v9,v[44:47] offset:11264
ds_read_b64_tr_b16 v[16:17],v6 offset:12288
ds_read_b64_tr_b16 v[18:19],v6 offset:12800
ds_read_b64_tr_b16 v[20:21],v49 offset:12288
ds_read_b64_tr_b16 v[22:23],v49 offset:12800
ds_read_b64_tr_b16 v[24:25],v6 offset:12320
ds_read_b64_tr_b16 v[26:27],v6 offset:12832
ds_read_b64_tr_b16 v[28:29],v49 offset:12320
ds_read_b64_tr_b16 v[30:31],v49 offset:12832
s_waitcnt lgkmcnt(0)
s_waitcnt vmcnt(17)
s_barrier
ds_write_b128 v9,v[16:19] offset:12288
ds_write_b128 v9,v[20:23] offset:13312
ds_write_b128 v9,v[24:27] offset:14336
ds_write_b128 v9,v[28:31] offset:15360
ds_read_b64_tr_b16 v[32:33],v6 offset:16384
ds_read_b64_tr_b16 v[34:35],v6 offset:16896
ds_read_b64_tr_b16 v[36:37],v49 offset:16384
ds_read_b64_tr_b16 v[38:39],v49 offset:16896
ds_read_b64_tr_b16 v[40:41],v6 offset:16416
ds_read_b64_tr_b16 v[42:43],v6 offset:16928
ds_read_b64_tr_b16 v[44:45],v49 offset:16416
ds_read_b64_tr_b16 v[46:47],v49 offset:16928
s_waitcnt lgkmcnt(0)
s_waitcnt vmcnt(13)
s_barrier
ds_write_b128 v9,v[32:35] offset:16384
ds_write_b128 v9,v[36:39] offset:17408
ds_write_b128 v9,v[40:43] offset:18432
ds_write_b128 v9,v[44:47] offset:19456
ds_read_b64_tr_b16 v[16:17],v6 offset:20480
ds_read_b64_tr_b16 v[18:19],v6 offset:20992
ds_read_b64_tr_b16 v[20:21],v49 offset:20480
ds_read_b64_tr_b16 v[22:23],v49 offset:20992
ds_read_b64_tr_b16 v[24:25],v6 offset:20512
ds_read_b64_tr_b16 v[26:27],v6 offset:21024
ds_read_b64_tr_b16 v[28:29],v49 offset:20512
ds_read_b64_tr_b16 v[30:31],v49 offset:21024
s_waitcnt lgkmcnt(0)
s_waitcnt vmcnt(9)
s_barrier
ds_write_b128 v9,v[16:19] offset:20480
ds_write_b128 v9,v[20:23] offset:21504
ds_write_b128 v9,v[24:27] offset:22528
ds_write_b128 v9,v[28:31] offset:23552
ds_read_b64_tr_b16 v[32:33],v6 offset:24576
ds_read_b64_tr_b16 v[34:35],v6 offset:25088
ds_read_b64_tr_b16 v[36:37],v49 offset:24576
ds_read_b64_tr_b16 v[38:39],v49 offset:25088
ds_read_b64_tr_b16 v[40:41],v6 offset:24608
ds_read_b64_tr_b16 v[42:43],v6 offset:25120
ds_read_b64_tr_b16 v[44:45],v49 offset:24608
ds_read_b64_tr_b16 v[46:47],v49 offset:25120
s_waitcnt lgkmcnt(0)
s_waitcnt vmcnt(5)
s_barrier
ds_write_b128 v9,v[32:35] offset:24576
ds_write_b128 v9,v[36:39] offset:25600
ds_write_b128 v9,v[40:43] offset:26624
ds_write_b128 v9,v[44:47] offset:27648
ds_read_b64_tr_b16 v[16:17],v6 offset:28672
ds_read_b64_tr_b16 v[18:19],v6 offset:29184
ds_read_b64_tr_b16 v[20:21],v49 offset:28672
ds_read_b64_tr_b16 v[22:23],v49 offset:29184
ds_read_b64_tr_b16 v[24:25],v6 offset:28704
ds_read_b64_tr_b16 v[26:27],v6 offset:29216
ds_read_b64_tr_b16 v[28:29],v49 offset:28704
ds_read_b64_tr_b16 v[30:31],v49 offset:29216
s_waitcnt lgkmcnt(0)
s_waitcnt vmcnt(1)
s_barrier
ds_write_b128 v9,v[16:19] offset:28672
ds_write_b128 v9,v[20:23] offset:29696
ds_write_b128 v9,v[24:27] offset:30720
ds_write_b128 v9,v[28:31] offset:31744
ds_read_b64_tr_b16 v[32:33],v6 offset:32768
ds_read_b64_tr_b16 v[34:35],v6 offset:33280
ds_read_b64_tr_b16 v[36:37],v49 offset:32768
ds_read_b64_tr_b16 v[38:39],v49 offset:33280
ds_read_b64_tr_b16 v[40:41],v6 offset:32800
ds_read_b64_tr_b16 v[42:43],v6 offset:33312
ds_read_b64_tr_b16 v[44:45],v49 offset:32800
ds_read_b64_tr_b16 v[46:47],v49 offset:33312
s_waitcnt lgkmcnt(0)
s_barrier
ds_write_b128 v9,v[32:35] offset:32768
ds_write_b128 v9,v[36:39] offset:33792
ds_write_b128 v9,v[40:43] offset:34816
ds_write_b128 v9,v[44:47] offset:35840
s_waitcnt vmcnt(0) lgkmcnt(0)
s_mov_b32 s63,1
v_readfirstlane_b32 s99,v51
s_nop 0
s_and_b32 s99,s99,1
s_lshl_b32 s99,s99,13
s_mov_b32 s60,128
v_add_u32 v53,v52,v51
v_cmp_le_u32 vcc,s60,v53
s_nop 0
s_cmp_eq_u64 vcc,-1
s_nop 1
s_cbranch_scc1 ch_st_2
v_mov_b32 v2,72
s_mov_b32 s99,128
s_mov_b32 s38,0
poll_3:
buffer_load_dword v3,v2,s[12:15],0 offen sc1
s_waitcnt vmcnt(0)
v_cmp_le_u32 vcc,s99,v3
s_nop 0
s_cmp_eq_u64 vcc,-1
s_nop 1
s_cbranch_scc1 polld_4
s_sleep 8
s_add_u32 s38,s38,1
s_cmp_lt_u32 s38,100000
s_cbranch_scc1 poll_3
s_mov_b32 s40,14
s_branch L_fail
polld_4:
v_readfirstlane_b32 s99,v3
s_nop 0
s_and_b32 s99,s99,1
s_lshl_b32 s99,s99,13
v_and_b32 v3,7,v0
v_min_u32 v2,1,v3
v_lshl_add_u32 v3,v2,3,v3
v_lshlrev_b32 v3,4,v3
s_mov_b32 s38,0
s_nop 0
reg_5:
buffer_load_dword v2,v3,s[12:15],0 offen sc1
s_waitcnt vmcnt(0)
v_readlane_b32 s50,v2,0
v_readlane_b32 s51,v2,1
v_readlane_b32 s52,v2,2
v_readlane_b32 s53,v2,3
v_readlane_b32 s54,v2,4
v_readlane_b32 s55,v2,5
v_readlane_b32 s56,v2,6
v_readlane_b32 s57,v2,7
v_readlane_b32 s58,v2,s39
s_nop 0
s_cmp_ge_u32 s58,32
s_nop 1
s_cbranch_scc1 regd_6
s_add_u32 s59,s50,s51
s_add_u32 s59,s59,s52
s_add_u32 s59,s59,s53
s_add_u32 s59,s59,s54
s_add_u32 s59,s59,s55
s_add_u32 s59,s59,s56
s_add_u32 s59,s59,s57
s_cmp_ge_u32 s59,256
s_cbranch_scc1 regd_6
s_sleep 2
s_add_u32 s38,s38,1
s_cmp_lt_u32 s38,100000
s_cbranch_scc1 reg_5
s_mov_b32 s40,15
s_branch L_fail
regd_6:
s_cmp_ge_u32 s58,32
s_cselect_b32 s63,1,0
ch_st_2:
s_lshl_b32 s60,s3,1
s_add_u32 s60,s60,s63
s_cmp_eq_u32 s60,0
s_cbranch_scc1 CH_0_0
s_cmp_eq_u32 s60,1
s_cbranch_scc1 CH_0_1
s_cmp_eq_u32 s60,2
s_cbranch_scc1 CH_1_0
s_cmp_eq_u32 s60,3
s_cbranch_scc1 CH_1_1
s_cmp_eq_u32 s60,4
s_cbranch_scc1 CH_2_0
s_cmp_eq_u32 s60,5
s_cbranch_scc1 CH_2_1
s_cmp_eq_u32 s60,6
s_cbranch_scc1 CH_3_0
s_cmp_eq_u32 s60,7
s_cbranch_scc1 CH_3_1
s_branch L_end
CH_0_0:
v_and_b32 v14,15,v0
v_lshrrev_b32 v15,4,v0
v_bfe_u32 v16,v0,1,1
v_mul_u32_u24 v2,0xaaaa,v16
v_add_u32 v2,0x4444,v2
v_add_u32 v3,0,v1
v_add_u32 v1,147456,v1
v_lshrrev_b32 v17,3,v14
v_lshlrev_b32 v4,8,v17
v_lshl_add_u32 v4,v16,7,v4
v_lshl_add_u32 v4,v15,5,v4
v_and_b32 v18,1,v0
v_lshl_add_u32 v4,v18,2,v4
v_bfe_u32 v19,v0,2,1
v_lshl_add_u32 v4,v19,3,v4
v_add_u32 v4,157696,v4
v_and_b32 v5,7,v0
v_lshlrev_b32 v5,4,v5
v_lshl_add_u32 v5,v15,7,v5
v_add_u32 v5,147456,v5
v_and_b32 v6,7,v0
v_lshl_add_u32 v6,v17,4,v6
v_add_u32 v6,0,v6
v_lshlrev_b32 v6,4,v6
v_lshl_add_u32 v6,v15,9,v6
v_bfe_u32 v7,v0,1,2
v_lshl_add_u32 v7,v7,2,v18
v_bfe_u32 v8,v0,4,1
v_lshl_add_u32 v7,v8,1,v7
v_lshrrev_b32 v13,5,v0
v_lshl_add_u32 v7,v13,4,v7
v_lshlrev_b32 v7,4,v7
v_add_u32 v7,157696,v7
v_lshlrev_b32 v13,8,v13
v_lshl_add_u32 v13,v14,3,v13
v_lshl_add_u32 v13,v8,2,v13
v_add_u32 v13,161792,v13
v_lshlrev_b32 v8,4,v14
v_lshl_add_u32 v8,v15,9,v8
v_add_u32 v8,131072,v8
v_lshlrev_b32 v9,14,v15
v_lshl_add_u32 v9,v14,4,v9
v_add_u32 v9,0,v9
v_lshrrev_b32 v10,5,v0
v_lshlrev_b32 v10,14,v10
v_and_b32 v32,31,v0
v_lshl_add_u32 v10,v32,3,v10
v_add_u32 v10,0,v10
v_lshlrev_b32 v11,3,v0
s_and_b32 s60,s41,1
s_lshl_b32 s60,s60,6
v_xor_b32 v11,s60,v11
s_lshl_b32 s60,s41,8
v_add_u32 v11,s60,v11
v_mov_b32 v20,0
v_cmp_eq_u32 vcc,0,v14
v_mov_b32 v32,0x3f80
s_nop 0
v_cndmask_b32 v20,v20,v32,vcc
v_cmp_eq_u32 vcc,1,v14
v_mov_b32 v32,0x3f800000
s_nop 0
v_cndmask_b32 v20,v20,v32,vcc
v_mov_b32 v21,0
v_cmp_eq_u32 vcc,2,v14
v_mov_b32 v32,0x3f80
s_nop 0
v_cndmask_b32 v21,v21,v32,vcc
v_cmp_eq_u32 vcc,3,v14
v_mov_b32 v32,0x3f800000
s_nop 0
v_cndmask_b32 v21,v21,v32,vcc
v_mov_b32 v22,0
v_cmp_eq_u32 vcc,4,v14
v_mov_b32 v32,0x3f80
s_nop 0
v_cndmask_b32 v22,v22,v32,vcc
v_cmp_eq_u32 vcc,5,v14
v_mov_b32 v32,0x3f800000
s_nop 0
v_cndmask_b32 v22,v22,v32,vcc
v_mov_b32 v23,0
v_cmp_eq_u32 vcc,6,v14
v_mov_b32 v32,0x3f80
s_nop 0
v_cndmask_b32 v23,v23,v32,vcc
v_cmp_eq_u32 vcc,7,v14
v_mov_b32 v32,0x3f800000
s_nop 0
v_cndmask_b32 v23,v23,v32,vcc
s_mul_i32 s60,s39,0x48000
s_add_u32 s60,s60,0x18010
s_lshl_b32 s101,s39,13
s_xor_b32 s101,s101,s99
s_xor_b32 s101,s101,8192
s_add_u32 s60,s60,s101
s_lshl_b32 s61,s41,8
s_add_u32 s60,s60,s61
v_lshlrev_b32 v12,7,v18
v_lshl_add_u32 v12,v16,4,v12
v_add_u32 v12,s60,v12
s_mul_i32 s37,s39,0x48000
s_add_u32 s37,s37,0x20000
s_lshl_b32 s101,s39,13
s_xor_b32 s101,s101,s99
s_xor_b32 s101,s101,8192
s_add_u32 s37,s37,s101
s_lshl_b32 s61,s41,7
s_add_u32 s37,s37,s61
s_mul_i32 s43,s39,0x3000000
s_add_u32 s43,s43,0x7ad0000
s_lshr_b32 s61,s41,4
s_lshl_b32 s61,s61,18
s_add_u32 s43,s43,s61
s_lshl_b32 s61,s41,13
s_add_u32 s43,s43,s61
s_mul_i32 s44,s39,0x0
s_add_u32 s44,s44,0x3dc000
s_lshl_b32 s101,s39,13
s_xor_b32 s101,s101,s99
s_xor_b32 s101,s101,8192
s_add_u32 s44,s44,s101
s_lshr_b32 s61,s41,1
s_lshl_b32 s61,s61,14
s_add_u32 s44,s44,s61
s_and_b32 s61,s41,1
s_lshl_b32 s61,s61,12
s_add_u32 s44,s44,s61
s_sub_u32 s42,s42,147456
s_lshl_b32 s98,s39,13
s_xor_b32 s98,s98,s99
s_xor_b32 s98,s98,8192
s_mul_i32 s45,s39,0x0
s_add_u32 s45,s45,0x100000
s_add_u32 s45,s45,s98
s_lshl_b32 s61,s41,14
s_add_u32 s32,s45,s61
s_sub_u32 s32,s32,147456
s_lshl_b32 s61,s41,8
s_add_u32 s45,s45,s61
s_mul_i32 s46,s39,0x0
s_add_u32 s46,s46,0x180000
s_add_u32 s46,s46,s98
s_and_b32 s61,s41,7
s_lshl_b32 s61,s61,14
s_add_u32 s33,s46,s61
s_sub_u32 s33,s33,147456
s_lshl_b32 s61,s41,8
s_add_u32 s46,s46,s61
s_mov_b32 s24,s4
s_mov_b32 s25,s5
s_mov_b32 s27,0x20000
s_cmp_lt_u32 s41,8
s_cselect_b32 s26,s6,0
s_mov_b32 s22,0x55555555
s_mov_b32 s23,0x55555555
s_mul_i32 s34,s39,0x0
s_add_u32 s34,s34,0x1a0000
s_add_u32 s34,s34,s98
s_add_u32 s36,s37,32768
s_mov_b32 s35,0x3e0293ee
s_mov_b32 s28,0
s_mov_b32 s66,s32
s_mov_b32 s67,s33
s_mov_b32 s64,s45
s_mov_b32 s65,s46
s_add_u32 s63,s64,0x10000
s_mov_b32 s49,s34
s_add_u32 s69,s34,0x8000
ds_read_b128 v[56:59],v3
ds_read_b128 v[60:63],v3 offset:1024
ds_read_b128 v[64:67],v3 offset:2048
ds_read_b128 v[68:71],v3 offset:3072
s_cmp_eq_u32 s39,0
s_cbranch_scc1 ch_nw_9
s_add_u32 s60,s42,0
buffer_load_dwordx4 v[32:35],v1,s[4:7],s60 offen
s_add_u32 s60,s42,1024
buffer_load_dwordx4 v[32:35],v1,s[4:7],s60 offen
s_add_u32 s60,s42,2048
buffer_load_dwordx4 v[32:35],v1,s[4:7],s60 offen
s_add_u32 s60,s42,3072
buffer_load_dwordx4 v[32:35],v1,s[4:7],s60 offen
s_add_u32 s60,s42,4096
buffer_load_dwordx4 v[32:35],v1,s[4:7],s60 offen
s_add_u32 s60,s42,5120
buffer_load_dwordx4 v[32:35],v1,s[4:7],s60 offen
s_add_u32 s60,s42,6144
buffer_load_dwordx4 v[32:35],v1,s[4:7],s60 offen
s_add_u32 s60,s42,7168
buffer_load_dwordx4 v[32:35],v1,s[4:7],s60 offen
s_add_u32 s60,s42,8192
buffer_load_dwordx4 v[32:35],v1,s[4:7],s60 offen
s_add_u32 s60,s42,9216
buffer_load_dwordx4 v[32:35],v1,s[4:7],s60 offen
s_add_u32 s60,s42,10240
buffer_load_dwordx4 v[32:35],v1,s[4:7],s60 offen
s_add_u32 s60,s42,11264
buffer_load_dwordx4 v[32:35],v1,s[4:7],s60 offen
s_add_u32 s60,s42,12288
buffer_load_dwordx4 v[32:35],v1,s[4:7],s60 offen
s_add_u32 s60,s42,13312
buffer_load_dwordx4 v[32:35],v1,s[4:7],s60 offen
s_add_u32 s60,s42,14336
buffer_load_dwordx4 v[32:35],v1,s[4:7],s60 offen
s_add_u32 s60,s42,15360
buffer_load_dwordx4 v[32:35],v1,s[4:7],s60 offen
s_add_u32 s60,s42,16384
buffer_load_dwordx4 v[32:35],v1,s[4:7],s60 offen
s_add_u32 s60,s42,17408
buffer_load_dwordx4 v[32:35],v1,s[4:7],s60 offen
s_add_u32 s60,s42,18432
buffer_load_dwordx4 v[32:35],v1,s[4:7],s60 offen
s_add_u32 s60,s42,19456
buffer_load_dwordx4 v[32:35],v1,s[4:7],s60 offen
s_add_u32 s60,s42,20480
buffer_load_dwordx4 v[32:35],v1,s[4:7],s60 offen
s_add_u32 s60,s42,21504
buffer_load_dwordx4 v[32:35],v1,s[4:7],s60 offen
s_add_u32 s60,s42,22528
buffer_load_dwordx4 v[32:35],v1,s[4:7],s60 offen
s_add_u32 s60,s42,23552
buffer_load_dwordx4 v[32:35],v1,s[4:7],s60 offen
s_waitcnt vmcnt(0) lgkmcnt(0)
s_getpc_b64 s[60:61]
pc_10:
s_add_u32 s60,s60,ch_beg_8-pc_10
s_addc_u32 s61,s61,0
s_mov_b32 s59,ch_end_7-ch_beg_8-4
v_lshlrev_b32 v38,7,v0
v_add_u32 v38,0,v38
v_min_u32 v38,s59,v38
v_mov_b32 v37,s61
v_add_co_u32 v36,vcc,s60,v38
s_nop 1
v_addc_co_u32 v37,vcc,0,v37,vcc
global_load_dword v39,v[36:37],off
s_waitcnt vmcnt(0)
s_waitcnt vmcnt(0)
s_nop 1
ch_nw_9:
v_lshl_add_u32 v24,v15,1,v16
v_lshlrev_b32 v24,4,v24
v_lshl_add_u32 v24,v18,7,v24
v_lshlrev_b32 v25,6,v19
v_xor_b32 v24,v24,v25
v_bfe_u32 v25,v0,2,2
v_lshl_add_u32 v24,v25,8,v24
v_add_u32 v0,147456,v24
s_mov_b32 s21,0
s_mov_b32 s20,0
v_mov_b64 v[32:33],0
v_mov_b64 v[34:35],0
v_mov_b64 v[36:37],0
v_mov_b64 v[38:39],0
v_mov_b64 v[40:41],0
v_mov_b64 v[42:43],0
v_mov_b64 v[44:45],0
v_mov_b64 v[46:47],0
v_mov_b64 v[48:49],0
v_mov_b64 v[50:51],0
v_mov_b64 v[52:53],0
v_mov_b64 v[54:55],0
s_nop 0
s_branch ch_top_11
ch_beg_8:
ch_hop_13:
ds_read_b128 v[56:59],v3
ds_read_b128 v[60:63],v3 offset:1024
ds_read_b128 v[64:67],v3 offset:2048
ds_read_b128 v[68:71],v3 offset:3072
s_add_u32 s28,s28,1
s_and_b32 s60,s28,3
s_lshl_b32 s60,s60,15
s_add_u32 s47,s34,s60
s_xor_b32 s60,s60,0x10000
s_add_u32 s49,s34,s60
s_mov_b32 s38,0
s_add_u32 s68,s66,4096
s_sleep 9
ch_r_15:
buffer_load_dwordx4 v[24:27],v1,s[4:7],s66 offen sc1
buffer_load_dwordx4 v[28:31],v1,s[4:7],s66 offen offset:1024 sc1
buffer_load_dwordx4 v[32:35],v1,s[4:7],s66 offen offset:2048 sc1
buffer_load_dwordx4 v[36:39],v1,s[4:7],s66 offen offset:3072 sc1
buffer_load_dwordx4 v[40:43],v1,s[4:7],s68 offen sc1
buffer_load_dwordx4 v[44:47],v1,s[4:7],s68 offen offset:1024 sc1
buffer_load_dwordx4 v[48:51],v1,s[4:7],s68 offen offset:2048 sc1
buffer_load_dwordx4 v[52:55],v1,s[4:7],s68 offen offset:3072 sc1
s_waitcnt vmcnt(7)
v_mfma_f32_16x16x32_bf16 v[16:19],v[20:23],v[24:27],0
v_bitop3_b32 v15,v24,v25,s48 bitop3:0x7e
v_bitop3_b32 v14,v26,v27,s48 bitop3:0x7e
v_or_b32 v14,v14,v15
s_waitcnt vmcnt(6)
v_mfma_f32_16x16x32_bf16 v[16:19],v[20:23],v[28:31],v[16:19]
v_bitop3_b32 v15,v28,v29,s48 bitop3:0x7e
v_bitop3_b32 v12,v30,v31,s48 bitop3:0x7e
v_or3_b32 v14,v14,v15,v12
s_waitcnt vmcnt(5)
v_mfma_f32_16x16x32_bf16 v[16:19],v[20:23],v[32:35],v[16:19]
v_bitop3_b32 v15,v32,v33,s48 bitop3:0x7e
v_bitop3_b32 v12,v34,v35,s48 bitop3:0x7e
v_or3_b32 v14,v14,v15,v12
s_waitcnt vmcnt(4)
v_mfma_f32_16x16x32_bf16 v[16:19],v[20:23],v[36:39],v[16:19]
v_bitop3_b32 v15,v36,v37,s48 bitop3:0x7e
v_bitop3_b32 v12,v38,v39,s48 bitop3:0x7e
v_or3_b32 v14,v14,v15,v12
s_waitcnt vmcnt(3)
v_mfma_f32_16x16x32_bf16 v[16:19],v[20:23],v[40:43],v[16:19]
v_bitop3_b32 v15,v40,v41,s48 bitop3:0x7e
v_bitop3_b32 v12,v42,v43,s48 bitop3:0x7e
v_or3_b32 v14,v14,v15,v12
s_waitcnt vmcnt(2)
v_mfma_f32_16x16x32_bf16 v[16:19],v[20:23],v[44:47],v[16:19]
v_bitop3_b32 v15,v44,v45,s48 bitop3:0x7e
v_bitop3_b32 v12,v46,v47,s48 bitop3:0x7e
v_or3_b32 v14,v14,v15,v12
s_waitcnt vmcnt(1)
v_mfma_f32_16x16x32_bf16 v[16:19],v[20:23],v[48:51],v[16:19]
v_bitop3_b32 v15,v48,v49,s48 bitop3:0x7e
v_bitop3_b32 v12,v50,v51,s48 bitop3:0x7e
v_or3_b32 v14,v14,v15,v12
s_waitcnt vmcnt(0)
v_mfma_f32_16x16x32_bf16 v[16:19],v[20:23],v[52:55],v[16:19]
v_bitop3_b32 v15,v52,v53,s48 bitop3:0x7e
v_bitop3_b32 v12,v54,v55,s48 bitop3:0x7e
v_or3_b32 v14,v14,v15,v12
v_and_b32 v14,1,v14
v_cmp_eq_u32 vcc,1,v14
s_nop 2
v_cvt_pk_bf16_f32 v14,v16,v17
v_cvt_pk_bf16_f32 v15,v18,v19
v_min_u32 v14,-2,v14
v_min_u32 v15,-2,v15
s_cbranch_vccnz ch_rf_16
s_mov_b32 exec_hi,0
buffer_store_dwordx2 v[14:15],v11,s[4:7],s47 offen sc1
s_mov_b64 exec,-1
ch_nr_14:
s_waitcnt lgkmcnt(0)
s_barrier
s_add_u32 s60,s42,4096
buffer_load_dwordx4 v[72:75],v1,s[4:7],s60 offen
s_add_u32 s60,s42,4096
buffer_load_dwordx4 v[76:79],v1,s[4:7],s60 offen offset:1024
s_add_u32 s60,s42,6144
buffer_load_dwordx4 v[80:83],v1,s[4:7],s60 offen
s_add_u32 s60,s42,6144
buffer_load_dwordx4 v[84:87],v1,s[4:7],s60 offen offset:1024
s_add_u32 s60,s42,8192
buffer_load_dwordx4 v[88:91],v1,s[4:7],s60 offen
s_add_u32 s60,s42,8192
buffer_load_dwordx4 v[92:95],v1,s[4:7],s60 offen offset:1024
v_mov_b64 v[32:33],0
v_mov_b64 v[34:35],0
v_mov_b64 v[36:37],0
v_mov_b64 v[38:39],0
v_mov_b64 v[40:41],0
v_mov_b64 v[42:43],0
v_mov_b64 v[44:45],0
v_mov_b64 v[46:47],0
v_mov_b64 v[48:49],0
v_mov_b64 v[50:51],0
v_mov_b64 v[52:53],0
v_mov_b64 v[54:55],0
s_add_u32 s69,s28,1
s_and_b32 s69,s69,3
s_lshl_b32 s69,s69,15
s_add_u32 s69,s69,s34
s_waitcnt vmcnt(0)
ch_top_11:
s_waitcnt lgkmcnt(0)
s_barrier
ds_read_b128 v[24:27],v0
ds_read_b128 v[28:31],v0 offset:1024
s_add_u32 s61,s43,4096
v_mov_b64 v[16:17],-1
s_waitcnt lgkmcnt(1)
v_smfmac_f32_16x16x64_bf16 v[32:35],v[24:27],v[96:103],v2
ds_read_b128 v[96:99],v3 offset:4096
v_smfmac_f32_16x16x64_bf16 v[36:39],v[24:27],v[104:111],v2
ds_read_b128 v[100:103],v3 offset:5120
s_add_u32 s60,s42,10240
buffer_load_dwordx4 v[104:107],v1,s[4:7],s60 offen
v_smfmac_f32_16x16x64_bf16 v[48:51],v[24:27],v[56:63],v2
ds_read_b128 v[56:59],v3 offset:6144
v_smfmac_f32_16x16x64_bf16 v[40:43],v[24:27],a[120:127],v2
ds_read_b128 v[60:63],v3 offset:7168
s_add_u32 s60,s42,10240
buffer_load_dwordx4 v[108:111],v1,s[4:7],s60 offen offset:1024
v_smfmac_f32_16x16x64_bf16 v[44:47],v[24:27],a[192:199],v2
v_smfmac_f32_16x16x64_bf16 v[52:55],v[24:27],v[64:71],v2
ds_read_b128 v[24:27],v0 offset:2048
s_waitcnt lgkmcnt(5)
v_smfmac_f32_16x16x64_bf16 v[32:35],v[28:31],v[72:79],v2
ds_read_b128 v[64:67],v3 offset:8192
v_smfmac_f32_16x16x64_bf16 v[36:39],v[28:31],v[80:87],v2
ds_read_b128 v[68:71],v3 offset:9216
s_waitcnt lgkmcnt(5)
v_smfmac_f32_16x16x64_bf16 v[48:51],v[28:31],v[96:103],v2
ds_read_b128 v[96:99],v3 offset:10240
v_smfmac_f32_16x16x64_bf16 v[40:43],v[28:31],v[88:95],v2
ds_read_b128 v[100:103],v3 offset:11264
buffer_load_dwordx4 v[72:75],v6,s[4:7],s43 offen sc1 nt
v_smfmac_f32_16x16x64_bf16 v[44:47],v[28:31],a[200:207],v2
s_waitcnt lgkmcnt(5)
v_smfmac_f32_16x16x64_bf16 v[52:55],v[28:31],v[56:63],v2
ds_read_b128 v[28:31],v0 offset:3072
s_waitcnt lgkmcnt(5)
v_smfmac_f32_16x16x64_bf16 v[32:35],v[24:27],a[0:7],v2
ds_read_b128 v[56:59],v3 offset:12288
v_smfmac_f32_16x16x64_bf16 v[36:39],v[24:27],a[56:63],v2
ds_read_b128 v[60:63],v3 offset:13312
buffer_load_dwordx4 v[76:79],v6,s[4:7],s43 offen offset:2048 sc1 nt
s_waitcnt lgkmcnt(5)
v_smfmac_f32_16x16x64_bf16 v[48:51],v[24:27],v[64:71],v2
ds_read_b128 v[64:67],v3 offset:14336
v_smfmac_f32_16x16x64_bf16 v[40:43],v[24:27],a[128:135],v2
ds_read_b128 v[68:71],v3 offset:15360
v_smfmac_f32_16x16x64_bf16 v[44:47],v[24:27],a[208:215],v2
s_waitcnt lgkmcnt(5)
v_smfmac_f32_16x16x64_bf16 v[52:55],v[24:27],v[96:103],v2
ds_read_b128 v[24:27],v0 offset:4096
buffer_load_dwordx4 v[80:83],v6,s[4:7],s61 offen sc1 nt
s_waitcnt lgkmcnt(5)
v_smfmac_f32_16x16x64_bf16 v[32:35],v[28:31],a[8:15],v2
ds_read_b128 v[96:99],v3 offset:16384
v_smfmac_f32_16x16x64_bf16 v[36:39],v[28:31],a[64:71],v2
ds_read_b128 v[100:103],v3 offset:17408
s_waitcnt lgkmcnt(5)
v_smfmac_f32_16x16x64_bf16 v[48:51],v[28:31],v[56:63],v2
ds_read_b128 v[56:59],v3 offset:18432
v_smfmac_f32_16x16x64_bf16 v[40:43],v[28:31],a[136:143],v2
ds_read_b128 v[60:63],v3 offset:19456
buffer_load_dwordx4 v[84:87],v6,s[4:7],s61 offen offset:2048 sc1 nt
v_smfmac_f32_16x16x64_bf16 v[44:47],v[28:31],a[216:223],v2
s_waitcnt lgkmcnt(5)
v_smfmac_f32_16x16x64_bf16 v[52:55],v[28:31],v[64:71],v2
ds_read_b128 v[28:31],v0 offset:5120
s_waitcnt lgkmcnt(5)
v_smfmac_f32_16x16x64_bf16 v[32:35],v[24:27],a[16:23],v2
ds_read_b128 v[64:67],v3 offset:20480
v_smfmac_f32_16x16x64_bf16 v[36:39],v[24:27],a[72:79],v2
ds_read_b128 v[68:71],v3 offset:21504
buffer_load_dwordx4 v[88:91],v8,s[4:7],s43 offen sc1 nt
s_waitcnt lgkmcnt(5)
v_smfmac_f32_16x16x64_bf16 v[48:51],v[24:27],v[96:103],v2
ds_read_b128 v[96:99],v3 offset:22528
v_smfmac_f32_16x16x64_bf16 v[40:43],v[24:27],a[144:151],v2
ds_read_b128 v[100:103],v3 offset:23552
v_smfmac_f32_16x16x64_bf16 v[44:47],v[24:27],a[224:231],v2
s_waitcnt lgkmcnt(5)
v_smfmac_f32_16x16x64_bf16 v[52:55],v[24:27],v[56:63],v2
ds_read_b128 v[24:27],v0 offset:6144
buffer_load_dwordx4 v[92:95],v8,s[4:7],s43 offen offset:256 sc1 nt
s_waitcnt lgkmcnt(5)
v_smfmac_f32_16x16x64_bf16 v[32:35],v[28:31],a[24:31],v2
ds_read_b128 v[56:59],v3 offset:24576
v_smfmac_f32_16x16x64_bf16 v[36:39],v[28:31],a[80:87],v2
ds_read_b128 v[60:63],v3 offset:25600
s_waitcnt lgkmcnt(5)
v_smfmac_f32_16x16x64_bf16 v[48:51],v[28:31],v[64:71],v2
ds_read_b128 v[64:67],v3 offset:26624
v_smfmac_f32_16x16x64_bf16 v[40:43],v[28:31],a[152:159],v2
ds_read_b128 v[68:71],v3 offset:27648
s_mov_b32 exec_hi,0
buffer_store_dwordx2 v[16:17],v11,s[4:7],s49 offen sc1
buffer_load_dword v12,v11,s[4:7],s69 offen sc1
s_mov_b64 exec,-1
v_smfmac_f32_16x16x64_bf16 v[44:47],v[28:31],a[232:239],v2
s_waitcnt lgkmcnt(5)
v_smfmac_f32_16x16x64_bf16 v[52:55],v[28:31],v[96:103],v2
ds_read_b128 v[28:31],v0 offset:7168
s_waitcnt lgkmcnt(5)
v_smfmac_f32_16x16x64_bf16 v[32:35],v[24:27],a[32:39],v2
ds_read_b128 v[96:99],v3 offset:28672
v_smfmac_f32_16x16x64_bf16 v[36:39],v[24:27],a[88:95],v2
ds_read_b128 v[100:103],v3 offset:29696
s_waitcnt lgkmcnt(5)
v_smfmac_f32_16x16x64_bf16 v[48:51],v[24:27],v[56:63],v2
ds_read_b128 v[56:59],v3 offset:30720
v_smfmac_f32_16x16x64_bf16 v[40:43],v[24:27],a[160:167],v2
ds_read_b128 v[60:63],v3 offset:31744
v_smfmac_f32_16x16x64_bf16 v[44:47],v[24:27],a[240:247],v2
s_waitcnt lgkmcnt(5)
v_smfmac_f32_16x16x64_bf16 v[52:55],v[24:27],v[64:71],v2
ds_read_b128 v[24:27],v0 offset:8192
s_waitcnt lgkmcnt(5)
v_smfmac_f32_16x16x64_bf16 v[32:35],v[28:31],a[40:47],v2
ds_read_b128 v[64:67],v3 offset:32768
v_smfmac_f32_16x16x64_bf16 v[36:39],v[28:31],a[96:103],v2
ds_read_b128 v[68:71],v3 offset:33792
s_waitcnt lgkmcnt(5)
v_smfmac_f32_16x16x64_bf16 v[48:51],v[28:31],v[96:103],v2
ds_read_b128 v[96:99],v3 offset:34816
v_smfmac_f32_16x16x64_bf16 v[40:43],v[28:31],a[168:175],v2
ds_read_b128 v[100:103],v3 offset:35840
v_smfmac_f32_16x16x64_bf16 v[44:47],v[28:31],a[248:255],v2
s_waitcnt lgkmcnt(5)
v_smfmac_f32_16x16x64_bf16 v[52:55],v[28:31],v[56:63],v2
ds_read_b128 v[28:31],v0 offset:9216
s_add_u32 s60,s42,12288
buffer_load_dwordx4 v[56:59],v1,s[4:7],s60 offen
s_waitcnt lgkmcnt(5)
s_waitcnt vmcnt(9)
v_smfmac_f32_16x16x64_bf16 v[32:35],v[24:27],v[104:111],v2
v_smfmac_f32_16x16x64_bf16 v[36:39],v[24:27],a[104:111],v2
v_smfmac_f32_16x16x64_bf16 v[40:43],v[24:27],a[176:183],v2
v_smfmac_f32_16x16x64_bf16 v[44:47],v[24:27],v[112:119],v2
s_add_u32 s60,s42,12288
buffer_load_dwordx4 v[60:63],v1,s[4:7],s60 offen offset:1024
s_waitcnt lgkmcnt(0)
v_smfmac_f32_16x16x64_bf16 v[32:35],v[28:31],a[48:55],v2
v_smfmac_f32_16x16x64_bf16 v[36:39],v[28:31],a[112:119],v2
v_smfmac_f32_16x16x64_bf16 v[40:43],v[28:31],a[184:191],v2
v_smfmac_f32_16x16x64_bf16 v[44:47],v[28:31],v[120:127],v2
s_add_u32 s60,s42,14336
buffer_load_dwordx4 v[104:107],v1,s[4:7],s60 offen
v_smfmac_f32_16x16x64_bf16 v[48:51],v[24:27],v[64:71],v2
s_nop 1
v_add_f32 v32,v32,v34
v_add_f32 v33,v33,v35
v_add_f32 v36,v36,v38
v_smfmac_f32_16x16x64_bf16 v[52:55],v[24:27],v[96:103],v2
v_add_f32 v37,v37,v39
v_mul_f32 v32,s35,v32
v_mul_f32 v33,s35,v33
v_smfmac_f32_16x16x64_bf16 v[48:51],v[28:31],v[128:135],v2
v_mul_f32 v36,s35,v36
v_mul_f32 v37,s35,v37
v_cvt_pk_bf16_f32 v14,v32,v36
v_smfmac_f32_16x16x64_bf16 v[52:55],v[28:31],v[136:143],v2
v_cvt_pk_bf16_f32 v15,v33,v37
ds_write_b32 v4,v14
ds_write_b32 v4,v15 offset:16
s_add_u32 s60,s42,14336
buffer_load_dwordx4 v[108:111],v1,s[4:7],s60 offen offset:1024
s_add_u32 s43,s43,786432
v_add_f32 v40,v40,v42
v_add_f32 v41,v41,v43
v_add_f32 v44,v44,v46
v_add_f32 v45,v45,v47
v_cvt_pk_bf16_f32 v16,v40,v44
v_cvt_pk_bf16_f32 v17,v41,v45
ds_write_b32 v4,v16 offset:2048
ds_write_b32 v4,v17 offset:2064
v_pk_add_f32 v[48:49],v[48:49],v[50:51]
v_pk_add_f32 v[52:53],v[52:53],v[54:55]
v_cvt_pk_bf16_f32 v48,v48,v49
v_mov_b32 v49,0
v_cvt_pk_bf16_f32 v52,v52,v53
v_mov_b32 v53,0
ds_write_b32 v13,v48
ds_write_b32 v13,v52 offset:128
s_add_u32 s60,s42,16384
buffer_load_dwordx4 v[64:67],v1,s[4:7],s60 offen
s_add_u32 s60,s42,16384
buffer_load_dwordx4 v[68:71],v1,s[4:7],s60 offen offset:1024
s_waitcnt lgkmcnt(0)
s_barrier
s_cmp_ge_u32 s28,63
s_cbranch_scc1 ch_fin_12
ds_read_b128 v[32:35],v5 offset:10240
ds_read_b128 v[36:39],v5 offset:10752
ds_read_b128 v[40:43],v5 offset:11264
ds_read_b128 v[44:47],v5 offset:11776
s_add_u32 s60,s42,18432
buffer_load_dwordx4 v[96:99],v1,s[4:7],s60 offen
s_add_u32 s60,s42,18432
buffer_load_dwordx4 v[100:103],v1,s[4:7],s60 offen offset:1024
s_waitcnt vmcnt(12)
s_waitcnt lgkmcnt(3)
v_mfma_f32_16x16x32_bf16 v[24:27],v[72:75],v[32:35],0
s_waitcnt lgkmcnt(2)
v_mfma_f32_16x16x32_bf16 v[24:27],v[76:79],v[36:39],v[24:27]
s_waitcnt lgkmcnt(1)
v_mfma_f32_16x16x32_bf16 v[24:27],v[80:83],v[40:43],v[24:27]
s_waitcnt lgkmcnt(0)
v_mfma_f32_16x16x32_bf16 v[24:27],v[84:87],v[44:47],v[24:27]
s_nop 7
ds_write_b128 v5,v[24:27]
s_add_u32 s60,s42,20480
buffer_load_dwordx4 v[72:75],v1,s[4:7],s60 offen
s_add_u32 s60,s42,20480
buffer_load_dwordx4 v[76:79],v1,s[4:7],s60 offen offset:1024
s_waitcnt lgkmcnt(0)
s_barrier
ds_read_b128 v[32:35],v5
ds_read_b128 v[36:39],v5 offset:512
ds_read_b64 v[40:41],v5 offset:1024
s_add_u32 s60,s42,22528
buffer_load_dwordx4 v[80:83],v1,s[4:7],s60 offen
s_add_u32 s60,s42,22528
buffer_load_dwordx4 v[84:87],v1,s[4:7],s60 offen offset:1024
s_waitcnt lgkmcnt(0)
v_max3_f32 v14,v32,v33,v34
v_max3_f32 v15,v35,v36,v37
v_max3_f32 v16,v38,v39,v40
v_max3_f32 v15,v14,v15,v41
v_mov_b32 v29,0
v_max_f32 v14,v15,v16
v_max_f32 v15,v15,v16
s_nop 1
v_permlane32_swap_b32 v14,v15
s_nop 0
v_max_f32 v16,v14,v15
v_max_f32 v14,v14,v15
s_nop 1
v_permlane16_swap_b32 v14,v16
s_nop 0
v_max_f32 v14,v14,v16
v_pk_add_f32 v[40:41],v[40:41],v[14:15] op_sel_hi:[1,0] neg_lo:[0,1] neg_hi:[0,1]
v_pk_add_f32 v[32:33],v[32:33],v[14:15] op_sel_hi:[1,0] neg_lo:[0,1] neg_hi:[0,1]
v_pk_add_f32 v[34:35],v[34:35],v[14:15] op_sel_hi:[1,0] neg_lo:[0,1] neg_hi:[0,1]
v_pk_add_f32 v[36:37],v[36:37],v[14:15] op_sel_hi:[1,0] neg_lo:[0,1] neg_hi:[0,1]
v_pk_add_f32 v[38:39],v[38:39],v[14:15] op_sel_hi:[1,0] neg_lo:[0,1] neg_hi:[0,1]
v_exp_f32 v40,v40
v_exp_f32 v41,v41
v_exp_f32 v32,v32
v_cvt_pk_bf16_f32 v28,v40,v41
v_add_f32 v14,v40,v41
v_exp_f32 v33,v33
v_mfma_f32_16x16x16_bf16 v[40:43],v[48:49],v[28:29],0
v_exp_f32 v34,v34
v_mfma_f32_16x16x16_bf16 v[44:47],v[52:53],v[28:29],0
v_exp_f32 v35,v35
v_exp_f32 v36,v36
v_exp_f32 v37,v37
v_exp_f32 v38,v38
v_exp_f32 v39,v39
v_cvt_pk_bf16_f32 v24,v32,v33
v_cvt_pk_bf16_f32 v25,v34,v35
v_cvt_pk_bf16_f32 v26,v36,v37
v_cvt_pk_bf16_f32 v27,v38,v39
s_waitcnt vmcnt(14)
v_pk_add_f32 v[32:33],v[32:33],v[34:35]
v_pk_add_f32 v[36:37],v[36:37],v[38:39]
v_mfma_f32_16x16x32_bf16 v[40:43],v[88:91],v[24:27],v[40:43]
v_add_f32 v32,v32,v36
v_add_f32 v33,v33,v37
v_mfma_f32_16x16x32_bf16 v[44:47],v[92:95],v[24:27],v[44:47]
v_add_f32 v32,v32,v14
v_add_f32 v14,v32,v33
v_add_f32 v15,v32,v33
v_mov_b32 v88,0
v_mov_b32 v89,0
v_permlane32_swap_b32 v14,v15
v_mov_b32 v90,0
v_add_f32 v16,v14,v15
v_add_f32 v14,v14,v15
v_mov_b32 v91,0
v_mov_b32 v92,0
v_permlane16_swap_b32 v14,v16
v_mov_b32 v93,0
v_add_f32 v14,v14,v16
v_rcp_f32 v14,v14
v_mov_b32 v94,0
v_mov_b32 v95,0
v_pk_mul_f32 v[40:41],v[40:41],v[14:15] op_sel_hi:[1,0]
v_pk_mul_f32 v[42:43],v[42:43],v[14:15] op_sel_hi:[1,0]
v_pk_mul_f32 v[44:45],v[44:45],v[14:15] op_sel_hi:[1,0]
v_pk_mul_f32 v[46:47],v[46:47],v[14:15] op_sel_hi:[1,0]
v_cvt_pk_bf16_f32 v16,v40,v41
v_cvt_pk_bf16_f32 v17,v42,v43
v_cvt_pk_bf16_f32 v18,v44,v45
v_cvt_pk_bf16_f32 v19,v46,v47
ds_write_b128 v7,v[16:19]
s_and_b32 s48,s28,1
s_mov_b64 vcc,s[22:23]
v_mov_b64 v[32:33],0
v_mov_b64 v[34:35],0
v_mov_b64 v[36:37],0
v_mov_b64 v[38:39],0
v_mov_b64 v[40:41],0
v_mov_b64 v[42:43],0
v_mov_b64 v[44:45],0
v_mov_b64 v[46:47],0
v_mov_b64 v[48:49],0
v_mov_b64 v[50:51],0
s_waitcnt lgkmcnt(0)
s_barrier
ds_read_b128 v[24:27],v1 offset:10240
ds_read_b128 v[28:31],v1 offset:11264
v_mov_b64 v[52:53],0
v_mov_b64 v[54:55],0
v_mov_b64 v[16:17],0
v_mov_b64 v[18:19],0
s_waitcnt lgkmcnt(0)
s_waitcnt vmcnt(10)
v_smfmac_f32_16x16x64_bf16 v[32:35],v[24:27],v[56:63],v2
s_waitcnt vmcnt(8)
v_smfmac_f32_16x16x64_bf16 v[32:35],v[28:31],v[104:111],v2
s_waitcnt vmcnt(6)
v_smfmac_f32_16x16x64_bf16 v[36:39],v[24:27],v[64:71],v2
s_waitcnt vmcnt(4)
v_smfmac_f32_16x16x64_bf16 v[36:39],v[28:31],v[96:103],v2
v_smfmac_f32_16x16x64_bf16 v[40:43],v[24:27],v[144:151],v2
s_add_u32 s60,s42,2048
buffer_load_dwordx4 v[104:107],v1,s[4:7],s60 offen
s_nop 0
v_add_f32 v32,v32,v34
v_add_f32 v33,v33,v35
v_smfmac_f32_16x16x64_bf16 v[40:43],v[28:31],v[152:159],v2
v_smfmac_f32_16x16x64_bf16 v[44:47],v[24:27],v[160:167],v2
v_add_f32 v36,v36,v38
v_add_f32 v37,v37,v39
v_cvt_pk_bf16_f32 v38,v32,v36
v_smfmac_f32_16x16x64_bf16 v[44:47],v[28:31],v[168:175],v2
s_add_u32 s60,s42,2048
buffer_load_dwordx4 v[108:111],v1,s[4:7],s60 offen offset:1024
v_cvt_pk_bf16_f32 v39,v33,v37
v_bfi_b32 v38,1,s48,v38
v_bfi_b32 v39,1,s48,v39
v_smfmac_f32_16x16x64_bf16 v[48:51],v[24:27],v[176:183],v2
s_nop 0
v_cndmask_b32_dpp v36,v39,v38,vcc quad_perm:[1,0,3,2] row_mask:0xf bank_mask:0xf
s_not_b64 vcc,vcc
v_cndmask_b32_dpp v37,v38,v39,vcc quad_perm:[1,0,3,2] row_mask:0xf bank_mask:0xf
v_smfmac_f32_16x16x64_bf16 v[48:51],v[28:31],v[184:191],v2
buffer_store_dwordx2 v[36:37],v10,s[4:7],s65 offen sc1
v_add_f32 v40,v40,v42
v_add_f32 v41,v41,v43
v_smfmac_f32_16x16x64_bf16 v[52:55],v[24:27],v[192:199],v2
v_add_f32 v44,v44,v46
v_add_f32 v45,v45,v47
v_cvt_pk_bf16_f32 v32,v40,v44
v_smfmac_f32_16x16x64_bf16 v[52:55],v[28:31],v[200:207],v2
s_add_u32 s60,s42,0
buffer_load_dwordx4 v[96:99],v1,s[4:7],s60 offen
v_cvt_pk_bf16_f32 v34,v41,v45
v_bfi_b32 v32,1,s48,v32
v_bfi_b32 v34,1,s48,v34
v_smfmac_f32_16x16x64_bf16 v[88:91],v[24:27],v[208:215],v2
v_mov_b64 v[40:41],0
v_mov_b64 v[42:43],0
v_add_f32 v48,v48,v50
v_smfmac_f32_16x16x64_bf16 v[88:91],v[28:31],v[216:223],v2
v_add_f32 v49,v49,v51
v_smfmac_f32_16x16x64_bf16 v[92:95],v[24:27],v[224:231],v2
s_add_u32 s60,s42,0
buffer_load_dwordx4 v[100:103],v1,s[4:7],s60 offen offset:1024
v_add_f32 v52,v52,v54
v_add_f32 v53,v53,v55
v_cvt_pk_bf16_f32 v33,v48,v52
v_smfmac_f32_16x16x64_bf16 v[92:95],v[28:31],v[232:239],v2
v_cvt_pk_bf16_f32 v35,v49,v53
v_bfi_b32 v33,1,s48,v33
v_bfi_b32 v35,1,s48,v35
v_smfmac_f32_16x16x64_bf16 v[16:19],v[24:27],v[240:247],v2
buffer_store_dwordx4 v[32:35],v9,s[4:7],s64 offen sc1
v_add_f32 v88,v88,v90
v_add_f32 v89,v89,v91
v_smfmac_f32_16x16x64_bf16 v[16:19],v[28:31],v[248:255],v2
s_waitcnt vmcnt(8)
v_smfmac_f32_16x16x64_bf16 v[40:43],v[24:27],v[72:79],v2
v_add_f32 v92,v92,v94
v_add_f32 v93,v93,v95
v_cvt_pk_bf16_f32 v44,v88,v92
s_waitcnt vmcnt(6)
v_smfmac_f32_16x16x64_bf16 v[40:43],v[28:31],v[80:87],v2
v_cvt_pk_bf16_f32 v46,v89,v93
v_bfi_b32 v44,1,s48,v44
v_bfi_b32 v46,1,s48,v46
v_add_f32 v16,v16,v18
v_add_f32 v17,v17,v19
s_nop 2
v_add_f32 v40,v40,v42
v_add_f32 v41,v41,v43
v_cvt_pk_bf16_f32 v45,v16,v40
v_cvt_pk_bf16_f32 v47,v17,v41
v_bfi_b32 v45,1,s48,v45
v_bfi_b32 v47,1,s48,v47
buffer_store_dwordx4 v[44:47],v9,s[4:7],s63 offen sc1
s_nop 0
s_branch ch_hop_13
ch_rf_16:
s_add_u32 s38,s38,1
s_cmp_lt_u32 s38,100000
s_cbranch_scc1 ch_r_15
s_mov_b32 s40,9
s_branch L_fail
ch_end_7:
ch_fin_12:
s_branch L_end
CH_0_1:
v_and_b32 v14,15,v0
v_lshrrev_b32 v15,4,v0
v_bfe_u32 v16,v0,1,1
v_mul_u32_u24 v2,0xaaaa,v16
v_add_u32 v2,0x4444,v2
v_add_u32 v3,0,v1
v_add_u32 v1,147456,v1
v_lshrrev_b32 v17,3,v14
v_lshlrev_b32 v4,8,v17
v_lshl_add_u32 v4,v16,7,v4
v_lshl_add_u32 v4,v15,5,v4
v_and_b32 v18,1,v0
v_lshl_add_u32 v4,v18,2,v4
v_bfe_u32 v19,v0,2,1
v_lshl_add_u32 v4,v19,3,v4
v_add_u32 v4,157696,v4
v_and_b32 v5,7,v0
v_lshlrev_b32 v5,4,v5
v_lshl_add_u32 v5,v15,7,v5
v_add_u32 v5,147456,v5
v_and_b32 v6,7,v0
v_lshl_add_u32 v6,v17,4,v6
v_add_u32 v6,0,v6
v_lshlrev_b32 v6,4,v6
v_lshl_add_u32 v6,v15,9,v6
v_bfe_u32 v7,v0,1,2
v_lshl_add_u32 v7,v7,2,v18
v_bfe_u32 v8,v0,4,1
v_lshl_add_u32 v7,v8,1,v7
v_lshrrev_b32 v13,5,v0
v_lshl_add_u32 v7,v13,4,v7
v_lshlrev_b32 v7,4,v7
v_add_u32 v7,157696,v7
v_lshlrev_b32 v13,8,v13
v_lshl_add_u32 v13,v14,3,v13
v_lshl_add_u32 v13,v8,2,v13
v_add_u32 v13,161792,v13
v_lshlrev_b32 v8,4,v14
v_lshl_add_u32 v8,v15,9,v8
v_add_u32 v8,131072,v8
v_lshlrev_b32 v9,14,v15
v_lshl_add_u32 v9,v14,4,v9
v_add_u32 v9,0,v9
v_lshrrev_b32 v10,5,v0
v_lshlrev_b32 v10,14,v10
v_and_b32 v32,31,v0
v_lshl_add_u32 v10,v32,3,v10
v_add_u32 v10,0,v10
v_lshlrev_b32 v11,3,v0
s_and_b32 s60,s41,1
s_lshl_b32 s60,s60,6
v_xor_b32 v11,s60,v11
s_lshl_b32 s60,s41,8
v_add_u32 v11,s60,v11
v_mov_b32 v20,0
v_cmp_eq_u32 vcc,0,v14
v_mov_b32 v32,0x3f80
s_nop 0
v_cndmask_b32 v20,v20,v32,vcc
v_cmp_eq_u32 vcc,1,v14
v_mov_b32 v32,0x3f800000
s_nop 0
v_cndmask_b32 v20,v20,v32,vcc
v_mov_b32 v21,0
v_cmp_eq_u32 vcc,2,v14
v_mov_b32 v32,0x3f80
s_nop 0
v_cndmask_b32 v21,v21,v32,vcc
v_cmp_eq_u32 vcc,3,v14
v_mov_b32 v32,0x3f800000
s_nop 0
v_cndmask_b32 v21,v21,v32,vcc
v_mov_b32 v22,0
v_cmp_eq_u32 vcc,4,v14
v_mov_b32 v32,0x3f80
s_nop 0
v_cndmask_b32 v22,v22,v32,vcc
v_cmp_eq_u32 vcc,5,v14
v_mov_b32 v32,0x3f800000
s_nop 0
v_cndmask_b32 v22,v22,v32,vcc
v_mov_b32 v23,0
v_cmp_eq_u32 vcc,6,v14
v_mov_b32 v32,0x3f80
s_nop 0
v_cndmask_b32 v23,v23,v32,vcc
v_cmp_eq_u32 vcc,7,v14
v_mov_b32 v32,0x3f800000
s_nop 0
v_cndmask_b32 v23,v23,v32,vcc
s_mul_i32 s60,s39,0x48000
s_add_u32 s60,s60,0x18010
s_lshl_b32 s101,s39,13
s_xor_b32 s101,s101,s99
s_xor_b32 s101,s101,8192
s_add_u32 s60,s60,s101
s_lshl_b32 s61,s41,8
s_add_u32 s60,s60,s61
v_lshlrev_b32 v12,7,v18
v_lshl_add_u32 v12,v16,4,v12
v_add_u32 v12,s60,v12
s_mul_i32 s37,s39,0x48000
s_add_u32 s37,s37,0x20000
s_lshl_b32 s101,s39,13
s_xor_b32 s101,s101,s99
s_xor_b32 s101,s101,8192
s_add_u32 s37,s37,s101
s_lshl_b32 s61,s41,7
s_add_u32 s37,s37,s61
s_mul_i32 s43,s39,0x3000000
s_add_u32 s43,s43,0x7ad0000
s_lshr_b32 s61,s41,4
s_lshl_b32 s61,s61,18
s_add_u32 s43,s43,s61
s_lshl_b32 s61,s41,13
s_add_u32 s43,s43,s61
s_mul_i32 s44,s39,0x0
s_add_u32 s44,s44,0x3dc000
s_lshl_b32 s101,s39,13
s_xor_b32 s101,s101,s99
s_xor_b32 s101,s101,8192
s_add_u32 s44,s44,s101
s_lshr_b32 s61,s41,1
s_lshl_b32 s61,s61,14
s_add_u32 s44,s44,s61
s_and_b32 s61,s41,1
s_lshl_b32 s61,s61,12
s_add_u32 s44,s44,s61
s_sub_u32 s42,s42,147456
s_lshl_b32 s98,s39,13
s_xor_b32 s98,s98,s99
s_xor_b32 s98,s98,8192
s_mul_i32 s45,s39,0x0
s_add_u32 s45,s45,0x100000
s_add_u32 s45,s45,s98
s_lshl_b32 s61,s41,14
s_add_u32 s32,s45,s61
s_sub_u32 s32,s32,147456
s_lshl_b32 s61,s41,8
s_add_u32 s45,s45,s61
s_mul_i32 s46,s39,0x0
s_add_u32 s46,s46,0x180000
s_add_u32 s46,s46,s98
s_and_b32 s61,s41,7
s_lshl_b32 s61,s61,14
s_add_u32 s33,s46,s61
s_sub_u32 s33,s33,147456
s_lshl_b32 s61,s41,8
s_add_u32 s46,s46,s61
s_mov_b32 s24,s4
s_mov_b32 s25,s5
s_mov_b32 s27,0x20000
s_cmp_lt_u32 s41,8
s_cselect_b32 s26,s6,0
s_mov_b32 s22,0x55555555
s_mov_b32 s23,0x55555555
s_mul_i32 s34,s39,0x0
s_add_u32 s34,s34,0x1a0000
s_add_u32 s34,s34,s98
s_add_u32 s36,s37,32768
s_mov_b32 s35,0x3e0293ee
s_mov_b32 s28,0
s_mov_b32 s66,s32
s_mov_b32 s67,s33
s_mov_b32 s64,s45
s_mov_b32 s65,s46
s_add_u32 s63,s64,0x10000
s_mov_b32 s49,s34
s_add_u32 s69,s34,0x8000
ds_read_b128 v[56:59],v3
ds_read_b128 v[60:63],v3 offset:1024
ds_read_b128 v[64:67],v3 offset:2048
ds_read_b128 v[68:71],v3 offset:3072
s_cmp_eq_u32 s39,0
s_cbranch_scc1 ch_nw_19
s_add_u32 s60,s42,0
buffer_load_dwordx4 v[32:35],v1,s[4:7],s60 offen
s_add_u32 s60,s42,1024
buffer_load_dwordx4 v[32:35],v1,s[4:7],s60 offen
s_add_u32 s60,s42,2048
buffer_load_dwordx4 v[32:35],v1,s[4:7],s60 offen
s_add_u32 s60,s42,3072
buffer_load_dwordx4 v[32:35],v1,s[4:7],s60 offen
s_add_u32 s60,s42,4096
buffer_load_dwordx4 v[32:35],v1,s[4:7],s60 offen
s_add_u32 s60,s42,5120
buffer_load_dwordx4 v[32:35],v1,s[4:7],s60 offen
s_add_u32 s60,s42,6144
buffer_load_dwordx4 v[32:35],v1,s[4:7],s60 offen
s_add_u32 s60,s42,7168
buffer_load_dwordx4 v[32:35],v1,s[4:7],s60 offen
s_add_u32 s60,s42,8192
buffer_load_dwordx4 v[32:35],v1,s[4:7],s60 offen
s_add_u32 s60,s42,9216
buffer_load_dwordx4 v[32:35],v1,s[4:7],s60 offen
s_add_u32 s60,s42,10240
buffer_load_dwordx4 v[32:35],v1,s[4:7],s60 offen
s_add_u32 s60,s42,11264
buffer_load_dwordx4 v[32:35],v1,s[4:7],s60 offen
s_add_u32 s60,s42,12288
buffer_load_dwordx4 v[32:35],v1,s[4:7],s60 offen
s_add_u32 s60,s42,13312
buffer_load_dwordx4 v[32:35],v1,s[4:7],s60 offen
s_add_u32 s60,s42,14336
buffer_load_dwordx4 v[32:35],v1,s[4:7],s60 offen
s_add_u32 s60,s42,15360
buffer_load_dwordx4 v[32:35],v1,s[4:7],s60 offen
s_add_u32 s60,s42,16384
buffer_load_dwordx4 v[32:35],v1,s[4:7],s60 offen
s_add_u32 s60,s42,17408
buffer_load_dwordx4 v[32:35],v1,s[4:7],s60 offen
s_add_u32 s60,s42,18432
buffer_load_dwordx4 v[32:35],v1,s[4:7],s60 offen
s_add_u32 s60,s42,19456
buffer_load_dwordx4 v[32:35],v1,s[4:7],s60 offen
s_add_u32 s60,s42,20480
buffer_load_dwordx4 v[32:35],v1,s[4:7],s60 offen
s_add_u32 s60,s42,21504
buffer_load_dwordx4 v[32:35],v1,s[4:7],s60 offen
s_add_u32 s60,s42,22528
buffer_load_dwordx4 v[32:35],v1,s[4:7],s60 offen
s_add_u32 s60,s42,23552
buffer_load_dwordx4 v[32:35],v1,s[4:7],s60 offen
s_waitcnt vmcnt(0) lgkmcnt(0)
s_getpc_b64 s[60:61]
pc_20:
s_add_u32 s60,s60,ch_beg_18-pc_20
s_addc_u32 s61,s61,0
s_mov_b32 s59,ch_end_17-ch_beg_18-4
v_lshlrev_b32 v38,7,v0
v_add_u32 v38,0,v38
v_min_u32 v38,s59,v38
v_mov_b32 v37,s61
v_add_co_u32 v36,vcc,s60,v38
s_nop 1
v_addc_co_u32 v37,vcc,0,v37,vcc
global_load_dword v39,v[36:37],off
s_waitcnt vmcnt(0)
s_waitcnt vmcnt(0)
s_nop 1
ch_nw_19:
v_lshl_add_u32 v24,v15,1,v16
v_lshlrev_b32 v24,4,v24
v_lshl_add_u32 v24,v18,7,v24
v_lshlrev_b32 v25,6,v19
v_xor_b32 v24,v24,v25
v_bfe_u32 v25,v0,2,2
v_lshl_add_u32 v24,v25,8,v24
v_add_u32 v0,147456,v24
s_mov_b32 s21,0
s_mov_b32 s20,0
v_mov_b64 v[32:33],0
v_mov_b64 v[34:35],0
v_mov_b64 v[36:37],0
v_mov_b64 v[38:39],0
v_mov_b64 v[40:41],0
v_mov_b64 v[42:43],0
v_mov_b64 v[44:45],0
v_mov_b64 v[46:47],0
v_mov_b64 v[48:49],0
v_mov_b64 v[50:51],0
v_mov_b64 v[52:53],0
v_mov_b64 v[54:55],0
s_nop 0
s_branch ch_top_21
ch_beg_18:
ch_hop_23:
ds_read_b128 v[56:59],v3
ds_read_b128 v[60:63],v3 offset:1024
ds_read_b128 v[64:67],v3 offset:2048
ds_read_b128 v[68:71],v3 offset:3072
s_add_u32 s28,s28,1
s_and_b32 s60,s28,3
s_lshl_b32 s60,s60,15
s_add_u32 s47,s34,s60
s_xor_b32 s60,s60,0x10000
s_add_u32 s49,s34,s60
s_mov_b32 s38,0
s_add_u32 s68,s66,4096
s_sleep 9
ch_r_25:
buffer_load_dwordx4 v[24:27],v1,s[4:7],s66 offen sc1
buffer_load_dwordx4 v[28:31],v1,s[4:7],s66 offen offset:1024 sc1
buffer_load_dwordx4 v[32:35],v1,s[4:7],s66 offen offset:2048 sc1
buffer_load_dwordx4 v[36:39],v1,s[4:7],s66 offen offset:3072 sc1
buffer_load_dwordx4 v[40:43],v1,s[4:7],s68 offen sc1
buffer_load_dwordx4 v[44:47],v1,s[4:7],s68 offen offset:1024 sc1
buffer_load_dwordx4 v[48:51],v1,s[4:7],s68 offen offset:2048 sc1
buffer_load_dwordx4 v[52:55],v1,s[4:7],s68 offen offset:3072 sc1
s_waitcnt vmcnt(7)
v_mfma_f32_16x16x32_bf16 v[16:19],v[20:23],v[24:27],0
v_bitop3_b32 v15,v24,v25,s48 bitop3:0x7e
v_bitop3_b32 v14,v26,v27,s48 bitop3:0x7e
v_or_b32 v14,v14,v15
s_waitcnt vmcnt(6)
v_mfma_f32_16x16x32_bf16 v[16:19],v[20:23],v[28:31],v[16:19]
v_bitop3_b32 v15,v28,v29,s48 bitop3:0x7e
v_bitop3_b32 v12,v30,v31,s48 bitop3:0x7e
v_or3_b32 v14,v14,v15,v12
s_waitcnt vmcnt(5)
v_mfma_f32_16x16x32_bf16 v[16:19],v[20:23],v[32:35],v[16:19]
v_bitop3_b32 v15,v32,v33,s48 bitop3:0x7e
v_bitop3_b32 v12,v34,v35,s48 bitop3:0x7e
v_or3_b32 v14,v14,v15,v12
s_waitcnt vmcnt(4)
v_mfma_f32_16x16x32_bf16 v[16:19],v[20:23],v[36:39],v[16:19]
v_bitop3_b32 v15,v36,v37,s48 bitop3:0x7e
v_bitop3_b32 v12,v38,v39,s48 bitop3:0x7e
v_or3_b32 v14,v14,v15,v12
s_waitcnt vmcnt(3)
v_mfma_f32_16x16x32_bf16 v[16:19],v[20:23],v[40:43],v[16:19]
v_bitop3_b32 v15,v40,v41,s48 bitop3:0x7e
v_bitop3_b32 v12,v42,v43,s48 bitop3:0x7e
v_or3_b32 v14,v14,v15,v12
s_waitcnt vmcnt(2)
v_mfma_f32_16x16x32_bf16 v[16:19],v[20:23],v[44:47],v[16:19]
v_bitop3_b32 v15,v44,v45,s48 bitop3:0x7e
v_bitop3_b32 v12,v46,v47,s48 bitop3:0x7e
v_or3_b32 v14,v14,v15,v12
s_waitcnt vmcnt(1)
v_mfma_f32_16x16x32_bf16 v[16:19],v[20:23],v[48:51],v[16:19]
v_bitop3_b32 v15,v48,v49,s48 bitop3:0x7e
v_bitop3_b32 v12,v50,v51,s48 bitop3:0x7e
v_or3_b32 v14,v14,v15,v12
s_waitcnt vmcnt(0)
v_mfma_f32_16x16x32_bf16 v[16:19],v[20:23],v[52:55],v[16:19]
v_bitop3_b32 v15,v52,v53,s48 bitop3:0x7e
v_bitop3_b32 v12,v54,v55,s48 bitop3:0x7e
v_or3_b32 v14,v14,v15,v12
v_and_b32 v14,1,v14
v_cmp_eq_u32 vcc,1,v14
s_nop 2
v_cvt_pk_bf16_f32 v14,v16,v17
v_cvt_pk_bf16_f32 v15,v18,v19
v_min_u32 v14,-2,v14
v_min_u32 v15,-2,v15
s_cbranch_vccnz ch_rf_26
s_mov_b32 exec_hi,0
buffer_store_dwordx2 v[14:15],v11,s[4:7],s47 offen
s_mov_b64 exec,-1
ch_nr_24:
s_waitcnt lgkmcnt(0)
s_barrier
s_add_u32 s60,s42,4096
buffer_load_dwordx4 v[72:75],v1,s[4:7],s60 offen
s_add_u32 s60,s42,4096
buffer_load_dwordx4 v[76:79],v1,s[4:7],s60 offen offset:1024
s_add_u32 s60,s42,6144
buffer_load_dwordx4 v[80:83],v1,s[4:7],s60 offen
s_add_u32 s60,s42,6144
buffer_load_dwordx4 v[84:87],v1,s[4:7],s60 offen offset:1024
s_add_u32 s60,s42,8192
buffer_load_dwordx4 v[88:91],v1,s[4:7],s60 offen
s_add_u32 s60,s42,8192
buffer_load_dwordx4 v[92:95],v1,s[4:7],s60 offen offset:1024
v_mov_b64 v[32:33],0
v_mov_b64 v[34:35],0
v_mov_b64 v[36:37],0
v_mov_b64 v[38:39],0
v_mov_b64 v[40:41],0
v_mov_b64 v[42:43],0
v_mov_b64 v[44:45],0
v_mov_b64 v[46:47],0
v_mov_b64 v[48:49],0
v_mov_b64 v[50:51],0
v_mov_b64 v[52:53],0
v_mov_b64 v[54:55],0
s_add_u32 s69,s28,1
s_and_b32 s69,s69,3
s_lshl_b32 s69,s69,15
s_add_u32 s69,s69,s34
s_waitcnt vmcnt(0)
ch_top_21:
s_waitcnt lgkmcnt(0)
s_barrier
ds_read_b128 v[24:27],v0
ds_read_b128 v[28:31],v0 offset:1024
s_add_u32 s61,s43,4096
v_mov_b64 v[16:17],-1
s_waitcnt lgkmcnt(1)
v_smfmac_f32_16x16x64_bf16 v[32:35],v[24:27],v[96:103],v2
ds_read_b128 v[96:99],v3 offset:4096
v_smfmac_f32_16x16x64_bf16 v[36:39],v[24:27],v[104:111],v2
ds_read_b128 v[100:103],v3 offset:5120
s_add_u32 s60,s42,10240
buffer_load_dwordx4 v[104:107],v1,s[4:7],s60 offen
v_smfmac_f32_16x16x64_bf16 v[48:51],v[24:27],v[56:63],v2
ds_read_b128 v[56:59],v3 offset:6144
v_smfmac_f32_16x16x64_bf16 v[40:43],v[24:27],a[120:127],v2
ds_read_b128 v[60:63],v3 offset:7168
s_add_u32 s60,s42,10240
buffer_load_dwordx4 v[108:111],v1,s[4:7],s60 offen offset:1024
v_smfmac_f32_16x16x64_bf16 v[44:47],v[24:27],a[192:199],v2
v_smfmac_f32_16x16x64_bf16 v[52:55],v[24:27],v[64:71],v2
ds_read_b128 v[24:27],v0 offset:2048
s_waitcnt lgkmcnt(5)
v_smfmac_f32_16x16x64_bf16 v[32:35],v[28:31],v[72:79],v2
ds_read_b128 v[64:67],v3 offset:8192
v_smfmac_f32_16x16x64_bf16 v[36:39],v[28:31],v[80:87],v2
ds_read_b128 v[68:71],v3 offset:9216
s_waitcnt lgkmcnt(5)
v_smfmac_f32_16x16x64_bf16 v[48:51],v[28:31],v[96:103],v2
ds_read_b128 v[96:99],v3 offset:10240
v_smfmac_f32_16x16x64_bf16 v[40:43],v[28:31],v[88:95],v2
ds_read_b128 v[100:103],v3 offset:11264
buffer_load_dwordx4 v[72:75],v6,s[4:7],s43 offen sc1 nt
v_smfmac_f32_16x16x64_bf16 v[44:47],v[28:31],a[200:207],v2
s_waitcnt lgkmcnt(5)
v_smfmac_f32_16x16x64_bf16 v[52:55],v[28:31],v[56:63],v2
ds_read_b128 v[28:31],v0 offset:3072
s_waitcnt lgkmcnt(5)
v_smfmac_f32_16x16x64_bf16 v[32:35],v[24:27],a[0:7],v2
ds_read_b128 v[56:59],v3 offset:12288
v_smfmac_f32_16x16x64_bf16 v[36:39],v[24:27],a[56:63],v2
ds_read_b128 v[60:63],v3 offset:13312
buffer_load_dwordx4 v[76:79],v6,s[4:7],s43 offen offset:2048 sc1 nt
s_waitcnt lgkmcnt(5)
v_smfmac_f32_16x16x64_bf16 v[48:51],v[24:27],v[64:71],v2
ds_read_b128 v[64:67],v3 offset:14336
v_smfmac_f32_16x16x64_bf16 v[40:43],v[24:27],a[128:135],v2
ds_read_b128 v[68:71],v3 offset:15360
v_smfmac_f32_16x16x64_bf16 v[44:47],v[24:27],a[208:215],v2
s_waitcnt lgkmcnt(5)
v_smfmac_f32_16x16x64_bf16 v[52:55],v[24:27],v[96:103],v2
ds_read_b128 v[24:27],v0 offset:4096
buffer_load_dwordx4 v[80:83],v6,s[4:7],s61 offen sc1 nt
s_waitcnt lgkmcnt(5)
v_smfmac_f32_16x16x64_bf16 v[32:35],v[28:31],a[8:15],v2
ds_read_b128 v[96:99],v3 offset:16384
v_smfmac_f32_16x16x64_bf16 v[36:39],v[28:31],a[64:71],v2
ds_read_b128 v[100:103],v3 offset:17408
s_waitcnt lgkmcnt(5)
v_smfmac_f32_16x16x64_bf16 v[48:51],v[28:31],v[56:63],v2
ds_read_b128 v[56:59],v3 offset:18432
v_smfmac_f32_16x16x64_bf16 v[40:43],v[28:31],a[136:143],v2
ds_read_b128 v[60:63],v3 offset:19456
buffer_load_dwordx4 v[84:87],v6,s[4:7],s61 offen offset:2048 sc1 nt
v_smfmac_f32_16x16x64_bf16 v[44:47],v[28:31],a[216:223],v2
s_waitcnt lgkmcnt(5)
v_smfmac_f32_16x16x64_bf16 v[52:55],v[28:31],v[64:71],v2
ds_read_b128 v[28:31],v0 offset:5120
s_waitcnt lgkmcnt(5)
v_smfmac_f32_16x16x64_bf16 v[32:35],v[24:27],a[16:23],v2
ds_read_b128 v[64:67],v3 offset:20480
v_smfmac_f32_16x16x64_bf16 v[36:39],v[24:27],a[72:79],v2
ds_read_b128 v[68:71],v3 offset:21504
buffer_load_dwordx4 v[88:91],v8,s[4:7],s43 offen sc1 nt
s_waitcnt lgkmcnt(5)
v_smfmac_f32_16x16x64_bf16 v[48:51],v[24:27],v[96:103],v2
ds_read_b128 v[96:99],v3 offset:22528
v_smfmac_f32_16x16x64_bf16 v[40:43],v[24:27],a[144:151],v2
ds_read_b128 v[100:103],v3 offset:23552
v_smfmac_f32_16x16x64_bf16 v[44:47],v[24:27],a[224:231],v2
s_waitcnt lgkmcnt(5)
v_smfmac_f32_16x16x64_bf16 v[52:55],v[24:27],v[56:63],v2
ds_read_b128 v[24:27],v0 offset:6144
buffer_load_dwordx4 v[92:95],v8,s[4:7],s43 offen offset:256 sc1 nt
s_waitcnt lgkmcnt(5)
v_smfmac_f32_16x16x64_bf16 v[32:35],v[28:31],a[24:31],v2
ds_read_b128 v[56:59],v3 offset:24576
v_smfmac_f32_16x16x64_bf16 v[36:39],v[28:31],a[80:87],v2
ds_read_b128 v[60:63],v3 offset:25600
s_waitcnt lgkmcnt(5)
v_smfmac_f32_16x16x64_bf16 v[48:51],v[28:31],v[64:71],v2
ds_read_b128 v[64:67],v3 offset:26624
v_smfmac_f32_16x16x64_bf16 v[40:43],v[28:31],a[152:159],v2
ds_read_b128 v[68:71],v3 offset:27648
s_mov_b32 exec_hi,0
buffer_store_dwordx2 v[16:17],v11,s[4:7],s49 offen
buffer_load_dword v12,v11,s[4:7],s69 offen sc1
s_mov_b64 exec,-1
v_smfmac_f32_16x16x64_bf16 v[44:47],v[28:31],a[232:239],v2
s_waitcnt lgkmcnt(5)
v_smfmac_f32_16x16x64_bf16 v[52:55],v[28:31],v[96:103],v2
ds_read_b128 v[28:31],v0 offset:7168
s_waitcnt lgkmcnt(5)
v_smfmac_f32_16x16x64_bf16 v[32:35],v[24:27],a[32:39],v2
ds_read_b128 v[96:99],v3 offset:28672
v_smfmac_f32_16x16x64_bf16 v[36:39],v[24:27],a[88:95],v2
ds_read_b128 v[100:103],v3 offset:29696
s_waitcnt lgkmcnt(5)
v_smfmac_f32_16x16x64_bf16 v[48:51],v[24:27],v[56:63],v2
ds_read_b128 v[56:59],v3 offset:30720
v_smfmac_f32_16x16x64_bf16 v[40:43],v[24:27],a[160:167],v2
ds_read_b128 v[60:63],v3 offset:31744
v_smfmac_f32_16x16x64_bf16 v[44:47],v[24:27],a[240:247],v2
s_waitcnt lgkmcnt(5)
v_smfmac_f32_16x16x64_bf16 v[52:55],v[24:27],v[64:71],v2
ds_read_b128 v[24:27],v0 offset:8192
s_waitcnt lgkmcnt(5)
v_smfmac_f32_16x16x64_bf16 v[32:35],v[28:31],a[40:47],v2
ds_read_b128 v[64:67],v3 offset:32768
v_smfmac_f32_16x16x64_bf16 v[36:39],v[28:31],a[96:103],v2
ds_read_b128 v[68:71],v3 offset:33792
s_waitcnt lgkmcnt(5)
v_smfmac_f32_16x16x64_bf16 v[48:51],v[28:31],v[96:103],v2
ds_read_b128 v[96:99],v3 offset:34816
v_smfmac_f32_16x16x64_bf16 v[40:43],v[28:31],a[168:175],v2
ds_read_b128 v[100:103],v3 offset:35840
v_smfmac_f32_16x16x64_bf16 v[44:47],v[28:31],a[248:255],v2
s_waitcnt lgkmcnt(5)
v_smfmac_f32_16x16x64_bf16 v[52:55],v[28:31],v[56:63],v2
ds_read_b128 v[28:31],v0 offset:9216
s_add_u32 s60,s42,12288
buffer_load_dwordx4 v[56:59],v1,s[4:7],s60 offen
s_waitcnt lgkmcnt(5)
s_waitcnt vmcnt(9)
v_smfmac_f32_16x16x64_bf16 v[32:35],v[24:27],v[104:111],v2
v_smfmac_f32_16x16x64_bf16 v[36:39],v[24:27],a[104:111],v2
v_smfmac_f32_16x16x64_bf16 v[40:43],v[24:27],a[176:183],v2
v_smfmac_f32_16x16x64_bf16 v[44:47],v[24:27],v[112:119],v2
s_add_u32 s60,s42,12288
buffer_load_dwordx4 v[60:63],v1,s[4:7],s60 offen offset:1024
s_waitcnt lgkmcnt(0)
v_smfmac_f32_16x16x64_bf16 v[32:35],v[28:31],a[48:55],v2
v_smfmac_f32_16x16x64_bf16 v[36:39],v[28:31],a[112:119],v2
v_smfmac_f32_16x16x64_bf16 v[40:43],v[28:31],a[184:191],v2
v_smfmac_f32_16x16x64_bf16 v[44:47],v[28:31],v[120:127],v2
s_add_u32 s60,s42,14336
buffer_load_dwordx4 v[104:107],v1,s[4:7],s60 offen
v_smfmac_f32_16x16x64_bf16 v[48:51],v[24:27],v[64:71],v2
s_nop 1
v_add_f32 v32,v32,v34
v_add_f32 v33,v33,v35
v_add_f32 v36,v36,v38
v_smfmac_f32_16x16x64_bf16 v[52:55],v[24:27],v[96:103],v2
v_add_f32 v37,v37,v39
v_mul_f32 v32,s35,v32
v_mul_f32 v33,s35,v33
v_smfmac_f32_16x16x64_bf16 v[48:51],v[28:31],v[128:135],v2
v_mul_f32 v36,s35,v36
v_mul_f32 v37,s35,v37
v_cvt_pk_bf16_f32 v14,v32,v36
v_smfmac_f32_16x16x64_bf16 v[52:55],v[28:31],v[136:143],v2
v_cvt_pk_bf16_f32 v15,v33,v37
ds_write_b32 v4,v14
ds_write_b32 v4,v15 offset:16
s_add_u32 s60,s42,14336
buffer_load_dwordx4 v[108:111],v1,s[4:7],s60 offen offset:1024
s_add_u32 s43,s43,786432
v_add_f32 v40,v40,v42
v_add_f32 v41,v41,v43
v_add_f32 v44,v44,v46
v_add_f32 v45,v45,v47
v_cvt_pk_bf16_f32 v16,v40,v44
v_cvt_pk_bf16_f32 v17,v41,v45
ds_write_b32 v4,v16 offset:2048
ds_write_b32 v4,v17 offset:2064
v_pk_add_f32 v[48:49],v[48:49],v[50:51]
v_pk_add_f32 v[52:53],v[52:53],v[54:55]
v_cvt_pk_bf16_f32 v48,v48,v49
v_mov_b32 v49,0
v_cvt_pk_bf16_f32 v52,v52,v53
v_mov_b32 v53,0
ds_write_b32 v13,v48
ds_write_b32 v13,v52 offset:128
s_add_u32 s60,s42,16384
buffer_load_dwordx4 v[64:67],v1,s[4:7],s60 offen
s_add_u32 s60,s42,16384
buffer_load_dwordx4 v[68:71],v1,s[4:7],s60 offen offset:1024
s_waitcnt lgkmcnt(0)
s_barrier
s_cmp_ge_u32 s28,63
s_cbranch_scc1 ch_fin_22
ds_read_b128 v[32:35],v5 offset:10240
ds_read_b128 v[36:39],v5 offset:10752
ds_read_b128 v[40:43],v5 offset:11264
ds_read_b128 v[44:47],v5 offset:11776
s_add_u32 s60,s42,18432
buffer_load_dwordx4 v[96:99],v1,s[4:7],s60 offen
s_add_u32 s60,s42,18432
buffer_load_dwordx4 v[100:103],v1,s[4:7],s60 offen offset:1024
s_waitcnt vmcnt(12)
s_waitcnt lgkmcnt(3)
v_mfma_f32_16x16x32_bf16 v[24:27],v[72:75],v[32:35],0
s_waitcnt lgkmcnt(2)
v_mfma_f32_16x16x32_bf16 v[24:27],v[76:79],v[36:39],v[24:27]
s_waitcnt lgkmcnt(1)
v_mfma_f32_16x16x32_bf16 v[24:27],v[80:83],v[40:43],v[24:27]
s_waitcnt lgkmcnt(0)
v_mfma_f32_16x16x32_bf16 v[24:27],v[84:87],v[44:47],v[24:27]
s_nop 7
ds_write_b128 v5,v[24:27]
s_add_u32 s60,s42,20480
buffer_load_dwordx4 v[72:75],v1,s[4:7],s60 offen
s_add_u32 s60,s42,20480
buffer_load_dwordx4 v[76:79],v1,s[4:7],s60 offen offset:1024
s_waitcnt lgkmcnt(0)
s_barrier
ds_read_b128 v[32:35],v5
ds_read_b128 v[36:39],v5 offset:512
ds_read_b64 v[40:41],v5 offset:1024
s_add_u32 s60,s42,22528
buffer_load_dwordx4 v[80:83],v1,s[4:7],s60 offen
s_add_u32 s60,s42,22528
buffer_load_dwordx4 v[84:87],v1,s[4:7],s60 offen offset:1024
s_waitcnt lgkmcnt(0)
v_max3_f32 v14,v32,v33,v34
v_max3_f32 v15,v35,v36,v37
v_max3_f32 v16,v38,v39,v40
v_max3_f32 v15,v14,v15,v41
v_mov_b32 v29,0
v_max_f32 v14,v15,v16
v_max_f32 v15,v15,v16
s_nop 1
v_permlane32_swap_b32 v14,v15
s_nop 0
v_max_f32 v16,v14,v15
v_max_f32 v14,v14,v15
s_nop 1
v_permlane16_swap_b32 v14,v16
s_nop 0
v_max_f32 v14,v14,v16
v_pk_add_f32 v[40:41],v[40:41],v[14:15] op_sel_hi:[1,0] neg_lo:[0,1] neg_hi:[0,1]
v_pk_add_f32 v[32:33],v[32:33],v[14:15] op_sel_hi:[1,0] neg_lo:[0,1] neg_hi:[0,1]
v_pk_add_f32 v[34:35],v[34:35],v[14:15] op_sel_hi:[1,0] neg_lo:[0,1] neg_hi:[0,1]
v_pk_add_f32 v[36:37],v[36:37],v[14:15] op_sel_hi:[1,0] neg_lo:[0,1] neg_hi:[0,1]
v_pk_add_f32 v[38:39],v[38:39],v[14:15] op_sel_hi:[1,0] neg_lo:[0,1] neg_hi:[0,1]
v_exp_f32 v40,v40
v_exp_f32 v41,v41
v_exp_f32 v32,v32
v_cvt_pk_bf16_f32 v28,v40,v41
v_add_f32 v14,v40,v41
v_exp_f32 v33,v33
v_mfma_f32_16x16x16_bf16 v[40:43],v[48:49],v[28:29],0
v_exp_f32 v34,v34
v_mfma_f32_16x16x16_bf16 v[44:47],v[52:53],v[28:29],0
v_exp_f32 v35,v35
v_exp_f32 v36,v36
v_exp_f32 v37,v37
v_exp_f32 v38,v38
v_exp_f32 v39,v39
v_cvt_pk_bf16_f32 v24,v32,v33
v_cvt_pk_bf16_f32 v25,v34,v35
v_cvt_pk_bf16_f32 v26,v36,v37
v_cvt_pk_bf16_f32 v27,v38,v39
s_waitcnt vmcnt(14)
v_pk_add_f32 v[32:33],v[32:33],v[34:35]
v_pk_add_f32 v[36:37],v[36:37],v[38:39]
v_mfma_f32_16x16x32_bf16 v[40:43],v[88:91],v[24:27],v[40:43]
v_add_f32 v32,v32,v36
v_add_f32 v33,v33,v37
v_mfma_f32_16x16x32_bf16 v[44:47],v[92:95],v[24:27],v[44:47]
v_add_f32 v32,v32,v14
v_add_f32 v14,v32,v33
v_add_f32 v15,v32,v33
v_mov_b32 v88,0
v_mov_b32 v89,0
v_permlane32_swap_b32 v14,v15
v_mov_b32 v90,0
v_add_f32 v16,v14,v15
v_add_f32 v14,v14,v15
v_mov_b32 v91,0
v_mov_b32 v92,0
v_permlane16_swap_b32 v14,v16
v_mov_b32 v93,0
v_add_f32 v14,v14,v16
v_rcp_f32 v14,v14
v_mov_b32 v94,0
v_mov_b32 v95,0
v_pk_mul_f32 v[40:41],v[40:41],v[14:15] op_sel_hi:[1,0]
v_pk_mul_f32 v[42:43],v[42:43],v[14:15] op_sel_hi:[1,0]
v_pk_mul_f32 v[44:45],v[44:45],v[14:15] op_sel_hi:[1,0]
v_pk_mul_f32 v[46:47],v[46:47],v[14:15] op_sel_hi:[1,0]
v_cvt_pk_bf16_f32 v16,v40,v41
v_cvt_pk_bf16_f32 v17,v42,v43
v_cvt_pk_bf16_f32 v18,v44,v45
v_cvt_pk_bf16_f32 v19,v46,v47
ds_write_b128 v7,v[16:19]
s_and_b32 s48,s28,1
s_mov_b64 vcc,s[22:23]
v_mov_b64 v[32:33],0
v_mov_b64 v[34:35],0
v_mov_b64 v[36:37],0
v_mov_b64 v[38:39],0
v_mov_b64 v[40:41],0
v_mov_b64 v[42:43],0
v_mov_b64 v[44:45],0
v_mov_b64 v[46:47],0
v_mov_b64 v[48:49],0
v_mov_b64 v[50:51],0
s_waitcnt lgkmcnt(0)
s_barrier
ds_read_b128 v[24:27],v1 offset:10240
ds_read_b128 v[28:31],v1 offset:11264
v_mov_b64 v[52:53],0
v_mov_b64 v[54:55],0
v_mov_b64 v[16:17],0
v_mov_b64 v[18:19],0
s_waitcnt lgkmcnt(0)
s_waitcnt vmcnt(10)
v_smfmac_f32_16x16x64_bf16 v[32:35],v[24:27],v[56:63],v2
s_waitcnt vmcnt(8)
v_smfmac_f32_16x16x64_bf16 v[32:35],v[28:31],v[104:111],v2
s_waitcnt vmcnt(6)
v_smfmac_f32_16x16x64_bf16 v[36:39],v[24:27],v[64:71],v2
s_waitcnt vmcnt(4)
v_smfmac_f32_16x16x64_bf16 v[36:39],v[28:31],v[96:103],v2
v_smfmac_f32_16x16x64_bf16 v[40:43],v[24:27],v[144:151],v2
s_add_u32 s60,s42,2048
buffer_load_dwordx4 v[104:107],v1,s[4:7],s60 offen
s_nop 0
v_add_f32 v32,v32,v34
v_add_f32 v33,v33,v35
v_smfmac_f32_16x16x64_bf16 v[40:43],v[28:31],v[152:159],v2
v_smfmac_f32_16x16x64_bf16 v[44:47],v[24:27],v[160:167],v2
v_add_f32 v36,v36,v38
v_add_f32 v37,v37,v39
v_cvt_pk_bf16_f32 v38,v32,v36
v_smfmac_f32_16x16x64_bf16 v[44:47],v[28:31],v[168:175],v2
s_add_u32 s60,s42,2048
buffer_load_dwordx4 v[108:111],v1,s[4:7],s60 offen offset:1024
v_cvt_pk_bf16_f32 v39,v33,v37
v_bfi_b32 v38,1,s48,v38
v_bfi_b32 v39,1,s48,v39
v_smfmac_f32_16x16x64_bf16 v[48:51],v[24:27],v[176:183],v2
s_nop 0
v_cndmask_b32_dpp v36,v39,v38,vcc quad_perm:[1,0,3,2] row_mask:0xf bank_mask:0xf
s_not_b64 vcc,vcc
v_cndmask_b32_dpp v37,v38,v39,vcc quad_perm:[1,0,3,2] row_mask:0xf bank_mask:0xf
v_smfmac_f32_16x16x64_bf16 v[48:51],v[28:31],v[184:191],v2
buffer_store_dwordx2 v[36:37],v10,s[4:7],s65 offen
v_add_f32 v40,v40,v42
v_add_f32 v41,v41,v43
v_smfmac_f32_16x16x64_bf16 v[52:55],v[24:27],v[192:199],v2
v_add_f32 v44,v44,v46
v_add_f32 v45,v45,v47
v_cvt_pk_bf16_f32 v32,v40,v44
v_smfmac_f32_16x16x64_bf16 v[52:55],v[28:31],v[200:207],v2
s_add_u32 s60,s42,0
buffer_load_dwordx4 v[96:99],v1,s[4:7],s60 offen
v_cvt_pk_bf16_f32 v34,v41,v45
v_bfi_b32 v32,1,s48,v32
v_bfi_b32 v34,1,s48,v34
v_smfmac_f32_16x16x64_bf16 v[88:91],v[24:27],v[208:215],v2
v_mov_b64 v[40:41],0
v_mov_b64 v[42:43],0
v_add_f32 v48,v48,v50
v_smfmac_f32_16x16x64_bf16 v[88:91],v[28:31],v[216:223],v2
v_add_f32 v49,v49,v51
v_smfmac_f32_16x16x64_bf16 v[92:95],v[24:27],v[224:231],v2
s_add_u32 s60,s42,0
buffer_load_dwordx4 v[100:103],v1,s[4:7],s60 offen offset:1024
v_add_f32 v52,v52,v54
v_add_f32 v53,v53,v55
v_cvt_pk_bf16_f32 v33,v48,v52
v_smfmac_f32_16x16x64_bf16 v[92:95],v[28:31],v[232:239],v2
v_cvt_pk_bf16_f32 v35,v49,v53
v_bfi_b32 v33,1,s48,v33
v_bfi_b32 v35,1,s48,v35
v_smfmac_f32_16x16x64_bf16 v[16:19],v[24:27],v[240:247],v2
buffer_store_dwordx4 v[32:35],v9,s[4:7],s64 offen
v_add_f32 v88,v88,v90
v_add_f32 v89,v89,v91
v_smfmac_f32_16x16x64_bf16 v[16:19],v[28:31],v[248:255],v2
s_waitcnt vmcnt(8)
v_smfmac_f32_16x16x64_bf16 v[40:43],v[24:27],v[72:79],v2
v_add_f32 v92,v92,v94
v_add_f32 v93,v93,v95
v_cvt_pk_bf16_f32 v44,v88,v92
s_waitcnt vmcnt(6)
v_smfmac_f32_16x16x64_bf16 v[40:43],v[28:31],v[80:87],v2
v_cvt_pk_bf16_f32 v46,v89,v93
v_bfi_b32 v44,1,s48,v44
v_bfi_b32 v46,1,s48,v46
v_add_f32 v16,v16,v18
v_add_f32 v17,v17,v19
s_nop 2
v_add_f32 v40,v40,v42
v_add_f32 v41,v41,v43
v_cvt_pk_bf16_f32 v45,v16,v40
v_cvt_pk_bf16_f32 v47,v17,v41
v_bfi_b32 v45,1,s48,v45
v_bfi_b32 v47,1,s48,v47
buffer_store_dwordx4 v[44:47],v9,s[4:7],s63 offen
s_nop 0
s_branch ch_hop_23
ch_rf_26:
s_add_u32 s38,s38,1
s_cmp_lt_u32 s38,100000
s_cbranch_scc1 ch_r_25
s_mov_b32 s40,9
s_branch L_fail
ch_end_17:
ch_fin_22:
s_branch L_end
CH_1_0:
v_and_b32 v14,15,v0
v_lshrrev_b32 v15,4,v0
v_bfe_u32 v16,v0,1,1
v_mul_u32_u24 v2,0xaaaa,v16
v_add_u32 v2,0x4444,v2
v_add_u32 v3,36864,v1
v_add_u32 v1,147456,v1
v_lshrrev_b32 v17,3,v14
v_lshlrev_b32 v4,8,v17
v_lshl_add_u32 v4,v16,7,v4
v_lshl_add_u32 v4,v15,5,v4
v_and_b32 v18,1,v0
v_lshl_add_u32 v4,v18,2,v4
v_bfe_u32 v19,v0,2,1
v_lshl_add_u32 v4,v19,3,v4
v_add_u32 v4,158208,v4
v_and_b32 v5,7,v0
v_lshlrev_b32 v5,4,v5
v_lshl_add_u32 v5,v15,7,v5
v_add_u32 v5,147456,v5
v_and_b32 v6,7,v0
v_lshl_add_u32 v6,v17,4,v6
v_add_u32 v6,8,v6
v_lshlrev_b32 v6,4,v6
v_lshl_add_u32 v6,v15,9,v6
v_bfe_u32 v7,v0,1,2
v_lshl_add_u32 v7,v7,2,v18
v_bfe_u32 v8,v0,4,1
v_lshl_add_u32 v7,v8,1,v7
v_lshrrev_b32 v13,5,v0
v_lshl_add_u32 v7,v13,4,v7
v_lshlrev_b32 v7,4,v7
v_add_u32 v7,158208,v7
v_lshlrev_b32 v13,8,v13
v_lshl_add_u32 v13,v14,3,v13
v_lshl_add_u32 v13,v8,2,v13
v_add_u32 v13,162304,v13
v_lshlrev_b32 v8,4,v14
v_lshl_add_u32 v8,v15,9,v8
v_add_u32 v8,133120,v8
v_lshlrev_b32 v9,14,v15
v_lshl_add_u32 v9,v14,4,v9
v_add_u32 v9,131072,v9
v_lshrrev_b32 v10,5,v0
v_lshlrev_b32 v10,14,v10
v_and_b32 v32,31,v0
v_lshl_add_u32 v10,v32,3,v10
v_add_u32 v10,32768,v10
v_and_b32 v11,7,v0
v_lshlrev_b32 v11,3,v11
v_lshl_add_u32 v11,v15,7,v11
s_bfe_u32 s60,s41,0x10001
s_lshl_b32 s60,s60,6
v_add_u32 v11,s60,v11
v_lshlrev_b32 v32,6,v17
v_xor_b32 v11,v32,v11
v_lshl_add_u32 v11,v17,8,v11
s_lshr_b32 s60,s41,2
s_lshl_b32 s60,s60,10
s_and_b32 s61,s41,1
s_lshl_b32 s61,s61,9
s_add_u32 s60,s60,s61
s_add_u32 s60,s60,16384
v_add_u32 v11,s60,v11
v_mov_b32 v20,0
v_cmp_eq_u32 vcc,0,v14
v_mov_b32 v32,0x3f80
s_nop 0
v_cndmask_b32 v20,v20,v32,vcc
v_cmp_eq_u32 vcc,1,v14
v_mov_b32 v32,0x3f800000
s_nop 0
v_cndmask_b32 v20,v20,v32,vcc
v_mov_b32 v21,0
v_cmp_eq_u32 vcc,2,v14
v_mov_b32 v32,0x3f80
s_nop 0
v_cndmask_b32 v21,v21,v32,vcc
v_cmp_eq_u32 vcc,3,v14
v_mov_b32 v32,0x3f800000
s_nop 0
v_cndmask_b32 v21,v21,v32,vcc
v_mov_b32 v22,0
v_cmp_eq_u32 vcc,4,v14
v_mov_b32 v32,0x3f80
s_nop 0
v_cndmask_b32 v22,v22,v32,vcc
v_cmp_eq_u32 vcc,5,v14
v_mov_b32 v32,0x3f800000
s_nop 0
v_cndmask_b32 v22,v22,v32,vcc
v_mov_b32 v23,0
v_cmp_eq_u32 vcc,6,v14
v_mov_b32 v32,0x3f80
s_nop 0
v_cndmask_b32 v23,v23,v32,vcc
v_cmp_eq_u32 vcc,7,v14
v_mov_b32 v32,0x3f800000
s_nop 0
v_cndmask_b32 v23,v23,v32,vcc
s_mul_i32 s60,s39,0x48000
s_add_u32 s60,s60,0x18010
s_lshl_b32 s101,s39,13
s_xor_b32 s101,s101,s99
s_xor_b32 s101,s101,8192
s_add_u32 s60,s60,s101
s_lshl_b32 s61,s41,8
s_add_u32 s60,s60,s61
v_lshlrev_b32 v12,7,v18
v_lshl_add_u32 v12,v16,4,v12
v_add_u32 v12,s60,v12
s_mul_i32 s37,s39,0x48000
s_add_u32 s37,s37,0x20000
s_lshl_b32 s101,s39,13
s_xor_b32 s101,s101,s99
s_xor_b32 s101,s101,8192
s_add_u32 s37,s37,s101
s_lshl_b32 s61,s41,7
s_add_u32 s37,s37,s61
s_mul_i32 s43,s39,0x3000000
s_add_u32 s43,s43,0x7ad0000
s_lshr_b32 s61,s41,4
s_lshl_b32 s61,s61,18
s_add_u32 s43,s43,s61
s_lshl_b32 s61,s41,13
s_add_u32 s43,s43,s61
s_mul_i32 s44,s39,0x0
s_add_u32 s44,s44,0x3dc000
s_lshl_b32 s101,s39,13
s_xor_b32 s101,s101,s99
s_xor_b32 s101,s101,8192
s_add_u32 s44,s44,s101
s_lshr_b32 s61,s41,1
s_lshl_b32 s61,s61,14
s_add_u32 s44,s44,s61
s_and_b32 s61,s41,1
s_lshl_b32 s61,s61,12
s_add_u32 s44,s44,s61
s_sub_u32 s42,s42,147456
s_lshl_b32 s98,s39,13
s_xor_b32 s98,s98,s99
s_xor_b32 s98,s98,8192
s_mul_i32 s45,s39,0x0
s_add_u32 s45,s45,0x100000
s_add_u32 s45,s45,s98
s_lshl_b32 s61,s41,14
s_add_u32 s32,s45,s61
s_sub_u32 s32,s32,147456
s_lshl_b32 s61,s41,8
s_add_u32 s45,s45,s61
s_mul_i32 s46,s39,0x0
s_add_u32 s46,s46,0x180000
s_add_u32 s46,s46,s98
s_and_b32 s61,s41,7
s_lshl_b32 s61,s61,14
s_add_u32 s33,s46,s61
s_sub_u32 s33,s33,147456
s_lshl_b32 s61,s41,8
s_add_u32 s46,s46,s61
s_mov_b32 s24,s4
s_mov_b32 s25,s5
s_mov_b32 s27,0x20000
s_cmp_lt_u32 s41,8
s_cselect_b32 s26,s6,0
s_mov_b32 s22,0x55555555
s_mov_b32 s23,0x55555555
s_mul_i32 s34,s39,0x0
s_add_u32 s34,s34,0x1a0000
s_add_u32 s34,s34,s98
s_add_u32 s36,s37,32768
s_mov_b32 s35,0x3e0293ee
s_mov_b32 s28,0
s_mov_b32 s66,s32
s_mov_b32 s67,s33
s_mov_b32 s64,s45
s_mov_b32 s65,s46
s_add_u32 s63,s64,0x10000
s_mov_b32 s49,s34
s_add_u32 s69,s34,0x8000
ds_read_b128 v[56:59],v3
ds_read_b128 v[60:63],v3 offset:1024
ds_read_b128 v[64:67],v3 offset:2048
ds_read_b128 v[68:71],v3 offset:3072
s_cmp_eq_u32 s39,0
s_cbranch_scc1 ch_nw_29
s_add_u32 s60,s42,0
buffer_load_dwordx4 v[32:35],v1,s[4:7],s60 offen
s_add_u32 s60,s42,1024
buffer_load_dwordx4 v[32:35],v1,s[4:7],s60 offen
s_add_u32 s60,s42,2048
buffer_load_dwordx4 v[32:35],v1,s[4:7],s60 offen
s_add_u32 s60,s42,3072
buffer_load_dwordx4 v[32:35],v1,s[4:7],s60 offen
s_add_u32 s60,s42,4096
buffer_load_dwordx4 v[32:35],v1,s[4:7],s60 offen
s_add_u32 s60,s42,5120
buffer_load_dwordx4 v[32:35],v1,s[4:7],s60 offen
s_add_u32 s60,s42,6144
buffer_load_dwordx4 v[32:35],v1,s[4:7],s60 offen
s_add_u32 s60,s42,7168
buffer_load_dwordx4 v[32:35],v1,s[4:7],s60 offen
s_add_u32 s60,s42,8192
buffer_load_dwordx4 v[32:35],v1,s[4:7],s60 offen
s_add_u32 s60,s42,9216
buffer_load_dwordx4 v[32:35],v1,s[4:7],s60 offen
s_add_u32 s60,s42,10240
buffer_load_dwordx4 v[32:35],v1,s[4:7],s60 offen
s_add_u32 s60,s42,11264
buffer_load_dwordx4 v[32:35],v1,s[4:7],s60 offen
s_add_u32 s60,s42,12288
buffer_load_dwordx4 v[32:35],v1,s[4:7],s60 offen
s_add_u32 s60,s42,13312
buffer_load_dwordx4 v[32:35],v1,s[4:7],s60 offen
s_add_u32 s60,s42,14336
buffer_load_dwordx4 v[32:35],v1,s[4:7],s60 offen
s_add_u32 s60,s42,15360
buffer_load_dwordx4 v[32:35],v1,s[4:7],s60 offen
s_add_u32 s60,s42,16384
buffer_load_dwordx4 v[32:35],v1,s[4:7],s60 offen
s_add_u32 s60,s42,17408
buffer_load_dwordx4 v[32:35],v1,s[4:7],s60 offen
s_add_u32 s60,s42,18432
buffer_load_dwordx4 v[32:35],v1,s[4:7],s60 offen
s_add_u32 s60,s42,19456
buffer_load_dwordx4 v[32:35],v1,s[4:7],s60 offen
s_add_u32 s60,s42,20480
buffer_load_dwordx4 v[32:35],v1,s[4:7],s60 offen
s_add_u32 s60,s42,21504
buffer_load_dwordx4 v[32:35],v1,s[4:7],s60 offen
s_add_u32 s60,s42,22528
buffer_load_dwordx4 v[32:35],v1,s[4:7],s60 offen
s_add_u32 s60,s42,23552
buffer_load_dwordx4 v[32:35],v1,s[4:7],s60 offen
s_waitcnt vmcnt(0) lgkmcnt(0)
s_getpc_b64 s[60:61]
pc_30:
s_add_u32 s60,s60,ch_beg_28-pc_30
s_addc_u32 s61,s61,0
s_mov_b32 s59,ch_end_27-ch_beg_28-4
v_lshlrev_b32 v38,7,v0
v_add_u32 v38,0,v38
v_min_u32 v38,s59,v38
v_mov_b32 v37,s61
v_add_co_u32 v36,vcc,s60,v38
s_nop 1
v_addc_co_u32 v37,vcc,0,v37,vcc
global_load_dword v39,v[36:37],off
s_waitcnt vmcnt(0)
s_waitcnt vmcnt(0)
s_nop 1
ch_nw_29:
v_lshl_add_u32 v24,v15,1,v16
v_lshlrev_b32 v24,4,v24
v_lshl_add_u32 v24,v18,7,v24
v_lshlrev_b32 v25,6,v19
v_xor_b32 v24,v24,v25
v_bfe_u32 v25,v0,2,2
v_lshl_add_u32 v24,v25,8,v24
v_add_u32 v0,147456,v24
s_mov_b32 s21,0
s_mov_b32 s20,0
v_mov_b64 v[32:33],0
v_mov_b64 v[34:35],0
v_mov_b64 v[36:37],0
v_mov_b64 v[38:39],0
v_mov_b64 v[40:41],0
v_mov_b64 v[42:43],0
v_mov_b64 v[44:45],0
v_mov_b64 v[46:47],0
v_mov_b64 v[48:49],0
v_mov_b64 v[50:51],0
v_mov_b64 v[52:53],0
v_mov_b64 v[54:55],0
s_nop 0
s_branch ch_top_31
ch_beg_28:
ch_hop_33:
ds_read_b128 v[56:59],v3
ds_read_b128 v[60:63],v3 offset:1024
ds_read_b128 v[64:67],v3 offset:2048
ds_read_b128 v[68:71],v3 offset:3072
s_add_u32 s28,s28,1
s_and_b32 s60,s28,3
s_lshl_b32 s60,s60,15
s_add_u32 s47,s34,s60
s_xor_b32 s60,s60,0x10000
s_add_u32 s49,s34,s60
s_mov_b32 s38,0
s_cmp_ge_u32 s41,8
s_cbranch_scc1 ch_nr_34
s_add_u32 s68,s67,4096
ch_r_35:
buffer_load_dwordx4 v[24:27],v1,s[4:7],s67 offen sc1
buffer_load_dwordx4 v[28:31],v1,s[4:7],s67 offen offset:1024 sc1
buffer_load_dwordx4 v[32:35],v1,s[4:7],s67 offen offset:2048 sc1
buffer_load_dwordx4 v[36:39],v1,s[4:7],s67 offen offset:3072 sc1
buffer_load_dwordx4 v[40:43],v1,s[4:7],s68 offen sc1
buffer_load_dwordx4 v[44:47],v1,s[4:7],s68 offen offset:1024 sc1
buffer_load_dwordx4 v[48:51],v1,s[4:7],s68 offen offset:2048 sc1
buffer_load_dwordx4 v[52:55],v1,s[4:7],s68 offen offset:3072 sc1
s_waitcnt vmcnt(7)
v_mfma_f32_16x16x32_bf16 v[16:19],v[20:23],v[24:27],0
v_bitop3_b32 v15,v24,v25,s48 bitop3:0x7e
v_bitop3_b32 v14,v26,v27,s48 bitop3:0x7e
v_or_b32 v14,v14,v15
s_waitcnt vmcnt(6)
v_mfma_f32_16x16x32_bf16 v[16:19],v[20:23],v[28:31],v[16:19]
v_bitop3_b32 v15,v28,v29,s48 bitop3:0x7e
v_bitop3_b32 v12,v30,v31,s48 bitop3:0x7e
v_or3_b32 v14,v14,v15,v12
s_waitcnt vmcnt(5)
v_mfma_f32_16x16x32_bf16 v[16:19],v[20:23],v[32:35],v[16:19]
v_bitop3_b32 v15,v32,v33,s48 bitop3:0x7e
v_bitop3_b32 v12,v34,v35,s48 bitop3:0x7e
v_or3_b32 v14,v14,v15,v12
s_waitcnt vmcnt(4)
v_mfma_f32_16x16x32_bf16 v[16:19],v[20:23],v[36:39],v[16:19]
v_bitop3_b32 v15,v36,v37,s48 bitop3:0x7e
v_bitop3_b32 v12,v38,v39,s48 bitop3:0x7e
v_or3_b32 v14,v14,v15,v12
s_waitcnt vmcnt(3)
v_mfma_f32_16x16x32_bf16 v[16:19],v[20:23],v[40:43],v[16:19]
v_bitop3_b32 v15,v40,v41,s48 bitop3:0x7e
v_bitop3_b32 v12,v42,v43,s48 bitop3:0x7e
v_or3_b32 v14,v14,v15,v12
s_waitcnt vmcnt(2)
v_mfma_f32_16x16x32_bf16 v[16:19],v[20:23],v[44:47],v[16:19]
v_bitop3_b32 v15,v44,v45,s48 bitop3:0x7e
v_bitop3_b32 v12,v46,v47,s48 bitop3:0x7e
v_or3_b32 v14,v14,v15,v12
s_waitcnt vmcnt(1)
v_mfma_f32_16x16x32_bf16 v[16:19],v[20:23],v[48:51],v[16:19]
v_bitop3_b32 v15,v48,v49,s48 bitop3:0x7e
v_bitop3_b32 v12,v50,v51,s48 bitop3:0x7e
v_or3_b32 v14,v14,v15,v12
s_waitcnt vmcnt(0)
v_mfma_f32_16x16x32_bf16 v[16:19],v[20:23],v[52:55],v[16:19]
v_bitop3_b32 v15,v52,v53,s48 bitop3:0x7e
v_bitop3_b32 v12,v54,v55,s48 bitop3:0x7e
v_or3_b32 v14,v14,v15,v12
v_and_b32 v14,1,v14
v_cmp_eq_u32 vcc,1,v14
s_nop 2
v_cvt_pk_bf16_f32 v14,v16,v17
v_cvt_pk_bf16_f32 v15,v18,v19
v_min_u32 v14,-2,v14
v_min_u32 v15,-2,v15
s_cbranch_vccnz ch_rf_36
s_mov_b32 exec_hi,0
buffer_store_dwordx2 v[14:15],v11,s[4:7],s47 offen sc1
s_mov_b64 exec,-1
ch_nr_34:
s_waitcnt lgkmcnt(0)
s_barrier
s_add_u32 s60,s42,4096
buffer_load_dwordx4 v[72:75],v1,s[4:7],s60 offen
s_add_u32 s60,s42,4096
buffer_load_dwordx4 v[76:79],v1,s[4:7],s60 offen offset:1024
s_add_u32 s60,s42,6144
buffer_load_dwordx4 v[80:83],v1,s[4:7],s60 offen
s_add_u32 s60,s42,6144
buffer_load_dwordx4 v[84:87],v1,s[4:7],s60 offen offset:1024
s_add_u32 s60,s42,8192
buffer_load_dwordx4 v[88:91],v1,s[4:7],s60 offen
s_add_u32 s60,s42,8192
buffer_load_dwordx4 v[92:95],v1,s[4:7],s60 offen offset:1024
v_mov_b64 v[32:33],0
v_mov_b64 v[34:35],0
v_mov_b64 v[36:37],0
v_mov_b64 v[38:39],0
v_mov_b64 v[40:41],0
v_mov_b64 v[42:43],0
v_mov_b64 v[44:45],0
v_mov_b64 v[46:47],0
v_mov_b64 v[48:49],0
v_mov_b64 v[50:51],0
v_mov_b64 v[52:53],0
v_mov_b64 v[54:55],0
s_add_u32 s69,s28,1
s_and_b32 s69,s69,3
s_lshl_b32 s69,s69,15
s_add_u32 s69,s69,s34
s_waitcnt vmcnt(0)
ch_top_31:
s_waitcnt lgkmcnt(0)
s_barrier
ds_read_b128 v[24:27],v0
ds_read_b128 v[28:31],v0 offset:1024
s_add_u32 s61,s43,4096
v_mov_b64 v[16:17],-1
s_waitcnt lgkmcnt(1)
v_smfmac_f32_16x16x64_bf16 v[32:35],v[24:27],v[96:103],v2
ds_read_b128 v[96:99],v3 offset:4096
v_smfmac_f32_16x16x64_bf16 v[36:39],v[24:27],v[104:111],v2
ds_read_b128 v[100:103],v3 offset:5120
s_add_u32 s60,s42,10240
buffer_load_dwordx4 v[104:107],v1,s[4:7],s60 offen
v_smfmac_f32_16x16x64_bf16 v[48:51],v[24:27],v[56:63],v2
ds_read_b128 v[56:59],v3 offset:6144
v_smfmac_f32_16x16x64_bf16 v[40:43],v[24:27],a[120:127],v2
ds_read_b128 v[60:63],v3 offset:7168
s_add_u32 s60,s42,10240
buffer_load_dwordx4 v[108:111],v1,s[4:7],s60 offen offset:1024
v_smfmac_f32_16x16x64_bf16 v[44:47],v[24:27],a[192:199],v2
v_smfmac_f32_16x16x64_bf16 v[52:55],v[24:27],v[64:71],v2
ds_read_b128 v[24:27],v0 offset:2048
s_waitcnt lgkmcnt(5)
v_smfmac_f32_16x16x64_bf16 v[32:35],v[28:31],v[72:79],v2
ds_read_b128 v[64:67],v3 offset:8192
v_smfmac_f32_16x16x64_bf16 v[36:39],v[28:31],v[80:87],v2
ds_read_b128 v[68:71],v3 offset:9216
s_waitcnt lgkmcnt(5)
v_smfmac_f32_16x16x64_bf16 v[48:51],v[28:31],v[96:103],v2
ds_read_b128 v[96:99],v3 offset:10240
v_smfmac_f32_16x16x64_bf16 v[40:43],v[28:31],v[88:95],v2
ds_read_b128 v[100:103],v3 offset:11264
buffer_load_dwordx4 v[72:75],v6,s[4:7],s43 offen sc1 nt
v_smfmac_f32_16x16x64_bf16 v[44:47],v[28:31],a[200:207],v2
s_waitcnt lgkmcnt(5)
v_smfmac_f32_16x16x64_bf16 v[52:55],v[28:31],v[56:63],v2
ds_read_b128 v[28:31],v0 offset:3072
s_waitcnt lgkmcnt(5)
v_smfmac_f32_16x16x64_bf16 v[32:35],v[24:27],a[0:7],v2
ds_read_b128 v[56:59],v3 offset:12288
v_smfmac_f32_16x16x64_bf16 v[36:39],v[24:27],a[56:63],v2
ds_read_b128 v[60:63],v3 offset:13312
buffer_load_dwordx4 v[76:79],v6,s[4:7],s43 offen offset:2048 sc1 nt
s_waitcnt lgkmcnt(5)
v_smfmac_f32_16x16x64_bf16 v[48:51],v[24:27],v[64:71],v2
ds_read_b128 v[64:67],v3 offset:14336
v_smfmac_f32_16x16x64_bf16 v[40:43],v[24:27],a[128:135],v2
ds_read_b128 v[68:71],v3 offset:15360
v_smfmac_f32_16x16x64_bf16 v[44:47],v[24:27],a[208:215],v2
s_waitcnt lgkmcnt(5)
v_smfmac_f32_16x16x64_bf16 v[52:55],v[24:27],v[96:103],v2
ds_read_b128 v[24:27],v0 offset:4096
buffer_load_dwordx4 v[80:83],v6,s[4:7],s61 offen sc1 nt
s_waitcnt lgkmcnt(5)
v_smfmac_f32_16x16x64_bf16 v[32:35],v[28:31],a[8:15],v2
ds_read_b128 v[96:99],v3 offset:16384
v_smfmac_f32_16x16x64_bf16 v[36:39],v[28:31],a[64:71],v2
ds_read_b128 v[100:103],v3 offset:17408
s_waitcnt lgkmcnt(5)
v_smfmac_f32_16x16x64_bf16 v[48:51],v[28:31],v[56:63],v2
ds_read_b128 v[56:59],v3 offset:18432
v_smfmac_f32_16x16x64_bf16 v[40:43],v[28:31],a[136:143],v2
ds_read_b128 v[60:63],v3 offset:19456
buffer_load_dwordx4 v[84:87],v6,s[4:7],s61 offen offset:2048 sc1 nt
v_smfmac_f32_16x16x64_bf16 v[44:47],v[28:31],a[216:223],v2
s_waitcnt lgkmcnt(5)
v_smfmac_f32_16x16x64_bf16 v[52:55],v[28:31],v[64:71],v2
ds_read_b128 v[28:31],v0 offset:5120
s_waitcnt lgkmcnt(5)
v_smfmac_f32_16x16x64_bf16 v[32:35],v[24:27],a[16:23],v2
ds_read_b128 v[64:67],v3 offset:20480
v_smfmac_f32_16x16x64_bf16 v[36:39],v[24:27],a[72:79],v2
ds_read_b128 v[68:71],v3 offset:21504
buffer_load_dwordx4 v[88:91],v8,s[4:7],s43 offen sc1 nt
s_waitcnt lgkmcnt(5)
v_smfmac_f32_16x16x64_bf16 v[48:51],v[24:27],v[96:103],v2
ds_read_b128 v[96:99],v3 offset:22528
v_smfmac_f32_16x16x64_bf16 v[40:43],v[24:27],a[144:151],v2
ds_read_b128 v[100:103],v3 offset:23552
v_smfmac_f32_16x16x64_bf16 v[44:47],v[24:27],a[224:231],v2
s_waitcnt lgkmcnt(5)
v_smfmac_f32_16x16x64_bf16 v[52:55],v[24:27],v[56:63],v2
ds_read_b128 v[24:27],v0 offset:6144
buffer_load_dwordx4 v[92:95],v8,s[4:7],s43 offen offset:256 sc1 nt
s_waitcnt lgkmcnt(5)
v_smfmac_f32_16x16x64_bf16 v[32:35],v[28:31],a[24:31],v2
ds_read_b128 v[56:59],v3 offset:24576
v_smfmac_f32_16x16x64_bf16 v[36:39],v[28:31],a[80:87],v2
ds_read_b128 v[60:63],v3 offset:25600
s_waitcnt lgkmcnt(5)
v_smfmac_f32_16x16x64_bf16 v[48:51],v[28:31],v[64:71],v2
ds_read_b128 v[64:67],v3 offset:26624
v_smfmac_f32_16x16x64_bf16 v[40:43],v[28:31],a[152:159],v2
ds_read_b128 v[68:71],v3 offset:27648
s_mov_b32 exec_hi,0
buffer_store_dwordx2 v[16:17],v11,s[24:27],s49 offen sc1
buffer_load_dword v12,v11,s[24:27],s69 offen sc1
s_mov_b64 exec,-1
v_smfmac_f32_16x16x64_bf16 v[44:47],v[28:31],a[232:239],v2
s_waitcnt lgkmcnt(5)
v_smfmac_f32_16x16x64_bf16 v[52:55],v[28:31],v[96:103],v2
ds_read_b128 v[28:31],v0 offset:7168
s_waitcnt lgkmcnt(5)
v_smfmac_f32_16x16x64_bf16 v[32:35],v[24:27],a[32:39],v2
ds_read_b128 v[96:99],v3 offset:28672
v_smfmac_f32_16x16x64_bf16 v[36:39],v[24:27],a[88:95],v2
ds_read_b128 v[100:103],v3 offset:29696
s_waitcnt lgkmcnt(5)
v_smfmac_f32_16x16x64_bf16 v[48:51],v[24:27],v[56:63],v2
ds_read_b128 v[56:59],v3 offset:30720
v_smfmac_f32_16x16x64_bf16 v[40:43],v[24:27],a[160:167],v2
ds_read_b128 v[60:63],v3 offset:31744
v_smfmac_f32_16x16x64_bf16 v[44:47],v[24:27],a[240:247],v2
s_waitcnt lgkmcnt(5)
v_smfmac_f32_16x16x64_bf16 v[52:55],v[24:27],v[64:71],v2
ds_read_b128 v[24:27],v0 offset:8192
s_waitcnt lgkmcnt(5)
v_smfmac_f32_16x16x64_bf16 v[32:35],v[28:31],a[40:47],v2
ds_read_b128 v[64:67],v3 offset:32768
v_smfmac_f32_16x16x64_bf16 v[36:39],v[28:31],a[96:103],v2
ds_read_b128 v[68:71],v3 offset:33792
s_waitcnt lgkmcnt(5)
v_smfmac_f32_16x16x64_bf16 v[48:51],v[28:31],v[96:103],v2
ds_read_b128 v[96:99],v3 offset:34816
v_smfmac_f32_16x16x64_bf16 v[40:43],v[28:31],a[168:175],v2
ds_read_b128 v[100:103],v3 offset:35840
v_smfmac_f32_16x16x64_bf16 v[44:47],v[28:31],a[248:255],v2
s_waitcnt lgkmcnt(5)
v_smfmac_f32_16x16x64_bf16 v[52:55],v[28:31],v[56:63],v2
ds_read_b128 v[28:31],v0 offset:9216
s_add_u32 s60,s42,12288
buffer_load_dwordx4 v[56:59],v1,s[4:7],s60 offen
s_waitcnt lgkmcnt(5)
s_waitcnt vmcnt(9)
v_smfmac_f32_16x16x64_bf16 v[32:35],v[24:27],v[104:111],v2
v_smfmac_f32_16x16x64_bf16 v[36:39],v[24:27],a[104:111],v2
v_smfmac_f32_16x16x64_bf16 v[40:43],v[24:27],a[176:183],v2
v_smfmac_f32_16x16x64_bf16 v[44:47],v[24:27],v[112:119],v2
s_add_u32 s60,s42,12288
buffer_load_dwordx4 v[60:63],v1,s[4:7],s60 offen offset:1024
s_waitcnt lgkmcnt(0)
v_smfmac_f32_16x16x64_bf16 v[32:35],v[28:31],a[48:55],v2
v_smfmac_f32_16x16x64_bf16 v[36:39],v[28:31],a[112:119],v2
v_smfmac_f32_16x16x64_bf16 v[40:43],v[28:31],a[184:191],v2
v_smfmac_f32_16x16x64_bf16 v[44:47],v[28:31],v[120:127],v2
s_add_u32 s60,s42,14336
buffer_load_dwordx4 v[104:107],v1,s[4:7],s60 offen
v_smfmac_f32_16x16x64_bf16 v[48:51],v[24:27],v[64:71],v2
s_nop 1
v_add_f32 v32,v32,v34
v_add_f32 v33,v33,v35
v_add_f32 v36,v36,v38
v_smfmac_f32_16x16x64_bf16 v[52:55],v[24:27],v[96:103],v2
v_add_f32 v37,v37,v39
v_mul_f32 v32,s35,v32
v_mul_f32 v33,s35,v33
v_smfmac_f32_16x16x64_bf16 v[48:51],v[28:31],v[128:135],v2
v_mul_f32 v36,s35,v36
v_mul_f32 v37,s35,v37
v_cvt_pk_bf16_f32 v14,v32,v36
v_smfmac_f32_16x16x64_bf16 v[52:55],v[28:31],v[136:143],v2
v_cvt_pk_bf16_f32 v15,v33,v37
ds_write_b32 v4,v14
ds_write_b32 v4,v15 offset:16
s_add_u32 s60,s42,14336
buffer_load_dwordx4 v[108:111],v1,s[4:7],s60 offen offset:1024
s_add_u32 s43,s43,786432
v_add_f32 v40,v40,v42
v_add_f32 v41,v41,v43
v_add_f32 v44,v44,v46
v_add_f32 v45,v45,v47
v_cvt_pk_bf16_f32 v16,v40,v44
v_cvt_pk_bf16_f32 v17,v41,v45
ds_write_b32 v4,v16 offset:2048
ds_write_b32 v4,v17 offset:2064
v_pk_add_f32 v[48:49],v[48:49],v[50:51]
v_pk_add_f32 v[52:53],v[52:53],v[54:55]
v_cvt_pk_bf16_f32 v48,v48,v49
v_mov_b32 v49,0
v_cvt_pk_bf16_f32 v52,v52,v53
v_mov_b32 v53,0
ds_write_b32 v13,v48
ds_write_b32 v13,v52 offset:128
s_add_u32 s60,s42,16384
buffer_load_dwordx4 v[64:67],v1,s[4:7],s60 offen
s_add_u32 s60,s42,16384
buffer_load_dwordx4 v[68:71],v1,s[4:7],s60 offen offset:1024
s_waitcnt lgkmcnt(0)
s_barrier
s_cmp_ge_u32 s28,63
s_cbranch_scc1 ch_fin_32
ds_read_b128 v[32:35],v5 offset:10240
ds_read_b128 v[36:39],v5 offset:10752
ds_read_b128 v[40:43],v5 offset:11264
ds_read_b128 v[44:47],v5 offset:11776
s_add_u32 s60,s42,18432
buffer_load_dwordx4 v[96:99],v1,s[4:7],s60 offen
s_add_u32 s60,s42,18432
buffer_load_dwordx4 v[100:103],v1,s[4:7],s60 offen offset:1024
s_waitcnt vmcnt(12)
s_waitcnt lgkmcnt(3)
v_mfma_f32_16x16x32_bf16 v[24:27],v[72:75],v[32:35],0
s_waitcnt lgkmcnt(2)
v_mfma_f32_16x16x32_bf16 v[24:27],v[76:79],v[36:39],v[24:27]
s_waitcnt lgkmcnt(1)
v_mfma_f32_16x16x32_bf16 v[24:27],v[80:83],v[40:43],v[24:27]
s_waitcnt lgkmcnt(0)
v_mfma_f32_16x16x32_bf16 v[24:27],v[84:87],v[44:47],v[24:27]
s_nop 7
ds_write_b128 v5,v[24:27] offset:512
s_add_u32 s60,s42,20480
buffer_load_dwordx4 v[72:75],v1,s[4:7],s60 offen
s_add_u32 s60,s42,20480
buffer_load_dwordx4 v[76:79],v1,s[4:7],s60 offen offset:1024
s_waitcnt lgkmcnt(0)
s_barrier
ds_read_b128 v[32:35],v5
ds_read_b128 v[36:39],v5 offset:512
ds_read_b64 v[40:41],v5 offset:1024
s_add_u32 s60,s42,22528
buffer_load_dwordx4 v[80:83],v1,s[4:7],s60 offen
s_add_u32 s60,s42,22528
buffer_load_dwordx4 v[84:87],v1,s[4:7],s60 offen offset:1024
s_waitcnt lgkmcnt(0)
v_max3_f32 v14,v32,v33,v34
v_max3_f32 v15,v35,v36,v37
v_max3_f32 v16,v38,v39,v40
v_max3_f32 v15,v14,v15,v41
v_mov_b32 v29,0
v_max_f32 v14,v15,v16
v_max_f32 v15,v15,v16
s_nop 1
v_permlane32_swap_b32 v14,v15
s_nop 0
v_max_f32 v16,v14,v15
v_max_f32 v14,v14,v15
s_nop 1
v_permlane16_swap_b32 v14,v16
s_nop 0
v_max_f32 v14,v14,v16
v_pk_add_f32 v[40:41],v[40:41],v[14:15] op_sel_hi:[1,0] neg_lo:[0,1] neg_hi:[0,1]
v_pk_add_f32 v[32:33],v[32:33],v[14:15] op_sel_hi:[1,0] neg_lo:[0,1] neg_hi:[0,1]
v_pk_add_f32 v[34:35],v[34:35],v[14:15] op_sel_hi:[1,0] neg_lo:[0,1] neg_hi:[0,1]
v_pk_add_f32 v[36:37],v[36:37],v[14:15] op_sel_hi:[1,0] neg_lo:[0,1] neg_hi:[0,1]
v_pk_add_f32 v[38:39],v[38:39],v[14:15] op_sel_hi:[1,0] neg_lo:[0,1] neg_hi:[0,1]
v_exp_f32 v40,v40
v_exp_f32 v41,v41
v_exp_f32 v32,v32
v_cvt_pk_bf16_f32 v28,v40,v41
v_add_f32 v14,v40,v41
v_exp_f32 v33,v33
v_mfma_f32_16x16x16_bf16 v[40:43],v[48:49],v[28:29],0
v_exp_f32 v34,v34
v_mfma_f32_16x16x16_bf16 v[44:47],v[52:53],v[28:29],0
v_exp_f32 v35,v35
v_exp_f32 v36,v36
v_exp_f32 v37,v37
v_exp_f32 v38,v38
v_exp_f32 v39,v39
v_cvt_pk_bf16_f32 v24,v32,v33
v_cvt_pk_bf16_f32 v25,v34,v35
v_cvt_pk_bf16_f32 v26,v36,v37
v_cvt_pk_bf16_f32 v27,v38,v39
s_waitcnt vmcnt(14)
v_pk_add_f32 v[32:33],v[32:33],v[34:35]
v_pk_add_f32 v[36:37],v[36:37],v[38:39]
v_mfma_f32_16x16x32_bf16 v[40:43],v[88:91],v[24:27],v[40:43]
v_add_f32 v32,v32,v36
v_add_f32 v33,v33,v37
v_mfma_f32_16x16x32_bf16 v[44:47],v[92:95],v[24:27],v[44:47]
v_add_f32 v32,v32,v14
v_add_f32 v14,v32,v33
v_add_f32 v15,v32,v33
v_mov_b32 v88,0
v_mov_b32 v89,0
v_permlane32_swap_b32 v14,v15
v_mov_b32 v90,0
v_add_f32 v16,v14,v15
v_add_f32 v14,v14,v15
v_mov_b32 v91,0
v_mov_b32 v92,0
v_permlane16_swap_b32 v14,v16
v_mov_b32 v93,0
v_add_f32 v14,v14,v16
v_rcp_f32 v14,v14
v_mov_b32 v94,0
v_mov_b32 v95,0
v_pk_mul_f32 v[40:41],v[40:41],v[14:15] op_sel_hi:[1,0]
v_pk_mul_f32 v[42:43],v[42:43],v[14:15] op_sel_hi:[1,0]
v_pk_mul_f32 v[44:45],v[44:45],v[14:15] op_sel_hi:[1,0]
v_pk_mul_f32 v[46:47],v[46:47],v[14:15] op_sel_hi:[1,0]
v_cvt_pk_bf16_f32 v16,v40,v41
v_cvt_pk_bf16_f32 v17,v42,v43
v_cvt_pk_bf16_f32 v18,v44,v45
v_cvt_pk_bf16_f32 v19,v46,v47
ds_write_b128 v7,v[16:19]
s_and_b32 s48,s28,1
s_mov_b64 vcc,s[22:23]
v_mov_b64 v[32:33],0
v_mov_b64 v[34:35],0
v_mov_b64 v[36:37],0
v_mov_b64 v[38:39],0
v_mov_b64 v[40:41],0
v_mov_b64 v[42:43],0
v_mov_b64 v[44:45],0
v_mov_b64 v[46:47],0
v_mov_b64 v[48:49],0
v_mov_b64 v[50:51],0
s_waitcnt lgkmcnt(0)
s_barrier
ds_read_b128 v[24:27],v1 offset:10240
ds_read_b128 v[28:31],v1 offset:11264
v_mov_b64 v[52:53],0
v_mov_b64 v[54:55],0
v_mov_b64 v[16:17],0
v_mov_b64 v[18:19],0
s_waitcnt lgkmcnt(0)
s_waitcnt vmcnt(10)
v_smfmac_f32_16x16x64_bf16 v[32:35],v[24:27],v[56:63],v2
s_waitcnt vmcnt(8)
v_smfmac_f32_16x16x64_bf16 v[32:35],v[28:31],v[104:111],v2
s_waitcnt vmcnt(6)
v_smfmac_f32_16x16x64_bf16 v[36:39],v[24:27],v[64:71],v2
s_waitcnt vmcnt(4)
v_smfmac_f32_16x16x64_bf16 v[36:39],v[28:31],v[96:103],v2
v_smfmac_f32_16x16x64_bf16 v[40:43],v[24:27],v[144:151],v2
s_add_u32 s60,s42,2048
buffer_load_dwordx4 v[104:107],v1,s[4:7],s60 offen
s_nop 0
v_add_f32 v32,v32,v34
v_add_f32 v33,v33,v35
v_smfmac_f32_16x16x64_bf16 v[40:43],v[28:31],v[152:159],v2
v_smfmac_f32_16x16x64_bf16 v[44:47],v[24:27],v[160:167],v2
v_add_f32 v36,v36,v38
v_add_f32 v37,v37,v39
v_cvt_pk_bf16_f32 v38,v32,v36
v_smfmac_f32_16x16x64_bf16 v[44:47],v[28:31],v[168:175],v2
s_add_u32 s60,s42,2048
buffer_load_dwordx4 v[108:111],v1,s[4:7],s60 offen offset:1024
v_cvt_pk_bf16_f32 v39,v33,v37
v_bfi_b32 v38,1,s48,v38
v_bfi_b32 v39,1,s48,v39
v_smfmac_f32_16x16x64_bf16 v[48:51],v[24:27],v[176:183],v2
s_nop 0
v_cndmask_b32_dpp v36,v39,v38,vcc quad_perm:[1,0,3,2] row_mask:0xf bank_mask:0xf
s_not_b64 vcc,vcc
v_cndmask_b32_dpp v37,v38,v39,vcc quad_perm:[1,0,3,2] row_mask:0xf bank_mask:0xf
v_smfmac_f32_16x16x64_bf16 v[48:51],v[28:31],v[184:191],v2
buffer_store_dwordx2 v[36:37],v10,s[4:7],s65 offen sc1
v_add_f32 v40,v40,v42
v_add_f32 v41,v41,v43
v_smfmac_f32_16x16x64_bf16 v[52:55],v[24:27],v[192:199],v2
v_add_f32 v44,v44,v46
v_add_f32 v45,v45,v47
v_cvt_pk_bf16_f32 v32,v40,v44
v_smfmac_f32_16x16x64_bf16 v[52:55],v[28:31],v[200:207],v2
s_add_u32 s60,s42,0
buffer_load_dwordx4 v[96:99],v1,s[4:7],s60 offen
v_cvt_pk_bf16_f32 v34,v41,v45
v_bfi_b32 v32,1,s48,v32
v_bfi_b32 v34,1,s48,v34
v_smfmac_f32_16x16x64_bf16 v[88:91],v[24:27],v[208:215],v2
v_mov_b64 v[40:41],0
v_mov_b64 v[42:43],0
v_add_f32 v48,v48,v50
v_smfmac_f32_16x16x64_bf16 v[88:91],v[28:31],v[216:223],v2
v_add_f32 v49,v49,v51
v_smfmac_f32_16x16x64_bf16 v[92:95],v[24:27],v[224:231],v2
s_add_u32 s60,s42,0
buffer_load_dwordx4 v[100:103],v1,s[4:7],s60 offen offset:1024
v_add_f32 v52,v52,v54
v_add_f32 v53,v53,v55
v_cvt_pk_bf16_f32 v33,v48,v52
v_smfmac_f32_16x16x64_bf16 v[92:95],v[28:31],v[232:239],v2
v_cvt_pk_bf16_f32 v35,v49,v53
v_bfi_b32 v33,1,s48,v33
v_bfi_b32 v35,1,s48,v35
v_smfmac_f32_16x16x64_bf16 v[16:19],v[24:27],v[240:247],v2
buffer_store_dwordx4 v[32:35],v9,s[4:7],s64 offen sc1
v_add_f32 v88,v88,v90
v_add_f32 v89,v89,v91
v_smfmac_f32_16x16x64_bf16 v[16:19],v[28:31],v[248:255],v2
s_waitcnt vmcnt(8)
v_smfmac_f32_16x16x64_bf16 v[40:43],v[24:27],v[72:79],v2
v_add_f32 v92,v92,v94
v_add_f32 v93,v93,v95
v_cvt_pk_bf16_f32 v44,v88,v92
s_waitcnt vmcnt(6)
v_smfmac_f32_16x16x64_bf16 v[40:43],v[28:31],v[80:87],v2
v_cvt_pk_bf16_f32 v46,v89,v93
v_bfi_b32 v44,1,s48,v44
v_bfi_b32 v46,1,s48,v46
v_add_f32 v16,v16,v18
v_add_f32 v17,v17,v19
s_nop 2
v_add_f32 v40,v40,v42
v_add_f32 v41,v41,v43
v_cvt_pk_bf16_f32 v45,v16,v40
v_cvt_pk_bf16_f32 v47,v17,v41
v_bfi_b32 v45,1,s48,v45
v_bfi_b32 v47,1,s48,v47
buffer_store_dwordx4 v[44:47],v9,s[4:7],s63 offen sc1
s_nop 0
s_branch ch_hop_33
ch_rf_36:
s_add_u32 s38,s38,1
s_cmp_lt_u32 s38,100000
s_cbranch_scc1 ch_r_35
s_mov_b32 s40,9
s_branch L_fail
ch_end_27:
ch_fin_32:
s_branch L_end
CH_1_1:
v_and_b32 v14,15,v0
v_lshrrev_b32 v15,4,v0
v_bfe_u32 v16,v0,1,1
v_mul_u32_u24 v2,0xaaaa,v16
v_add_u32 v2,0x4444,v2
v_add_u32 v3,36864,v1
v_add_u32 v1,147456,v1
v_lshrrev_b32 v17,3,v14
v_lshlrev_b32 v4,8,v17
v_lshl_add_u32 v4,v16,7,v4
v_lshl_add_u32 v4,v15,5,v4
v_and_b32 v18,1,v0
v_lshl_add_u32 v4,v18,2,v4
v_bfe_u32 v19,v0,2,1
v_lshl_add_u32 v4,v19,3,v4
v_add_u32 v4,158208,v4
v_and_b32 v5,7,v0
v_lshlrev_b32 v5,4,v5
v_lshl_add_u32 v5,v15,7,v5
v_add_u32 v5,147456,v5
v_and_b32 v6,7,v0
v_lshl_add_u32 v6,v17,4,v6
v_add_u32 v6,8,v6
v_lshlrev_b32 v6,4,v6
v_lshl_add_u32 v6,v15,9,v6
v_bfe_u32 v7,v0,1,2
v_lshl_add_u32 v7,v7,2,v18
v_bfe_u32 v8,v0,4,1
v_lshl_add_u32 v7,v8,1,v7
v_lshrrev_b32 v13,5,v0
v_lshl_add_u32 v7,v13,4,v7
v_lshlrev_b32 v7,4,v7
v_add_u32 v7,158208,v7
v_lshlrev_b32 v13,8,v13
v_lshl_add_u32 v13,v14,3,v13
v_lshl_add_u32 v13,v8,2,v13
v_add_u32 v13,162304,v13
v_lshlrev_b32 v8,4,v14
v_lshl_add_u32 v8,v15,9,v8
v_add_u32 v8,133120,v8
v_lshlrev_b32 v9,14,v15
v_lshl_add_u32 v9,v14,4,v9
v_add_u32 v9,131072,v9
v_lshrrev_b32 v10,5,v0
v_lshlrev_b32 v10,14,v10
v_and_b32 v32,31,v0
v_lshl_add_u32 v10,v32,3,v10
v_add_u32 v10,32768,v10
v_and_b32 v11,7,v0
v_lshlrev_b32 v11,3,v11
v_lshl_add_u32 v11,v15,7,v11
s_bfe_u32 s60,s41,0x10001
s_lshl_b32 s60,s60,6
v_add_u32 v11,s60,v11
v_lshlrev_b32 v32,6,v17
v_xor_b32 v11,v32,v11
v_lshl_add_u32 v11,v17,8,v11
s_lshr_b32 s60,s41,2
s_lshl_b32 s60,s60,10
s_and_b32 s61,s41,1
s_lshl_b32 s61,s61,9
s_add_u32 s60,s60,s61
s_add_u32 s60,s60,16384
v_add_u32 v11,s60,v11
v_mov_b32 v20,0
v_cmp_eq_u32 vcc,0,v14
v_mov_b32 v32,0x3f80
s_nop 0
v_cndmask_b32 v20,v20,v32,vcc
v_cmp_eq_u32 vcc,1,v14
v_mov_b32 v32,0x3f800000
s_nop 0
v_cndmask_b32 v20,v20,v32,vcc
v_mov_b32 v21,0
v_cmp_eq_u32 vcc,2,v14
v_mov_b32 v32,0x3f80
s_nop 0
v_cndmask_b32 v21,v21,v32,vcc
v_cmp_eq_u32 vcc,3,v14
v_mov_b32 v32,0x3f800000
s_nop 0
v_cndmask_b32 v21,v21,v32,vcc
v_mov_b32 v22,0
v_cmp_eq_u32 vcc,4,v14
v_mov_b32 v32,0x3f80
s_nop 0
v_cndmask_b32 v22,v22,v32,vcc
v_cmp_eq_u32 vcc,5,v14
v_mov_b32 v32,0x3f800000
s_nop 0
v_cndmask_b32 v22,v22,v32,vcc
v_mov_b32 v23,0
v_cmp_eq_u32 vcc,6,v14
v_mov_b32 v32,0x3f80
s_nop 0
v_cndmask_b32 v23,v23,v32,vcc
v_cmp_eq_u32 vcc,7,v14
v_mov_b32 v32,0x3f800000
s_nop 0
v_cndmask_b32 v23,v23,v32,vcc
s_mul_i32 s60,s39,0x48000
s_add_u32 s60,s60,0x18010
s_lshl_b32 s101,s39,13
s_xor_b32 s101,s101,s99
s_xor_b32 s101,s101,8192
s_add_u32 s60,s60,s101
s_lshl_b32 s61,s41,8
s_add_u32 s60,s60,s61
v_lshlrev_b32 v12,7,v18
v_lshl_add_u32 v12,v16,4,v12
v_add_u32 v12,s60,v12
s_mul_i32 s37,s39,0x48000
s_add_u32 s37,s37,0x20000
s_lshl_b32 s101,s39,13
s_xor_b32 s101,s101,s99
s_xor_b32 s101,s101,8192
s_add_u32 s37,s37,s101
s_lshl_b32 s61,s41,7
s_add_u32 s37,s37,s61
s_mul_i32 s43,s39,0x3000000
s_add_u32 s43,s43,0x7ad0000
s_lshr_b32 s61,s41,4
s_lshl_b32 s61,s61,18
s_add_u32 s43,s43,s61
s_lshl_b32 s61,s41,13
s_add_u32 s43,s43,s61
s_mul_i32 s44,s39,0x0
s_add_u32 s44,s44,0x3dc000
s_lshl_b32 s101,s39,13
s_xor_b32 s101,s101,s99
s_xor_b32 s101,s101,8192
s_add_u32 s44,s44,s101
s_lshr_b32 s61,s41,1
s_lshl_b32 s61,s61,14
s_add_u32 s44,s44,s61
s_and_b32 s61,s41,1
s_lshl_b32 s61,s61,12
s_add_u32 s44,s44,s61
s_sub_u32 s42,s42,147456
s_lshl_b32 s98,s39,13
s_xor_b32 s98,s98,s99
s_xor_b32 s98,s98,8192
s_mul_i32 s45,s39,0x0
s_add_u32 s45,s45,0x100000
s_add_u32 s45,s45,s98
s_lshl_b32 s61,s41,14
s_add_u32 s32,s45,s61
s_sub_u32 s32,s32,147456
s_lshl_b32 s61,s41,8
s_add_u32 s45,s45,s61
s_mul_i32 s46,s39,0x0
s_add_u32 s46,s46,0x180000
s_add_u32 s46,s46,s98
s_and_b32 s61,s41,7
s_lshl_b32 s61,s61,14
s_add_u32 s33,s46,s61
s_sub_u32 s33,s33,147456
s_lshl_b32 s61,s41,8
s_add_u32 s46,s46,s61
s_mov_b32 s24,s4
s_mov_b32 s25,s5
s_mov_b32 s27,0x20000
s_cmp_lt_u32 s41,8
s_cselect_b32 s26,s6,0
s_mov_b32 s22,0x55555555
s_mov_b32 s23,0x55555555
s_mul_i32 s34,s39,0x0
s_add_u32 s34,s34,0x1a0000
s_add_u32 s34,s34,s98
s_add_u32 s36,s37,32768
s_mov_b32 s35,0x3e0293ee
s_mov_b32 s28,0
s_mov_b32 s66,s32
s_mov_b32 s67,s33
s_mov_b32 s64,s45
s_mov_b32 s65,s46
s_add_u32 s63,s64,0x10000
s_mov_b32 s49,s34
s_add_u32 s69,s34,0x8000
ds_read_b128 v[56:59],v3
ds_read_b128 v[60:63],v3 offset:1024
ds_read_b128 v[64:67],v3 offset:2048
ds_read_b128 v[68:71],v3 offset:3072
s_cmp_eq_u32 s39,0
s_cbranch_scc1 ch_nw_39
s_add_u32 s60,s42,0
buffer_load_dwordx4 v[32:35],v1,s[4:7],s60 offen
s_add_u32 s60,s42,1024
buffer_load_dwordx4 v[32:35],v1,s[4:7],s60 offen
s_add_u32 s60,s42,2048
buffer_load_dwordx4 v[32:35],v1,s[4:7],s60 offen
s_add_u32 s60,s42,3072
buffer_load_dwordx4 v[32:35],v1,s[4:7],s60 offen
s_add_u32 s60,s42,4096
buffer_load_dwordx4 v[32:35],v1,s[4:7],s60 offen
s_add_u32 s60,s42,5120
buffer_load_dwordx4 v[32:35],v1,s[4:7],s60 offen
s_add_u32 s60,s42,6144
buffer_load_dwordx4 v[32:35],v1,s[4:7],s60 offen
s_add_u32 s60,s42,7168
buffer_load_dwordx4 v[32:35],v1,s[4:7],s60 offen
s_add_u32 s60,s42,8192
buffer_load_dwordx4 v[32:35],v1,s[4:7],s60 offen
s_add_u32 s60,s42,9216
buffer_load_dwordx4 v[32:35],v1,s[4:7],s60 offen
s_add_u32 s60,s42,10240
buffer_load_dwordx4 v[32:35],v1,s[4:7],s60 offen
s_add_u32 s60,s42,11264
buffer_load_dwordx4 v[32:35],v1,s[4:7],s60 offen
s_add_u32 s60,s42,12288
buffer_load_dwordx4 v[32:35],v1,s[4:7],s60 offen
s_add_u32 s60,s42,13312
buffer_load_dwordx4 v[32:35],v1,s[4:7],s60 offen
s_add_u32 s60,s42,14336
buffer_load_dwordx4 v[32:35],v1,s[4:7],s60 offen
s_add_u32 s60,s42,15360
buffer_load_dwordx4 v[32:35],v1,s[4:7],s60 offen
s_add_u32 s60,s42,16384
buffer_load_dwordx4 v[32:35],v1,s[4:7],s60 offen
s_add_u32 s60,s42,17408
buffer_load_dwordx4 v[32:35],v1,s[4:7],s60 offen
s_add_u32 s60,s42,18432
buffer_load_dwordx4 v[32:35],v1,s[4:7],s60 offen
s_add_u32 s60,s42,19456
buffer_load_dwordx4 v[32:35],v1,s[4:7],s60 offen
s_add_u32 s60,s42,20480
buffer_load_dwordx4 v[32:35],v1,s[4:7],s60 offen
s_add_u32 s60,s42,21504
buffer_load_dwordx4 v[32:35],v1,s[4:7],s60 offen
s_add_u32 s60,s42,22528
buffer_load_dwordx4 v[32:35],v1,s[4:7],s60 offen
s_add_u32 s60,s42,23552
buffer_load_dwordx4 v[32:35],v1,s[4:7],s60 offen
s_waitcnt vmcnt(0) lgkmcnt(0)
s_getpc_b64 s[60:61]
pc_40:
s_add_u32 s60,s60,ch_beg_38-pc_40
s_addc_u32 s61,s61,0
s_mov_b32 s59,ch_end_37-ch_beg_38-4
v_lshlrev_b32 v38,7,v0
v_add_u32 v38,0,v38
v_min_u32 v38,s59,v38
v_mov_b32 v37,s61
v_add_co_u32 v36,vcc,s60,v38
s_nop 1
v_addc_co_u32 v37,vcc,0,v37,vcc
global_load_dword v39,v[36:37],off
s_waitcnt vmcnt(0)
s_waitcnt vmcnt(0)
s_nop 1
ch_nw_39:
v_lshl_add_u32 v24,v15,1,v16
v_lshlrev_b32 v24,4,v24
v_lshl_add_u32 v24,v18,7,v24
v_lshlrev_b32 v25,6,v19
v_xor_b32 v24,v24,v25
v_bfe_u32 v25,v0,2,2
v_lshl_add_u32 v24,v25,8,v24
v_add_u32 v0,147456,v24
s_mov_b32 s21,0
s_mov_b32 s20,0
v_mov_b64 v[32:33],0
v_mov_b64 v[34:35],0
v_mov_b64 v[36:37],0
v_mov_b64 v[38:39],0
v_mov_b64 v[40:41],0
v_mov_b64 v[42:43],0
v_mov_b64 v[44:45],0
v_mov_b64 v[46:47],0
v_mov_b64 v[48:49],0
v_mov_b64 v[50:51],0
v_mov_b64 v[52:53],0
v_mov_b64 v[54:55],0
s_nop 0
s_branch ch_top_41
ch_beg_38:
ch_hop_43:
ds_read_b128 v[56:59],v3
ds_read_b128 v[60:63],v3 offset:1024
ds_read_b128 v[64:67],v3 offset:2048
ds_read_b128 v[68:71],v3 offset:3072
s_add_u32 s28,s28,1
s_and_b32 s60,s28,3
s_lshl_b32 s60,s60,15
s_add_u32 s47,s34,s60
s_xor_b32 s60,s60,0x10000
s_add_u32 s49,s34,s60
s_mov_b32 s38,0
s_cmp_ge_u32 s41,8
s_cbranch_scc1 ch_nr_44
s_add_u32 s68,s67,4096
ch_r_45:
buffer_load_dwordx4 v[24:27],v1,s[4:7],s67 offen sc1
buffer_load_dwordx4 v[28:31],v1,s[4:7],s67 offen offset:1024 sc1
buffer_load_dwordx4 v[32:35],v1,s[4:7],s67 offen offset:2048 sc1
buffer_load_dwordx4 v[36:39],v1,s[4:7],s67 offen offset:3072 sc1
buffer_load_dwordx4 v[40:43],v1,s[4:7],s68 offen sc1
buffer_load_dwordx4 v[44:47],v1,s[4:7],s68 offen offset:1024 sc1
buffer_load_dwordx4 v[48:51],v1,s[4:7],s68 offen offset:2048 sc1
buffer_load_dwordx4 v[52:55],v1,s[4:7],s68 offen offset:3072 sc1
s_waitcnt vmcnt(7)
v_mfma_f32_16x16x32_bf16 v[16:19],v[20:23],v[24:27],0
v_bitop3_b32 v15,v24,v25,s48 bitop3:0x7e
v_bitop3_b32 v14,v26,v27,s48 bitop3:0x7e
v_or_b32 v14,v14,v15
s_waitcnt vmcnt(6)
v_mfma_f32_16x16x32_bf16 v[16:19],v[20:23],v[28:31],v[16:19]
v_bitop3_b32 v15,v28,v29,s48 bitop3:0x7e
v_bitop3_b32 v12,v30,v31,s48 bitop3:0x7e
v_or3_b32 v14,v14,v15,v12
s_waitcnt vmcnt(5)
v_mfma_f32_16x16x32_bf16 v[16:19],v[20:23],v[32:35],v[16:19]
v_bitop3_b32 v15,v32,v33,s48 bitop3:0x7e
v_bitop3_b32 v12,v34,v35,s48 bitop3:0x7e
v_or3_b32 v14,v14,v15,v12
s_waitcnt vmcnt(4)
v_mfma_f32_16x16x32_bf16 v[16:19],v[20:23],v[36:39],v[16:19]
v_bitop3_b32 v15,v36,v37,s48 bitop3:0x7e
v_bitop3_b32 v12,v38,v39,s48 bitop3:0x7e
v_or3_b32 v14,v14,v15,v12
s_waitcnt vmcnt(3)
v_mfma_f32_16x16x32_bf16 v[16:19],v[20:23],v[40:43],v[16:19]
v_bitop3_b32 v15,v40,v41,s48 bitop3:0x7e
v_bitop3_b32 v12,v42,v43,s48 bitop3:0x7e
v_or3_b32 v14,v14,v15,v12
s_waitcnt vmcnt(2)
v_mfma_f32_16x16x32_bf16 v[16:19],v[20:23],v[44:47],v[16:19]
v_bitop3_b32 v15,v44,v45,s48 bitop3:0x7e
v_bitop3_b32 v12,v46,v47,s48 bitop3:0x7e
v_or3_b32 v14,v14,v15,v12
s_waitcnt vmcnt(1)
v_mfma_f32_16x16x32_bf16 v[16:19],v[20:23],v[48:51],v[16:19]
v_bitop3_b32 v15,v48,v49,s48 bitop3:0x7e
v_bitop3_b32 v12,v50,v51,s48 bitop3:0x7e
v_or3_b32 v14,v14,v15,v12
s_waitcnt vmcnt(0)
v_mfma_f32_16x16x32_bf16 v[16:19],v[20:23],v[52:55],v[16:19]
v_bitop3_b32 v15,v52,v53,s48 bitop3:0x7e
v_bitop3_b32 v12,v54,v55,s48 bitop3:0x7e
v_or3_b32 v14,v14,v15,v12
v_and_b32 v14,1,v14
v_cmp_eq_u32 vcc,1,v14
s_nop 2
v_cvt_pk_bf16_f32 v14,v16,v17
v_cvt_pk_bf16_f32 v15,v18,v19
v_min_u32 v14,-2,v14
v_min_u32 v15,-2,v15
s_cbranch_vccnz ch_rf_46
s_mov_b32 exec_hi,0
buffer_store_dwordx2 v[14:15],v11,s[4:7],s47 offen
s_mov_b64 exec,-1
ch_nr_44:
s_waitcnt lgkmcnt(0)
s_barrier
s_add_u32 s60,s42,4096
buffer_load_dwordx4 v[72:75],v1,s[4:7],s60 offen
s_add_u32 s60,s42,4096
buffer_load_dwordx4 v[76:79],v1,s[4:7],s60 offen offset:1024
s_add_u32 s60,s42,6144
buffer_load_dwordx4 v[80:83],v1,s[4:7],s60 offen
s_add_u32 s60,s42,6144
buffer_load_dwordx4 v[84:87],v1,s[4:7],s60 offen offset:1024
s_add_u32 s60,s42,8192
buffer_load_dwordx4 v[88:91],v1,s[4:7],s60 offen
s_add_u32 s60,s42,8192
buffer_load_dwordx4 v[92:95],v1,s[4:7],s60 offen offset:1024
v_mov_b64 v[32:33],0
v_mov_b64 v[34:35],0
v_mov_b64 v[36:37],0
v_mov_b64 v[38:39],0
v_mov_b64 v[40:41],0
v_mov_b64 v[42:43],0
v_mov_b64 v[44:45],0
v_mov_b64 v[46:47],0
v_mov_b64 v[48:49],0
v_mov_b64 v[50:51],0
v_mov_b64 v[52:53],0
v_mov_b64 v[54:55],0
s_add_u32 s69,s28,1
s_and_b32 s69,s69,3
s_lshl_b32 s69,s69,15
s_add_u32 s69,s69,s34
s_waitcnt vmcnt(0)
ch_top_41:
s_waitcnt lgkmcnt(0)
s_barrier
ds_read_b128 v[24:27],v0
ds_read_b128 v[28:31],v0 offset:1024
s_add_u32 s61,s43,4096
v_mov_b64 v[16:17],-1
s_waitcnt lgkmcnt(1)
v_smfmac_f32_16x16x64_bf16 v[32:35],v[24:27],v[96:103],v2
ds_read_b128 v[96:99],v3 offset:4096
v_smfmac_f32_16x16x64_bf16 v[36:39],v[24:27],v[104:111],v2
ds_read_b128 v[100:103],v3 offset:5120
s_add_u32 s60,s42,10240
buffer_load_dwordx4 v[104:107],v1,s[4:7],s60 offen
v_smfmac_f32_16x16x64_bf16 v[48:51],v[24:27],v[56:63],v2
ds_read_b128 v[56:59],v3 offset:6144
v_smfmac_f32_16x16x64_bf16 v[40:43],v[24:27],a[120:127],v2
ds_read_b128 v[60:63],v3 offset:7168
s_add_u32 s60,s42,10240
buffer_load_dwordx4 v[108:111],v1,s[4:7],s60 offen offset:1024
v_smfmac_f32_16x16x64_bf16 v[44:47],v[24:27],a[192:199],v2
v_smfmac_f32_16x16x64_bf16 v[52:55],v[24:27],v[64:71],v2
ds_read_b128 v[24:27],v0 offset:2048
s_waitcnt lgkmcnt(5)
v_smfmac_f32_16x16x64_bf16 v[32:35],v[28:31],v[72:79],v2
ds_read_b128 v[64:67],v3 offset:8192
v_smfmac_f32_16x16x64_bf16 v[36:39],v[28:31],v[80:87],v2
ds_read_b128 v[68:71],v3 offset:9216
s_waitcnt lgkmcnt(5)
v_smfmac_f32_16x16x64_bf16 v[48:51],v[28:31],v[96:103],v2
ds_read_b128 v[96:99],v3 offset:10240
v_smfmac_f32_16x16x64_bf16 v[40:43],v[28:31],v[88:95],v2
ds_read_b128 v[100:103],v3 offset:11264
buffer_load_dwordx4 v[72:75],v6,s[4:7],s43 offen sc1 nt
v_smfmac_f32_16x16x64_bf16 v[44:47],v[28:31],a[200:207],v2
s_waitcnt lgkmcnt(5)
v_smfmac_f32_16x16x64_bf16 v[52:55],v[28:31],v[56:63],v2
ds_read_b128 v[28:31],v0 offset:3072
s_waitcnt lgkmcnt(5)
v_smfmac_f32_16x16x64_bf16 v[32:35],v[24:27],a[0:7],v2
ds_read_b128 v[56:59],v3 offset:12288
v_smfmac_f32_16x16x64_bf16 v[36:39],v[24:27],a[56:63],v2
ds_read_b128 v[60:63],v3 offset:13312
buffer_load_dwordx4 v[76:79],v6,s[4:7],s43 offen offset:2048 sc1 nt
s_waitcnt lgkmcnt(5)
v_smfmac_f32_16x16x64_bf16 v[48:51],v[24:27],v[64:71],v2
ds_read_b128 v[64:67],v3 offset:14336
v_smfmac_f32_16x16x64_bf16 v[40:43],v[24:27],a[128:135],v2
ds_read_b128 v[68:71],v3 offset:15360
v_smfmac_f32_16x16x64_bf16 v[44:47],v[24:27],a[208:215],v2
s_waitcnt lgkmcnt(5)
v_smfmac_f32_16x16x64_bf16 v[52:55],v[24:27],v[96:103],v2
ds_read_b128 v[24:27],v0 offset:4096
buffer_load_dwordx4 v[80:83],v6,s[4:7],s61 offen sc1 nt
s_waitcnt lgkmcnt(5)
v_smfmac_f32_16x16x64_bf16 v[32:35],v[28:31],a[8:15],v2
ds_read_b128 v[96:99],v3 offset:16384
v_smfmac_f32_16x16x64_bf16 v[36:39],v[28:31],a[64:71],v2
ds_read_b128 v[100:103],v3 offset:17408
s_waitcnt lgkmcnt(5)
v_smfmac_f32_16x16x64_bf16 v[48:51],v[28:31],v[56:63],v2
ds_read_b128 v[56:59],v3 offset:18432
v_smfmac_f32_16x16x64_bf16 v[40:43],v[28:31],a[136:143],v2
ds_read_b128 v[60:63],v3 offset:19456
buffer_load_dwordx4 v[84:87],v6,s[4:7],s61 offen offset:2048 sc1 nt
v_smfmac_f32_16x16x64_bf16 v[44:47],v[28:31],a[216:223],v2
s_waitcnt lgkmcnt(5)
v_smfmac_f32_16x16x64_bf16 v[52:55],v[28:31],v[64:71],v2
ds_read_b128 v[28:31],v0 offset:5120
s_waitcnt lgkmcnt(5)
v_smfmac_f32_16x16x64_bf16 v[32:35],v[24:27],a[16:23],v2
ds_read_b128 v[64:67],v3 offset:20480
v_smfmac_f32_16x16x64_bf16 v[36:39],v[24:27],a[72:79],v2
ds_read_b128 v[68:71],v3 offset:21504
buffer_load_dwordx4 v[88:91],v8,s[4:7],s43 offen sc1 nt
s_waitcnt lgkmcnt(5)
v_smfmac_f32_16x16x64_bf16 v[48:51],v[24:27],v[96:103],v2
ds_read_b128 v[96:99],v3 offset:22528
v_smfmac_f32_16x16x64_bf16 v[40:43],v[24:27],a[144:151],v2
ds_read_b128 v[100:103],v3 offset:23552
v_smfmac_f32_16x16x64_bf16 v[44:47],v[24:27],a[224:231],v2
s_waitcnt lgkmcnt(5)
v_smfmac_f32_16x16x64_bf16 v[52:55],v[24:27],v[56:63],v2
ds_read_b128 v[24:27],v0 offset:6144
buffer_load_dwordx4 v[92:95],v8,s[4:7],s43 offen offset:256 sc1 nt
s_waitcnt lgkmcnt(5)
v_smfmac_f32_16x16x64_bf16 v[32:35],v[28:31],a[24:31],v2
ds_read_b128 v[56:59],v3 offset:24576
v_smfmac_f32_16x16x64_bf16 v[36:39],v[28:31],a[80:87],v2
ds_read_b128 v[60:63],v3 offset:25600
s_waitcnt lgkmcnt(5)
v_smfmac_f32_16x16x64_bf16 v[48:51],v[28:31],v[64:71],v2
ds_read_b128 v[64:67],v3 offset:26624
v_smfmac_f32_16x16x64_bf16 v[40:43],v[28:31],a[152:159],v2
ds_read_b128 v[68:71],v3 offset:27648
s_mov_b32 exec_hi,0
buffer_store_dwordx2 v[16:17],v11,s[24:27],s49 offen
buffer_load_dword v12,v11,s[24:27],s69 offen sc1
s_mov_b64 exec,-1
v_smfmac_f32_16x16x64_bf16 v[44:47],v[28:31],a[232:239],v2
s_waitcnt lgkmcnt(5)
v_smfmac_f32_16x16x64_bf16 v[52:55],v[28:31],v[96:103],v2
ds_read_b128 v[28:31],v0 offset:7168
s_waitcnt lgkmcnt(5)
v_smfmac_f32_16x16x64_bf16 v[32:35],v[24:27],a[32:39],v2
ds_read_b128 v[96:99],v3 offset:28672
v_smfmac_f32_16x16x64_bf16 v[36:39],v[24:27],a[88:95],v2
ds_read_b128 v[100:103],v3 offset:29696
s_waitcnt lgkmcnt(5)
v_smfmac_f32_16x16x64_bf16 v[48:51],v[24:27],v[56:63],v2
ds_read_b128 v[56:59],v3 offset:30720
v_smfmac_f32_16x16x64_bf16 v[40:43],v[24:27],a[160:167],v2
ds_read_b128 v[60:63],v3 offset:31744
v_smfmac_f32_16x16x64_bf16 v[44:47],v[24:27],a[240:247],v2
s_waitcnt lgkmcnt(5)
v_smfmac_f32_16x16x64_bf16 v[52:55],v[24:27],v[64:71],v2
ds_read_b128 v[24:27],v0 offset:8192
s_waitcnt lgkmcnt(5)
v_smfmac_f32_16x16x64_bf16 v[32:35],v[28:31],a[40:47],v2
ds_read_b128 v[64:67],v3 offset:32768
v_smfmac_f32_16x16x64_bf16 v[36:39],v[28:31],a[96:103],v2
ds_read_b128 v[68:71],v3 offset:33792
s_waitcnt lgkmcnt(5)
v_smfmac_f32_16x16x64_bf16 v[48:51],v[28:31],v[96:103],v2
ds_read_b128 v[96:99],v3 offset:34816
v_smfmac_f32_16x16x64_bf16 v[40:43],v[28:31],a[168:175],v2
ds_read_b128 v[100:103],v3 offset:35840
v_smfmac_f32_16x16x64_bf16 v[44:47],v[28:31],a[248:255],v2
s_waitcnt lgkmcnt(5)
v_smfmac_f32_16x16x64_bf16 v[52:55],v[28:31],v[56:63],v2
ds_read_b128 v[28:31],v0 offset:9216
s_add_u32 s60,s42,12288
buffer_load_dwordx4 v[56:59],v1,s[4:7],s60 offen
s_waitcnt lgkmcnt(5)
s_waitcnt vmcnt(9)
v_smfmac_f32_16x16x64_bf16 v[32:35],v[24:27],v[104:111],v2
v_smfmac_f32_16x16x64_bf16 v[36:39],v[24:27],a[104:111],v2
v_smfmac_f32_16x16x64_bf16 v[40:43],v[24:27],a[176:183],v2
v_smfmac_f32_16x16x64_bf16 v[44:47],v[24:27],v[112:119],v2
s_add_u32 s60,s42,12288
buffer_load_dwordx4 v[60:63],v1,s[4:7],s60 offen offset:1024
s_waitcnt lgkmcnt(0)
v_smfmac_f32_16x16x64_bf16 v[32:35],v[28:31],a[48:55],v2
v_smfmac_f32_16x16x64_bf16 v[36:39],v[28:31],a[112:119],v2
v_smfmac_f32_16x16x64_bf16 v[40:43],v[28:31],a[184:191],v2
v_smfmac_f32_16x16x64_bf16 v[44:47],v[28:31],v[120:127],v2
s_add_u32 s60,s42,14336
buffer_load_dwordx4 v[104:107],v1,s[4:7],s60 offen
v_smfmac_f32_16x16x64_bf16 v[48:51],v[24:27],v[64:71],v2
s_nop 1
v_add_f32 v32,v32,v34
v_add_f32 v33,v33,v35
v_add_f32 v36,v36,v38
v_smfmac_f32_16x16x64_bf16 v[52:55],v[24:27],v[96:103],v2
v_add_f32 v37,v37,v39
v_mul_f32 v32,s35,v32
v_mul_f32 v33,s35,v33
v_smfmac_f32_16x16x64_bf16 v[48:51],v[28:31],v[128:135],v2
v_mul_f32 v36,s35,v36
v_mul_f32 v37,s35,v37
v_cvt_pk_bf16_f32 v14,v32,v36
v_smfmac_f32_16x16x64_bf16 v[52:55],v[28:31],v[136:143],v2
v_cvt_pk_bf16_f32 v15,v33,v37
ds_write_b32 v4,v14
ds_write_b32 v4,v15 offset:16
s_add_u32 s60,s42,14336
buffer_load_dwordx4 v[108:111],v1,s[4:7],s60 offen offset:1024
s_add_u32 s43,s43,786432
v_add_f32 v40,v40,v42
v_add_f32 v41,v41,v43
v_add_f32 v44,v44,v46
v_add_f32 v45,v45,v47
v_cvt_pk_bf16_f32 v16,v40,v44
v_cvt_pk_bf16_f32 v17,v41,v45
ds_write_b32 v4,v16 offset:2048
ds_write_b32 v4,v17 offset:2064
v_pk_add_f32 v[48:49],v[48:49],v[50:51]
v_pk_add_f32 v[52:53],v[52:53],v[54:55]
v_cvt_pk_bf16_f32 v48,v48,v49
v_mov_b32 v49,0
v_cvt_pk_bf16_f32 v52,v52,v53
v_mov_b32 v53,0
ds_write_b32 v13,v48
ds_write_b32 v13,v52 offset:128
s_add_u32 s60,s42,16384
buffer_load_dwordx4 v[64:67],v1,s[4:7],s60 offen
s_add_u32 s60,s42,16384
buffer_load_dwordx4 v[68:71],v1,s[4:7],s60 offen offset:1024
s_waitcnt lgkmcnt(0)
s_barrier
s_cmp_ge_u32 s28,63
s_cbranch_scc1 ch_fin_42
ds_read_b128 v[32:35],v5 offset:10240
ds_read_b128 v[36:39],v5 offset:10752
ds_read_b128 v[40:43],v5 offset:11264
ds_read_b128 v[44:47],v5 offset:11776
s_add_u32 s60,s42,18432
buffer_load_dwordx4 v[96:99],v1,s[4:7],s60 offen
s_add_u32 s60,s42,18432
buffer_load_dwordx4 v[100:103],v1,s[4:7],s60 offen offset:1024
s_waitcnt vmcnt(12)
s_waitcnt lgkmcnt(3)
v_mfma_f32_16x16x32_bf16 v[24:27],v[72:75],v[32:35],0
s_waitcnt lgkmcnt(2)
v_mfma_f32_16x16x32_bf16 v[24:27],v[76:79],v[36:39],v[24:27]
s_waitcnt lgkmcnt(1)
v_mfma_f32_16x16x32_bf16 v[24:27],v[80:83],v[40:43],v[24:27]
s_waitcnt lgkmcnt(0)
v_mfma_f32_16x16x32_bf16 v[24:27],v[84:87],v[44:47],v[24:27]
s_nop 7
ds_write_b128 v5,v[24:27] offset:512
s_add_u32 s60,s42,20480
buffer_load_dwordx4 v[72:75],v1,s[4:7],s60 offen
s_add_u32 s60,s42,20480
buffer_load_dwordx4 v[76:79],v1,s[4:7],s60 offen offset:1024
s_waitcnt lgkmcnt(0)
s_barrier
ds_read_b128 v[32:35],v5
ds_read_b128 v[36:39],v5 offset:512
ds_read_b64 v[40:41],v5 offset:1024
s_add_u32 s60,s42,22528
buffer_load_dwordx4 v[80:83],v1,s[4:7],s60 offen
s_add_u32 s60,s42,22528
buffer_load_dwordx4 v[84:87],v1,s[4:7],s60 offen offset:1024
s_waitcnt lgkmcnt(0)
v_max3_f32 v14,v32,v33,v34
v_max3_f32 v15,v35,v36,v37
v_max3_f32 v16,v38,v39,v40
v_max3_f32 v15,v14,v15,v41
v_mov_b32 v29,0
v_max_f32 v14,v15,v16
v_max_f32 v15,v15,v16
s_nop 1
v_permlane32_swap_b32 v14,v15
s_nop 0
v_max_f32 v16,v14,v15
v_max_f32 v14,v14,v15
s_nop 1
v_permlane16_swap_b32 v14,v16
s_nop 0
v_max_f32 v14,v14,v16
v_pk_add_f32 v[40:41],v[40:41],v[14:15] op_sel_hi:[1,0] neg_lo:[0,1] neg_hi:[0,1]
v_pk_add_f32 v[32:33],v[32:33],v[14:15] op_sel_hi:[1,0] neg_lo:[0,1] neg_hi:[0,1]
v_pk_add_f32 v[34:35],v[34:35],v[14:15] op_sel_hi:[1,0] neg_lo:[0,1] neg_hi:[0,1]
v_pk_add_f32 v[36:37],v[36:37],v[14:15] op_sel_hi:[1,0] neg_lo:[0,1] neg_hi:[0,1]
v_pk_add_f32 v[38:39],v[38:39],v[14:15] op_sel_hi:[1,0] neg_lo:[0,1] neg_hi:[0,1]
v_exp_f32 v40,v40
v_exp_f32 v41,v41
v_exp_f32 v32,v32
v_cvt_pk_bf16_f32 v28,v40,v41
v_add_f32 v14,v40,v41
v_exp_f32 v33,v33
v_mfma_f32_16x16x16_bf16 v[40:43],v[48:49],v[28:29],0
v_exp_f32 v34,v34
v_mfma_f32_16x16x16_bf16 v[44:47],v[52:53],v[28:29],0
v_exp_f32 v35,v35
v_exp_f32 v36,v36
v_exp_f32 v37,v37
v_exp_f32 v38,v38
v_exp_f32 v39,v39
v_cvt_pk_bf16_f32 v24,v32,v33
v_cvt_pk_bf16_f32 v25,v34,v35
v_cvt_pk_bf16_f32 v26,v36,v37
v_cvt_pk_bf16_f32 v27,v38,v39
s_waitcnt vmcnt(14)
v_pk_add_f32 v[32:33],v[32:33],v[34:35]
v_pk_add_f32 v[36:37],v[36:37],v[38:39]
v_mfma_f32_16x16x32_bf16 v[40:43],v[88:91],v[24:27],v[40:43]
v_add_f32 v32,v32,v36
v_add_f32 v33,v33,v37
v_mfma_f32_16x16x32_bf16 v[44:47],v[92:95],v[24:27],v[44:47]
v_add_f32 v32,v32,v14
v_add_f32 v14,v32,v33
v_add_f32 v15,v32,v33
v_mov_b32 v88,0
v_mov_b32 v89,0
v_permlane32_swap_b32 v14,v15
v_mov_b32 v90,0
v_add_f32 v16,v14,v15
v_add_f32 v14,v14,v15
v_mov_b32 v91,0
v_mov_b32 v92,0
v_permlane16_swap_b32 v14,v16
v_mov_b32 v93,0
v_add_f32 v14,v14,v16
v_rcp_f32 v14,v14
v_mov_b32 v94,0
v_mov_b32 v95,0
v_pk_mul_f32 v[40:41],v[40:41],v[14:15] op_sel_hi:[1,0]
v_pk_mul_f32 v[42:43],v[42:43],v[14:15] op_sel_hi:[1,0]
v_pk_mul_f32 v[44:45],v[44:45],v[14:15] op_sel_hi:[1,0]
v_pk_mul_f32 v[46:47],v[46:47],v[14:15] op_sel_hi:[1,0]
v_cvt_pk_bf16_f32 v16,v40,v41
v_cvt_pk_bf16_f32 v17,v42,v43
v_cvt_pk_bf16_f32 v18,v44,v45
v_cvt_pk_bf16_f32 v19,v46,v47
ds_write_b128 v7,v[16:19]
s_and_b32 s48,s28,1
s_mov_b64 vcc,s[22:23]
v_mov_b64 v[32:33],0
v_mov_b64 v[34:35],0
v_mov_b64 v[36:37],0
v_mov_b64 v[38:39],0
v_mov_b64 v[40:41],0
v_mov_b64 v[42:43],0
v_mov_b64 v[44:45],0
v_mov_b64 v[46:47],0
v_mov_b64 v[48:49],0
v_mov_b64 v[50:51],0
s_waitcnt lgkmcnt(0)
s_barrier
ds_read_b128 v[24:27],v1 offset:10240
ds_read_b128 v[28:31],v1 offset:11264
v_mov_b64 v[52:53],0
v_mov_b64 v[54:55],0
v_mov_b64 v[16:17],0
v_mov_b64 v[18:19],0
s_waitcnt lgkmcnt(0)
s_waitcnt vmcnt(10)
v_smfmac_f32_16x16x64_bf16 v[32:35],v[24:27],v[56:63],v2
s_waitcnt vmcnt(8)
v_smfmac_f32_16x16x64_bf16 v[32:35],v[28:31],v[104:111],v2
s_waitcnt vmcnt(6)
v_smfmac_f32_16x16x64_bf16 v[36:39],v[24:27],v[64:71],v2
s_waitcnt vmcnt(4)
v_smfmac_f32_16x16x64_bf16 v[36:39],v[28:31],v[96:103],v2
v_smfmac_f32_16x16x64_bf16 v[40:43],v[24:27],v[144:151],v2
s_add_u32 s60,s42,2048
buffer_load_dwordx4 v[104:107],v1,s[4:7],s60 offen
s_nop 0
v_add_f32 v32,v32,v34
v_add_f32 v33,v33,v35
v_smfmac_f32_16x16x64_bf16 v[40:43],v[28:31],v[152:159],v2
v_smfmac_f32_16x16x64_bf16 v[44:47],v[24:27],v[160:167],v2
v_add_f32 v36,v36,v38
v_add_f32 v37,v37,v39
v_cvt_pk_bf16_f32 v38,v32,v36
v_smfmac_f32_16x16x64_bf16 v[44:47],v[28:31],v[168:175],v2
s_add_u32 s60,s42,2048
buffer_load_dwordx4 v[108:111],v1,s[4:7],s60 offen offset:1024
v_cvt_pk_bf16_f32 v39,v33,v37
v_bfi_b32 v38,1,s48,v38
v_bfi_b32 v39,1,s48,v39
v_smfmac_f32_16x16x64_bf16 v[48:51],v[24:27],v[176:183],v2
s_nop 0
v_cndmask_b32_dpp v36,v39,v38,vcc quad_perm:[1,0,3,2] row_mask:0xf bank_mask:0xf
s_not_b64 vcc,vcc
v_cndmask_b32_dpp v37,v38,v39,vcc quad_perm:[1,0,3,2] row_mask:0xf bank_mask:0xf
v_smfmac_f32_16x16x64_bf16 v[48:51],v[28:31],v[184:191],v2
buffer_store_dwordx2 v[36:37],v10,s[4:7],s65 offen
v_add_f32 v40,v40,v42
v_add_f32 v41,v41,v43
v_smfmac_f32_16x16x64_bf16 v[52:55],v[24:27],v[192:199],v2
v_add_f32 v44,v44,v46
v_add_f32 v45,v45,v47
v_cvt_pk_bf16_f32 v32,v40,v44
v_smfmac_f32_16x16x64_bf16 v[52:55],v[28:31],v[200:207],v2
s_add_u32 s60,s42,0
buffer_load_dwordx4 v[96:99],v1,s[4:7],s60 offen
v_cvt_pk_bf16_f32 v34,v41,v45
v_bfi_b32 v32,1,s48,v32
v_bfi_b32 v34,1,s48,v34
v_smfmac_f32_16x16x64_bf16 v[88:91],v[24:27],v[208:215],v2
v_mov_b64 v[40:41],0
v_mov_b64 v[42:43],0
v_add_f32 v48,v48,v50
v_smfmac_f32_16x16x64_bf16 v[88:91],v[28:31],v[216:223],v2
v_add_f32 v49,v49,v51
v_smfmac_f32_16x16x64_bf16 v[92:95],v[24:27],v[224:231],v2
s_add_u32 s60,s42,0
buffer_load_dwordx4 v[100:103],v1,s[4:7],s60 offen offset:1024
v_add_f32 v52,v52,v54
v_add_f32 v53,v53,v55
v_cvt_pk_bf16_f32 v33,v48,v52
v_smfmac_f32_16x16x64_bf16 v[92:95],v[28:31],v[232:239],v2
v_cvt_pk_bf16_f32 v35,v49,v53
v_bfi_b32 v33,1,s48,v33
v_bfi_b32 v35,1,s48,v35
v_smfmac_f32_16x16x64_bf16 v[16:19],v[24:27],v[240:247],v2
buffer_store_dwordx4 v[32:35],v9,s[4:7],s64 offen
v_add_f32 v88,v88,v90
v_add_f32 v89,v89,v91
v_smfmac_f32_16x16x64_bf16 v[16:19],v[28:31],v[248:255],v2
s_waitcnt vmcnt(8)
v_smfmac_f32_16x16x64_bf16 v[40:43],v[24:27],v[72:79],v2
v_add_f32 v92,v92,v94
v_add_f32 v93,v93,v95
v_cvt_pk_bf16_f32 v44,v88,v92
s_waitcnt vmcnt(6)
v_smfmac_f32_16x16x64_bf16 v[40:43],v[28:31],v[80:87],v2
v_cvt_pk_bf16_f32 v46,v89,v93
v_bfi_b32 v44,1,s48,v44
v_bfi_b32 v46,1,s48,v46
v_add_f32 v16,v16,v18
v_add_f32 v17,v17,v19
s_nop 2
v_add_f32 v40,v40,v42
v_add_f32 v41,v41,v43
v_cvt_pk_bf16_f32 v45,v16,v40
v_cvt_pk_bf16_f32 v47,v17,v41
v_bfi_b32 v45,1,s48,v45
v_bfi_b32 v47,1,s48,v47
buffer_store_dwordx4 v[44:47],v9,s[4:7],s63 offen
s_nop 0
s_branch ch_hop_43
ch_rf_46:
s_add_u32 s38,s38,1
s_cmp_lt_u32 s38,100000
s_cbranch_scc1 ch_r_45
s_mov_b32 s40,9
s_branch L_fail
ch_end_37:
ch_fin_42:
s_branch L_end
CH_2_0:
v_and_b32 v14,15,v0
v_lshrrev_b32 v15,4,v0
v_bfe_u32 v16,v0,1,1
v_mul_u32_u24 v2,0xaaaa,v16
v_add_u32 v2,0x4444,v2
v_add_u32 v3,73728,v1
v_add_u32 v1,147456,v1
v_lshrrev_b32 v17,3,v14
v_lshlrev_b32 v4,8,v17
v_lshl_add_u32 v4,v16,7,v4
v_lshl_add_u32 v4,v15,5,v4
v_and_b32 v18,1,v0
v_lshl_add_u32 v4,v18,2,v4
v_bfe_u32 v19,v0,2,1
v_lshl_add_u32 v4,v19,3,v4
v_add_u32 v4,158720,v4
v_and_b32 v5,7,v0
v_lshlrev_b32 v5,4,v5
v_lshl_add_u32 v5,v15,7,v5
v_add_u32 v5,147456,v5
v_lshrrev_b32 v6,2,v14
v_lshl_add_u32 v6,v6,1,v18
v_lshlrev_b32 v6,4,v6
v_lshl_add_u32 v6,v15,7,v6
v_add_u32 v6,159744,v6
v_bfe_u32 v7,v0,1,2
v_lshl_add_u32 v7,v7,2,v18
v_bfe_u32 v8,v0,4,1
v_lshl_add_u32 v7,v8,1,v7
v_lshrrev_b32 v13,5,v0
v_lshl_add_u32 v7,v13,4,v7
v_lshlrev_b32 v7,4,v7
v_add_u32 v7,158720,v7
v_lshlrev_b32 v13,8,v13
v_lshl_add_u32 v13,v14,3,v13
v_lshl_add_u32 v13,v8,2,v13
v_add_u32 v13,162816,v13
v_lshlrev_b32 v8,4,v14
v_lshl_add_u32 v8,v15,9,v8
v_add_u32 v8,135168,v8
v_lshlrev_b32 v9,14,v15
v_lshl_add_u32 v9,v14,4,v9
v_add_u32 v9,262144,v9
v_lshrrev_b32 v10,5,v0
v_lshlrev_b32 v10,14,v10
v_and_b32 v32,31,v0
v_lshl_add_u32 v10,v32,3,v10
v_add_u32 v10,65536,v10
s_mul_i32 s60,s39,0x48000
s_add_u32 s60,s60,0x18010
s_lshl_b32 s101,s39,13
s_xor_b32 s101,s101,s99
s_xor_b32 s101,s101,8192
s_add_u32 s60,s60,s101
s_lshl_b32 s61,s41,8
s_add_u32 s60,s60,s61
v_lshlrev_b32 v12,7,v18
v_lshl_add_u32 v12,v16,4,v12
v_add_u32 v12,s60,v12
s_mul_i32 s37,s39,0x48000
s_add_u32 s37,s37,0x20000
s_lshl_b32 s101,s39,13
s_xor_b32 s101,s101,s99
s_xor_b32 s101,s101,8192
s_add_u32 s37,s37,s101
s_lshl_b32 s61,s41,7
s_add_u32 s37,s37,s61
s_mul_i32 s43,s39,0x3000000
s_add_u32 s43,s43,0x7ad0000
s_lshr_b32 s61,s41,4
s_lshl_b32 s61,s61,18
s_add_u32 s43,s43,s61
s_lshl_b32 s61,s41,13
s_add_u32 s43,s43,s61
s_mul_i32 s44,s39,0x0
s_add_u32 s44,s44,0x3dc000
s_lshl_b32 s101,s39,13
s_xor_b32 s101,s101,s99
s_xor_b32 s101,s101,8192
s_add_u32 s44,s44,s101
s_lshr_b32 s61,s41,1
s_lshl_b32 s61,s61,14
s_add_u32 s44,s44,s61
s_and_b32 s61,s41,1
s_lshl_b32 s61,s61,12
s_add_u32 s44,s44,s61
s_sub_u32 s42,s42,147456
s_lshl_b32 s98,s39,13
s_xor_b32 s98,s98,s99
s_xor_b32 s98,s98,8192
s_mul_i32 s45,s39,0x0
s_add_u32 s45,s45,0x100000
s_add_u32 s45,s45,s98
s_lshl_b32 s61,s41,14
s_add_u32 s32,s45,s61
s_sub_u32 s32,s32,147456
s_lshl_b32 s61,s41,8
s_add_u32 s45,s45,s61
s_mul_i32 s46,s39,0x0
s_add_u32 s46,s46,0x180000
s_add_u32 s46,s46,s98
s_and_b32 s61,s41,7
s_lshl_b32 s61,s61,14
s_add_u32 s33,s46,s61
s_sub_u32 s33,s33,147456
s_lshl_b32 s61,s41,8
s_add_u32 s46,s46,s61
s_mov_b32 s24,s4
s_mov_b32 s25,s5
s_mov_b32 s27,0x20000
s_cmp_lt_u32 s41,8
s_cselect_b32 s26,s6,0
s_mov_b32 s26,0
s_mov_b32 s22,0x55555555
s_mov_b32 s23,0x55555555
s_mul_i32 s34,s39,0x0
s_add_u32 s34,s34,0x1a0000
s_add_u32 s34,s34,s98
s_add_u32 s36,s37,32768
s_mov_b32 s35,0x3e0293ee
s_mov_b32 s28,0
s_mov_b32 s66,s32
s_mov_b32 s67,s33
s_mov_b32 s64,s45
s_mov_b32 s65,s46
s_add_u32 s63,s64,0x10000
s_mov_b32 s49,s34
s_add_u32 s69,s34,0x8000
ds_read_b128 v[56:59],v3
ds_read_b128 v[60:63],v3 offset:1024
ds_read_b128 v[64:67],v3 offset:2048
ds_read_b128 v[68:71],v3 offset:3072
s_cmp_eq_u32 s39,0
s_cbranch_scc1 ch_nw_49
s_add_u32 s60,s42,0
buffer_load_dwordx4 v[32:35],v1,s[4:7],s60 offen
s_add_u32 s60,s42,1024
buffer_load_dwordx4 v[32:35],v1,s[4:7],s60 offen
s_add_u32 s60,s42,2048
buffer_load_dwordx4 v[32:35],v1,s[4:7],s60 offen
s_add_u32 s60,s42,3072
buffer_load_dwordx4 v[32:35],v1,s[4:7],s60 offen
s_add_u32 s60,s42,4096
buffer_load_dwordx4 v[32:35],v1,s[4:7],s60 offen
s_add_u32 s60,s42,5120
buffer_load_dwordx4 v[32:35],v1,s[4:7],s60 offen
s_add_u32 s60,s42,6144
buffer_load_dwordx4 v[32:35],v1,s[4:7],s60 offen
s_add_u32 s60,s42,7168
buffer_load_dwordx4 v[32:35],v1,s[4:7],s60 offen
s_add_u32 s60,s42,8192
buffer_load_dwordx4 v[32:35],v1,s[4:7],s60 offen
s_add_u32 s60,s42,9216
buffer_load_dwordx4 v[32:35],v1,s[4:7],s60 offen
s_add_u32 s60,s42,10240
buffer_load_dwordx4 v[32:35],v1,s[4:7],s60 offen
s_add_u32 s60,s42,11264
buffer_load_dwordx4 v[32:35],v1,s[4:7],s60 offen
s_add_u32 s60,s42,12288
buffer_load_dwordx4 v[32:35],v1,s[4:7],s60 offen
s_add_u32 s60,s42,13312
buffer_load_dwordx4 v[32:35],v1,s[4:7],s60 offen
s_add_u32 s60,s42,14336
buffer_load_dwordx4 v[32:35],v1,s[4:7],s60 offen
s_add_u32 s60,s42,15360
buffer_load_dwordx4 v[32:35],v1,s[4:7],s60 offen
s_add_u32 s60,s42,16384
buffer_load_dwordx4 v[32:35],v1,s[4:7],s60 offen
s_add_u32 s60,s42,17408
buffer_load_dwordx4 v[32:35],v1,s[4:7],s60 offen
s_add_u32 s60,s42,18432
buffer_load_dwordx4 v[32:35],v1,s[4:7],s60 offen
s_add_u32 s60,s42,19456
buffer_load_dwordx4 v[32:35],v1,s[4:7],s60 offen
s_add_u32 s60,s42,20480
buffer_load_dwordx4 v[32:35],v1,s[4:7],s60 offen
s_add_u32 s60,s42,21504
buffer_load_dwordx4 v[32:35],v1,s[4:7],s60 offen
s_add_u32 s60,s42,22528
buffer_load_dwordx4 v[32:35],v1,s[4:7],s60 offen
s_add_u32 s60,s42,23552
buffer_load_dwordx4 v[32:35],v1,s[4:7],s60 offen
s_waitcnt vmcnt(0) lgkmcnt(0)
s_getpc_b64 s[60:61]
pc_50:
s_add_u32 s60,s60,ch_beg_48-pc_50
s_addc_u32 s61,s61,0
s_mov_b32 s59,ch_end_47-ch_beg_48-4
v_lshlrev_b32 v38,7,v0
v_add_u32 v38,0,v38
v_min_u32 v38,s59,v38
v_mov_b32 v37,s61
v_add_co_u32 v36,vcc,s60,v38
s_nop 1
v_addc_co_u32 v37,vcc,0,v37,vcc
global_load_dword v39,v[36:37],off
s_waitcnt vmcnt(0)
s_waitcnt vmcnt(0)
s_nop 1
ch_nw_49:
v_lshl_add_u32 v24,v15,1,v16
v_lshlrev_b32 v24,4,v24
v_lshl_add_u32 v24,v18,7,v24
v_lshlrev_b32 v25,6,v19
v_xor_b32 v24,v24,v25
v_bfe_u32 v25,v0,2,2
v_lshl_add_u32 v24,v25,8,v24
v_add_u32 v0,147456,v24
s_mov_b32 s21,0
s_mov_b32 s20,0
s_add_u32 s31,s28,1
s_cmp_eq_u32 s21,0
s_cbranch_scc1 ch_kf_52
ch_ok_51:
s_add_u32 s20,s28,1
s_mul_i32 s59,s20,43
s_lshr_b32 s59,s59,7
s_mul_i32 s59,s59,3
s_sub_u32 s59,s20,s59
s_min_u32 s101,s20,42
s_sub_u32 s101,s101,33
s_and_b32 s101,s101,1
s_cmp_lt_u32 s20,33
s_cselect_b32 s20,s59,s101
s_cmp_eq_u32 s39,0
s_cselect_b32 s20,s20,0
s_lshl_b32 s20,s20,2
v_mov_b64 v[32:33],0
v_mov_b64 v[34:35],0
v_mov_b64 v[36:37],0
v_mov_b64 v[38:39],0
v_mov_b64 v[40:41],0
v_mov_b64 v[42:43],0
v_mov_b64 v[44:45],0
v_mov_b64 v[46:47],0
v_mov_b64 v[48:49],0
v_mov_b64 v[50:51],0
v_mov_b64 v[52:53],0
v_mov_b64 v[54:55],0
s_nop 0
s_branch ch_top_53
ch_beg_48:
ch_hop_55:
ds_read_b128 v[56:59],v3
ds_read_b128 v[60:63],v3 offset:1024
ds_read_b128 v[64:67],v3 offset:2048
ds_read_b128 v[68:71],v3 offset:3072
s_add_u32 s60,s42,4096
buffer_load_dwordx4 v[72:75],v1,s[4:7],s60 offen
s_add_u32 s60,s42,4096
buffer_load_dwordx4 v[76:79],v1,s[4:7],s60 offen offset:1024
s_add_u32 s60,s42,6144
buffer_load_dwordx4 v[80:83],v1,s[4:7],s60 offen
s_add_u32 s60,s42,6144
buffer_load_dwordx4 v[84:87],v1,s[4:7],s60 offen offset:1024
s_add_u32 s60,s42,8192
buffer_load_dwordx4 v[88:91],v1,s[4:7],s60 offen
s_add_u32 s60,s42,8192
buffer_load_dwordx4 v[92:95],v1,s[4:7],s60 offen offset:1024
s_waitcnt vmcnt(13)
s_add_u32 s31,s28,2
v_min_u32 v20,v20,v21
v_add_u32 v20,6,v20
v_min_u32 v11,v11,v20
v_cmp_le_u32 vcc,s31,v11
s_nop 0
s_cmp_eq_u64 vcc,-1
s_cselect_b32 s21,1,0
s_add_u32 s28,s28,1
s_and_b32 s60,s28,3
s_lshl_b32 s60,s60,15
s_add_u32 s47,s34,s60
s_xor_b32 s60,s60,0x10000
s_add_u32 s49,s34,s60
s_mov_b32 s38,0
s_add_u32 s68,s47,-147456
s_add_u32 s69,s47,-143360
s_add_u32 s20,s28,1
s_mul_i32 s59,s20,43
s_lshr_b32 s59,s59,7
s_mul_i32 s59,s59,3
s_sub_u32 s59,s20,s59
s_min_u32 s101,s20,42
s_sub_u32 s101,s101,33
s_and_b32 s101,s101,1
s_cmp_lt_u32 s20,33
s_cselect_b32 s20,s59,s101
s_cmp_eq_u32 s39,0
s_cselect_b32 s20,s20,0
s_lshl_b32 s20,s20,2
v_mov_b64 v[36:37],0
v_mov_b64 v[38:39],0
v_mov_b64 v[40:41],0
v_mov_b64 v[42:43],0
v_mov_b64 v[44:45],0
v_mov_b64 v[46:47],0
v_mov_b64 v[48:49],0
v_mov_b64 v[50:51],0
v_mov_b64 v[52:53],0
v_mov_b64 v[54:55],0
s_waitcnt lgkmcnt(0)
s_barrier
s_sleep 7
ch_m_56:
buffer_load_dwordx4 v[32:35],v1,s[4:7],s68 offen sc1
buffer_load_dwordx4 v[28:31],v1,s[4:7],s68 offen offset:1024 sc1
buffer_load_dwordx4 v[24:27],v1,s[4:7],s68 offen offset:2048 sc1
buffer_load_dwordx4 v[20:23],v1,s[4:7],s68 offen offset:3072 sc1
buffer_load_dwordx4 v[16:19],v1,s[4:7],s69 offen sc1
s_waitcnt vmcnt(4)
ds_write_b128 v1,v[32:35]
v_max3_u32 v14,v32,v33,v34
v_max_u32 v14,v14,v35
s_waitcnt vmcnt(3)
ds_write_b128 v1,v[28:31] offset:1024
v_max3_u32 v14,v14,v28,v29
v_max3_u32 v14,v14,v30,v31
s_waitcnt vmcnt(2)
ds_write_b128 v1,v[24:27] offset:2048
v_max3_u32 v14,v14,v24,v25
v_max3_u32 v14,v14,v26,v27
s_waitcnt vmcnt(1)
ds_write_b128 v1,v[20:23] offset:3072
v_max3_u32 v14,v14,v20,v21
v_max3_u32 v14,v14,v22,v23
s_waitcnt vmcnt(0)
ds_write_b128 v1,v[16:19] offset:4096
v_max3_u32 v14,v14,v16,v17
v_max3_u32 v14,v14,v18,v19
v_cmp_eq_u32 vcc,-1,v14
s_cbranch_vccnz ch_mf_57
s_add_u32 s31,s28,1
s_cmp_eq_u32 s21,0
s_cbranch_scc1 ch_kf_59
ch_ok_58:
ch_top_53:
v_mov_b64 v[32:33],0
v_mov_b64 v[34:35],0
s_waitcnt lgkmcnt(0)
s_barrier
ds_read_b128 v[24:27],v0
ds_read_b128 v[28:31],v0 offset:1024
s_add_u32 s61,s43,4096
s_waitcnt lgkmcnt(1)
v_smfmac_f32_16x16x64_bf16 v[32:35],v[24:27],v[96:103],v2
ds_read_b128 v[96:99],v3 offset:4096
v_smfmac_f32_16x16x64_bf16 v[36:39],v[24:27],v[104:111],v2
ds_read_b128 v[100:103],v3 offset:5120
s_add_u32 s60,s42,10240
buffer_load_dwordx4 v[104:107],v1,s[4:7],s60 offen
v_smfmac_f32_16x16x64_bf16 v[48:51],v[24:27],v[56:63],v2
ds_read_b128 v[56:59],v3 offset:6144
v_smfmac_f32_16x16x64_bf16 v[40:43],v[24:27],a[120:127],v2
ds_read_b128 v[60:63],v3 offset:7168
s_add_u32 s60,s42,10240
buffer_load_dwordx4 v[108:111],v1,s[4:7],s60 offen offset:1024
v_smfmac_f32_16x16x64_bf16 v[44:47],v[24:27],a[192:199],v2
v_smfmac_f32_16x16x64_bf16 v[52:55],v[24:27],v[64:71],v2
ds_read_b128 v[24:27],v0 offset:2048
s_waitcnt lgkmcnt(5)
v_smfmac_f32_16x16x64_bf16 v[32:35],v[28:31],v[72:79],v2
ds_read_b128 v[64:67],v3 offset:8192
v_smfmac_f32_16x16x64_bf16 v[36:39],v[28:31],v[80:87],v2
ds_read_b128 v[68:71],v3 offset:9216
s_waitcnt lgkmcnt(5)
v_smfmac_f32_16x16x64_bf16 v[48:51],v[28:31],v[96:103],v2
ds_read_b128 v[96:99],v3 offset:10240
v_smfmac_f32_16x16x64_bf16 v[40:43],v[28:31],v[88:95],v2
ds_read_b128 v[100:103],v3 offset:11264
buffer_load_dwordx4 v[88:91],v8,s[4:7],s43 offen sc1 nt
v_smfmac_f32_16x16x64_bf16 v[44:47],v[28:31],a[200:207],v2
s_waitcnt lgkmcnt(5)
v_smfmac_f32_16x16x64_bf16 v[52:55],v[28:31],v[56:63],v2
ds_read_b128 v[28:31],v0 offset:3072
s_waitcnt lgkmcnt(5)
v_smfmac_f32_16x16x64_bf16 v[32:35],v[24:27],a[0:7],v2
ds_read_b128 v[56:59],v3 offset:12288
buffer_load_dwordx4 v[92:95],v8,s[4:7],s43 offen offset:256 sc1 nt
v_smfmac_f32_16x16x64_bf16 v[36:39],v[24:27],a[56:63],v2
ds_read_b128 v[60:63],v3 offset:13312
s_waitcnt lgkmcnt(5)
v_smfmac_f32_16x16x64_bf16 v[48:51],v[24:27],v[64:71],v2
ds_read_b128 v[64:67],v3 offset:14336
v_smfmac_f32_16x16x64_bf16 v[40:43],v[24:27],a[128:135],v2
ds_read_b128 v[68:71],v3 offset:15360
v_smfmac_f32_16x16x64_bf16 v[44:47],v[24:27],a[208:215],v2
s_waitcnt lgkmcnt(5)
v_smfmac_f32_16x16x64_bf16 v[52:55],v[24:27],v[96:103],v2
ds_read_b128 v[24:27],v0 offset:4096
s_waitcnt lgkmcnt(5)
v_smfmac_f32_16x16x64_bf16 v[32:35],v[28:31],a[8:15],v2
ds_read_b128 v[96:99],v3 offset:16384
v_smfmac_f32_16x16x64_bf16 v[36:39],v[28:31],a[64:71],v2
ds_read_b128 v[100:103],v3 offset:17408
s_waitcnt lgkmcnt(5)
v_smfmac_f32_16x16x64_bf16 v[48:51],v[28:31],v[56:63],v2
ds_read_b128 v[56:59],v3 offset:18432
v_smfmac_f32_16x16x64_bf16 v[40:43],v[28:31],a[136:143],v2
ds_read_b128 v[60:63],v3 offset:19456
v_smfmac_f32_16x16x64_bf16 v[44:47],v[28:31],a[216:223],v2
s_waitcnt lgkmcnt(5)
v_smfmac_f32_16x16x64_bf16 v[52:55],v[28:31],v[64:71],v2
ds_read_b128 v[28:31],v0 offset:5120
s_waitcnt lgkmcnt(5)
v_smfmac_f32_16x16x64_bf16 v[32:35],v[24:27],a[16:23],v2
ds_read_b128 v[64:67],v3 offset:20480
v_smfmac_f32_16x16x64_bf16 v[36:39],v[24:27],a[72:79],v2
ds_read_b128 v[68:71],v3 offset:21504
s_waitcnt lgkmcnt(5)
v_smfmac_f32_16x16x64_bf16 v[48:51],v[24:27],v[96:103],v2
ds_read_b128 v[96:99],v3 offset:22528
v_smfmac_f32_16x16x64_bf16 v[40:43],v[24:27],a[144:151],v2
ds_read_b128 v[100:103],v3 offset:23552
v_smfmac_f32_16x16x64_bf16 v[44:47],v[24:27],a[224:231],v2
s_waitcnt lgkmcnt(5)
v_smfmac_f32_16x16x64_bf16 v[52:55],v[24:27],v[56:63],v2
ds_read_b128 v[24:27],v0 offset:6144
s_waitcnt lgkmcnt(5)
v_smfmac_f32_16x16x64_bf16 v[32:35],v[28:31],a[24:31],v2
ds_read_b128 v[56:59],v3 offset:24576
v_smfmac_f32_16x16x64_bf16 v[36:39],v[28:31],a[80:87],v2
ds_read_b128 v[60:63],v3 offset:25600
s_waitcnt lgkmcnt(5)
v_smfmac_f32_16x16x64_bf16 v[48:51],v[28:31],v[64:71],v2
ds_read_b128 v[64:67],v3 offset:26624
v_smfmac_f32_16x16x64_bf16 v[40:43],v[28:31],a[152:159],v2
ds_read_b128 v[68:71],v3 offset:27648
v_smfmac_f32_16x16x64_bf16 v[44:47],v[28:31],a[232:239],v2
s_waitcnt lgkmcnt(5)
v_smfmac_f32_16x16x64_bf16 v[52:55],v[28:31],v[96:103],v2
ds_read_b128 v[28:31],v0 offset:7168
s_waitcnt lgkmcnt(5)
v_smfmac_f32_16x16x64_bf16 v[32:35],v[24:27],a[32:39],v2
ds_read_b128 v[96:99],v3 offset:28672
v_smfmac_f32_16x16x64_bf16 v[36:39],v[24:27],a[88:95],v2
ds_read_b128 v[100:103],v3 offset:29696
s_waitcnt lgkmcnt(5)
v_smfmac_f32_16x16x64_bf16 v[48:51],v[24:27],v[56:63],v2
ds_read_b128 v[56:59],v3 offset:30720
v_smfmac_f32_16x16x64_bf16 v[40:43],v[24:27],a[160:167],v2
ds_read_b128 v[60:63],v3 offset:31744
v_smfmac_f32_16x16x64_bf16 v[44:47],v[24:27],a[240:247],v2
s_waitcnt lgkmcnt(5)
v_smfmac_f32_16x16x64_bf16 v[52:55],v[24:27],v[64:71],v2
ds_read_b128 v[24:27],v0 offset:8192
s_waitcnt lgkmcnt(5)
v_smfmac_f32_16x16x64_bf16 v[32:35],v[28:31],a[40:47],v2
ds_read_b128 v[64:67],v3 offset:32768
v_smfmac_f32_16x16x64_bf16 v[36:39],v[28:31],a[96:103],v2
ds_read_b128 v[68:71],v3 offset:33792
s_waitcnt lgkmcnt(5)
v_smfmac_f32_16x16x64_bf16 v[48:51],v[28:31],v[96:103],v2
ds_read_b128 v[96:99],v3 offset:34816
v_smfmac_f32_16x16x64_bf16 v[40:43],v[28:31],a[168:175],v2
ds_read_b128 v[100:103],v3 offset:35840
v_smfmac_f32_16x16x64_bf16 v[44:47],v[28:31],a[248:255],v2
s_waitcnt lgkmcnt(5)
v_smfmac_f32_16x16x64_bf16 v[52:55],v[28:31],v[56:63],v2
ds_read_b128 v[28:31],v0 offset:9216
s_add_u32 s60,s42,12288
buffer_load_dwordx4 v[56:59],v1,s[4:7],s60 offen
s_waitcnt lgkmcnt(5)
s_waitcnt vmcnt(3)
v_smfmac_f32_16x16x64_bf16 v[32:35],v[24:27],v[104:111],v2
v_smfmac_f32_16x16x64_bf16 v[36:39],v[24:27],a[104:111],v2
v_smfmac_f32_16x16x64_bf16 v[40:43],v[24:27],a[176:183],v2
s_add_u32 s60,s42,12288
buffer_load_dwordx4 v[60:63],v1,s[4:7],s60 offen offset:1024
v_smfmac_f32_16x16x64_bf16 v[44:47],v[24:27],v[112:119],v2
s_waitcnt lgkmcnt(0)
v_smfmac_f32_16x16x64_bf16 v[32:35],v[28:31],a[48:55],v2
v_smfmac_f32_16x16x64_bf16 v[36:39],v[28:31],a[112:119],v2
s_add_u32 s60,s42,14336
buffer_load_dwordx4 v[104:107],v1,s[4:7],s60 offen
v_smfmac_f32_16x16x64_bf16 v[40:43],v[28:31],a[184:191],v2
v_smfmac_f32_16x16x64_bf16 v[44:47],v[28:31],v[120:127],v2
v_smfmac_f32_16x16x64_bf16 v[48:51],v[24:27],v[64:71],v2
s_nop 1
v_add_f32 v32,v32,v34
v_add_f32 v33,v33,v35
v_add_f32 v36,v36,v38
s_add_u32 s60,s42,14336
buffer_load_dwordx4 v[108:111],v1,s[4:7],s60 offen offset:1024
v_smfmac_f32_16x16x64_bf16 v[52:55],v[24:27],v[96:103],v2
v_add_f32 v37,v37,v39
v_mul_f32 v32,s35,v32
v_mul_f32 v33,s35,v33
v_smfmac_f32_16x16x64_bf16 v[48:51],v[28:31],v[128:135],v2
v_mul_f32 v36,s35,v36
v_mul_f32 v37,s35,v37
v_cvt_pk_bf16_f32 v14,v32,v36
v_smfmac_f32_16x16x64_bf16 v[52:55],v[28:31],v[136:143],v2
v_cvt_pk_bf16_f32 v15,v33,v37
ds_write_b32 v4,v14
ds_write_b32 v4,v15 offset:16
s_add_u32 s60,s42,16384
buffer_load_dwordx4 v[64:67],v1,s[4:7],s60 offen
s_add_u32 s43,s43,786432
v_add_f32 v40,v40,v42
v_add_f32 v41,v41,v43
v_add_f32 v44,v44,v46
v_add_f32 v45,v45,v47
v_cvt_pk_bf16_f32 v16,v40,v44
v_cvt_pk_bf16_f32 v17,v41,v45
ds_write_b32 v4,v16 offset:2048
ds_write_b32 v4,v17 offset:2064
v_pk_add_f32 v[48:49],v[48:49],v[50:51]
v_pk_add_f32 v[52:53],v[52:53],v[54:55]
v_cvt_pk_bf16_f32 v48,v48,v49
v_mov_b32 v49,0
v_cvt_pk_bf16_f32 v52,v52,v53
v_mov_b32 v53,0
ds_write_b32 v13,v48
ds_write_b32 v13,v52 offset:128
s_add_u32 s60,s42,16384
buffer_load_dwordx4 v[68:71],v1,s[4:7],s60 offen offset:1024
s_add_u32 s60,s42,18432
buffer_load_dwordx4 v[96:99],v1,s[4:7],s60 offen
s_waitcnt lgkmcnt(0)
s_barrier
s_cmp_ge_u32 s28,63
s_cbranch_scc1 ch_fin_54
ds_read_b128 v[32:35],v5 offset:10240
ds_read_b128 v[72:75],v6
ds_read_b128 v[36:39],v5 offset:10752
ds_read_b128 v[76:79],v6 offset:512
ds_read_b128 v[40:43],v5 offset:11264
ds_read_b128 v[80:83],v6 offset:1024
ds_read_b128 v[44:47],v5 offset:11776
ds_read_b128 v[84:87],v6 offset:1536
s_add_u32 s60,s42,18432
buffer_load_dwordx4 v[100:103],v1,s[4:7],s60 offen offset:1024
s_waitcnt lgkmcnt(6)
v_mfma_f32_16x16x32_bf16 v[24:27],v[72:75],v[32:35],0
s_waitcnt lgkmcnt(4)
v_mfma_f32_16x16x32_bf16 v[24:27],v[76:79],v[36:39],v[24:27]
s_waitcnt lgkmcnt(2)
v_mfma_f32_16x16x32_bf16 v[24:27],v[80:83],v[40:43],v[24:27]
s_waitcnt lgkmcnt(0)
v_mfma_f32_16x16x32_bf16 v[24:27],v[84:87],v[44:47],v[24:27]
s_nop 7
ds_write_b128 v5,v[24:27] offset:1024
s_add_u32 s60,s42,20480
buffer_load_dwordx4 v[72:75],v1,s[4:7],s60 offen
s_add_u32 s60,s42,20480
buffer_load_dwordx4 v[76:79],v1,s[4:7],s60 offen offset:1024
s_waitcnt lgkmcnt(0)
s_barrier
ds_read_b128 v[32:35],v5
ds_read_b128 v[36:39],v5 offset:512
ds_read_b64 v[40:41],v5 offset:1024
s_add_u32 s60,s42,22528
buffer_load_dwordx4 v[80:83],v1,s[4:7],s60 offen
s_add_u32 s60,s42,22528
buffer_load_dwordx4 v[84:87],v1,s[4:7],s60 offen offset:1024
s_waitcnt lgkmcnt(0)
v_max3_f32 v14,v32,v33,v34
v_max3_f32 v15,v35,v36,v37
v_max3_f32 v16,v38,v39,v40
v_max3_f32 v15,v14,v15,v41
v_mov_b32 v29,0
v_max_f32 v14,v15,v16
v_max_f32 v15,v15,v16
s_nop 1
v_permlane32_swap_b32 v14,v15
s_nop 0
v_max_f32 v16,v14,v15
v_max_f32 v14,v14,v15
s_nop 1
v_permlane16_swap_b32 v14,v16
s_nop 0
v_max_f32 v14,v14,v16
v_pk_add_f32 v[40:41],v[40:41],v[14:15] op_sel_hi:[1,0] neg_lo:[0,1] neg_hi:[0,1]
v_pk_add_f32 v[32:33],v[32:33],v[14:15] op_sel_hi:[1,0] neg_lo:[0,1] neg_hi:[0,1]
v_pk_add_f32 v[34:35],v[34:35],v[14:15] op_sel_hi:[1,0] neg_lo:[0,1] neg_hi:[0,1]
v_pk_add_f32 v[36:37],v[36:37],v[14:15] op_sel_hi:[1,0] neg_lo:[0,1] neg_hi:[0,1]
v_pk_add_f32 v[38:39],v[38:39],v[14:15] op_sel_hi:[1,0] neg_lo:[0,1] neg_hi:[0,1]
v_exp_f32 v40,v40
v_exp_f32 v41,v41
v_exp_f32 v32,v32
v_cvt_pk_bf16_f32 v28,v40,v41
v_add_f32 v14,v40,v41
v_exp_f32 v33,v33
v_mfma_f32_16x16x16_bf16 v[40:43],v[48:49],v[28:29],0
v_exp_f32 v34,v34
v_mfma_f32_16x16x16_bf16 v[44:47],v[52:53],v[28:29],0
v_exp_f32 v35,v35
v_exp_f32 v36,v36
v_exp_f32 v37,v37
v_exp_f32 v38,v38
v_exp_f32 v39,v39
v_cvt_pk_bf16_f32 v24,v32,v33
v_cvt_pk_bf16_f32 v25,v34,v35
v_cvt_pk_bf16_f32 v26,v36,v37
v_cvt_pk_bf16_f32 v27,v38,v39
s_waitcnt vmcnt(12)
v_pk_add_f32 v[32:33],v[32:33],v[34:35]
v_pk_add_f32 v[36:37],v[36:37],v[38:39]
v_mfma_f32_16x16x32_bf16 v[40:43],v[88:91],v[24:27],v[40:43]
v_add_f32 v32,v32,v36
v_add_f32 v33,v33,v37
v_mfma_f32_16x16x32_bf16 v[44:47],v[92:95],v[24:27],v[44:47]
v_add_f32 v32,v32,v14
v_add_f32 v14,v32,v33
v_add_f32 v15,v32,v33
v_mov_b32 v88,0
v_mov_b32 v89,0
v_permlane32_swap_b32 v14,v15
v_mov_b32 v90,0
v_add_f32 v16,v14,v15
v_add_f32 v14,v14,v15
v_mov_b32 v91,0
v_mov_b32 v92,0
v_permlane16_swap_b32 v14,v16
v_mov_b32 v93,0
v_add_f32 v14,v14,v16
v_rcp_f32 v14,v14
v_mov_b32 v94,0
v_mov_b32 v95,0
v_pk_mul_f32 v[40:41],v[40:41],v[14:15] op_sel_hi:[1,0]
v_pk_mul_f32 v[42:43],v[42:43],v[14:15] op_sel_hi:[1,0]
v_pk_mul_f32 v[44:45],v[44:45],v[14:15] op_sel_hi:[1,0]
v_pk_mul_f32 v[46:47],v[46:47],v[14:15] op_sel_hi:[1,0]
v_cvt_pk_bf16_f32 v16,v40,v41
v_cvt_pk_bf16_f32 v17,v42,v43
v_cvt_pk_bf16_f32 v18,v44,v45
v_cvt_pk_bf16_f32 v19,v46,v47
ds_write_b128 v7,v[16:19]
s_and_b32 s48,s28,1
s_mov_b64 vcc,s[22:23]
v_mov_b64 v[32:33],0
v_mov_b64 v[34:35],0
v_mov_b64 v[36:37],0
v_mov_b64 v[38:39],0
v_mov_b64 v[40:41],0
v_mov_b64 v[42:43],0
v_mov_b64 v[44:45],0
v_mov_b64 v[46:47],0
v_mov_b64 v[48:49],0
v_mov_b64 v[50:51],0
s_waitcnt lgkmcnt(0)
s_barrier
ds_read_b128 v[24:27],v1 offset:10240
ds_read_b128 v[28:31],v1 offset:11264
v_mov_b64 v[52:53],0
v_mov_b64 v[54:55],0
v_mov_b64 v[16:17],0
v_mov_b64 v[18:19],0
s_waitcnt lgkmcnt(0)
s_waitcnt vmcnt(10)
v_smfmac_f32_16x16x64_bf16 v[32:35],v[24:27],v[56:63],v2
s_waitcnt vmcnt(8)
v_smfmac_f32_16x16x64_bf16 v[32:35],v[28:31],v[104:111],v2
buffer_load_dword v11,v12,s[4:7],s20 offen sc1
buffer_load_dwordx2 v[20:21],off,s[4:7],s36 sc1
s_waitcnt vmcnt(8)
v_smfmac_f32_16x16x64_bf16 v[36:39],v[24:27],v[64:71],v2
s_waitcnt vmcnt(6)
v_smfmac_f32_16x16x64_bf16 v[36:39],v[28:31],v[96:103],v2
v_smfmac_f32_16x16x64_bf16 v[40:43],v[24:27],v[144:151],v2
s_add_u32 s60,s42,2048
buffer_load_dwordx4 v[104:107],v1,s[4:7],s60 offen
v_add_f32 v32,v32,v34
v_add_f32 v33,v33,v35
v_smfmac_f32_16x16x64_bf16 v[40:43],v[28:31],v[152:159],v2
v_smfmac_f32_16x16x64_bf16 v[44:47],v[24:27],v[160:167],v2
s_nop 0
v_add_f32 v36,v36,v38
v_add_f32 v37,v37,v39
v_cvt_pk_bf16_f32 v38,v32,v36
v_smfmac_f32_16x16x64_bf16 v[44:47],v[28:31],v[168:175],v2
s_add_u32 s60,s42,2048
buffer_load_dwordx4 v[108:111],v1,s[4:7],s60 offen offset:1024
v_cvt_pk_bf16_f32 v39,v33,v37
v_bfi_b32 v38,1,s48,v38
v_bfi_b32 v39,1,s48,v39
v_smfmac_f32_16x16x64_bf16 v[48:51],v[24:27],v[176:183],v2
s_nop 0
v_cndmask_b32_dpp v36,v39,v38,vcc quad_perm:[1,0,3,2] row_mask:0xf bank_mask:0xf
s_not_b64 vcc,vcc
v_cndmask_b32_dpp v37,v38,v39,vcc quad_perm:[1,0,3,2] row_mask:0xf bank_mask:0xf
v_smfmac_f32_16x16x64_bf16 v[48:51],v[28:31],v[184:191],v2
buffer_store_dwordx2 v[36:37],v10,s[4:7],s65 offen sc1
v_add_f32 v40,v40,v42
v_add_f32 v41,v41,v43
v_smfmac_f32_16x16x64_bf16 v[52:55],v[24:27],v[192:199],v2
v_add_f32 v44,v44,v46
v_add_f32 v45,v45,v47
v_cvt_pk_bf16_f32 v32,v40,v44
v_smfmac_f32_16x16x64_bf16 v[52:55],v[28:31],v[200:207],v2
s_add_u32 s60,s42,0
buffer_load_dwordx4 v[96:99],v1,s[4:7],s60 offen
v_cvt_pk_bf16_f32 v34,v41,v45
v_bfi_b32 v32,1,s48,v32
v_bfi_b32 v34,1,s48,v34
v_smfmac_f32_16x16x64_bf16 v[88:91],v[24:27],v[208:215],v2
v_mov_b64 v[40:41],0
v_mov_b64 v[42:43],0
v_add_f32 v48,v48,v50
v_smfmac_f32_16x16x64_bf16 v[88:91],v[28:31],v[216:223],v2
v_add_f32 v49,v49,v51
v_smfmac_f32_16x16x64_bf16 v[92:95],v[24:27],v[224:231],v2
s_add_u32 s60,s42,0
buffer_load_dwordx4 v[100:103],v1,s[4:7],s60 offen offset:1024
v_add_f32 v52,v52,v54
v_add_f32 v53,v53,v55
v_cvt_pk_bf16_f32 v33,v48,v52
v_smfmac_f32_16x16x64_bf16 v[92:95],v[28:31],v[232:239],v2
v_cvt_pk_bf16_f32 v35,v49,v53
v_bfi_b32 v33,1,s48,v33
v_bfi_b32 v35,1,s48,v35
v_smfmac_f32_16x16x64_bf16 v[16:19],v[24:27],v[240:247],v2
buffer_store_dwordx4 v[32:35],v9,s[4:7],s64 offen sc1
v_add_f32 v88,v88,v90
v_add_f32 v89,v89,v91
v_smfmac_f32_16x16x64_bf16 v[16:19],v[28:31],v[248:255],v2
s_waitcnt vmcnt(10)
v_smfmac_f32_16x16x64_bf16 v[40:43],v[24:27],v[72:79],v2
v_add_f32 v92,v92,v94
v_add_f32 v93,v93,v95
v_cvt_pk_bf16_f32 v44,v88,v92
s_waitcnt vmcnt(8)
v_smfmac_f32_16x16x64_bf16 v[40:43],v[28:31],v[80:87],v2
v_cvt_pk_bf16_f32 v46,v89,v93
v_bfi_b32 v44,1,s48,v44
v_bfi_b32 v46,1,s48,v46
v_add_f32 v16,v16,v18
v_add_f32 v17,v17,v19
s_nop 2
v_add_f32 v40,v40,v42
v_add_f32 v41,v41,v43
v_cvt_pk_bf16_f32 v45,v16,v40
v_cvt_pk_bf16_f32 v47,v17,v41
v_bfi_b32 v45,1,s48,v45
v_bfi_b32 v47,1,s48,v47
buffer_store_dwordx4 v[44:47],v9,s[4:7],s63 offen sc1
s_nop 0
s_branch ch_hop_55
ch_mf_57:
s_add_u32 s38,s38,1
s_cmp_lt_u32 s38,100000
s_cbranch_scc1 ch_m_56
s_mov_b32 s40,10
s_branch L_fail
ch_kf_52:
s_add_u32 s60,s28,0
s_mul_i32 s59,s60,43
s_lshr_b32 s59,s59,7
s_mul_i32 s59,s59,3
s_sub_u32 s59,s60,s59
s_min_u32 s101,s60,42
s_sub_u32 s101,s101,33
s_and_b32 s101,s101,1
s_cmp_lt_u32 s60,33
s_cselect_b32 s60,s59,s101
s_cmp_eq_u32 s39,0
s_cselect_b32 s60,s60,0
s_lshl_b32 s60,s60,2
s_mov_b32 s38,0
poll_60:
buffer_load_dword v15,v12,s[4:7],s60 offen sc1
s_waitcnt vmcnt(0)
v_cmp_le_u32 vcc,s31,v15
s_nop 0
s_cmp_eq_u64 vcc,-1
s_nop 1
s_cbranch_scc1 polld_61
s_add_u32 s38,s38,1
s_cmp_lt_u32 s38,100000
s_cbranch_scc1 poll_60
s_mov_b32 s40,8
s_branch L_fail
polld_61:
v_mbcnt_lo_u32_b32 v14,-1,0
v_and_b32 v14,1,v14
v_lshlrev_b32 v14,2,v14
s_sub_i32 s60,s31,6
s_max_i32 s60,s60,0
s_mov_b32 s38,0
poll_62:
buffer_load_dword v15,v14,s[4:7],s36 offen sc1
s_waitcnt vmcnt(0)
v_cmp_le_u32 vcc,s60,v15
s_nop 0
s_cmp_eq_u64 vcc,-1
s_nop 1
s_cbranch_scc1 polld_63
s_sleep 2
s_add_u32 s38,s38,1
s_cmp_lt_u32 s38,100000
s_cbranch_scc1 poll_62
s_mov_b32 s40,8
s_branch L_fail
polld_63:
s_branch ch_ok_51
ch_kf_59:
s_add_u32 s60,s28,0
s_mul_i32 s59,s60,43
s_lshr_b32 s59,s59,7
s_mul_i32 s59,s59,3
s_sub_u32 s59,s60,s59
s_min_u32 s101,s60,42
s_sub_u32 s101,s101,33
s_and_b32 s101,s101,1
s_cmp_lt_u32 s60,33
s_cselect_b32 s60,s59,s101
s_cmp_eq_u32 s39,0
s_cselect_b32 s60,s60,0
s_lshl_b32 s60,s60,2
s_mov_b32 s38,0
poll_64:
buffer_load_dword v15,v12,s[4:7],s60 offen sc1
s_waitcnt vmcnt(0)
v_cmp_le_u32 vcc,s31,v15
s_nop 0
s_cmp_eq_u64 vcc,-1
s_nop 1
s_cbranch_scc1 polld_65
s_add_u32 s38,s38,1
s_cmp_lt_u32 s38,100000
s_cbranch_scc1 poll_64
s_mov_b32 s40,8
s_branch L_fail
polld_65:
v_mbcnt_lo_u32_b32 v14,-1,0
v_and_b32 v14,1,v14
v_lshlrev_b32 v14,2,v14
s_sub_i32 s60,s31,6
s_max_i32 s60,s60,0
s_mov_b32 s38,0
poll_66:
buffer_load_dword v15,v14,s[4:7],s36 offen sc1
s_waitcnt vmcnt(0)
v_cmp_le_u32 vcc,s60,v15
s_nop 0
s_cmp_eq_u64 vcc,-1
s_nop 1
s_cbranch_scc1 polld_67
s_sleep 2
s_add_u32 s38,s38,1
s_cmp_lt_u32 s38,100000
s_cbranch_scc1 poll_66
s_mov_b32 s40,8
s_branch L_fail
polld_67:
s_branch ch_ok_58
ch_end_47:
ch_fin_54:
s_branch L_end
CH_2_1:
v_and_b32 v14,15,v0
v_lshrrev_b32 v15,4,v0
v_bfe_u32 v16,v0,1,1
v_mul_u32_u24 v2,0xaaaa,v16
v_add_u32 v2,0x4444,v2
v_add_u32 v3,73728,v1
v_add_u32 v1,147456,v1
v_lshrrev_b32 v17,3,v14
v_lshlrev_b32 v4,8,v17
v_lshl_add_u32 v4,v16,7,v4
v_lshl_add_u32 v4,v15,5,v4
v_and_b32 v18,1,v0
v_lshl_add_u32 v4,v18,2,v4
v_bfe_u32 v19,v0,2,1
v_lshl_add_u32 v4,v19,3,v4
v_add_u32 v4,158720,v4
v_and_b32 v5,7,v0
v_lshlrev_b32 v5,4,v5
v_lshl_add_u32 v5,v15,7,v5
v_add_u32 v5,147456,v5
v_lshrrev_b32 v6,2,v14
v_lshl_add_u32 v6,v6,1,v18
v_lshlrev_b32 v6,4,v6
v_lshl_add_u32 v6,v15,7,v6
v_add_u32 v6,159744,v6
v_bfe_u32 v7,v0,1,2
v_lshl_add_u32 v7,v7,2,v18
v_bfe_u32 v8,v0,4,1
v_lshl_add_u32 v7,v8,1,v7
v_lshrrev_b32 v13,5,v0
v_lshl_add_u32 v7,v13,4,v7
v_lshlrev_b32 v7,4,v7
v_add_u32 v7,158720,v7
v_lshlrev_b32 v13,8,v13
v_lshl_add_u32 v13,v14,3,v13
v_lshl_add_u32 v13,v8,2,v13
v_add_u32 v13,162816,v13
v_lshlrev_b32 v8,4,v14
v_lshl_add_u32 v8,v15,9,v8
v_add_u32 v8,135168,v8
v_lshlrev_b32 v9,14,v15
v_lshl_add_u32 v9,v14,4,v9
v_add_u32 v9,262144,v9
v_lshrrev_b32 v10,5,v0
v_lshlrev_b32 v10,14,v10
v_and_b32 v32,31,v0
v_lshl_add_u32 v10,v32,3,v10
v_add_u32 v10,65536,v10
s_mul_i32 s60,s39,0x48000
s_add_u32 s60,s60,0x18010
s_lshl_b32 s101,s39,13
s_xor_b32 s101,s101,s99
s_xor_b32 s101,s101,8192
s_add_u32 s60,s60,s101
s_lshl_b32 s61,s41,8
s_add_u32 s60,s60,s61
v_lshlrev_b32 v12,7,v18
v_lshl_add_u32 v12,v16,4,v12
v_add_u32 v12,s60,v12
s_mul_i32 s37,s39,0x48000
s_add_u32 s37,s37,0x20000
s_lshl_b32 s101,s39,13
s_xor_b32 s101,s101,s99
s_xor_b32 s101,s101,8192
s_add_u32 s37,s37,s101
s_lshl_b32 s61,s41,7
s_add_u32 s37,s37,s61
s_mul_i32 s43,s39,0x3000000
s_add_u32 s43,s43,0x7ad0000
s_lshr_b32 s61,s41,4
s_lshl_b32 s61,s61,18
s_add_u32 s43,s43,s61
s_lshl_b32 s61,s41,13
s_add_u32 s43,s43,s61
s_mul_i32 s44,s39,0x0
s_add_u32 s44,s44,0x3dc000
s_lshl_b32 s101,s39,13
s_xor_b32 s101,s101,s99
s_xor_b32 s101,s101,8192
s_add_u32 s44,s44,s101
s_lshr_b32 s61,s41,1
s_lshl_b32 s61,s61,14
s_add_u32 s44,s44,s61
s_and_b32 s61,s41,1
s_lshl_b32 s61,s61,12
s_add_u32 s44,s44,s61
s_sub_u32 s42,s42,147456
s_lshl_b32 s98,s39,13
s_xor_b32 s98,s98,s99
s_xor_b32 s98,s98,8192
s_mul_i32 s45,s39,0x0
s_add_u32 s45,s45,0x100000
s_add_u32 s45,s45,s98
s_lshl_b32 s61,s41,14
s_add_u32 s32,s45,s61
s_sub_u32 s32,s32,147456
s_lshl_b32 s61,s41,8
s_add_u32 s45,s45,s61
s_mul_i32 s46,s39,0x0
s_add_u32 s46,s46,0x180000
s_add_u32 s46,s46,s98
s_and_b32 s61,s41,7
s_lshl_b32 s61,s61,14
s_add_u32 s33,s46,s61
s_sub_u32 s33,s33,147456
s_lshl_b32 s61,s41,8
s_add_u32 s46,s46,s61
s_mov_b32 s24,s4
s_mov_b32 s25,s5
s_mov_b32 s27,0x20000
s_cmp_lt_u32 s41,8
s_cselect_b32 s26,s6,0
s_mov_b32 s26,0
s_mov_b32 s22,0x55555555
s_mov_b32 s23,0x55555555
s_mul_i32 s34,s39,0x0
s_add_u32 s34,s34,0x1a0000
s_add_u32 s34,s34,s98
s_add_u32 s36,s37,32768
s_mov_b32 s35,0x3e0293ee
s_mov_b32 s28,0
s_mov_b32 s66,s32
s_mov_b32 s67,s33
s_mov_b32 s64,s45
s_mov_b32 s65,s46
s_add_u32 s63,s64,0x10000
s_mov_b32 s49,s34
s_add_u32 s69,s34,0x8000
ds_read_b128 v[56:59],v3
ds_read_b128 v[60:63],v3 offset:1024
ds_read_b128 v[64:67],v3 offset:2048
ds_read_b128 v[68:71],v3 offset:3072
s_cmp_eq_u32 s39,0
s_cbranch_scc1 ch_nw_70
s_add_u32 s60,s42,0
buffer_load_dwordx4 v[32:35],v1,s[4:7],s60 offen
s_add_u32 s60,s42,1024
buffer_load_dwordx4 v[32:35],v1,s[4:7],s60 offen
s_add_u32 s60,s42,2048
buffer_load_dwordx4 v[32:35],v1,s[4:7],s60 offen
s_add_u32 s60,s42,3072
buffer_load_dwordx4 v[32:35],v1,s[4:7],s60 offen
s_add_u32 s60,s42,4096
buffer_load_dwordx4 v[32:35],v1,s[4:7],s60 offen
s_add_u32 s60,s42,5120
buffer_load_dwordx4 v[32:35],v1,s[4:7],s60 offen
s_add_u32 s60,s42,6144
buffer_load_dwordx4 v[32:35],v1,s[4:7],s60 offen
s_add_u32 s60,s42,7168
buffer_load_dwordx4 v[32:35],v1,s[4:7],s60 offen
s_add_u32 s60,s42,8192
buffer_load_dwordx4 v[32:35],v1,s[4:7],s60 offen
s_add_u32 s60,s42,9216
buffer_load_dwordx4 v[32:35],v1,s[4:7],s60 offen
s_add_u32 s60,s42,10240
buffer_load_dwordx4 v[32:35],v1,s[4:7],s60 offen
s_add_u32 s60,s42,11264
buffer_load_dwordx4 v[32:35],v1,s[4:7],s60 offen
s_add_u32 s60,s42,12288
buffer_load_dwordx4 v[32:35],v1,s[4:7],s60 offen
s_add_u32 s60,s42,13312
buffer_load_dwordx4 v[32:35],v1,s[4:7],s60 offen
s_add_u32 s60,s42,14336
buffer_load_dwordx4 v[32:35],v1,s[4:7],s60 offen
s_add_u32 s60,s42,15360
buffer_load_dwordx4 v[32:35],v1,s[4:7],s60 offen
s_add_u32 s60,s42,16384
buffer_load_dwordx4 v[32:35],v1,s[4:7],s60 offen
s_add_u32 s60,s42,17408
buffer_load_dwordx4 v[32:35],v1,s[4:7],s60 offen
s_add_u32 s60,s42,18432
buffer_load_dwordx4 v[32:35],v1,s[4:7],s60 offen
s_add_u32 s60,s42,19456
buffer_load_dwordx4 v[32:35],v1,s[4:7],s60 offen
s_add_u32 s60,s42,20480
buffer_load_dwordx4 v[32:35],v1,s[4:7],s60 offen
s_add_u32 s60,s42,21504
buffer_load_dwordx4 v[32:35],v1,s[4:7],s60 offen
s_add_u32 s60,s42,22528
buffer_load_dwordx4 v[32:35],v1,s[4:7],s60 offen
s_add_u32 s60,s42,23552
buffer_load_dwordx4 v[32:35],v1,s[4:7],s60 offen
s_waitcnt vmcnt(0) lgkmcnt(0)
s_getpc_b64 s[60:61]
pc_71:
s_add_u32 s60,s60,ch_beg_69-pc_71
s_addc_u32 s61,s61,0
s_mov_b32 s59,ch_end_68-ch_beg_69-4
v_lshlrev_b32 v38,7,v0
v_add_u32 v38,0,v38
v_min_u32 v38,s59,v38
v_mov_b32 v37,s61
v_add_co_u32 v36,vcc,s60,v38
s_nop 1
v_addc_co_u32 v37,vcc,0,v37,vcc
global_load_dword v39,v[36:37],off
s_waitcnt vmcnt(0)
s_waitcnt vmcnt(0)
s_nop 1
ch_nw_70:
v_lshl_add_u32 v24,v15,1,v16
v_lshlrev_b32 v24,4,v24
v_lshl_add_u32 v24,v18,7,v24
v_lshlrev_b32 v25,6,v19
v_xor_b32 v24,v24,v25
v_bfe_u32 v25,v0,2,2
v_lshl_add_u32 v24,v25,8,v24
v_add_u32 v0,147456,v24
s_mov_b32 s21,0
s_mov_b32 s20,0
s_add_u32 s31,s28,1
s_cmp_eq_u32 s21,0
s_cbranch_scc1 ch_kf_73
ch_ok_72:
s_add_u32 s20,s28,1
s_mul_i32 s59,s20,43
s_lshr_b32 s59,s59,7
s_mul_i32 s59,s59,3
s_sub_u32 s59,s20,s59
s_min_u32 s101,s20,42
s_sub_u32 s101,s101,33
s_and_b32 s101,s101,1
s_cmp_lt_u32 s20,33
s_cselect_b32 s20,s59,s101
s_cmp_eq_u32 s39,0
s_cselect_b32 s20,s20,0
s_lshl_b32 s20,s20,2
v_mov_b64 v[32:33],0
v_mov_b64 v[34:35],0
v_mov_b64 v[36:37],0
v_mov_b64 v[38:39],0
v_mov_b64 v[40:41],0
v_mov_b64 v[42:43],0
v_mov_b64 v[44:45],0
v_mov_b64 v[46:47],0
v_mov_b64 v[48:49],0
v_mov_b64 v[50:51],0
v_mov_b64 v[52:53],0
v_mov_b64 v[54:55],0
s_nop 0
s_branch ch_top_74
ch_beg_69:
ch_hop_76:
ds_read_b128 v[56:59],v3
ds_read_b128 v[60:63],v3 offset:1024
ds_read_b128 v[64:67],v3 offset:2048
ds_read_b128 v[68:71],v3 offset:3072
s_add_u32 s60,s42,4096
buffer_load_dwordx4 v[72:75],v1,s[4:7],s60 offen
s_add_u32 s60,s42,4096
buffer_load_dwordx4 v[76:79],v1,s[4:7],s60 offen offset:1024
s_add_u32 s60,s42,6144
buffer_load_dwordx4 v[80:83],v1,s[4:7],s60 offen
s_add_u32 s60,s42,6144
buffer_load_dwordx4 v[84:87],v1,s[4:7],s60 offen offset:1024
s_add_u32 s60,s42,8192
buffer_load_dwordx4 v[88:91],v1,s[4:7],s60 offen
s_add_u32 s60,s42,8192
buffer_load_dwordx4 v[92:95],v1,s[4:7],s60 offen offset:1024
s_waitcnt vmcnt(13)
s_add_u32 s31,s28,2
v_min_u32 v20,v20,v21
v_add_u32 v20,6,v20
v_min_u32 v11,v11,v20
v_cmp_le_u32 vcc,s31,v11
s_nop 0
s_cmp_eq_u64 vcc,-1
s_cselect_b32 s21,1,0
s_add_u32 s28,s28,1
s_and_b32 s60,s28,3
s_lshl_b32 s60,s60,15
s_add_u32 s47,s34,s60
s_xor_b32 s60,s60,0x10000
s_add_u32 s49,s34,s60
s_mov_b32 s38,0
s_add_u32 s68,s47,-147456
s_add_u32 s69,s47,-143360
s_add_u32 s20,s28,1
s_mul_i32 s59,s20,43
s_lshr_b32 s59,s59,7
s_mul_i32 s59,s59,3
s_sub_u32 s59,s20,s59
s_min_u32 s101,s20,42
s_sub_u32 s101,s101,33
s_and_b32 s101,s101,1
s_cmp_lt_u32 s20,33
s_cselect_b32 s20,s59,s101
s_cmp_eq_u32 s39,0
s_cselect_b32 s20,s20,0
s_lshl_b32 s20,s20,2
v_mov_b64 v[36:37],0
v_mov_b64 v[38:39],0
v_mov_b64 v[40:41],0
v_mov_b64 v[42:43],0
v_mov_b64 v[44:45],0
v_mov_b64 v[46:47],0
v_mov_b64 v[48:49],0
v_mov_b64 v[50:51],0
v_mov_b64 v[52:53],0
v_mov_b64 v[54:55],0
s_waitcnt lgkmcnt(0)
s_barrier
s_sleep 7
ch_m_77:
buffer_load_dwordx4 v[32:35],v1,s[4:7],s68 offen sc1
buffer_load_dwordx4 v[28:31],v1,s[4:7],s68 offen offset:1024 sc1
buffer_load_dwordx4 v[24:27],v1,s[4:7],s68 offen offset:2048 sc1
buffer_load_dwordx4 v[20:23],v1,s[4:7],s68 offen offset:3072 sc1
buffer_load_dwordx4 v[16:19],v1,s[4:7],s69 offen sc1
s_waitcnt vmcnt(4)
ds_write_b128 v1,v[32:35]
v_max3_u32 v14,v32,v33,v34
v_max_u32 v14,v14,v35
s_waitcnt vmcnt(3)
ds_write_b128 v1,v[28:31] offset:1024
v_max3_u32 v14,v14,v28,v29
v_max3_u32 v14,v14,v30,v31
s_waitcnt vmcnt(2)
ds_write_b128 v1,v[24:27] offset:2048
v_max3_u32 v14,v14,v24,v25
v_max3_u32 v14,v14,v26,v27
s_waitcnt vmcnt(1)
ds_write_b128 v1,v[20:23] offset:3072
v_max3_u32 v14,v14,v20,v21
v_max3_u32 v14,v14,v22,v23
s_waitcnt vmcnt(0)
ds_write_b128 v1,v[16:19] offset:4096
v_max3_u32 v14,v14,v16,v17
v_max3_u32 v14,v14,v18,v19
v_cmp_eq_u32 vcc,-1,v14
s_cbranch_vccnz ch_mf_78
s_add_u32 s31,s28,1
s_cmp_eq_u32 s21,0
s_cbranch_scc1 ch_kf_80
ch_ok_79:
ch_top_74:
v_mov_b64 v[32:33],0
v_mov_b64 v[34:35],0
s_waitcnt lgkmcnt(0)
s_barrier
ds_read_b128 v[24:27],v0
ds_read_b128 v[28:31],v0 offset:1024
s_add_u32 s61,s43,4096
s_waitcnt lgkmcnt(1)
v_smfmac_f32_16x16x64_bf16 v[32:35],v[24:27],v[96:103],v2
ds_read_b128 v[96:99],v3 offset:4096
v_smfmac_f32_16x16x64_bf16 v[36:39],v[24:27],v[104:111],v2
ds_read_b128 v[100:103],v3 offset:5120
s_add_u32 s60,s42,10240
buffer_load_dwordx4 v[104:107],v1,s[4:7],s60 offen
v_smfmac_f32_16x16x64_bf16 v[48:51],v[24:27],v[56:63],v2
ds_read_b128 v[56:59],v3 offset:6144
v_smfmac_f32_16x16x64_bf16 v[40:43],v[24:27],a[120:127],v2
ds_read_b128 v[60:63],v3 offset:7168
s_add_u32 s60,s42,10240
buffer_load_dwordx4 v[108:111],v1,s[4:7],s60 offen offset:1024
v_smfmac_f32_16x16x64_bf16 v[44:47],v[24:27],a[192:199],v2
v_smfmac_f32_16x16x64_bf16 v[52:55],v[24:27],v[64:71],v2
ds_read_b128 v[24:27],v0 offset:2048
s_waitcnt lgkmcnt(5)
v_smfmac_f32_16x16x64_bf16 v[32:35],v[28:31],v[72:79],v2
ds_read_b128 v[64:67],v3 offset:8192
v_smfmac_f32_16x16x64_bf16 v[36:39],v[28:31],v[80:87],v2
ds_read_b128 v[68:71],v3 offset:9216
s_waitcnt lgkmcnt(5)
v_smfmac_f32_16x16x64_bf16 v[48:51],v[28:31],v[96:103],v2
ds_read_b128 v[96:99],v3 offset:10240
v_smfmac_f32_16x16x64_bf16 v[40:43],v[28:31],v[88:95],v2
ds_read_b128 v[100:103],v3 offset:11264
buffer_load_dwordx4 v[88:91],v8,s[4:7],s43 offen sc1 nt
v_smfmac_f32_16x16x64_bf16 v[44:47],v[28:31],a[200:207],v2
s_waitcnt lgkmcnt(5)
v_smfmac_f32_16x16x64_bf16 v[52:55],v[28:31],v[56:63],v2
ds_read_b128 v[28:31],v0 offset:3072
s_waitcnt lgkmcnt(5)
v_smfmac_f32_16x16x64_bf16 v[32:35],v[24:27],a[0:7],v2
ds_read_b128 v[56:59],v3 offset:12288
buffer_load_dwordx4 v[92:95],v8,s[4:7],s43 offen offset:256 sc1 nt
v_smfmac_f32_16x16x64_bf16 v[36:39],v[24:27],a[56:63],v2
ds_read_b128 v[60:63],v3 offset:13312
s_waitcnt lgkmcnt(5)
v_smfmac_f32_16x16x64_bf16 v[48:51],v[24:27],v[64:71],v2
ds_read_b128 v[64:67],v3 offset:14336
v_smfmac_f32_16x16x64_bf16 v[40:43],v[24:27],a[128:135],v2
ds_read_b128 v[68:71],v3 offset:15360
v_smfmac_f32_16x16x64_bf16 v[44:47],v[24:27],a[208:215],v2
s_waitcnt lgkmcnt(5)
v_smfmac_f32_16x16x64_bf16 v[52:55],v[24:27],v[96:103],v2
ds_read_b128 v[24:27],v0 offset:4096
s_waitcnt lgkmcnt(5)
v_smfmac_f32_16x16x64_bf16 v[32:35],v[28:31],a[8:15],v2
ds_read_b128 v[96:99],v3 offset:16384
v_smfmac_f32_16x16x64_bf16 v[36:39],v[28:31],a[64:71],v2
ds_read_b128 v[100:103],v3 offset:17408
s_waitcnt lgkmcnt(5)
v_smfmac_f32_16x16x64_bf16 v[48:51],v[28:31],v[56:63],v2
ds_read_b128 v[56:59],v3 offset:18432
v_smfmac_f32_16x16x64_bf16 v[40:43],v[28:31],a[136:143],v2
ds_read_b128 v[60:63],v3 offset:19456
v_smfmac_f32_16x16x64_bf16 v[44:47],v[28:31],a[216:223],v2
s_waitcnt lgkmcnt(5)
v_smfmac_f32_16x16x64_bf16 v[52:55],v[28:31],v[64:71],v2
ds_read_b128 v[28:31],v0 offset:5120
s_waitcnt lgkmcnt(5)
v_smfmac_f32_16x16x64_bf16 v[32:35],v[24:27],a[16:23],v2
ds_read_b128 v[64:67],v3 offset:20480
v_smfmac_f32_16x16x64_bf16 v[36:39],v[24:27],a[72:79],v2
ds_read_b128 v[68:71],v3 offset:21504
s_waitcnt lgkmcnt(5)
v_smfmac_f32_16x16x64_bf16 v[48:51],v[24:27],v[96:103],v2
ds_read_b128 v[96:99],v3 offset:22528
v_smfmac_f32_16x16x64_bf16 v[40:43],v[24:27],a[144:151],v2
ds_read_b128 v[100:103],v3 offset:23552
v_smfmac_f32_16x16x64_bf16 v[44:47],v[24:27],a[224:231],v2
s_waitcnt lgkmcnt(5)
v_smfmac_f32_16x16x64_bf16 v[52:55],v[24:27],v[56:63],v2
ds_read_b128 v[24:27],v0 offset:6144
s_waitcnt lgkmcnt(5)
v_smfmac_f32_16x16x64_bf16 v[32:35],v[28:31],a[24:31],v2
ds_read_b128 v[56:59],v3 offset:24576
v_smfmac_f32_16x16x64_bf16 v[36:39],v[28:31],a[80:87],v2
ds_read_b128 v[60:63],v3 offset:25600
s_waitcnt lgkmcnt(5)
v_smfmac_f32_16x16x64_bf16 v[48:51],v[28:31],v[64:71],v2
ds_read_b128 v[64:67],v3 offset:26624
v_smfmac_f32_16x16x64_bf16 v[40:43],v[28:31],a[152:159],v2
ds_read_b128 v[68:71],v3 offset:27648
v_smfmac_f32_16x16x64_bf16 v[44:47],v[28:31],a[232:239],v2
s_waitcnt lgkmcnt(5)
v_smfmac_f32_16x16x64_bf16 v[52:55],v[28:31],v[96:103],v2
ds_read_b128 v[28:31],v0 offset:7168
s_waitcnt lgkmcnt(5)
v_smfmac_f32_16x16x64_bf16 v[32:35],v[24:27],a[32:39],v2
ds_read_b128 v[96:99],v3 offset:28672
v_smfmac_f32_16x16x64_bf16 v[36:39],v[24:27],a[88:95],v2
ds_read_b128 v[100:103],v3 offset:29696
s_waitcnt lgkmcnt(5)
v_smfmac_f32_16x16x64_bf16 v[48:51],v[24:27],v[56:63],v2
ds_read_b128 v[56:59],v3 offset:30720
v_smfmac_f32_16x16x64_bf16 v[40:43],v[24:27],a[160:167],v2
ds_read_b128 v[60:63],v3 offset:31744
v_smfmac_f32_16x16x64_bf16 v[44:47],v[24:27],a[240:247],v2
s_waitcnt lgkmcnt(5)
v_smfmac_f32_16x16x64_bf16 v[52:55],v[24:27],v[64:71],v2
ds_read_b128 v[24:27],v0 offset:8192
s_waitcnt lgkmcnt(5)
v_smfmac_f32_16x16x64_bf16 v[32:35],v[28:31],a[40:47],v2
ds_read_b128 v[64:67],v3 offset:32768
v_smfmac_f32_16x16x64_bf16 v[36:39],v[28:31],a[96:103],v2
ds_read_b128 v[68:71],v3 offset:33792
s_waitcnt lgkmcnt(5)
v_smfmac_f32_16x16x64_bf16 v[48:51],v[28:31],v[96:103],v2
ds_read_b128 v[96:99],v3 offset:34816
v_smfmac_f32_16x16x64_bf16 v[40:43],v[28:31],a[168:175],v2
ds_read_b128 v[100:103],v3 offset:35840
v_smfmac_f32_16x16x64_bf16 v[44:47],v[28:31],a[248:255],v2
s_waitcnt lgkmcnt(5)
v_smfmac_f32_16x16x64_bf16 v[52:55],v[28:31],v[56:63],v2
ds_read_b128 v[28:31],v0 offset:9216
s_add_u32 s60,s42,12288
buffer_load_dwordx4 v[56:59],v1,s[4:7],s60 offen
s_waitcnt lgkmcnt(5)
s_waitcnt vmcnt(3)
v_smfmac_f32_16x16x64_bf16 v[32:35],v[24:27],v[104:111],v2
v_smfmac_f32_16x16x64_bf16 v[36:39],v[24:27],a[104:111],v2
v_smfmac_f32_16x16x64_bf16 v[40:43],v[24:27],a[176:183],v2
s_add_u32 s60,s42,12288
buffer_load_dwordx4 v[60:63],v1,s[4:7],s60 offen offset:1024
v_smfmac_f32_16x16x64_bf16 v[44:47],v[24:27],v[112:119],v2
s_waitcnt lgkmcnt(0)
v_smfmac_f32_16x16x64_bf16 v[32:35],v[28:31],a[48:55],v2
v_smfmac_f32_16x16x64_bf16 v[36:39],v[28:31],a[112:119],v2
s_add_u32 s60,s42,14336
buffer_load_dwordx4 v[104:107],v1,s[4:7],s60 offen
v_smfmac_f32_16x16x64_bf16 v[40:43],v[28:31],a[184:191],v2
v_smfmac_f32_16x16x64_bf16 v[44:47],v[28:31],v[120:127],v2
v_smfmac_f32_16x16x64_bf16 v[48:51],v[24:27],v[64:71],v2
s_nop 1
v_add_f32 v32,v32,v34
v_add_f32 v33,v33,v35
v_add_f32 v36,v36,v38
s_add_u32 s60,s42,14336
buffer_load_dwordx4 v[108:111],v1,s[4:7],s60 offen offset:1024
v_smfmac_f32_16x16x64_bf16 v[52:55],v[24:27],v[96:103],v2
v_add_f32 v37,v37,v39
v_mul_f32 v32,s35,v32
v_mul_f32 v33,s35,v33
v_smfmac_f32_16x16x64_bf16 v[48:51],v[28:31],v[128:135],v2
v_mul_f32 v36,s35,v36
v_mul_f32 v37,s35,v37
v_cvt_pk_bf16_f32 v14,v32,v36
v_smfmac_f32_16x16x64_bf16 v[52:55],v[28:31],v[136:143],v2
v_cvt_pk_bf16_f32 v15,v33,v37
ds_write_b32 v4,v14
ds_write_b32 v4,v15 offset:16
s_add_u32 s60,s42,16384
buffer_load_dwordx4 v[64:67],v1,s[4:7],s60 offen
s_add_u32 s43,s43,786432
v_add_f32 v40,v40,v42
v_add_f32 v41,v41,v43
v_add_f32 v44,v44,v46
v_add_f32 v45,v45,v47
v_cvt_pk_bf16_f32 v16,v40,v44
v_cvt_pk_bf16_f32 v17,v41,v45
ds_write_b32 v4,v16 offset:2048
ds_write_b32 v4,v17 offset:2064
v_pk_add_f32 v[48:49],v[48:49],v[50:51]
v_pk_add_f32 v[52:53],v[52:53],v[54:55]
v_cvt_pk_bf16_f32 v48,v48,v49
v_mov_b32 v49,0
v_cvt_pk_bf16_f32 v52,v52,v53
v_mov_b32 v53,0
ds_write_b32 v13,v48
ds_write_b32 v13,v52 offset:128
s_add_u32 s60,s42,16384
buffer_load_dwordx4 v[68:71],v1,s[4:7],s60 offen offset:1024
s_add_u32 s60,s42,18432
buffer_load_dwordx4 v[96:99],v1,s[4:7],s60 offen
s_waitcnt lgkmcnt(0)
s_barrier
s_cmp_ge_u32 s28,63
s_cbranch_scc1 ch_fin_75
ds_read_b128 v[32:35],v5 offset:10240
ds_read_b128 v[72:75],v6
ds_read_b128 v[36:39],v5 offset:10752
ds_read_b128 v[76:79],v6 offset:512
ds_read_b128 v[40:43],v5 offset:11264
ds_read_b128 v[80:83],v6 offset:1024
ds_read_b128 v[44:47],v5 offset:11776
ds_read_b128 v[84:87],v6 offset:1536
s_add_u32 s60,s42,18432
buffer_load_dwordx4 v[100:103],v1,s[4:7],s60 offen offset:1024
s_waitcnt lgkmcnt(6)
v_mfma_f32_16x16x32_bf16 v[24:27],v[72:75],v[32:35],0
s_waitcnt lgkmcnt(4)
v_mfma_f32_16x16x32_bf16 v[24:27],v[76:79],v[36:39],v[24:27]
s_waitcnt lgkmcnt(2)
v_mfma_f32_16x16x32_bf16 v[24:27],v[80:83],v[40:43],v[24:27]
s_waitcnt lgkmcnt(0)
v_mfma_f32_16x16x32_bf16 v[24:27],v[84:87],v[44:47],v[24:27]
s_nop 7
ds_write_b128 v5,v[24:27] offset:1024
s_add_u32 s60,s42,20480
buffer_load_dwordx4 v[72:75],v1,s[4:7],s60 offen
s_add_u32 s60,s42,20480
buffer_load_dwordx4 v[76:79],v1,s[4:7],s60 offen offset:1024
s_waitcnt lgkmcnt(0)
s_barrier
ds_read_b128 v[32:35],v5
ds_read_b128 v[36:39],v5 offset:512
ds_read_b64 v[40:41],v5 offset:1024
s_add_u32 s60,s42,22528
buffer_load_dwordx4 v[80:83],v1,s[4:7],s60 offen
s_add_u32 s60,s42,22528
buffer_load_dwordx4 v[84:87],v1,s[4:7],s60 offen offset:1024
s_waitcnt lgkmcnt(0)
v_max3_f32 v14,v32,v33,v34
v_max3_f32 v15,v35,v36,v37
v_max3_f32 v16,v38,v39,v40
v_max3_f32 v15,v14,v15,v41
v_mov_b32 v29,0
v_max_f32 v14,v15,v16
v_max_f32 v15,v15,v16
s_nop 1
v_permlane32_swap_b32 v14,v15
s_nop 0
v_max_f32 v16,v14,v15
v_max_f32 v14,v14,v15
s_nop 1
v_permlane16_swap_b32 v14,v16
s_nop 0
v_max_f32 v14,v14,v16
v_pk_add_f32 v[40:41],v[40:41],v[14:15] op_sel_hi:[1,0] neg_lo:[0,1] neg_hi:[0,1]
v_pk_add_f32 v[32:33],v[32:33],v[14:15] op_sel_hi:[1,0] neg_lo:[0,1] neg_hi:[0,1]
v_pk_add_f32 v[34:35],v[34:35],v[14:15] op_sel_hi:[1,0] neg_lo:[0,1] neg_hi:[0,1]
v_pk_add_f32 v[36:37],v[36:37],v[14:15] op_sel_hi:[1,0] neg_lo:[0,1] neg_hi:[0,1]
v_pk_add_f32 v[38:39],v[38:39],v[14:15] op_sel_hi:[1,0] neg_lo:[0,1] neg_hi:[0,1]
v_exp_f32 v40,v40
v_exp_f32 v41,v41
v_exp_f32 v32,v32
v_cvt_pk_bf16_f32 v28,v40,v41
v_add_f32 v14,v40,v41
v_exp_f32 v33,v33
v_mfma_f32_16x16x16_bf16 v[40:43],v[48:49],v[28:29],0
v_exp_f32 v34,v34
v_mfma_f32_16x16x16_bf16 v[44:47],v[52:53],v[28:29],0
v_exp_f32 v35,v35
v_exp_f32 v36,v36
v_exp_f32 v37,v37
v_exp_f32 v38,v38
v_exp_f32 v39,v39
v_cvt_pk_bf16_f32 v24,v32,v33
v_cvt_pk_bf16_f32 v25,v34,v35
v_cvt_pk_bf16_f32 v26,v36,v37
v_cvt_pk_bf16_f32 v27,v38,v39
s_waitcnt vmcnt(12)
v_pk_add_f32 v[32:33],v[32:33],v[34:35]
v_pk_add_f32 v[36:37],v[36:37],v[38:39]
v_mfma_f32_16x16x32_bf16 v[40:43],v[88:91],v[24:27],v[40:43]
v_add_f32 v32,v32,v36
v_add_f32 v33,v33,v37
v_mfma_f32_16x16x32_bf16 v[44:47],v[92:95],v[24:27],v[44:47]
v_add_f32 v32,v32,v14
v_add_f32 v14,v32,v33
v_add_f32 v15,v32,v33
v_mov_b32 v88,0
v_mov_b32 v89,0
v_permlane32_swap_b32 v14,v15
v_mov_b32 v90,0
v_add_f32 v16,v14,v15
v_add_f32 v14,v14,v15
v_mov_b32 v91,0
v_mov_b32 v92,0
v_permlane16_swap_b32 v14,v16
v_mov_b32 v93,0
v_add_f32 v14,v14,v16
v_rcp_f32 v14,v14
v_mov_b32 v94,0
v_mov_b32 v95,0
v_pk_mul_f32 v[40:41],v[40:41],v[14:15] op_sel_hi:[1,0]
v_pk_mul_f32 v[42:43],v[42:43],v[14:15] op_sel_hi:[1,0]
v_pk_mul_f32 v[44:45],v[44:45],v[14:15] op_sel_hi:[1,0]
v_pk_mul_f32 v[46:47],v[46:47],v[14:15] op_sel_hi:[1,0]
v_cvt_pk_bf16_f32 v16,v40,v41
v_cvt_pk_bf16_f32 v17,v42,v43
v_cvt_pk_bf16_f32 v18,v44,v45
v_cvt_pk_bf16_f32 v19,v46,v47
ds_write_b128 v7,v[16:19]
s_and_b32 s48,s28,1
s_mov_b64 vcc,s[22:23]
v_mov_b64 v[32:33],0
v_mov_b64 v[34:35],0
v_mov_b64 v[36:37],0
v_mov_b64 v[38:39],0
v_mov_b64 v[40:41],0
v_mov_b64 v[42:43],0
v_mov_b64 v[44:45],0
v_mov_b64 v[46:47],0
v_mov_b64 v[48:49],0
v_mov_b64 v[50:51],0
s_waitcnt lgkmcnt(0)
s_barrier
ds_read_b128 v[24:27],v1 offset:10240
ds_read_b128 v[28:31],v1 offset:11264
v_mov_b64 v[52:53],0
v_mov_b64 v[54:55],0
v_mov_b64 v[16:17],0
v_mov_b64 v[18:19],0
s_waitcnt lgkmcnt(0)
s_waitcnt vmcnt(10)
v_smfmac_f32_16x16x64_bf16 v[32:35],v[24:27],v[56:63],v2
s_waitcnt vmcnt(8)
v_smfmac_f32_16x16x64_bf16 v[32:35],v[28:31],v[104:111],v2
buffer_load_dword v11,v12,s[4:7],s20 offen sc1
buffer_load_dwordx2 v[20:21],off,s[4:7],s36 sc1
s_waitcnt vmcnt(8)
v_smfmac_f32_16x16x64_bf16 v[36:39],v[24:27],v[64:71],v2
s_waitcnt vmcnt(6)
v_smfmac_f32_16x16x64_bf16 v[36:39],v[28:31],v[96:103],v2
v_smfmac_f32_16x16x64_bf16 v[40:43],v[24:27],v[144:151],v2
s_add_u32 s60,s42,2048
buffer_load_dwordx4 v[104:107],v1,s[4:7],s60 offen
v_add_f32 v32,v32,v34
v_add_f32 v33,v33,v35
v_smfmac_f32_16x16x64_bf16 v[40:43],v[28:31],v[152:159],v2
v_smfmac_f32_16x16x64_bf16 v[44:47],v[24:27],v[160:167],v2
s_nop 0
v_add_f32 v36,v36,v38
v_add_f32 v37,v37,v39
v_cvt_pk_bf16_f32 v38,v32,v36
v_smfmac_f32_16x16x64_bf16 v[44:47],v[28:31],v[168:175],v2
s_add_u32 s60,s42,2048
buffer_load_dwordx4 v[108:111],v1,s[4:7],s60 offen offset:1024
v_cvt_pk_bf16_f32 v39,v33,v37
v_bfi_b32 v38,1,s48,v38
v_bfi_b32 v39,1,s48,v39
v_smfmac_f32_16x16x64_bf16 v[48:51],v[24:27],v[176:183],v2
s_nop 0
v_cndmask_b32_dpp v36,v39,v38,vcc quad_perm:[1,0,3,2] row_mask:0xf bank_mask:0xf
s_not_b64 vcc,vcc
v_cndmask_b32_dpp v37,v38,v39,vcc quad_perm:[1,0,3,2] row_mask:0xf bank_mask:0xf
v_smfmac_f32_16x16x64_bf16 v[48:51],v[28:31],v[184:191],v2
buffer_store_dwordx2 v[36:37],v10,s[4:7],s65 offen
v_add_f32 v40,v40,v42
v_add_f32 v41,v41,v43
v_smfmac_f32_16x16x64_bf16 v[52:55],v[24:27],v[192:199],v2
v_add_f32 v44,v44,v46
v_add_f32 v45,v45,v47
v_cvt_pk_bf16_f32 v32,v40,v44
v_smfmac_f32_16x16x64_bf16 v[52:55],v[28:31],v[200:207],v2
s_add_u32 s60,s42,0
buffer_load_dwordx4 v[96:99],v1,s[4:7],s60 offen
v_cvt_pk_bf16_f32 v34,v41,v45
v_bfi_b32 v32,1,s48,v32
v_bfi_b32 v34,1,s48,v34
v_smfmac_f32_16x16x64_bf16 v[88:91],v[24:27],v[208:215],v2
v_mov_b64 v[40:41],0
v_mov_b64 v[42:43],0
v_add_f32 v48,v48,v50
v_smfmac_f32_16x16x64_bf16 v[88:91],v[28:31],v[216:223],v2
v_add_f32 v49,v49,v51
v_smfmac_f32_16x16x64_bf16 v[92:95],v[24:27],v[224:231],v2
s_add_u32 s60,s42,0
buffer_load_dwordx4 v[100:103],v1,s[4:7],s60 offen offset:1024
v_add_f32 v52,v52,v54
v_add_f32 v53,v53,v55
v_cvt_pk_bf16_f32 v33,v48,v52
v_smfmac_f32_16x16x64_bf16 v[92:95],v[28:31],v[232:239],v2
v_cvt_pk_bf16_f32 v35,v49,v53
v_bfi_b32 v33,1,s48,v33
v_bfi_b32 v35,1,s48,v35
v_smfmac_f32_16x16x64_bf16 v[16:19],v[24:27],v[240:247],v2
buffer_store_dwordx4 v[32:35],v9,s[4:7],s64 offen
v_add_f32 v88,v88,v90
v_add_f32 v89,v89,v91
v_smfmac_f32_16x16x64_bf16 v[16:19],v[28:31],v[248:255],v2
s_waitcnt vmcnt(10)
v_smfmac_f32_16x16x64_bf16 v[40:43],v[24:27],v[72:79],v2
v_add_f32 v92,v92,v94
v_add_f32 v93,v93,v95
v_cvt_pk_bf16_f32 v44,v88,v92
s_waitcnt vmcnt(8)
v_smfmac_f32_16x16x64_bf16 v[40:43],v[28:31],v[80:87],v2
v_cvt_pk_bf16_f32 v46,v89,v93
v_bfi_b32 v44,1,s48,v44
v_bfi_b32 v46,1,s48,v46
v_add_f32 v16,v16,v18
v_add_f32 v17,v17,v19
s_nop 2
v_add_f32 v40,v40,v42
v_add_f32 v41,v41,v43
v_cvt_pk_bf16_f32 v45,v16,v40
v_cvt_pk_bf16_f32 v47,v17,v41
v_bfi_b32 v45,1,s48,v45
v_bfi_b32 v47,1,s48,v47
buffer_store_dwordx4 v[44:47],v9,s[4:7],s63 offen
s_nop 0
s_branch ch_hop_76
ch_mf_78:
s_add_u32 s38,s38,1
s_cmp_lt_u32 s38,100000
s_cbranch_scc1 ch_m_77
s_mov_b32 s40,10
s_branch L_fail
ch_kf_73:
s_add_u32 s60,s28,0
s_mul_i32 s59,s60,43
s_lshr_b32 s59,s59,7
s_mul_i32 s59,s59,3
s_sub_u32 s59,s60,s59
s_min_u32 s101,s60,42
s_sub_u32 s101,s101,33
s_and_b32 s101,s101,1
s_cmp_lt_u32 s60,33
s_cselect_b32 s60,s59,s101
s_cmp_eq_u32 s39,0
s_cselect_b32 s60,s60,0
s_lshl_b32 s60,s60,2
s_mov_b32 s38,0
poll_81:
buffer_load_dword v15,v12,s[4:7],s60 offen sc1
s_waitcnt vmcnt(0)
v_cmp_le_u32 vcc,s31,v15
s_nop 0
s_cmp_eq_u64 vcc,-1
s_nop 1
s_cbranch_scc1 polld_82
s_add_u32 s38,s38,1
s_cmp_lt_u32 s38,100000
s_cbranch_scc1 poll_81
s_mov_b32 s40,8
s_branch L_fail
polld_82:
v_mbcnt_lo_u32_b32 v14,-1,0
v_and_b32 v14,1,v14
v_lshlrev_b32 v14,2,v14
s_sub_i32 s60,s31,6
s_max_i32 s60,s60,0
s_mov_b32 s38,0
poll_83:
buffer_load_dword v15,v14,s[4:7],s36 offen sc1
s_waitcnt vmcnt(0)
v_cmp_le_u32 vcc,s60,v15
s_nop 0
s_cmp_eq_u64 vcc,-1
s_nop 1
s_cbranch_scc1 polld_84
s_sleep 2
s_add_u32 s38,s38,1
s_cmp_lt_u32 s38,100000
s_cbranch_scc1 poll_83
s_mov_b32 s40,8
s_branch L_fail
polld_84:
s_branch ch_ok_72
ch_kf_80:
s_add_u32 s60,s28,0
s_mul_i32 s59,s60,43
s_lshr_b32 s59,s59,7
s_mul_i32 s59,s59,3
s_sub_u32 s59,s60,s59
s_min_u32 s101,s60,42
s_sub_u32 s101,s101,33
s_and_b32 s101,s101,1
s_cmp_lt_u32 s60,33
s_cselect_b32 s60,s59,s101
s_cmp_eq_u32 s39,0
s_cselect_b32 s60,s60,0
s_lshl_b32 s60,s60,2
s_mov_b32 s38,0
poll_85:
buffer_load_dword v15,v12,s[4:7],s60 offen sc1
s_waitcnt vmcnt(0)
v_cmp_le_u32 vcc,s31,v15
s_nop 0
s_cmp_eq_u64 vcc,-1
s_nop 1
s_cbranch_scc1 polld_86
s_add_u32 s38,s38,1
s_cmp_lt_u32 s38,100000
s_cbranch_scc1 poll_85
s_mov_b32 s40,8
s_branch L_fail
polld_86:
v_mbcnt_lo_u32_b32 v14,-1,0
v_and_b32 v14,1,v14
v_lshlrev_b32 v14,2,v14
s_sub_i32 s60,s31,6
s_max_i32 s60,s60,0
s_mov_b32 s38,0
poll_87:
buffer_load_dword v15,v14,s[4:7],s36 offen sc1
s_waitcnt vmcnt(0)
v_cmp_le_u32 vcc,s60,v15
s_nop 0
s_cmp_eq_u64 vcc,-1
s_nop 1
s_cbranch_scc1 polld_88
s_sleep 2
s_add_u32 s38,s38,1
s_cmp_lt_u32 s38,100000
s_cbranch_scc1 poll_87
s_mov_b32 s40,8
s_branch L_fail
polld_88:
s_branch ch_ok_79
ch_end_68:
ch_fin_75:
s_branch L_end
CH_3_0:
v_and_b32 v14,15,v0
v_lshrrev_b32 v15,4,v0
v_bfe_u32 v16,v0,1,1
v_mul_u32_u24 v2,0xaaaa,v16
v_add_u32 v2,0x4444,v2
v_add_u32 v3,110592,v1
v_add_u32 v1,147456,v1
v_lshrrev_b32 v17,3,v14
v_lshlrev_b32 v4,8,v17
v_lshl_add_u32 v4,v16,7,v4
v_lshl_add_u32 v4,v15,5,v4
v_and_b32 v18,1,v0
v_lshl_add_u32 v4,v18,2,v4
v_bfe_u32 v19,v0,2,1
v_lshl_add_u32 v4,v19,3,v4
v_add_u32 v4,159232,v4
v_and_b32 v5,7,v0
v_lshlrev_b32 v5,4,v5
v_lshl_add_u32 v5,v15,7,v5
v_add_u32 v5,147456,v5
v_lshrrev_b32 v6,2,v14
v_lshl_add_u32 v6,v6,1,v18
v_lshlrev_b32 v6,4,v6
v_lshl_add_u32 v6,v15,7,v6
v_add_u32 v6,159744,v6
v_bfe_u32 v7,v0,1,2
v_lshl_add_u32 v7,v7,2,v18
v_bfe_u32 v8,v0,4,1
v_lshl_add_u32 v7,v8,1,v7
v_lshrrev_b32 v13,5,v0
v_lshl_add_u32 v7,v13,4,v7
v_lshlrev_b32 v7,4,v7
v_add_u32 v7,159232,v7
v_lshlrev_b32 v13,8,v13
v_lshl_add_u32 v13,v14,3,v13
v_lshl_add_u32 v13,v8,2,v13
v_add_u32 v13,163328,v13
v_lshlrev_b32 v8,4,v14
v_lshl_add_u32 v8,v15,9,v8
v_add_u32 v8,137216,v8
v_lshlrev_b32 v9,14,v15
v_lshl_add_u32 v9,v14,4,v9
v_add_u32 v9,393216,v9
v_lshrrev_b32 v10,5,v0
v_lshlrev_b32 v10,14,v10
v_and_b32 v32,31,v0
v_lshl_add_u32 v10,v32,3,v10
v_add_u32 v10,98304,v10
s_mul_i32 s60,s39,0x48000
s_add_u32 s60,s60,0x18010
s_lshl_b32 s101,s39,13
s_xor_b32 s101,s101,s99
s_xor_b32 s101,s101,8192
s_add_u32 s60,s60,s101
s_lshl_b32 s61,s41,8
s_add_u32 s60,s60,s61
v_lshlrev_b32 v12,7,v18
v_lshl_add_u32 v12,v16,4,v12
v_add_u32 v12,s60,v12
s_mul_i32 s37,s39,0x48000
s_add_u32 s37,s37,0x20000
s_lshl_b32 s101,s39,13
s_xor_b32 s101,s101,s99
s_xor_b32 s101,s101,8192
s_add_u32 s37,s37,s101
s_lshl_b32 s61,s41,7
s_add_u32 s37,s37,s61
s_mul_i32 s43,s39,0x3000000
s_add_u32 s43,s43,0x7ad0000
s_lshr_b32 s61,s41,4
s_lshl_b32 s61,s61,18
s_add_u32 s43,s43,s61
s_lshl_b32 s61,s41,13
s_add_u32 s43,s43,s61
s_mul_i32 s44,s39,0x0
s_add_u32 s44,s44,0x3dc000
s_lshl_b32 s101,s39,13
s_xor_b32 s101,s101,s99
s_xor_b32 s101,s101,8192
s_add_u32 s44,s44,s101
s_lshr_b32 s61,s41,1
s_lshl_b32 s61,s61,14
s_add_u32 s44,s44,s61
s_and_b32 s61,s41,1
s_lshl_b32 s61,s61,12
s_add_u32 s44,s44,s61
s_sub_u32 s42,s42,147456
s_lshl_b32 s98,s39,13
s_xor_b32 s98,s98,s99
s_xor_b32 s98,s98,8192
s_mul_i32 s45,s39,0x0
s_add_u32 s45,s45,0x100000
s_add_u32 s45,s45,s98
s_lshl_b32 s61,s41,14
s_add_u32 s32,s45,s61
s_sub_u32 s32,s32,147456
s_lshl_b32 s61,s41,8
s_add_u32 s45,s45,s61
s_mul_i32 s46,s39,0x0
s_add_u32 s46,s46,0x180000
s_add_u32 s46,s46,s98
s_and_b32 s61,s41,7
s_lshl_b32 s61,s61,14
s_add_u32 s33,s46,s61
s_sub_u32 s33,s33,147456
s_lshl_b32 s61,s41,8
s_add_u32 s46,s46,s61
s_mov_b32 s24,s4
s_mov_b32 s25,s5
s_mov_b32 s27,0x20000
s_cmp_lt_u32 s41,8
s_cselect_b32 s26,s6,0
s_mov_b32 s26,0
s_mov_b32 s22,0x55555555
s_mov_b32 s23,0x55555555
s_mul_i32 s34,s39,0x0
s_add_u32 s34,s34,0x1a0000
s_add_u32 s34,s34,s98
s_add_u32 s36,s37,32768
s_mov_b32 s35,0x3e0293ee
s_mov_b32 s28,0
s_mov_b32 s66,s32
s_mov_b32 s67,s33
s_mov_b32 s64,s45
s_mov_b32 s65,s46
s_add_u32 s63,s64,0x10000
s_mov_b32 s49,s34
s_add_u32 s69,s34,0x8000
ds_read_b128 v[56:59],v3
ds_read_b128 v[60:63],v3 offset:1024
ds_read_b128 v[64:67],v3 offset:2048
ds_read_b128 v[68:71],v3 offset:3072
s_cmp_eq_u32 s39,0
s_cbranch_scc1 ch_nw_91
s_add_u32 s60,s42,0
buffer_load_dwordx4 v[32:35],v1,s[4:7],s60 offen
s_add_u32 s60,s42,1024
buffer_load_dwordx4 v[32:35],v1,s[4:7],s60 offen
s_add_u32 s60,s42,2048
buffer_load_dwordx4 v[32:35],v1,s[4:7],s60 offen
s_add_u32 s60,s42,3072
buffer_load_dwordx4 v[32:35],v1,s[4:7],s60 offen
s_add_u32 s60,s42,4096
buffer_load_dwordx4 v[32:35],v1,s[4:7],s60 offen
s_add_u32 s60,s42,5120
buffer_load_dwordx4 v[32:35],v1,s[4:7],s60 offen
s_add_u32 s60,s42,6144
buffer_load_dwordx4 v[32:35],v1,s[4:7],s60 offen
s_add_u32 s60,s42,7168
buffer_load_dwordx4 v[32:35],v1,s[4:7],s60 offen
s_add_u32 s60,s42,8192
buffer_load_dwordx4 v[32:35],v1,s[4:7],s60 offen
s_add_u32 s60,s42,9216
buffer_load_dwordx4 v[32:35],v1,s[4:7],s60 offen
s_add_u32 s60,s42,10240
buffer_load_dwordx4 v[32:35],v1,s[4:7],s60 offen
s_add_u32 s60,s42,11264
buffer_load_dwordx4 v[32:35],v1,s[4:7],s60 offen
s_add_u32 s60,s42,12288
buffer_load_dwordx4 v[32:35],v1,s[4:7],s60 offen
s_add_u32 s60,s42,13312
buffer_load_dwordx4 v[32:35],v1,s[4:7],s60 offen
s_add_u32 s60,s42,14336
buffer_load_dwordx4 v[32:35],v1,s[4:7],s60 offen
s_add_u32 s60,s42,15360
buffer_load_dwordx4 v[32:35],v1,s[4:7],s60 offen
s_add_u32 s60,s42,16384
buffer_load_dwordx4 v[32:35],v1,s[4:7],s60 offen
s_add_u32 s60,s42,17408
buffer_load_dwordx4 v[32:35],v1,s[4:7],s60 offen
s_add_u32 s60,s42,18432
buffer_load_dwordx4 v[32:35],v1,s[4:7],s60 offen
s_add_u32 s60,s42,19456
buffer_load_dwordx4 v[32:35],v1,s[4:7],s60 offen
s_add_u32 s60,s42,20480
buffer_load_dwordx4 v[32:35],v1,s[4:7],s60 offen
s_add_u32 s60,s42,21504
buffer_load_dwordx4 v[32:35],v1,s[4:7],s60 offen
s_add_u32 s60,s42,22528
buffer_load_dwordx4 v[32:35],v1,s[4:7],s60 offen
s_add_u32 s60,s42,23552
buffer_load_dwordx4 v[32:35],v1,s[4:7],s60 offen
s_waitcnt vmcnt(0) lgkmcnt(0)
s_getpc_b64 s[60:61]
pc_92:
s_add_u32 s60,s60,ch_beg_90-pc_92
s_addc_u32 s61,s61,0
s_mov_b32 s59,ch_end_89-ch_beg_90-4
v_lshlrev_b32 v38,7,v0
v_add_u32 v38,0,v38
v_min_u32 v38,s59,v38
v_mov_b32 v37,s61
v_add_co_u32 v36,vcc,s60,v38
s_nop 1
v_addc_co_u32 v37,vcc,0,v37,vcc
global_load_dword v39,v[36:37],off
s_waitcnt vmcnt(0)
s_waitcnt vmcnt(0)
s_nop 1
ch_nw_91:
v_lshl_add_u32 v24,v15,1,v16
v_lshlrev_b32 v24,4,v24
v_lshl_add_u32 v24,v18,7,v24
v_lshlrev_b32 v25,6,v19
v_xor_b32 v24,v24,v25
v_bfe_u32 v25,v0,2,2
v_lshl_add_u32 v24,v25,8,v24
v_add_u32 v0,147456,v24
s_mov_b32 s21,0
s_mov_b32 s20,0
v_mov_b64 v[32:33],0
v_mov_b64 v[34:35],0
v_mov_b64 v[36:37],0
v_mov_b64 v[38:39],0
v_mov_b64 v[40:41],0
v_mov_b64 v[42:43],0
v_mov_b64 v[44:45],0
v_mov_b64 v[46:47],0
v_mov_b64 v[48:49],0
v_mov_b64 v[50:51],0
v_mov_b64 v[52:53],0
v_mov_b64 v[54:55],0
s_nop 0
s_branch ch_top_93
ch_beg_90:
ch_hop_95:
ds_read_b128 v[56:59],v3
ds_read_b128 v[60:63],v3 offset:1024
ds_read_b128 v[64:67],v3 offset:2048
ds_read_b128 v[68:71],v3 offset:3072
s_add_u32 s60,s42,4096
buffer_load_dwordx4 v[72:75],v1,s[4:7],s60 offen
s_add_u32 s60,s42,4096
buffer_load_dwordx4 v[76:79],v1,s[4:7],s60 offen offset:1024
s_add_u32 s60,s42,6144
buffer_load_dwordx4 v[80:83],v1,s[4:7],s60 offen
s_add_u32 s60,s42,6144
buffer_load_dwordx4 v[84:87],v1,s[4:7],s60 offen offset:1024
s_add_u32 s60,s42,8192
buffer_load_dwordx4 v[88:91],v1,s[4:7],s60 offen
s_add_u32 s60,s42,8192
buffer_load_dwordx4 v[92:95],v1,s[4:7],s60 offen offset:1024
s_add_u32 s28,s28,1
s_and_b32 s60,s28,3
s_lshl_b32 s60,s60,15
s_add_u32 s47,s34,s60
s_xor_b32 s60,s60,0x10000
s_add_u32 s49,s34,s60
s_mov_b32 s38,0
s_add_u32 s68,s47,-143360
s_add_u32 s69,s47,-131072
v_mov_b64 v[36:37],0
v_mov_b64 v[38:39],0
v_mov_b64 v[40:41],0
v_mov_b64 v[42:43],0
v_mov_b64 v[44:45],0
v_mov_b64 v[46:47],0
v_mov_b64 v[48:49],0
v_mov_b64 v[50:51],0
v_mov_b64 v[52:53],0
v_mov_b64 v[54:55],0
s_waitcnt lgkmcnt(0)
s_barrier
s_sleep 7
ch_m_96:
buffer_load_dwordx4 v[32:35],v1,s[4:7],s68 offen offset:1024 sc1
buffer_load_dwordx4 v[28:31],v1,s[4:7],s68 offen offset:2048 sc1
buffer_load_dwordx4 v[24:27],v1,s[4:7],s68 offen offset:3072 sc1
buffer_load_dwordx4 v[20:23],v1,s[4:7],s69 offen sc1
buffer_load_dwordx4 v[16:19],v1,s[4:7],s69 offen offset:1024 sc1
s_waitcnt vmcnt(4)
ds_write_b128 v1,v[32:35] offset:5120
v_max3_u32 v14,v32,v33,v34
v_max_u32 v14,v14,v35
s_waitcnt vmcnt(3)
ds_write_b128 v1,v[28:31] offset:6144
v_max3_u32 v14,v14,v28,v29
v_max3_u32 v14,v14,v30,v31
s_waitcnt vmcnt(2)
ds_write_b128 v1,v[24:27] offset:7168
v_max3_u32 v14,v14,v24,v25
v_max3_u32 v14,v14,v26,v27
s_waitcnt vmcnt(1)
ds_write_b128 v1,v[20:23] offset:8192
v_max3_u32 v14,v14,v20,v21
v_max3_u32 v14,v14,v22,v23
s_waitcnt vmcnt(0)
ds_write_b128 v1,v[16:19] offset:9216
v_max3_u32 v14,v14,v16,v17
v_max3_u32 v14,v14,v18,v19
v_cmp_eq_u32 vcc,-1,v14
s_cbranch_vccnz ch_mf_97
ch_top_93:
v_mov_b64 v[32:33],0
v_mov_b64 v[34:35],0
s_waitcnt lgkmcnt(0)
s_barrier
ds_read_b128 v[24:27],v0
ds_read_b128 v[28:31],v0 offset:1024
s_add_u32 s61,s43,4096
s_waitcnt lgkmcnt(1)
v_smfmac_f32_16x16x64_bf16 v[32:35],v[24:27],v[96:103],v2
ds_read_b128 v[96:99],v3 offset:4096
v_smfmac_f32_16x16x64_bf16 v[36:39],v[24:27],v[104:111],v2
ds_read_b128 v[100:103],v3 offset:5120
s_add_u32 s60,s42,10240
buffer_load_dwordx4 v[104:107],v1,s[4:7],s60 offen
v_smfmac_f32_16x16x64_bf16 v[48:51],v[24:27],v[56:63],v2
ds_read_b128 v[56:59],v3 offset:6144
v_smfmac_f32_16x16x64_bf16 v[40:43],v[24:27],a[120:127],v2
ds_read_b128 v[60:63],v3 offset:7168
s_add_u32 s60,s42,10240
buffer_load_dwordx4 v[108:111],v1,s[4:7],s60 offen offset:1024
v_smfmac_f32_16x16x64_bf16 v[44:47],v[24:27],a[192:199],v2
v_smfmac_f32_16x16x64_bf16 v[52:55],v[24:27],v[64:71],v2
ds_read_b128 v[24:27],v0 offset:2048
s_waitcnt lgkmcnt(5)
v_smfmac_f32_16x16x64_bf16 v[32:35],v[28:31],v[72:79],v2
ds_read_b128 v[64:67],v3 offset:8192
v_smfmac_f32_16x16x64_bf16 v[36:39],v[28:31],v[80:87],v2
ds_read_b128 v[68:71],v3 offset:9216
s_waitcnt lgkmcnt(5)
v_smfmac_f32_16x16x64_bf16 v[48:51],v[28:31],v[96:103],v2
ds_read_b128 v[96:99],v3 offset:10240
v_smfmac_f32_16x16x64_bf16 v[40:43],v[28:31],v[88:95],v2
ds_read_b128 v[100:103],v3 offset:11264
buffer_load_dwordx4 v[88:91],v8,s[4:7],s43 offen sc1 nt
v_smfmac_f32_16x16x64_bf16 v[44:47],v[28:31],a[200:207],v2
s_waitcnt lgkmcnt(5)
v_smfmac_f32_16x16x64_bf16 v[52:55],v[28:31],v[56:63],v2
ds_read_b128 v[28:31],v0 offset:3072
s_waitcnt lgkmcnt(5)
v_smfmac_f32_16x16x64_bf16 v[32:35],v[24:27],a[0:7],v2
ds_read_b128 v[56:59],v3 offset:12288
buffer_load_dwordx4 v[92:95],v8,s[4:7],s43 offen offset:256 sc1 nt
v_smfmac_f32_16x16x64_bf16 v[36:39],v[24:27],a[56:63],v2
ds_read_b128 v[60:63],v3 offset:13312
s_waitcnt lgkmcnt(5)
v_smfmac_f32_16x16x64_bf16 v[48:51],v[24:27],v[64:71],v2
ds_read_b128 v[64:67],v3 offset:14336
v_smfmac_f32_16x16x64_bf16 v[40:43],v[24:27],a[128:135],v2
ds_read_b128 v[68:71],v3 offset:15360
v_smfmac_f32_16x16x64_bf16 v[44:47],v[24:27],a[208:215],v2
s_waitcnt lgkmcnt(5)
v_smfmac_f32_16x16x64_bf16 v[52:55],v[24:27],v[96:103],v2
ds_read_b128 v[24:27],v0 offset:4096
s_waitcnt lgkmcnt(5)
v_smfmac_f32_16x16x64_bf16 v[32:35],v[28:31],a[8:15],v2
ds_read_b128 v[96:99],v3 offset:16384
v_smfmac_f32_16x16x64_bf16 v[36:39],v[28:31],a[64:71],v2
ds_read_b128 v[100:103],v3 offset:17408
s_waitcnt lgkmcnt(5)
v_smfmac_f32_16x16x64_bf16 v[48:51],v[28:31],v[56:63],v2
ds_read_b128 v[56:59],v3 offset:18432
v_smfmac_f32_16x16x64_bf16 v[40:43],v[28:31],a[136:143],v2
ds_read_b128 v[60:63],v3 offset:19456
v_smfmac_f32_16x16x64_bf16 v[44:47],v[28:31],a[216:223],v2
s_waitcnt lgkmcnt(5)
v_smfmac_f32_16x16x64_bf16 v[52:55],v[28:31],v[64:71],v2
ds_read_b128 v[28:31],v0 offset:5120
s_waitcnt lgkmcnt(5)
v_smfmac_f32_16x16x64_bf16 v[32:35],v[24:27],a[16:23],v2
ds_read_b128 v[64:67],v3 offset:20480
v_smfmac_f32_16x16x64_bf16 v[36:39],v[24:27],a[72:79],v2
ds_read_b128 v[68:71],v3 offset:21504
s_waitcnt lgkmcnt(5)
v_smfmac_f32_16x16x64_bf16 v[48:51],v[24:27],v[96:103],v2
ds_read_b128 v[96:99],v3 offset:22528
v_smfmac_f32_16x16x64_bf16 v[40:43],v[24:27],a[144:151],v2
ds_read_b128 v[100:103],v3 offset:23552
v_smfmac_f32_16x16x64_bf16 v[44:47],v[24:27],a[224:231],v2
s_waitcnt lgkmcnt(5)
v_smfmac_f32_16x16x64_bf16 v[52:55],v[24:27],v[56:63],v2
ds_read_b128 v[24:27],v0 offset:6144
s_waitcnt lgkmcnt(5)
v_smfmac_f32_16x16x64_bf16 v[32:35],v[28:31],a[24:31],v2
ds_read_b128 v[56:59],v3 offset:24576
v_smfmac_f32_16x16x64_bf16 v[36:39],v[28:31],a[80:87],v2
ds_read_b128 v[60:63],v3 offset:25600
s_waitcnt lgkmcnt(5)
v_smfmac_f32_16x16x64_bf16 v[48:51],v[28:31],v[64:71],v2
ds_read_b128 v[64:67],v3 offset:26624
v_smfmac_f32_16x16x64_bf16 v[40:43],v[28:31],a[152:159],v2
ds_read_b128 v[68:71],v3 offset:27648
v_smfmac_f32_16x16x64_bf16 v[44:47],v[28:31],a[232:239],v2
s_waitcnt lgkmcnt(5)
v_smfmac_f32_16x16x64_bf16 v[52:55],v[28:31],v[96:103],v2
ds_read_b128 v[28:31],v0 offset:7168
s_waitcnt lgkmcnt(5)
v_smfmac_f32_16x16x64_bf16 v[32:35],v[24:27],a[32:39],v2
ds_read_b128 v[96:99],v3 offset:28672
v_smfmac_f32_16x16x64_bf16 v[36:39],v[24:27],a[88:95],v2
ds_read_b128 v[100:103],v3 offset:29696
s_waitcnt lgkmcnt(5)
v_smfmac_f32_16x16x64_bf16 v[48:51],v[24:27],v[56:63],v2
ds_read_b128 v[56:59],v3 offset:30720
v_smfmac_f32_16x16x64_bf16 v[40:43],v[24:27],a[160:167],v2
ds_read_b128 v[60:63],v3 offset:31744
v_smfmac_f32_16x16x64_bf16 v[44:47],v[24:27],a[240:247],v2
s_waitcnt lgkmcnt(5)
v_smfmac_f32_16x16x64_bf16 v[52:55],v[24:27],v[64:71],v2
ds_read_b128 v[24:27],v0 offset:8192
s_waitcnt lgkmcnt(5)
v_smfmac_f32_16x16x64_bf16 v[32:35],v[28:31],a[40:47],v2
ds_read_b128 v[64:67],v3 offset:32768
v_smfmac_f32_16x16x64_bf16 v[36:39],v[28:31],a[96:103],v2
ds_read_b128 v[68:71],v3 offset:33792
s_waitcnt lgkmcnt(5)
v_smfmac_f32_16x16x64_bf16 v[48:51],v[28:31],v[96:103],v2
ds_read_b128 v[96:99],v3 offset:34816
v_smfmac_f32_16x16x64_bf16 v[40:43],v[28:31],a[168:175],v2
ds_read_b128 v[100:103],v3 offset:35840
v_smfmac_f32_16x16x64_bf16 v[44:47],v[28:31],a[248:255],v2
s_waitcnt lgkmcnt(5)
v_smfmac_f32_16x16x64_bf16 v[52:55],v[28:31],v[56:63],v2
ds_read_b128 v[28:31],v0 offset:9216
s_add_u32 s60,s42,12288
buffer_load_dwordx4 v[56:59],v1,s[4:7],s60 offen
s_waitcnt lgkmcnt(5)
s_waitcnt vmcnt(3)
v_smfmac_f32_16x16x64_bf16 v[32:35],v[24:27],v[104:111],v2
v_smfmac_f32_16x16x64_bf16 v[36:39],v[24:27],a[104:111],v2
v_smfmac_f32_16x16x64_bf16 v[40:43],v[24:27],a[176:183],v2
s_add_u32 s60,s42,12288
buffer_load_dwordx4 v[60:63],v1,s[4:7],s60 offen offset:1024
v_smfmac_f32_16x16x64_bf16 v[44:47],v[24:27],v[112:119],v2
s_waitcnt lgkmcnt(0)
v_smfmac_f32_16x16x64_bf16 v[32:35],v[28:31],a[48:55],v2
v_smfmac_f32_16x16x64_bf16 v[36:39],v[28:31],a[112:119],v2
s_add_u32 s60,s42,14336
buffer_load_dwordx4 v[104:107],v1,s[4:7],s60 offen
v_smfmac_f32_16x16x64_bf16 v[40:43],v[28:31],a[184:191],v2
v_smfmac_f32_16x16x64_bf16 v[44:47],v[28:31],v[120:127],v2
v_smfmac_f32_16x16x64_bf16 v[48:51],v[24:27],v[64:71],v2
s_nop 1
v_add_f32 v32,v32,v34
v_add_f32 v33,v33,v35
v_add_f32 v36,v36,v38
s_add_u32 s60,s42,14336
buffer_load_dwordx4 v[108:111],v1,s[4:7],s60 offen offset:1024
v_smfmac_f32_16x16x64_bf16 v[52:55],v[24:27],v[96:103],v2
v_add_f32 v37,v37,v39
v_mul_f32 v32,s35,v32
v_mul_f32 v33,s35,v33
v_smfmac_f32_16x16x64_bf16 v[48:51],v[28:31],v[128:135],v2
v_mul_f32 v36,s35,v36
v_mul_f32 v37,s35,v37
v_cvt_pk_bf16_f32 v14,v32,v36
v_smfmac_f32_16x16x64_bf16 v[52:55],v[28:31],v[136:143],v2
v_cvt_pk_bf16_f32 v15,v33,v37
ds_write_b32 v4,v14
ds_write_b32 v4,v15 offset:16
s_add_u32 s60,s42,16384
buffer_load_dwordx4 v[64:67],v1,s[4:7],s60 offen
s_add_u32 s43,s43,786432
v_add_f32 v40,v40,v42
v_add_f32 v41,v41,v43
v_add_f32 v44,v44,v46
v_add_f32 v45,v45,v47
v_cvt_pk_bf16_f32 v16,v40,v44
v_cvt_pk_bf16_f32 v17,v41,v45
ds_write_b32 v4,v16 offset:2048
ds_write_b32 v4,v17 offset:2064
v_pk_add_f32 v[48:49],v[48:49],v[50:51]
v_pk_add_f32 v[52:53],v[52:53],v[54:55]
v_cvt_pk_bf16_f32 v48,v48,v49
v_mov_b32 v49,0
v_cvt_pk_bf16_f32 v52,v52,v53
v_mov_b32 v53,0
ds_write_b32 v13,v48
ds_write_b32 v13,v52 offset:128
s_add_u32 s60,s42,16384
buffer_load_dwordx4 v[68:71],v1,s[4:7],s60 offen offset:1024
s_add_u32 s60,s42,18432
buffer_load_dwordx4 v[96:99],v1,s[4:7],s60 offen
s_waitcnt lgkmcnt(0)
s_barrier
ds_read_b128 v[72:75],v1 offset:12288
ds_read_b128 v[76:79],v1 offset:13312
ds_read_b128 v[80:83],v1 offset:14336
ds_read_b128 v[84:87],v1 offset:15360
s_add_u32 s60,s42,18432
buffer_load_dwordx4 v[100:103],v1,s[4:7],s60 offen offset:1024
s_and_b32 s62,s28,7
s_mul_i32 s62,s62,262144
s_add_u32 s62,s62,s44
s_waitcnt lgkmcnt(3)
v_min_u32 v72,-2,v72
v_min_u32 v73,-2,v73
v_min_u32 v74,-2,v74
v_min_u32 v75,-2,v75
buffer_store_dwordx4 v[72:75],v1,s[4:7],s62 offen sc1
s_waitcnt lgkmcnt(2)
v_min_u32 v76,-2,v76
v_min_u32 v77,-2,v77
v_min_u32 v78,-2,v78
v_min_u32 v79,-2,v79
buffer_store_dwordx4 v[76:79],v1,s[4:7],s62 offen offset:1024 sc1
s_waitcnt lgkmcnt(1)
v_min_u32 v80,-2,v80
v_min_u32 v81,-2,v81
v_min_u32 v82,-2,v82
v_min_u32 v83,-2,v83
buffer_store_dwordx4 v[80:83],v1,s[4:7],s62 offen offset:2048 sc1
s_waitcnt lgkmcnt(0)
v_min_u32 v84,-2,v84
v_min_u32 v85,-2,v85
v_min_u32 v86,-2,v86
v_min_u32 v87,-2,v87
buffer_store_dwordx4 v[84:87],v1,s[4:7],s62 offen offset:3072 sc1
s_add_u32 s62,s28,1
v_mov_b32 v14,s62
s_mov_b64 exec,1
buffer_store_dword v14,off,s[4:7],s37 sc1
s_mov_b64 exec,-1
s_cmp_ge_u32 s28,63
s_cbranch_scc1 ch_fin_94
s_add_u32 s60,s42,20480
buffer_load_dwordx4 v[72:75],v1,s[4:7],s60 offen
s_add_u32 s60,s42,20480
buffer_load_dwordx4 v[76:79],v1,s[4:7],s60 offen offset:1024
s_waitcnt lgkmcnt(0)
s_barrier
ds_read_b128 v[32:35],v5
ds_read_b128 v[36:39],v5 offset:512
ds_read_b64 v[40:41],v5 offset:1024
s_add_u32 s60,s42,22528
buffer_load_dwordx4 v[80:83],v1,s[4:7],s60 offen
s_add_u32 s60,s42,22528
buffer_load_dwordx4 v[84:87],v1,s[4:7],s60 offen offset:1024
s_waitcnt lgkmcnt(0)
v_max3_f32 v14,v32,v33,v34
v_max3_f32 v15,v35,v36,v37
v_max3_f32 v16,v38,v39,v40
v_max3_f32 v15,v14,v15,v41
v_mov_b32 v29,0
v_max_f32 v14,v15,v16
v_max_f32 v15,v15,v16
s_nop 1
v_permlane32_swap_b32 v14,v15
s_nop 0
v_max_f32 v16,v14,v15
v_max_f32 v14,v14,v15
s_nop 1
v_permlane16_swap_b32 v14,v16
s_nop 0
v_max_f32 v14,v14,v16
v_pk_add_f32 v[40:41],v[40:41],v[14:15] op_sel_hi:[1,0] neg_lo:[0,1] neg_hi:[0,1]
v_pk_add_f32 v[32:33],v[32:33],v[14:15] op_sel_hi:[1,0] neg_lo:[0,1] neg_hi:[0,1]
v_pk_add_f32 v[34:35],v[34:35],v[14:15] op_sel_hi:[1,0] neg_lo:[0,1] neg_hi:[0,1]
v_pk_add_f32 v[36:37],v[36:37],v[14:15] op_sel_hi:[1,0] neg_lo:[0,1] neg_hi:[0,1]
v_pk_add_f32 v[38:39],v[38:39],v[14:15] op_sel_hi:[1,0] neg_lo:[0,1] neg_hi:[0,1]
v_exp_f32 v40,v40
v_exp_f32 v41,v41
v_exp_f32 v32,v32
v_cvt_pk_bf16_f32 v28,v40,v41
v_add_f32 v14,v40,v41
v_exp_f32 v33,v33
v_mfma_f32_16x16x16_bf16 v[40:43],v[48:49],v[28:29],0
v_exp_f32 v34,v34
v_mfma_f32_16x16x16_bf16 v[44:47],v[52:53],v[28:29],0
v_exp_f32 v35,v35
v_exp_f32 v36,v36
v_exp_f32 v37,v37
v_exp_f32 v38,v38
v_exp_f32 v39,v39
v_cvt_pk_bf16_f32 v24,v32,v33
v_cvt_pk_bf16_f32 v25,v34,v35
v_cvt_pk_bf16_f32 v26,v36,v37
v_cvt_pk_bf16_f32 v27,v38,v39
s_waitcnt vmcnt(17)
v_pk_add_f32 v[32:33],v[32:33],v[34:35]
v_pk_add_f32 v[36:37],v[36:37],v[38:39]
v_mfma_f32_16x16x32_bf16 v[40:43],v[88:91],v[24:27],v[40:43]
v_add_f32 v32,v32,v36
v_add_f32 v33,v33,v37
v_mfma_f32_16x16x32_bf16 v[44:47],v[92:95],v[24:27],v[44:47]
v_add_f32 v32,v32,v14
v_add_f32 v14,v32,v33
v_add_f32 v15,v32,v33
v_mov_b32 v88,0
v_mov_b32 v89,0
v_permlane32_swap_b32 v14,v15
v_mov_b32 v90,0
v_add_f32 v16,v14,v15
v_add_f32 v14,v14,v15
v_mov_b32 v91,0
v_mov_b32 v92,0
v_permlane16_swap_b32 v14,v16
v_mov_b32 v93,0
v_add_f32 v14,v14,v16
v_rcp_f32 v14,v14
v_mov_b32 v94,0
v_mov_b32 v95,0
v_pk_mul_f32 v[40:41],v[40:41],v[14:15] op_sel_hi:[1,0]
v_pk_mul_f32 v[42:43],v[42:43],v[14:15] op_sel_hi:[1,0]
v_pk_mul_f32 v[44:45],v[44:45],v[14:15] op_sel_hi:[1,0]
v_pk_mul_f32 v[46:47],v[46:47],v[14:15] op_sel_hi:[1,0]
v_cvt_pk_bf16_f32 v16,v40,v41
v_cvt_pk_bf16_f32 v17,v42,v43
v_cvt_pk_bf16_f32 v18,v44,v45
v_cvt_pk_bf16_f32 v19,v46,v47
ds_write_b128 v7,v[16:19]
s_and_b32 s48,s28,1
s_mov_b64 vcc,s[22:23]
v_mov_b64 v[32:33],0
v_mov_b64 v[34:35],0
v_mov_b64 v[36:37],0
v_mov_b64 v[38:39],0
v_mov_b64 v[40:41],0
v_mov_b64 v[42:43],0
v_mov_b64 v[44:45],0
v_mov_b64 v[46:47],0
v_mov_b64 v[48:49],0
v_mov_b64 v[50:51],0
s_waitcnt lgkmcnt(0)
s_barrier
ds_read_b128 v[24:27],v1 offset:10240
ds_read_b128 v[28:31],v1 offset:11264
v_mov_b64 v[52:53],0
v_mov_b64 v[54:55],0
v_mov_b64 v[16:17],0
v_mov_b64 v[18:19],0
s_waitcnt lgkmcnt(0)
s_waitcnt vmcnt(15)
v_smfmac_f32_16x16x64_bf16 v[32:35],v[24:27],v[56:63],v2
s_waitcnt vmcnt(13)
v_smfmac_f32_16x16x64_bf16 v[32:35],v[28:31],v[104:111],v2
s_waitcnt vmcnt(11)
v_smfmac_f32_16x16x64_bf16 v[36:39],v[24:27],v[64:71],v2
s_waitcnt vmcnt(9)
v_smfmac_f32_16x16x64_bf16 v[36:39],v[28:31],v[96:103],v2
v_smfmac_f32_16x16x64_bf16 v[40:43],v[24:27],v[144:151],v2
s_add_u32 s60,s42,2048
buffer_load_dwordx4 v[104:107],v1,s[4:7],s60 offen
s_nop 0
v_add_f32 v32,v32,v34
v_add_f32 v33,v33,v35
v_smfmac_f32_16x16x64_bf16 v[40:43],v[28:31],v[152:159],v2
v_smfmac_f32_16x16x64_bf16 v[44:47],v[24:27],v[160:167],v2
v_add_f32 v36,v36,v38
v_add_f32 v37,v37,v39
v_cvt_pk_bf16_f32 v38,v32,v36
v_smfmac_f32_16x16x64_bf16 v[44:47],v[28:31],v[168:175],v2
s_add_u32 s60,s42,2048
buffer_load_dwordx4 v[108:111],v1,s[4:7],s60 offen offset:1024
v_cvt_pk_bf16_f32 v39,v33,v37
v_bfi_b32 v38,1,s48,v38
v_bfi_b32 v39,1,s48,v39
v_smfmac_f32_16x16x64_bf16 v[48:51],v[24:27],v[176:183],v2
s_nop 0
v_cndmask_b32_dpp v36,v39,v38,vcc quad_perm:[1,0,3,2] row_mask:0xf bank_mask:0xf
s_not_b64 vcc,vcc
v_cndmask_b32_dpp v37,v38,v39,vcc quad_perm:[1,0,3,2] row_mask:0xf bank_mask:0xf
v_smfmac_f32_16x16x64_bf16 v[48:51],v[28:31],v[184:191],v2
buffer_store_dwordx2 v[36:37],v10,s[4:7],s65 offen sc1
v_add_f32 v40,v40,v42
v_add_f32 v41,v41,v43
v_smfmac_f32_16x16x64_bf16 v[52:55],v[24:27],v[192:199],v2
v_add_f32 v44,v44,v46
v_add_f32 v45,v45,v47
v_cvt_pk_bf16_f32 v32,v40,v44
v_smfmac_f32_16x16x64_bf16 v[52:55],v[28:31],v[200:207],v2
s_add_u32 s60,s42,0
buffer_load_dwordx4 v[96:99],v1,s[4:7],s60 offen
v_cvt_pk_bf16_f32 v34,v41,v45
v_bfi_b32 v32,1,s48,v32
v_bfi_b32 v34,1,s48,v34
v_smfmac_f32_16x16x64_bf16 v[88:91],v[24:27],v[208:215],v2
v_mov_b64 v[40:41],0
v_mov_b64 v[42:43],0
v_add_f32 v48,v48,v50
v_smfmac_f32_16x16x64_bf16 v[88:91],v[28:31],v[216:223],v2
v_add_f32 v49,v49,v51
v_smfmac_f32_16x16x64_bf16 v[92:95],v[24:27],v[224:231],v2
s_add_u32 s60,s42,0
buffer_load_dwordx4 v[100:103],v1,s[4:7],s60 offen offset:1024
v_add_f32 v52,v52,v54
v_add_f32 v53,v53,v55
v_cvt_pk_bf16_f32 v33,v48,v52
v_smfmac_f32_16x16x64_bf16 v[92:95],v[28:31],v[232:239],v2
v_cvt_pk_bf16_f32 v35,v49,v53
v_bfi_b32 v33,1,s48,v33
v_bfi_b32 v35,1,s48,v35
v_smfmac_f32_16x16x64_bf16 v[16:19],v[24:27],v[240:247],v2
buffer_store_dwordx4 v[32:35],v9,s[4:7],s64 offen sc1
v_add_f32 v88,v88,v90
v_add_f32 v89,v89,v91
v_smfmac_f32_16x16x64_bf16 v[16:19],v[28:31],v[248:255],v2
s_waitcnt vmcnt(8)
v_smfmac_f32_16x16x64_bf16 v[40:43],v[24:27],v[72:79],v2
v_add_f32 v92,v92,v94
v_add_f32 v93,v93,v95
v_cvt_pk_bf16_f32 v44,v88,v92
s_waitcnt vmcnt(6)
v_smfmac_f32_16x16x64_bf16 v[40:43],v[28:31],v[80:87],v2
v_cvt_pk_bf16_f32 v46,v89,v93
v_bfi_b32 v44,1,s48,v44
v_bfi_b32 v46,1,s48,v46
v_add_f32 v16,v16,v18
v_add_f32 v17,v17,v19
s_nop 2
v_add_f32 v40,v40,v42
v_add_f32 v41,v41,v43
v_cvt_pk_bf16_f32 v45,v16,v40
v_cvt_pk_bf16_f32 v47,v17,v41
v_bfi_b32 v45,1,s48,v45
v_bfi_b32 v47,1,s48,v47
buffer_store_dwordx4 v[44:47],v9,s[4:7],s63 offen sc1
s_nop 0
s_branch ch_hop_95
ch_mf_97:
s_add_u32 s38,s38,1
s_cmp_lt_u32 s38,100000
s_cbranch_scc1 ch_m_96
s_mov_b32 s40,10
s_branch L_fail
ch_end_89:
ch_fin_94:
s_branch L_end
CH_3_1:
v_and_b32 v14,15,v0
v_lshrrev_b32 v15,4,v0
v_bfe_u32 v16,v0,1,1
v_mul_u32_u24 v2,0xaaaa,v16
v_add_u32 v2,0x4444,v2
v_add_u32 v3,110592,v1
v_add_u32 v1,147456,v1
v_lshrrev_b32 v17,3,v14
v_lshlrev_b32 v4,8,v17
v_lshl_add_u32 v4,v16,7,v4
v_lshl_add_u32 v4,v15,5,v4
v_and_b32 v18,1,v0
v_lshl_add_u32 v4,v18,2,v4
v_bfe_u32 v19,v0,2,1
v_lshl_add_u32 v4,v19,3,v4
v_add_u32 v4,159232,v4
v_and_b32 v5,7,v0
v_lshlrev_b32 v5,4,v5
v_lshl_add_u32 v5,v15,7,v5
v_add_u32 v5,147456,v5
v_lshrrev_b32 v6,2,v14
v_lshl_add_u32 v6,v6,1,v18
v_lshlrev_b32 v6,4,v6
v_lshl_add_u32 v6,v15,7,v6
v_add_u32 v6,159744,v6
v_bfe_u32 v7,v0,1,2
v_lshl_add_u32 v7,v7,2,v18
v_bfe_u32 v8,v0,4,1
v_lshl_add_u32 v7,v8,1,v7
v_lshrrev_b32 v13,5,v0
v_lshl_add_u32 v7,v13,4,v7
v_lshlrev_b32 v7,4,v7
v_add_u32 v7,159232,v7
v_lshlrev_b32 v13,8,v13
v_lshl_add_u32 v13,v14,3,v13
v_lshl_add_u32 v13,v8,2,v13
v_add_u32 v13,163328,v13
v_lshlrev_b32 v8,4,v14
v_lshl_add_u32 v8,v15,9,v8
v_add_u32 v8,137216,v8
v_lshlrev_b32 v9,14,v15
v_lshl_add_u32 v9,v14,4,v9
v_add_u32 v9,393216,v9
v_lshrrev_b32 v10,5,v0
v_lshlrev_b32 v10,14,v10
v_and_b32 v32,31,v0
v_lshl_add_u32 v10,v32,3,v10
v_add_u32 v10,98304,v10
s_mul_i32 s60,s39,0x48000
s_add_u32 s60,s60,0x18010
s_lshl_b32 s101,s39,13
s_xor_b32 s101,s101,s99
s_xor_b32 s101,s101,8192
s_add_u32 s60,s60,s101
s_lshl_b32 s61,s41,8
s_add_u32 s60,s60,s61
v_lshlrev_b32 v12,7,v18
v_lshl_add_u32 v12,v16,4,v12
v_add_u32 v12,s60,v12
s_mul_i32 s37,s39,0x48000
s_add_u32 s37,s37,0x20000
s_lshl_b32 s101,s39,13
s_xor_b32 s101,s101,s99
s_xor_b32 s101,s101,8192
s_add_u32 s37,s37,s101
s_lshl_b32 s61,s41,7
s_add_u32 s37,s37,s61
s_mul_i32 s43,s39,0x3000000
s_add_u32 s43,s43,0x7ad0000
s_lshr_b32 s61,s41,4
s_lshl_b32 s61,s61,18
s_add_u32 s43,s43,s61
s_lshl_b32 s61,s41,13
s_add_u32 s43,s43,s61
s_mul_i32 s44,s39,0x0
s_add_u32 s44,s44,0x3dc000
s_lshl_b32 s101,s39,13
s_xor_b32 s101,s101,s99
s_xor_b32 s101,s101,8192
s_add_u32 s44,s44,s101
s_lshr_b32 s61,s41,1
s_lshl_b32 s61,s61,14
s_add_u32 s44,s44,s61
s_and_b32 s61,s41,1
s_lshl_b32 s61,s61,12
s_add_u32 s44,s44,s61
s_sub_u32 s42,s42,147456
s_lshl_b32 s98,s39,13
s_xor_b32 s98,s98,s99
s_xor_b32 s98,s98,8192
s_mul_i32 s45,s39,0x0
s_add_u32 s45,s45,0x100000
s_add_u32 s45,s45,s98
s_lshl_b32 s61,s41,14
s_add_u32 s32,s45,s61
s_sub_u32 s32,s32,147456
s_lshl_b32 s61,s41,8
s_add_u32 s45,s45,s61
s_mul_i32 s46,s39,0x0
s_add_u32 s46,s46,0x180000
s_add_u32 s46,s46,s98
s_and_b32 s61,s41,7
s_lshl_b32 s61,s61,14
s_add_u32 s33,s46,s61
s_sub_u32 s33,s33,147456
s_lshl_b32 s61,s41,8
s_add_u32 s46,s46,s61
s_mov_b32 s24,s4
s_mov_b32 s25,s5
s_mov_b32 s27,0x20000
s_cmp_lt_u32 s41,8
s_cselect_b32 s26,s6,0
s_mov_b32 s26,0
s_mov_b32 s22,0x55555555
s_mov_b32 s23,0x55555555
s_mul_i32 s34,s39,0x0
s_add_u32 s34,s34,0x1a0000
s_add_u32 s34,s34,s98
s_add_u32 s36,s37,32768
s_mov_b32 s35,0x3e0293ee
s_mov_b32 s28,0
s_mov_b32 s66,s32
s_mov_b32 s67,s33
s_mov_b32 s64,s45
s_mov_b32 s65,s46
s_add_u32 s63,s64,0x10000
s_mov_b32 s49,s34
s_add_u32 s69,s34,0x8000
ds_read_b128 v[56:59],v3
ds_read_b128 v[60:63],v3 offset:1024
ds_read_b128 v[64:67],v3 offset:2048
ds_read_b128 v[68:71],v3 offset:3072
s_cmp_eq_u32 s39,0
s_cbranch_scc1 ch_nw_100
s_add_u32 s60,s42,0
buffer_load_dwordx4 v[32:35],v1,s[4:7],s60 offen
s_add_u32 s60,s42,1024
buffer_load_dwordx4 v[32:35],v1,s[4:7],s60 offen
s_add_u32 s60,s42,2048
buffer_load_dwordx4 v[32:35],v1,s[4:7],s60 offen
s_add_u32 s60,s42,3072
buffer_load_dwordx4 v[32:35],v1,s[4:7],s60 offen
s_add_u32 s60,s42,4096
buffer_load_dwordx4 v[32:35],v1,s[4:7],s60 offen
s_add_u32 s60,s42,5120
buffer_load_dwordx4 v[32:35],v1,s[4:7],s60 offen
s_add_u32 s60,s42,6144
buffer_load_dwordx4 v[32:35],v1,s[4:7],s60 offen
s_add_u32 s60,s42,7168
buffer_load_dwordx4 v[32:35],v1,s[4:7],s60 offen
s_add_u32 s60,s42,8192
buffer_load_dwordx4 v[32:35],v1,s[4:7],s60 offen
s_add_u32 s60,s42,9216
buffer_load_dwordx4 v[32:35],v1,s[4:7],s60 offen
s_add_u32 s60,s42,10240
buffer_load_dwordx4 v[32:35],v1,s[4:7],s60 offen
s_add_u32 s60,s42,11264
buffer_load_dwordx4 v[32:35],v1,s[4:7],s60 offen
s_add_u32 s60,s42,12288
buffer_load_dwordx4 v[32:35],v1,s[4:7],s60 offen
s_add_u32 s60,s42,13312
buffer_load_dwordx4 v[32:35],v1,s[4:7],s60 offen
s_add_u32 s60,s42,14336
buffer_load_dwordx4 v[32:35],v1,s[4:7],s60 offen
s_add_u32 s60,s42,15360
buffer_load_dwordx4 v[32:35],v1,s[4:7],s60 offen
s_add_u32 s60,s42,16384
buffer_load_dwordx4 v[32:35],v1,s[4:7],s60 offen
s_add_u32 s60,s42,17408
buffer_load_dwordx4 v[32:35],v1,s[4:7],s60 offen
s_add_u32 s60,s42,18432
buffer_load_dwordx4 v[32:35],v1,s[4:7],s60 offen
s_add_u32 s60,s42,19456
buffer_load_dwordx4 v[32:35],v1,s[4:7],s60 offen
s_add_u32 s60,s42,20480
buffer_load_dwordx4 v[32:35],v1,s[4:7],s60 offen
s_add_u32 s60,s42,21504
buffer_load_dwordx4 v[32:35],v1,s[4:7],s60 offen
s_add_u32 s60,s42,22528
buffer_load_dwordx4 v[32:35],v1,s[4:7],s60 offen
s_add_u32 s60,s42,23552
buffer_load_dwordx4 v[32:35],v1,s[4:7],s60 offen
s_waitcnt vmcnt(0) lgkmcnt(0)
s_getpc_b64 s[60:61]
pc_101:
s_add_u32 s60,s60,ch_beg_99-pc_101
s_addc_u32 s61,s61,0
s_mov_b32 s59,ch_end_98-ch_beg_99-4
v_lshlrev_b32 v38,7,v0
v_add_u32 v38,0,v38
v_min_u32 v38,s59,v38
v_mov_b32 v37,s61
v_add_co_u32 v36,vcc,s60,v38
s_nop 1
v_addc_co_u32 v37,vcc,0,v37,vcc
global_load_dword v39,v[36:37],off
s_waitcnt vmcnt(0)
s_waitcnt vmcnt(0)
s_nop 1
ch_nw_100:
v_lshl_add_u32 v24,v15,1,v16
v_lshlrev_b32 v24,4,v24
v_lshl_add_u32 v24,v18,7,v24
v_lshlrev_b32 v25,6,v19
v_xor_b32 v24,v24,v25
v_bfe_u32 v25,v0,2,2
v_lshl_add_u32 v24,v25,8,v24
v_add_u32 v0,147456,v24
s_mov_b32 s21,0
s_mov_b32 s20,0
v_mov_b64 v[32:33],0
v_mov_b64 v[34:35],0
v_mov_b64 v[36:37],0
v_mov_b64 v[38:39],0
v_mov_b64 v[40:41],0
v_mov_b64 v[42:43],0
v_mov_b64 v[44:45],0
v_mov_b64 v[46:47],0
v_mov_b64 v[48:49],0
v_mov_b64 v[50:51],0
v_mov_b64 v[52:53],0
v_mov_b64 v[54:55],0
s_nop 0
s_branch ch_top_102
ch_beg_99:
ch_hop_104:
ds_read_b128 v[56:59],v3
ds_read_b128 v[60:63],v3 offset:1024
ds_read_b128 v[64:67],v3 offset:2048
ds_read_b128 v[68:71],v3 offset:3072
s_add_u32 s60,s42,4096
buffer_load_dwordx4 v[72:75],v1,s[4:7],s60 offen
s_add_u32 s60,s42,4096
buffer_load_dwordx4 v[76:79],v1,s[4:7],s60 offen offset:1024
s_add_u32 s60,s42,6144
buffer_load_dwordx4 v[80:83],v1,s[4:7],s60 offen
s_add_u32 s60,s42,6144
buffer_load_dwordx4 v[84:87],v1,s[4:7],s60 offen offset:1024
s_add_u32 s60,s42,8192
buffer_load_dwordx4 v[88:91],v1,s[4:7],s60 offen
s_add_u32 s60,s42,8192
buffer_load_dwordx4 v[92:95],v1,s[4:7],s60 offen offset:1024
s_add_u32 s28,s28,1
s_and_b32 s60,s28,3
s_lshl_b32 s60,s60,15
s_add_u32 s47,s34,s60
s_xor_b32 s60,s60,0x10000
s_add_u32 s49,s34,s60
s_mov_b32 s38,0
s_add_u32 s68,s47,-143360
s_add_u32 s69,s47,-131072
v_mov_b64 v[36:37],0
v_mov_b64 v[38:39],0
v_mov_b64 v[40:41],0
v_mov_b64 v[42:43],0
v_mov_b64 v[44:45],0
v_mov_b64 v[46:47],0
v_mov_b64 v[48:49],0
v_mov_b64 v[50:51],0
v_mov_b64 v[52:53],0
v_mov_b64 v[54:55],0
s_waitcnt lgkmcnt(0)
s_barrier
s_sleep 7
ch_m_105:
buffer_load_dwordx4 v[32:35],v1,s[4:7],s68 offen offset:1024 sc1
buffer_load_dwordx4 v[28:31],v1,s[4:7],s68 offen offset:2048 sc1
buffer_load_dwordx4 v[24:27],v1,s[4:7],s68 offen offset:3072 sc1
buffer_load_dwordx4 v[20:23],v1,s[4:7],s69 offen sc1
buffer_load_dwordx4 v[16:19],v1,s[4:7],s69 offen offset:1024 sc1
s_waitcnt vmcnt(4)
ds_write_b128 v1,v[32:35] offset:5120
v_max3_u32 v14,v32,v33,v34
v_max_u32 v14,v14,v35
s_waitcnt vmcnt(3)
ds_write_b128 v1,v[28:31] offset:6144
v_max3_u32 v14,v14,v28,v29
v_max3_u32 v14,v14,v30,v31
s_waitcnt vmcnt(2)
ds_write_b128 v1,v[24:27] offset:7168
v_max3_u32 v14,v14,v24,v25
v_max3_u32 v14,v14,v26,v27
s_waitcnt vmcnt(1)
ds_write_b128 v1,v[20:23] offset:8192
v_max3_u32 v14,v14,v20,v21
v_max3_u32 v14,v14,v22,v23
s_waitcnt vmcnt(0)
ds_write_b128 v1,v[16:19] offset:9216
v_max3_u32 v14,v14,v16,v17
v_max3_u32 v14,v14,v18,v19
v_cmp_eq_u32 vcc,-1,v14
s_cbranch_vccnz ch_mf_106
ch_top_102:
v_mov_b64 v[32:33],0
v_mov_b64 v[34:35],0
s_waitcnt lgkmcnt(0)
s_barrier
ds_read_b128 v[24:27],v0
ds_read_b128 v[28:31],v0 offset:1024
s_add_u32 s61,s43,4096
s_waitcnt lgkmcnt(1)
v_smfmac_f32_16x16x64_bf16 v[32:35],v[24:27],v[96:103],v2
ds_read_b128 v[96:99],v3 offset:4096
v_smfmac_f32_16x16x64_bf16 v[36:39],v[24:27],v[104:111],v2
ds_read_b128 v[100:103],v3 offset:5120
s_add_u32 s60,s42,10240
buffer_load_dwordx4 v[104:107],v1,s[4:7],s60 offen
v_smfmac_f32_16x16x64_bf16 v[48:51],v[24:27],v[56:63],v2
ds_read_b128 v[56:59],v3 offset:6144
v_smfmac_f32_16x16x64_bf16 v[40:43],v[24:27],a[120:127],v2
ds_read_b128 v[60:63],v3 offset:7168
s_add_u32 s60,s42,10240
buffer_load_dwordx4 v[108:111],v1,s[4:7],s60 offen offset:1024
v_smfmac_f32_16x16x64_bf16 v[44:47],v[24:27],a[192:199],v2
v_smfmac_f32_16x16x64_bf16 v[52:55],v[24:27],v[64:71],v2
ds_read_b128 v[24:27],v0 offset:2048
s_waitcnt lgkmcnt(5)
v_smfmac_f32_16x16x64_bf16 v[32:35],v[28:31],v[72:79],v2
ds_read_b128 v[64:67],v3 offset:8192
v_smfmac_f32_16x16x64_bf16 v[36:39],v[28:31],v[80:87],v2
ds_read_b128 v[68:71],v3 offset:9216
s_waitcnt lgkmcnt(5)
v_smfmac_f32_16x16x64_bf16 v[48:51],v[28:31],v[96:103],v2
ds_read_b128 v[96:99],v3 offset:10240
v_smfmac_f32_16x16x64_bf16 v[40:43],v[28:31],v[88:95],v2
ds_read_b128 v[100:103],v3 offset:11264
buffer_load_dwordx4 v[88:91],v8,s[4:7],s43 offen sc1 nt
v_smfmac_f32_16x16x64_bf16 v[44:47],v[28:31],a[200:207],v2
s_waitcnt lgkmcnt(5)
v_smfmac_f32_16x16x64_bf16 v[52:55],v[28:31],v[56:63],v2
ds_read_b128 v[28:31],v0 offset:3072
s_waitcnt lgkmcnt(5)
v_smfmac_f32_16x16x64_bf16 v[32:35],v[24:27],a[0:7],v2
ds_read_b128 v[56:59],v3 offset:12288
buffer_load_dwordx4 v[92:95],v8,s[4:7],s43 offen offset:256 sc1 nt
v_smfmac_f32_16x16x64_bf16 v[36:39],v[24:27],a[56:63],v2
ds_read_b128 v[60:63],v3 offset:13312
s_waitcnt lgkmcnt(5)
v_smfmac_f32_16x16x64_bf16 v[48:51],v[24:27],v[64:71],v2
ds_read_b128 v[64:67],v3 offset:14336
v_smfmac_f32_16x16x64_bf16 v[40:43],v[24:27],a[128:135],v2
ds_read_b128 v[68:71],v3 offset:15360
v_smfmac_f32_16x16x64_bf16 v[44:47],v[24:27],a[208:215],v2
s_waitcnt lgkmcnt(5)
v_smfmac_f32_16x16x64_bf16 v[52:55],v[24:27],v[96:103],v2
ds_read_b128 v[24:27],v0 offset:4096
s_waitcnt lgkmcnt(5)
v_smfmac_f32_16x16x64_bf16 v[32:35],v[28:31],a[8:15],v2
ds_read_b128 v[96:99],v3 offset:16384
v_smfmac_f32_16x16x64_bf16 v[36:39],v[28:31],a[64:71],v2
ds_read_b128 v[100:103],v3 offset:17408
s_waitcnt lgkmcnt(5)
v_smfmac_f32_16x16x64_bf16 v[48:51],v[28:31],v[56:63],v2
ds_read_b128 v[56:59],v3 offset:18432
v_smfmac_f32_16x16x64_bf16 v[40:43],v[28:31],a[136:143],v2
ds_read_b128 v[60:63],v3 offset:19456
v_smfmac_f32_16x16x64_bf16 v[44:47],v[28:31],a[216:223],v2
s_waitcnt lgkmcnt(5)
v_smfmac_f32_16x16x64_bf16 v[52:55],v[28:31],v[64:71],v2
ds_read_b128 v[28:31],v0 offset:5120
s_waitcnt lgkmcnt(5)
v_smfmac_f32_16x16x64_bf16 v[32:35],v[24:27],a[16:23],v2
ds_read_b128 v[64:67],v3 offset:20480
v_smfmac_f32_16x16x64_bf16 v[36:39],v[24:27],a[72:79],v2
ds_read_b128 v[68:71],v3 offset:21504
s_waitcnt lgkmcnt(5)
v_smfmac_f32_16x16x64_bf16 v[48:51],v[24:27],v[96:103],v2
ds_read_b128 v[96:99],v3 offset:22528
v_smfmac_f32_16x16x64_bf16 v[40:43],v[24:27],a[144:151],v2
ds_read_b128 v[100:103],v3 offset:23552
v_smfmac_f32_16x16x64_bf16 v[44:47],v[24:27],a[224:231],v2
s_waitcnt lgkmcnt(5)
v_smfmac_f32_16x16x64_bf16 v[52:55],v[24:27],v[56:63],v2
ds_read_b128 v[24:27],v0 offset:6144
s_waitcnt lgkmcnt(5)
v_smfmac_f32_16x16x64_bf16 v[32:35],v[28:31],a[24:31],v2
ds_read_b128 v[56:59],v3 offset:24576
v_smfmac_f32_16x16x64_bf16 v[36:39],v[28:31],a[80:87],v2
ds_read_b128 v[60:63],v3 offset:25600
s_waitcnt lgkmcnt(5)
v_smfmac_f32_16x16x64_bf16 v[48:51],v[28:31],v[64:71],v2
ds_read_b128 v[64:67],v3 offset:26624
v_smfmac_f32_16x16x64_bf16 v[40:43],v[28:31],a[152:159],v2
ds_read_b128 v[68:71],v3 offset:27648
v_smfmac_f32_16x16x64_bf16 v[44:47],v[28:31],a[232:239],v2
s_waitcnt lgkmcnt(5)
v_smfmac_f32_16x16x64_bf16 v[52:55],v[28:31],v[96:103],v2
ds_read_b128 v[28:31],v0 offset:7168
s_waitcnt lgkmcnt(5)
v_smfmac_f32_16x16x64_bf16 v[32:35],v[24:27],a[32:39],v2
ds_read_b128 v[96:99],v3 offset:28672
v_smfmac_f32_16x16x64_bf16 v[36:39],v[24:27],a[88:95],v2
ds_read_b128 v[100:103],v3 offset:29696
s_waitcnt lgkmcnt(5)
v_smfmac_f32_16x16x64_bf16 v[48:51],v[24:27],v[56:63],v2
ds_read_b128 v[56:59],v3 offset:30720
v_smfmac_f32_16x16x64_bf16 v[40:43],v[24:27],a[160:167],v2
ds_read_b128 v[60:63],v3 offset:31744
v_smfmac_f32_16x16x64_bf16 v[44:47],v[24:27],a[240:247],v2
s_waitcnt lgkmcnt(5)
v_smfmac_f32_16x16x64_bf16 v[52:55],v[24:27],v[64:71],v2
ds_read_b128 v[24:27],v0 offset:8192
s_waitcnt lgkmcnt(5)
v_smfmac_f32_16x16x64_bf16 v[32:35],v[28:31],a[40:47],v2
ds_read_b128 v[64:67],v3 offset:32768
v_smfmac_f32_16x16x64_bf16 v[36:39],v[28:31],a[96:103],v2
ds_read_b128 v[68:71],v3 offset:33792
s_waitcnt lgkmcnt(5)
v_smfmac_f32_16x16x64_bf16 v[48:51],v[28:31],v[96:103],v2
ds_read_b128 v[96:99],v3 offset:34816
v_smfmac_f32_16x16x64_bf16 v[40:43],v[28:31],a[168:175],v2
ds_read_b128 v[100:103],v3 offset:35840
v_smfmac_f32_16x16x64_bf16 v[44:47],v[28:31],a[248:255],v2
s_waitcnt lgkmcnt(5)
v_smfmac_f32_16x16x64_bf16 v[52:55],v[28:31],v[56:63],v2
ds_read_b128 v[28:31],v0 offset:9216
s_add_u32 s60,s42,12288
buffer_load_dwordx4 v[56:59],v1,s[4:7],s60 offen
s_waitcnt lgkmcnt(5)
s_waitcnt vmcnt(3)
v_smfmac_f32_16x16x64_bf16 v[32:35],v[24:27],v[104:111],v2
v_smfmac_f32_16x16x64_bf16 v[36:39],v[24:27],a[104:111],v2
v_smfmac_f32_16x16x64_bf16 v[40:43],v[24:27],a[176:183],v2
s_add_u32 s60,s42,12288
buffer_load_dwordx4 v[60:63],v1,s[4:7],s60 offen offset:1024
v_smfmac_f32_16x16x64_bf16 v[44:47],v[24:27],v[112:119],v2
s_waitcnt lgkmcnt(0)
v_smfmac_f32_16x16x64_bf16 v[32:35],v[28:31],a[48:55],v2
v_smfmac_f32_16x16x64_bf16 v[36:39],v[28:31],a[112:119],v2
s_add_u32 s60,s42,14336
buffer_load_dwordx4 v[104:107],v1,s[4:7],s60 offen
v_smfmac_f32_16x16x64_bf16 v[40:43],v[28:31],a[184:191],v2
v_smfmac_f32_16x16x64_bf16 v[44:47],v[28:31],v[120:127],v2
v_smfmac_f32_16x16x64_bf16 v[48:51],v[24:27],v[64:71],v2
s_nop 1
v_add_f32 v32,v32,v34
v_add_f32 v33,v33,v35
v_add_f32 v36,v36,v38
s_add_u32 s60,s42,14336
buffer_load_dwordx4 v[108:111],v1,s[4:7],s60 offen offset:1024
v_smfmac_f32_16x16x64_bf16 v[52:55],v[24:27],v[96:103],v2
v_add_f32 v37,v37,v39
v_mul_f32 v32,s35,v32
v_mul_f32 v33,s35,v33
v_smfmac_f32_16x16x64_bf16 v[48:51],v[28:31],v[128:135],v2
v_mul_f32 v36,s35,v36
v_mul_f32 v37,s35,v37
v_cvt_pk_bf16_f32 v14,v32,v36
v_smfmac_f32_16x16x64_bf16 v[52:55],v[28:31],v[136:143],v2
v_cvt_pk_bf16_f32 v15,v33,v37
ds_write_b32 v4,v14
ds_write_b32 v4,v15 offset:16
s_add_u32 s60,s42,16384
buffer_load_dwordx4 v[64:67],v1,s[4:7],s60 offen
s_add_u32 s43,s43,786432
v_add_f32 v40,v40,v42
v_add_f32 v41,v41,v43
v_add_f32 v44,v44,v46
v_add_f32 v45,v45,v47
v_cvt_pk_bf16_f32 v16,v40,v44
v_cvt_pk_bf16_f32 v17,v41,v45
ds_write_b32 v4,v16 offset:2048
ds_write_b32 v4,v17 offset:2064
v_pk_add_f32 v[48:49],v[48:49],v[50:51]
v_pk_add_f32 v[52:53],v[52:53],v[54:55]
v_cvt_pk_bf16_f32 v48,v48,v49
v_mov_b32 v49,0
v_cvt_pk_bf16_f32 v52,v52,v53
v_mov_b32 v53,0
ds_write_b32 v13,v48
ds_write_b32 v13,v52 offset:128
s_add_u32 s60,s42,16384
buffer_load_dwordx4 v[68:71],v1,s[4:7],s60 offen offset:1024
s_add_u32 s60,s42,18432
buffer_load_dwordx4 v[96:99],v1,s[4:7],s60 offen
s_waitcnt lgkmcnt(0)
s_barrier
ds_read_b128 v[72:75],v1 offset:12288
ds_read_b128 v[76:79],v1 offset:13312
ds_read_b128 v[80:83],v1 offset:14336
ds_read_b128 v[84:87],v1 offset:15360
s_add_u32 s60,s42,18432
buffer_load_dwordx4 v[100:103],v1,s[4:7],s60 offen offset:1024
s_and_b32 s62,s28,7
s_mul_i32 s62,s62,262144
s_add_u32 s62,s62,s44
s_waitcnt lgkmcnt(3)
v_min_u32 v72,-2,v72
v_min_u32 v73,-2,v73
v_min_u32 v74,-2,v74
v_min_u32 v75,-2,v75
buffer_store_dwordx4 v[72:75],v1,s[4:7],s62 offen sc1
s_waitcnt lgkmcnt(2)
v_min_u32 v76,-2,v76
v_min_u32 v77,-2,v77
v_min_u32 v78,-2,v78
v_min_u32 v79,-2,v79
buffer_store_dwordx4 v[76:79],v1,s[4:7],s62 offen offset:1024 sc1
s_waitcnt lgkmcnt(1)
v_min_u32 v80,-2,v80
v_min_u32 v81,-2,v81
v_min_u32 v82,-2,v82
v_min_u32 v83,-2,v83
buffer_store_dwordx4 v[80:83],v1,s[4:7],s62 offen offset:2048 sc1
s_waitcnt lgkmcnt(0)
v_min_u32 v84,-2,v84
v_min_u32 v85,-2,v85
v_min_u32 v86,-2,v86
v_min_u32 v87,-2,v87
buffer_store_dwordx4 v[84:87],v1,s[4:7],s62 offen offset:3072 sc1
s_add_u32 s62,s28,1
v_mov_b32 v14,s62
s_mov_b64 exec,1
buffer_store_dword v14,off,s[4:7],s37 sc1
s_mov_b64 exec,-1
s_cmp_ge_u32 s28,63
s_cbranch_scc1 ch_fin_103
s_add_u32 s60,s42,20480
buffer_load_dwordx4 v[72:75],v1,s[4:7],s60 offen
s_add_u32 s60,s42,20480
buffer_load_dwordx4 v[76:79],v1,s[4:7],s60 offen offset:1024
s_waitcnt lgkmcnt(0)
s_barrier
ds_read_b128 v[32:35],v5
ds_read_b128 v[36:39],v5 offset:512
ds_read_b64 v[40:41],v5 offset:1024
s_add_u32 s60,s42,22528
buffer_load_dwordx4 v[80:83],v1,s[4:7],s60 offen
s_add_u32 s60,s42,22528
buffer_load_dwordx4 v[84:87],v1,s[4:7],s60 offen offset:1024
s_waitcnt lgkmcnt(0)
v_max3_f32 v14,v32,v33,v34
v_max3_f32 v15,v35,v36,v37
v_max3_f32 v16,v38,v39,v40
v_max3_f32 v15,v14,v15,v41
v_mov_b32 v29,0
v_max_f32 v14,v15,v16
v_max_f32 v15,v15,v16
s_nop 1
v_permlane32_swap_b32 v14,v15
s_nop 0
v_max_f32 v16,v14,v15
v_max_f32 v14,v14,v15
s_nop 1
v_permlane16_swap_b32 v14,v16
s_nop 0
v_max_f32 v14,v14,v16
v_pk_add_f32 v[40:41],v[40:41],v[14:15] op_sel_hi:[1,0] neg_lo:[0,1] neg_hi:[0,1]
v_pk_add_f32 v[32:33],v[32:33],v[14:15] op_sel_hi:[1,0] neg_lo:[0,1] neg_hi:[0,1]
v_pk_add_f32 v[34:35],v[34:35],v[14:15] op_sel_hi:[1,0] neg_lo:[0,1] neg_hi:[0,1]
v_pk_add_f32 v[36:37],v[36:37],v[14:15] op_sel_hi:[1,0] neg_lo:[0,1] neg_hi:[0,1]
v_pk_add_f32 v[38:39],v[38:39],v[14:15] op_sel_hi:[1,0] neg_lo:[0,1] neg_hi:[0,1]
v_exp_f32 v40,v40
v_exp_f32 v41,v41
v_exp_f32 v32,v32
v_cvt_pk_bf16_f32 v28,v40,v41
v_add_f32 v14,v40,v41
v_exp_f32 v33,v33
v_mfma_f32_16x16x16_bf16 v[40:43],v[48:49],v[28:29],0
v_exp_f32 v34,v34
v_mfma_f32_16x16x16_bf16 v[44:47],v[52:53],v[28:29],0
v_exp_f32 v35,v35
v_exp_f32 v36,v36
v_exp_f32 v37,v37
v_exp_f32 v38,v38
v_exp_f32 v39,v39
v_cvt_pk_bf16_f32 v24,v32,v33
v_cvt_pk_bf16_f32 v25,v34,v35
v_cvt_pk_bf16_f32 v26,v36,v37
v_cvt_pk_bf16_f32 v27,v38,v39
s_waitcnt vmcnt(17)
v_pk_add_f32 v[32:33],v[32:33],v[34:35]
v_pk_add_f32 v[36:37],v[36:37],v[38:39]
v_mfma_f32_16x16x32_bf16 v[40:43],v[88:91],v[24:27],v[40:43]
v_add_f32 v32,v32,v36
v_add_f32 v33,v33,v37
v_mfma_f32_16x16x32_bf16 v[44:47],v[92:95],v[24:27],v[44:47]
v_add_f32 v32,v32,v14
v_add_f32 v14,v32,v33
v_add_f32 v15,v32,v33
v_mov_b32 v88,0
v_mov_b32 v89,0
v_permlane32_swap_b32 v14,v15
v_mov_b32 v90,0
v_add_f32 v16,v14,v15
v_add_f32 v14,v14,v15
v_mov_b32 v91,0
v_mov_b32 v92,0
v_permlane16_swap_b32 v14,v16
v_mov_b32 v93,0
v_add_f32 v14,v14,v16
v_rcp_f32 v14,v14
v_mov_b32 v94,0
v_mov_b32 v95,0
v_pk_mul_f32 v[40:41],v[40:41],v[14:15] op_sel_hi:[1,0]
v_pk_mul_f32 v[42:43],v[42:43],v[14:15] op_sel_hi:[1,0]
v_pk_mul_f32 v[44:45],v[44:45],v[14:15] op_sel_hi:[1,0]
v_pk_mul_f32 v[46:47],v[46:47],v[14:15] op_sel_hi:[1,0]
v_cvt_pk_bf16_f32 v16,v40,v41
v_cvt_pk_bf16_f32 v17,v42,v43
v_cvt_pk_bf16_f32 v18,v44,v45
v_cvt_pk_bf16_f32 v19,v46,v47
ds_write_b128 v7,v[16:19]
s_and_b32 s48,s28,1
s_mov_b64 vcc,s[22:23]
v_mov_b64 v[32:33],0
v_mov_b64 v[34:35],0
v_mov_b64 v[36:37],0
v_mov_b64 v[38:39],0
v_mov_b64 v[40:41],0
v_mov_b64 v[42:43],0
v_mov_b64 v[44:45],0
v_mov_b64 v[46:47],0
v_mov_b64 v[48:49],0
v_mov_b64 v[50:51],0
s_waitcnt lgkmcnt(0)
s_barrier
ds_read_b128 v[24:27],v1 offset:10240
ds_read_b128 v[28:31],v1 offset:11264
v_mov_b64 v[52:53],0
v_mov_b64 v[54:55],0
v_mov_b64 v[16:17],0
v_mov_b64 v[18:19],0
s_waitcnt lgkmcnt(0)
s_waitcnt vmcnt(15)
v_smfmac_f32_16x16x64_bf16 v[32:35],v[24:27],v[56:63],v2
s_waitcnt vmcnt(13)
v_smfmac_f32_16x16x64_bf16 v[32:35],v[28:31],v[104:111],v2
s_waitcnt vmcnt(11)
v_smfmac_f32_16x16x64_bf16 v[36:39],v[24:27],v[64:71],v2
s_waitcnt vmcnt(9)
v_smfmac_f32_16x16x64_bf16 v[36:39],v[28:31],v[96:103],v2
v_smfmac_f32_16x16x64_bf16 v[40:43],v[24:27],v[144:151],v2
s_add_u32 s60,s42,2048
buffer_load_dwordx4 v[104:107],v1,s[4:7],s60 offen
s_nop 0
v_add_f32 v32,v32,v34
v_add_f32 v33,v33,v35
v_smfmac_f32_16x16x64_bf16 v[40:43],v[28:31],v[152:159],v2
v_smfmac_f32_16x16x64_bf16 v[44:47],v[24:27],v[160:167],v2
v_add_f32 v36,v36,v38
v_add_f32 v37,v37,v39
v_cvt_pk_bf16_f32 v38,v32,v36
v_smfmac_f32_16x16x64_bf16 v[44:47],v[28:31],v[168:175],v2
s_add_u32 s60,s42,2048
buffer_load_dwordx4 v[108:111],v1,s[4:7],s60 offen offset:1024
v_cvt_pk_bf16_f32 v39,v33,v37
v_bfi_b32 v38,1,s48,v38
v_bfi_b32 v39,1,s48,v39
v_smfmac_f32_16x16x64_bf16 v[48:51],v[24:27],v[176:183],v2
s_nop 0
v_cndmask_b32_dpp v36,v39,v38,vcc quad_perm:[1,0,3,2] row_mask:0xf bank_mask:0xf
s_not_b64 vcc,vcc
v_cndmask_b32_dpp v37,v38,v39,vcc quad_perm:[1,0,3,2] row_mask:0xf bank_mask:0xf
v_smfmac_f32_16x16x64_bf16 v[48:51],v[28:31],v[184:191],v2
buffer_store_dwordx2 v[36:37],v10,s[4:7],s65 offen
v_add_f32 v40,v40,v42
v_add_f32 v41,v41,v43
v_smfmac_f32_16x16x64_bf16 v[52:55],v[24:27],v[192:199],v2
v_add_f32 v44,v44,v46
v_add_f32 v45,v45,v47
v_cvt_pk_bf16_f32 v32,v40,v44
v_smfmac_f32_16x16x64_bf16 v[52:55],v[28:31],v[200:207],v2
s_add_u32 s60,s42,0
buffer_load_dwordx4 v[96:99],v1,s[4:7],s60 offen
v_cvt_pk_bf16_f32 v34,v41,v45
v_bfi_b32 v32,1,s48,v32
v_bfi_b32 v34,1,s48,v34
v_smfmac_f32_16x16x64_bf16 v[88:91],v[24:27],v[208:215],v2
v_mov_b64 v[40:41],0
v_mov_b64 v[42:43],0
v_add_f32 v48,v48,v50
v_smfmac_f32_16x16x64_bf16 v[88:91],v[28:31],v[216:223],v2
v_add_f32 v49,v49,v51
v_smfmac_f32_16x16x64_bf16 v[92:95],v[24:27],v[224:231],v2
s_add_u32 s60,s42,0
buffer_load_dwordx4 v[100:103],v1,s[4:7],s60 offen offset:1024
v_add_f32 v52,v52,v54
v_add_f32 v53,v53,v55
v_cvt_pk_bf16_f32 v33,v48,v52
v_smfmac_f32_16x16x64_bf16 v[92:95],v[28:31],v[232:239],v2
v_cvt_pk_bf16_f32 v35,v49,v53
v_bfi_b32 v33,1,s48,v33
v_bfi_b32 v35,1,s48,v35
v_smfmac_f32_16x16x64_bf16 v[16:19],v[24:27],v[240:247],v2
buffer_store_dwordx4 v[32:35],v9,s[4:7],s64 offen
v_add_f32 v88,v88,v90
v_add_f32 v89,v89,v91
v_smfmac_f32_16x16x64_bf16 v[16:19],v[28:31],v[248:255],v2
s_waitcnt vmcnt(8)
v_smfmac_f32_16x16x64_bf16 v[40:43],v[24:27],v[72:79],v2
v_add_f32 v92,v92,v94
v_add_f32 v93,v93,v95
v_cvt_pk_bf16_f32 v44,v88,v92
s_waitcnt vmcnt(6)
v_smfmac_f32_16x16x64_bf16 v[40:43],v[28:31],v[80:87],v2
v_cvt_pk_bf16_f32 v46,v89,v93
v_bfi_b32 v44,1,s48,v44
v_bfi_b32 v46,1,s48,v46
v_add_f32 v16,v16,v18
v_add_f32 v17,v17,v19
s_nop 2
v_add_f32 v40,v40,v42
v_add_f32 v41,v41,v43
v_cvt_pk_bf16_f32 v45,v16,v40
v_cvt_pk_bf16_f32 v47,v17,v41
v_bfi_b32 v45,1,s48,v45
v_bfi_b32 v47,1,s48,v47
buffer_store_dwordx4 v[44:47],v9,s[4:7],s63 offen
s_nop 0
s_branch ch_hop_104
ch_mf_106:
s_add_u32 s38,s38,1
s_cmp_lt_u32 s38,100000
s_cbranch_scc1 ch_m_105
s_mov_b32 s40,10
s_branch L_fail
ch_end_98:
ch_fin_103:
s_branch L_end
L_fail:
s_lshl_b32 s42,s2,8
s_or_b32 s42,s42,s40
s_lshl_b32 s43,s28,16
s_or_b32 s42,s42,s43
s_lshl_b32 s43,s40,4
s_add_u32 s43,s43,12
s_mov_b64 exec,-1
v_mov_b32 v1,s42
v_mov_b32 v2,0
buffer_store_dword v1,v2,s[12:15],s43 offen
s_nop 0
L_end:
s_endpgm
.globl interleave_layers__memory_aug_recurrent_mem_tr__mixer_s_mlp__prompt_kernel
.p2align 8
.type interleave_layers__memory_aug_recurrent_mem_tr__mixer_s_mlp__prompt_kernel,@function
interleave_layers__memory_aug_recurrent_mem_tr__mixer_s_mlp__prompt_kernel:
s_cmp_ge_u32 s2,256
s_cbranch_scc1 L_end
s_load_dwordx2 s[20:21],s[0:1],112
s_load_dwordx2 s[22:23],s[0:1],96
s_load_dwordx2 s[24:25],s[0:1],104
s_load_dwordx2 s[26:27],s[0:1],8
v_lshrrev_b32 v1,6,v0
v_and_b32 v0,63,v0
v_readfirstlane_b32 s3,v1
s_getreg_b32 s41,hwreg(HW_REG_XCC_ID)
s_and_b32 s41,s41,7
s_lshl_b32 s41,s41,2
s_lshr_b32 s41,0x67314520,s41
s_and_b32 s41,s41,7
s_waitcnt lgkmcnt(0)
s_mov_b32 s4,s20
s_and_b32 s5,s21,0xffff
s_mov_b32 s6,0x10000000
s_mov_b32 s7,0x20000
s_mov_b32 s8,s22
s_and_b32 s9,s23,0xffff
s_mov_b32 s10,0x280000
s_mov_b32 s11,0x20000
s_mov_b32 s12,s24
s_and_b32 s13,s25,0xffff
s_mov_b32 s14,0x100
s_mov_b32 s15,0x20000
s_mov_b32 s16,s26
s_and_b32 s17,s27,0xffff
s_mov_b32 s18,0x2800
s_mov_b32 s19,0x20000
s_mov_b32 s28,0
v_mov_b32 v4,163824
s_cmp_lg_u32 s3,0
s_cbranch_scc1 claimed_107
s_min_u32 s42,s41,1
s_lshl_b32 s42,s42,3
s_add_u32 s42,s42,s41
s_lshl_b32 s42,s42,4
v_mov_b32 v2,1
v_mov_b32 v3,0
s_mov_b64 exec,1
buffer_atomic_add v2,v3,s[12:15],s42 offen sc0 sc1
s_waitcnt vmcnt(0)
s_mov_b64 exec,-1
v_readfirstlane_b32 s43,v2
s_lshl_b32 s44,s41,5
s_add_u32 s44,s44,s43
s_cmp_lt_u32 s43,32
s_nop 0
s_cbranch_scc1 got_108
v_mov_b32 v2,1
s_mov_b64 exec,1
s_mov_b32 s42,128
buffer_atomic_add v2,v3,s[12:15],s42 offen sc0 sc1
s_waitcnt vmcnt(0)
s_mov_b64 exec,-1
v_readfirstlane_b32 s43,v2
v_and_b32 v3,7,v0
v_min_u32 v2,1,v3
v_lshl_add_u32 v3,v2,3,v3
v_lshlrev_b32 v3,4,v3
s_mov_b32 s38,0
s_nop 0
reg_109:
buffer_load_dword v2,v3,s[12:15],0 offen sc1
s_waitcnt vmcnt(0)
v_readlane_b32 s50,v2,0
v_readlane_b32 s51,v2,1
v_readlane_b32 s52,v2,2
v_readlane_b32 s53,v2,3
v_readlane_b32 s54,v2,4
v_readlane_b32 s55,v2,5
v_readlane_b32 s56,v2,6
v_readlane_b32 s57,v2,7
s_add_u32 s59,s50,s51
s_add_u32 s59,s59,s52
s_add_u32 s59,s59,s53
s_add_u32 s59,s59,s54
s_add_u32 s59,s59,s55
s_add_u32 s59,s59,s56
s_add_u32 s59,s59,s57
s_cmp_ge_u32 s59,256
s_cbranch_scc1 regd_110
s_sleep 2
s_add_u32 s38,s38,1
s_cmp_lt_u32 s38,100000
s_cbranch_scc1 reg_109
s_mov_b32 s40,15
s_branch L_fail
regd_110:
s_mov_b32 s44,999
s_min_u32 s45,s50,32
s_sub_u32 s46,32,s45
s_add_u32 s45,s45,s43
s_add_u32 s45,s45,0
s_cmp_lt_u32 s43,s46
s_cselect_b32 s44,s45,s44
s_sub_u32 s43,s43,s46
s_min_u32 s45,s51,32
s_sub_u32 s46,32,s45
s_add_u32 s45,s45,s43
s_add_u32 s45,s45,32
s_cmp_lt_u32 s43,s46
s_cselect_b32 s44,s45,s44
s_sub_u32 s43,s43,s46
s_min_u32 s45,s52,32
s_sub_u32 s46,32,s45
s_add_u32 s45,s45,s43
s_add_u32 s45,s45,64
s_cmp_lt_u32 s43,s46
s_cselect_b32 s44,s45,s44
s_sub_u32 s43,s43,s46
s_min_u32 s45,s53,32
s_sub_u32 s46,32,s45
s_add_u32 s45,s45,s43
s_add_u32 s45,s45,96
s_cmp_lt_u32 s43,s46
s_cselect_b32 s44,s45,s44
s_sub_u32 s43,s43,s46
s_min_u32 s45,s54,32
s_sub_u32 s46,32,s45
s_add_u32 s45,s45,s43
s_add_u32 s45,s45,128
s_cmp_lt_u32 s43,s46
s_cselect_b32 s44,s45,s44
s_sub_u32 s43,s43,s46
s_min_u32 s45,s55,32
s_sub_u32 s46,32,s45
s_add_u32 s45,s45,s43
s_add_u32 s45,s45,160
s_cmp_lt_u32 s43,s46
s_cselect_b32 s44,s45,s44
s_sub_u32 s43,s43,s46
s_min_u32 s45,s56,32
s_sub_u32 s46,32,s45
s_add_u32 s45,s45,s43
s_add_u32 s45,s45,192
s_cmp_lt_u32 s43,s46
s_cselect_b32 s44,s45,s44
s_sub_u32 s43,s43,s46
s_min_u32 s45,s57,32
s_sub_u32 s46,32,s45
s_add_u32 s45,s45,s43
s_add_u32 s45,s45,224
s_cmp_lt_u32 s43,s46
s_cselect_b32 s44,s45,s44
s_sub_u32 s43,s43,s46
got_108:
v_mov_b32 v2,s44
ds_write_b32 v4,v2
s_waitcnt lgkmcnt(0)
claimed_107:
s_barrier
ds_read_b32 v2,v4
s_waitcnt lgkmcnt(0)
v_readfirstlane_b32 s2,v2
s_barrier
s_cmp_ge_u32 s2,256
s_nop 1
s_cbranch_scc1 L_end
s_cmp_lt_u32 s2,32
s_cbranch_scc1 R_chain
s_cmp_ge_u32 s2,64
s_cbranch_scc1 wk_111
s_sub_u32 s42,s2,32
L_init:
s_load_dwordx2 s[20:21],s[0:1],0
s_lshl_b32 s41,s42,2
s_add_u32 s41,s41,s3
v_lshlrev_b32 v2,4,v0
v_lshrrev_b32 v4,5,v0
v_and_b32 v5,31,v0
v_mul_u32_u24 v3,1280,v5
v_lshl_add_u32 v3,v4,3,v3
v_lshlrev_b32 v5,3,v5
s_mov_b32 s43,s3
s_mul_i32 s44,s42,40960
s_mul_i32 s45,s43,320
s_add_u32 s44,s44,s45
s_waitcnt lgkmcnt(0)
s_mov_b32 s24,s20
s_and_b32 s25,s21,0xffff
s_mov_b32 s26,0x280000
s_mov_b32 s27,0x20000
buffer_load_dwordx2 v[16:17],v3,s[24:27],s44 offen
buffer_load_dwordx2 v[18:19],v3,s[24:27],s44 offen offset:16
buffer_load_dwordx2 v[20:21],v3,s[24:27],s44 offen offset:32
buffer_load_dwordx2 v[22:23],v3,s[24:27],s44 offen offset:48
buffer_load_dwordx2 v[24:25],v3,s[24:27],s44 offen offset:64
buffer_load_dwordx2 v[26:27],v3,s[24:27],s44 offen offset:80
buffer_load_dwordx2 v[28:29],v3,s[24:27],s44 offen offset:96
buffer_load_dwordx2 v[30:31],v3,s[24:27],s44 offen offset:112
buffer_load_dwordx2 v[32:33],v3,s[24:27],s44 offen offset:128
buffer_load_dwordx2 v[34:35],v3,s[24:27],s44 offen offset:144
buffer_load_dwordx2 v[36:37],v3,s[24:27],s44 offen offset:160
buffer_load_dwordx2 v[38:39],v3,s[24:27],s44 offen offset:176
buffer_load_dwordx2 v[40:41],v3,s[24:27],s44 offen offset:192
buffer_load_dwordx2 v[42:43],v3,s[24:27],s44 offen offset:208
buffer_load_dwordx2 v[44:45],v3,s[24:27],s44 offen offset:224
buffer_load_dwordx2 v[46:47],v3,s[24:27],s44 offen offset:240
buffer_load_dwordx2 v[48:49],v3,s[24:27],s44 offen offset:256
buffer_load_dwordx2 v[50:51],v3,s[24:27],s44 offen offset:272
buffer_load_dwordx2 v[52:53],v3,s[24:27],s44 offen offset:288
buffer_load_dwordx2 v[54:55],v3,s[24:27],s44 offen offset:304
v_mov_b32 v8,-1
v_mov_b32 v12,0
v_mov_b32 v9,-1
v_mov_b32 v13,0
v_mov_b32 v10,-1
v_mov_b32 v14,0
v_mov_b32 v11,-1
v_mov_b32 v15,0
s_mul_i32 s46,s41,2304
s_add_u32 s46,s46,65536
v_lshlrev_b32 v6,7,v0
v_cmp_gt_u32 vcc,18,v0
s_nop 0
s_mov_b64 exec,vcc
buffer_store_dwordx4 v[12:15],v6,s[4:7],s46 offen sc1
buffer_store_dwordx4 v[12:15],v6,s[4:7],s46 offen offset:16 sc1
buffer_store_dwordx4 v[12:15],v6,s[4:7],s46 offen offset:32 sc1
s_mov_b64 exec,-1
s_mul_i32 s45,s42,49152
s_add_u32 s45,s45,55574528
s_mul_i32 s46,s43,10240
s_add_u32 s46,s46,s45
s_mul_i32 s47,s43,1280
s_add_u32 s47,s47,s45
s_add_u32 s47,s47,40960
s_waitcnt vmcnt(19)
buffer_store_dwordx4 v[16:19],v2,s[4:7],s46 offen sc1
buffer_store_dwordx4 v[20:23],v2,s[4:7],s46 offen offset:1024 sc1
s_add_u32 s46,s46,2048
v_mov_b32 v100,0
v_mov_b32 v101,0
v_lshlrev_b32 v6,16,v16
v_and_b32 v7,0xffff0000,v16
v_add_f32 v100,v100,v6
v_fmac_f32 v101,v6,v6
v_add_f32 v100,v100,v7
v_fmac_f32 v101,v7,v7
v_lshlrev_b32 v6,16,v17
v_and_b32 v7,0xffff0000,v17
v_add_f32 v100,v100,v6
v_fmac_f32 v101,v6,v6
v_add_f32 v100,v100,v7
v_fmac_f32 v101,v7,v7
v_lshlrev_b32 v6,16,v18
v_and_b32 v7,0xffff0000,v18
v_add_f32 v100,v100,v6
v_fmac_f32 v101,v6,v6
v_add_f32 v100,v100,v7
v_fmac_f32 v101,v7,v7
v_lshlrev_b32 v6,16,v19
v_and_b32 v7,0xffff0000,v19
v_add_f32 v100,v100,v6
v_fmac_f32 v101,v6,v6
v_add_f32 v100,v100,v7
v_fmac_f32 v101,v7,v7
v_lshlrev_b32 v6,16,v20
v_and_b32 v7,0xffff0000,v20
v_add_f32 v100,v100,v6
v_fmac_f32 v101,v6,v6
v_add_f32 v100,v100,v7
v_fmac_f32 v101,v7,v7
v_lshlrev_b32 v6,16,v21
v_and_b32 v7,0xffff0000,v21
v_add_f32 v100,v100,v6
v_fmac_f32 v101,v6,v6
v_add_f32 v100,v100,v7
v_fmac_f32 v101,v7,v7
v_lshlrev_b32 v6,16,v22
v_and_b32 v7,0xffff0000,v22
v_add_f32 v100,v100,v6
v_fmac_f32 v101,v6,v6
v_add_f32 v100,v100,v7
v_fmac_f32 v101,v7,v7
v_lshlrev_b32 v6,16,v23
v_and_b32 v7,0xffff0000,v23
v_add_f32 v100,v100,v6
v_fmac_f32 v101,v6,v6
v_add_f32 v100,v100,v7
v_fmac_f32 v101,v7,v7
v_mov_b32 v6,v100
v_mov_b32 v7,v101
s_nop 0
v_permlane32_swap_b32 v100,v6
v_permlane32_swap_b32 v101,v7
v_add_f32 v100,v100,v6
v_add_f32 v101,v101,v7
buffer_store_dwordx2 v[100:101],v5,s[4:7],s47 offen sc1
s_waitcnt vmcnt(18)
buffer_store_dwordx4 v[24:27],v2,s[4:7],s46 offen sc1
buffer_store_dwordx4 v[28:31],v2,s[4:7],s46 offen offset:1024 sc1
s_add_u32 s46,s46,2048
v_mov_b32 v102,0
v_mov_b32 v103,0
v_lshlrev_b32 v6,16,v24
v_and_b32 v7,0xffff0000,v24
v_add_f32 v102,v102,v6
v_fmac_f32 v103,v6,v6
v_add_f32 v102,v102,v7
v_fmac_f32 v103,v7,v7
v_lshlrev_b32 v6,16,v25
v_and_b32 v7,0xffff0000,v25
v_add_f32 v102,v102,v6
v_fmac_f32 v103,v6,v6
v_add_f32 v102,v102,v7
v_fmac_f32 v103,v7,v7
v_lshlrev_b32 v6,16,v26
v_and_b32 v7,0xffff0000,v26
v_add_f32 v102,v102,v6
v_fmac_f32 v103,v6,v6
v_add_f32 v102,v102,v7
v_fmac_f32 v103,v7,v7
v_lshlrev_b32 v6,16,v27
v_and_b32 v7,0xffff0000,v27
v_add_f32 v102,v102,v6
v_fmac_f32 v103,v6,v6
v_add_f32 v102,v102,v7
v_fmac_f32 v103,v7,v7
v_lshlrev_b32 v6,16,v28
v_and_b32 v7,0xffff0000,v28
v_add_f32 v102,v102,v6
v_fmac_f32 v103,v6,v6
v_add_f32 v102,v102,v7
v_fmac_f32 v103,v7,v7
v_lshlrev_b32 v6,16,v29
v_and_b32 v7,0xffff0000,v29
v_add_f32 v102,v102,v6
v_fmac_f32 v103,v6,v6
v_add_f32 v102,v102,v7
v_fmac_f32 v103,v7,v7
v_lshlrev_b32 v6,16,v30
v_and_b32 v7,0xffff0000,v30
v_add_f32 v102,v102,v6
v_fmac_f32 v103,v6,v6
v_add_f32 v102,v102,v7
v_fmac_f32 v103,v7,v7
v_lshlrev_b32 v6,16,v31
v_and_b32 v7,0xffff0000,v31
v_add_f32 v102,v102,v6
v_fmac_f32 v103,v6,v6
v_add_f32 v102,v102,v7
v_fmac_f32 v103,v7,v7
v_mov_b32 v6,v102
v_mov_b32 v7,v103
s_nop 0
v_permlane32_swap_b32 v102,v6
v_permlane32_swap_b32 v103,v7
v_add_f32 v102,v102,v6
v_add_f32 v103,v103,v7
buffer_store_dwordx2 v[102:103],v5,s[4:7],s47 offen offset:256 sc1
s_waitcnt vmcnt(17)
buffer_store_dwordx4 v[32:35],v2,s[4:7],s46 offen sc1
buffer_store_dwordx4 v[36:39],v2,s[4:7],s46 offen offset:1024 sc1
s_add_u32 s46,s46,2048
v_mov_b32 v104,0
v_mov_b32 v105,0
v_lshlrev_b32 v6,16,v32
v_and_b32 v7,0xffff0000,v32
v_add_f32 v104,v104,v6
v_fmac_f32 v105,v6,v6
v_add_f32 v104,v104,v7
v_fmac_f32 v105,v7,v7
v_lshlrev_b32 v6,16,v33
v_and_b32 v7,0xffff0000,v33
v_add_f32 v104,v104,v6
v_fmac_f32 v105,v6,v6
v_add_f32 v104,v104,v7
v_fmac_f32 v105,v7,v7
v_lshlrev_b32 v6,16,v34
v_and_b32 v7,0xffff0000,v34
v_add_f32 v104,v104,v6
v_fmac_f32 v105,v6,v6
v_add_f32 v104,v104,v7
v_fmac_f32 v105,v7,v7
v_lshlrev_b32 v6,16,v35
v_and_b32 v7,0xffff0000,v35
v_add_f32 v104,v104,v6
v_fmac_f32 v105,v6,v6
v_add_f32 v104,v104,v7
v_fmac_f32 v105,v7,v7
v_lshlrev_b32 v6,16,v36
v_and_b32 v7,0xffff0000,v36
v_add_f32 v104,v104,v6
v_fmac_f32 v105,v6,v6
v_add_f32 v104,v104,v7
v_fmac_f32 v105,v7,v7
v_lshlrev_b32 v6,16,v37
v_and_b32 v7,0xffff0000,v37
v_add_f32 v104,v104,v6
v_fmac_f32 v105,v6,v6
v_add_f32 v104,v104,v7
v_fmac_f32 v105,v7,v7
v_lshlrev_b32 v6,16,v38
v_and_b32 v7,0xffff0000,v38
v_add_f32 v104,v104,v6
v_fmac_f32 v105,v6,v6
v_add_f32 v104,v104,v7
v_fmac_f32 v105,v7,v7
v_lshlrev_b32 v6,16,v39
v_and_b32 v7,0xffff0000,v39
v_add_f32 v104,v104,v6
v_fmac_f32 v105,v6,v6
v_add_f32 v104,v104,v7
v_fmac_f32 v105,v7,v7
v_mov_b32 v6,v104
v_mov_b32 v7,v105
s_nop 0
v_permlane32_swap_b32 v104,v6
v_permlane32_swap_b32 v105,v7
v_add_f32 v104,v104,v6
v_add_f32 v105,v105,v7
buffer_store_dwordx2 v[104:105],v5,s[4:7],s47 offen offset:512 sc1
s_waitcnt vmcnt(16)
buffer_store_dwordx4 v[40:43],v2,s[4:7],s46 offen sc1
buffer_store_dwordx4 v[44:47],v2,s[4:7],s46 offen offset:1024 sc1
s_add_u32 s46,s46,2048
v_mov_b32 v106,0
v_mov_b32 v107,0
v_lshlrev_b32 v6,16,v40
v_and_b32 v7,0xffff0000,v40
v_add_f32 v106,v106,v6
v_fmac_f32 v107,v6,v6
v_add_f32 v106,v106,v7
v_fmac_f32 v107,v7,v7
v_lshlrev_b32 v6,16,v41
v_and_b32 v7,0xffff0000,v41
v_add_f32 v106,v106,v6
v_fmac_f32 v107,v6,v6
v_add_f32 v106,v106,v7
v_fmac_f32 v107,v7,v7
v_lshlrev_b32 v6,16,v42
v_and_b32 v7,0xffff0000,v42
v_add_f32 v106,v106,v6
v_fmac_f32 v107,v6,v6
v_add_f32 v106,v106,v7
v_fmac_f32 v107,v7,v7
v_lshlrev_b32 v6,16,v43
v_and_b32 v7,0xffff0000,v43
v_add_f32 v106,v106,v6
v_fmac_f32 v107,v6,v6
v_add_f32 v106,v106,v7
v_fmac_f32 v107,v7,v7
v_lshlrev_b32 v6,16,v44
v_and_b32 v7,0xffff0000,v44
v_add_f32 v106,v106,v6
v_fmac_f32 v107,v6,v6
v_add_f32 v106,v106,v7
v_fmac_f32 v107,v7,v7
v_lshlrev_b32 v6,16,v45
v_and_b32 v7,0xffff0000,v45
v_add_f32 v106,v106,v6
v_fmac_f32 v107,v6,v6
v_add_f32 v106,v106,v7
v_fmac_f32 v107,v7,v7
v_lshlrev_b32 v6,16,v46
v_and_b32 v7,0xffff0000,v46
v_add_f32 v106,v106,v6
v_fmac_f32 v107,v6,v6
v_add_f32 v106,v106,v7
v_fmac_f32 v107,v7,v7
v_lshlrev_b32 v6,16,v47
v_and_b32 v7,0xffff0000,v47
v_add_f32 v106,v106,v6
v_fmac_f32 v107,v6,v6
v_add_f32 v106,v106,v7
v_fmac_f32 v107,v7,v7
v_mov_b32 v6,v106
v_mov_b32 v7,v107
s_nop 0
v_permlane32_swap_b32 v106,v6
v_permlane32_swap_b32 v107,v7
v_add_f32 v106,v106,v6
v_add_f32 v107,v107,v7
buffer_store_dwordx2 v[106:107],v5,s[4:7],s47 offen offset:768 sc1
s_waitcnt vmcnt(15)
buffer_store_dwordx4 v[48:51],v2,s[4:7],s46 offen sc1
buffer_store_dwordx4 v[52:55],v2,s[4:7],s46 offen offset:1024 sc1
s_add_u32 s46,s46,2048
v_mov_b32 v108,0
v_mov_b32 v109,0
v_lshlrev_b32 v6,16,v48
v_and_b32 v7,0xffff0000,v48
v_add_f32 v108,v108,v6
v_fmac_f32 v109,v6,v6
v_add_f32 v108,v108,v7
v_fmac_f32 v109,v7,v7
v_lshlrev_b32 v6,16,v49
v_and_b32 v7,0xffff0000,v49
v_add_f32 v108,v108,v6
v_fmac_f32 v109,v6,v6
v_add_f32 v108,v108,v7
v_fmac_f32 v109,v7,v7
v_lshlrev_b32 v6,16,v50
v_and_b32 v7,0xffff0000,v50
v_add_f32 v108,v108,v6
v_fmac_f32 v109,v6,v6
v_add_f32 v108,v108,v7
v_fmac_f32 v109,v7,v7
v_lshlrev_b32 v6,16,v51
v_and_b32 v7,0xffff0000,v51
v_add_f32 v108,v108,v6
v_fmac_f32 v109,v6,v6
v_add_f32 v108,v108,v7
v_fmac_f32 v109,v7,v7
v_lshlrev_b32 v6,16,v52
v_and_b32 v7,0xffff0000,v52
v_add_f32 v108,v108,v6
v_fmac_f32 v109,v6,v6
v_add_f32 v108,v108,v7
v_fmac_f32 v109,v7,v7
v_lshlrev_b32 v6,16,v53
v_and_b32 v7,0xffff0000,v53
v_add_f32 v108,v108,v6
v_fmac_f32 v109,v6,v6
v_add_f32 v108,v108,v7
v_fmac_f32 v109,v7,v7
v_lshlrev_b32 v6,16,v54
v_and_b32 v7,0xffff0000,v54
v_add_f32 v108,v108,v6
v_fmac_f32 v109,v6,v6
v_add_f32 v108,v108,v7
v_fmac_f32 v109,v7,v7
v_lshlrev_b32 v6,16,v55
v_and_b32 v7,0xffff0000,v55
v_add_f32 v108,v108,v6
v_fmac_f32 v109,v6,v6
v_add_f32 v108,v108,v7
v_fmac_f32 v109,v7,v7
v_mov_b32 v6,v108
v_mov_b32 v7,v109
s_nop 0
v_permlane32_swap_b32 v108,v6
v_permlane32_swap_b32 v109,v7
v_add_f32 v108,v108,v6
v_add_f32 v109,v109,v7
buffer_store_dwordx2 v[108:109],v5,s[4:7],s47 offen offset:1024 sc1
s_mov_b32 s48,2
s_cmp_lg_u32 s41,0
s_cbranch_scc1 init_p_112
s_waitcnt vmcnt(0)
s_mov_b32 s64,-1
s_mov_b32 s65,-1
s_mov_b32 s49,0
s_mov_b64 exec,1
init_l_113:
s_mov_b32 s46,0
s_memtime s[60:61]
s_waitcnt lgkmcnt(0)
buffer_store_dword v12,off,s[4:7],s46 sc1
s_waitcnt vmcnt(0)
s_memtime s[62:63]
s_waitcnt lgkmcnt(0)
s_sub_u32 s47,s62,s60
s_min_u32 s64,s64,s47
s_mov_b32 s46,8192
s_memtime s[60:61]
s_waitcnt lgkmcnt(0)
buffer_store_dword v12,off,s[4:7],s46 sc1
s_waitcnt vmcnt(0)
s_memtime s[62:63]
s_waitcnt lgkmcnt(0)
s_sub_u32 s47,s62,s60
s_min_u32 s65,s65,s47
s_add_u32 s49,s49,1
s_cmp_lt_u32 s49,6
s_cbranch_scc1 init_l_113
s_mov_b64 exec,-1
s_cmp_gt_u32 s64,s65
s_cselect_b32 s48,3,2
init_p_112:
s_waitcnt vmcnt(0)
s_barrier
s_cmp_lg_u32 s3,0
s_cbranch_scc1 init_d_114
v_mov_b32 v6,s48
s_mov_b32 s46,68
s_mov_b64 exec,1
buffer_atomic_add v6,off,s[12:15],s46 sc1
s_mov_b64 exec,-1
init_d_114:
s_mul_i32 s46,s41,16384
s_cmp_ge_u32 s41,128
s_cselect_b32 s47,1048576,0
s_add_u32 s46,s46,s47
s_add_u32 s46,s46,1048576
buffer_store_dwordx4 v[8:11],v2,s[4:7],s46 offen sc1
buffer_store_dwordx4 v[8:11],v2,s[4:7],s46 offen offset:1024 sc1
buffer_store_dwordx4 v[8:11],v2,s[4:7],s46 offen offset:2048 sc1
buffer_store_dwordx4 v[8:11],v2,s[4:7],s46 offen offset:3072 sc1
s_add_u32 s46,s46,4096
buffer_store_dwordx4 v[8:11],v2,s[4:7],s46 offen sc1
buffer_store_dwordx4 v[8:11],v2,s[4:7],s46 offen offset:1024 sc1
buffer_store_dwordx4 v[8:11],v2,s[4:7],s46 offen offset:2048 sc1
buffer_store_dwordx4 v[8:11],v2,s[4:7],s46 offen offset:3072 sc1
s_add_u32 s46,s46,4096
buffer_store_dwordx4 v[8:11],v2,s[4:7],s46 offen sc1
buffer_store_dwordx4 v[8:11],v2,s[4:7],s46 offen offset:1024 sc1
buffer_store_dwordx4 v[8:11],v2,s[4:7],s46 offen offset:2048 sc1
buffer_store_dwordx4 v[8:11],v2,s[4:7],s46 offen offset:3072 sc1
s_add_u32 s46,s46,4096
buffer_store_dwordx4 v[8:11],v2,s[4:7],s46 offen sc1
buffer_store_dwordx4 v[8:11],v2,s[4:7],s46 offen offset:1024 sc1
buffer_store_dwordx4 v[8:11],v2,s[4:7],s46 offen offset:2048 sc1
buffer_store_dwordx4 v[8:11],v2,s[4:7],s46 offen offset:3072 sc1
s_add_u32 s46,s46,4096
s_waitcnt vmcnt(0)
s_barrier
s_cmp_lg_u32 s3,0
s_cbranch_scc1 init_d_115
v_mov_b32 v6,s48
s_mov_b32 s46,72
s_mov_b64 exec,1
buffer_atomic_add v6,off,s[12:15],s46 sc1
s_mov_b64 exec,-1
init_d_115:
s_cmp_ge_u32 s2,64
s_cbranch_scc1 L_steady
v_mov_b32 v2,132
s_mov_b32 s38,0
s_nop 0
poll_116:
buffer_load_dword v3,v2,s[12:15],0 offen sc1
s_waitcnt vmcnt(0)
v_cmp_le_u32 vcc,1,v3
s_nop 0
s_cmp_eq_u64 vcc,-1
s_nop 1
s_cbranch_scc1 polld_117
s_sleep 16
s_add_u32 s38,s38,1
s_cmp_lt_u32 s38,100000
s_cbranch_scc1 poll_116
s_mov_b32 s40,14
s_branch L_fail
polld_117:
s_branch R_chain
wk_111:
s_sub_u32 s42,s2,64
s_mov_b32 s39,0
s_mov_b32 s43,0
s_mov_b32 s65,0
s_cmp_lt_u32 s42,8
s_cbranch_scc1 P1_go
s_mov_b32 s43,8
s_mov_b32 s65,0
s_cmp_lt_u32 s42,16
s_cbranch_scc1 P1_go
s_mov_b32 s43,16
s_mov_b32 s65,0
s_cmp_lt_u32 s42,24
s_cbranch_scc1 P1_go
s_cmp_lt_u32 s42,29
s_cbranch_scc1 L_steady
s_cmp_ge_u32 s42,30
s_cbranch_scc1 dsp_118
s_add_u32 s42,s42,3
s_branch L_init
dsp_118:
s_mov_b32 s43,14
s_mov_b32 s65,1
s_cmp_lt_u32 s42,32
s_cbranch_scc1 P1_go
s_mov_b32 s43,-24
s_mov_b32 s65,0
s_cmp_lt_u32 s42,40
s_cbranch_scc1 P1_go
s_mov_b32 s43,-16
s_mov_b32 s65,0
s_cmp_lt_u32 s42,48
s_cbranch_scc1 P1_go
s_mov_b32 s43,-8
s_mov_b32 s65,0
s_cmp_lt_u32 s42,56
s_cbranch_scc1 P1_go
s_mov_b32 s43,-46
s_mov_b32 s65,1
s_cmp_lt_u32 s42,61
s_cbranch_scc1 P1_go
s_mov_b32 s43,-29
s_mov_b32 s65,2
s_cmp_lt_u32 s42,62
s_cbranch_scc1 P1_go
s_mov_b32 s43,-16
s_mov_b32 s65,1
s_cmp_lt_u32 s42,64
s_cbranch_scc1 P1_go
s_cmp_lt_u32 s42,69
s_cbranch_scc1 L_steady
s_mov_b32 s43,-69
s_mov_b32 s65,2
s_cmp_lt_u32 s42,83
s_cbranch_scc1 P1_go
s_mov_b32 s43,-69
s_mov_b32 s65,2
s_cmp_lt_u32 s42,91
s_cbranch_scc1 P1_go
s_cmp_lt_u32 s42,93
s_cbranch_scc1 L_steady
s_cmp_ge_u32 s42,96
s_cbranch_scc1 dsp_119
s_add_u32 s42,s42,-60
s_branch L_init
dsp_119:
s_cmp_ge_u32 s42,112
s_cbranch_scc1 dsp_120
s_add_u32 s42,s42,-60
s_branch L_init
dsp_120:
s_cmp_lt_u32 s42,116
s_cbranch_scc1 L_steady
s_cmp_ge_u32 s42,128
s_cbranch_scc1 dsp_121
s_add_u32 s42,s42,-64
s_branch L_init
dsp_121:
s_mov_b32 s43,-113
s_mov_b32 s65,1
s_cmp_lt_u32 s42,133
s_cbranch_scc1 P1_go
s_mov_b32 s43,-113
s_mov_b32 s65,1
s_cmp_lt_u32 s42,147
s_cbranch_scc1 P1_go
s_mov_b32 s43,-113
s_mov_b32 s65,1
s_cmp_lt_u32 s42,157
s_cbranch_scc1 P1_go
s_mov_b32 s43,-124
s_mov_b32 s65,2
s_cmp_lt_u32 s42,160
s_cbranch_scc1 P1_go
s_mov_b32 s43,-138
s_mov_b32 s65,2
s_cmp_lt_u32 s42,170
s_cbranch_scc1 P1_go
s_mov_b32 s43,-170
s_mov_b32 s65,1
s_cmp_lt_u32 s42,180
s_cbranch_scc1 P1_go
s_mov_b32 s43,-144
s_mov_b32 s65,2
s_cmp_lt_u32 s42,192
s_cbranch_scc1 P1_go
P1_go:
s_add_u32 s42,s42,s43
s_lshl_b32 s41,s42,2
s_add_u32 s41,s41,s3
s_cmp_ge_u32 s42,32
s_cbranch_scc1 R_v
s_mov_b32 s24,s4
s_mov_b32 s25,s5
s_mov_b32 s27,0x20000
s_cmp_lt_u32 s41,192
s_cselect_b32 s26,s6,0
s_min_u32 s41,s41,191
v_lshlrev_b32 v1,4,v0
s_lshr_b32 s42,s41,6
s_lshl_b32 s42,s42,3
s_add_u32 s42,s42,16
s_load_dwordx2 s[20:21],s[0:1],s42
s_waitcnt lgkmcnt(0)
s_mov_b32 s16,s20
s_and_b32 s17,s21,0xffff
s_mov_b32 s18,0x500000
s_mov_b32 s19,0x20000
s_and_b32 s42,s41,63
s_lshl_b32 s42,s42,7
v_lshrrev_b32 v98,3,v0
v_mul_u32_u24 v96,8192,v98
v_and_b32 v98,7,v0
v_lshl_add_u32 v96,v98,4,v96
v_and_b32 v98,3,v0
v_lshlrev_b32 v97,3,v98
v_bfe_u32 v98,v0,4,1
v_lshl_add_u32 v97,v98,5,v97
v_bfe_u32 v98,v0,2,2
v_lshl_add_u32 v97,v98,7,v97
v_lshrrev_b32 v98,5,v0
v_lshl_add_u32 v97,v98,9,v97
s_mul_i32 s22,s3,40960
v_add_u32 v97,s22,v97
v_xor_b32 v98,64,v97
s_add_u32 s20,s42,0
s_add_u32 s23,s22,0
s_mov_b32 m0,s23
s_nop 0
buffer_load_dwordx4 v96,s[16:19],s20 offen lds
s_add_u32 s23,s22,1024
s_mov_b32 m0,s23
s_add_u32 s20,s20,65536
buffer_load_dwordx4 v96,s[16:19],s20 offen lds
s_add_u32 s20,s42,131072
s_add_u32 s23,s22,2048
s_mov_b32 m0,s23
s_nop 0
buffer_load_dwordx4 v96,s[16:19],s20 offen lds
s_add_u32 s23,s22,3072
s_mov_b32 m0,s23
s_add_u32 s20,s20,65536
buffer_load_dwordx4 v96,s[16:19],s20 offen lds
s_add_u32 s20,s42,262144
s_add_u32 s23,s22,4096
s_mov_b32 m0,s23
s_nop 0
buffer_load_dwordx4 v96,s[16:19],s20 offen lds
s_add_u32 s23,s22,5120
s_mov_b32 m0,s23
s_add_u32 s20,s20,65536
buffer_load_dwordx4 v96,s[16:19],s20 offen lds
s_add_u32 s20,s42,393216
s_add_u32 s23,s22,6144
s_mov_b32 m0,s23
s_nop 0
buffer_load_dwordx4 v96,s[16:19],s20 offen lds
s_add_u32 s23,s22,7168
s_mov_b32 m0,s23
s_add_u32 s20,s20,65536
buffer_load_dwordx4 v96,s[16:19],s20 offen lds
s_add_u32 s20,s42,524288
s_add_u32 s23,s22,8192
s_mov_b32 m0,s23
s_nop 0
buffer_load_dwordx4 v96,s[16:19],s20 offen lds
s_add_u32 s23,s22,9216
s_mov_b32 m0,s23
s_add_u32 s20,s20,65536
buffer_load_dwordx4 v96,s[16:19],s20 offen lds
s_add_u32 s20,s42,655360
s_add_u32 s23,s22,10240
s_mov_b32 m0,s23
s_nop 0
buffer_load_dwordx4 v96,s[16:19],s20 offen lds
s_add_u32 s23,s22,11264
s_mov_b32 m0,s23
s_add_u32 s20,s20,65536
buffer_load_dwordx4 v96,s[16:19],s20 offen lds
s_add_u32 s20,s42,786432
s_add_u32 s23,s22,12288
s_mov_b32 m0,s23
s_nop 0
buffer_load_dwordx4 v96,s[16:19],s20 offen lds
s_add_u32 s23,s22,13312
s_mov_b32 m0,s23
s_add_u32 s20,s20,65536
buffer_load_dwordx4 v96,s[16:19],s20 offen lds
s_add_u32 s20,s42,917504
s_add_u32 s23,s22,14336
s_mov_b32 m0,s23
s_nop 0
buffer_load_dwordx4 v96,s[16:19],s20 offen lds
s_add_u32 s23,s22,15360
s_mov_b32 m0,s23
s_add_u32 s20,s20,65536
buffer_load_dwordx4 v96,s[16:19],s20 offen lds
s_add_u32 s20,s42,1048576
s_add_u32 s23,s22,16384
s_mov_b32 m0,s23
s_nop 0
buffer_load_dwordx4 v96,s[16:19],s20 offen lds
s_add_u32 s23,s22,17408
s_mov_b32 m0,s23
s_add_u32 s20,s20,65536
buffer_load_dwordx4 v96,s[16:19],s20 offen lds
s_add_u32 s20,s42,1179648
s_add_u32 s23,s22,18432
s_mov_b32 m0,s23
s_nop 0
buffer_load_dwordx4 v96,s[16:19],s20 offen lds
s_add_u32 s23,s22,19456
s_mov_b32 m0,s23
s_add_u32 s20,s20,65536
buffer_load_dwordx4 v96,s[16:19],s20 offen lds
s_add_u32 s20,s42,1310720
s_add_u32 s23,s22,20480
s_mov_b32 m0,s23
s_nop 0
buffer_load_dwordx4 v96,s[16:19],s20 offen lds
s_add_u32 s23,s22,21504
s_mov_b32 m0,s23
s_add_u32 s20,s20,65536
buffer_load_dwordx4 v96,s[16:19],s20 offen lds
s_add_u32 s20,s42,1441792
s_add_u32 s23,s22,22528
s_mov_b32 m0,s23
s_nop 0
buffer_load_dwordx4 v96,s[16:19],s20 offen lds
s_add_u32 s23,s22,23552
s_mov_b32 m0,s23
s_add_u32 s20,s20,65536
buffer_load_dwordx4 v96,s[16:19],s20 offen lds
s_add_u32 s20,s42,1572864
s_add_u32 s23,s22,24576
s_mov_b32 m0,s23
s_nop 0
buffer_load_dwordx4 v96,s[16:19],s20 offen lds
s_add_u32 s23,s22,25600
s_mov_b32 m0,s23
s_add_u32 s20,s20,65536
buffer_load_dwordx4 v96,s[16:19],s20 offen lds
s_add_u32 s20,s42,1703936
s_add_u32 s23,s22,26624
s_mov_b32 m0,s23
s_nop 0
buffer_load_dwordx4 v96,s[16:19],s20 offen lds
s_add_u32 s23,s22,27648
s_mov_b32 m0,s23
s_add_u32 s20,s20,65536
buffer_load_dwordx4 v96,s[16:19],s20 offen lds
s_add_u32 s20,s42,1835008
s_add_u32 s23,s22,28672
s_mov_b32 m0,s23
s_nop 0
buffer_load_dwordx4 v96,s[16:19],s20 offen lds
s_add_u32 s23,s22,29696
s_mov_b32 m0,s23
s_add_u32 s20,s20,65536
buffer_load_dwordx4 v96,s[16:19],s20 offen lds
s_add_u32 s20,s42,1966080
s_add_u32 s23,s22,30720
s_mov_b32 m0,s23
s_nop 0
buffer_load_dwordx4 v96,s[16:19],s20 offen lds
s_add_u32 s23,s22,31744
s_mov_b32 m0,s23
s_add_u32 s20,s20,65536
buffer_load_dwordx4 v96,s[16:19],s20 offen lds
s_add_u32 s20,s42,2097152
s_add_u32 s23,s22,32768
s_mov_b32 m0,s23
s_nop 0
buffer_load_dwordx4 v96,s[16:19],s20 offen lds
s_add_u32 s23,s22,33792
s_mov_b32 m0,s23
s_add_u32 s20,s20,65536
buffer_load_dwordx4 v96,s[16:19],s20 offen lds
s_add_u32 s20,s42,2228224
s_add_u32 s23,s22,34816
s_mov_b32 m0,s23
s_nop 0
buffer_load_dwordx4 v96,s[16:19],s20 offen lds
s_add_u32 s23,s22,35840
s_mov_b32 m0,s23
s_add_u32 s20,s20,65536
buffer_load_dwordx4 v96,s[16:19],s20 offen lds
s_waitcnt vmcnt(34)
ds_read_b64_tr_b16 a[0:1],v97
ds_read_b64_tr_b16 a[2:3],v97 offset:1024
ds_read_b64_tr_b16 a[160:161],v98
ds_read_b64_tr_b16 a[162:163],v98 offset:1024
s_waitcnt vmcnt(32)
ds_read_b64_tr_b16 a[4:5],v97 offset:2048
ds_read_b64_tr_b16 a[6:7],v97 offset:3072
ds_read_b64_tr_b16 a[164:165],v98 offset:2048
ds_read_b64_tr_b16 a[166:167],v98 offset:3072
s_waitcnt vmcnt(30)
ds_read_b64_tr_b16 a[8:9],v97 offset:4096
ds_read_b64_tr_b16 a[10:11],v97 offset:5120
ds_read_b64_tr_b16 a[168:169],v98 offset:4096
ds_read_b64_tr_b16 a[170:171],v98 offset:5120
s_waitcnt lgkmcnt(8)
s_add_u32 s20,s42,2359296
s_add_u32 s23,s22,0
s_mov_b32 m0,s23
s_nop 0
buffer_load_dwordx4 v96,s[16:19],s20 offen lds
s_add_u32 s23,s22,1024
s_mov_b32 m0,s23
s_add_u32 s20,s20,65536
buffer_load_dwordx4 v96,s[16:19],s20 offen lds
s_waitcnt vmcnt(30)
ds_read_b64_tr_b16 a[12:13],v97 offset:6144
ds_read_b64_tr_b16 a[14:15],v97 offset:7168
ds_read_b64_tr_b16 a[172:173],v98 offset:6144
ds_read_b64_tr_b16 a[174:175],v98 offset:7168
s_waitcnt lgkmcnt(8)
s_add_u32 s20,s42,2490368
s_add_u32 s23,s22,2048
s_mov_b32 m0,s23
s_nop 0
buffer_load_dwordx4 v96,s[16:19],s20 offen lds
s_add_u32 s23,s22,3072
s_mov_b32 m0,s23
s_add_u32 s20,s20,65536
buffer_load_dwordx4 v96,s[16:19],s20 offen lds
s_waitcnt vmcnt(30)
ds_read_b64_tr_b16 a[16:17],v97 offset:8192
ds_read_b64_tr_b16 a[18:19],v97 offset:9216
ds_read_b64_tr_b16 a[176:177],v98 offset:8192
ds_read_b64_tr_b16 a[178:179],v98 offset:9216
s_waitcnt lgkmcnt(8)
s_add_u32 s20,s42,2621440
s_add_u32 s23,s22,4096
s_mov_b32 m0,s23
s_nop 0
buffer_load_dwordx4 v96,s[16:19],s20 offen lds
s_add_u32 s23,s22,5120
s_mov_b32 m0,s23
s_add_u32 s20,s20,65536
buffer_load_dwordx4 v96,s[16:19],s20 offen lds
s_waitcnt vmcnt(30)
ds_read_b64_tr_b16 a[20:21],v97 offset:10240
ds_read_b64_tr_b16 a[22:23],v97 offset:11264
ds_read_b64_tr_b16 a[180:181],v98 offset:10240
ds_read_b64_tr_b16 a[182:183],v98 offset:11264
s_waitcnt lgkmcnt(8)
s_add_u32 s20,s42,2752512
s_add_u32 s23,s22,6144
s_mov_b32 m0,s23
s_nop 0
buffer_load_dwordx4 v96,s[16:19],s20 offen lds
s_add_u32 s23,s22,7168
s_mov_b32 m0,s23
s_add_u32 s20,s20,65536
buffer_load_dwordx4 v96,s[16:19],s20 offen lds
s_waitcnt vmcnt(30)
ds_read_b64_tr_b16 a[24:25],v97 offset:12288
ds_read_b64_tr_b16 a[26:27],v97 offset:13312
ds_read_b64_tr_b16 a[184:185],v98 offset:12288
ds_read_b64_tr_b16 a[186:187],v98 offset:13312
s_waitcnt lgkmcnt(8)
s_add_u32 s20,s42,2883584
s_add_u32 s23,s22,8192
s_mov_b32 m0,s23
s_nop 0
buffer_load_dwordx4 v96,s[16:19],s20 offen lds
s_add_u32 s23,s22,9216
s_mov_b32 m0,s23
s_add_u32 s20,s20,65536
buffer_load_dwordx4 v96,s[16:19],s20 offen lds
s_waitcnt vmcnt(30)
ds_read_b64_tr_b16 a[28:29],v97 offset:14336
ds_read_b64_tr_b16 a[30:31],v97 offset:15360
ds_read_b64_tr_b16 a[188:189],v98 offset:14336
ds_read_b64_tr_b16 a[190:191],v98 offset:15360
s_waitcnt lgkmcnt(8)
s_add_u32 s20,s42,3014656
s_add_u32 s23,s22,10240
s_mov_b32 m0,s23
s_nop 0
buffer_load_dwordx4 v96,s[16:19],s20 offen lds
s_add_u32 s23,s22,11264
s_mov_b32 m0,s23
s_add_u32 s20,s20,65536
buffer_load_dwordx4 v96,s[16:19],s20 offen lds
s_waitcnt vmcnt(30)
ds_read_b64_tr_b16 a[32:33],v97 offset:16384
ds_read_b64_tr_b16 a[34:35],v97 offset:17408
ds_read_b64_tr_b16 a[192:193],v98 offset:16384
ds_read_b64_tr_b16 a[194:195],v98 offset:17408
s_waitcnt lgkmcnt(8)
s_add_u32 s20,s42,3145728
s_add_u32 s23,s22,12288
s_mov_b32 m0,s23
s_nop 0
buffer_load_dwordx4 v96,s[16:19],s20 offen lds
s_add_u32 s23,s22,13312
s_mov_b32 m0,s23
s_add_u32 s20,s20,65536
buffer_load_dwordx4 v96,s[16:19],s20 offen lds
s_waitcnt vmcnt(30)
ds_read_b64_tr_b16 a[36:37],v97 offset:18432
ds_read_b64_tr_b16 a[38:39],v97 offset:19456
ds_read_b64_tr_b16 a[196:197],v98 offset:18432
ds_read_b64_tr_b16 a[198:199],v98 offset:19456
s_waitcnt lgkmcnt(8)
s_add_u32 s20,s42,3276800
s_add_u32 s23,s22,14336
s_mov_b32 m0,s23
s_nop 0
buffer_load_dwordx4 v96,s[16:19],s20 offen lds
s_add_u32 s23,s22,15360
s_mov_b32 m0,s23
s_add_u32 s20,s20,65536
buffer_load_dwordx4 v96,s[16:19],s20 offen lds
s_waitcnt vmcnt(30)
ds_read_b64_tr_b16 a[40:41],v97 offset:20480
ds_read_b64_tr_b16 a[42:43],v97 offset:21504
ds_read_b64_tr_b16 a[200:201],v98 offset:20480
ds_read_b64_tr_b16 a[202:203],v98 offset:21504
s_waitcnt lgkmcnt(8)
s_add_u32 s20,s42,3407872
s_add_u32 s23,s22,16384
s_mov_b32 m0,s23
s_nop 0
buffer_load_dwordx4 v96,s[16:19],s20 offen lds
s_add_u32 s23,s22,17408
s_mov_b32 m0,s23
s_add_u32 s20,s20,65536
buffer_load_dwordx4 v96,s[16:19],s20 offen lds
s_waitcnt vmcnt(30)
ds_read_b64_tr_b16 a[44:45],v97 offset:22528
ds_read_b64_tr_b16 a[46:47],v97 offset:23552
ds_read_b64_tr_b16 a[204:205],v98 offset:22528
ds_read_b64_tr_b16 a[206:207],v98 offset:23552
s_waitcnt lgkmcnt(8)
s_add_u32 s20,s42,3538944
s_add_u32 s23,s22,18432
s_mov_b32 m0,s23
s_nop 0
buffer_load_dwordx4 v96,s[16:19],s20 offen lds
s_add_u32 s23,s22,19456
s_mov_b32 m0,s23
s_add_u32 s20,s20,65536
buffer_load_dwordx4 v96,s[16:19],s20 offen lds
s_waitcnt vmcnt(30)
ds_read_b64_tr_b16 a[48:49],v97 offset:24576
ds_read_b64_tr_b16 a[50:51],v97 offset:25600
ds_read_b64_tr_b16 a[208:209],v98 offset:24576
ds_read_b64_tr_b16 a[210:211],v98 offset:25600
s_waitcnt lgkmcnt(8)
s_add_u32 s20,s42,3670016
s_add_u32 s23,s22,20480
s_mov_b32 m0,s23
s_nop 0
buffer_load_dwordx4 v96,s[16:19],s20 offen lds
s_add_u32 s23,s22,21504
s_mov_b32 m0,s23
s_add_u32 s20,s20,65536
buffer_load_dwordx4 v96,s[16:19],s20 offen lds
s_waitcnt vmcnt(30)
ds_read_b64_tr_b16 a[52:53],v97 offset:26624
ds_read_b64_tr_b16 a[54:55],v97 offset:27648
ds_read_b64_tr_b16 a[212:213],v98 offset:26624
ds_read_b64_tr_b16 a[214:215],v98 offset:27648
s_waitcnt lgkmcnt(8)
s_add_u32 s20,s42,3801088
s_add_u32 s23,s22,22528
s_mov_b32 m0,s23
s_nop 0
buffer_load_dwordx4 v96,s[16:19],s20 offen lds
s_add_u32 s23,s22,23552
s_mov_b32 m0,s23
s_add_u32 s20,s20,65536
buffer_load_dwordx4 v96,s[16:19],s20 offen lds
s_waitcnt vmcnt(30)
ds_read_b64_tr_b16 a[56:57],v97 offset:28672
ds_read_b64_tr_b16 a[58:59],v97 offset:29696
ds_read_b64_tr_b16 a[216:217],v98 offset:28672
ds_read_b64_tr_b16 a[218:219],v98 offset:29696
s_waitcnt lgkmcnt(8)
s_add_u32 s20,s42,3932160
s_add_u32 s23,s22,24576
s_mov_b32 m0,s23
s_nop 0
buffer_load_dwordx4 v96,s[16:19],s20 offen lds
s_add_u32 s23,s22,25600
s_mov_b32 m0,s23
s_add_u32 s20,s20,65536
buffer_load_dwordx4 v96,s[16:19],s20 offen lds
s_waitcnt vmcnt(30)
ds_read_b64_tr_b16 a[60:61],v97 offset:30720
ds_read_b64_tr_b16 a[62:63],v97 offset:31744
ds_read_b64_tr_b16 a[220:221],v98 offset:30720
ds_read_b64_tr_b16 a[222:223],v98 offset:31744
s_waitcnt lgkmcnt(8)
s_add_u32 s20,s42,4063232
s_add_u32 s23,s22,26624
s_mov_b32 m0,s23
s_nop 0
buffer_load_dwordx4 v96,s[16:19],s20 offen lds
s_add_u32 s23,s22,27648
s_mov_b32 m0,s23
s_add_u32 s20,s20,65536
buffer_load_dwordx4 v96,s[16:19],s20 offen lds
s_waitcnt vmcnt(30)
ds_read_b64_tr_b16 a[64:65],v97 offset:32768
ds_read_b64_tr_b16 a[66:67],v97 offset:33792
ds_read_b64_tr_b16 a[224:225],v98 offset:32768
ds_read_b64_tr_b16 a[226:227],v98 offset:33792
s_waitcnt lgkmcnt(8)
s_add_u32 s20,s42,4194304
s_add_u32 s23,s22,28672
s_mov_b32 m0,s23
s_nop 0
buffer_load_dwordx4 v96,s[16:19],s20 offen lds
s_add_u32 s23,s22,29696
s_mov_b32 m0,s23
s_add_u32 s20,s20,65536
buffer_load_dwordx4 v96,s[16:19],s20 offen lds
s_waitcnt vmcnt(30)
ds_read_b64_tr_b16 a[68:69],v97 offset:34816
ds_read_b64_tr_b16 a[70:71],v97 offset:35840
ds_read_b64_tr_b16 a[228:229],v98 offset:34816
ds_read_b64_tr_b16 a[230:231],v98 offset:35840
s_waitcnt lgkmcnt(8)
s_add_u32 s20,s42,4325376
s_add_u32 s23,s22,30720
s_mov_b32 m0,s23
s_nop 0
buffer_load_dwordx4 v96,s[16:19],s20 offen lds
s_add_u32 s23,s22,31744
s_mov_b32 m0,s23
s_add_u32 s20,s20,65536
buffer_load_dwordx4 v96,s[16:19],s20 offen lds
s_waitcnt vmcnt(30)
ds_read_b64_tr_b16 a[72:73],v97
ds_read_b64_tr_b16 a[74:75],v97 offset:1024
ds_read_b64_tr_b16 a[232:233],v98
ds_read_b64_tr_b16 a[234:235],v98 offset:1024
s_waitcnt lgkmcnt(8)
s_add_u32 s20,s42,4456448
s_add_u32 s23,s22,32768
s_mov_b32 m0,s23
s_nop 0
buffer_load_dwordx4 v96,s[16:19],s20 offen lds
s_add_u32 s23,s22,33792
s_mov_b32 m0,s23
s_add_u32 s20,s20,65536
buffer_load_dwordx4 v96,s[16:19],s20 offen lds
s_waitcnt vmcnt(30)
ds_read_b64_tr_b16 a[76:77],v97 offset:2048
ds_read_b64_tr_b16 a[78:79],v97 offset:3072
ds_read_b64_tr_b16 a[236:237],v98 offset:2048
ds_read_b64_tr_b16 a[238:239],v98 offset:3072
s_waitcnt lgkmcnt(8)
s_add_u32 s20,s42,4587520
s_add_u32 s23,s22,34816
s_mov_b32 m0,s23
s_nop 0
buffer_load_dwordx4 v96,s[16:19],s20 offen lds
s_add_u32 s23,s22,35840
s_mov_b32 m0,s23
s_add_u32 s20,s20,65536
buffer_load_dwordx4 v96,s[16:19],s20 offen lds
s_waitcnt vmcnt(30)
ds_read_b64_tr_b16 a[80:81],v97 offset:4096
ds_read_b64_tr_b16 a[82:83],v97 offset:5120
ds_read_b64_tr_b16 a[240:241],v98 offset:4096
ds_read_b64_tr_b16 a[242:243],v98 offset:5120
s_waitcnt lgkmcnt(8)
s_add_u32 s20,s42,4718592
s_add_u32 s23,s22,0
s_mov_b32 m0,s23
s_nop 0
buffer_load_dwordx4 v96,s[16:19],s20 offen lds
s_add_u32 s23,s22,1024
s_mov_b32 m0,s23
s_add_u32 s20,s20,65536
buffer_load_dwordx4 v96,s[16:19],s20 offen lds
s_waitcnt vmcnt(30)
ds_read_b64_tr_b16 a[84:85],v97 offset:6144
ds_read_b64_tr_b16 a[86:87],v97 offset:7168
ds_read_b64_tr_b16 a[244:245],v98 offset:6144
ds_read_b64_tr_b16 a[246:247],v98 offset:7168
s_waitcnt lgkmcnt(8)
s_add_u32 s20,s42,4849664
s_add_u32 s23,s22,2048
s_mov_b32 m0,s23
s_nop 0
buffer_load_dwordx4 v96,s[16:19],s20 offen lds
s_add_u32 s23,s22,3072
s_mov_b32 m0,s23
s_add_u32 s20,s20,65536
buffer_load_dwordx4 v96,s[16:19],s20 offen lds
s_waitcnt vmcnt(30)
ds_read_b64_tr_b16 a[88:89],v97 offset:8192
ds_read_b64_tr_b16 a[90:91],v97 offset:9216
ds_read_b64_tr_b16 a[248:249],v98 offset:8192
ds_read_b64_tr_b16 a[250:251],v98 offset:9216
s_waitcnt lgkmcnt(8)
s_add_u32 s20,s42,4980736
s_add_u32 s23,s22,4096
s_mov_b32 m0,s23
s_nop 0
buffer_load_dwordx4 v96,s[16:19],s20 offen lds
s_add_u32 s23,s22,5120
s_mov_b32 m0,s23
s_add_u32 s20,s20,65536
buffer_load_dwordx4 v96,s[16:19],s20 offen lds
s_waitcnt vmcnt(30)
ds_read_b64_tr_b16 a[92:93],v97 offset:10240
ds_read_b64_tr_b16 a[94:95],v97 offset:11264
ds_read_b64_tr_b16 a[252:253],v98 offset:10240
ds_read_b64_tr_b16 a[254:255],v98 offset:11264
s_waitcnt lgkmcnt(8)
s_add_u32 s20,s42,5111808
s_add_u32 s23,s22,6144
s_mov_b32 m0,s23
s_nop 0
buffer_load_dwordx4 v96,s[16:19],s20 offen lds
s_add_u32 s23,s22,7168
s_mov_b32 m0,s23
s_add_u32 s20,s20,65536
buffer_load_dwordx4 v96,s[16:19],s20 offen lds
s_waitcnt vmcnt(30)
ds_read_b64_tr_b16 a[96:97],v97 offset:12288
ds_read_b64_tr_b16 a[98:99],v97 offset:13312
ds_read_b64_tr_b16 v[192:193],v98 offset:12288
ds_read_b64_tr_b16 v[194:195],v98 offset:13312
s_waitcnt vmcnt(28)
ds_read_b64_tr_b16 a[100:101],v97 offset:14336
ds_read_b64_tr_b16 a[102:103],v97 offset:15360
ds_read_b64_tr_b16 v[196:197],v98 offset:14336
ds_read_b64_tr_b16 v[198:199],v98 offset:15360
s_waitcnt vmcnt(26)
ds_read_b64_tr_b16 a[104:105],v97 offset:16384
ds_read_b64_tr_b16 a[106:107],v97 offset:17408
ds_read_b64_tr_b16 v[200:201],v98 offset:16384
ds_read_b64_tr_b16 v[202:203],v98 offset:17408
s_waitcnt vmcnt(24)
ds_read_b64_tr_b16 a[108:109],v97 offset:18432
ds_read_b64_tr_b16 a[110:111],v97 offset:19456
ds_read_b64_tr_b16 v[204:205],v98 offset:18432
ds_read_b64_tr_b16 v[206:207],v98 offset:19456
s_waitcnt vmcnt(22)
ds_read_b64_tr_b16 a[112:113],v97 offset:20480
ds_read_b64_tr_b16 a[114:115],v97 offset:21504
ds_read_b64_tr_b16 v[208:209],v98 offset:20480
ds_read_b64_tr_b16 v[210:211],v98 offset:21504
s_waitcnt vmcnt(20)
ds_read_b64_tr_b16 a[116:117],v97 offset:22528
ds_read_b64_tr_b16 a[118:119],v97 offset:23552
ds_read_b64_tr_b16 v[212:213],v98 offset:22528
ds_read_b64_tr_b16 v[214:215],v98 offset:23552
s_waitcnt vmcnt(18)
ds_read_b64_tr_b16 a[120:121],v97 offset:24576
ds_read_b64_tr_b16 a[122:123],v97 offset:25600
ds_read_b64_tr_b16 v[216:217],v98 offset:24576
ds_read_b64_tr_b16 v[218:219],v98 offset:25600
s_waitcnt vmcnt(16)
ds_read_b64_tr_b16 a[124:125],v97 offset:26624
ds_read_b64_tr_b16 a[126:127],v97 offset:27648
ds_read_b64_tr_b16 v[220:221],v98 offset:26624
ds_read_b64_tr_b16 v[222:223],v98 offset:27648
s_waitcnt vmcnt(14)
ds_read_b64_tr_b16 a[128:129],v97 offset:28672
ds_read_b64_tr_b16 a[130:131],v97 offset:29696
ds_read_b64_tr_b16 v[224:225],v98 offset:28672
ds_read_b64_tr_b16 v[226:227],v98 offset:29696
s_waitcnt vmcnt(12)
ds_read_b64_tr_b16 a[132:133],v97 offset:30720
ds_read_b64_tr_b16 a[134:135],v97 offset:31744
ds_read_b64_tr_b16 v[228:229],v98 offset:30720
ds_read_b64_tr_b16 v[230:231],v98 offset:31744
s_waitcnt vmcnt(10)
ds_read_b64_tr_b16 a[136:137],v97 offset:32768
ds_read_b64_tr_b16 a[138:139],v97 offset:33792
ds_read_b64_tr_b16 v[232:233],v98 offset:32768
ds_read_b64_tr_b16 v[234:235],v98 offset:33792
s_waitcnt vmcnt(8)
ds_read_b64_tr_b16 a[140:141],v97 offset:34816
ds_read_b64_tr_b16 a[142:143],v97 offset:35840
ds_read_b64_tr_b16 v[236:237],v98 offset:34816
ds_read_b64_tr_b16 v[238:239],v98 offset:35840
s_waitcnt vmcnt(6)
ds_read_b64_tr_b16 a[144:145],v97
ds_read_b64_tr_b16 a[146:147],v97 offset:1024
ds_read_b64_tr_b16 v[240:241],v98
ds_read_b64_tr_b16 v[242:243],v98 offset:1024
s_waitcnt vmcnt(4)
ds_read_b64_tr_b16 a[148:149],v97 offset:2048
ds_read_b64_tr_b16 a[150:151],v97 offset:3072
ds_read_b64_tr_b16 v[244:245],v98 offset:2048
ds_read_b64_tr_b16 v[246:247],v98 offset:3072
s_waitcnt vmcnt(2)
ds_read_b64_tr_b16 a[152:153],v97 offset:4096
ds_read_b64_tr_b16 a[154:155],v97 offset:5120
ds_read_b64_tr_b16 v[248:249],v98 offset:4096
ds_read_b64_tr_b16 v[250:251],v98 offset:5120
s_waitcnt vmcnt(0)
ds_read_b64_tr_b16 a[156:157],v97 offset:6144
ds_read_b64_tr_b16 a[158:159],v97 offset:7168
ds_read_b64_tr_b16 v[252:253],v98 offset:6144
ds_read_b64_tr_b16 v[254:255],v98 offset:7168
s_waitcnt lgkmcnt(0)
s_barrier
v_mov_b32 v96,68
s_mov_b32 s99,128
s_mov_b32 s38,0
poll_122:
buffer_load_dword v97,v96,s[12:15],0 offen sc1
s_waitcnt vmcnt(0)
v_cmp_le_u32 vcc,s99,v97
s_nop 0
s_cmp_eq_u64 vcc,-1
s_nop 1
s_cbranch_scc1 polld_123
s_sleep 8
s_add_u32 s38,s38,1
s_cmp_lt_u32 s38,100000
s_cbranch_scc1 poll_122
s_mov_b32 s40,14
s_branch L_fail
polld_123:
v_readfirstlane_b32 s99,v97
s_nop 0
s_and_b32 s99,s99,1
s_lshl_b32 s99,s99,13
v_and_b32 v9,31,v0
v_lshrrev_b32 v5,5,v0
v_mul_u32_u24 v7,2560,v5
v_lshl_add_u32 v7,v9,3,v7
s_lshl_b32 s43,s3,10
v_mov_b32 v80,0x3f803f80
v_mov_b32 v81,0x3f803f80
v_mov_b32 v82,0x3f803f80
v_mov_b32 v83,0x3f803f80
s_nop 1
v_mfma_f32_32x32x16_bf16 v[48:63],a[0:3],v[80:83],0
v_mfma_f32_32x32x16_bf16 v[48:63],a[4:7],v[80:83],v[48:63]
v_mfma_f32_32x32x16_bf16 v[48:63],a[8:11],v[80:83],v[48:63]
v_mfma_f32_32x32x16_bf16 v[48:63],a[12:15],v[80:83],v[48:63]
v_mfma_f32_32x32x16_bf16 v[48:63],a[16:19],v[80:83],v[48:63]
v_mfma_f32_32x32x16_bf16 v[48:63],a[20:23],v[80:83],v[48:63]
v_mfma_f32_32x32x16_bf16 v[48:63],a[24:27],v[80:83],v[48:63]
v_mfma_f32_32x32x16_bf16 v[48:63],a[28:31],v[80:83],v[48:63]
v_mfma_f32_32x32x16_bf16 v[48:63],a[32:35],v[80:83],v[48:63]
v_mfma_f32_32x32x16_bf16 v[48:63],a[36:39],v[80:83],v[48:63]
v_mfma_f32_32x32x16_bf16 v[48:63],a[40:43],v[80:83],v[48:63]
v_mfma_f32_32x32x16_bf16 v[48:63],a[44:47],v[80:83],v[48:63]
v_mfma_f32_32x32x16_bf16 v[48:63],a[48:51],v[80:83],v[48:63]
v_mfma_f32_32x32x16_bf16 v[48:63],a[52:55],v[80:83],v[48:63]
v_mfma_f32_32x32x16_bf16 v[48:63],a[56:59],v[80:83],v[48:63]
v_mfma_f32_32x32x16_bf16 v[48:63],a[60:63],v[80:83],v[48:63]
v_mfma_f32_32x32x16_bf16 v[48:63],a[64:67],v[80:83],v[48:63]
v_mfma_f32_32x32x16_bf16 v[48:63],a[68:71],v[80:83],v[48:63]
v_mfma_f32_32x32x16_bf16 v[48:63],a[72:75],v[80:83],v[48:63]
v_mfma_f32_32x32x16_bf16 v[48:63],a[76:79],v[80:83],v[48:63]
v_mfma_f32_32x32x16_bf16 v[48:63],a[80:83],v[80:83],v[48:63]
v_mfma_f32_32x32x16_bf16 v[48:63],a[84:87],v[80:83],v[48:63]
v_mfma_f32_32x32x16_bf16 v[48:63],a[88:91],v[80:83],v[48:63]
v_mfma_f32_32x32x16_bf16 v[48:63],a[92:95],v[80:83],v[48:63]
v_mfma_f32_32x32x16_bf16 v[48:63],a[96:99],v[80:83],v[48:63]
v_mfma_f32_32x32x16_bf16 v[48:63],a[100:103],v[80:83],v[48:63]
v_mfma_f32_32x32x16_bf16 v[48:63],a[104:107],v[80:83],v[48:63]
v_mfma_f32_32x32x16_bf16 v[48:63],a[108:111],v[80:83],v[48:63]
v_mfma_f32_32x32x16_bf16 v[48:63],a[112:115],v[80:83],v[48:63]
v_mfma_f32_32x32x16_bf16 v[48:63],a[116:119],v[80:83],v[48:63]
v_mfma_f32_32x32x16_bf16 v[48:63],a[120:123],v[80:83],v[48:63]
v_mfma_f32_32x32x16_bf16 v[48:63],a[124:127],v[80:83],v[48:63]
v_mfma_f32_32x32x16_bf16 v[48:63],a[128:131],v[80:83],v[48:63]
v_mfma_f32_32x32x16_bf16 v[48:63],a[132:135],v[80:83],v[48:63]
v_mfma_f32_32x32x16_bf16 v[48:63],a[136:139],v[80:83],v[48:63]
v_mfma_f32_32x32x16_bf16 v[48:63],a[140:143],v[80:83],v[48:63]
v_mfma_f32_32x32x16_bf16 v[48:63],a[144:147],v[80:83],v[48:63]
v_mfma_f32_32x32x16_bf16 v[48:63],a[148:151],v[80:83],v[48:63]
v_mfma_f32_32x32x16_bf16 v[48:63],a[152:155],v[80:83],v[48:63]
v_mfma_f32_32x32x16_bf16 v[48:63],a[156:159],v[80:83],v[48:63]
v_mfma_f32_32x32x16_bf16 v[64:79],a[160:163],v[80:83],0
v_mfma_f32_32x32x16_bf16 v[64:79],a[164:167],v[80:83],v[64:79]
v_mfma_f32_32x32x16_bf16 v[64:79],a[168:171],v[80:83],v[64:79]
v_mfma_f32_32x32x16_bf16 v[64:79],a[172:175],v[80:83],v[64:79]
v_mfma_f32_32x32x16_bf16 v[64:79],a[176:179],v[80:83],v[64:79]
v_mfma_f32_32x32x16_bf16 v[64:79],a[180:183],v[80:83],v[64:79]
v_mfma_f32_32x32x16_bf16 v[64:79],a[184:187],v[80:83],v[64:79]
v_mfma_f32_32x32x16_bf16 v[64:79],a[188:191],v[80:83],v[64:79]
v_mfma_f32_32x32x16_bf16 v[64:79],a[192:195],v[80:83],v[64:79]
v_mfma_f32_32x32x16_bf16 v[64:79],a[196:199],v[80:83],v[64:79]
v_mfma_f32_32x32x16_bf16 v[64:79],a[200:203],v[80:83],v[64:79]
v_mfma_f32_32x32x16_bf16 v[64:79],a[204:207],v[80:83],v[64:79]
v_mfma_f32_32x32x16_bf16 v[64:79],a[208:211],v[80:83],v[64:79]
v_mfma_f32_32x32x16_bf16 v[64:79],a[212:215],v[80:83],v[64:79]
v_mfma_f32_32x32x16_bf16 v[64:79],a[216:219],v[80:83],v[64:79]
v_mfma_f32_32x32x16_bf16 v[64:79],a[220:223],v[80:83],v[64:79]
v_mfma_f32_32x32x16_bf16 v[64:79],a[224:227],v[80:83],v[64:79]
v_mfma_f32_32x32x16_bf16 v[64:79],a[228:231],v[80:83],v[64:79]
v_mfma_f32_32x32x16_bf16 v[64:79],a[232:235],v[80:83],v[64:79]
v_mfma_f32_32x32x16_bf16 v[64:79],a[236:239],v[80:83],v[64:79]
v_mfma_f32_32x32x16_bf16 v[64:79],a[240:243],v[80:83],v[64:79]
v_mfma_f32_32x32x16_bf16 v[64:79],a[244:247],v[80:83],v[64:79]
v_mfma_f32_32x32x16_bf16 v[64:79],a[248:251],v[80:83],v[64:79]
v_mfma_f32_32x32x16_bf16 v[64:79],a[252:255],v[80:83],v[64:79]
v_mfma_f32_32x32x16_bf16 v[64:79],v[192:195],v[80:83],v[64:79]
v_mfma_f32_32x32x16_bf16 v[64:79],v[196:199],v[80:83],v[64:79]
v_mfma_f32_32x32x16_bf16 v[64:79],v[200:203],v[80:83],v[64:79]
v_mfma_f32_32x32x16_bf16 v[64:79],v[204:207],v[80:83],v[64:79]
v_mfma_f32_32x32x16_bf16 v[64:79],v[208:211],v[80:83],v[64:79]
v_mfma_f32_32x32x16_bf16 v[64:79],v[212:215],v[80:83],v[64:79]
v_mfma_f32_32x32x16_bf16 v[64:79],v[216:219],v[80:83],v[64:79]
v_mfma_f32_32x32x16_bf16 v[64:79],v[220:223],v[80:83],v[64:79]
v_mfma_f32_32x32x16_bf16 v[64:79],v[224:227],v[80:83],v[64:79]
v_mfma_f32_32x32x16_bf16 v[64:79],v[228:231],v[80:83],v[64:79]
v_mfma_f32_32x32x16_bf16 v[64:79],v[232:235],v[80:83],v[64:79]
v_mfma_f32_32x32x16_bf16 v[64:79],v[236:239],v[80:83],v[64:79]
v_mfma_f32_32x32x16_bf16 v[64:79],v[240:243],v[80:83],v[64:79]
v_mfma_f32_32x32x16_bf16 v[64:79],v[244:247],v[80:83],v[64:79]
v_mfma_f32_32x32x16_bf16 v[64:79],v[248:251],v[80:83],v[64:79]
v_mfma_f32_32x32x16_bf16 v[64:79],v[252:255],v[80:83],v[64:79]
v_mov_b32 v160,0xc0135761
v_mov_b32 v161,0xc0135761
v_mov_b32 v162,0xbdd2d3e8
v_mov_b32 v163,0xbdd2d3e8
s_mov_b32 s48,0x3acccccd
s_mov_b32 s49,0x3727c5ac
s_mov_b32 s35,0
s_cmp_lt_u32 s41,64
s_cselect_b32 s47,0x3e0293ee,1.0
s_mov_b32 s28,0
s_mov_b32 s63,64
s_nop 0
ns_init_124:
v_min_u32 v3,19,v0
v_lshlrev_b32 v3,7,v3
s_mul_i32 s42,s39,0x48000
s_add_u32 s42,s42,0x10000
s_lshl_b32 s101,s39,13
s_xor_b32 s101,s101,s99
s_xor_b32 s101,s101,8192
s_add_u32 s42,s42,s101
v_add_u32 v3,s42,v3
s_mul_i32 s37,s39,0x48000
s_add_u32 s37,s37,0x18000
s_lshl_b32 s101,s39,13
s_xor_b32 s101,s101,s99
s_xor_b32 s101,s101,8192
s_add_u32 s37,s37,s101
s_and_b32 s42,s41,63
s_lshl_b32 s42,s42,7
s_add_u32 s37,s37,s42
s_lshr_b32 s42,s41,6
s_lshl_b32 s42,s42,4
s_add_u32 s37,s37,s42
s_lshl_b32 s42,s65,2
s_add_u32 s37,s37,s42
s_mul_i32 s66,s39,0x300000
s_add_u32 s66,s66,0x3500000
s_add_u32 s66,s66,s43
s_mov_b32 s67,s66
s_mul_i32 s68,s39,0x3000000
s_add_u32 s68,s68,0x7ab0000
s_bfe_u32 s42,s41,0x10005
s_mul_i32 s42,s42,393216
s_add_u32 s68,s68,s42
s_lshr_b32 s42,s41,6
s_lshl_b32 s42,s42,17
s_add_u32 s68,s68,s42
s_and_b32 s42,s41,31
s_lshl_b32 s42,s42,12
s_add_u32 s68,s68,s42
s_cmp_eq_u32 s39,0
s_cbranch_scc1 ns_stream_125
s_waitcnt vmcnt(0) lgkmcnt(0)
s_getpc_b64 s[60:61]
pc_128:
s_add_u32 s60,s60,ns_top_126-pc_128
s_addc_u32 s61,s61,0
s_mov_b32 s59,ns_fin_127-ns_top_126-4
v_lshlrev_b32 v98,7,v0
v_add_u32 v98,0,v98
v_min_u32 v98,s59,v98
v_mov_b32 v97,s61
v_add_co_u32 v96,vcc,s60,v98
s_nop 1
v_addc_co_u32 v97,vcc,0,v97,vcc
global_load_dword v99,v[96:97],off
s_waitcnt vmcnt(0)
s_mov_b32 s30,0
s_add_u32 s31,s28,1
s_mul_i32 s42,s28,49152
s_add_u32 s32,s66,s42
s_add_u32 s33,s67,s42
s_mov_b32 s38,0
poll_129:
buffer_load_dword v4,v3,s[4:7],0 offen sc1
s_waitcnt vmcnt(0)
v_cmp_le_u32 vcc,s31,v4
s_nop 0
s_cmp_eq_u64 vcc,-1
s_nop 1
s_cbranch_scc1 polld_130
s_sleep 2
s_add_u32 s38,s38,1
s_cmp_lt_u32 s38,100000
s_cbranch_scc1 poll_129
s_mov_b32 s40,1
s_branch L_fail
polld_130:
s_add_u32 s44,s35,s43
s_add_u32 s46,s44,0
s_mov_b32 m0,s46
s_add_u32 s46,s32,0
buffer_load_dwordx4 v1,s[4:7],s46 offen sc1 lds
s_add_u32 s46,s44,4096
s_mov_b32 m0,s46
s_add_u32 s46,s32,4096
buffer_load_dwordx4 v1,s[4:7],s46 offen sc1 lds
s_add_u32 s46,s44,8192
s_mov_b32 m0,s46
s_add_u32 s46,s32,8192
buffer_load_dwordx4 v1,s[4:7],s46 offen sc1 lds
s_add_u32 s46,s44,40960
s_mov_b32 m0,s46
s_add_u32 s46,s33,40960
buffer_load_dwordx4 v1,s[4:7],s46 offen sc1 lds
s_add_u32 s46,s44,45056
s_mov_b32 m0,s46
s_add_u32 s46,s33,45056
buffer_load_dwordx4 v1,s[4:7],s46 offen sc1 lds
s_add_u32 s46,s44,12288
s_mov_b32 m0,s46
s_add_u32 s46,s32,12288
buffer_load_dwordx4 v1,s[4:7],s46 offen sc1 lds
s_add_u32 s46,s44,16384
s_mov_b32 m0,s46
s_add_u32 s46,s32,16384
buffer_load_dwordx4 v1,s[4:7],s46 offen sc1 lds
s_add_u32 s46,s44,20480
s_mov_b32 m0,s46
s_add_u32 s46,s32,20480
buffer_load_dwordx4 v1,s[4:7],s46 offen sc1 lds
s_add_u32 s46,s44,24576
s_mov_b32 m0,s46
s_add_u32 s46,s32,24576
buffer_load_dwordx4 v1,s[4:7],s46 offen sc1 lds
s_add_u32 s46,s44,28672
s_mov_b32 m0,s46
s_add_u32 s46,s32,28672
buffer_load_dwordx4 v1,s[4:7],s46 offen sc1 lds
s_add_u32 s46,s44,32768
s_mov_b32 m0,s46
s_add_u32 s46,s32,32768
buffer_load_dwordx4 v1,s[4:7],s46 offen sc1 lds
s_add_u32 s46,s44,36864
s_mov_b32 m0,s46
s_add_u32 s46,s32,36864
buffer_load_dwordx4 v1,s[4:7],s46 offen sc1 lds
s_mov_b32 s34,1
ns_top_126:
v_add_u32 v6,s35,v1
s_add_u32 s62,s28,1
s_mul_i32 s36,s28,786432
s_add_u32 s36,s36,s68
s_add_u32 s31,s62,1
s_mul_i32 s42,s62,49152
s_add_u32 s32,s66,s42
s_add_u32 s33,s67,s42
s_xor_b32 s44,s35,49152
s_add_u32 s44,s44,s43
s_cmp_eq_u32 s34,0
s_cbranch_scc1 ns_s_131
s_waitcnt vmcnt(9)
ns_s_131:
s_barrier
ds_read_b128 v[80:83],v6
ds_read_b128 v[84:87],v6 offset:1024
ds_read_b128 v[88:91],v6 offset:2048
v_cmp_le_u32 vcc,s31,v4
s_nop 0
s_cmp_eq_u64 vcc,-1
s_cselect_b64 vcc,-1,0
s_cmp_lt_u32 s62,s63
s_cselect_b64 vcc,vcc,0
s_cmp_eq_u32 s34,0
s_cselect_b64 vcc,vcc,0
s_and_b32 s29,vcc_lo,1
ds_read_b128 v[92:95],v6 offset:3072
s_waitcnt lgkmcnt(3)
v_mfma_f32_32x32x16_bf16 v[16:31],a[0:3],v[80:83],0
s_cbranch_vccz ns_d_132
s_add_u32 s46,s44,0
s_mov_b32 m0,s46
s_add_u32 s46,s32,0
buffer_load_dwordx4 v1,s[4:7],s46 offen sc1 lds
ns_d_132:
v_mfma_f32_32x32x16_bf16 v[32:47],a[160:163],v[80:83],0
ds_read_b128 v[80:83],v6 offset:4096
s_waitcnt lgkmcnt(3)
v_mfma_f32_32x32x16_bf16 v[16:31],a[4:7],v[84:87],v[16:31]
s_cbranch_vccz ns_d_133
s_add_u32 s46,s44,4096
s_mov_b32 m0,s46
s_add_u32 s46,s32,4096
buffer_load_dwordx4 v1,s[4:7],s46 offen sc1 lds
ns_d_133:
v_mfma_f32_32x32x16_bf16 v[32:47],a[164:167],v[84:87],v[32:47]
ds_read_b128 v[84:87],v6 offset:5120
s_waitcnt lgkmcnt(3)
v_mfma_f32_32x32x16_bf16 v[16:31],a[8:11],v[88:91],v[16:31]
s_cbranch_vccz ns_d_134
s_add_u32 s46,s44,8192
s_mov_b32 m0,s46
s_add_u32 s46,s32,8192
buffer_load_dwordx4 v1,s[4:7],s46 offen sc1 lds
ns_d_134:
v_mfma_f32_32x32x16_bf16 v[32:47],a[168:171],v[88:91],v[32:47]
ds_read_b128 v[88:91],v6 offset:6144
s_waitcnt lgkmcnt(3)
v_mfma_f32_32x32x16_bf16 v[16:31],a[12:15],v[92:95],v[16:31]
s_cbranch_vccz ns_d_135
s_add_u32 s46,s44,40960
s_mov_b32 m0,s46
s_add_u32 s46,s33,40960
buffer_load_dwordx4 v1,s[4:7],s46 offen sc1 lds
ns_d_135:
v_mfma_f32_32x32x16_bf16 v[32:47],a[172:175],v[92:95],v[32:47]
ds_read_b128 v[92:95],v6 offset:7168
s_waitcnt lgkmcnt(3)
v_mfma_f32_32x32x16_bf16 v[16:31],a[16:19],v[80:83],v[16:31]
s_cbranch_vccz ns_d_136
s_add_u32 s46,s44,45056
s_mov_b32 m0,s46
s_add_u32 s46,s33,45056
buffer_load_dwordx4 v1,s[4:7],s46 offen sc1 lds
ns_d_136:
v_mfma_f32_32x32x16_bf16 v[32:47],a[176:179],v[80:83],v[32:47]
ds_read_b128 v[80:83],v6 offset:8192
s_waitcnt lgkmcnt(3)
v_mfma_f32_32x32x16_bf16 v[16:31],a[20:23],v[84:87],v[16:31]
s_cbranch_vccz ns_d_137
s_add_u32 s46,s44,12288
s_mov_b32 m0,s46
s_add_u32 s46,s32,12288
buffer_load_dwordx4 v1,s[4:7],s46 offen sc1 lds
ns_d_137:
v_mfma_f32_32x32x16_bf16 v[32:47],a[180:183],v[84:87],v[32:47]
ds_read_b128 v[84:87],v6 offset:9216
s_waitcnt lgkmcnt(3)
v_mfma_f32_32x32x16_bf16 v[16:31],a[24:27],v[88:91],v[16:31]
s_cbranch_vccz ns_d_138
s_add_u32 s46,s44,16384
s_mov_b32 m0,s46
s_add_u32 s46,s32,16384
buffer_load_dwordx4 v1,s[4:7],s46 offen sc1 lds
ns_d_138:
v_mfma_f32_32x32x16_bf16 v[32:47],a[184:187],v[88:91],v[32:47]
ds_read_b128 v[88:91],v6 offset:10240
s_waitcnt lgkmcnt(3)
v_mfma_f32_32x32x16_bf16 v[16:31],a[28:31],v[92:95],v[16:31]
s_cbranch_vccz ns_d_139
s_add_u32 s46,s44,20480
s_mov_b32 m0,s46
s_add_u32 s46,s32,20480
buffer_load_dwordx4 v1,s[4:7],s46 offen sc1 lds
ns_d_139:
v_mfma_f32_32x32x16_bf16 v[32:47],a[188:191],v[92:95],v[32:47]
ds_read_b128 v[92:95],v6 offset:11264
s_waitcnt lgkmcnt(3)
v_mfma_f32_32x32x16_bf16 v[16:31],a[32:35],v[80:83],v[16:31]
s_cbranch_vccz ns_d_140
s_add_u32 s46,s44,24576
s_mov_b32 m0,s46
s_add_u32 s46,s32,24576
buffer_load_dwordx4 v1,s[4:7],s46 offen sc1 lds
ns_d_140:
v_mfma_f32_32x32x16_bf16 v[32:47],a[192:195],v[80:83],v[32:47]
s_cmp_eq_u32 s34,0
s_cbranch_scc1 ns_s_141
s_waitcnt vmcnt(3)
ns_s_141:
s_barrier
ds_read_b128 v[80:83],v6 offset:12288
s_waitcnt lgkmcnt(3)
v_mfma_f32_32x32x16_bf16 v[16:31],a[36:39],v[84:87],v[16:31]
s_cbranch_vccz ns_d_142
s_add_u32 s46,s44,28672
s_mov_b32 m0,s46
s_add_u32 s46,s32,28672
buffer_load_dwordx4 v1,s[4:7],s46 offen sc1 lds
ns_d_142:
v_add_u32 v5,s35,v7
v_mfma_f32_32x32x16_bf16 v[32:47],a[196:199],v[84:87],v[32:47]
ds_read_b64 v[96:97],v5 offset:40960
ds_read_b64 v[98:99],v5 offset:41216
ds_read_b64 v[100:101],v5 offset:41472
ds_read_b128 v[84:87],v6 offset:13312
s_waitcnt lgkmcnt(6)
v_mfma_f32_32x32x16_bf16 v[16:31],a[40:43],v[88:91],v[16:31]
s_cbranch_vccz ns_d_143
s_add_u32 s46,s44,32768
s_mov_b32 m0,s46
s_add_u32 s46,s32,32768
buffer_load_dwordx4 v1,s[4:7],s46 offen sc1 lds
ns_d_143:
ds_read_b64 v[102:103],v5 offset:41728
v_mfma_f32_32x32x16_bf16 v[32:47],a[200:203],v[88:91],v[32:47]
ds_read_b64 v[104:105],v5 offset:41984
ds_read_b64 v[106:107],v5 offset:42240
ds_read_b64 v[108:109],v5 offset:42496
ds_read_b128 v[88:91],v6 offset:14336
s_waitcnt lgkmcnt(10)
v_mfma_f32_32x32x16_bf16 v[16:31],a[44:47],v[92:95],v[16:31]
s_cbranch_vccz ns_d_144
s_add_u32 s46,s44,36864
s_mov_b32 m0,s46
s_add_u32 s46,s32,36864
buffer_load_dwordx4 v1,s[4:7],s46 offen sc1 lds
ns_d_144:
ds_read_b64 v[110:111],v5 offset:42752
v_mfma_f32_32x32x16_bf16 v[32:47],a[204:207],v[92:95],v[32:47]
ds_read_b64 v[112:113],v5 offset:43008
ds_read_b64 v[114:115],v5 offset:43264
ds_read_b128 v[92:95],v6 offset:15360
s_waitcnt lgkmcnt(13)
v_mfma_f32_32x32x16_bf16 v[16:31],a[48:51],v[80:83],v[16:31]
v_mfma_f32_32x32x16_bf16 v[32:47],a[208:211],v[80:83],v[32:47]
s_cmp_eq_u32 s30,0
s_cbranch_scc1 ns_np_145
s_waitcnt vmcnt(12)
s_cbranch_vccnz ns_w0_146
s_waitcnt vmcnt(0)
ns_w0_146:
v_mov_b32 v2,s64
s_mov_b64 exec,1
buffer_store_dword v2,off,s[24:27],s37 sc1
s_mov_b64 exec,-1
s_mov_b32 s30,0
ns_np_145:
ds_read_b128 v[80:83],v6 offset:16384
s_waitcnt lgkmcnt(10)
v_mfma_f32_32x32x16_bf16 v[16:31],a[52:55],v[84:87],v[16:31]
s_waitcnt lgkmcnt(2)
v_add_f32 v96,v96,v106
v_add_f32 v97,v97,v107
v_mfma_f32_32x32x16_bf16 v[32:47],a[212:215],v[84:87],v[32:47]
v_add_f32 v98,v98,v108
v_add_f32 v99,v99,v109
v_add_f32 v100,v100,v110
ds_read_b128 v[84:87],v6 offset:17408
v_mfma_f32_32x32x16_bf16 v[16:31],a[56:59],v[88:91],v[16:31]
v_add_f32 v101,v101,v111
v_add_f32 v102,v102,v112
v_add_f32 v103,v103,v113
v_mfma_f32_32x32x16_bf16 v[32:47],a[216:219],v[88:91],v[32:47]
v_add_f32 v104,v104,v114
v_add_f32 v105,v105,v115
v_add_f32 v96,v96,v100
ds_read_b128 v[88:91],v6 offset:18432
s_waitcnt lgkmcnt(3)
v_mfma_f32_32x32x16_bf16 v[16:31],a[60:63],v[92:95],v[16:31]
v_add_f32 v97,v97,v101
v_add_f32 v98,v98,v102
v_add_f32 v99,v99,v103
v_mfma_f32_32x32x16_bf16 v[32:47],a[220:223],v[92:95],v[32:47]
v_add_f32 v104,v104,v96
v_add_f32 v105,v105,v97
v_add_f32 v12,v104,v98
ds_read_b128 v[92:95],v6 offset:19456
s_waitcnt lgkmcnt(3)
v_mfma_f32_32x32x16_bf16 v[16:31],a[64:67],v[80:83],v[16:31]
v_add_f32 v13,v105,v99
v_mov_b32 v96,v12
v_mov_b32 v97,v13
v_mfma_f32_32x32x16_bf16 v[32:47],a[224:227],v[80:83],v[32:47]
ds_read_b128 v[80:83],v6 offset:20480
s_waitcnt lgkmcnt(3)
v_mfma_f32_32x32x16_bf16 v[16:31],a[68:71],v[84:87],v[16:31]
v_permlane32_swap_b32 v12,v96
v_permlane32_swap_b32 v13,v97
v_mfma_f32_32x32x16_bf16 v[32:47],a[228:231],v[84:87],v[32:47]
v_add_f32 v12,v12,v96
v_add_f32 v13,v13,v97
v_mul_f32 v12,s48,v12
ds_read_b128 v[84:87],v6 offset:21504
s_waitcnt lgkmcnt(3)
v_mfma_f32_32x32x16_bf16 v[16:31],a[72:75],v[88:91],v[16:31]
v_mul_f32 v13,s48,v13
v_fma_f32 v13,-v12,v12,v13
v_max_f32 v13,0,v13
v_mfma_f32_32x32x16_bf16 v[32:47],a[232:235],v[88:91],v[32:47]
v_add_f32 v96,s49,v13
v_rsq_f32 v10,v96
ds_read_b128 v[88:91],v6 offset:22528
s_waitcnt lgkmcnt(3)
v_mfma_f32_32x32x16_bf16 v[16:31],a[76:79],v[92:95],v[16:31]
v_mul_f32 v10,s47,v10
v_mul_f32 v11,v12,v10
v_mov_b32 v164,v10
v_mfma_f32_32x32x16_bf16 v[32:47],a[236:239],v[92:95],v[32:47]
v_mov_b32 v165,v10
v_mul_f32_e64 v96,-v11,v48
v_mul_f32_e64 v97,-v11,v49
ds_read_b128 v[92:95],v6 offset:23552
s_waitcnt lgkmcnt(3)
v_mfma_f32_32x32x16_bf16 v[16:31],a[80:83],v[80:83],v[16:31]
v_mul_f32_e64 v98,-v11,v50
v_mul_f32_e64 v99,-v11,v51
v_mul_f32_e64 v100,-v11,v52
v_mfma_f32_32x32x16_bf16 v[32:47],a[240:243],v[80:83],v[32:47]
v_mul_f32_e64 v101,-v11,v53
v_mul_f32_e64 v102,-v11,v54
v_mul_f32_e64 v103,-v11,v55
buffer_load_dword v4,v3,s[4:7],0 offen sc1
ds_read_b128 v[80:83],v6 offset:24576
s_waitcnt lgkmcnt(3)
v_mfma_f32_32x32x16_bf16 v[16:31],a[84:87],v[84:87],v[16:31]
v_mul_f32_e64 v104,-v11,v56
v_mul_f32_e64 v105,-v11,v57
v_mul_f32_e64 v106,-v11,v58
v_mfma_f32_32x32x16_bf16 v[32:47],a[244:247],v[84:87],v[32:47]
v_mul_f32_e64 v107,-v11,v59
v_mul_f32_e64 v108,-v11,v60
v_mul_f32_e64 v109,-v11,v61
ds_read_b128 v[84:87],v6 offset:25600
s_waitcnt lgkmcnt(3)
v_mfma_f32_32x32x16_bf16 v[16:31],a[88:91],v[88:91],v[16:31]
v_mul_f32_e64 v110,-v11,v62
v_mul_f32_e64 v111,-v11,v63
v_mul_f32_e64 v112,-v11,v64
v_mfma_f32_32x32x16_bf16 v[32:47],a[248:251],v[88:91],v[32:47]
v_mul_f32_e64 v113,-v11,v65
v_mul_f32_e64 v114,-v11,v66
v_mul_f32_e64 v115,-v11,v67
ds_read_b128 v[88:91],v6 offset:26624
s_waitcnt lgkmcnt(3)
v_mfma_f32_32x32x16_bf16 v[16:31],a[92:95],v[92:95],v[16:31]
v_mul_f32_e64 v116,-v11,v68
v_mul_f32_e64 v117,-v11,v69
v_mul_f32_e64 v118,-v11,v70
v_mfma_f32_32x32x16_bf16 v[32:47],a[252:255],v[92:95],v[32:47]
v_mul_f32_e64 v119,-v11,v71
v_mul_f32_e64 v120,-v11,v72
v_mul_f32_e64 v121,-v11,v73
ds_read_b128 v[92:95],v6 offset:27648
s_waitcnt lgkmcnt(3)
v_mfma_f32_32x32x16_bf16 v[16:31],a[96:99],v[80:83],v[16:31]
v_mul_f32_e64 v122,-v11,v74
v_mul_f32_e64 v123,-v11,v75
v_mul_f32_e64 v124,-v11,v76
v_mfma_f32_32x32x16_bf16 v[32:47],v[192:195],v[80:83],v[32:47]
v_mul_f32_e64 v125,-v11,v77
v_mul_f32_e64 v126,-v11,v78
v_mul_f32_e64 v127,-v11,v79
s_cmp_eq_u32 s34,0
s_cbranch_scc1 ns_s_147
s_waitcnt vmcnt(0)
ns_s_147:
s_barrier
ds_read_b128 v[80:83],v6 offset:28672
s_waitcnt lgkmcnt(3)
v_mfma_f32_32x32x16_bf16 v[16:31],a[100:103],v[84:87],v[16:31]
v_mfma_f32_32x32x16_bf16 v[32:47],v[196:199],v[84:87],v[32:47]
ds_read_b128 v[84:87],v6 offset:29696
s_waitcnt lgkmcnt(3)
v_mfma_f32_32x32x16_bf16 v[16:31],a[104:107],v[88:91],v[16:31]
v_mfma_f32_32x32x16_bf16 v[32:47],v[200:203],v[88:91],v[32:47]
ds_read_b128 v[88:91],v6 offset:30720
s_waitcnt lgkmcnt(3)
v_mfma_f32_32x32x16_bf16 v[16:31],a[108:111],v[92:95],v[16:31]
v_mfma_f32_32x32x16_bf16 v[32:47],v[204:207],v[92:95],v[32:47]
ds_read_b128 v[92:95],v6 offset:31744
s_waitcnt lgkmcnt(3)
v_mfma_f32_32x32x16_bf16 v[16:31],a[112:115],v[80:83],v[16:31]
v_mfma_f32_32x32x16_bf16 v[32:47],v[208:211],v[80:83],v[32:47]
ds_read_b128 v[80:83],v6 offset:32768
s_waitcnt lgkmcnt(3)
v_mfma_f32_32x32x16_bf16 v[16:31],a[116:119],v[84:87],v[16:31]
v_mfma_f32_32x32x16_bf16 v[32:47],v[212:215],v[84:87],v[32:47]
ds_read_b128 v[84:87],v6 offset:33792
s_waitcnt lgkmcnt(3)
v_mfma_f32_32x32x16_bf16 v[16:31],a[120:123],v[88:91],v[16:31]
v_mfma_f32_32x32x16_bf16 v[32:47],v[216:219],v[88:91],v[32:47]
ds_read_b128 v[88:91],v6 offset:34816
s_waitcnt lgkmcnt(3)
v_mfma_f32_32x32x16_bf16 v[16:31],a[124:127],v[92:95],v[16:31]
v_mfma_f32_32x32x16_bf16 v[32:47],v[220:223],v[92:95],v[32:47]
ds_read_b128 v[92:95],v6 offset:35840
s_waitcnt lgkmcnt(3)
v_mfma_f32_32x32x16_bf16 v[16:31],a[128:131],v[80:83],v[16:31]
v_mfma_f32_32x32x16_bf16 v[32:47],v[224:227],v[80:83],v[32:47]
ds_read_b128 v[80:83],v6 offset:36864
s_waitcnt lgkmcnt(3)
v_mfma_f32_32x32x16_bf16 v[16:31],a[132:135],v[84:87],v[16:31]
v_mfma_f32_32x32x16_bf16 v[32:47],v[228:231],v[84:87],v[32:47]
s_mov_b64 vcc,0
s_cmp_lg_u32 s29,0
s_cbranch_scc1 ns_sk_148
s_waitcnt vmcnt(0)
v_cmp_le_u32 vcc,s31,v4
s_nop 0
s_cmp_eq_u64 vcc,-1
s_cselect_b64 vcc,-1,0
s_cmp_lt_u32 s62,s63
s_cselect_b64 vcc,vcc,0
s_and_b32 s29,vcc_lo,1
ns_sk_148:
ds_read_b128 v[84:87],v6 offset:37888
s_waitcnt lgkmcnt(3)
v_mfma_f32_32x32x16_bf16 v[16:31],a[136:139],v[88:91],v[16:31]
s_cbranch_vccz ns_d_149
s_add_u32 s46,s44,0
s_mov_b32 m0,s46
s_add_u32 s46,s32,0
buffer_load_dwordx4 v1,s[4:7],s46 offen sc1 lds
ns_d_149:
v_mfma_f32_32x32x16_bf16 v[32:47],v[232:235],v[88:91],v[32:47]
s_cbranch_vccz ns_d_150
s_add_u32 s46,s44,4096
s_mov_b32 m0,s46
s_add_u32 s46,s32,4096
buffer_load_dwordx4 v1,s[4:7],s46 offen sc1 lds
ns_d_150:
ds_read_b128 v[88:91],v6 offset:38912
s_waitcnt lgkmcnt(3)
v_mfma_f32_32x32x16_bf16 v[16:31],a[140:143],v[92:95],v[16:31]
s_cbranch_vccz ns_d_151
s_add_u32 s46,s44,8192
s_mov_b32 m0,s46
s_add_u32 s46,s32,8192
buffer_load_dwordx4 v1,s[4:7],s46 offen sc1 lds
ns_d_151:
v_mfma_f32_32x32x16_bf16 v[32:47],v[236:239],v[92:95],v[32:47]
s_cbranch_vccz ns_d_152
s_add_u32 s46,s44,40960
s_mov_b32 m0,s46
s_add_u32 s46,s33,40960
buffer_load_dwordx4 v1,s[4:7],s46 offen sc1 lds
ns_d_152:
ds_read_b128 v[92:95],v6 offset:39936
s_waitcnt lgkmcnt(3)
v_mfma_f32_32x32x16_bf16 v[16:31],a[144:147],v[80:83],v[16:31]
s_cbranch_vccz ns_d_153
s_add_u32 s46,s44,45056
s_mov_b32 m0,s46
s_add_u32 s46,s33,45056
buffer_load_dwordx4 v1,s[4:7],s46 offen sc1 lds
ns_d_153:
v_mfma_f32_32x32x16_bf16 v[32:47],v[240:243],v[80:83],v[32:47]
s_cbranch_vccz ns_d_154
s_add_u32 s46,s44,12288
s_mov_b32 m0,s46
s_add_u32 s46,s32,12288
buffer_load_dwordx4 v1,s[4:7],s46 offen sc1 lds
ns_d_154:
s_waitcnt lgkmcnt(2)
v_mfma_f32_32x32x16_bf16 v[16:31],a[148:151],v[84:87],v[16:31]
s_cbranch_vccz ns_d_155
s_add_u32 s46,s44,16384
s_mov_b32 m0,s46
s_add_u32 s46,s32,16384
buffer_load_dwordx4 v1,s[4:7],s46 offen sc1 lds
ns_d_155:
v_mfma_f32_32x32x16_bf16 v[32:47],v[244:247],v[84:87],v[32:47]
s_cbranch_vccz ns_d_156
s_add_u32 s46,s44,20480
s_mov_b32 m0,s46
s_add_u32 s46,s32,20480
buffer_load_dwordx4 v1,s[4:7],s46 offen sc1 lds
ns_d_156:
s_waitcnt lgkmcnt(1)
v_mfma_f32_32x32x16_bf16 v[16:31],a[152:155],v[88:91],v[16:31]
s_cbranch_vccz ns_d_157
s_add_u32 s46,s44,24576
s_mov_b32 m0,s46
s_add_u32 s46,s32,24576
buffer_load_dwordx4 v1,s[4:7],s46 offen sc1 lds
ns_d_157:
v_mfma_f32_32x32x16_bf16 v[32:47],v[248:251],v[88:91],v[32:47]
s_cbranch_vccz ns_d_158
s_add_u32 s46,s44,28672
s_mov_b32 m0,s46
s_add_u32 s46,s32,28672
buffer_load_dwordx4 v1,s[4:7],s46 offen sc1 lds
ns_d_158:
s_waitcnt lgkmcnt(0)
v_mfma_f32_32x32x16_bf16 v[16:31],a[156:159],v[92:95],v[16:31]
s_cbranch_vccz ns_d_159
s_add_u32 s46,s44,32768
s_mov_b32 m0,s46
s_add_u32 s46,s32,32768
buffer_load_dwordx4 v1,s[4:7],s46 offen sc1 lds
ns_d_159:
v_mfma_f32_32x32x16_bf16 v[32:47],v[252:255],v[92:95],v[32:47]
s_cbranch_vccz ns_d_160
s_add_u32 s46,s44,36864
s_mov_b32 m0,s46
s_add_u32 s46,s32,36864
buffer_load_dwordx4 v1,s[4:7],s46 offen sc1 lds
ns_d_160:
buffer_load_dword v4,v3,s[4:7],0 offen sc1
v_pk_fma_f32 v[16:17],v[16:17],v[164:165],v[96:97]
v_pk_fma_f32 v[18:19],v[18:19],v[164:165],v[98:99]
v_pk_fma_f32 v[20:21],v[20:21],v[164:165],v[100:101]
v_pk_fma_f32 v[22:23],v[22:23],v[164:165],v[102:103]
v_cvt_pk_bf16_f32 v144,v16,v17
v_cvt_pk_bf16_f32 v145,v18,v19
v_cvt_pk_bf16_f32 v146,v20,v21
v_cvt_pk_bf16_f32 v147,v22,v23
buffer_store_dwordx4 v[144:147],v1,s[24:27],s36 offen sc1
v_pk_fma_f32 v[24:25],v[24:25],v[164:165],v[104:105]
v_pk_fma_f32 v[26:27],v[26:27],v[164:165],v[106:107]
v_pk_fma_f32 v[28:29],v[28:29],v[164:165],v[108:109]
v_pk_fma_f32 v[30:31],v[30:31],v[164:165],v[110:111]
v_cvt_pk_bf16_f32 v148,v24,v25
v_cvt_pk_bf16_f32 v149,v26,v27
v_cvt_pk_bf16_f32 v150,v28,v29
v_cvt_pk_bf16_f32 v151,v30,v31
buffer_store_dwordx4 v[148:151],v1,s[24:27],s36 offen offset:1024 sc1
v_pk_fma_f32 v[32:33],v[32:33],v[164:165],v[112:113]
v_pk_fma_f32 v[34:35],v[34:35],v[164:165],v[114:115]
v_pk_fma_f32 v[36:37],v[36:37],v[164:165],v[116:117]
v_pk_fma_f32 v[38:39],v[38:39],v[164:165],v[118:119]
v_cvt_pk_bf16_f32 v152,v32,v33
v_cvt_pk_bf16_f32 v153,v34,v35
v_cvt_pk_bf16_f32 v154,v36,v37
v_cvt_pk_bf16_f32 v155,v38,v39
buffer_store_dwordx4 v[152:155],v1,s[24:27],s36 offen offset:2048 sc1
v_pk_fma_f32 v[40:41],v[40:41],v[164:165],v[120:121]
v_pk_fma_f32 v[42:43],v[42:43],v[164:165],v[122:123]
v_pk_fma_f32 v[44:45],v[44:45],v[164:165],v[124:125]
v_pk_fma_f32 v[46:47],v[46:47],v[164:165],v[126:127]
v_cvt_pk_bf16_f32 v156,v40,v41
v_cvt_pk_bf16_f32 v157,v42,v43
v_cvt_pk_bf16_f32 v158,v44,v45
v_cvt_pk_bf16_f32 v159,v46,v47
buffer_store_dwordx4 v[156:159],v1,s[24:27],s36 offen offset:3072 sc1
s_waitcnt vmcnt(4)
v_cmp_le_u32 vcc,s31,v4
s_nop 0
s_cmp_eq_u64 vcc,-1
s_cselect_b64 vcc,-1,0
s_cmp_lt_u32 s62,s63
s_cselect_b64 vcc,vcc,0
s_add_u32 s64,s28,1
s_mov_b32 s28,s62
s_mov_b32 s69,s36
s_xor_b32 s35,s35,49152
s_mov_b32 s30,1
s_mov_b32 s34,0
s_cmp_lg_u32 s29,0
s_cbranch_scc1 ns_top_126
s_mov_b32 s34,1
s_cbranch_vccz ns_blk_161
s_add_u32 s46,s44,0
s_mov_b32 m0,s46
s_add_u32 s46,s32,0
buffer_load_dwordx4 v1,s[4:7],s46 offen sc1 lds
s_add_u32 s46,s44,4096
s_mov_b32 m0,s46
s_add_u32 s46,s32,4096
buffer_load_dwordx4 v1,s[4:7],s46 offen sc1 lds
s_add_u32 s46,s44,8192
s_mov_b32 m0,s46
s_add_u32 s46,s32,8192
buffer_load_dwordx4 v1,s[4:7],s46 offen sc1 lds
s_add_u32 s46,s44,40960
s_mov_b32 m0,s46
s_add_u32 s46,s33,40960
buffer_load_dwordx4 v1,s[4:7],s46 offen sc1 lds
s_waitcnt vmcnt(4)
v_mov_b32 v2,s64
s_mov_b64 exec,1
buffer_store_dword v2,off,s[24:27],s37 sc1
s_mov_b64 exec,-1
s_mov_b32 s30,0
s_add_u32 s46,s44,45056
s_mov_b32 m0,s46
s_add_u32 s46,s33,45056
buffer_load_dwordx4 v1,s[4:7],s46 offen sc1 lds
s_add_u32 s46,s44,12288
s_mov_b32 m0,s46
s_add_u32 s46,s32,12288
buffer_load_dwordx4 v1,s[4:7],s46 offen sc1 lds
s_add_u32 s46,s44,16384
s_mov_b32 m0,s46
s_add_u32 s46,s32,16384
buffer_load_dwordx4 v1,s[4:7],s46 offen sc1 lds
s_add_u32 s46,s44,20480
s_mov_b32 m0,s46
s_add_u32 s46,s32,20480
buffer_load_dwordx4 v1,s[4:7],s46 offen sc1 lds
s_add_u32 s46,s44,24576
s_mov_b32 m0,s46
s_add_u32 s46,s32,24576
buffer_load_dwordx4 v1,s[4:7],s46 offen sc1 lds
s_add_u32 s46,s44,28672
s_mov_b32 m0,s46
s_add_u32 s46,s32,28672
buffer_load_dwordx4 v1,s[4:7],s46 offen sc1 lds
s_add_u32 s46,s44,32768
s_mov_b32 m0,s46
s_add_u32 s46,s32,32768
buffer_load_dwordx4 v1,s[4:7],s46 offen sc1 lds
s_add_u32 s46,s44,36864
s_mov_b32 m0,s46
s_add_u32 s46,s32,36864
buffer_load_dwordx4 v1,s[4:7],s46 offen sc1 lds
s_branch ns_top_126
ns_blk_161:
s_mov_b32 s34,1
buffer_load_dword v4,v3,s[4:7],0 offen sc1
s_waitcnt vmcnt(1)
v_mov_b32 v2,s64
s_mov_b64 exec,1
buffer_store_dword v2,off,s[24:27],s37 sc1
s_mov_b64 exec,-1
s_mov_b32 s30,0
s_cmp_ge_u32 s28,s63
s_cbranch_scc1 ns_fin_127
s_waitcnt vmcnt(1)
v_cmp_le_u32 vcc,s31,v4
s_nop 0
s_cmp_eq_u64 vcc,-1
s_nop 1
s_cbranch_scc1 ns_rdy_162
s_mov_b32 s38,0
poll_163:
buffer_load_dword v4,v3,s[4:7],0 offen sc1
s_waitcnt vmcnt(0)
v_cmp_le_u32 vcc,s31,v4
s_nop 0
s_cmp_eq_u64 vcc,-1
s_nop 1
s_cbranch_scc1 polld_164
s_sleep 2
s_add_u32 s38,s38,1
s_cmp_lt_u32 s38,100000
s_cbranch_scc1 poll_163
s_mov_b32 s40,1
s_branch L_fail
polld_164:
ns_rdy_162:
s_add_u32 s46,s44,0
s_mov_b32 m0,s46
s_add_u32 s46,s32,0
buffer_load_dwordx4 v1,s[4:7],s46 offen sc1 lds
s_add_u32 s46,s44,4096
s_mov_b32 m0,s46
s_add_u32 s46,s32,4096
buffer_load_dwordx4 v1,s[4:7],s46 offen sc1 lds
s_add_u32 s46,s44,8192
s_mov_b32 m0,s46
s_add_u32 s46,s32,8192
buffer_load_dwordx4 v1,s[4:7],s46 offen sc1 lds
s_add_u32 s46,s44,40960
s_mov_b32 m0,s46
s_add_u32 s46,s33,40960
buffer_load_dwordx4 v1,s[4:7],s46 offen sc1 lds
s_add_u32 s46,s44,45056
s_mov_b32 m0,s46
s_add_u32 s46,s33,45056
buffer_load_dwordx4 v1,s[4:7],s46 offen sc1 lds
s_add_u32 s46,s44,12288
s_mov_b32 m0,s46
s_add_u32 s46,s32,12288
buffer_load_dwordx4 v1,s[4:7],s46 offen sc1 lds
s_add_u32 s46,s44,16384
s_mov_b32 m0,s46
s_add_u32 s46,s32,16384
buffer_load_dwordx4 v1,s[4:7],s46 offen sc1 lds
s_add_u32 s46,s44,20480
s_mov_b32 m0,s46
s_add_u32 s46,s32,20480
buffer_load_dwordx4 v1,s[4:7],s46 offen sc1 lds
s_add_u32 s46,s44,24576
s_mov_b32 m0,s46
s_add_u32 s46,s32,24576
buffer_load_dwordx4 v1,s[4:7],s46 offen sc1 lds
s_add_u32 s46,s44,28672
s_mov_b32 m0,s46
s_add_u32 s46,s32,28672
buffer_load_dwordx4 v1,s[4:7],s46 offen sc1 lds
s_add_u32 s46,s44,32768
s_mov_b32 m0,s46
s_add_u32 s46,s32,32768
buffer_load_dwordx4 v1,s[4:7],s46 offen sc1 lds
s_add_u32 s46,s44,36864
s_mov_b32 m0,s46
s_add_u32 s46,s32,36864
buffer_load_dwordx4 v1,s[4:7],s46 offen sc1 lds
s_branch ns_top_126
ns_fin_127:
s_branch L_end
ns_stream_125:
s_mov_b32 s28,s65
s_cmp_eq_u32 s65,0
s_cselect_b32 s63,43,64
s_cmp_eq_u32 s65,2
s_cselect_b32 s63,33,s63
s_mul_i32 s42,s28,49152
s_add_u32 s32,s66,s42
s_add_u32 s33,s67,s42
s_mov_b32 s44,s43
s_mov_b32 s35,0
s_add_u32 s46,s44,0
s_mov_b32 m0,s46
s_add_u32 s46,s32,0
buffer_load_dwordx4 v1,s[4:7],s46 offen sc1 lds
s_add_u32 s46,s44,4096
s_mov_b32 m0,s46
s_add_u32 s46,s32,4096
buffer_load_dwordx4 v1,s[4:7],s46 offen sc1 lds
s_add_u32 s46,s44,8192
s_mov_b32 m0,s46
s_add_u32 s46,s32,8192
buffer_load_dwordx4 v1,s[4:7],s46 offen sc1 lds
s_add_u32 s46,s44,40960
s_mov_b32 m0,s46
s_add_u32 s46,s33,40960
buffer_load_dwordx4 v1,s[4:7],s46 offen sc1 lds
s_add_u32 s46,s44,45056
s_mov_b32 m0,s46
s_add_u32 s46,s33,45056
buffer_load_dwordx4 v1,s[4:7],s46 offen sc1 lds
s_add_u32 s46,s44,12288
s_mov_b32 m0,s46
s_add_u32 s46,s32,12288
buffer_load_dwordx4 v1,s[4:7],s46 offen sc1 lds
s_add_u32 s46,s44,16384
s_mov_b32 m0,s46
s_add_u32 s46,s32,16384
buffer_load_dwordx4 v1,s[4:7],s46 offen sc1 lds
s_add_u32 s46,s44,20480
s_mov_b32 m0,s46
s_add_u32 s46,s32,20480
buffer_load_dwordx4 v1,s[4:7],s46 offen sc1 lds
s_add_u32 s46,s44,24576
s_mov_b32 m0,s46
s_add_u32 s46,s32,24576
buffer_load_dwordx4 v1,s[4:7],s46 offen sc1 lds
s_add_u32 s46,s44,28672
s_mov_b32 m0,s46
s_add_u32 s46,s32,28672
buffer_load_dwordx4 v1,s[4:7],s46 offen sc1 lds
s_add_u32 s46,s44,32768
s_mov_b32 m0,s46
s_add_u32 s46,s32,32768
buffer_load_dwordx4 v1,s[4:7],s46 offen sc1 lds
s_add_u32 s46,s44,36864
s_mov_b32 m0,s46
s_add_u32 s46,s32,36864
buffer_load_dwordx4 v1,s[4:7],s46 offen sc1 lds
s_waitcnt vmcnt(0)
s_barrier
v_mov_b32 v188,v1
s_mov_b32 s61,s26
s_mov_b32 s26,0
ds_read_b128 v[80:83],v188
ds_read_b128 v[84:87],v188 offset:1024
ds_read_b128 v[88:91],v188 offset:2048
ns_sl_166:
v_mov_b32 v6,v188
s_cmp_lt_u32 s28,42
s_cselect_b32 s62,2,1
s_cmp_lt_u32 s28,33
s_cselect_b32 s62,3,s62
s_add_u32 s62,s62,s28
s_min_u32 s60,s62,63
s_mul_i32 s42,s60,49152
s_add_u32 s32,s66,s42
s_add_u32 s33,s67,s42
s_add_u32 s34,s35,49152
s_cmp_eq_u32 s34,147456
s_cselect_b32 s34,0,s34
s_add_u32 s44,s34,s43
v_add_u32 v188,s34,v1
ds_read_b128 v[92:95],v6 offset:3072
s_waitcnt lgkmcnt(3)
v_mfma_f32_32x32x16_bf16 v[16:31],a[0:3],v[80:83],0
s_add_u32 s46,s44,0
s_mov_b32 m0,s46
s_add_u32 s46,s32,0
buffer_load_dwordx4 v1,s[4:7],s46 offen sc1 lds
v_mfma_f32_32x32x16_bf16 v[32:47],a[160:163],v[80:83],0
ds_read_b128 v[80:83],v6 offset:4096
s_waitcnt lgkmcnt(3)
v_mfma_f32_32x32x16_bf16 v[16:31],a[4:7],v[84:87],v[16:31]
v_mfma_f32_32x32x16_bf16 v[32:47],a[164:167],v[84:87],v[32:47]
ds_read_b128 v[84:87],v6 offset:5120
s_waitcnt lgkmcnt(3)
v_mfma_f32_32x32x16_bf16 v[16:31],a[8:11],v[88:91],v[16:31]
s_add_u32 s46,s44,4096
s_mov_b32 m0,s46
s_add_u32 s46,s32,4096
buffer_load_dwordx4 v1,s[4:7],s46 offen sc1 lds
v_mfma_f32_32x32x16_bf16 v[32:47],a[168:171],v[88:91],v[32:47]
v_mul_f32_e64 v168,-v11,v48
v_fma_f32 v128,v128,v10,v168
v_mul_f32_e64 v169,-v11,v49
ds_read_b128 v[88:91],v6 offset:6144
s_waitcnt lgkmcnt(3)
v_mfma_f32_32x32x16_bf16 v[16:31],a[12:15],v[92:95],v[16:31]
v_fma_f32 v129,v129,v10,v169
v_mul_f32_e64 v170,-v11,v50
v_fma_f32 v130,v130,v10,v170
v_mfma_f32_32x32x16_bf16 v[32:47],a[172:175],v[92:95],v[32:47]
v_mul_f32_e64 v171,-v11,v51
v_fma_f32 v131,v131,v10,v171
v_mul_f32_e64 v168,-v11,v52
ds_read_b128 v[92:95],v6 offset:7168
s_waitcnt lgkmcnt(3)
v_mfma_f32_32x32x16_bf16 v[16:31],a[16:19],v[80:83],v[16:31]
s_add_u32 s46,s44,8192
s_mov_b32 m0,s46
s_add_u32 s46,s32,8192
buffer_load_dwordx4 v1,s[4:7],s46 offen sc1 lds
v_mfma_f32_32x32x16_bf16 v[32:47],a[176:179],v[80:83],v[32:47]
v_fma_f32 v132,v132,v10,v168
v_mul_f32_e64 v169,-v11,v53
v_fma_f32 v133,v133,v10,v169
ds_read_b128 v[80:83],v6 offset:8192
s_waitcnt lgkmcnt(3)
v_mfma_f32_32x32x16_bf16 v[16:31],a[20:23],v[84:87],v[16:31]
v_mul_f32_e64 v170,-v11,v54
v_fma_f32 v134,v134,v10,v170
v_mul_f32_e64 v171,-v11,v55
v_mfma_f32_32x32x16_bf16 v[32:47],a[180:183],v[84:87],v[32:47]
v_fma_f32 v135,v135,v10,v171
v_cvt_pk_bf16_f32 v144,v128,v129
v_cvt_pk_bf16_f32 v145,v130,v131
ds_read_b128 v[84:87],v6 offset:9216
s_waitcnt lgkmcnt(3)
v_mfma_f32_32x32x16_bf16 v[16:31],a[24:27],v[88:91],v[16:31]
s_add_u32 s46,s44,40960
s_mov_b32 m0,s46
s_add_u32 s46,s33,40960
buffer_load_dwordx4 v1,s[4:7],s46 offen sc1 lds
v_mfma_f32_32x32x16_bf16 v[32:47],a[184:187],v[88:91],v[32:47]
v_cvt_pk_bf16_f32 v146,v132,v133
v_cvt_pk_bf16_f32 v147,v134,v135
buffer_store_dwordx4 v[144:147],v1,s[24:27],s36 offen sc1
ds_read_b128 v[88:91],v6 offset:10240
s_waitcnt lgkmcnt(3)
v_mfma_f32_32x32x16_bf16 v[16:31],a[28:31],v[92:95],v[16:31]
v_mul_f32_e64 v168,-v11,v56
v_fma_f32 v136,v136,v10,v168
v_mul_f32_e64 v169,-v11,v57
v_mfma_f32_32x32x16_bf16 v[32:47],a[188:191],v[92:95],v[32:47]
v_fma_f32 v137,v137,v10,v169
v_mul_f32_e64 v170,-v11,v58
v_fma_f32 v138,v138,v10,v170
ds_read_b128 v[92:95],v6 offset:11264
s_waitcnt lgkmcnt(3)
v_mfma_f32_32x32x16_bf16 v[16:31],a[32:35],v[80:83],v[16:31]
s_add_u32 s46,s44,45056
s_mov_b32 m0,s46
s_add_u32 s46,s33,45056
buffer_load_dwordx4 v1,s[4:7],s46 offen sc1 lds
v_mfma_f32_32x32x16_bf16 v[32:47],a[192:195],v[80:83],v[32:47]
v_mul_f32_e64 v171,-v11,v59
v_fma_f32 v139,v139,v10,v171
v_mul_f32_e64 v168,-v11,v60
ds_read_b128 v[80:83],v6 offset:12288
s_waitcnt lgkmcnt(3)
v_mfma_f32_32x32x16_bf16 v[16:31],a[36:39],v[84:87],v[16:31]
v_fma_f32 v140,v140,v10,v168
v_mul_f32_e64 v169,-v11,v61
v_fma_f32 v141,v141,v10,v169
v_mfma_f32_32x32x16_bf16 v[32:47],a[196:199],v[84:87],v[32:47]
v_mul_f32_e64 v170,-v11,v62
v_fma_f32 v142,v142,v10,v170
v_mul_f32_e64 v171,-v11,v63
ds_read_b128 v[84:87],v6 offset:13312
s_waitcnt lgkmcnt(3)
v_mfma_f32_32x32x16_bf16 v[16:31],a[40:43],v[88:91],v[16:31]
s_add_u32 s46,s44,12288
s_mov_b32 m0,s46
s_add_u32 s46,s32,12288
buffer_load_dwordx4 v1,s[4:7],s46 offen sc1 lds
v_mfma_f32_32x32x16_bf16 v[32:47],a[200:203],v[88:91],v[32:47]
v_fma_f32 v143,v143,v10,v171
v_cvt_pk_bf16_f32 v148,v136,v137
v_cvt_pk_bf16_f32 v149,v138,v139
ds_read_b128 v[88:91],v6 offset:14336
s_waitcnt lgkmcnt(3)
v_mfma_f32_32x32x16_bf16 v[16:31],a[44:47],v[92:95],v[16:31]
v_cvt_pk_bf16_f32 v150,v140,v141
v_cvt_pk_bf16_f32 v151,v142,v143
buffer_store_dwordx4 v[148:151],v1,s[24:27],s36 offen offset:1024 sc1
v_mfma_f32_32x32x16_bf16 v[32:47],a[204:207],v[92:95],v[32:47]
v_mul_f32_e64 v168,-v11,v64
v_fma_f32 v172,v172,v10,v168
v_mul_f32_e64 v169,-v11,v65
ds_read_b128 v[92:95],v6 offset:15360
s_waitcnt lgkmcnt(3)
v_mfma_f32_32x32x16_bf16 v[16:31],a[48:51],v[80:83],v[16:31]
s_add_u32 s46,s44,16384
s_mov_b32 m0,s46
s_add_u32 s46,s32,16384
buffer_load_dwordx4 v1,s[4:7],s46 offen sc1 lds
v_mfma_f32_32x32x16_bf16 v[32:47],a[208:211],v[80:83],v[32:47]
v_fma_f32 v173,v173,v10,v169
v_mul_f32_e64 v170,-v11,v66
v_fma_f32 v174,v174,v10,v170
ds_read_b128 v[80:83],v6 offset:16384
s_waitcnt lgkmcnt(3)
v_mfma_f32_32x32x16_bf16 v[16:31],a[52:55],v[84:87],v[16:31]
v_mul_f32_e64 v171,-v11,v67
v_fma_f32 v175,v175,v10,v171
v_mul_f32_e64 v168,-v11,v68
v_mfma_f32_32x32x16_bf16 v[32:47],a[212:215],v[84:87],v[32:47]
v_fma_f32 v176,v176,v10,v168
v_mul_f32_e64 v169,-v11,v69
v_fma_f32 v177,v177,v10,v169
ds_read_b128 v[84:87],v6 offset:17408
s_waitcnt lgkmcnt(3)
v_mfma_f32_32x32x16_bf16 v[16:31],a[56:59],v[88:91],v[16:31]
s_add_u32 s46,s44,20480
s_mov_b32 m0,s46
s_add_u32 s46,s32,20480
buffer_load_dwordx4 v1,s[4:7],s46 offen sc1 lds
v_mfma_f32_32x32x16_bf16 v[32:47],a[216:219],v[88:91],v[32:47]
v_mul_f32_e64 v170,-v11,v70
v_fma_f32 v178,v178,v10,v170
v_mul_f32_e64 v171,-v11,v71
ds_read_b128 v[88:91],v6 offset:18432
s_waitcnt lgkmcnt(3)
v_mfma_f32_32x32x16_bf16 v[16:31],a[60:63],v[92:95],v[16:31]
v_fma_f32 v179,v179,v10,v171
v_cvt_pk_bf16_f32 v152,v172,v173
v_cvt_pk_bf16_f32 v153,v174,v175
v_mfma_f32_32x32x16_bf16 v[32:47],a[220:223],v[92:95],v[32:47]
v_cvt_pk_bf16_f32 v154,v176,v177
v_cvt_pk_bf16_f32 v155,v178,v179
buffer_store_dwordx4 v[152:155],v1,s[24:27],s36 offen offset:2048 sc1
ds_read_b128 v[92:95],v6 offset:19456
s_waitcnt lgkmcnt(3)
v_mfma_f32_32x32x16_bf16 v[16:31],a[64:67],v[80:83],v[16:31]
s_add_u32 s46,s44,24576
s_mov_b32 m0,s46
s_add_u32 s46,s32,24576
buffer_load_dwordx4 v1,s[4:7],s46 offen sc1 lds
v_mfma_f32_32x32x16_bf16 v[32:47],a[224:227],v[80:83],v[32:47]
v_mul_f32_e64 v168,-v11,v72
v_fma_f32 v180,v180,v10,v168
v_mul_f32_e64 v169,-v11,v73
ds_read_b128 v[80:83],v6 offset:20480
s_waitcnt lgkmcnt(3)
v_mfma_f32_32x32x16_bf16 v[16:31],a[68:71],v[84:87],v[16:31]
v_fma_f32 v181,v181,v10,v169
v_mul_f32_e64 v170,-v11,v74
v_fma_f32 v182,v182,v10,v170
v_mfma_f32_32x32x16_bf16 v[32:47],a[228:231],v[84:87],v[32:47]
v_mul_f32_e64 v171,-v11,v75
v_fma_f32 v183,v183,v10,v171
v_mul_f32_e64 v168,-v11,v76
ds_read_b128 v[84:87],v6 offset:21504
s_waitcnt lgkmcnt(3)
v_mfma_f32_32x32x16_bf16 v[16:31],a[72:75],v[88:91],v[16:31]
s_add_u32 s46,s44,28672
s_mov_b32 m0,s46
s_add_u32 s46,s32,28672
buffer_load_dwordx4 v1,s[4:7],s46 offen sc1 lds
v_mfma_f32_32x32x16_bf16 v[32:47],a[232:235],v[88:91],v[32:47]
v_fma_f32 v184,v184,v10,v168
v_mul_f32_e64 v169,-v11,v77
v_fma_f32 v185,v185,v10,v169
ds_read_b128 v[88:91],v6 offset:22528
s_waitcnt lgkmcnt(3)
v_mfma_f32_32x32x16_bf16 v[16:31],a[76:79],v[92:95],v[16:31]
v_mul_f32_e64 v170,-v11,v78
v_fma_f32 v186,v186,v10,v170
v_mul_f32_e64 v171,-v11,v79
v_mfma_f32_32x32x16_bf16 v[32:47],a[236:239],v[92:95],v[32:47]
v_fma_f32 v187,v187,v10,v171
v_cvt_pk_bf16_f32 v156,v180,v181
v_cvt_pk_bf16_f32 v157,v182,v183
ds_read_b128 v[92:95],v6 offset:23552
s_waitcnt lgkmcnt(3)
v_mfma_f32_32x32x16_bf16 v[16:31],a[80:83],v[80:83],v[16:31]
s_add_u32 s46,s44,32768
s_mov_b32 m0,s46
s_add_u32 s46,s32,32768
buffer_load_dwordx4 v1,s[4:7],s46 offen sc1 lds
v_mfma_f32_32x32x16_bf16 v[32:47],a[240:243],v[80:83],v[32:47]
v_cvt_pk_bf16_f32 v158,v184,v185
v_cvt_pk_bf16_f32 v159,v186,v187
buffer_store_dwordx4 v[156:159],v1,s[24:27],s36 offen offset:3072 sc1
ds_read_b128 v[80:83],v6 offset:24576
s_waitcnt lgkmcnt(3)
v_mfma_f32_32x32x16_bf16 v[16:31],a[84:87],v[84:87],v[16:31]
v_add_u32 v5,s35,v7
ds_read_b64 v[96:97],v5 offset:40960
ds_read_b64 v[98:99],v5 offset:41216
v_mfma_f32_32x32x16_bf16 v[32:47],a[244:247],v[84:87],v[32:47]
ds_read_b64 v[100:101],v5 offset:41472
ds_read_b64 v[102:103],v5 offset:41728
ds_read_b64 v[104:105],v5 offset:41984
ds_read_b128 v[84:87],v6 offset:25600
s_waitcnt lgkmcnt(8)
v_mfma_f32_32x32x16_bf16 v[16:31],a[88:91],v[88:91],v[16:31]
s_add_u32 s46,s44,36864
s_mov_b32 m0,s46
s_add_u32 s46,s32,36864
buffer_load_dwordx4 v1,s[4:7],s46 offen sc1 lds
v_mfma_f32_32x32x16_bf16 v[32:47],a[248:251],v[88:91],v[32:47]
ds_read_b64 v[106:107],v5 offset:42240
ds_read_b64 v[108:109],v5 offset:42496
ds_read_b64 v[110:111],v5 offset:42752
ds_read_b128 v[88:91],v6 offset:26624
s_waitcnt lgkmcnt(11)
v_mfma_f32_32x32x16_bf16 v[16:31],a[92:95],v[92:95],v[16:31]
ds_read_b64 v[112:113],v5 offset:43008
ds_read_b64 v[114:115],v5 offset:43264
v_mfma_f32_32x32x16_bf16 v[32:47],a[252:255],v[92:95],v[32:47]
ds_read_b128 v[92:95],v6 offset:27648
s_waitcnt lgkmcnt(13)
v_mfma_f32_32x32x16_bf16 v[16:31],a[96:99],v[80:83],v[16:31]
v_mfma_f32_32x32x16_bf16 v[32:47],v[192:195],v[80:83],v[32:47]
s_waitcnt lgkmcnt(1)
v_add_f32 v96,v96,v106
v_add_f32 v97,v97,v107
ds_read_b128 v[80:83],v6 offset:28672
v_mfma_f32_32x32x16_bf16 v[16:31],a[100:103],v[84:87],v[16:31]
v_add_f32 v98,v98,v108
v_add_f32 v99,v99,v109
v_add_f32 v100,v100,v110
v_mfma_f32_32x32x16_bf16 v[32:47],v[196:199],v[84:87],v[32:47]
v_add_f32 v101,v101,v111
v_add_f32 v102,v102,v112
v_add_f32 v103,v103,v113
ds_read_b128 v[84:87],v6 offset:29696
v_mfma_f32_32x32x16_bf16 v[16:31],a[104:107],v[88:91],v[16:31]
v_add_f32 v104,v104,v114
v_add_f32 v105,v105,v115
v_add_f32 v96,v96,v100
v_mfma_f32_32x32x16_bf16 v[32:47],v[200:203],v[88:91],v[32:47]
v_add_f32 v97,v97,v101
v_add_f32 v98,v98,v102
v_add_f32 v99,v99,v103
ds_read_b128 v[88:91],v6 offset:30720
s_waitcnt lgkmcnt(3)
v_mfma_f32_32x32x16_bf16 v[16:31],a[108:111],v[92:95],v[16:31]
v_add_f32 v104,v104,v96
v_add_f32 v105,v105,v97
v_add_f32 v12,v104,v98
v_mfma_f32_32x32x16_bf16 v[32:47],v[204:207],v[92:95],v[32:47]
v_add_f32 v13,v105,v99
v_mov_b32 v96,v12
v_mov_b32 v97,v13
ds_read_b128 v[92:95],v6 offset:31744
s_waitcnt lgkmcnt(3)
v_mfma_f32_32x32x16_bf16 v[16:31],a[112:115],v[80:83],v[16:31]
v_mfma_f32_32x32x16_bf16 v[32:47],v[208:211],v[80:83],v[32:47]
v_permlane32_swap_b32 v12,v96
v_permlane32_swap_b32 v13,v97
ds_read_b128 v[80:83],v6 offset:32768
s_waitcnt lgkmcnt(3)
v_mfma_f32_32x32x16_bf16 v[16:31],a[116:119],v[84:87],v[16:31]
v_add_f32 v12,v12,v96
v_add_f32 v13,v13,v97
v_mul_f32 v12,s48,v12
v_mfma_f32_32x32x16_bf16 v[32:47],v[212:215],v[84:87],v[32:47]
v_mul_f32 v13,s48,v13
v_fma_f32 v13,-v12,v12,v13
v_max_f32 v13,0,v13
ds_read_b128 v[84:87],v6 offset:33792
s_waitcnt lgkmcnt(3)
v_mfma_f32_32x32x16_bf16 v[16:31],a[120:123],v[88:91],v[16:31]
v_add_f32 v96,s49,v13
v_rsq_f32 v10,v96
v_mfma_f32_32x32x16_bf16 v[32:47],v[216:219],v[88:91],v[32:47]
v_mul_f32 v10,s47,v10
v_mul_f32 v11,v12,v10
v_mov_b32 v164,v10
ds_read_b128 v[88:91],v6 offset:34816
s_waitcnt lgkmcnt(3)
v_mfma_f32_32x32x16_bf16 v[16:31],a[124:127],v[92:95],v[16:31]
v_mov_b32 v165,v10
v_mfma_f32_32x32x16_bf16 v[32:47],v[220:223],v[92:95],v[32:47]
ds_read_b128 v[92:95],v6 offset:35840
s_waitcnt lgkmcnt(3)
v_mfma_f32_32x32x16_bf16 v[16:31],a[128:131],v[80:83],v[16:31]
v_mfma_f32_32x32x16_bf16 v[32:47],v[224:227],v[80:83],v[32:47]
ds_read_b128 v[80:83],v6 offset:36864
s_waitcnt lgkmcnt(3)
v_mfma_f32_32x32x16_bf16 v[16:31],a[132:135],v[84:87],v[16:31]
v_mfma_f32_32x32x16_bf16 v[32:47],v[228:231],v[84:87],v[32:47]
ds_read_b128 v[84:87],v6 offset:37888
s_waitcnt lgkmcnt(3)
v_mfma_f32_32x32x16_bf16 v[16:31],a[136:139],v[88:91],v[16:31]
v_mfma_f32_32x32x16_bf16 v[32:47],v[232:235],v[88:91],v[32:47]
ds_read_b128 v[88:91],v6 offset:38912
s_waitcnt lgkmcnt(3)
v_mfma_f32_32x32x16_bf16 v[16:31],a[140:143],v[92:95],v[16:31]
v_mfma_f32_32x32x16_bf16 v[32:47],v[236:239],v[92:95],v[32:47]
ds_read_b128 v[92:95],v6 offset:39936
s_waitcnt lgkmcnt(3)
v_mfma_f32_32x32x16_bf16 v[16:31],a[144:147],v[80:83],v[16:31]
v_mfma_f32_32x32x16_bf16 v[32:47],v[240:243],v[80:83],v[32:47]
s_waitcnt vmcnt(0)
s_barrier
v_mov_b32 v2,s64
s_mov_b64 exec,1
buffer_store_dword v2,off,s[24:27],s37 sc1
s_mov_b64 exec,-1
ds_read_b128 v[80:83],v188
s_waitcnt lgkmcnt(3)
v_mfma_f32_32x32x16_bf16 v[16:31],a[148:151],v[84:87],v[16:31]
v_mfma_f32_32x32x16_bf16 v[32:47],v[244:247],v[84:87],v[32:47]
ds_read_b128 v[84:87],v188 offset:1024
s_waitcnt lgkmcnt(3)
v_mfma_f32_32x32x16_bf16 v[16:31],a[152:155],v[88:91],v[16:31]
v_mfma_f32_32x32x16_bf16 v[32:47],v[248:251],v[88:91],v[32:47]
ds_read_b128 v[88:91],v188 offset:2048
s_waitcnt lgkmcnt(3)
v_mfma_f32_32x32x16_bf16 v[16:31],a[156:159],v[92:95],v[16:31]
v_mfma_f32_32x32x16_bf16 v[32:47],v[252:255],v[92:95],v[32:47]
s_mul_i32 s36,s28,786432
s_add_u32 s36,s36,s68
s_add_u32 s64,s28,1
s_mov_b32 s28,s62
s_mov_b32 s35,s34
s_mov_b32 s26,s61
s_cmp_ge_u32 s28,s63
s_cbranch_scc1 ns_se_167
v_mov_b32 v6,v188
s_cmp_lt_u32 s28,42
s_cselect_b32 s62,2,1
s_cmp_lt_u32 s28,33
s_cselect_b32 s62,3,s62
s_add_u32 s62,s62,s28
s_min_u32 s60,s62,63
s_mul_i32 s42,s60,49152
s_add_u32 s32,s66,s42
s_add_u32 s33,s67,s42
s_add_u32 s34,s35,49152
s_cmp_eq_u32 s34,147456
s_cselect_b32 s34,0,s34
s_add_u32 s44,s34,s43
v_add_u32 v188,s34,v1
ds_read_b128 v[92:95],v6 offset:3072
s_waitcnt lgkmcnt(3)
v_mfma_f32_32x32x16_bf16 v[128:143],a[0:3],v[80:83],0
s_add_u32 s46,s44,0
s_mov_b32 m0,s46
s_add_u32 s46,s32,0
buffer_load_dwordx4 v1,s[4:7],s46 offen sc1 lds
v_mfma_f32_32x32x16_bf16 v[172:187],a[160:163],v[80:83],0
ds_read_b128 v[80:83],v6 offset:4096
s_waitcnt lgkmcnt(3)
v_mfma_f32_32x32x16_bf16 v[128:143],a[4:7],v[84:87],v[128:143]
v_mfma_f32_32x32x16_bf16 v[172:187],a[164:167],v[84:87],v[172:187]
ds_read_b128 v[84:87],v6 offset:5120
s_waitcnt lgkmcnt(3)
v_mfma_f32_32x32x16_bf16 v[128:143],a[8:11],v[88:91],v[128:143]
s_add_u32 s46,s44,4096
s_mov_b32 m0,s46
s_add_u32 s46,s32,4096
buffer_load_dwordx4 v1,s[4:7],s46 offen sc1 lds
v_mfma_f32_32x32x16_bf16 v[172:187],a[168:171],v[88:91],v[172:187]
v_mul_f32_e64 v168,-v11,v48
v_fma_f32 v16,v16,v10,v168
v_mul_f32_e64 v169,-v11,v49
ds_read_b128 v[88:91],v6 offset:6144
s_waitcnt lgkmcnt(3)
v_mfma_f32_32x32x16_bf16 v[128:143],a[12:15],v[92:95],v[128:143]
v_fma_f32 v17,v17,v10,v169
v_mul_f32_e64 v170,-v11,v50
v_fma_f32 v18,v18,v10,v170
v_mfma_f32_32x32x16_bf16 v[172:187],a[172:175],v[92:95],v[172:187]
v_mul_f32_e64 v171,-v11,v51
v_fma_f32 v19,v19,v10,v171
v_mul_f32_e64 v168,-v11,v52
ds_read_b128 v[92:95],v6 offset:7168
s_waitcnt lgkmcnt(3)
v_mfma_f32_32x32x16_bf16 v[128:143],a[16:19],v[80:83],v[128:143]
s_add_u32 s46,s44,8192
s_mov_b32 m0,s46
s_add_u32 s46,s32,8192
buffer_load_dwordx4 v1,s[4:7],s46 offen sc1 lds
v_mfma_f32_32x32x16_bf16 v[172:187],a[176:179],v[80:83],v[172:187]
v_fma_f32 v20,v20,v10,v168
v_mul_f32_e64 v169,-v11,v53
v_fma_f32 v21,v21,v10,v169
ds_read_b128 v[80:83],v6 offset:8192
s_waitcnt lgkmcnt(3)
v_mfma_f32_32x32x16_bf16 v[128:143],a[20:23],v[84:87],v[128:143]
v_mul_f32_e64 v170,-v11,v54
v_fma_f32 v22,v22,v10,v170
v_mul_f32_e64 v171,-v11,v55
v_mfma_f32_32x32x16_bf16 v[172:187],a[180:183],v[84:87],v[172:187]
v_fma_f32 v23,v23,v10,v171
v_cvt_pk_bf16_f32 v144,v16,v17
v_cvt_pk_bf16_f32 v145,v18,v19
ds_read_b128 v[84:87],v6 offset:9216
s_waitcnt lgkmcnt(3)
v_mfma_f32_32x32x16_bf16 v[128:143],a[24:27],v[88:91],v[128:143]
s_add_u32 s46,s44,40960
s_mov_b32 m0,s46
s_add_u32 s46,s33,40960
buffer_load_dwordx4 v1,s[4:7],s46 offen sc1 lds
v_mfma_f32_32x32x16_bf16 v[172:187],a[184:187],v[88:91],v[172:187]
v_cvt_pk_bf16_f32 v146,v20,v21
v_cvt_pk_bf16_f32 v147,v22,v23
buffer_store_dwordx4 v[144:147],v1,s[24:27],s36 offen sc1
ds_read_b128 v[88:91],v6 offset:10240
s_waitcnt lgkmcnt(3)
v_mfma_f32_32x32x16_bf16 v[128:143],a[28:31],v[92:95],v[128:143]
v_mul_f32_e64 v168,-v11,v56
v_fma_f32 v24,v24,v10,v168
v_mul_f32_e64 v169,-v11,v57
v_mfma_f32_32x32x16_bf16 v[172:187],a[188:191],v[92:95],v[172:187]
v_fma_f32 v25,v25,v10,v169
v_mul_f32_e64 v170,-v11,v58
v_fma_f32 v26,v26,v10,v170
ds_read_b128 v[92:95],v6 offset:11264
s_waitcnt lgkmcnt(3)
v_mfma_f32_32x32x16_bf16 v[128:143],a[32:35],v[80:83],v[128:143]
s_add_u32 s46,s44,45056
s_mov_b32 m0,s46
s_add_u32 s46,s33,45056
buffer_load_dwordx4 v1,s[4:7],s46 offen sc1 lds
v_mfma_f32_32x32x16_bf16 v[172:187],a[192:195],v[80:83],v[172:187]
v_mul_f32_e64 v171,-v11,v59
v_fma_f32 v27,v27,v10,v171
v_mul_f32_e64 v168,-v11,v60
ds_read_b128 v[80:83],v6 offset:12288
s_waitcnt lgkmcnt(3)
v_mfma_f32_32x32x16_bf16 v[128:143],a[36:39],v[84:87],v[128:143]
v_fma_f32 v28,v28,v10,v168
v_mul_f32_e64 v169,-v11,v61
v_fma_f32 v29,v29,v10,v169
v_mfma_f32_32x32x16_bf16 v[172:187],a[196:199],v[84:87],v[172:187]
v_mul_f32_e64 v170,-v11,v62
v_fma_f32 v30,v30,v10,v170
v_mul_f32_e64 v171,-v11,v63
ds_read_b128 v[84:87],v6 offset:13312
s_waitcnt lgkmcnt(3)
v_mfma_f32_32x32x16_bf16 v[128:143],a[40:43],v[88:91],v[128:143]
s_add_u32 s46,s44,12288
s_mov_b32 m0,s46
s_add_u32 s46,s32,12288
buffer_load_dwordx4 v1,s[4:7],s46 offen sc1 lds
v_mfma_f32_32x32x16_bf16 v[172:187],a[200:203],v[88:91],v[172:187]
v_fma_f32 v31,v31,v10,v171
v_cvt_pk_bf16_f32 v148,v24,v25
v_cvt_pk_bf16_f32 v149,v26,v27
ds_read_b128 v[88:91],v6 offset:14336
s_waitcnt lgkmcnt(3)
v_mfma_f32_32x32x16_bf16 v[128:143],a[44:47],v[92:95],v[128:143]
v_cvt_pk_bf16_f32 v150,v28,v29
v_cvt_pk_bf16_f32 v151,v30,v31
buffer_store_dwordx4 v[148:151],v1,s[24:27],s36 offen offset:1024 sc1
v_mfma_f32_32x32x16_bf16 v[172:187],a[204:207],v[92:95],v[172:187]
v_mul_f32_e64 v168,-v11,v64
v_fma_f32 v32,v32,v10,v168
v_mul_f32_e64 v169,-v11,v65
ds_read_b128 v[92:95],v6 offset:15360
s_waitcnt lgkmcnt(3)
v_mfma_f32_32x32x16_bf16 v[128:143],a[48:51],v[80:83],v[128:143]
s_add_u32 s46,s44,16384
s_mov_b32 m0,s46
s_add_u32 s46,s32,16384
buffer_load_dwordx4 v1,s[4:7],s46 offen sc1 lds
v_mfma_f32_32x32x16_bf16 v[172:187],a[208:211],v[80:83],v[172:187]
v_fma_f32 v33,v33,v10,v169
v_mul_f32_e64 v170,-v11,v66
v_fma_f32 v34,v34,v10,v170
ds_read_b128 v[80:83],v6 offset:16384
s_waitcnt lgkmcnt(3)
v_mfma_f32_32x32x16_bf16 v[128:143],a[52:55],v[84:87],v[128:143]
v_mul_f32_e64 v171,-v11,v67
v_fma_f32 v35,v35,v10,v171
v_mul_f32_e64 v168,-v11,v68
v_mfma_f32_32x32x16_bf16 v[172:187],a[212:215],v[84:87],v[172:187]
v_fma_f32 v36,v36,v10,v168
v_mul_f32_e64 v169,-v11,v69
v_fma_f32 v37,v37,v10,v169
ds_read_b128 v[84:87],v6 offset:17408
s_waitcnt lgkmcnt(3)
v_mfma_f32_32x32x16_bf16 v[128:143],a[56:59],v[88:91],v[128:143]
s_add_u32 s46,s44,20480
s_mov_b32 m0,s46
s_add_u32 s46,s32,20480
buffer_load_dwordx4 v1,s[4:7],s46 offen sc1 lds
v_mfma_f32_32x32x16_bf16 v[172:187],a[216:219],v[88:91],v[172:187]
v_mul_f32_e64 v170,-v11,v70
v_fma_f32 v38,v38,v10,v170
v_mul_f32_e64 v171,-v11,v71
ds_read_b128 v[88:91],v6 offset:18432
s_waitcnt lgkmcnt(3)
v_mfma_f32_32x32x16_bf16 v[128:143],a[60:63],v[92:95],v[128:143]
v_fma_f32 v39,v39,v10,v171
v_cvt_pk_bf16_f32 v152,v32,v33
v_cvt_pk_bf16_f32 v153,v34,v35
v_mfma_f32_32x32x16_bf16 v[172:187],a[220:223],v[92:95],v[172:187]
v_cvt_pk_bf16_f32 v154,v36,v37
v_cvt_pk_bf16_f32 v155,v38,v39
buffer_store_dwordx4 v[152:155],v1,s[24:27],s36 offen offset:2048 sc1
ds_read_b128 v[92:95],v6 offset:19456
s_waitcnt lgkmcnt(3)
v_mfma_f32_32x32x16_bf16 v[128:143],a[64:67],v[80:83],v[128:143]
s_add_u32 s46,s44,24576
s_mov_b32 m0,s46
s_add_u32 s46,s32,24576
buffer_load_dwordx4 v1,s[4:7],s46 offen sc1 lds
v_mfma_f32_32x32x16_bf16 v[172:187],a[224:227],v[80:83],v[172:187]
v_mul_f32_e64 v168,-v11,v72
v_fma_f32 v40,v40,v10,v168
v_mul_f32_e64 v169,-v11,v73
ds_read_b128 v[80:83],v6 offset:20480
s_waitcnt lgkmcnt(3)
v_mfma_f32_32x32x16_bf16 v[128:143],a[68:71],v[84:87],v[128:143]
v_fma_f32 v41,v41,v10,v169
v_mul_f32_e64 v170,-v11,v74
v_fma_f32 v42,v42,v10,v170
v_mfma_f32_32x32x16_bf16 v[172:187],a[228:231],v[84:87],v[172:187]
v_mul_f32_e64 v171,-v11,v75
v_fma_f32 v43,v43,v10,v171
v_mul_f32_e64 v168,-v11,v76
ds_read_b128 v[84:87],v6 offset:21504
s_waitcnt lgkmcnt(3)
v_mfma_f32_32x32x16_bf16 v[128:143],a[72:75],v[88:91],v[128:143]
s_add_u32 s46,s44,28672
s_mov_b32 m0,s46
s_add_u32 s46,s32,28672
buffer_load_dwordx4 v1,s[4:7],s46 offen sc1 lds
v_mfma_f32_32x32x16_bf16 v[172:187],a[232:235],v[88:91],v[172:187]
v_fma_f32 v44,v44,v10,v168
v_mul_f32_e64 v169,-v11,v77
v_fma_f32 v45,v45,v10,v169
ds_read_b128 v[88:91],v6 offset:22528
s_waitcnt lgkmcnt(3)
v_mfma_f32_32x32x16_bf16 v[128:143],a[76:79],v[92:95],v[128:143]
v_mul_f32_e64 v170,-v11,v78
v_fma_f32 v46,v46,v10,v170
v_mul_f32_e64 v171,-v11,v79
v_mfma_f32_32x32x16_bf16 v[172:187],a[236:239],v[92:95],v[172:187]
v_fma_f32 v47,v47,v10,v171
v_cvt_pk_bf16_f32 v156,v40,v41
v_cvt_pk_bf16_f32 v157,v42,v43
ds_read_b128 v[92:95],v6 offset:23552
s_waitcnt lgkmcnt(3)
v_mfma_f32_32x32x16_bf16 v[128:143],a[80:83],v[80:83],v[128:143]
s_add_u32 s46,s44,32768
s_mov_b32 m0,s46
s_add_u32 s46,s32,32768
buffer_load_dwordx4 v1,s[4:7],s46 offen sc1 lds
v_mfma_f32_32x32x16_bf16 v[172:187],a[240:243],v[80:83],v[172:187]
v_cvt_pk_bf16_f32 v158,v44,v45
v_cvt_pk_bf16_f32 v159,v46,v47
buffer_store_dwordx4 v[156:159],v1,s[24:27],s36 offen offset:3072 sc1
ds_read_b128 v[80:83],v6 offset:24576
s_waitcnt lgkmcnt(3)
v_mfma_f32_32x32x16_bf16 v[128:143],a[84:87],v[84:87],v[128:143]
v_add_u32 v5,s35,v7
ds_read_b64 v[96:97],v5 offset:40960
ds_read_b64 v[98:99],v5 offset:41216
v_mfma_f32_32x32x16_bf16 v[172:187],a[244:247],v[84:87],v[172:187]
ds_read_b64 v[100:101],v5 offset:41472
ds_read_b64 v[102:103],v5 offset:41728
ds_read_b64 v[104:105],v5 offset:41984
ds_read_b128 v[84:87],v6 offset:25600
s_waitcnt lgkmcnt(8)
v_mfma_f32_32x32x16_bf16 v[128:143],a[88:91],v[88:91],v[128:143]
s_add_u32 s46,s44,36864
s_mov_b32 m0,s46
s_add_u32 s46,s32,36864
buffer_load_dwordx4 v1,s[4:7],s46 offen sc1 lds
v_mfma_f32_32x32x16_bf16 v[172:187],a[248:251],v[88:91],v[172:187]
ds_read_b64 v[106:107],v5 offset:42240
ds_read_b64 v[108:109],v5 offset:42496
ds_read_b64 v[110:111],v5 offset:42752
ds_read_b128 v[88:91],v6 offset:26624
s_waitcnt lgkmcnt(11)
v_mfma_f32_32x32x16_bf16 v[128:143],a[92:95],v[92:95],v[128:143]
ds_read_b64 v[112:113],v5 offset:43008
ds_read_b64 v[114:115],v5 offset:43264
v_mfma_f32_32x32x16_bf16 v[172:187],a[252:255],v[92:95],v[172:187]
ds_read_b128 v[92:95],v6 offset:27648
s_waitcnt lgkmcnt(13)
v_mfma_f32_32x32x16_bf16 v[128:143],a[96:99],v[80:83],v[128:143]
v_mfma_f32_32x32x16_bf16 v[172:187],v[192:195],v[80:83],v[172:187]
s_waitcnt lgkmcnt(1)
v_add_f32 v96,v96,v106
v_add_f32 v97,v97,v107
ds_read_b128 v[80:83],v6 offset:28672
v_mfma_f32_32x32x16_bf16 v[128:143],a[100:103],v[84:87],v[128:143]
v_add_f32 v98,v98,v108
v_add_f32 v99,v99,v109
v_add_f32 v100,v100,v110
v_mfma_f32_32x32x16_bf16 v[172:187],v[196:199],v[84:87],v[172:187]
v_add_f32 v101,v101,v111
v_add_f32 v102,v102,v112
v_add_f32 v103,v103,v113
ds_read_b128 v[84:87],v6 offset:29696
v_mfma_f32_32x32x16_bf16 v[128:143],a[104:107],v[88:91],v[128:143]
v_add_f32 v104,v104,v114
v_add_f32 v105,v105,v115
v_add_f32 v96,v96,v100
v_mfma_f32_32x32x16_bf16 v[172:187],v[200:203],v[88:91],v[172:187]
v_add_f32 v97,v97,v101
v_add_f32 v98,v98,v102
v_add_f32 v99,v99,v103
ds_read_b128 v[88:91],v6 offset:30720
s_waitcnt lgkmcnt(3)
v_mfma_f32_32x32x16_bf16 v[128:143],a[108:111],v[92:95],v[128:143]
v_add_f32 v104,v104,v96
v_add_f32 v105,v105,v97
v_add_f32 v12,v104,v98
v_mfma_f32_32x32x16_bf16 v[172:187],v[204:207],v[92:95],v[172:187]
v_add_f32 v13,v105,v99
v_mov_b32 v96,v12
v_mov_b32 v97,v13
ds_read_b128 v[92:95],v6 offset:31744
s_waitcnt lgkmcnt(3)
v_mfma_f32_32x32x16_bf16 v[128:143],a[112:115],v[80:83],v[128:143]
v_mfma_f32_32x32x16_bf16 v[172:187],v[208:211],v[80:83],v[172:187]
v_permlane32_swap_b32 v12,v96
v_permlane32_swap_b32 v13,v97
ds_read_b128 v[80:83],v6 offset:32768
s_waitcnt lgkmcnt(3)
v_mfma_f32_32x32x16_bf16 v[128:143],a[116:119],v[84:87],v[128:143]
v_add_f32 v12,v12,v96
v_add_f32 v13,v13,v97
v_mul_f32 v12,s48,v12
v_mfma_f32_32x32x16_bf16 v[172:187],v[212:215],v[84:87],v[172:187]
v_mul_f32 v13,s48,v13
v_fma_f32 v13,-v12,v12,v13
v_max_f32 v13,0,v13
ds_read_b128 v[84:87],v6 offset:33792
s_waitcnt lgkmcnt(3)
v_mfma_f32_32x32x16_bf16 v[128:143],a[120:123],v[88:91],v[128:143]
v_add_f32 v96,s49,v13
v_rsq_f32 v10,v96
v_mfma_f32_32x32x16_bf16 v[172:187],v[216:219],v[88:91],v[172:187]
v_mul_f32 v10,s47,v10
v_mul_f32 v11,v12,v10
v_mov_b32 v164,v10
ds_read_b128 v[88:91],v6 offset:34816
s_waitcnt lgkmcnt(3)
v_mfma_f32_32x32x16_bf16 v[128:143],a[124:127],v[92:95],v[128:143]
v_mov_b32 v165,v10
v_mfma_f32_32x32x16_bf16 v[172:187],v[220:223],v[92:95],v[172:187]
ds_read_b128 v[92:95],v6 offset:35840
s_waitcnt lgkmcnt(3)
v_mfma_f32_32x32x16_bf16 v[128:143],a[128:131],v[80:83],v[128:143]
v_mfma_f32_32x32x16_bf16 v[172:187],v[224:227],v[80:83],v[172:187]
ds_read_b128 v[80:83],v6 offset:36864
s_waitcnt lgkmcnt(3)
v_mfma_f32_32x32x16_bf16 v[128:143],a[132:135],v[84:87],v[128:143]
v_mfma_f32_32x32x16_bf16 v[172:187],v[228:231],v[84:87],v[172:187]
ds_read_b128 v[84:87],v6 offset:37888
s_waitcnt lgkmcnt(3)
v_mfma_f32_32x32x16_bf16 v[128:143],a[136:139],v[88:91],v[128:143]
v_mfma_f32_32x32x16_bf16 v[172:187],v[232:235],v[88:91],v[172:187]
ds_read_b128 v[88:91],v6 offset:38912
s_waitcnt lgkmcnt(3)
v_mfma_f32_32x32x16_bf16 v[128:143],a[140:143],v[92:95],v[128:143]
v_mfma_f32_32x32x16_bf16 v[172:187],v[236:239],v[92:95],v[172:187]
ds_read_b128 v[92:95],v6 offset:39936
s_waitcnt lgkmcnt(3)
v_mfma_f32_32x32x16_bf16 v[128:143],a[144:147],v[80:83],v[128:143]
v_mfma_f32_32x32x16_bf16 v[172:187],v[240:243],v[80:83],v[172:187]
s_waitcnt vmcnt(0)
s_barrier
v_mov_b32 v2,s64
s_mov_b64 exec,1
buffer_store_dword v2,off,s[24:27],s37 sc1
s_mov_b64 exec,-1
ds_read_b128 v[80:83],v188
s_waitcnt lgkmcnt(3)
v_mfma_f32_32x32x16_bf16 v[128:143],a[148:151],v[84:87],v[128:143]
v_mfma_f32_32x32x16_bf16 v[172:187],v[244:247],v[84:87],v[172:187]
ds_read_b128 v[84:87],v188 offset:1024
s_waitcnt lgkmcnt(3)
v_mfma_f32_32x32x16_bf16 v[128:143],a[152:155],v[88:91],v[128:143]
v_mfma_f32_32x32x16_bf16 v[172:187],v[248:251],v[88:91],v[172:187]
ds_read_b128 v[88:91],v188 offset:2048
s_waitcnt lgkmcnt(3)
v_mfma_f32_32x32x16_bf16 v[128:143],a[156:159],v[92:95],v[128:143]
v_mfma_f32_32x32x16_bf16 v[172:187],v[252:255],v[92:95],v[172:187]
s_mul_i32 s36,s28,786432
s_add_u32 s36,s36,s68
s_add_u32 s64,s28,1
s_mov_b32 s28,s62
s_mov_b32 s35,s34
s_mov_b32 s26,s61
s_cmp_ge_u32 s28,s63
s_cbranch_scc1 ns_se_168
s_branch ns_sl_166
s_nop 2
ns_se_167:
s_nop 7
s_nop 3
v_mul_f32_e64 v168,-v11,v48
v_fma_f32 v16,v16,v10,v168
v_mul_f32_e64 v169,-v11,v49
v_fma_f32 v17,v17,v10,v169
v_mul_f32_e64 v170,-v11,v50
v_fma_f32 v18,v18,v10,v170
v_mul_f32_e64 v171,-v11,v51
v_fma_f32 v19,v19,v10,v171
v_mul_f32_e64 v168,-v11,v52
v_fma_f32 v20,v20,v10,v168
v_mul_f32_e64 v169,-v11,v53
v_fma_f32 v21,v21,v10,v169
v_mul_f32_e64 v170,-v11,v54
v_fma_f32 v22,v22,v10,v170
v_mul_f32_e64 v171,-v11,v55
v_fma_f32 v23,v23,v10,v171
v_cvt_pk_bf16_f32 v144,v16,v17
v_cvt_pk_bf16_f32 v145,v18,v19
v_cvt_pk_bf16_f32 v146,v20,v21
v_cvt_pk_bf16_f32 v147,v22,v23
buffer_store_dwordx4 v[144:147],v1,s[24:27],s36 offen sc1
v_mul_f32_e64 v168,-v11,v56
v_fma_f32 v24,v24,v10,v168
v_mul_f32_e64 v169,-v11,v57
v_fma_f32 v25,v25,v10,v169
v_mul_f32_e64 v170,-v11,v58
v_fma_f32 v26,v26,v10,v170
v_mul_f32_e64 v171,-v11,v59
v_fma_f32 v27,v27,v10,v171
v_mul_f32_e64 v168,-v11,v60
v_fma_f32 v28,v28,v10,v168
v_mul_f32_e64 v169,-v11,v61
v_fma_f32 v29,v29,v10,v169
v_mul_f32_e64 v170,-v11,v62
v_fma_f32 v30,v30,v10,v170
v_mul_f32_e64 v171,-v11,v63
v_fma_f32 v31,v31,v10,v171
v_cvt_pk_bf16_f32 v148,v24,v25
v_cvt_pk_bf16_f32 v149,v26,v27
v_cvt_pk_bf16_f32 v150,v28,v29
v_cvt_pk_bf16_f32 v151,v30,v31
buffer_store_dwordx4 v[148:151],v1,s[24:27],s36 offen offset:1024 sc1
v_mul_f32_e64 v168,-v11,v64
v_fma_f32 v32,v32,v10,v168
v_mul_f32_e64 v169,-v11,v65
v_fma_f32 v33,v33,v10,v169
v_mul_f32_e64 v170,-v11,v66
v_fma_f32 v34,v34,v10,v170
v_mul_f32_e64 v171,-v11,v67
v_fma_f32 v35,v35,v10,v171
v_mul_f32_e64 v168,-v11,v68
v_fma_f32 v36,v36,v10,v168
v_mul_f32_e64 v169,-v11,v69
v_fma_f32 v37,v37,v10,v169
v_mul_f32_e64 v170,-v11,v70
v_fma_f32 v38,v38,v10,v170
v_mul_f32_e64 v171,-v11,v71
v_fma_f32 v39,v39,v10,v171
v_cvt_pk_bf16_f32 v152,v32,v33
v_cvt_pk_bf16_f32 v153,v34,v35
v_cvt_pk_bf16_f32 v154,v36,v37
v_cvt_pk_bf16_f32 v155,v38,v39
buffer_store_dwordx4 v[152:155],v1,s[24:27],s36 offen offset:2048 sc1
v_mul_f32_e64 v168,-v11,v72
v_fma_f32 v40,v40,v10,v168
v_mul_f32_e64 v169,-v11,v73
v_fma_f32 v41,v41,v10,v169
v_mul_f32_e64 v170,-v11,v74
v_fma_f32 v42,v42,v10,v170
v_mul_f32_e64 v171,-v11,v75
v_fma_f32 v43,v43,v10,v171
v_mul_f32_e64 v168,-v11,v76
v_fma_f32 v44,v44,v10,v168
v_mul_f32_e64 v169,-v11,v77
v_fma_f32 v45,v45,v10,v169
v_mul_f32_e64 v170,-v11,v78
v_fma_f32 v46,v46,v10,v170
v_mul_f32_e64 v171,-v11,v79
v_fma_f32 v47,v47,v10,v171
v_cvt_pk_bf16_f32 v156,v40,v41
v_cvt_pk_bf16_f32 v157,v42,v43
v_cvt_pk_bf16_f32 v158,v44,v45
v_cvt_pk_bf16_f32 v159,v46,v47
buffer_store_dwordx4 v[156:159],v1,s[24:27],s36 offen offset:3072 sc1
s_nop 0
s_branch ns_stop_165
ns_se_168:
s_nop 7
s_nop 3
v_mul_f32_e64 v168,-v11,v48
v_fma_f32 v128,v128,v10,v168
v_mul_f32_e64 v169,-v11,v49
v_fma_f32 v129,v129,v10,v169
v_mul_f32_e64 v170,-v11,v50
v_fma_f32 v130,v130,v10,v170
v_mul_f32_e64 v171,-v11,v51
v_fma_f32 v131,v131,v10,v171
v_mul_f32_e64 v168,-v11,v52
v_fma_f32 v132,v132,v10,v168
v_mul_f32_e64 v169,-v11,v53
v_fma_f32 v133,v133,v10,v169
v_mul_f32_e64 v170,-v11,v54
v_fma_f32 v134,v134,v10,v170
v_mul_f32_e64 v171,-v11,v55
v_fma_f32 v135,v135,v10,v171
v_cvt_pk_bf16_f32 v144,v128,v129
v_cvt_pk_bf16_f32 v145,v130,v131
v_cvt_pk_bf16_f32 v146,v132,v133
v_cvt_pk_bf16_f32 v147,v134,v135
buffer_store_dwordx4 v[144:147],v1,s[24:27],s36 offen sc1
v_mul_f32_e64 v168,-v11,v56
v_fma_f32 v136,v136,v10,v168
v_mul_f32_e64 v169,-v11,v57
v_fma_f32 v137,v137,v10,v169
v_mul_f32_e64 v170,-v11,v58
v_fma_f32 v138,v138,v10,v170
v_mul_f32_e64 v171,-v11,v59
v_fma_f32 v139,v139,v10,v171
v_mul_f32_e64 v168,-v11,v60
v_fma_f32 v140,v140,v10,v168
v_mul_f32_e64 v169,-v11,v61
v_fma_f32 v141,v141,v10,v169
v_mul_f32_e64 v170,-v11,v62
v_fma_f32 v142,v142,v10,v170
v_mul_f32_e64 v171,-v11,v63
v_fma_f32 v143,v143,v10,v171
v_cvt_pk_bf16_f32 v148,v136,v137
v_cvt_pk_bf16_f32 v149,v138,v139
v_cvt_pk_bf16_f32 v150,v140,v141
v_cvt_pk_bf16_f32 v151,v142,v143
buffer_store_dwordx4 v[148:151],v1,s[24:27],s36 offen offset:1024 sc1
v_mul_f32_e64 v168,-v11,v64
v_fma_f32 v172,v172,v10,v168
v_mul_f32_e64 v169,-v11,v65
v_fma_f32 v173,v173,v10,v169
v_mul_f32_e64 v170,-v11,v66
v_fma_f32 v174,v174,v10,v170
v_mul_f32_e64 v171,-v11,v67
v_fma_f32 v175,v175,v10,v171
v_mul_f32_e64 v168,-v11,v68
v_fma_f32 v176,v176,v10,v168
v_mul_f32_e64 v169,-v11,v69
v_fma_f32 v177,v177,v10,v169
v_mul_f32_e64 v170,-v11,v70
v_fma_f32 v178,v178,v10,v170
v_mul_f32_e64 v171,-v11,v71
v_fma_f32 v179,v179,v10,v171
v_cvt_pk_bf16_f32 v152,v172,v173
v_cvt_pk_bf16_f32 v153,v174,v175
v_cvt_pk_bf16_f32 v154,v176,v177
v_cvt_pk_bf16_f32 v155,v178,v179
buffer_store_dwordx4 v[152:155],v1,s[24:27],s36 offen offset:2048 sc1
v_mul_f32_e64 v168,-v11,v72
v_fma_f32 v180,v180,v10,v168
v_mul_f32_e64 v169,-v11,v73
v_fma_f32 v181,v181,v10,v169
v_mul_f32_e64 v170,-v11,v74
v_fma_f32 v182,v182,v10,v170
v_mul_f32_e64 v171,-v11,v75
v_fma_f32 v183,v183,v10,v171
v_mul_f32_e64 v168,-v11,v76
v_fma_f32 v184,v184,v10,v168
v_mul_f32_e64 v169,-v11,v77
v_fma_f32 v185,v185,v10,v169
v_mul_f32_e64 v170,-v11,v78
v_fma_f32 v186,v186,v10,v170
v_mul_f32_e64 v171,-v11,v79
v_fma_f32 v187,v187,v10,v171
v_cvt_pk_bf16_f32 v156,v180,v181
v_cvt_pk_bf16_f32 v157,v182,v183
v_cvt_pk_bf16_f32 v158,v184,v185
v_cvt_pk_bf16_f32 v159,v186,v187
buffer_store_dwordx4 v[156:159],v1,s[24:27],s36 offen offset:3072 sc1
s_nop 0
s_branch ns_stop_165
ns_stop_165:
s_waitcnt vmcnt(0) lgkmcnt(0)
v_mov_b32 v2,s64
s_mov_b64 exec,1
buffer_store_dword v2,off,s[24:27],s37 sc1
s_mov_b64 exec,-1
s_cmp_lg_u32 s65,0
s_cbranch_scc1 L_steady
s_barrier
s_mov_b32 s39,1
s_mov_b32 s28,0
s_mov_b32 s63,64
s_mov_b32 s35,0
s_branch ns_init_124
R_v:
s_mov_b32 s24,s4
s_mov_b32 s25,s5
s_mov_b32 s27,0x20000
s_cmp_lt_u32 s41,192
s_cselect_b32 s26,s6,0
s_min_u32 s41,s41,191
v_lshlrev_b32 v1,4,v0
s_lshr_b32 s42,s41,6
s_lshl_b32 s42,s42,3
s_add_u32 s42,s42,16
s_load_dwordx2 s[20:21],s[0:1],s42
s_waitcnt lgkmcnt(0)
s_mov_b32 s16,s20
s_and_b32 s17,s21,0xffff
s_mov_b32 s18,0x500000
s_mov_b32 s19,0x20000
s_and_b32 s42,s41,63
s_lshl_b32 s42,s42,7
v_lshrrev_b32 v98,3,v0
v_mul_u32_u24 v96,8192,v98
v_and_b32 v98,7,v0
v_lshl_add_u32 v96,v98,4,v96
v_and_b32 v98,3,v0
v_lshlrev_b32 v97,3,v98
v_bfe_u32 v98,v0,4,1
v_lshl_add_u32 v97,v98,5,v97
v_bfe_u32 v98,v0,2,2
v_lshl_add_u32 v97,v98,7,v97
v_lshrrev_b32 v98,5,v0
v_lshl_add_u32 v97,v98,9,v97
s_mul_i32 s22,s3,40960
v_add_u32 v97,s22,v97
v_xor_b32 v98,64,v97
s_add_u32 s20,s42,0
s_add_u32 s23,s22,0
s_mov_b32 m0,s23
s_nop 0
buffer_load_dwordx4 v96,s[16:19],s20 offen lds
s_add_u32 s23,s22,1024
s_mov_b32 m0,s23
s_add_u32 s20,s20,65536
buffer_load_dwordx4 v96,s[16:19],s20 offen lds
s_add_u32 s20,s42,131072
s_add_u32 s23,s22,2048
s_mov_b32 m0,s23
s_nop 0
buffer_load_dwordx4 v96,s[16:19],s20 offen lds
s_add_u32 s23,s22,3072
s_mov_b32 m0,s23
s_add_u32 s20,s20,65536
buffer_load_dwordx4 v96,s[16:19],s20 offen lds
s_add_u32 s20,s42,262144
s_add_u32 s23,s22,4096
s_mov_b32 m0,s23
s_nop 0
buffer_load_dwordx4 v96,s[16:19],s20 offen lds
s_add_u32 s23,s22,5120
s_mov_b32 m0,s23
s_add_u32 s20,s20,65536
buffer_load_dwordx4 v96,s[16:19],s20 offen lds
s_add_u32 s20,s42,393216
s_add_u32 s23,s22,6144
s_mov_b32 m0,s23
s_nop 0
buffer_load_dwordx4 v96,s[16:19],s20 offen lds
s_add_u32 s23,s22,7168
s_mov_b32 m0,s23
s_add_u32 s20,s20,65536
buffer_load_dwordx4 v96,s[16:19],s20 offen lds
s_add_u32 s20,s42,524288
s_add_u32 s23,s22,8192
s_mov_b32 m0,s23
s_nop 0
buffer_load_dwordx4 v96,s[16:19],s20 offen lds
s_add_u32 s23,s22,9216
s_mov_b32 m0,s23
s_add_u32 s20,s20,65536
buffer_load_dwordx4 v96,s[16:19],s20 offen lds
s_add_u32 s20,s42,655360
s_add_u32 s23,s22,10240
s_mov_b32 m0,s23
s_nop 0
buffer_load_dwordx4 v96,s[16:19],s20 offen lds
s_add_u32 s23,s22,11264
s_mov_b32 m0,s23
s_add_u32 s20,s20,65536
buffer_load_dwordx4 v96,s[16:19],s20 offen lds
s_add_u32 s20,s42,786432
s_add_u32 s23,s22,12288
s_mov_b32 m0,s23
s_nop 0
buffer_load_dwordx4 v96,s[16:19],s20 offen lds
s_add_u32 s23,s22,13312
s_mov_b32 m0,s23
s_add_u32 s20,s20,65536
buffer_load_dwordx4 v96,s[16:19],s20 offen lds
s_add_u32 s20,s42,917504
s_add_u32 s23,s22,14336
s_mov_b32 m0,s23
s_nop 0
buffer_load_dwordx4 v96,s[16:19],s20 offen lds
s_add_u32 s23,s22,15360
s_mov_b32 m0,s23
s_add_u32 s20,s20,65536
buffer_load_dwordx4 v96,s[16:19],s20 offen lds
s_add_u32 s20,s42,1048576
s_add_u32 s23,s22,16384
s_mov_b32 m0,s23
s_nop 0
buffer_load_dwordx4 v96,s[16:19],s20 offen lds
s_add_u32 s23,s22,17408
s_mov_b32 m0,s23
s_add_u32 s20,s20,65536
buffer_load_dwordx4 v96,s[16:19],s20 offen lds
s_add_u32 s20,s42,1179648
s_add_u32 s23,s22,18432
s_mov_b32 m0,s23
s_nop 0
buffer_load_dwordx4 v96,s[16:19],s20 offen lds
s_add_u32 s23,s22,19456
s_mov_b32 m0,s23
s_add_u32 s20,s20,65536
buffer_load_dwordx4 v96,s[16:19],s20 offen lds
s_add_u32 s20,s42,1310720
s_add_u32 s23,s22,20480
s_mov_b32 m0,s23
s_nop 0
buffer_load_dwordx4 v96,s[16:19],s20 offen lds
s_add_u32 s23,s22,21504
s_mov_b32 m0,s23
s_add_u32 s20,s20,65536
buffer_load_dwordx4 v96,s[16:19],s20 offen lds
s_add_u32 s20,s42,1441792
s_add_u32 s23,s22,22528
s_mov_b32 m0,s23
s_nop 0
buffer_load_dwordx4 v96,s[16:19],s20 offen lds
s_add_u32 s23,s22,23552
s_mov_b32 m0,s23
s_add_u32 s20,s20,65536
buffer_load_dwordx4 v96,s[16:19],s20 offen lds
s_add_u32 s20,s42,1572864
s_add_u32 s23,s22,24576
s_mov_b32 m0,s23
s_nop 0
buffer_load_dwordx4 v96,s[16:19],s20 offen lds
s_add_u32 s23,s22,25600
s_mov_b32 m0,s23
s_add_u32 s20,s20,65536
buffer_load_dwordx4 v96,s[16:19],s20 offen lds
s_add_u32 s20,s42,1703936
s_add_u32 s23,s22,26624
s_mov_b32 m0,s23
s_nop 0
buffer_load_dwordx4 v96,s[16:19],s20 offen lds
s_add_u32 s23,s22,27648
s_mov_b32 m0,s23
s_add_u32 s20,s20,65536
buffer_load_dwordx4 v96,s[16:19],s20 offen lds
s_add_u32 s20,s42,1835008
s_add_u32 s23,s22,28672
s_mov_b32 m0,s23
s_nop 0
buffer_load_dwordx4 v96,s[16:19],s20 offen lds
s_add_u32 s23,s22,29696
s_mov_b32 m0,s23
s_add_u32 s20,s20,65536
buffer_load_dwordx4 v96,s[16:19],s20 offen lds
s_add_u32 s20,s42,1966080
s_add_u32 s23,s22,30720
s_mov_b32 m0,s23
s_nop 0
buffer_load_dwordx4 v96,s[16:19],s20 offen lds
s_add_u32 s23,s22,31744
s_mov_b32 m0,s23
s_add_u32 s20,s20,65536
buffer_load_dwordx4 v96,s[16:19],s20 offen lds
s_add_u32 s20,s42,2097152
s_add_u32 s23,s22,32768
s_mov_b32 m0,s23
s_nop 0
buffer_load_dwordx4 v96,s[16:19],s20 offen lds
s_add_u32 s23,s22,33792
s_mov_b32 m0,s23
s_add_u32 s20,s20,65536
buffer_load_dwordx4 v96,s[16:19],s20 offen lds
s_add_u32 s20,s42,2228224
s_add_u32 s23,s22,34816
s_mov_b32 m0,s23
s_nop 0
buffer_load_dwordx4 v96,s[16:19],s20 offen lds
s_add_u32 s23,s22,35840
s_mov_b32 m0,s23
s_add_u32 s20,s20,65536
buffer_load_dwordx4 v96,s[16:19],s20 offen lds
s_waitcnt vmcnt(34)
ds_read_b64_tr_b16 a[0:1],v97
ds_read_b64_tr_b16 a[2:3],v97 offset:1024
ds_read_b64_tr_b16 a[160:161],v98
ds_read_b64_tr_b16 a[162:163],v98 offset:1024
s_waitcnt vmcnt(32)
ds_read_b64_tr_b16 a[4:5],v97 offset:2048
ds_read_b64_tr_b16 a[6:7],v97 offset:3072
ds_read_b64_tr_b16 a[164:165],v98 offset:2048
ds_read_b64_tr_b16 a[166:167],v98 offset:3072
s_waitcnt vmcnt(30)
ds_read_b64_tr_b16 a[8:9],v97 offset:4096
ds_read_b64_tr_b16 a[10:11],v97 offset:5120
ds_read_b64_tr_b16 a[168:169],v98 offset:4096
ds_read_b64_tr_b16 a[170:171],v98 offset:5120
s_waitcnt lgkmcnt(8)
s_add_u32 s20,s42,2359296
s_add_u32 s23,s22,0
s_mov_b32 m0,s23
s_nop 0
buffer_load_dwordx4 v96,s[16:19],s20 offen lds
s_add_u32 s23,s22,1024
s_mov_b32 m0,s23
s_add_u32 s20,s20,65536
buffer_load_dwordx4 v96,s[16:19],s20 offen lds
s_waitcnt vmcnt(30)
ds_read_b64_tr_b16 a[12:13],v97 offset:6144
ds_read_b64_tr_b16 a[14:15],v97 offset:7168
ds_read_b64_tr_b16 a[172:173],v98 offset:6144
ds_read_b64_tr_b16 a[174:175],v98 offset:7168
s_waitcnt lgkmcnt(8)
s_add_u32 s20,s42,2490368
s_add_u32 s23,s22,2048
s_mov_b32 m0,s23
s_nop 0
buffer_load_dwordx4 v96,s[16:19],s20 offen lds
s_add_u32 s23,s22,3072
s_mov_b32 m0,s23
s_add_u32 s20,s20,65536
buffer_load_dwordx4 v96,s[16:19],s20 offen lds
s_waitcnt vmcnt(30)
ds_read_b64_tr_b16 a[16:17],v97 offset:8192
ds_read_b64_tr_b16 a[18:19],v97 offset:9216
ds_read_b64_tr_b16 a[176:177],v98 offset:8192
ds_read_b64_tr_b16 a[178:179],v98 offset:9216
s_waitcnt lgkmcnt(8)
s_add_u32 s20,s42,2621440
s_add_u32 s23,s22,4096
s_mov_b32 m0,s23
s_nop 0
buffer_load_dwordx4 v96,s[16:19],s20 offen lds
s_add_u32 s23,s22,5120
s_mov_b32 m0,s23
s_add_u32 s20,s20,65536
buffer_load_dwordx4 v96,s[16:19],s20 offen lds
s_waitcnt vmcnt(30)
ds_read_b64_tr_b16 a[20:21],v97 offset:10240
ds_read_b64_tr_b16 a[22:23],v97 offset:11264
ds_read_b64_tr_b16 a[180:181],v98 offset:10240
ds_read_b64_tr_b16 a[182:183],v98 offset:11264
s_waitcnt lgkmcnt(8)
s_add_u32 s20,s42,2752512
s_add_u32 s23,s22,6144
s_mov_b32 m0,s23
s_nop 0
buffer_load_dwordx4 v96,s[16:19],s20 offen lds
s_add_u32 s23,s22,7168
s_mov_b32 m0,s23
s_add_u32 s20,s20,65536
buffer_load_dwordx4 v96,s[16:19],s20 offen lds
s_waitcnt vmcnt(30)
ds_read_b64_tr_b16 a[24:25],v97 offset:12288
ds_read_b64_tr_b16 a[26:27],v97 offset:13312
ds_read_b64_tr_b16 a[184:185],v98 offset:12288
ds_read_b64_tr_b16 a[186:187],v98 offset:13312
s_waitcnt lgkmcnt(8)
s_add_u32 s20,s42,2883584
s_add_u32 s23,s22,8192
s_mov_b32 m0,s23
s_nop 0
buffer_load_dwordx4 v96,s[16:19],s20 offen lds
s_add_u32 s23,s22,9216
s_mov_b32 m0,s23
s_add_u32 s20,s20,65536
buffer_load_dwordx4 v96,s[16:19],s20 offen lds
s_waitcnt vmcnt(30)
ds_read_b64_tr_b16 a[28:29],v97 offset:14336
ds_read_b64_tr_b16 a[30:31],v97 offset:15360
ds_read_b64_tr_b16 a[188:189],v98 offset:14336
ds_read_b64_tr_b16 a[190:191],v98 offset:15360
s_waitcnt lgkmcnt(8)
s_add_u32 s20,s42,3014656
s_add_u32 s23,s22,10240
s_mov_b32 m0,s23
s_nop 0
buffer_load_dwordx4 v96,s[16:19],s20 offen lds
s_add_u32 s23,s22,11264
s_mov_b32 m0,s23
s_add_u32 s20,s20,65536
buffer_load_dwordx4 v96,s[16:19],s20 offen lds
s_waitcnt vmcnt(30)
ds_read_b64_tr_b16 a[32:33],v97 offset:16384
ds_read_b64_tr_b16 a[34:35],v97 offset:17408
ds_read_b64_tr_b16 a[192:193],v98 offset:16384
ds_read_b64_tr_b16 a[194:195],v98 offset:17408
s_waitcnt lgkmcnt(8)
s_add_u32 s20,s42,3145728
s_add_u32 s23,s22,12288
s_mov_b32 m0,s23
s_nop 0
buffer_load_dwordx4 v96,s[16:19],s20 offen lds
s_add_u32 s23,s22,13312
s_mov_b32 m0,s23
s_add_u32 s20,s20,65536
buffer_load_dwordx4 v96,s[16:19],s20 offen lds
s_waitcnt vmcnt(30)
ds_read_b64_tr_b16 a[36:37],v97 offset:18432
ds_read_b64_tr_b16 a[38:39],v97 offset:19456
ds_read_b64_tr_b16 a[196:197],v98 offset:18432
ds_read_b64_tr_b16 a[198:199],v98 offset:19456
s_waitcnt lgkmcnt(8)
s_add_u32 s20,s42,3276800
s_add_u32 s23,s22,14336
s_mov_b32 m0,s23
s_nop 0
buffer_load_dwordx4 v96,s[16:19],s20 offen lds
s_add_u32 s23,s22,15360
s_mov_b32 m0,s23
s_add_u32 s20,s20,65536
buffer_load_dwordx4 v96,s[16:19],s20 offen lds
s_waitcnt vmcnt(30)
ds_read_b64_tr_b16 a[40:41],v97 offset:20480
ds_read_b64_tr_b16 a[42:43],v97 offset:21504
ds_read_b64_tr_b16 a[200:201],v98 offset:20480
ds_read_b64_tr_b16 a[202:203],v98 offset:21504
s_waitcnt lgkmcnt(8)
s_add_u32 s20,s42,3407872
s_add_u32 s23,s22,16384
s_mov_b32 m0,s23
s_nop 0
buffer_load_dwordx4 v96,s[16:19],s20 offen lds
s_add_u32 s23,s22,17408
s_mov_b32 m0,s23
s_add_u32 s20,s20,65536
buffer_load_dwordx4 v96,s[16:19],s20 offen lds
s_waitcnt vmcnt(30)
ds_read_b64_tr_b16 a[44:45],v97 offset:22528
ds_read_b64_tr_b16 a[46:47],v97 offset:23552
ds_read_b64_tr_b16 a[204:205],v98 offset:22528
ds_read_b64_tr_b16 a[206:207],v98 offset:23552
s_waitcnt lgkmcnt(8)
s_add_u32 s20,s42,3538944
s_add_u32 s23,s22,18432
s_mov_b32 m0,s23
s_nop 0
buffer_load_dwordx4 v96,s[16:19],s20 offen lds
s_add_u32 s23,s22,19456
s_mov_b32 m0,s23
s_add_u32 s20,s20,65536
buffer_load_dwordx4 v96,s[16:19],s20 offen lds
s_waitcnt vmcnt(30)
ds_read_b64_tr_b16 a[48:49],v97 offset:24576
ds_read_b64_tr_b16 a[50:51],v97 offset:25600
ds_read_b64_tr_b16 a[208:209],v98 offset:24576
ds_read_b64_tr_b16 a[210:211],v98 offset:25600
s_waitcnt lgkmcnt(8)
s_add_u32 s20,s42,3670016
s_add_u32 s23,s22,20480
s_mov_b32 m0,s23
s_nop 0
buffer_load_dwordx4 v96,s[16:19],s20 offen lds
s_add_u32 s23,s22,21504
s_mov_b32 m0,s23
s_add_u32 s20,s20,65536
buffer_load_dwordx4 v96,s[16:19],s20 offen lds
s_waitcnt vmcnt(30)
ds_read_b64_tr_b16 a[52:53],v97 offset:26624
ds_read_b64_tr_b16 a[54:55],v97 offset:27648
ds_read_b64_tr_b16 a[212:213],v98 offset:26624
ds_read_b64_tr_b16 a[214:215],v98 offset:27648
s_waitcnt lgkmcnt(8)
s_add_u32 s20,s42,3801088
s_add_u32 s23,s22,22528
s_mov_b32 m0,s23
s_nop 0
buffer_load_dwordx4 v96,s[16:19],s20 offen lds
s_add_u32 s23,s22,23552
s_mov_b32 m0,s23
s_add_u32 s20,s20,65536
buffer_load_dwordx4 v96,s[16:19],s20 offen lds
s_waitcnt vmcnt(30)
ds_read_b64_tr_b16 a[56:57],v97 offset:28672
ds_read_b64_tr_b16 a[58:59],v97 offset:29696
ds_read_b64_tr_b16 a[216:217],v98 offset:28672
ds_read_b64_tr_b16 a[218:219],v98 offset:29696
s_waitcnt lgkmcnt(8)
s_add_u32 s20,s42,3932160
s_add_u32 s23,s22,24576
s_mov_b32 m0,s23
s_nop 0
buffer_load_dwordx4 v96,s[16:19],s20 offen lds
s_add_u32 s23,s22,25600
s_mov_b32 m0,s23
s_add_u32 s20,s20,65536
buffer_load_dwordx4 v96,s[16:19],s20 offen lds
s_waitcnt vmcnt(30)
ds_read_b64_tr_b16 a[60:61],v97 offset:30720
ds_read_b64_tr_b16 a[62:63],v97 offset:31744
ds_read_b64_tr_b16 a[220:221],v98 offset:30720
ds_read_b64_tr_b16 a[222:223],v98 offset:31744
s_waitcnt lgkmcnt(8)
s_add_u32 s20,s42,4063232
s_add_u32 s23,s22,26624
s_mov_b32 m0,s23
s_nop 0
buffer_load_dwordx4 v96,s[16:19],s20 offen lds
s_add_u32 s23,s22,27648
s_mov_b32 m0,s23
s_add_u32 s20,s20,65536
buffer_load_dwordx4 v96,s[16:19],s20 offen lds
s_waitcnt vmcnt(30)
ds_read_b64_tr_b16 a[64:65],v97 offset:32768
ds_read_b64_tr_b16 a[66:67],v97 offset:33792
ds_read_b64_tr_b16 a[224:225],v98 offset:32768
ds_read_b64_tr_b16 a[226:227],v98 offset:33792
s_waitcnt lgkmcnt(8)
s_add_u32 s20,s42,4194304
s_add_u32 s23,s22,28672
s_mov_b32 m0,s23
s_nop 0
buffer_load_dwordx4 v96,s[16:19],s20 offen lds
s_add_u32 s23,s22,29696
s_mov_b32 m0,s23
s_add_u32 s20,s20,65536
buffer_load_dwordx4 v96,s[16:19],s20 offen lds
s_waitcnt vmcnt(30)
ds_read_b64_tr_b16 a[68:69],v97 offset:34816
ds_read_b64_tr_b16 a[70:71],v97 offset:35840
ds_read_b64_tr_b16 a[228:229],v98 offset:34816
ds_read_b64_tr_b16 a[230:231],v98 offset:35840
s_waitcnt lgkmcnt(8)
s_add_u32 s20,s42,4325376
s_add_u32 s23,s22,30720
s_mov_b32 m0,s23
s_nop 0
buffer_load_dwordx4 v96,s[16:19],s20 offen lds
s_add_u32 s23,s22,31744
s_mov_b32 m0,s23
s_add_u32 s20,s20,65536
buffer_load_dwordx4 v96,s[16:19],s20 offen lds
s_waitcnt vmcnt(30)
ds_read_b64_tr_b16 a[72:73],v97
ds_read_b64_tr_b16 a[74:75],v97 offset:1024
ds_read_b64_tr_b16 a[232:233],v98
ds_read_b64_tr_b16 a[234:235],v98 offset:1024
s_waitcnt lgkmcnt(8)
s_add_u32 s20,s42,4456448
s_add_u32 s23,s22,32768
s_mov_b32 m0,s23
s_nop 0
buffer_load_dwordx4 v96,s[16:19],s20 offen lds
s_add_u32 s23,s22,33792
s_mov_b32 m0,s23
s_add_u32 s20,s20,65536
buffer_load_dwordx4 v96,s[16:19],s20 offen lds
s_waitcnt vmcnt(30)
ds_read_b64_tr_b16 a[76:77],v97 offset:2048
ds_read_b64_tr_b16 a[78:79],v97 offset:3072
ds_read_b64_tr_b16 a[236:237],v98 offset:2048
ds_read_b64_tr_b16 a[238:239],v98 offset:3072
s_waitcnt lgkmcnt(8)
s_add_u32 s20,s42,4587520
s_add_u32 s23,s22,34816
s_mov_b32 m0,s23
s_nop 0
buffer_load_dwordx4 v96,s[16:19],s20 offen lds
s_add_u32 s23,s22,35840
s_mov_b32 m0,s23
s_add_u32 s20,s20,65536
buffer_load_dwordx4 v96,s[16:19],s20 offen lds
s_waitcnt vmcnt(30)
ds_read_b64_tr_b16 a[80:81],v97 offset:4096
ds_read_b64_tr_b16 a[82:83],v97 offset:5120
ds_read_b64_tr_b16 a[240:241],v98 offset:4096
ds_read_b64_tr_b16 a[242:243],v98 offset:5120
s_waitcnt lgkmcnt(8)
s_add_u32 s20,s42,4718592
s_add_u32 s23,s22,0
s_mov_b32 m0,s23
s_nop 0
buffer_load_dwordx4 v96,s[16:19],s20 offen lds
s_add_u32 s23,s22,1024
s_mov_b32 m0,s23
s_add_u32 s20,s20,65536
buffer_load_dwordx4 v96,s[16:19],s20 offen lds
s_waitcnt vmcnt(30)
ds_read_b64_tr_b16 a[84:85],v97 offset:6144
ds_read_b64_tr_b16 a[86:87],v97 offset:7168
ds_read_b64_tr_b16 a[244:245],v98 offset:6144
ds_read_b64_tr_b16 a[246:247],v98 offset:7168
s_waitcnt lgkmcnt(8)
s_add_u32 s20,s42,4849664
s_add_u32 s23,s22,2048
s_mov_b32 m0,s23
s_nop 0
buffer_load_dwordx4 v96,s[16:19],s20 offen lds
s_add_u32 s23,s22,3072
s_mov_b32 m0,s23
s_add_u32 s20,s20,65536
buffer_load_dwordx4 v96,s[16:19],s20 offen lds
s_waitcnt vmcnt(30)
ds_read_b64_tr_b16 a[88:89],v97 offset:8192
ds_read_b64_tr_b16 a[90:91],v97 offset:9216
ds_read_b64_tr_b16 a[248:249],v98 offset:8192
ds_read_b64_tr_b16 a[250:251],v98 offset:9216
s_waitcnt lgkmcnt(8)
s_add_u32 s20,s42,4980736
s_add_u32 s23,s22,4096
s_mov_b32 m0,s23
s_nop 0
buffer_load_dwordx4 v96,s[16:19],s20 offen lds
s_add_u32 s23,s22,5120
s_mov_b32 m0,s23
s_add_u32 s20,s20,65536
buffer_load_dwordx4 v96,s[16:19],s20 offen lds
s_waitcnt vmcnt(30)
ds_read_b64_tr_b16 a[92:93],v97 offset:10240
ds_read_b64_tr_b16 a[94:95],v97 offset:11264
ds_read_b64_tr_b16 a[252:253],v98 offset:10240
ds_read_b64_tr_b16 a[254:255],v98 offset:11264
s_waitcnt lgkmcnt(8)
s_add_u32 s20,s42,5111808
s_add_u32 s23,s22,6144
s_mov_b32 m0,s23
s_nop 0
buffer_load_dwordx4 v96,s[16:19],s20 offen lds
s_add_u32 s23,s22,7168
s_mov_b32 m0,s23
s_add_u32 s20,s20,65536
buffer_load_dwordx4 v96,s[16:19],s20 offen lds
s_waitcnt vmcnt(30)
ds_read_b64_tr_b16 a[96:97],v97 offset:12288
ds_read_b64_tr_b16 a[98:99],v97 offset:13312
ds_read_b64_tr_b16 v[192:193],v98 offset:12288
ds_read_b64_tr_b16 v[194:195],v98 offset:13312
s_waitcnt vmcnt(28)
ds_read_b64_tr_b16 a[100:101],v97 offset:14336
ds_read_b64_tr_b16 a[102:103],v97 offset:15360
ds_read_b64_tr_b16 v[196:197],v98 offset:14336
ds_read_b64_tr_b16 v[198:199],v98 offset:15360
s_waitcnt vmcnt(26)
ds_read_b64_tr_b16 a[104:105],v97 offset:16384
ds_read_b64_tr_b16 a[106:107],v97 offset:17408
ds_read_b64_tr_b16 v[200:201],v98 offset:16384
ds_read_b64_tr_b16 v[202:203],v98 offset:17408
s_waitcnt vmcnt(24)
ds_read_b64_tr_b16 a[108:109],v97 offset:18432
ds_read_b64_tr_b16 a[110:111],v97 offset:19456
ds_read_b64_tr_b16 v[204:205],v98 offset:18432
ds_read_b64_tr_b16 v[206:207],v98 offset:19456
s_waitcnt vmcnt(22)
ds_read_b64_tr_b16 a[112:113],v97 offset:20480
ds_read_b64_tr_b16 a[114:115],v97 offset:21504
ds_read_b64_tr_b16 v[208:209],v98 offset:20480
ds_read_b64_tr_b16 v[210:211],v98 offset:21504
s_waitcnt vmcnt(20)
ds_read_b64_tr_b16 a[116:117],v97 offset:22528
ds_read_b64_tr_b16 a[118:119],v97 offset:23552
ds_read_b64_tr_b16 v[212:213],v98 offset:22528
ds_read_b64_tr_b16 v[214:215],v98 offset:23552
s_waitcnt vmcnt(18)
ds_read_b64_tr_b16 a[120:121],v97 offset:24576
ds_read_b64_tr_b16 a[122:123],v97 offset:25600
ds_read_b64_tr_b16 v[216:217],v98 offset:24576
ds_read_b64_tr_b16 v[218:219],v98 offset:25600
s_waitcnt vmcnt(16)
ds_read_b64_tr_b16 a[124:125],v97 offset:26624
ds_read_b64_tr_b16 a[126:127],v97 offset:27648
ds_read_b64_tr_b16 v[220:221],v98 offset:26624
ds_read_b64_tr_b16 v[222:223],v98 offset:27648
s_waitcnt vmcnt(14)
ds_read_b64_tr_b16 a[128:129],v97 offset:28672
ds_read_b64_tr_b16 a[130:131],v97 offset:29696
ds_read_b64_tr_b16 v[224:225],v98 offset:28672
ds_read_b64_tr_b16 v[226:227],v98 offset:29696
s_waitcnt vmcnt(12)
ds_read_b64_tr_b16 a[132:133],v97 offset:30720
ds_read_b64_tr_b16 a[134:135],v97 offset:31744
ds_read_b64_tr_b16 v[228:229],v98 offset:30720
ds_read_b64_tr_b16 v[230:231],v98 offset:31744
s_waitcnt vmcnt(10)
ds_read_b64_tr_b16 a[136:137],v97 offset:32768
ds_read_b64_tr_b16 a[138:139],v97 offset:33792
ds_read_b64_tr_b16 v[232:233],v98 offset:32768
ds_read_b64_tr_b16 v[234:235],v98 offset:33792
s_waitcnt vmcnt(8)
ds_read_b64_tr_b16 a[140:141],v97 offset:34816
ds_read_b64_tr_b16 a[142:143],v97 offset:35840
ds_read_b64_tr_b16 v[236:237],v98 offset:34816
ds_read_b64_tr_b16 v[238:239],v98 offset:35840
s_waitcnt vmcnt(6)
ds_read_b64_tr_b16 a[144:145],v97
ds_read_b64_tr_b16 a[146:147],v97 offset:1024
ds_read_b64_tr_b16 v[240:241],v98
ds_read_b64_tr_b16 v[242:243],v98 offset:1024
s_waitcnt vmcnt(4)
ds_read_b64_tr_b16 a[148:149],v97 offset:2048
ds_read_b64_tr_b16 a[150:151],v97 offset:3072
ds_read_b64_tr_b16 v[244:245],v98 offset:2048
ds_read_b64_tr_b16 v[246:247],v98 offset:3072
s_waitcnt vmcnt(2)
ds_read_b64_tr_b16 a[152:153],v97 offset:4096
ds_read_b64_tr_b16 a[154:155],v97 offset:5120
ds_read_b64_tr_b16 v[248:249],v98 offset:4096
ds_read_b64_tr_b16 v[250:251],v98 offset:5120
s_waitcnt vmcnt(0)
ds_read_b64_tr_b16 a[156:157],v97 offset:6144
ds_read_b64_tr_b16 a[158:159],v97 offset:7168
ds_read_b64_tr_b16 v[252:253],v98 offset:6144
ds_read_b64_tr_b16 v[254:255],v98 offset:7168
s_waitcnt lgkmcnt(0)
s_barrier
v_mov_b32 v96,68
s_mov_b32 s99,128
s_mov_b32 s38,0
poll_169:
buffer_load_dword v97,v96,s[12:15],0 offen sc1
s_waitcnt vmcnt(0)
v_cmp_le_u32 vcc,s99,v97
s_nop 0
s_cmp_eq_u64 vcc,-1
s_nop 1
s_cbranch_scc1 polld_170
s_sleep 8
s_add_u32 s38,s38,1
s_cmp_lt_u32 s38,100000
s_cbranch_scc1 poll_169
s_mov_b32 s40,14
s_branch L_fail
polld_170:
v_readfirstlane_b32 s99,v97
s_nop 0
s_and_b32 s99,s99,1
s_lshl_b32 s99,s99,13
v_and_b32 v9,31,v0
v_lshrrev_b32 v5,5,v0
v_mul_u32_u24 v7,2560,v5
v_lshl_add_u32 v7,v9,3,v7
s_lshl_b32 s43,s3,10
v_mov_b32 v80,0x3f803f80
v_mov_b32 v81,0x3f803f80
v_mov_b32 v82,0x3f803f80
v_mov_b32 v83,0x3f803f80
s_nop 1
v_mfma_f32_32x32x16_bf16 v[48:63],v[80:83],a[0:3],0
v_mfma_f32_32x32x16_bf16 v[48:63],v[80:83],a[4:7],v[48:63]
v_mfma_f32_32x32x16_bf16 v[48:63],v[80:83],a[8:11],v[48:63]
v_mfma_f32_32x32x16_bf16 v[48:63],v[80:83],a[12:15],v[48:63]
v_mfma_f32_32x32x16_bf16 v[48:63],v[80:83],a[16:19],v[48:63]
v_mfma_f32_32x32x16_bf16 v[48:63],v[80:83],a[20:23],v[48:63]
v_mfma_f32_32x32x16_bf16 v[48:63],v[80:83],a[24:27],v[48:63]
v_mfma_f32_32x32x16_bf16 v[48:63],v[80:83],a[28:31],v[48:63]
v_mfma_f32_32x32x16_bf16 v[48:63],v[80:83],a[32:35],v[48:63]
v_mfma_f32_32x32x16_bf16 v[48:63],v[80:83],a[36:39],v[48:63]
v_mfma_f32_32x32x16_bf16 v[48:63],v[80:83],a[40:43],v[48:63]
v_mfma_f32_32x32x16_bf16 v[48:63],v[80:83],a[44:47],v[48:63]
v_mfma_f32_32x32x16_bf16 v[48:63],v[80:83],a[48:51],v[48:63]
v_mfma_f32_32x32x16_bf16 v[48:63],v[80:83],a[52:55],v[48:63]
v_mfma_f32_32x32x16_bf16 v[48:63],v[80:83],a[56:59],v[48:63]
v_mfma_f32_32x32x16_bf16 v[48:63],v[80:83],a[60:63],v[48:63]
v_mfma_f32_32x32x16_bf16 v[48:63],v[80:83],a[64:67],v[48:63]
v_mfma_f32_32x32x16_bf16 v[48:63],v[80:83],a[68:71],v[48:63]
v_mfma_f32_32x32x16_bf16 v[48:63],v[80:83],a[72:75],v[48:63]
v_mfma_f32_32x32x16_bf16 v[48:63],v[80:83],a[76:79],v[48:63]
v_mfma_f32_32x32x16_bf16 v[48:63],v[80:83],a[80:83],v[48:63]
v_mfma_f32_32x32x16_bf16 v[48:63],v[80:83],a[84:87],v[48:63]
v_mfma_f32_32x32x16_bf16 v[48:63],v[80:83],a[88:91],v[48:63]
v_mfma_f32_32x32x16_bf16 v[48:63],v[80:83],a[92:95],v[48:63]
v_mfma_f32_32x32x16_bf16 v[48:63],v[80:83],a[96:99],v[48:63]
v_mfma_f32_32x32x16_bf16 v[48:63],v[80:83],a[100:103],v[48:63]
v_mfma_f32_32x32x16_bf16 v[48:63],v[80:83],a[104:107],v[48:63]
v_mfma_f32_32x32x16_bf16 v[48:63],v[80:83],a[108:111],v[48:63]
v_mfma_f32_32x32x16_bf16 v[48:63],v[80:83],a[112:115],v[48:63]
v_mfma_f32_32x32x16_bf16 v[48:63],v[80:83],a[116:119],v[48:63]
v_mfma_f32_32x32x16_bf16 v[48:63],v[80:83],a[120:123],v[48:63]
v_mfma_f32_32x32x16_bf16 v[48:63],v[80:83],a[124:127],v[48:63]
v_mfma_f32_32x32x16_bf16 v[48:63],v[80:83],a[128:131],v[48:63]
v_mfma_f32_32x32x16_bf16 v[48:63],v[80:83],a[132:135],v[48:63]
v_mfma_f32_32x32x16_bf16 v[48:63],v[80:83],a[136:139],v[48:63]
v_mfma_f32_32x32x16_bf16 v[48:63],v[80:83],a[140:143],v[48:63]
v_mfma_f32_32x32x16_bf16 v[48:63],v[80:83],a[144:147],v[48:63]
v_mfma_f32_32x32x16_bf16 v[48:63],v[80:83],a[148:151],v[48:63]
v_mfma_f32_32x32x16_bf16 v[48:63],v[80:83],a[152:155],v[48:63]
v_mfma_f32_32x32x16_bf16 v[48:63],v[80:83],a[156:159],v[48:63]
v_mfma_f32_32x32x16_bf16 v[64:79],v[80:83],a[160:163],0
v_mfma_f32_32x32x16_bf16 v[64:79],v[80:83],a[164:167],v[64:79]
v_mfma_f32_32x32x16_bf16 v[64:79],v[80:83],a[168:171],v[64:79]
v_mfma_f32_32x32x16_bf16 v[64:79],v[80:83],a[172:175],v[64:79]
v_mfma_f32_32x32x16_bf16 v[64:79],v[80:83],a[176:179],v[64:79]
v_mfma_f32_32x32x16_bf16 v[64:79],v[80:83],a[180:183],v[64:79]
v_mfma_f32_32x32x16_bf16 v[64:79],v[80:83],a[184:187],v[64:79]
v_mfma_f32_32x32x16_bf16 v[64:79],v[80:83],a[188:191],v[64:79]
v_mfma_f32_32x32x16_bf16 v[64:79],v[80:83],a[192:195],v[64:79]
v_mfma_f32_32x32x16_bf16 v[64:79],v[80:83],a[196:199],v[64:79]
v_mfma_f32_32x32x16_bf16 v[64:79],v[80:83],a[200:203],v[64:79]
v_mfma_f32_32x32x16_bf16 v[64:79],v[80:83],a[204:207],v[64:79]
v_mfma_f32_32x32x16_bf16 v[64:79],v[80:83],a[208:211],v[64:79]
v_mfma_f32_32x32x16_bf16 v[64:79],v[80:83],a[212:215],v[64:79]
v_mfma_f32_32x32x16_bf16 v[64:79],v[80:83],a[216:219],v[64:79]
v_mfma_f32_32x32x16_bf16 v[64:79],v[80:83],a[220:223],v[64:79]
v_mfma_f32_32x32x16_bf16 v[64:79],v[80:83],a[224:227],v[64:79]
v_mfma_f32_32x32x16_bf16 v[64:79],v[80:83],a[228:231],v[64:79]
v_mfma_f32_32x32x16_bf16 v[64:79],v[80:83],a[232:235],v[64:79]
v_mfma_f32_32x32x16_bf16 v[64:79],v[80:83],a[236:239],v[64:79]
v_mfma_f32_32x32x16_bf16 v[64:79],v[80:83],a[240:243],v[64:79]
v_mfma_f32_32x32x16_bf16 v[64:79],v[80:83],a[244:247],v[64:79]
v_mfma_f32_32x32x16_bf16 v[64:79],v[80:83],a[248:251],v[64:79]
v_mfma_f32_32x32x16_bf16 v[64:79],v[80:83],a[252:255],v[64:79]
v_mfma_f32_32x32x16_bf16 v[64:79],v[80:83],v[192:195],v[64:79]
v_mfma_f32_32x32x16_bf16 v[64:79],v[80:83],v[196:199],v[64:79]
v_mfma_f32_32x32x16_bf16 v[64:79],v[80:83],v[200:203],v[64:79]
v_mfma_f32_32x32x16_bf16 v[64:79],v[80:83],v[204:207],v[64:79]
v_mfma_f32_32x32x16_bf16 v[64:79],v[80:83],v[208:211],v[64:79]
v_mfma_f32_32x32x16_bf16 v[64:79],v[80:83],v[212:215],v[64:79]
v_mfma_f32_32x32x16_bf16 v[64:79],v[80:83],v[216:219],v[64:79]
v_mfma_f32_32x32x16_bf16 v[64:79],v[80:83],v[220:223],v[64:79]
v_mfma_f32_32x32x16_bf16 v[64:79],v[80:83],v[224:227],v[64:79]
v_mfma_f32_32x32x16_bf16 v[64:79],v[80:83],v[228:231],v[64:79]
v_mfma_f32_32x32x16_bf16 v[64:79],v[80:83],v[232:235],v[64:79]
v_mfma_f32_32x32x16_bf16 v[64:79],v[80:83],v[236:239],v[64:79]
v_mfma_f32_32x32x16_bf16 v[64:79],v[80:83],v[240:243],v[64:79]
v_mfma_f32_32x32x16_bf16 v[64:79],v[80:83],v[244:247],v[64:79]
v_mfma_f32_32x32x16_bf16 v[64:79],v[80:83],v[248:251],v[64:79]
v_mfma_f32_32x32x16_bf16 v[64:79],v[80:83],v[252:255],v[64:79]
v_mov_b32 v160,0xc0135761
v_mov_b32 v161,0xc0135761
v_mov_b32 v162,0xbdd2d3e8
v_mov_b32 v163,0xbdd2d3e8
s_mov_b32 s48,0x3acccccd
s_mov_b32 s49,0x3727c5ac
s_mov_b32 s35,0
s_mov_b32 s28,0
s_mov_b32 s63,64
s_nop 2
ns_init_171:
v_min_u32 v3,19,v0
v_lshlrev_b32 v3,7,v3
s_mul_i32 s42,s39,0x48000
s_add_u32 s42,s42,0x10000
s_lshl_b32 s101,s39,13
s_xor_b32 s101,s101,s99
s_xor_b32 s101,s101,8192
s_add_u32 s42,s42,s101
v_add_u32 v3,s42,v3
s_mul_i32 s37,s39,0x48000
s_add_u32 s37,s37,0x18000
s_lshl_b32 s101,s39,13
s_xor_b32 s101,s101,s99
s_xor_b32 s101,s101,8192
s_add_u32 s37,s37,s101
s_and_b32 s42,s41,63
s_lshl_b32 s42,s42,7
s_add_u32 s37,s37,s42
s_lshr_b32 s42,s41,6
s_lshl_b32 s42,s42,4
s_add_u32 s37,s37,s42
s_lshl_b32 s42,s65,2
s_add_u32 s37,s37,s42
s_mul_i32 s66,s39,0x300000
s_add_u32 s66,s66,0x3500000
s_add_u32 s66,s66,s43
s_mov_b32 s67,s66
s_mul_i32 s68,s39,0x3000000
s_add_u32 s68,s68,0x7ab0000
s_bfe_u32 s42,s41,0x10005
s_mul_i32 s42,s42,393216
s_add_u32 s68,s68,s42
s_lshr_b32 s42,s41,6
s_lshl_b32 s42,s42,17
s_add_u32 s68,s68,s42
s_and_b32 s42,s41,31
s_lshl_b32 s42,s42,12
s_add_u32 s68,s68,s42
s_cmp_eq_u32 s39,0
s_cbranch_scc1 ns_stream_172
s_waitcnt vmcnt(0) lgkmcnt(0)
s_getpc_b64 s[60:61]
pc_175:
s_add_u32 s60,s60,ns_top_173-pc_175
s_addc_u32 s61,s61,0
s_mov_b32 s59,ns_fin_174-ns_top_173-4
v_lshlrev_b32 v98,7,v0
v_add_u32 v98,0,v98
v_min_u32 v98,s59,v98
v_mov_b32 v97,s61
v_add_co_u32 v96,vcc,s60,v98
s_nop 1
v_addc_co_u32 v97,vcc,0,v97,vcc
global_load_dword v99,v[96:97],off
s_waitcnt vmcnt(0)
s_mov_b32 s30,0
s_add_u32 s31,s28,1
s_mul_i32 s42,s28,49152
s_add_u32 s32,s66,s42
s_add_u32 s33,s67,s42
s_mov_b32 s38,0
poll_176:
buffer_load_dword v4,v3,s[4:7],0 offen sc1
s_waitcnt vmcnt(0)
v_cmp_le_u32 vcc,s31,v4
s_nop 0
s_cmp_eq_u64 vcc,-1
s_nop 1
s_cbranch_scc1 polld_177
s_sleep 2
s_add_u32 s38,s38,1
s_cmp_lt_u32 s38,100000
s_cbranch_scc1 poll_176
s_mov_b32 s40,2
s_branch L_fail
polld_177:
s_add_u32 s44,s35,s43
s_add_u32 s46,s44,0
s_mov_b32 m0,s46
s_add_u32 s46,s32,0
buffer_load_dwordx4 v1,s[4:7],s46 offen sc1 lds
s_add_u32 s46,s44,4096
s_mov_b32 m0,s46
s_add_u32 s46,s32,4096
buffer_load_dwordx4 v1,s[4:7],s46 offen sc1 lds
s_add_u32 s46,s44,8192
s_mov_b32 m0,s46
s_add_u32 s46,s32,8192
buffer_load_dwordx4 v1,s[4:7],s46 offen sc1 lds
s_add_u32 s46,s44,40960
s_mov_b32 m0,s46
s_add_u32 s46,s33,40960
buffer_load_dwordx4 v1,s[4:7],s46 offen sc1 lds
s_add_u32 s46,s44,45056
s_mov_b32 m0,s46
s_add_u32 s46,s33,45056
buffer_load_dwordx4 v1,s[4:7],s46 offen sc1 lds
s_add_u32 s46,s44,12288
s_mov_b32 m0,s46
s_add_u32 s46,s32,12288
buffer_load_dwordx4 v1,s[4:7],s46 offen sc1 lds
s_add_u32 s46,s44,16384
s_mov_b32 m0,s46
s_add_u32 s46,s32,16384
buffer_load_dwordx4 v1,s[4:7],s46 offen sc1 lds
s_add_u32 s46,s44,20480
s_mov_b32 m0,s46
s_add_u32 s46,s32,20480
buffer_load_dwordx4 v1,s[4:7],s46 offen sc1 lds
s_add_u32 s46,s44,24576
s_mov_b32 m0,s46
s_add_u32 s46,s32,24576
buffer_load_dwordx4 v1,s[4:7],s46 offen sc1 lds
s_add_u32 s46,s44,28672
s_mov_b32 m0,s46
s_add_u32 s46,s32,28672
buffer_load_dwordx4 v1,s[4:7],s46 offen sc1 lds
s_add_u32 s46,s44,32768
s_mov_b32 m0,s46
s_add_u32 s46,s32,32768
buffer_load_dwordx4 v1,s[4:7],s46 offen sc1 lds
s_add_u32 s46,s44,36864
s_mov_b32 m0,s46
s_add_u32 s46,s32,36864
buffer_load_dwordx4 v1,s[4:7],s46 offen sc1 lds
s_mov_b32 s34,1
ns_top_173:
v_add_u32 v6,s35,v1
s_add_u32 s62,s28,1
s_mul_i32 s36,s28,786432
s_add_u32 s36,s36,s68
s_add_u32 s31,s62,1
s_mul_i32 s42,s62,49152
s_add_u32 s32,s66,s42
s_add_u32 s33,s67,s42
s_xor_b32 s44,s35,49152
s_add_u32 s44,s44,s43
s_cmp_eq_u32 s34,0
s_cbranch_scc1 ns_s_178
s_waitcnt vmcnt(9)
ns_s_178:
s_barrier
ds_read_b128 v[80:83],v6
ds_read_b128 v[84:87],v6 offset:1024
ds_read_b128 v[88:91],v6 offset:2048
v_cmp_le_u32 vcc,s31,v4
s_nop 0
s_cmp_eq_u64 vcc,-1
s_cselect_b64 vcc,-1,0
s_cmp_lt_u32 s62,s63
s_cselect_b64 vcc,vcc,0
s_cmp_eq_u32 s34,0
s_cselect_b64 vcc,vcc,0
s_and_b32 s29,vcc_lo,1
ds_read_b128 v[92:95],v6 offset:3072
s_waitcnt lgkmcnt(3)
v_mfma_f32_32x32x16_bf16 v[16:31],v[80:83],a[0:3],0
s_cbranch_vccz ns_d_179
s_add_u32 s46,s44,0
s_mov_b32 m0,s46
s_add_u32 s46,s32,0
buffer_load_dwordx4 v1,s[4:7],s46 offen sc1 lds
ns_d_179:
v_mfma_f32_32x32x16_bf16 v[32:47],v[80:83],a[160:163],0
ds_read_b128 v[80:83],v6 offset:4096
s_waitcnt lgkmcnt(3)
v_mfma_f32_32x32x16_bf16 v[16:31],v[84:87],a[4:7],v[16:31]
s_cbranch_vccz ns_d_180
s_add_u32 s46,s44,4096
s_mov_b32 m0,s46
s_add_u32 s46,s32,4096
buffer_load_dwordx4 v1,s[4:7],s46 offen sc1 lds
ns_d_180:
v_mfma_f32_32x32x16_bf16 v[32:47],v[84:87],a[164:167],v[32:47]
ds_read_b128 v[84:87],v6 offset:5120
s_waitcnt lgkmcnt(3)
v_mfma_f32_32x32x16_bf16 v[16:31],v[88:91],a[8:11],v[16:31]
s_cbranch_vccz ns_d_181
s_add_u32 s46,s44,8192
s_mov_b32 m0,s46
s_add_u32 s46,s32,8192
buffer_load_dwordx4 v1,s[4:7],s46 offen sc1 lds
ns_d_181:
v_mfma_f32_32x32x16_bf16 v[32:47],v[88:91],a[168:171],v[32:47]
ds_read_b128 v[88:91],v6 offset:6144
s_waitcnt lgkmcnt(3)
v_mfma_f32_32x32x16_bf16 v[16:31],v[92:95],a[12:15],v[16:31]
s_cbranch_vccz ns_d_182
s_add_u32 s46,s44,40960
s_mov_b32 m0,s46
s_add_u32 s46,s33,40960
buffer_load_dwordx4 v1,s[4:7],s46 offen sc1 lds
ns_d_182:
v_mfma_f32_32x32x16_bf16 v[32:47],v[92:95],a[172:175],v[32:47]
ds_read_b128 v[92:95],v6 offset:7168
s_waitcnt lgkmcnt(3)
v_mfma_f32_32x32x16_bf16 v[16:31],v[80:83],a[16:19],v[16:31]
s_cbranch_vccz ns_d_183
s_add_u32 s46,s44,45056
s_mov_b32 m0,s46
s_add_u32 s46,s33,45056
buffer_load_dwordx4 v1,s[4:7],s46 offen sc1 lds
ns_d_183:
v_mfma_f32_32x32x16_bf16 v[32:47],v[80:83],a[176:179],v[32:47]
ds_read_b128 v[80:83],v6 offset:8192
s_waitcnt lgkmcnt(3)
v_mfma_f32_32x32x16_bf16 v[16:31],v[84:87],a[20:23],v[16:31]
s_cbranch_vccz ns_d_184
s_add_u32 s46,s44,12288
s_mov_b32 m0,s46
s_add_u32 s46,s32,12288
buffer_load_dwordx4 v1,s[4:7],s46 offen sc1 lds
ns_d_184:
v_mfma_f32_32x32x16_bf16 v[32:47],v[84:87],a[180:183],v[32:47]
ds_read_b128 v[84:87],v6 offset:9216
s_waitcnt lgkmcnt(3)
v_mfma_f32_32x32x16_bf16 v[16:31],v[88:91],a[24:27],v[16:31]
s_cbranch_vccz ns_d_185
s_add_u32 s46,s44,16384
s_mov_b32 m0,s46
s_add_u32 s46,s32,16384
buffer_load_dwordx4 v1,s[4:7],s46 offen sc1 lds
ns_d_185:
v_mfma_f32_32x32x16_bf16 v[32:47],v[88:91],a[184:187],v[32:47]
ds_read_b128 v[88:91],v6 offset:10240
s_waitcnt lgkmcnt(3)
v_mfma_f32_32x32x16_bf16 v[16:31],v[92:95],a[28:31],v[16:31]
s_cbranch_vccz ns_d_186
s_add_u32 s46,s44,20480
s_mov_b32 m0,s46
s_add_u32 s46,s32,20480
buffer_load_dwordx4 v1,s[4:7],s46 offen sc1 lds
ns_d_186:
v_mfma_f32_32x32x16_bf16 v[32:47],v[92:95],a[188:191],v[32:47]
ds_read_b128 v[92:95],v6 offset:11264
s_waitcnt lgkmcnt(3)
v_mfma_f32_32x32x16_bf16 v[16:31],v[80:83],a[32:35],v[16:31]
s_cbranch_vccz ns_d_187
s_add_u32 s46,s44,24576
s_mov_b32 m0,s46
s_add_u32 s46,s32,24576
buffer_load_dwordx4 v1,s[4:7],s46 offen sc1 lds
ns_d_187:
v_mfma_f32_32x32x16_bf16 v[32:47],v[80:83],a[192:195],v[32:47]
s_cmp_eq_u32 s34,0
s_cbranch_scc1 ns_s_188
s_waitcnt vmcnt(3)
ns_s_188:
s_barrier
ds_read_b128 v[80:83],v6 offset:12288
s_waitcnt lgkmcnt(3)
v_mfma_f32_32x32x16_bf16 v[16:31],v[84:87],a[36:39],v[16:31]
s_cbranch_vccz ns_d_189
s_add_u32 s46,s44,28672
s_mov_b32 m0,s46
s_add_u32 s46,s32,28672
buffer_load_dwordx4 v1,s[4:7],s46 offen sc1 lds
ns_d_189:
v_add_u32 v5,s35,v7
v_mfma_f32_32x32x16_bf16 v[32:47],v[84:87],a[196:199],v[32:47]
ds_read_b64 v[96:97],v5 offset:40960
ds_read_b64 v[98:99],v5 offset:41216
ds_read_b64 v[100:101],v5 offset:41472
ds_read_b128 v[84:87],v6 offset:13312
s_waitcnt lgkmcnt(6)
v_mfma_f32_32x32x16_bf16 v[16:31],v[88:91],a[40:43],v[16:31]
s_cbranch_vccz ns_d_190
s_add_u32 s46,s44,32768
s_mov_b32 m0,s46
s_add_u32 s46,s32,32768
buffer_load_dwordx4 v1,s[4:7],s46 offen sc1 lds
ns_d_190:
ds_read_b64 v[102:103],v5 offset:41728
v_mfma_f32_32x32x16_bf16 v[32:47],v[88:91],a[200:203],v[32:47]
ds_read_b64 v[104:105],v5 offset:41984
ds_read_b64 v[106:107],v5 offset:42240
ds_read_b64 v[108:109],v5 offset:42496
ds_read_b128 v[88:91],v6 offset:14336
s_waitcnt lgkmcnt(10)
v_mfma_f32_32x32x16_bf16 v[16:31],v[92:95],a[44:47],v[16:31]
s_cbranch_vccz ns_d_191
s_add_u32 s46,s44,36864
s_mov_b32 m0,s46
s_add_u32 s46,s32,36864
buffer_load_dwordx4 v1,s[4:7],s46 offen sc1 lds
ns_d_191:
ds_read_b64 v[110:111],v5 offset:42752
v_mfma_f32_32x32x16_bf16 v[32:47],v[92:95],a[204:207],v[32:47]
ds_read_b64 v[112:113],v5 offset:43008
ds_read_b64 v[114:115],v5 offset:43264
ds_read_b128 v[92:95],v6 offset:15360
s_waitcnt lgkmcnt(13)
v_mfma_f32_32x32x16_bf16 v[16:31],v[80:83],a[48:51],v[16:31]
v_mfma_f32_32x32x16_bf16 v[32:47],v[80:83],a[208:211],v[32:47]
s_cmp_eq_u32 s30,0
s_cbranch_scc1 ns_np_192
s_waitcnt vmcnt(12)
s_cbranch_vccnz ns_w0_193
s_waitcnt vmcnt(0)
ns_w0_193:
v_mov_b32 v2,s64
s_mov_b64 exec,1
buffer_store_dword v2,off,s[24:27],s37 sc1
s_mov_b64 exec,-1
s_mov_b32 s30,0
ns_np_192:
ds_read_b128 v[80:83],v6 offset:16384
s_waitcnt lgkmcnt(10)
v_mfma_f32_32x32x16_bf16 v[16:31],v[84:87],a[52:55],v[16:31]
s_waitcnt lgkmcnt(2)
v_add_f32 v96,v96,v106
v_add_f32 v97,v97,v107
v_mfma_f32_32x32x16_bf16 v[32:47],v[84:87],a[212:215],v[32:47]
v_add_f32 v98,v98,v108
v_add_f32 v99,v99,v109
v_add_f32 v100,v100,v110
ds_read_b128 v[84:87],v6 offset:17408
v_mfma_f32_32x32x16_bf16 v[16:31],v[88:91],a[56:59],v[16:31]
v_add_f32 v101,v101,v111
v_add_f32 v102,v102,v112
v_add_f32 v103,v103,v113
v_mfma_f32_32x32x16_bf16 v[32:47],v[88:91],a[216:219],v[32:47]
v_add_f32 v104,v104,v114
v_add_f32 v105,v105,v115
v_add_f32 v96,v96,v100
ds_read_b128 v[88:91],v6 offset:18432
s_waitcnt lgkmcnt(3)
v_mfma_f32_32x32x16_bf16 v[16:31],v[92:95],a[60:63],v[16:31]
v_add_f32 v97,v97,v101
v_add_f32 v98,v98,v102
v_add_f32 v99,v99,v103
v_mfma_f32_32x32x16_bf16 v[32:47],v[92:95],a[220:223],v[32:47]
v_add_f32 v104,v104,v96
v_add_f32 v105,v105,v97
v_add_f32 v12,v104,v98
ds_read_b128 v[92:95],v6 offset:19456
s_waitcnt lgkmcnt(3)
v_mfma_f32_32x32x16_bf16 v[16:31],v[80:83],a[64:67],v[16:31]
v_add_f32 v13,v105,v99
v_mov_b32 v96,v12
v_mov_b32 v97,v13
v_mfma_f32_32x32x16_bf16 v[32:47],v[80:83],a[224:227],v[32:47]
ds_read_b128 v[80:83],v6 offset:20480
s_waitcnt lgkmcnt(3)
v_mfma_f32_32x32x16_bf16 v[16:31],v[84:87],a[68:71],v[16:31]
v_permlane32_swap_b32 v12,v96
v_permlane32_swap_b32 v13,v97
v_mfma_f32_32x32x16_bf16 v[32:47],v[84:87],a[228:231],v[32:47]
v_add_f32 v12,v12,v96
v_add_f32 v13,v13,v97
v_mul_f32 v12,s48,v12
ds_read_b128 v[84:87],v6 offset:21504
s_waitcnt lgkmcnt(3)
v_mfma_f32_32x32x16_bf16 v[16:31],v[88:91],a[72:75],v[16:31]
v_mul_f32 v13,s48,v13
v_fma_f32 v13,-v12,v12,v13
v_max_f32 v13,0,v13
v_mfma_f32_32x32x16_bf16 v[32:47],v[88:91],a[232:235],v[32:47]
v_add_f32 v96,s49,v13
v_rsq_f32 v10,v96
ds_read_b128 v[88:91],v6 offset:22528
s_waitcnt lgkmcnt(3)
v_mfma_f32_32x32x16_bf16 v[16:31],v[92:95],a[76:79],v[16:31]
v_mul_f32 v11,v12,v10
v_mov_b32 v164,v10
v_mov_b32 v165,v10
v_mfma_f32_32x32x16_bf16 v[32:47],v[92:95],a[236:239],v[32:47]
s_lshl_b32 s60,s3,8
s_add_u32 s60,s60,147456
v_lshlrev_b32 v12,2,v9
ds_read_b128 v[92:95],v6 offset:23552
s_waitcnt lgkmcnt(3)
v_mfma_f32_32x32x16_bf16 v[16:31],v[80:83],a[80:83],v[16:31]
v_add_u32 v12,s60,v12
ds_write_b32 v12,v10
ds_write_b32 v12,v11 offset:128
v_mfma_f32_32x32x16_bf16 v[32:47],v[80:83],a[240:243],v[32:47]
v_lshrrev_b32 v13,5,v0
v_lshlrev_b32 v13,4,v13
v_add_u32 v13,s60,v13
buffer_load_dword v4,v3,s[4:7],0 offen sc1
ds_read_b128 v[80:83],v6 offset:24576
s_waitcnt lgkmcnt(5)
v_mfma_f32_32x32x16_bf16 v[16:31],v[84:87],a[84:87],v[16:31]
ds_read_b128 v[96:99],v13
ds_read_b128 v[112:115],v13 offset:128
ds_read_b128 v[100:103],v13 offset:32
v_mfma_f32_32x32x16_bf16 v[32:47],v[84:87],a[244:247],v[32:47]
ds_read_b128 v[116:119],v13 offset:160
ds_read_b128 v[104:107],v13 offset:64
ds_read_b128 v[120:123],v13 offset:192
ds_read_b128 v[84:87],v6 offset:25600
s_waitcnt lgkmcnt(11)
v_mfma_f32_32x32x16_bf16 v[16:31],v[88:91],a[88:91],v[16:31]
ds_read_b128 v[108:111],v13 offset:96
ds_read_b128 v[124:127],v13 offset:224
v_mfma_f32_32x32x16_bf16 v[32:47],v[88:91],a[248:251],v[32:47]
ds_read_b128 v[88:91],v6 offset:26624
s_waitcnt lgkmcnt(13)
v_mfma_f32_32x32x16_bf16 v[16:31],v[92:95],a[92:95],v[16:31]
v_mfma_f32_32x32x16_bf16 v[32:47],v[92:95],a[252:255],v[32:47]
s_waitcnt lgkmcnt(1)
v_mul_f32_e64 v128,-v112,v48
v_mul_f32_e64 v129,-v113,v48
ds_read_b128 v[92:95],v6 offset:27648
v_mfma_f32_32x32x16_bf16 v[16:31],v[80:83],a[96:99],v[16:31]
v_mul_f32_e64 v130,-v114,v48
v_mul_f32_e64 v131,-v115,v48
v_mul_f32_e64 v132,-v116,v48
v_mfma_f32_32x32x16_bf16 v[32:47],v[80:83],v[192:195],v[32:47]
v_mul_f32_e64 v133,-v117,v48
v_mul_f32_e64 v134,-v118,v48
v_mul_f32_e64 v135,-v119,v48
s_cmp_eq_u32 s34,0
s_cbranch_scc1 ns_s_194
s_waitcnt vmcnt(0)
ns_s_194:
s_barrier
ds_read_b128 v[80:83],v6 offset:28672
v_mfma_f32_32x32x16_bf16 v[16:31],v[84:87],a[100:103],v[16:31]
v_mul_f32_e64 v136,-v120,v48
v_mul_f32_e64 v137,-v121,v48
v_mul_f32_e64 v138,-v122,v48
v_mfma_f32_32x32x16_bf16 v[32:47],v[84:87],v[196:199],v[32:47]
v_mul_f32_e64 v139,-v123,v48
v_mul_f32_e64 v140,-v124,v48
v_mul_f32_e64 v141,-v125,v48
ds_read_b128 v[84:87],v6 offset:29696
s_waitcnt lgkmcnt(3)
v_mfma_f32_32x32x16_bf16 v[16:31],v[88:91],a[104:107],v[16:31]
v_mul_f32_e64 v142,-v126,v48
v_mul_f32_e64 v143,-v127,v48
v_mfma_f32_32x32x16_bf16 v[32:47],v[88:91],v[200:203],v[32:47]
ds_read_b128 v[88:91],v6 offset:30720
s_waitcnt lgkmcnt(3)
v_mfma_f32_32x32x16_bf16 v[16:31],v[92:95],a[108:111],v[16:31]
v_mfma_f32_32x32x16_bf16 v[32:47],v[92:95],v[204:207],v[32:47]
ds_read_b128 v[92:95],v6 offset:31744
s_waitcnt lgkmcnt(3)
v_mfma_f32_32x32x16_bf16 v[16:31],v[80:83],a[112:115],v[16:31]
v_mfma_f32_32x32x16_bf16 v[32:47],v[80:83],v[208:211],v[32:47]
ds_read_b128 v[80:83],v6 offset:32768
s_waitcnt lgkmcnt(3)
v_mfma_f32_32x32x16_bf16 v[16:31],v[84:87],a[116:119],v[16:31]
v_mfma_f32_32x32x16_bf16 v[32:47],v[84:87],v[212:215],v[32:47]
ds_read_b128 v[84:87],v6 offset:33792
s_waitcnt lgkmcnt(3)
v_mfma_f32_32x32x16_bf16 v[16:31],v[88:91],a[120:123],v[16:31]
v_mfma_f32_32x32x16_bf16 v[32:47],v[88:91],v[216:219],v[32:47]
ds_read_b128 v[88:91],v6 offset:34816
s_waitcnt lgkmcnt(3)
v_mfma_f32_32x32x16_bf16 v[16:31],v[92:95],a[124:127],v[16:31]
v_mfma_f32_32x32x16_bf16 v[32:47],v[92:95],v[220:223],v[32:47]
ds_read_b128 v[92:95],v6 offset:35840
s_waitcnt lgkmcnt(3)
v_mfma_f32_32x32x16_bf16 v[16:31],v[80:83],a[128:131],v[16:31]
v_mfma_f32_32x32x16_bf16 v[32:47],v[80:83],v[224:227],v[32:47]
ds_read_b128 v[80:83],v6 offset:36864
s_waitcnt lgkmcnt(3)
v_mfma_f32_32x32x16_bf16 v[16:31],v[84:87],a[132:135],v[16:31]
v_mfma_f32_32x32x16_bf16 v[32:47],v[84:87],v[228:231],v[32:47]
s_mov_b64 vcc,0
s_cmp_lg_u32 s29,0
s_cbranch_scc1 ns_sk_195
s_waitcnt vmcnt(0)
v_cmp_le_u32 vcc,s31,v4
s_nop 0
s_cmp_eq_u64 vcc,-1
s_cselect_b64 vcc,-1,0
s_cmp_lt_u32 s62,s63
s_cselect_b64 vcc,vcc,0
s_and_b32 s29,vcc_lo,1
ns_sk_195:
ds_read_b128 v[84:87],v6 offset:37888
s_waitcnt lgkmcnt(3)
v_mfma_f32_32x32x16_bf16 v[16:31],v[88:91],a[136:139],v[16:31]
s_cbranch_vccz ns_d_196
s_add_u32 s46,s44,0
s_mov_b32 m0,s46
s_add_u32 s46,s32,0
buffer_load_dwordx4 v1,s[4:7],s46 offen sc1 lds
ns_d_196:
v_mfma_f32_32x32x16_bf16 v[32:47],v[88:91],v[232:235],v[32:47]
s_cbranch_vccz ns_d_197
s_add_u32 s46,s44,4096
s_mov_b32 m0,s46
s_add_u32 s46,s32,4096
buffer_load_dwordx4 v1,s[4:7],s46 offen sc1 lds
ns_d_197:
ds_read_b128 v[88:91],v6 offset:38912
s_waitcnt lgkmcnt(3)
v_mfma_f32_32x32x16_bf16 v[16:31],v[92:95],a[140:143],v[16:31]
s_cbranch_vccz ns_d_198
s_add_u32 s46,s44,8192
s_mov_b32 m0,s46
s_add_u32 s46,s32,8192
buffer_load_dwordx4 v1,s[4:7],s46 offen sc1 lds
ns_d_198:
v_mfma_f32_32x32x16_bf16 v[32:47],v[92:95],v[236:239],v[32:47]
s_cbranch_vccz ns_d_199
s_add_u32 s46,s44,40960
s_mov_b32 m0,s46
s_add_u32 s46,s33,40960
buffer_load_dwordx4 v1,s[4:7],s46 offen sc1 lds
ns_d_199:
ds_read_b128 v[92:95],v6 offset:39936
s_waitcnt lgkmcnt(3)
v_mfma_f32_32x32x16_bf16 v[16:31],v[80:83],a[144:147],v[16:31]
s_cbranch_vccz ns_d_200
s_add_u32 s46,s44,45056
s_mov_b32 m0,s46
s_add_u32 s46,s33,45056
buffer_load_dwordx4 v1,s[4:7],s46 offen sc1 lds
ns_d_200:
v_mfma_f32_32x32x16_bf16 v[32:47],v[80:83],v[240:243],v[32:47]
s_cbranch_vccz ns_d_201
s_add_u32 s46,s44,12288
s_mov_b32 m0,s46
s_add_u32 s46,s32,12288
buffer_load_dwordx4 v1,s[4:7],s46 offen sc1 lds
ns_d_201:
s_waitcnt lgkmcnt(2)
v_mfma_f32_32x32x16_bf16 v[16:31],v[84:87],a[148:151],v[16:31]
s_cbranch_vccz ns_d_202
s_add_u32 s46,s44,16384
s_mov_b32 m0,s46
s_add_u32 s46,s32,16384
buffer_load_dwordx4 v1,s[4:7],s46 offen sc1 lds
ns_d_202:
v_mfma_f32_32x32x16_bf16 v[32:47],v[84:87],v[244:247],v[32:47]
s_cbranch_vccz ns_d_203
s_add_u32 s46,s44,20480
s_mov_b32 m0,s46
s_add_u32 s46,s32,20480
buffer_load_dwordx4 v1,s[4:7],s46 offen sc1 lds
ns_d_203:
s_waitcnt lgkmcnt(1)
v_mfma_f32_32x32x16_bf16 v[16:31],v[88:91],a[152:155],v[16:31]
s_cbranch_vccz ns_d_204
s_add_u32 s46,s44,24576
s_mov_b32 m0,s46
s_add_u32 s46,s32,24576
buffer_load_dwordx4 v1,s[4:7],s46 offen sc1 lds
ns_d_204:
v_mfma_f32_32x32x16_bf16 v[32:47],v[88:91],v[248:251],v[32:47]
s_cbranch_vccz ns_d_205
s_add_u32 s46,s44,28672
s_mov_b32 m0,s46
s_add_u32 s46,s32,28672
buffer_load_dwordx4 v1,s[4:7],s46 offen sc1 lds
ns_d_205:
s_waitcnt lgkmcnt(0)
v_mfma_f32_32x32x16_bf16 v[16:31],v[92:95],a[156:159],v[16:31]
s_cbranch_vccz ns_d_206
s_add_u32 s46,s44,32768
s_mov_b32 m0,s46
s_add_u32 s46,s32,32768
buffer_load_dwordx4 v1,s[4:7],s46 offen sc1 lds
ns_d_206:
v_mfma_f32_32x32x16_bf16 v[32:47],v[92:95],v[252:255],v[32:47]
s_cbranch_vccz ns_d_207
s_add_u32 s46,s44,36864
s_mov_b32 m0,s46
s_add_u32 s46,s32,36864
buffer_load_dwordx4 v1,s[4:7],s46 offen sc1 lds
ns_d_207:
buffer_load_dword v4,v3,s[4:7],0 offen sc1
v_pk_fma_f32 v[16:17],v[16:17],v[96:97],v[128:129]
v_pk_fma_f32 v[18:19],v[18:19],v[98:99],v[130:131]
v_pk_fma_f32 v[20:21],v[20:21],v[100:101],v[132:133]
v_pk_fma_f32 v[22:23],v[22:23],v[102:103],v[134:135]
v_cvt_pk_bf16_f32 v144,v16,v17
v_cvt_pk_bf16_f32 v145,v18,v19
v_cvt_pk_bf16_f32 v146,v20,v21
v_cvt_pk_bf16_f32 v147,v22,v23
buffer_store_dwordx4 v[144:147],v1,s[24:27],s36 offen sc1
v_pk_fma_f32 v[24:25],v[24:25],v[104:105],v[136:137]
v_pk_fma_f32 v[26:27],v[26:27],v[106:107],v[138:139]
v_pk_fma_f32 v[28:29],v[28:29],v[108:109],v[140:141]
v_pk_fma_f32 v[30:31],v[30:31],v[110:111],v[142:143]
v_cvt_pk_bf16_f32 v148,v24,v25
v_cvt_pk_bf16_f32 v149,v26,v27
v_cvt_pk_bf16_f32 v150,v28,v29
v_cvt_pk_bf16_f32 v151,v30,v31
buffer_store_dwordx4 v[148:151],v1,s[24:27],s36 offen offset:1024 sc1
v_mul_f32_e64 v128,-v112,v64
v_mul_f32_e64 v129,-v113,v64
v_mul_f32_e64 v130,-v114,v64
v_mul_f32_e64 v131,-v115,v64
v_mul_f32_e64 v132,-v116,v64
v_mul_f32_e64 v133,-v117,v64
v_mul_f32_e64 v134,-v118,v64
v_mul_f32_e64 v135,-v119,v64
v_mul_f32_e64 v136,-v120,v64
v_mul_f32_e64 v137,-v121,v64
v_mul_f32_e64 v138,-v122,v64
v_mul_f32_e64 v139,-v123,v64
v_mul_f32_e64 v140,-v124,v64
v_mul_f32_e64 v141,-v125,v64
v_mul_f32_e64 v142,-v126,v64
v_mul_f32_e64 v143,-v127,v64
v_pk_fma_f32 v[32:33],v[32:33],v[96:97],v[128:129]
v_pk_fma_f32 v[34:35],v[34:35],v[98:99],v[130:131]
v_pk_fma_f32 v[36:37],v[36:37],v[100:101],v[132:133]
v_pk_fma_f32 v[38:39],v[38:39],v[102:103],v[134:135]
v_cvt_pk_bf16_f32 v152,v32,v33
v_cvt_pk_bf16_f32 v153,v34,v35
v_cvt_pk_bf16_f32 v154,v36,v37
v_cvt_pk_bf16_f32 v155,v38,v39
buffer_store_dwordx4 v[152:155],v1,s[24:27],s36 offen offset:2048 sc1
v_pk_fma_f32 v[40:41],v[40:41],v[104:105],v[136:137]
v_pk_fma_f32 v[42:43],v[42:43],v[106:107],v[138:139]
v_pk_fma_f32 v[44:45],v[44:45],v[108:109],v[140:141]
v_pk_fma_f32 v[46:47],v[46:47],v[110:111],v[142:143]
v_cvt_pk_bf16_f32 v156,v40,v41
v_cvt_pk_bf16_f32 v157,v42,v43
v_cvt_pk_bf16_f32 v158,v44,v45
v_cvt_pk_bf16_f32 v159,v46,v47
buffer_store_dwordx4 v[156:159],v1,s[24:27],s36 offen offset:3072 sc1
s_waitcnt vmcnt(4)
v_cmp_le_u32 vcc,s31,v4
s_nop 0
s_cmp_eq_u64 vcc,-1
s_cselect_b64 vcc,-1,0
s_cmp_lt_u32 s62,s63
s_cselect_b64 vcc,vcc,0
s_add_u32 s64,s28,1
s_mov_b32 s28,s62
s_mov_b32 s69,s36
s_xor_b32 s35,s35,49152
s_mov_b32 s30,1
s_mov_b32 s34,0
s_cmp_lg_u32 s29,0
s_cbranch_scc1 ns_top_173
s_mov_b32 s34,1
s_cbranch_vccz ns_blk_208
s_add_u32 s46,s44,0
s_mov_b32 m0,s46
s_add_u32 s46,s32,0
buffer_load_dwordx4 v1,s[4:7],s46 offen sc1 lds
s_add_u32 s46,s44,4096
s_mov_b32 m0,s46
s_add_u32 s46,s32,4096
buffer_load_dwordx4 v1,s[4:7],s46 offen sc1 lds
s_add_u32 s46,s44,8192
s_mov_b32 m0,s46
s_add_u32 s46,s32,8192
buffer_load_dwordx4 v1,s[4:7],s46 offen sc1 lds
s_add_u32 s46,s44,40960
s_mov_b32 m0,s46
s_add_u32 s46,s33,40960
buffer_load_dwordx4 v1,s[4:7],s46 offen sc1 lds
s_waitcnt vmcnt(4)
v_mov_b32 v2,s64
s_mov_b64 exec,1
buffer_store_dword v2,off,s[24:27],s37 sc1
s_mov_b64 exec,-1
s_mov_b32 s30,0
s_add_u32 s46,s44,45056
s_mov_b32 m0,s46
s_add_u32 s46,s33,45056
buffer_load_dwordx4 v1,s[4:7],s46 offen sc1 lds
s_add_u32 s46,s44,12288
s_mov_b32 m0,s46
s_add_u32 s46,s32,12288
buffer_load_dwordx4 v1,s[4:7],s46 offen sc1 lds
s_add_u32 s46,s44,16384
s_mov_b32 m0,s46
s_add_u32 s46,s32,16384
buffer_load_dwordx4 v1,s[4:7],s46 offen sc1 lds
s_add_u32 s46,s44,20480
s_mov_b32 m0,s46
s_add_u32 s46,s32,20480
buffer_load_dwordx4 v1,s[4:7],s46 offen sc1 lds
s_add_u32 s46,s44,24576
s_mov_b32 m0,s46
s_add_u32 s46,s32,24576
buffer_load_dwordx4 v1,s[4:7],s46 offen sc1 lds
s_add_u32 s46,s44,28672
s_mov_b32 m0,s46
s_add_u32 s46,s32,28672
buffer_load_dwordx4 v1,s[4:7],s46 offen sc1 lds
s_add_u32 s46,s44,32768
s_mov_b32 m0,s46
s_add_u32 s46,s32,32768
buffer_load_dwordx4 v1,s[4:7],s46 offen sc1 lds
s_add_u32 s46,s44,36864
s_mov_b32 m0,s46
s_add_u32 s46,s32,36864
buffer_load_dwordx4 v1,s[4:7],s46 offen sc1 lds
s_branch ns_top_173
ns_blk_208:
s_mov_b32 s34,1
buffer_load_dword v4,v3,s[4:7],0 offen sc1
s_waitcnt vmcnt(1)
v_mov_b32 v2,s64
s_mov_b64 exec,1
buffer_store_dword v2,off,s[24:27],s37 sc1
s_mov_b64 exec,-1
s_mov_b32 s30,0
s_cmp_ge_u32 s28,s63
s_cbranch_scc1 ns_fin_174
s_waitcnt vmcnt(1)
v_cmp_le_u32 vcc,s31,v4
s_nop 0
s_cmp_eq_u64 vcc,-1
s_nop 1
s_cbranch_scc1 ns_rdy_209
s_mov_b32 s38,0
poll_210:
buffer_load_dword v4,v3,s[4:7],0 offen sc1
s_waitcnt vmcnt(0)
v_cmp_le_u32 vcc,s31,v4
s_nop 0
s_cmp_eq_u64 vcc,-1
s_nop 1
s_cbranch_scc1 polld_211
s_sleep 2
s_add_u32 s38,s38,1
s_cmp_lt_u32 s38,100000
s_cbranch_scc1 poll_210
s_mov_b32 s40,2
s_branch L_fail
polld_211:
ns_rdy_209:
s_add_u32 s46,s44,0
s_mov_b32 m0,s46
s_add_u32 s46,s32,0
buffer_load_dwordx4 v1,s[4:7],s46 offen sc1 lds
s_add_u32 s46,s44,4096
s_mov_b32 m0,s46
s_add_u32 s46,s32,4096
buffer_load_dwordx4 v1,s[4:7],s46 offen sc1 lds
s_add_u32 s46,s44,8192
s_mov_b32 m0,s46
s_add_u32 s46,s32,8192
buffer_load_dwordx4 v1,s[4:7],s46 offen sc1 lds
s_add_u32 s46,s44,40960
s_mov_b32 m0,s46
s_add_u32 s46,s33,40960
buffer_load_dwordx4 v1,s[4:7],s46 offen sc1 lds
s_add_u32 s46,s44,45056
s_mov_b32 m0,s46
s_add_u32 s46,s33,45056
buffer_load_dwordx4 v1,s[4:7],s46 offen sc1 lds
s_add_u32 s46,s44,12288
s_mov_b32 m0,s46
s_add_u32 s46,s32,12288
buffer_load_dwordx4 v1,s[4:7],s46 offen sc1 lds
s_add_u32 s46,s44,16384
s_mov_b32 m0,s46
s_add_u32 s46,s32,16384
buffer_load_dwordx4 v1,s[4:7],s46 offen sc1 lds
s_add_u32 s46,s44,20480
s_mov_b32 m0,s46
s_add_u32 s46,s32,20480
buffer_load_dwordx4 v1,s[4:7],s46 offen sc1 lds
s_add_u32 s46,s44,24576
s_mov_b32 m0,s46
s_add_u32 s46,s32,24576
buffer_load_dwordx4 v1,s[4:7],s46 offen sc1 lds
s_add_u32 s46,s44,28672
s_mov_b32 m0,s46
s_add_u32 s46,s32,28672
buffer_load_dwordx4 v1,s[4:7],s46 offen sc1 lds
s_add_u32 s46,s44,32768
s_mov_b32 m0,s46
s_add_u32 s46,s32,32768
buffer_load_dwordx4 v1,s[4:7],s46 offen sc1 lds
s_add_u32 s46,s44,36864
s_mov_b32 m0,s46
s_add_u32 s46,s32,36864
buffer_load_dwordx4 v1,s[4:7],s46 offen sc1 lds
s_branch ns_top_173
ns_fin_174:
s_branch L_end
ns_stream_172:
s_mov_b32 s28,s65
s_cmp_eq_u32 s65,0
s_cselect_b32 s63,43,64
s_cmp_eq_u32 s65,2
s_cselect_b32 s63,33,s63
s_mul_i32 s42,s28,49152
s_add_u32 s32,s66,s42
s_add_u32 s33,s67,s42
s_mov_b32 s44,s43
s_mov_b32 s35,0
s_add_u32 s46,s44,0
s_mov_b32 m0,s46
s_add_u32 s46,s32,0
buffer_load_dwordx4 v1,s[4:7],s46 offen sc1 lds
s_add_u32 s46,s44,4096
s_mov_b32 m0,s46
s_add_u32 s46,s32,4096
buffer_load_dwordx4 v1,s[4:7],s46 offen sc1 lds
s_add_u32 s46,s44,8192
s_mov_b32 m0,s46
s_add_u32 s46,s32,8192
buffer_load_dwordx4 v1,s[4:7],s46 offen sc1 lds
s_add_u32 s46,s44,40960
s_mov_b32 m0,s46
s_add_u32 s46,s33,40960
buffer_load_dwordx4 v1,s[4:7],s46 offen sc1 lds
s_add_u32 s46,s44,45056
s_mov_b32 m0,s46
s_add_u32 s46,s33,45056
buffer_load_dwordx4 v1,s[4:7],s46 offen sc1 lds
s_add_u32 s46,s44,12288
s_mov_b32 m0,s46
s_add_u32 s46,s32,12288
buffer_load_dwordx4 v1,s[4:7],s46 offen sc1 lds
s_add_u32 s46,s44,16384
s_mov_b32 m0,s46
s_add_u32 s46,s32,16384
buffer_load_dwordx4 v1,s[4:7],s46 offen sc1 lds
s_add_u32 s46,s44,20480
s_mov_b32 m0,s46
s_add_u32 s46,s32,20480
buffer_load_dwordx4 v1,s[4:7],s46 offen sc1 lds
s_add_u32 s46,s44,24576
s_mov_b32 m0,s46
s_add_u32 s46,s32,24576
buffer_load_dwordx4 v1,s[4:7],s46 offen sc1 lds
s_add_u32 s46,s44,28672
s_mov_b32 m0,s46
s_add_u32 s46,s32,28672
buffer_load_dwordx4 v1,s[4:7],s46 offen sc1 lds
s_add_u32 s46,s44,32768
s_mov_b32 m0,s46
s_add_u32 s46,s32,32768
buffer_load_dwordx4 v1,s[4:7],s46 offen sc1 lds
s_add_u32 s46,s44,36864
s_mov_b32 m0,s46
s_add_u32 s46,s32,36864
buffer_load_dwordx4 v1,s[4:7],s46 offen sc1 lds
s_waitcnt vmcnt(0)
s_barrier
v_mov_b32 v188,v1
s_mov_b32 s61,s26
s_mov_b32 s26,0
ds_read_b128 v[80:83],v188
ds_read_b128 v[84:87],v188 offset:1024
ds_read_b128 v[88:91],v188 offset:2048
ns_sl_213:
v_mov_b32 v6,v188
s_cmp_lt_u32 s28,42
s_cselect_b32 s62,2,1
s_cmp_lt_u32 s28,33
s_cselect_b32 s62,3,s62
s_add_u32 s62,s62,s28
s_min_u32 s60,s62,63
s_mul_i32 s42,s60,49152
s_add_u32 s32,s66,s42
s_add_u32 s33,s67,s42
s_add_u32 s34,s35,49152
s_cmp_eq_u32 s34,147456
s_cselect_b32 s34,0,s34
s_add_u32 s44,s34,s43
v_add_u32 v188,s34,v1
ds_read_b128 v[92:95],v6 offset:3072
s_waitcnt lgkmcnt(3)
v_mfma_f32_32x32x16_bf16 v[16:31],v[80:83],a[0:3],0
s_add_u32 s46,s44,0
s_mov_b32 m0,s46
s_add_u32 s46,s32,0
buffer_load_dwordx4 v1,s[4:7],s46 offen sc1 lds
v_mfma_f32_32x32x16_bf16 v[32:47],v[80:83],a[160:163],0
ds_read_b128 v[80:83],v6 offset:4096
s_waitcnt lgkmcnt(3)
v_mfma_f32_32x32x16_bf16 v[16:31],v[84:87],a[4:7],v[16:31]
v_mfma_f32_32x32x16_bf16 v[32:47],v[84:87],a[164:167],v[32:47]
ds_read_b128 v[84:87],v6 offset:5120
s_waitcnt lgkmcnt(3)
v_mfma_f32_32x32x16_bf16 v[16:31],v[88:91],a[8:11],v[16:31]
s_add_u32 s46,s44,4096
s_mov_b32 m0,s46
s_add_u32 s46,s32,4096
buffer_load_dwordx4 v1,s[4:7],s46 offen sc1 lds
v_mfma_f32_32x32x16_bf16 v[32:47],v[88:91],a[168:171],v[32:47]
v_mul_f32_e64 v168,-v112,v48
v_fma_f32 v128,v128,v96,v168
v_mul_f32_e64 v169,-v113,v48
ds_read_b128 v[88:91],v6 offset:6144
s_waitcnt lgkmcnt(3)
v_mfma_f32_32x32x16_bf16 v[16:31],v[92:95],a[12:15],v[16:31]
v_fma_f32 v129,v129,v97,v169
v_mul_f32_e64 v170,-v114,v48
v_fma_f32 v130,v130,v98,v170
v_mfma_f32_32x32x16_bf16 v[32:47],v[92:95],a[172:175],v[32:47]
v_mul_f32_e64 v171,-v115,v48
v_fma_f32 v131,v131,v99,v171
v_mul_f32_e64 v168,-v116,v48
ds_read_b128 v[92:95],v6 offset:7168
s_waitcnt lgkmcnt(3)
v_mfma_f32_32x32x16_bf16 v[16:31],v[80:83],a[16:19],v[16:31]
s_add_u32 s46,s44,8192
s_mov_b32 m0,s46
s_add_u32 s46,s32,8192
buffer_load_dwordx4 v1,s[4:7],s46 offen sc1 lds
v_mfma_f32_32x32x16_bf16 v[32:47],v[80:83],a[176:179],v[32:47]
v_fma_f32 v132,v132,v100,v168
v_mul_f32_e64 v169,-v117,v48
v_fma_f32 v133,v133,v101,v169
ds_read_b128 v[80:83],v6 offset:8192
s_waitcnt lgkmcnt(3)
v_mfma_f32_32x32x16_bf16 v[16:31],v[84:87],a[20:23],v[16:31]
v_mul_f32_e64 v170,-v118,v48
v_fma_f32 v134,v134,v102,v170
v_mul_f32_e64 v171,-v119,v48
v_mfma_f32_32x32x16_bf16 v[32:47],v[84:87],a[180:183],v[32:47]
v_fma_f32 v135,v135,v103,v171
v_cvt_pk_bf16_f32 v144,v128,v129
v_cvt_pk_bf16_f32 v145,v130,v131
ds_read_b128 v[84:87],v6 offset:9216
s_waitcnt lgkmcnt(3)
v_mfma_f32_32x32x16_bf16 v[16:31],v[88:91],a[24:27],v[16:31]
s_add_u32 s46,s44,40960
s_mov_b32 m0,s46
s_add_u32 s46,s33,40960
buffer_load_dwordx4 v1,s[4:7],s46 offen sc1 lds
v_mfma_f32_32x32x16_bf16 v[32:47],v[88:91],a[184:187],v[32:47]
v_cvt_pk_bf16_f32 v146,v132,v133
v_cvt_pk_bf16_f32 v147,v134,v135
buffer_store_dwordx4 v[144:147],v1,s[24:27],s36 offen sc1
ds_read_b128 v[88:91],v6 offset:10240
s_waitcnt lgkmcnt(3)
v_mfma_f32_32x32x16_bf16 v[16:31],v[92:95],a[28:31],v[16:31]
v_mul_f32_e64 v168,-v120,v48
v_fma_f32 v136,v136,v104,v168
v_mul_f32_e64 v169,-v121,v48
v_mfma_f32_32x32x16_bf16 v[32:47],v[92:95],a[188:191],v[32:47]
v_fma_f32 v137,v137,v105,v169
v_mul_f32_e64 v170,-v122,v48
v_fma_f32 v138,v138,v106,v170
ds_read_b128 v[92:95],v6 offset:11264
s_waitcnt lgkmcnt(3)
v_mfma_f32_32x32x16_bf16 v[16:31],v[80:83],a[32:35],v[16:31]
s_add_u32 s46,s44,45056
s_mov_b32 m0,s46
s_add_u32 s46,s33,45056
buffer_load_dwordx4 v1,s[4:7],s46 offen sc1 lds
v_mfma_f32_32x32x16_bf16 v[32:47],v[80:83],a[192:195],v[32:47]
v_mul_f32_e64 v171,-v123,v48
v_fma_f32 v139,v139,v107,v171
v_mul_f32_e64 v168,-v124,v48
ds_read_b128 v[80:83],v6 offset:12288
s_waitcnt lgkmcnt(3)
v_mfma_f32_32x32x16_bf16 v[16:31],v[84:87],a[36:39],v[16:31]
v_fma_f32 v140,v140,v108,v168
v_mul_f32_e64 v169,-v125,v48
v_fma_f32 v141,v141,v109,v169
v_mfma_f32_32x32x16_bf16 v[32:47],v[84:87],a[196:199],v[32:47]
v_mul_f32_e64 v170,-v126,v48
v_fma_f32 v142,v142,v110,v170
v_mul_f32_e64 v171,-v127,v48
ds_read_b128 v[84:87],v6 offset:13312
s_waitcnt lgkmcnt(3)
v_mfma_f32_32x32x16_bf16 v[16:31],v[88:91],a[40:43],v[16:31]
s_add_u32 s46,s44,12288
s_mov_b32 m0,s46
s_add_u32 s46,s32,12288
buffer_load_dwordx4 v1,s[4:7],s46 offen sc1 lds
v_mfma_f32_32x32x16_bf16 v[32:47],v[88:91],a[200:203],v[32:47]
v_fma_f32 v143,v143,v111,v171
v_cvt_pk_bf16_f32 v148,v136,v137
v_cvt_pk_bf16_f32 v149,v138,v139
ds_read_b128 v[88:91],v6 offset:14336
s_waitcnt lgkmcnt(3)
v_mfma_f32_32x32x16_bf16 v[16:31],v[92:95],a[44:47],v[16:31]
v_cvt_pk_bf16_f32 v150,v140,v141
v_cvt_pk_bf16_f32 v151,v142,v143
buffer_store_dwordx4 v[148:151],v1,s[24:27],s36 offen offset:1024 sc1
v_mfma_f32_32x32x16_bf16 v[32:47],v[92:95],a[204:207],v[32:47]
v_mul_f32_e64 v168,-v112,v64
v_fma_f32 v172,v172,v96,v168
v_mul_f32_e64 v169,-v113,v64
ds_read_b128 v[92:95],v6 offset:15360
s_waitcnt lgkmcnt(3)
v_mfma_f32_32x32x16_bf16 v[16:31],v[80:83],a[48:51],v[16:31]
s_add_u32 s46,s44,16384
s_mov_b32 m0,s46
s_add_u32 s46,s32,16384
buffer_load_dwordx4 v1,s[4:7],s46 offen sc1 lds
v_mfma_f32_32x32x16_bf16 v[32:47],v[80:83],a[208:211],v[32:47]
v_fma_f32 v173,v173,v97,v169
v_mul_f32_e64 v170,-v114,v64
v_fma_f32 v174,v174,v98,v170
ds_read_b128 v[80:83],v6 offset:16384
s_waitcnt lgkmcnt(3)
v_mfma_f32_32x32x16_bf16 v[16:31],v[84:87],a[52:55],v[16:31]
v_mul_f32_e64 v171,-v115,v64
v_fma_f32 v175,v175,v99,v171
v_mul_f32_e64 v168,-v116,v64
v_mfma_f32_32x32x16_bf16 v[32:47],v[84:87],a[212:215],v[32:47]
v_fma_f32 v176,v176,v100,v168
v_mul_f32_e64 v169,-v117,v64
v_fma_f32 v177,v177,v101,v169
ds_read_b128 v[84:87],v6 offset:17408
s_waitcnt lgkmcnt(3)
v_mfma_f32_32x32x16_bf16 v[16:31],v[88:91],a[56:59],v[16:31]
s_add_u32 s46,s44,20480
s_mov_b32 m0,s46
s_add_u32 s46,s32,20480
buffer_load_dwordx4 v1,s[4:7],s46 offen sc1 lds
v_mfma_f32_32x32x16_bf16 v[32:47],v[88:91],a[216:219],v[32:47]
v_mul_f32_e64 v170,-v118,v64
v_fma_f32 v178,v178,v102,v170
v_mul_f32_e64 v171,-v119,v64
ds_read_b128 v[88:91],v6 offset:18432
s_waitcnt lgkmcnt(3)
v_mfma_f32_32x32x16_bf16 v[16:31],v[92:95],a[60:63],v[16:31]
v_fma_f32 v179,v179,v103,v171
v_cvt_pk_bf16_f32 v152,v172,v173
v_cvt_pk_bf16_f32 v153,v174,v175
v_mfma_f32_32x32x16_bf16 v[32:47],v[92:95],a[220:223],v[32:47]
v_cvt_pk_bf16_f32 v154,v176,v177
v_cvt_pk_bf16_f32 v155,v178,v179
buffer_store_dwordx4 v[152:155],v1,s[24:27],s36 offen offset:2048 sc1
ds_read_b128 v[92:95],v6 offset:19456
s_waitcnt lgkmcnt(3)
v_mfma_f32_32x32x16_bf16 v[16:31],v[80:83],a[64:67],v[16:31]
s_add_u32 s46,s44,24576
s_mov_b32 m0,s46
s_add_u32 s46,s32,24576
buffer_load_dwordx4 v1,s[4:7],s46 offen sc1 lds
v_mfma_f32_32x32x16_bf16 v[32:47],v[80:83],a[224:227],v[32:47]
v_mul_f32_e64 v168,-v120,v64
v_fma_f32 v180,v180,v104,v168
v_mul_f32_e64 v169,-v121,v64
ds_read_b128 v[80:83],v6 offset:20480
s_waitcnt lgkmcnt(3)
v_mfma_f32_32x32x16_bf16 v[16:31],v[84:87],a[68:71],v[16:31]
v_fma_f32 v181,v181,v105,v169
v_mul_f32_e64 v170,-v122,v64
v_fma_f32 v182,v182,v106,v170
v_mfma_f32_32x32x16_bf16 v[32:47],v[84:87],a[228:231],v[32:47]
v_mul_f32_e64 v171,-v123,v64
v_fma_f32 v183,v183,v107,v171
v_mul_f32_e64 v168,-v124,v64
ds_read_b128 v[84:87],v6 offset:21504
s_waitcnt lgkmcnt(3)
v_mfma_f32_32x32x16_bf16 v[16:31],v[88:91],a[72:75],v[16:31]
s_add_u32 s46,s44,28672
s_mov_b32 m0,s46
s_add_u32 s46,s32,28672
buffer_load_dwordx4 v1,s[4:7],s46 offen sc1 lds
v_mfma_f32_32x32x16_bf16 v[32:47],v[88:91],a[232:235],v[32:47]
v_fma_f32 v184,v184,v108,v168
v_mul_f32_e64 v169,-v125,v64
v_fma_f32 v185,v185,v109,v169
ds_read_b128 v[88:91],v6 offset:22528
s_waitcnt lgkmcnt(3)
v_mfma_f32_32x32x16_bf16 v[16:31],v[92:95],a[76:79],v[16:31]
v_mul_f32_e64 v170,-v126,v64
v_fma_f32 v186,v186,v110,v170
v_mul_f32_e64 v171,-v127,v64
v_mfma_f32_32x32x16_bf16 v[32:47],v[92:95],a[236:239],v[32:47]
v_fma_f32 v187,v187,v111,v171
v_cvt_pk_bf16_f32 v156,v180,v181
v_cvt_pk_bf16_f32 v157,v182,v183
ds_read_b128 v[92:95],v6 offset:23552
s_waitcnt lgkmcnt(3)
v_mfma_f32_32x32x16_bf16 v[16:31],v[80:83],a[80:83],v[16:31]
s_add_u32 s46,s44,32768
s_mov_b32 m0,s46
s_add_u32 s46,s32,32768
buffer_load_dwordx4 v1,s[4:7],s46 offen sc1 lds
v_mfma_f32_32x32x16_bf16 v[32:47],v[80:83],a[240:243],v[32:47]
v_cvt_pk_bf16_f32 v158,v184,v185
v_cvt_pk_bf16_f32 v159,v186,v187
buffer_store_dwordx4 v[156:159],v1,s[24:27],s36 offen offset:3072 sc1
ds_read_b128 v[80:83],v6 offset:24576
s_waitcnt lgkmcnt(3)
v_mfma_f32_32x32x16_bf16 v[16:31],v[84:87],a[84:87],v[16:31]
v_add_u32 v5,s35,v7
ds_read_b64 v[96:97],v5 offset:40960
ds_read_b64 v[98:99],v5 offset:41216
v_mfma_f32_32x32x16_bf16 v[32:47],v[84:87],a[244:247],v[32:47]
ds_read_b64 v[100:101],v5 offset:41472
ds_read_b64 v[102:103],v5 offset:41728
ds_read_b64 v[104:105],v5 offset:41984
ds_read_b128 v[84:87],v6 offset:25600
s_waitcnt lgkmcnt(8)
v_mfma_f32_32x32x16_bf16 v[16:31],v[88:91],a[88:91],v[16:31]
s_add_u32 s46,s44,36864
s_mov_b32 m0,s46
s_add_u32 s46,s32,36864
buffer_load_dwordx4 v1,s[4:7],s46 offen sc1 lds
v_mfma_f32_32x32x16_bf16 v[32:47],v[88:91],a[248:251],v[32:47]
ds_read_b64 v[106:107],v5 offset:42240
ds_read_b64 v[108:109],v5 offset:42496
ds_read_b64 v[110:111],v5 offset:42752
ds_read_b128 v[88:91],v6 offset:26624
s_waitcnt lgkmcnt(11)
v_mfma_f32_32x32x16_bf16 v[16:31],v[92:95],a[92:95],v[16:31]
ds_read_b64 v[112:113],v5 offset:43008
ds_read_b64 v[114:115],v5 offset:43264
v_mfma_f32_32x32x16_bf16 v[32:47],v[92:95],a[252:255],v[32:47]
ds_read_b128 v[92:95],v6 offset:27648
s_waitcnt lgkmcnt(13)
v_mfma_f32_32x32x16_bf16 v[16:31],v[80:83],a[96:99],v[16:31]
v_mfma_f32_32x32x16_bf16 v[32:47],v[80:83],v[192:195],v[32:47]
s_waitcnt lgkmcnt(1)
v_add_f32 v96,v96,v106
v_add_f32 v97,v97,v107
ds_read_b128 v[80:83],v6 offset:28672
v_mfma_f32_32x32x16_bf16 v[16:31],v[84:87],a[100:103],v[16:31]
v_add_f32 v98,v98,v108
v_add_f32 v99,v99,v109
v_add_f32 v100,v100,v110
v_mfma_f32_32x32x16_bf16 v[32:47],v[84:87],v[196:199],v[32:47]
v_add_f32 v101,v101,v111
v_add_f32 v102,v102,v112
v_add_f32 v103,v103,v113
ds_read_b128 v[84:87],v6 offset:29696
v_mfma_f32_32x32x16_bf16 v[16:31],v[88:91],a[104:107],v[16:31]
v_add_f32 v104,v104,v114
v_add_f32 v105,v105,v115
v_add_f32 v96,v96,v100
v_mfma_f32_32x32x16_bf16 v[32:47],v[88:91],v[200:203],v[32:47]
v_add_f32 v97,v97,v101
v_add_f32 v98,v98,v102
v_add_f32 v99,v99,v103
ds_read_b128 v[88:91],v6 offset:30720
s_waitcnt lgkmcnt(3)
v_mfma_f32_32x32x16_bf16 v[16:31],v[92:95],a[108:111],v[16:31]
v_add_f32 v104,v104,v96
v_add_f32 v105,v105,v97
v_add_f32 v12,v104,v98
v_mfma_f32_32x32x16_bf16 v[32:47],v[92:95],v[204:207],v[32:47]
v_add_f32 v13,v105,v99
v_mov_b32 v96,v12
v_mov_b32 v97,v13
ds_read_b128 v[92:95],v6 offset:31744
s_waitcnt lgkmcnt(3)
v_mfma_f32_32x32x16_bf16 v[16:31],v[80:83],a[112:115],v[16:31]
v_mfma_f32_32x32x16_bf16 v[32:47],v[80:83],v[208:211],v[32:47]
v_permlane32_swap_b32 v12,v96
v_permlane32_swap_b32 v13,v97
ds_read_b128 v[80:83],v6 offset:32768
s_waitcnt lgkmcnt(3)
v_mfma_f32_32x32x16_bf16 v[16:31],v[84:87],a[116:119],v[16:31]
v_add_f32 v12,v12,v96
v_add_f32 v13,v13,v97
v_mul_f32 v12,s48,v12
v_mfma_f32_32x32x16_bf16 v[32:47],v[84:87],v[212:215],v[32:47]
v_mul_f32 v13,s48,v13
v_fma_f32 v13,-v12,v12,v13
v_max_f32 v13,0,v13
ds_read_b128 v[84:87],v6 offset:33792
s_waitcnt lgkmcnt(3)
v_mfma_f32_32x32x16_bf16 v[16:31],v[88:91],a[120:123],v[16:31]
v_add_f32 v96,s49,v13
v_rsq_f32 v10,v96
v_mfma_f32_32x32x16_bf16 v[32:47],v[88:91],v[216:219],v[32:47]
v_mul_f32 v11,v12,v10
v_mov_b32 v164,v10
v_mov_b32 v165,v10
ds_read_b128 v[88:91],v6 offset:34816
s_waitcnt lgkmcnt(3)
v_mfma_f32_32x32x16_bf16 v[16:31],v[92:95],a[124:127],v[16:31]
s_lshl_b32 s60,s3,8
s_add_u32 s60,s60,147456
v_lshlrev_b32 v12,2,v9
v_mfma_f32_32x32x16_bf16 v[32:47],v[92:95],v[220:223],v[32:47]
v_add_u32 v12,s60,v12
ds_write_b32 v12,v10
ds_write_b32 v12,v11 offset:128
ds_read_b128 v[92:95],v6 offset:35840
s_waitcnt lgkmcnt(5)
v_mfma_f32_32x32x16_bf16 v[16:31],v[80:83],a[128:131],v[16:31]
v_lshrrev_b32 v13,5,v0
v_lshlrev_b32 v13,4,v13
v_add_u32 v13,s60,v13
v_mfma_f32_32x32x16_bf16 v[32:47],v[80:83],v[224:227],v[32:47]
ds_read_b128 v[96:99],v13
ds_read_b128 v[112:115],v13 offset:128
ds_read_b128 v[100:103],v13 offset:32
ds_read_b128 v[80:83],v6 offset:36864
s_waitcnt lgkmcnt(8)
v_mfma_f32_32x32x16_bf16 v[16:31],v[84:87],a[132:135],v[16:31]
ds_read_b128 v[116:119],v13 offset:160
ds_read_b128 v[104:107],v13 offset:64
ds_read_b128 v[120:123],v13 offset:192
v_mfma_f32_32x32x16_bf16 v[32:47],v[84:87],v[228:231],v[32:47]
ds_read_b128 v[108:111],v13 offset:96
ds_read_b128 v[124:127],v13 offset:224
ds_read_b128 v[84:87],v6 offset:37888
s_waitcnt lgkmcnt(13)
v_mfma_f32_32x32x16_bf16 v[16:31],v[88:91],a[136:139],v[16:31]
v_mfma_f32_32x32x16_bf16 v[32:47],v[88:91],v[232:235],v[32:47]
ds_read_b128 v[88:91],v6 offset:38912
s_waitcnt lgkmcnt(11)
v_mfma_f32_32x32x16_bf16 v[16:31],v[92:95],a[140:143],v[16:31]
s_waitcnt lgkmcnt(2)
v_mfma_f32_32x32x16_bf16 v[32:47],v[92:95],v[236:239],v[32:47]
ds_read_b128 v[92:95],v6 offset:39936
v_mfma_f32_32x32x16_bf16 v[16:31],v[80:83],a[144:147],v[16:31]
v_mfma_f32_32x32x16_bf16 v[32:47],v[80:83],v[240:243],v[32:47]
s_waitcnt vmcnt(0)
s_barrier
v_mov_b32 v2,s64
s_mov_b64 exec,1
buffer_store_dword v2,off,s[24:27],s37 sc1
s_mov_b64 exec,-1
ds_read_b128 v[80:83],v188
s_waitcnt lgkmcnt(3)
v_mfma_f32_32x32x16_bf16 v[16:31],v[84:87],a[148:151],v[16:31]
v_mfma_f32_32x32x16_bf16 v[32:47],v[84:87],v[244:247],v[32:47]
ds_read_b128 v[84:87],v188 offset:1024
s_waitcnt lgkmcnt(3)
v_mfma_f32_32x32x16_bf16 v[16:31],v[88:91],a[152:155],v[16:31]
v_mfma_f32_32x32x16_bf16 v[32:47],v[88:91],v[248:251],v[32:47]
ds_read_b128 v[88:91],v188 offset:2048
s_waitcnt lgkmcnt(3)
v_mfma_f32_32x32x16_bf16 v[16:31],v[92:95],a[156:159],v[16:31]
v_mfma_f32_32x32x16_bf16 v[32:47],v[92:95],v[252:255],v[32:47]
s_mul_i32 s36,s28,786432
s_add_u32 s36,s36,s68
s_add_u32 s64,s28,1
s_mov_b32 s28,s62
s_mov_b32 s35,s34
s_mov_b32 s26,s61
s_cmp_ge_u32 s28,s63
s_cbranch_scc1 ns_se_214
v_mov_b32 v6,v188
s_cmp_lt_u32 s28,42
s_cselect_b32 s62,2,1
s_cmp_lt_u32 s28,33
s_cselect_b32 s62,3,s62
s_add_u32 s62,s62,s28
s_min_u32 s60,s62,63
s_mul_i32 s42,s60,49152
s_add_u32 s32,s66,s42
s_add_u32 s33,s67,s42
s_add_u32 s34,s35,49152
s_cmp_eq_u32 s34,147456
s_cselect_b32 s34,0,s34
s_add_u32 s44,s34,s43
v_add_u32 v188,s34,v1
ds_read_b128 v[92:95],v6 offset:3072
s_waitcnt lgkmcnt(3)
v_mfma_f32_32x32x16_bf16 v[128:143],v[80:83],a[0:3],0
s_add_u32 s46,s44,0
s_mov_b32 m0,s46
s_add_u32 s46,s32,0
buffer_load_dwordx4 v1,s[4:7],s46 offen sc1 lds
v_mfma_f32_32x32x16_bf16 v[172:187],v[80:83],a[160:163],0
ds_read_b128 v[80:83],v6 offset:4096
s_waitcnt lgkmcnt(3)
v_mfma_f32_32x32x16_bf16 v[128:143],v[84:87],a[4:7],v[128:143]
v_mfma_f32_32x32x16_bf16 v[172:187],v[84:87],a[164:167],v[172:187]
ds_read_b128 v[84:87],v6 offset:5120
s_waitcnt lgkmcnt(3)
v_mfma_f32_32x32x16_bf16 v[128:143],v[88:91],a[8:11],v[128:143]
s_add_u32 s46,s44,4096
s_mov_b32 m0,s46
s_add_u32 s46,s32,4096
buffer_load_dwordx4 v1,s[4:7],s46 offen sc1 lds
v_mfma_f32_32x32x16_bf16 v[172:187],v[88:91],a[168:171],v[172:187]
v_mul_f32_e64 v168,-v112,v48
v_fma_f32 v16,v16,v96,v168
v_mul_f32_e64 v169,-v113,v48
ds_read_b128 v[88:91],v6 offset:6144
s_waitcnt lgkmcnt(3)
v_mfma_f32_32x32x16_bf16 v[128:143],v[92:95],a[12:15],v[128:143]
v_fma_f32 v17,v17,v97,v169
v_mul_f32_e64 v170,-v114,v48
v_fma_f32 v18,v18,v98,v170
v_mfma_f32_32x32x16_bf16 v[172:187],v[92:95],a[172:175],v[172:187]
v_mul_f32_e64 v171,-v115,v48
v_fma_f32 v19,v19,v99,v171
v_mul_f32_e64 v168,-v116,v48
ds_read_b128 v[92:95],v6 offset:7168
s_waitcnt lgkmcnt(3)
v_mfma_f32_32x32x16_bf16 v[128:143],v[80:83],a[16:19],v[128:143]
s_add_u32 s46,s44,8192
s_mov_b32 m0,s46
s_add_u32 s46,s32,8192
buffer_load_dwordx4 v1,s[4:7],s46 offen sc1 lds
v_mfma_f32_32x32x16_bf16 v[172:187],v[80:83],a[176:179],v[172:187]
v_fma_f32 v20,v20,v100,v168
v_mul_f32_e64 v169,-v117,v48
v_fma_f32 v21,v21,v101,v169
ds_read_b128 v[80:83],v6 offset:8192
s_waitcnt lgkmcnt(3)
v_mfma_f32_32x32x16_bf16 v[128:143],v[84:87],a[20:23],v[128:143]
v_mul_f32_e64 v170,-v118,v48
v_fma_f32 v22,v22,v102,v170
v_mul_f32_e64 v171,-v119,v48
v_mfma_f32_32x32x16_bf16 v[172:187],v[84:87],a[180:183],v[172:187]
v_fma_f32 v23,v23,v103,v171
v_cvt_pk_bf16_f32 v144,v16,v17
v_cvt_pk_bf16_f32 v145,v18,v19
ds_read_b128 v[84:87],v6 offset:9216
s_waitcnt lgkmcnt(3)
v_mfma_f32_32x32x16_bf16 v[128:143],v[88:91],a[24:27],v[128:143]
s_add_u32 s46,s44,40960
s_mov_b32 m0,s46
s_add_u32 s46,s33,40960
buffer_load_dwordx4 v1,s[4:7],s46 offen sc1 lds
v_mfma_f32_32x32x16_bf16 v[172:187],v[88:91],a[184:187],v[172:187]
v_cvt_pk_bf16_f32 v146,v20,v21
v_cvt_pk_bf16_f32 v147,v22,v23
buffer_store_dwordx4 v[144:147],v1,s[24:27],s36 offen sc1
ds_read_b128 v[88:91],v6 offset:10240
s_waitcnt lgkmcnt(3)
v_mfma_f32_32x32x16_bf16 v[128:143],v[92:95],a[28:31],v[128:143]
v_mul_f32_e64 v168,-v120,v48
v_fma_f32 v24,v24,v104,v168
v_mul_f32_e64 v169,-v121,v48
v_mfma_f32_32x32x16_bf16 v[172:187],v[92:95],a[188:191],v[172:187]
v_fma_f32 v25,v25,v105,v169
v_mul_f32_e64 v170,-v122,v48
v_fma_f32 v26,v26,v106,v170
ds_read_b128 v[92:95],v6 offset:11264
s_waitcnt lgkmcnt(3)
v_mfma_f32_32x32x16_bf16 v[128:143],v[80:83],a[32:35],v[128:143]
s_add_u32 s46,s44,45056
s_mov_b32 m0,s46
s_add_u32 s46,s33,45056
buffer_load_dwordx4 v1,s[4:7],s46 offen sc1 lds
v_mfma_f32_32x32x16_bf16 v[172:187],v[80:83],a[192:195],v[172:187]
v_mul_f32_e64 v171,-v123,v48
v_fma_f32 v27,v27,v107,v171
v_mul_f32_e64 v168,-v124,v48
ds_read_b128 v[80:83],v6 offset:12288
s_waitcnt lgkmcnt(3)
v_mfma_f32_32x32x16_bf16 v[128:143],v[84:87],a[36:39],v[128:143]
v_fma_f32 v28,v28,v108,v168
v_mul_f32_e64 v169,-v125,v48
v_fma_f32 v29,v29,v109,v169
v_mfma_f32_32x32x16_bf16 v[172:187],v[84:87],a[196:199],v[172:187]
v_mul_f32_e64 v170,-v126,v48
v_fma_f32 v30,v30,v110,v170
v_mul_f32_e64 v171,-v127,v48
ds_read_b128 v[84:87],v6 offset:13312
s_waitcnt lgkmcnt(3)
v_mfma_f32_32x32x16_bf16 v[128:143],v[88:91],a[40:43],v[128:143]
s_add_u32 s46,s44,12288
s_mov_b32 m0,s46
s_add_u32 s46,s32,12288
buffer_load_dwordx4 v1,s[4:7],s46 offen sc1 lds
v_mfma_f32_32x32x16_bf16 v[172:187],v[88:91],a[200:203],v[172:187]
v_fma_f32 v31,v31,v111,v171
v_cvt_pk_bf16_f32 v148,v24,v25
v_cvt_pk_bf16_f32 v149,v26,v27
ds_read_b128 v[88:91],v6 offset:14336
s_waitcnt lgkmcnt(3)
v_mfma_f32_32x32x16_bf16 v[128:143],v[92:95],a[44:47],v[128:143]
v_cvt_pk_bf16_f32 v150,v28,v29
v_cvt_pk_bf16_f32 v151,v30,v31
buffer_store_dwordx4 v[148:151],v1,s[24:27],s36 offen offset:1024 sc1
v_mfma_f32_32x32x16_bf16 v[172:187],v[92:95],a[204:207],v[172:187]
v_mul_f32_e64 v168,-v112,v64
v_fma_f32 v32,v32,v96,v168
v_mul_f32_e64 v169,-v113,v64
ds_read_b128 v[92:95],v6 offset:15360
s_waitcnt lgkmcnt(3)
v_mfma_f32_32x32x16_bf16 v[128:143],v[80:83],a[48:51],v[128:143]
s_add_u32 s46,s44,16384
s_mov_b32 m0,s46
s_add_u32 s46,s32,16384
buffer_load_dwordx4 v1,s[4:7],s46 offen sc1 lds
v_mfma_f32_32x32x16_bf16 v[172:187],v[80:83],a[208:211],v[172:187]
v_fma_f32 v33,v33,v97,v169
v_mul_f32_e64 v170,-v114,v64
v_fma_f32 v34,v34,v98,v170
ds_read_b128 v[80:83],v6 offset:16384
s_waitcnt lgkmcnt(3)
v_mfma_f32_32x32x16_bf16 v[128:143],v[84:87],a[52:55],v[128:143]
v_mul_f32_e64 v171,-v115,v64
v_fma_f32 v35,v35,v99,v171
v_mul_f32_e64 v168,-v116,v64
v_mfma_f32_32x32x16_bf16 v[172:187],v[84:87],a[212:215],v[172:187]
v_fma_f32 v36,v36,v100,v168
v_mul_f32_e64 v169,-v117,v64
v_fma_f32 v37,v37,v101,v169
ds_read_b128 v[84:87],v6 offset:17408
s_waitcnt lgkmcnt(3)
v_mfma_f32_32x32x16_bf16 v[128:143],v[88:91],a[56:59],v[128:143]
s_add_u32 s46,s44,20480
s_mov_b32 m0,s46
s_add_u32 s46,s32,20480
buffer_load_dwordx4 v1,s[4:7],s46 offen sc1 lds
v_mfma_f32_32x32x16_bf16 v[172:187],v[88:91],a[216:219],v[172:187]
v_mul_f32_e64 v170,-v118,v64
v_fma_f32 v38,v38,v102,v170
v_mul_f32_e64 v171,-v119,v64
ds_read_b128 v[88:91],v6 offset:18432
s_waitcnt lgkmcnt(3)
v_mfma_f32_32x32x16_bf16 v[128:143],v[92:95],a[60:63],v[128:143]
v_fma_f32 v39,v39,v103,v171
v_cvt_pk_bf16_f32 v152,v32,v33
v_cvt_pk_bf16_f32 v153,v34,v35
v_mfma_f32_32x32x16_bf16 v[172:187],v[92:95],a[220:223],v[172:187]
v_cvt_pk_bf16_f32 v154,v36,v37
v_cvt_pk_bf16_f32 v155,v38,v39
buffer_store_dwordx4 v[152:155],v1,s[24:27],s36 offen offset:2048 sc1
ds_read_b128 v[92:95],v6 offset:19456
s_waitcnt lgkmcnt(3)
v_mfma_f32_32x32x16_bf16 v[128:143],v[80:83],a[64:67],v[128:143]
s_add_u32 s46,s44,24576
s_mov_b32 m0,s46
s_add_u32 s46,s32,24576
buffer_load_dwordx4 v1,s[4:7],s46 offen sc1 lds
v_mfma_f32_32x32x16_bf16 v[172:187],v[80:83],a[224:227],v[172:187]
v_mul_f32_e64 v168,-v120,v64
v_fma_f32 v40,v40,v104,v168
v_mul_f32_e64 v169,-v121,v64
ds_read_b128 v[80:83],v6 offset:20480
s_waitcnt lgkmcnt(3)
v_mfma_f32_32x32x16_bf16 v[128:143],v[84:87],a[68:71],v[128:143]
v_fma_f32 v41,v41,v105,v169
v_mul_f32_e64 v170,-v122,v64
v_fma_f32 v42,v42,v106,v170
v_mfma_f32_32x32x16_bf16 v[172:187],v[84:87],a[228:231],v[172:187]
v_mul_f32_e64 v171,-v123,v64
v_fma_f32 v43,v43,v107,v171
v_mul_f32_e64 v168,-v124,v64
ds_read_b128 v[84:87],v6 offset:21504
s_waitcnt lgkmcnt(3)
v_mfma_f32_32x32x16_bf16 v[128:143],v[88:91],a[72:75],v[128:143]
s_add_u32 s46,s44,28672
s_mov_b32 m0,s46
s_add_u32 s46,s32,28672
buffer_load_dwordx4 v1,s[4:7],s46 offen sc1 lds
v_mfma_f32_32x32x16_bf16 v[172:187],v[88:91],a[232:235],v[172:187]
v_fma_f32 v44,v44,v108,v168
v_mul_f32_e64 v169,-v125,v64
v_fma_f32 v45,v45,v109,v169
ds_read_b128 v[88:91],v6 offset:22528
s_waitcnt lgkmcnt(3)
v_mfma_f32_32x32x16_bf16 v[128:143],v[92:95],a[76:79],v[128:143]
v_mul_f32_e64 v170,-v126,v64
v_fma_f32 v46,v46,v110,v170
v_mul_f32_e64 v171,-v127,v64
v_mfma_f32_32x32x16_bf16 v[172:187],v[92:95],a[236:239],v[172:187]
v_fma_f32 v47,v47,v111,v171
v_cvt_pk_bf16_f32 v156,v40,v41
v_cvt_pk_bf16_f32 v157,v42,v43
ds_read_b128 v[92:95],v6 offset:23552
s_waitcnt lgkmcnt(3)
v_mfma_f32_32x32x16_bf16 v[128:143],v[80:83],a[80:83],v[128:143]
s_add_u32 s46,s44,32768
s_mov_b32 m0,s46
s_add_u32 s46,s32,32768
buffer_load_dwordx4 v1,s[4:7],s46 offen sc1 lds
v_mfma_f32_32x32x16_bf16 v[172:187],v[80:83],a[240:243],v[172:187]
v_cvt_pk_bf16_f32 v158,v44,v45
v_cvt_pk_bf16_f32 v159,v46,v47
buffer_store_dwordx4 v[156:159],v1,s[24:27],s36 offen offset:3072 sc1
ds_read_b128 v[80:83],v6 offset:24576
s_waitcnt lgkmcnt(3)
v_mfma_f32_32x32x16_bf16 v[128:143],v[84:87],a[84:87],v[128:143]
v_add_u32 v5,s35,v7
ds_read_b64 v[96:97],v5 offset:40960
ds_read_b64 v[98:99],v5 offset:41216
v_mfma_f32_32x32x16_bf16 v[172:187],v[84:87],a[244:247],v[172:187]
ds_read_b64 v[100:101],v5 offset:41472
ds_read_b64 v[102:103],v5 offset:41728
ds_read_b64 v[104:105],v5 offset:41984
ds_read_b128 v[84:87],v6 offset:25600
s_waitcnt lgkmcnt(8)
v_mfma_f32_32x32x16_bf16 v[128:143],v[88:91],a[88:91],v[128:143]
s_add_u32 s46,s44,36864
s_mov_b32 m0,s46
s_add_u32 s46,s32,36864
buffer_load_dwordx4 v1,s[4:7],s46 offen sc1 lds
v_mfma_f32_32x32x16_bf16 v[172:187],v[88:91],a[248:251],v[172:187]
ds_read_b64 v[106:107],v5 offset:42240
ds_read_b64 v[108:109],v5 offset:42496
ds_read_b64 v[110:111],v5 offset:42752
ds_read_b128 v[88:91],v6 offset:26624
s_waitcnt lgkmcnt(11)
v_mfma_f32_32x32x16_bf16 v[128:143],v[92:95],a[92:95],v[128:143]
ds_read_b64 v[112:113],v5 offset:43008
ds_read_b64 v[114:115],v5 offset:43264
v_mfma_f32_32x32x16_bf16 v[172:187],v[92:95],a[252:255],v[172:187]
ds_read_b128 v[92:95],v6 offset:27648
s_waitcnt lgkmcnt(13)
v_mfma_f32_32x32x16_bf16 v[128:143],v[80:83],a[96:99],v[128:143]
v_mfma_f32_32x32x16_bf16 v[172:187],v[80:83],v[192:195],v[172:187]
s_waitcnt lgkmcnt(1)
v_add_f32 v96,v96,v106
v_add_f32 v97,v97,v107
ds_read_b128 v[80:83],v6 offset:28672
v_mfma_f32_32x32x16_bf16 v[128:143],v[84:87],a[100:103],v[128:143]
v_add_f32 v98,v98,v108
v_add_f32 v99,v99,v109
v_add_f32 v100,v100,v110
v_mfma_f32_32x32x16_bf16 v[172:187],v[84:87],v[196:199],v[172:187]
v_add_f32 v101,v101,v111
v_add_f32 v102,v102,v112
v_add_f32 v103,v103,v113
ds_read_b128 v[84:87],v6 offset:29696
v_mfma_f32_32x32x16_bf16 v[128:143],v[88:91],a[104:107],v[128:143]
v_add_f32 v104,v104,v114
v_add_f32 v105,v105,v115
v_add_f32 v96,v96,v100
v_mfma_f32_32x32x16_bf16 v[172:187],v[88:91],v[200:203],v[172:187]
v_add_f32 v97,v97,v101
v_add_f32 v98,v98,v102
v_add_f32 v99,v99,v103
ds_read_b128 v[88:91],v6 offset:30720
s_waitcnt lgkmcnt(3)
v_mfma_f32_32x32x16_bf16 v[128:143],v[92:95],a[108:111],v[128:143]
v_add_f32 v104,v104,v96
v_add_f32 v105,v105,v97
v_add_f32 v12,v104,v98
v_mfma_f32_32x32x16_bf16 v[172:187],v[92:95],v[204:207],v[172:187]
v_add_f32 v13,v105,v99
v_mov_b32 v96,v12
v_mov_b32 v97,v13
ds_read_b128 v[92:95],v6 offset:31744
s_waitcnt lgkmcnt(3)
v_mfma_f32_32x32x16_bf16 v[128:143],v[80:83],a[112:115],v[128:143]
v_mfma_f32_32x32x16_bf16 v[172:187],v[80:83],v[208:211],v[172:187]
v_permlane32_swap_b32 v12,v96
v_permlane32_swap_b32 v13,v97
ds_read_b128 v[80:83],v6 offset:32768
s_waitcnt lgkmcnt(3)
v_mfma_f32_32x32x16_bf16 v[128:143],v[84:87],a[116:119],v[128:143]
v_add_f32 v12,v12,v96
v_add_f32 v13,v13,v97
v_mul_f32 v12,s48,v12
v_mfma_f32_32x32x16_bf16 v[172:187],v[84:87],v[212:215],v[172:187]
v_mul_f32 v13,s48,v13
v_fma_f32 v13,-v12,v12,v13
v_max_f32 v13,0,v13
ds_read_b128 v[84:87],v6 offset:33792
s_waitcnt lgkmcnt(3)
v_mfma_f32_32x32x16_bf16 v[128:143],v[88:91],a[120:123],v[128:143]
v_add_f32 v96,s49,v13
v_rsq_f32 v10,v96
v_mfma_f32_32x32x16_bf16 v[172:187],v[88:91],v[216:219],v[172:187]
v_mul_f32 v11,v12,v10
v_mov_b32 v164,v10
v_mov_b32 v165,v10
ds_read_b128 v[88:91],v6 offset:34816
s_waitcnt lgkmcnt(3)
v_mfma_f32_32x32x16_bf16 v[128:143],v[92:95],a[124:127],v[128:143]
s_lshl_b32 s60,s3,8
s_add_u32 s60,s60,147456
v_lshlrev_b32 v12,2,v9
v_mfma_f32_32x32x16_bf16 v[172:187],v[92:95],v[220:223],v[172:187]
v_add_u32 v12,s60,v12
ds_write_b32 v12,v10
ds_write_b32 v12,v11 offset:128
ds_read_b128 v[92:95],v6 offset:35840
s_waitcnt lgkmcnt(5)
v_mfma_f32_32x32x16_bf16 v[128:143],v[80:83],a[128:131],v[128:143]
v_lshrrev_b32 v13,5,v0
v_lshlrev_b32 v13,4,v13
v_add_u32 v13,s60,v13
v_mfma_f32_32x32x16_bf16 v[172:187],v[80:83],v[224:227],v[172:187]
ds_read_b128 v[96:99],v13
ds_read_b128 v[112:115],v13 offset:128
ds_read_b128 v[100:103],v13 offset:32
ds_read_b128 v[80:83],v6 offset:36864
s_waitcnt lgkmcnt(8)
v_mfma_f32_32x32x16_bf16 v[128:143],v[84:87],a[132:135],v[128:143]
ds_read_b128 v[116:119],v13 offset:160
ds_read_b128 v[104:107],v13 offset:64
ds_read_b128 v[120:123],v13 offset:192
v_mfma_f32_32x32x16_bf16 v[172:187],v[84:87],v[228:231],v[172:187]
ds_read_b128 v[108:111],v13 offset:96
ds_read_b128 v[124:127],v13 offset:224
ds_read_b128 v[84:87],v6 offset:37888
s_waitcnt lgkmcnt(13)
v_mfma_f32_32x32x16_bf16 v[128:143],v[88:91],a[136:139],v[128:143]
v_mfma_f32_32x32x16_bf16 v[172:187],v[88:91],v[232:235],v[172:187]
ds_read_b128 v[88:91],v6 offset:38912
s_waitcnt lgkmcnt(11)
v_mfma_f32_32x32x16_bf16 v[128:143],v[92:95],a[140:143],v[128:143]
s_waitcnt lgkmcnt(2)
v_mfma_f32_32x32x16_bf16 v[172:187],v[92:95],v[236:239],v[172:187]
ds_read_b128 v[92:95],v6 offset:39936
v_mfma_f32_32x32x16_bf16 v[128:143],v[80:83],a[144:147],v[128:143]
v_mfma_f32_32x32x16_bf16 v[172:187],v[80:83],v[240:243],v[172:187]
s_waitcnt vmcnt(0)
s_barrier
v_mov_b32 v2,s64
s_mov_b64 exec,1
buffer_store_dword v2,off,s[24:27],s37 sc1
s_mov_b64 exec,-1
ds_read_b128 v[80:83],v188
s_waitcnt lgkmcnt(3)
v_mfma_f32_32x32x16_bf16 v[128:143],v[84:87],a[148:151],v[128:143]
v_mfma_f32_32x32x16_bf16 v[172:187],v[84:87],v[244:247],v[172:187]
ds_read_b128 v[84:87],v188 offset:1024
s_waitcnt lgkmcnt(3)
v_mfma_f32_32x32x16_bf16 v[128:143],v[88:91],a[152:155],v[128:143]
v_mfma_f32_32x32x16_bf16 v[172:187],v[88:91],v[248:251],v[172:187]
ds_read_b128 v[88:91],v188 offset:2048
s_waitcnt lgkmcnt(3)
v_mfma_f32_32x32x16_bf16 v[128:143],v[92:95],a[156:159],v[128:143]
v_mfma_f32_32x32x16_bf16 v[172:187],v[92:95],v[252:255],v[172:187]
s_mul_i32 s36,s28,786432
s_add_u32 s36,s36,s68
s_add_u32 s64,s28,1
s_mov_b32 s28,s62
s_mov_b32 s35,s34
s_mov_b32 s26,s61
s_cmp_ge_u32 s28,s63
s_cbranch_scc1 ns_se_215
s_branch ns_sl_213
s_nop 2
ns_se_214:
s_nop 7
s_nop 3
v_mul_f32_e64 v168,-v112,v48
v_fma_f32 v16,v16,v96,v168
v_mul_f32_e64 v169,-v113,v48
v_fma_f32 v17,v17,v97,v169
v_mul_f32_e64 v170,-v114,v48
v_fma_f32 v18,v18,v98,v170
v_mul_f32_e64 v171,-v115,v48
v_fma_f32 v19,v19,v99,v171
v_mul_f32_e64 v168,-v116,v48
v_fma_f32 v20,v20,v100,v168
v_mul_f32_e64 v169,-v117,v48
v_fma_f32 v21,v21,v101,v169
v_mul_f32_e64 v170,-v118,v48
v_fma_f32 v22,v22,v102,v170
v_mul_f32_e64 v171,-v119,v48
v_fma_f32 v23,v23,v103,v171
v_cvt_pk_bf16_f32 v144,v16,v17
v_cvt_pk_bf16_f32 v145,v18,v19
v_cvt_pk_bf16_f32 v146,v20,v21
v_cvt_pk_bf16_f32 v147,v22,v23
buffer_store_dwordx4 v[144:147],v1,s[24:27],s36 offen sc1
v_mul_f32_e64 v168,-v120,v48
v_fma_f32 v24,v24,v104,v168
v_mul_f32_e64 v169,-v121,v48
v_fma_f32 v25,v25,v105,v169
v_mul_f32_e64 v170,-v122,v48
v_fma_f32 v26,v26,v106,v170
v_mul_f32_e64 v171,-v123,v48
v_fma_f32 v27,v27,v107,v171
v_mul_f32_e64 v168,-v124,v48
v_fma_f32 v28,v28,v108,v168
v_mul_f32_e64 v169,-v125,v48
v_fma_f32 v29,v29,v109,v169
v_mul_f32_e64 v170,-v126,v48
v_fma_f32 v30,v30,v110,v170
v_mul_f32_e64 v171,-v127,v48
v_fma_f32 v31,v31,v111,v171
v_cvt_pk_bf16_f32 v148,v24,v25
v_cvt_pk_bf16_f32 v149,v26,v27
v_cvt_pk_bf16_f32 v150,v28,v29
v_cvt_pk_bf16_f32 v151,v30,v31
buffer_store_dwordx4 v[148:151],v1,s[24:27],s36 offen offset:1024 sc1
v_mul_f32_e64 v168,-v112,v64
v_fma_f32 v32,v32,v96,v168
v_mul_f32_e64 v169,-v113,v64
v_fma_f32 v33,v33,v97,v169
v_mul_f32_e64 v170,-v114,v64
v_fma_f32 v34,v34,v98,v170
v_mul_f32_e64 v171,-v115,v64
v_fma_f32 v35,v35,v99,v171
v_mul_f32_e64 v168,-v116,v64
v_fma_f32 v36,v36,v100,v168
v_mul_f32_e64 v169,-v117,v64
v_fma_f32 v37,v37,v101,v169
v_mul_f32_e64 v170,-v118,v64
v_fma_f32 v38,v38,v102,v170
v_mul_f32_e64 v171,-v119,v64
v_fma_f32 v39,v39,v103,v171
v_cvt_pk_bf16_f32 v152,v32,v33
v_cvt_pk_bf16_f32 v153,v34,v35
v_cvt_pk_bf16_f32 v154,v36,v37
v_cvt_pk_bf16_f32 v155,v38,v39
buffer_store_dwordx4 v[152:155],v1,s[24:27],s36 offen offset:2048 sc1
v_mul_f32_e64 v168,-v120,v64
v_fma_f32 v40,v40,v104,v168
v_mul_f32_e64 v169,-v121,v64
v_fma_f32 v41,v41,v105,v169
v_mul_f32_e64 v170,-v122,v64
v_fma_f32 v42,v42,v106,v170
v_mul_f32_e64 v171,-v123,v64
v_fma_f32 v43,v43,v107,v171
v_mul_f32_e64 v168,-v124,v64
v_fma_f32 v44,v44,v108,v168
v_mul_f32_e64 v169,-v125,v64
v_fma_f32 v45,v45,v109,v169
v_mul_f32_e64 v170,-v126,v64
v_fma_f32 v46,v46,v110,v170
v_mul_f32_e64 v171,-v127,v64
v_fma_f32 v47,v47,v111,v171
v_cvt_pk_bf16_f32 v156,v40,v41
v_cvt_pk_bf16_f32 v157,v42,v43
v_cvt_pk_bf16_f32 v158,v44,v45
v_cvt_pk_bf16_f32 v159,v46,v47
buffer_store_dwordx4 v[156:159],v1,s[24:27],s36 offen offset:3072 sc1
s_nop 0
s_branch ns_stop_212
ns_se_215:
s_nop 7
s_nop 3
v_mul_f32_e64 v168,-v112,v48
v_fma_f32 v128,v128,v96,v168
v_mul_f32_e64 v169,-v113,v48
v_fma_f32 v129,v129,v97,v169
v_mul_f32_e64 v170,-v114,v48
v_fma_f32 v130,v130,v98,v170
v_mul_f32_e64 v171,-v115,v48
v_fma_f32 v131,v131,v99,v171
v_mul_f32_e64 v168,-v116,v48
v_fma_f32 v132,v132,v100,v168
v_mul_f32_e64 v169,-v117,v48
v_fma_f32 v133,v133,v101,v169
v_mul_f32_e64 v170,-v118,v48
v_fma_f32 v134,v134,v102,v170
v_mul_f32_e64 v171,-v119,v48
v_fma_f32 v135,v135,v103,v171
v_cvt_pk_bf16_f32 v144,v128,v129
v_cvt_pk_bf16_f32 v145,v130,v131
v_cvt_pk_bf16_f32 v146,v132,v133
v_cvt_pk_bf16_f32 v147,v134,v135
buffer_store_dwordx4 v[144:147],v1,s[24:27],s36 offen sc1
v_mul_f32_e64 v168,-v120,v48
v_fma_f32 v136,v136,v104,v168
v_mul_f32_e64 v169,-v121,v48
v_fma_f32 v137,v137,v105,v169
v_mul_f32_e64 v170,-v122,v48
v_fma_f32 v138,v138,v106,v170
v_mul_f32_e64 v171,-v123,v48
v_fma_f32 v139,v139,v107,v171
v_mul_f32_e64 v168,-v124,v48
v_fma_f32 v140,v140,v108,v168
v_mul_f32_e64 v169,-v125,v48
v_fma_f32 v141,v141,v109,v169
v_mul_f32_e64 v170,-v126,v48
v_fma_f32 v142,v142,v110,v170
v_mul_f32_e64 v171,-v127,v48
v_fma_f32 v143,v143,v111,v171
v_cvt_pk_bf16_f32 v148,v136,v137
v_cvt_pk_bf16_f32 v149,v138,v139
v_cvt_pk_bf16_f32 v150,v140,v141
v_cvt_pk_bf16_f32 v151,v142,v143
buffer_store_dwordx4 v[148:151],v1,s[24:27],s36 offen offset:1024 sc1
v_mul_f32_e64 v168,-v112,v64
v_fma_f32 v172,v172,v96,v168
v_mul_f32_e64 v169,-v113,v64
v_fma_f32 v173,v173,v97,v169
v_mul_f32_e64 v170,-v114,v64
v_fma_f32 v174,v174,v98,v170
v_mul_f32_e64 v171,-v115,v64
v_fma_f32 v175,v175,v99,v171
v_mul_f32_e64 v168,-v116,v64
v_fma_f32 v176,v176,v100,v168
v_mul_f32_e64 v169,-v117,v64
v_fma_f32 v177,v177,v101,v169
v_mul_f32_e64 v170,-v118,v64
v_fma_f32 v178,v178,v102,v170
v_mul_f32_e64 v171,-v119,v64
v_fma_f32 v179,v179,v103,v171
v_cvt_pk_bf16_f32 v152,v172,v173
v_cvt_pk_bf16_f32 v153,v174,v175
v_cvt_pk_bf16_f32 v154,v176,v177
v_cvt_pk_bf16_f32 v155,v178,v179
buffer_store_dwordx4 v[152:155],v1,s[24:27],s36 offen offset:2048 sc1
v_mul_f32_e64 v168,-v120,v64
v_fma_f32 v180,v180,v104,v168
v_mul_f32_e64 v169,-v121,v64
v_fma_f32 v181,v181,v105,v169
v_mul_f32_e64 v170,-v122,v64
v_fma_f32 v182,v182,v106,v170
v_mul_f32_e64 v171,-v123,v64
v_fma_f32 v183,v183,v107,v171
v_mul_f32_e64 v168,-v124,v64
v_fma_f32 v184,v184,v108,v168
v_mul_f32_e64 v169,-v125,v64
v_fma_f32 v185,v185,v109,v169
v_mul_f32_e64 v170,-v126,v64
v_fma_f32 v186,v186,v110,v170
v_mul_f32_e64 v171,-v127,v64
v_fma_f32 v187,v187,v111,v171
v_cvt_pk_bf16_f32 v156,v180,v181
v_cvt_pk_bf16_f32 v157,v182,v183
v_cvt_pk_bf16_f32 v158,v184,v185
v_cvt_pk_bf16_f32 v159,v186,v187
buffer_store_dwordx4 v[156:159],v1,s[24:27],s36 offen offset:3072 sc1
s_nop 0
s_branch ns_stop_212
ns_stop_212:
s_waitcnt vmcnt(0) lgkmcnt(0)
v_mov_b32 v2,s64
s_mov_b64 exec,1
buffer_store_dword v2,off,s[24:27],s37 sc1
s_mov_b64 exec,-1
s_cmp_lg_u32 s65,0
s_cbranch_scc1 L_steady
s_barrier
s_mov_b32 s39,1
s_mov_b32 s28,0
s_mov_b32 s63,64
s_mov_b32 s35,0
s_branch ns_init_171
L_steady:
s_barrier
s_sub_u32 s42,s2,64
s_mov_b32 s43,0
s_mov_b32 s39,1
s_cmp_lt_u32 s42,8
s_cbranch_scc1 L_end
s_mov_b32 s43,8
s_mov_b32 s39,1
s_cmp_lt_u32 s42,16
s_cbranch_scc1 L_end
s_mov_b32 s43,16
s_mov_b32 s39,1
s_cmp_lt_u32 s42,24
s_cbranch_scc1 L_end
s_mov_b32 s43,-24
s_mov_b32 s39,0
s_cmp_lt_u32 s42,29
s_cbranch_scc1 R_w1
s_mov_b32 s43,-14
s_mov_b32 s39,0
s_cmp_lt_u32 s42,30
s_cbranch_scc1 R_att
s_mov_b32 s43,-30
s_mov_b32 s39,0
s_cmp_lt_u32 s42,32
s_cbranch_scc1 L_end
s_mov_b32 s43,-24
s_mov_b32 s39,1
s_cmp_lt_u32 s42,40
s_cbranch_scc1 L_end
s_mov_b32 s43,-16
s_mov_b32 s39,1
s_cmp_lt_u32 s42,48
s_cbranch_scc1 L_end
s_mov_b32 s43,-8
s_mov_b32 s39,1
s_cmp_lt_u32 s42,56
s_cbranch_scc1 L_end
s_mov_b32 s43,-56
s_mov_b32 s39,1
s_cmp_lt_u32 s42,61
s_cbranch_scc1 R_w1
s_mov_b32 s43,-46
s_mov_b32 s39,1
s_cmp_lt_u32 s42,62
s_cbranch_scc1 R_att
s_mov_b32 s43,-62
s_mov_b32 s39,0
s_cmp_lt_u32 s42,64
s_cbranch_scc1 L_end
s_mov_b32 s43,-64
s_mov_b32 s39,0
s_cmp_lt_u32 s42,69
s_cbranch_scc1 R_w2
s_mov_b32 s43,-69
s_mov_b32 s39,0
s_cmp_lt_u32 s42,83
s_cbranch_scc1 R_w3
s_mov_b32 s43,-83
s_mov_b32 s39,0
s_cmp_lt_u32 s42,91
s_cbranch_scc1 R_w4
s_mov_b32 s43,-83
s_mov_b32 s39,0
s_cmp_lt_u32 s42,93
s_cbranch_scc1 R_w4
s_mov_b32 s43,-81
s_mov_b32 s39,0
s_cmp_lt_u32 s42,96
s_cbranch_scc1 R_att
s_mov_b32 s43,-96
s_mov_b32 s39,0
s_cmp_lt_u32 s42,116
s_cbranch_scc1 R_wo
s_mov_b32 s43,-116
s_mov_b32 s39,0
s_cmp_lt_u32 s42,128
s_cbranch_scc1 R_att
s_mov_b32 s43,-128
s_mov_b32 s39,1
s_cmp_lt_u32 s42,133
s_cbranch_scc1 R_w2
s_mov_b32 s43,-133
s_mov_b32 s39,1
s_cmp_lt_u32 s42,147
s_cbranch_scc1 R_w3
s_mov_b32 s43,-147
s_mov_b32 s39,1
s_cmp_lt_u32 s42,157
s_cbranch_scc1 R_w4
s_mov_b32 s43,-145
s_mov_b32 s39,1
s_cmp_lt_u32 s42,160
s_cbranch_scc1 R_att
s_mov_b32 s43,-160
s_mov_b32 s39,1
s_cmp_lt_u32 s42,170
s_cbranch_scc1 R_wo
s_mov_b32 s43,-160
s_mov_b32 s39,1
s_cmp_lt_u32 s42,180
s_cbranch_scc1 R_wo
s_mov_b32 s43,-180
s_mov_b32 s39,1
s_cmp_lt_u32 s42,192
s_cbranch_scc1 R_att
s_branch L_end
R_wo:
s_add_u32 s42,s42,s43
s_cmp_ge_u32 s3,2
s_cbranch_scc1 ks_hi_216
v_lshlrev_b32 v1,4,v0
s_mov_b32 s24,s4
s_mov_b32 s25,s5
s_mov_b32 s26,s6
s_mov_b32 s27,0x20000
s_cmp_ge_u32 s42,10
s_cselect_b32 s44,1,0
s_cselect_b32 s43,10,0
s_sub_u32 s43,s42,s43
s_lshl_b32 s43,s43,1
s_and_b32 s45,s3,1
s_mul_i32 s45,s45,30
s_lshl_b32 s46,s44,7
s_add_u32 s45,s45,s46
s_add_u32 s45,s45,0
s_and_b32 s48,s3,1
s_add_u32 s49,s43,s48
s_load_dwordx2 s[20:21],s[0:1],40
s_waitcnt lgkmcnt(0)
s_mov_b32 s16,s20
s_and_b32 s17,s21,0xffff
s_mov_b32 s18,0x500000
s_mov_b32 s19,0x20000
s_lshl_b32 s46,s43,6
s_mul_i32 s64,s45,20480
s_add_u32 s64,s64,s46
s_mul_i32 s41,s42,13
s_mul_hi_u32 s46,s41,0x8888889
s_mul_i32 s47,s46,30
s_sub_u32 s41,s41,s47
v_lshrrev_b32 v170,3,v0
v_mul_u32_u24 v168,1280,v170
v_and_b32 v170,7,v0
v_lshl_add_u32 v168,v170,4,v168
v_and_b32 v170,3,v0
v_lshlrev_b32 v169,3,v170
v_bfe_u32 v170,v0,4,1
v_lshl_add_u32 v169,v170,5,v169
v_bfe_u32 v170,v0,2,2
v_lshl_add_u32 v169,v170,7,v169
v_lshrrev_b32 v170,5,v0
v_lshl_add_u32 v169,v170,9,v169
s_mul_i32 s22,s3,40960
v_add_u32 v169,s22,v169
s_lshl_b32 s23,s48,6
v_add_u32 v169,s23,v169
v_xor_b32 v170,64,v169
s_add_u32 s20,s41,-30
s_cselect_b32 s47,0,30
s_add_u32 s20,s20,s47
s_mul_i32 s20,s20,20480
s_add_u32 s20,s20,s64
s_add_u32 s23,s22,0
s_mov_b32 m0,s23
s_nop 0
buffer_load_dwordx4 v168,s[16:19],s20 offen lds
s_add_u32 s23,s22,1024
s_mov_b32 m0,s23
s_add_u32 s20,s20,10240
buffer_load_dwordx4 v168,s[16:19],s20 offen lds
s_add_u32 s20,s41,-29
s_cselect_b32 s47,0,30
s_add_u32 s20,s20,s47
s_mul_i32 s20,s20,20480
s_add_u32 s20,s20,s64
s_add_u32 s23,s22,2048
s_mov_b32 m0,s23
s_nop 0
buffer_load_dwordx4 v168,s[16:19],s20 offen lds
s_add_u32 s23,s22,3072
s_mov_b32 m0,s23
s_add_u32 s20,s20,10240
buffer_load_dwordx4 v168,s[16:19],s20 offen lds
s_add_u32 s20,s41,-28
s_cselect_b32 s47,0,30
s_add_u32 s20,s20,s47
s_mul_i32 s20,s20,20480
s_add_u32 s20,s20,s64
s_add_u32 s23,s22,4096
s_mov_b32 m0,s23
s_nop 0
buffer_load_dwordx4 v168,s[16:19],s20 offen lds
s_add_u32 s23,s22,5120
s_mov_b32 m0,s23
s_add_u32 s20,s20,10240
buffer_load_dwordx4 v168,s[16:19],s20 offen lds
s_add_u32 s20,s41,-27
s_cselect_b32 s47,0,30
s_add_u32 s20,s20,s47
s_mul_i32 s20,s20,20480
s_add_u32 s20,s20,s64
s_add_u32 s23,s22,6144
s_mov_b32 m0,s23
s_nop 0
buffer_load_dwordx4 v168,s[16:19],s20 offen lds
s_add_u32 s23,s22,7168
s_mov_b32 m0,s23
s_add_u32 s20,s20,10240
buffer_load_dwordx4 v168,s[16:19],s20 offen lds
s_add_u32 s20,s41,-26
s_cselect_b32 s47,0,30
s_add_u32 s20,s20,s47
s_mul_i32 s20,s20,20480
s_add_u32 s20,s20,s64
s_add_u32 s23,s22,8192
s_mov_b32 m0,s23
s_nop 0
buffer_load_dwordx4 v168,s[16:19],s20 offen lds
s_add_u32 s23,s22,9216
s_mov_b32 m0,s23
s_add_u32 s20,s20,10240
buffer_load_dwordx4 v168,s[16:19],s20 offen lds
s_add_u32 s20,s41,-25
s_cselect_b32 s47,0,30
s_add_u32 s20,s20,s47
s_mul_i32 s20,s20,20480
s_add_u32 s20,s20,s64
s_add_u32 s23,s22,10240
s_mov_b32 m0,s23
s_nop 0
buffer_load_dwordx4 v168,s[16:19],s20 offen lds
s_add_u32 s23,s22,11264
s_mov_b32 m0,s23
s_add_u32 s20,s20,10240
buffer_load_dwordx4 v168,s[16:19],s20 offen lds
s_add_u32 s20,s41,-24
s_cselect_b32 s47,0,30
s_add_u32 s20,s20,s47
s_mul_i32 s20,s20,20480
s_add_u32 s20,s20,s64
s_add_u32 s23,s22,12288
s_mov_b32 m0,s23
s_nop 0
buffer_load_dwordx4 v168,s[16:19],s20 offen lds
s_add_u32 s23,s22,13312
s_mov_b32 m0,s23
s_add_u32 s20,s20,10240
buffer_load_dwordx4 v168,s[16:19],s20 offen lds
s_add_u32 s20,s41,-23
s_cselect_b32 s47,0,30
s_add_u32 s20,s20,s47
s_mul_i32 s20,s20,20480
s_add_u32 s20,s20,s64
s_add_u32 s23,s22,14336
s_mov_b32 m0,s23
s_nop 0
buffer_load_dwordx4 v168,s[16:19],s20 offen lds
s_add_u32 s23,s22,15360
s_mov_b32 m0,s23
s_add_u32 s20,s20,10240
buffer_load_dwordx4 v168,s[16:19],s20 offen lds
s_add_u32 s20,s41,-22
s_cselect_b32 s47,0,30
s_add_u32 s20,s20,s47
s_mul_i32 s20,s20,20480
s_add_u32 s20,s20,s64
s_add_u32 s23,s22,16384
s_mov_b32 m0,s23
s_nop 0
buffer_load_dwordx4 v168,s[16:19],s20 offen lds
s_add_u32 s23,s22,17408
s_mov_b32 m0,s23
s_add_u32 s20,s20,10240
buffer_load_dwordx4 v168,s[16:19],s20 offen lds
s_add_u32 s20,s41,-21
s_cselect_b32 s47,0,30
s_add_u32 s20,s20,s47
s_mul_i32 s20,s20,20480
s_add_u32 s20,s20,s64
s_add_u32 s23,s22,18432
s_mov_b32 m0,s23
s_nop 0
buffer_load_dwordx4 v168,s[16:19],s20 offen lds
s_add_u32 s23,s22,19456
s_mov_b32 m0,s23
s_add_u32 s20,s20,10240
buffer_load_dwordx4 v168,s[16:19],s20 offen lds
s_add_u32 s20,s41,-20
s_cselect_b32 s47,0,30
s_add_u32 s20,s20,s47
s_mul_i32 s20,s20,20480
s_add_u32 s20,s20,s64
s_add_u32 s23,s22,20480
s_mov_b32 m0,s23
s_nop 0
buffer_load_dwordx4 v168,s[16:19],s20 offen lds
s_add_u32 s23,s22,21504
s_mov_b32 m0,s23
s_add_u32 s20,s20,10240
buffer_load_dwordx4 v168,s[16:19],s20 offen lds
s_add_u32 s20,s41,-19
s_cselect_b32 s47,0,30
s_add_u32 s20,s20,s47
s_mul_i32 s20,s20,20480
s_add_u32 s20,s20,s64
s_add_u32 s23,s22,22528
s_mov_b32 m0,s23
s_nop 0
buffer_load_dwordx4 v168,s[16:19],s20 offen lds
s_add_u32 s23,s22,23552
s_mov_b32 m0,s23
s_add_u32 s20,s20,10240
buffer_load_dwordx4 v168,s[16:19],s20 offen lds
s_add_u32 s20,s41,-18
s_cselect_b32 s47,0,30
s_add_u32 s20,s20,s47
s_mul_i32 s20,s20,20480
s_add_u32 s20,s20,s64
s_add_u32 s23,s22,24576
s_mov_b32 m0,s23
s_nop 0
buffer_load_dwordx4 v168,s[16:19],s20 offen lds
s_add_u32 s23,s22,25600
s_mov_b32 m0,s23
s_add_u32 s20,s20,10240
buffer_load_dwordx4 v168,s[16:19],s20 offen lds
s_add_u32 s20,s41,-17
s_cselect_b32 s47,0,30
s_add_u32 s20,s20,s47
s_mul_i32 s20,s20,20480
s_add_u32 s20,s20,s64
s_add_u32 s23,s22,26624
s_mov_b32 m0,s23
s_nop 0
buffer_load_dwordx4 v168,s[16:19],s20 offen lds
s_add_u32 s23,s22,27648
s_mov_b32 m0,s23
s_add_u32 s20,s20,10240
buffer_load_dwordx4 v168,s[16:19],s20 offen lds
s_add_u32 s20,s41,-16
s_cselect_b32 s47,0,30
s_add_u32 s20,s20,s47
s_mul_i32 s20,s20,20480
s_add_u32 s20,s20,s64
s_add_u32 s23,s22,28672
s_mov_b32 m0,s23
s_nop 0
buffer_load_dwordx4 v168,s[16:19],s20 offen lds
s_add_u32 s23,s22,29696
s_mov_b32 m0,s23
s_add_u32 s20,s20,10240
buffer_load_dwordx4 v168,s[16:19],s20 offen lds
s_add_u32 s20,s41,-15
s_cselect_b32 s47,0,30
s_add_u32 s20,s20,s47
s_mul_i32 s20,s20,20480
s_add_u32 s20,s20,s64
s_add_u32 s23,s22,30720
s_mov_b32 m0,s23
s_nop 0
buffer_load_dwordx4 v168,s[16:19],s20 offen lds
s_add_u32 s23,s22,31744
s_mov_b32 m0,s23
s_add_u32 s20,s20,10240
buffer_load_dwordx4 v168,s[16:19],s20 offen lds
s_add_u32 s20,s41,-14
s_cselect_b32 s47,0,30
s_add_u32 s20,s20,s47
s_mul_i32 s20,s20,20480
s_add_u32 s20,s20,s64
s_add_u32 s23,s22,32768
s_mov_b32 m0,s23
s_nop 0
buffer_load_dwordx4 v168,s[16:19],s20 offen lds
s_add_u32 s23,s22,33792
s_mov_b32 m0,s23
s_add_u32 s20,s20,10240
buffer_load_dwordx4 v168,s[16:19],s20 offen lds
s_add_u32 s20,s41,-13
s_cselect_b32 s47,0,30
s_add_u32 s20,s20,s47
s_mul_i32 s20,s20,20480
s_add_u32 s20,s20,s64
s_add_u32 s23,s22,34816
s_mov_b32 m0,s23
s_nop 0
buffer_load_dwordx4 v168,s[16:19],s20 offen lds
s_add_u32 s23,s22,35840
s_mov_b32 m0,s23
s_add_u32 s20,s20,10240
buffer_load_dwordx4 v168,s[16:19],s20 offen lds
s_waitcnt vmcnt(34)
ds_read_b64_tr_b16 a[0:1],v169
ds_read_b64_tr_b16 a[2:3],v169 offset:1024
ds_read_b64_tr_b16 a[120:121],v170
ds_read_b64_tr_b16 a[122:123],v170 offset:1024
s_waitcnt vmcnt(32)
ds_read_b64_tr_b16 a[4:5],v169 offset:2048
ds_read_b64_tr_b16 a[6:7],v169 offset:3072
ds_read_b64_tr_b16 a[124:125],v170 offset:2048
ds_read_b64_tr_b16 a[126:127],v170 offset:3072
s_waitcnt vmcnt(30)
ds_read_b64_tr_b16 a[8:9],v169 offset:4096
ds_read_b64_tr_b16 a[10:11],v169 offset:5120
ds_read_b64_tr_b16 a[128:129],v170 offset:4096
ds_read_b64_tr_b16 a[130:131],v170 offset:5120
s_waitcnt lgkmcnt(8)
s_add_u32 s20,s41,-12
s_cselect_b32 s47,0,30
s_add_u32 s20,s20,s47
s_mul_i32 s20,s20,20480
s_add_u32 s20,s20,s64
s_add_u32 s23,s22,0
s_mov_b32 m0,s23
s_nop 0
buffer_load_dwordx4 v168,s[16:19],s20 offen lds
s_add_u32 s23,s22,1024
s_mov_b32 m0,s23
s_add_u32 s20,s20,10240
buffer_load_dwordx4 v168,s[16:19],s20 offen lds
s_waitcnt vmcnt(30)
ds_read_b64_tr_b16 a[12:13],v169 offset:6144
ds_read_b64_tr_b16 a[14:15],v169 offset:7168
ds_read_b64_tr_b16 a[132:133],v170 offset:6144
ds_read_b64_tr_b16 a[134:135],v170 offset:7168
s_waitcnt lgkmcnt(8)
s_add_u32 s20,s41,-11
s_cselect_b32 s47,0,30
s_add_u32 s20,s20,s47
s_mul_i32 s20,s20,20480
s_add_u32 s20,s20,s64
s_add_u32 s23,s22,2048
s_mov_b32 m0,s23
s_nop 0
buffer_load_dwordx4 v168,s[16:19],s20 offen lds
s_add_u32 s23,s22,3072
s_mov_b32 m0,s23
s_add_u32 s20,s20,10240
buffer_load_dwordx4 v168,s[16:19],s20 offen lds
s_waitcnt vmcnt(30)
ds_read_b64_tr_b16 a[16:17],v169 offset:8192
ds_read_b64_tr_b16 a[18:19],v169 offset:9216
ds_read_b64_tr_b16 a[136:137],v170 offset:8192
ds_read_b64_tr_b16 a[138:139],v170 offset:9216
s_waitcnt lgkmcnt(8)
s_add_u32 s20,s41,-10
s_cselect_b32 s47,0,30
s_add_u32 s20,s20,s47
s_mul_i32 s20,s20,20480
s_add_u32 s20,s20,s64
s_add_u32 s23,s22,4096
s_mov_b32 m0,s23
s_nop 0
buffer_load_dwordx4 v168,s[16:19],s20 offen lds
s_add_u32 s23,s22,5120
s_mov_b32 m0,s23
s_add_u32 s20,s20,10240
buffer_load_dwordx4 v168,s[16:19],s20 offen lds
s_waitcnt vmcnt(30)
ds_read_b64_tr_b16 a[20:21],v169 offset:10240
ds_read_b64_tr_b16 a[22:23],v169 offset:11264
ds_read_b64_tr_b16 a[140:141],v170 offset:10240
ds_read_b64_tr_b16 a[142:143],v170 offset:11264
s_waitcnt lgkmcnt(8)
s_add_u32 s20,s41,-9
s_cselect_b32 s47,0,30
s_add_u32 s20,s20,s47
s_mul_i32 s20,s20,20480
s_add_u32 s20,s20,s64
s_add_u32 s23,s22,6144
s_mov_b32 m0,s23
s_nop 0
buffer_load_dwordx4 v168,s[16:19],s20 offen lds
s_add_u32 s23,s22,7168
s_mov_b32 m0,s23
s_add_u32 s20,s20,10240
buffer_load_dwordx4 v168,s[16:19],s20 offen lds
s_waitcnt vmcnt(30)
ds_read_b64_tr_b16 a[24:25],v169 offset:12288
ds_read_b64_tr_b16 a[26:27],v169 offset:13312
ds_read_b64_tr_b16 a[144:145],v170 offset:12288
ds_read_b64_tr_b16 a[146:147],v170 offset:13312
s_waitcnt lgkmcnt(8)
s_add_u32 s20,s41,-8
s_cselect_b32 s47,0,30
s_add_u32 s20,s20,s47
s_mul_i32 s20,s20,20480
s_add_u32 s20,s20,s64
s_add_u32 s23,s22,8192
s_mov_b32 m0,s23
s_nop 0
buffer_load_dwordx4 v168,s[16:19],s20 offen lds
s_add_u32 s23,s22,9216
s_mov_b32 m0,s23
s_add_u32 s20,s20,10240
buffer_load_dwordx4 v168,s[16:19],s20 offen lds
s_waitcnt vmcnt(30)
ds_read_b64_tr_b16 a[28:29],v169 offset:14336
ds_read_b64_tr_b16 a[30:31],v169 offset:15360
ds_read_b64_tr_b16 a[148:149],v170 offset:14336
ds_read_b64_tr_b16 a[150:151],v170 offset:15360
s_waitcnt lgkmcnt(8)
s_add_u32 s20,s41,-7
s_cselect_b32 s47,0,30
s_add_u32 s20,s20,s47
s_mul_i32 s20,s20,20480
s_add_u32 s20,s20,s64
s_add_u32 s23,s22,10240
s_mov_b32 m0,s23
s_nop 0
buffer_load_dwordx4 v168,s[16:19],s20 offen lds
s_add_u32 s23,s22,11264
s_mov_b32 m0,s23
s_add_u32 s20,s20,10240
buffer_load_dwordx4 v168,s[16:19],s20 offen lds
s_waitcnt vmcnt(30)
ds_read_b64_tr_b16 a[32:33],v169 offset:16384
ds_read_b64_tr_b16 a[34:35],v169 offset:17408
ds_read_b64_tr_b16 a[152:153],v170 offset:16384
ds_read_b64_tr_b16 a[154:155],v170 offset:17408
s_waitcnt lgkmcnt(8)
s_add_u32 s20,s41,-6
s_cselect_b32 s47,0,30
s_add_u32 s20,s20,s47
s_mul_i32 s20,s20,20480
s_add_u32 s20,s20,s64
s_add_u32 s23,s22,12288
s_mov_b32 m0,s23
s_nop 0
buffer_load_dwordx4 v168,s[16:19],s20 offen lds
s_add_u32 s23,s22,13312
s_mov_b32 m0,s23
s_add_u32 s20,s20,10240
buffer_load_dwordx4 v168,s[16:19],s20 offen lds
s_waitcnt vmcnt(30)
ds_read_b64_tr_b16 a[36:37],v169 offset:18432
ds_read_b64_tr_b16 a[38:39],v169 offset:19456
ds_read_b64_tr_b16 a[156:157],v170 offset:18432
ds_read_b64_tr_b16 a[158:159],v170 offset:19456
s_waitcnt lgkmcnt(8)
s_add_u32 s20,s41,-5
s_cselect_b32 s47,0,30
s_add_u32 s20,s20,s47
s_mul_i32 s20,s20,20480
s_add_u32 s20,s20,s64
s_add_u32 s23,s22,14336
s_mov_b32 m0,s23
s_nop 0
buffer_load_dwordx4 v168,s[16:19],s20 offen lds
s_add_u32 s23,s22,15360
s_mov_b32 m0,s23
s_add_u32 s20,s20,10240
buffer_load_dwordx4 v168,s[16:19],s20 offen lds
s_waitcnt vmcnt(30)
ds_read_b64_tr_b16 a[40:41],v169 offset:20480
ds_read_b64_tr_b16 a[42:43],v169 offset:21504
ds_read_b64_tr_b16 a[160:161],v170 offset:20480
ds_read_b64_tr_b16 a[162:163],v170 offset:21504
s_waitcnt lgkmcnt(8)
s_add_u32 s20,s41,-4
s_cselect_b32 s47,0,30
s_add_u32 s20,s20,s47
s_mul_i32 s20,s20,20480
s_add_u32 s20,s20,s64
s_add_u32 s23,s22,16384
s_mov_b32 m0,s23
s_nop 0
buffer_load_dwordx4 v168,s[16:19],s20 offen lds
s_add_u32 s23,s22,17408
s_mov_b32 m0,s23
s_add_u32 s20,s20,10240
buffer_load_dwordx4 v168,s[16:19],s20 offen lds
s_waitcnt vmcnt(30)
ds_read_b64_tr_b16 a[44:45],v169 offset:22528
ds_read_b64_tr_b16 a[46:47],v169 offset:23552
ds_read_b64_tr_b16 a[164:165],v170 offset:22528
ds_read_b64_tr_b16 a[166:167],v170 offset:23552
s_waitcnt lgkmcnt(8)
s_add_u32 s20,s41,-3
s_cselect_b32 s47,0,30
s_add_u32 s20,s20,s47
s_mul_i32 s20,s20,20480
s_add_u32 s20,s20,s64
s_add_u32 s23,s22,18432
s_mov_b32 m0,s23
s_nop 0
buffer_load_dwordx4 v168,s[16:19],s20 offen lds
s_add_u32 s23,s22,19456
s_mov_b32 m0,s23
s_add_u32 s20,s20,10240
buffer_load_dwordx4 v168,s[16:19],s20 offen lds
s_waitcnt vmcnt(30)
ds_read_b64_tr_b16 a[48:49],v169 offset:24576
ds_read_b64_tr_b16 a[50:51],v169 offset:25600
ds_read_b64_tr_b16 a[168:169],v170 offset:24576
ds_read_b64_tr_b16 a[170:171],v170 offset:25600
s_waitcnt lgkmcnt(8)
s_add_u32 s20,s41,-2
s_cselect_b32 s47,0,30
s_add_u32 s20,s20,s47
s_mul_i32 s20,s20,20480
s_add_u32 s20,s20,s64
s_add_u32 s23,s22,20480
s_mov_b32 m0,s23
s_nop 0
buffer_load_dwordx4 v168,s[16:19],s20 offen lds
s_add_u32 s23,s22,21504
s_mov_b32 m0,s23
s_add_u32 s20,s20,10240
buffer_load_dwordx4 v168,s[16:19],s20 offen lds
s_waitcnt vmcnt(30)
ds_read_b64_tr_b16 a[52:53],v169 offset:26624
ds_read_b64_tr_b16 a[54:55],v169 offset:27648
ds_read_b64_tr_b16 a[172:173],v170 offset:26624
ds_read_b64_tr_b16 a[174:175],v170 offset:27648
s_waitcnt lgkmcnt(8)
s_add_u32 s20,s41,-1
s_cselect_b32 s47,0,30
s_add_u32 s20,s20,s47
s_mul_i32 s20,s20,20480
s_add_u32 s20,s20,s64
s_add_u32 s23,s22,22528
s_mov_b32 m0,s23
s_nop 0
buffer_load_dwordx4 v168,s[16:19],s20 offen lds
s_add_u32 s23,s22,23552
s_mov_b32 m0,s23
s_add_u32 s20,s20,10240
buffer_load_dwordx4 v168,s[16:19],s20 offen lds
s_waitcnt vmcnt(30)
ds_read_b64_tr_b16 a[56:57],v169 offset:28672
ds_read_b64_tr_b16 a[58:59],v169 offset:29696
ds_read_b64_tr_b16 a[176:177],v170 offset:28672
ds_read_b64_tr_b16 a[178:179],v170 offset:29696
s_waitcnt vmcnt(28)
ds_read_b64_tr_b16 a[60:61],v169 offset:30720
ds_read_b64_tr_b16 a[62:63],v169 offset:31744
ds_read_b64_tr_b16 a[180:181],v170 offset:30720
ds_read_b64_tr_b16 a[182:183],v170 offset:31744
s_waitcnt vmcnt(26)
ds_read_b64_tr_b16 a[64:65],v169 offset:32768
ds_read_b64_tr_b16 a[66:67],v169 offset:33792
ds_read_b64_tr_b16 a[184:185],v170 offset:32768
ds_read_b64_tr_b16 a[186:187],v170 offset:33792
s_waitcnt vmcnt(24)
ds_read_b64_tr_b16 a[68:69],v169 offset:34816
ds_read_b64_tr_b16 a[70:71],v169 offset:35840
ds_read_b64_tr_b16 a[188:189],v170 offset:34816
ds_read_b64_tr_b16 a[190:191],v170 offset:35840
s_waitcnt vmcnt(22)
ds_read_b64_tr_b16 a[72:73],v169
ds_read_b64_tr_b16 a[74:75],v169 offset:1024
ds_read_b64_tr_b16 a[192:193],v170
ds_read_b64_tr_b16 a[194:195],v170 offset:1024
s_waitcnt vmcnt(20)
ds_read_b64_tr_b16 a[76:77],v169 offset:2048
ds_read_b64_tr_b16 a[78:79],v169 offset:3072
ds_read_b64_tr_b16 a[196:197],v170 offset:2048
ds_read_b64_tr_b16 a[198:199],v170 offset:3072
s_waitcnt vmcnt(18)
ds_read_b64_tr_b16 a[80:81],v169 offset:4096
ds_read_b64_tr_b16 a[82:83],v169 offset:5120
ds_read_b64_tr_b16 a[200:201],v170 offset:4096
ds_read_b64_tr_b16 a[202:203],v170 offset:5120
s_waitcnt vmcnt(16)
ds_read_b64_tr_b16 a[84:85],v169 offset:6144
ds_read_b64_tr_b16 a[86:87],v169 offset:7168
ds_read_b64_tr_b16 a[204:205],v170 offset:6144
ds_read_b64_tr_b16 a[206:207],v170 offset:7168
s_waitcnt vmcnt(14)
ds_read_b64_tr_b16 a[88:89],v169 offset:8192
ds_read_b64_tr_b16 a[90:91],v169 offset:9216
ds_read_b64_tr_b16 a[208:209],v170 offset:8192
ds_read_b64_tr_b16 a[210:211],v170 offset:9216
s_waitcnt vmcnt(12)
ds_read_b64_tr_b16 a[92:93],v169 offset:10240
ds_read_b64_tr_b16 a[94:95],v169 offset:11264
ds_read_b64_tr_b16 a[212:213],v170 offset:10240
ds_read_b64_tr_b16 a[214:215],v170 offset:11264
s_waitcnt vmcnt(10)
ds_read_b64_tr_b16 a[96:97],v169 offset:12288
ds_read_b64_tr_b16 a[98:99],v169 offset:13312
ds_read_b64_tr_b16 a[216:217],v170 offset:12288
ds_read_b64_tr_b16 a[218:219],v170 offset:13312
s_waitcnt vmcnt(8)
ds_read_b64_tr_b16 a[100:101],v169 offset:14336
ds_read_b64_tr_b16 a[102:103],v169 offset:15360
ds_read_b64_tr_b16 a[220:221],v170 offset:14336
ds_read_b64_tr_b16 a[222:223],v170 offset:15360
s_waitcnt vmcnt(6)
ds_read_b64_tr_b16 a[104:105],v169 offset:16384
ds_read_b64_tr_b16 a[106:107],v169 offset:17408
ds_read_b64_tr_b16 a[224:225],v170 offset:16384
ds_read_b64_tr_b16 a[226:227],v170 offset:17408
s_waitcnt vmcnt(4)
ds_read_b64_tr_b16 a[108:109],v169 offset:18432
ds_read_b64_tr_b16 a[110:111],v169 offset:19456
ds_read_b64_tr_b16 a[228:229],v170 offset:18432
ds_read_b64_tr_b16 a[230:231],v170 offset:19456
s_waitcnt vmcnt(2)
ds_read_b64_tr_b16 a[112:113],v169 offset:20480
ds_read_b64_tr_b16 a[114:115],v169 offset:21504
ds_read_b64_tr_b16 a[232:233],v170 offset:20480
ds_read_b64_tr_b16 a[234:235],v170 offset:21504
s_waitcnt vmcnt(0)
ds_read_b64_tr_b16 a[116:117],v169 offset:22528
ds_read_b64_tr_b16 a[118:119],v169 offset:23552
ds_read_b64_tr_b16 a[236:237],v170 offset:22528
ds_read_b64_tr_b16 a[238:239],v170 offset:23552
s_waitcnt lgkmcnt(0)
s_barrier
s_lshl_b32 s41,s41,10
s_lshr_b32 s20,s2,5
v_and_b32 v169,7,v0
v_min_u32 v168,1,v169
v_lshl_add_u32 v169,v168,3,v169
v_lshlrev_b32 v169,4,v169
s_mov_b32 s38,0
s_nop 0
reg_217:
buffer_load_dword v168,v169,s[12:15],0 offen sc1
s_waitcnt vmcnt(0)
v_readlane_b32 s50,v168,0
v_readlane_b32 s51,v168,1
v_readlane_b32 s52,v168,2
v_readlane_b32 s53,v168,3
v_readlane_b32 s54,v168,4
v_readlane_b32 s55,v168,5
v_readlane_b32 s56,v168,6
v_readlane_b32 s57,v168,7
v_readlane_b32 s58,v168,s20
s_nop 0
s_cmp_ge_u32 s58,32
s_nop 1
s_cbranch_scc1 regd_218
s_add_u32 s59,s50,s51
s_add_u32 s59,s59,s52
s_add_u32 s59,s59,s53
s_add_u32 s59,s59,s54
s_add_u32 s59,s59,s55
s_add_u32 s59,s59,s56
s_add_u32 s59,s59,s57
s_cmp_ge_u32 s59,256
s_cbranch_scc1 regd_218
s_sleep 2
s_add_u32 s38,s38,1
s_cmp_lt_u32 s38,100000
s_cbranch_scc1 reg_217
s_mov_b32 s40,15
s_branch L_fail
regd_218:
s_cmp_ge_u32 s58,32
s_cselect_b32 s21,1,0
v_mov_b32 v168,72
s_mov_b32 s99,128
s_mov_b32 s38,0
poll_219:
buffer_load_dword v169,v168,s[12:15],0 offen sc1
s_waitcnt vmcnt(0)
v_cmp_le_u32 vcc,s99,v169
s_nop 0
s_cmp_eq_u64 vcc,-1
s_nop 1
s_cbranch_scc1 polld_220
s_sleep 8
s_add_u32 s38,s38,1
s_cmp_lt_u32 s38,100000
s_cbranch_scc1 poll_219
s_mov_b32 s40,14
s_branch L_fail
polld_220:
v_readfirstlane_b32 s99,v169
s_nop 0
s_and_b32 s99,s99,1
s_lshl_b32 s99,s99,13
s_mul_i32 s32,s39,0x1000000
s_add_u32 s32,s32,0x5ab0000
s_lshl_b32 s46,s45,10
s_add_u32 s32,s32,s46
s_mul_i32 s46,s39,0x48000
s_add_u32 s46,s46,0x28000
s_lshl_b32 s101,s39,13
s_xor_b32 s101,s101,s99
s_xor_b32 s101,s101,8192
s_add_u32 s46,s46,s101
s_lshr_b32 s47,s45,3
v_add_u32 v2,s47,v0
s_add_u32 s47,s45,29
s_lshr_b32 s47,s47,3
v_min_u32 v2,s47,v2
v_lshlrev_b32 v2,7,v2
v_add_u32 v2,s46,v2
s_mul_i32 s46,s39,0x48000
s_add_u32 s46,s46,0x38000
s_lshl_b32 s101,s39,13
s_xor_b32 s101,s101,s99
s_xor_b32 s101,s101,8192
s_add_u32 s46,s46,s101
s_lshl_b32 s47,s43,7
s_add_u32 s46,s46,s47
v_and_b32 v12,1,v0
v_lshlrev_b32 v12,7,v12
v_add_u32 v12,s46,v12
v_cmp_lt_u32 vcc,31,v0
s_cmp_eq_u32 s44,0
s_cselect_b64 vcc,0,vcc
v_cndmask_b32 v2,v2,v12,vcc
v_cndmask_b32 v3,0,8,vcc
s_not_b64 s[22:23],vcc
s_lshl_b32 s60,s49,11
s_mul_i32 s33,s39,0x300000
s_add_u32 s33,s33,0x3500000
s_add_u32 s33,s33,s60
s_mul_i32 s36,s39,0x300000
s_add_u32 s36,s36,0x3b00000
s_mul_i32 s34,s39,0xa0000
s_add_u32 s34,s34,0x1c0000
s_lshl_b32 s46,s49,12
s_add_u32 s34,s34,s46
s_mul_i32 s37,s39,0x48000
s_add_u32 s37,s37,0x38000
s_lshl_b32 s101,s39,13
s_xor_b32 s101,s101,s99
s_xor_b32 s101,s101,8192
s_add_u32 s37,s37,s101
s_lshl_b32 s61,s49,7
s_add_u32 s37,s37,s61
s_lshl_b32 s61,s49,8
s_add_u32 s63,s36,s61
s_add_u32 s63,s63,40960
s_add_u32 s36,s36,s60
v_and_b32 v10,31,v0
v_lshlrev_b32 v10,3,v10
s_cmp_eq_u32 s44,0
s_cselect_b32 s26,s6,0
s_add_u32 s32,s32,s41
s_sub_u32 s65,s32,30720
s_lshl_b32 s46,s48,14
v_add_u32 v9,s46,v1
s_lshl_b32 s46,s3,12
v_add_u32 v8,s46,v9
s_mov_b32 s58,s60
s_waitcnt vmcnt(0) lgkmcnt(0)
s_getpc_b64 s[60:61]
pc_223:
s_add_u32 s60,s60,ks_top_221-pc_223
s_addc_u32 s61,s61,0
s_mov_b32 s59,ks_fin_222-ks_top_221-4
v_lshlrev_b32 v170,7,v0
v_add_u32 v170,0,v170
v_min_u32 v170,s59,v170
v_mov_b32 v169,s61
v_add_co_u32 v168,vcc,s60,v170
s_nop 1
v_addc_co_u32 v169,vcc,0,v169,vcc
global_load_dword v171,v[168:169],off
s_waitcnt vmcnt(0)
s_mov_b32 s28,0
s_mov_b32 s31,1
s_mov_b32 s30,0
s_mov_b32 s67,64
s_mov_b32 s38,0
poll_224:
buffer_load_dwordx2 v[6:7],v2,s[4:7],0 offen sc1
s_waitcnt vmcnt(0)
s_bitcmp0_b32 s31,0
s_cselect_b64 vcc,s[22:23],0
v_cndmask_b32 v4,v6,v7,vcc
v_add_u32 v4,v3,v4
v_cmp_le_u32 vcc,s31,v4
s_nop 0
s_cmp_eq_u64 vcc,-1
s_nop 1
s_cbranch_scc1 polld_225
s_sleep 2
s_add_u32 s38,s38,1
s_cmp_lt_u32 s38,100000
s_cbranch_scc1 poll_224
s_mov_b32 s40,11
s_branch L_fail
polld_225:
buffer_load_dwordx4 v[168:171],v1,s[24:27],s33 offen sc1
buffer_load_dwordx4 v[172:175],v1,s[24:27],s33 offen offset:1024 sc1
s_cmp_lt_u32 s41,30720
s_cselect_b32 s46,s32,s65
s_add_u32 s46,s46,0
buffer_load_dwordx4 v[48:51],v1,s[4:7],s46 offen sc1
s_cmp_lt_u32 s41,29696
s_cselect_b32 s46,s32,s65
s_add_u32 s46,s46,0
buffer_load_dwordx4 v[52:55],v1,s[4:7],s46 offen offset:1024 sc1
s_cmp_lt_u32 s41,28672
s_cselect_b32 s46,s32,s65
s_add_u32 s46,s46,0
buffer_load_dwordx4 v[56:59],v1,s[4:7],s46 offen offset:2048 sc1
s_cmp_lt_u32 s41,27648
s_cselect_b32 s46,s32,s65
s_add_u32 s46,s46,0
buffer_load_dwordx4 v[60:63],v1,s[4:7],s46 offen offset:3072 sc1
s_cmp_lt_u32 s41,26624
s_cselect_b32 s46,s32,s65
s_add_u32 s46,s46,4096
buffer_load_dwordx4 v[64:67],v1,s[4:7],s46 offen sc1
s_cmp_lt_u32 s41,25600
s_cselect_b32 s46,s32,s65
s_add_u32 s46,s46,4096
buffer_load_dwordx4 v[68:71],v1,s[4:7],s46 offen offset:1024 sc1
s_cmp_lt_u32 s41,24576
s_cselect_b32 s46,s32,s65
s_add_u32 s46,s46,4096
buffer_load_dwordx4 v[72:75],v1,s[4:7],s46 offen offset:2048 sc1
s_cmp_lt_u32 s41,23552
s_cselect_b32 s46,s32,s65
s_add_u32 s46,s46,4096
buffer_load_dwordx4 v[76:79],v1,s[4:7],s46 offen offset:3072 sc1
s_cmp_lt_u32 s41,22528
s_cselect_b32 s46,s32,s65
s_add_u32 s46,s46,8192
buffer_load_dwordx4 v[80:83],v1,s[4:7],s46 offen sc1
s_cmp_lt_u32 s41,21504
s_cselect_b32 s46,s32,s65
s_add_u32 s46,s46,8192
buffer_load_dwordx4 v[84:87],v1,s[4:7],s46 offen offset:1024 sc1
s_cmp_lt_u32 s41,20480
s_cselect_b32 s46,s32,s65
s_add_u32 s46,s46,8192
buffer_load_dwordx4 v[88:91],v1,s[4:7],s46 offen offset:2048 sc1
s_cmp_lt_u32 s41,19456
s_cselect_b32 s46,s32,s65
s_add_u32 s46,s46,8192
buffer_load_dwordx4 v[92:95],v1,s[4:7],s46 offen offset:3072 sc1
s_cmp_lt_u32 s41,18432
s_cselect_b32 s46,s32,s65
s_add_u32 s46,s46,12288
buffer_load_dwordx4 v[96:99],v1,s[4:7],s46 offen sc1
s_cmp_lt_u32 s41,17408
s_cselect_b32 s46,s32,s65
s_add_u32 s46,s46,12288
buffer_load_dwordx4 v[100:103],v1,s[4:7],s46 offen offset:1024 sc1
s_cmp_lt_u32 s41,16384
s_cselect_b32 s46,s32,s65
s_add_u32 s46,s46,12288
buffer_load_dwordx4 v[104:107],v1,s[4:7],s46 offen offset:2048 sc1
s_cmp_lt_u32 s41,15360
s_cselect_b32 s46,s32,s65
s_add_u32 s46,s46,12288
buffer_load_dwordx4 v[108:111],v1,s[4:7],s46 offen offset:3072 sc1
ks_top_221:
s_cmp_ge_u32 s28,s67
s_cbranch_scc1 L_end
s_add_u32 s31,s28,2
s_mov_b32 s29,0
s_and_b32 s68,s28,7
s_mul_i32 s68,s68,81920
s_add_u32 s68,s68,s34
s_bfe_u32 s66,s28,0x10003
s_bitcmp0_b32 s31,0
s_cselect_b64 vcc,s[22:23],0
v_cndmask_b32 v4,v6,v7,vcc
v_add_u32 v4,v3,v4
v_cmp_le_u32 vcc,s31,v4
s_nop 0
s_cmp_eq_u64 vcc,-1
s_cselect_b32 s35,1,0
s_waitcnt vmcnt(15)
v_mfma_f32_32x32x16_bf16 v[16:31],a[0:3],v[48:51],0
s_cmp_lt_u32 s41,14336
s_cselect_b32 s46,s32,s65
s_add_u32 s46,s46,16384
buffer_load_dwordx4 v[112:115],v1,s[4:7],s46 offen sc1
v_mfma_f32_32x32x16_bf16 v[32:47],a[120:123],v[48:51],0
s_waitcnt vmcnt(15)
v_mfma_f32_32x32x16_bf16 v[16:31],a[4:7],v[52:55],v[16:31]
s_cmp_lt_u32 s41,13312
s_cselect_b32 s46,s32,s65
s_add_u32 s46,s46,16384
buffer_load_dwordx4 v[116:119],v1,s[4:7],s46 offen offset:1024 sc1
v_mfma_f32_32x32x16_bf16 v[32:47],a[124:127],v[52:55],v[32:47]
s_waitcnt vmcnt(15)
v_mfma_f32_32x32x16_bf16 v[16:31],a[8:11],v[56:59],v[16:31]
s_cmp_lt_u32 s41,12288
s_cselect_b32 s46,s32,s65
s_add_u32 s46,s46,16384
buffer_load_dwordx4 v[120:123],v1,s[4:7],s46 offen offset:2048 sc1
v_mfma_f32_32x32x16_bf16 v[32:47],a[128:131],v[56:59],v[32:47]
s_waitcnt vmcnt(15)
v_mfma_f32_32x32x16_bf16 v[16:31],a[12:15],v[60:63],v[16:31]
s_cmp_lt_u32 s41,11264
s_cselect_b32 s46,s32,s65
s_add_u32 s46,s46,16384
buffer_load_dwordx4 v[124:127],v1,s[4:7],s46 offen offset:3072 sc1
v_mfma_f32_32x32x16_bf16 v[32:47],a[132:135],v[60:63],v[32:47]
s_cmp_lg_u32 s35,0
s_cbranch_scc1 ks_cp_228
buffer_load_dwordx2 v[6:7],v2,s[4:7],0 offen sc1
ks_cp_228:
buffer_load_dwordx4 v[168:171],v1,s[24:27],s33 offen sc1
buffer_load_dwordx4 v[172:175],v1,s[24:27],s33 offen offset:1024 sc1
s_waitcnt vmcnt(15)
v_mfma_f32_32x32x16_bf16 v[16:31],a[16:19],v[64:67],v[16:31]
s_cmp_lt_u32 s41,10240
s_cselect_b32 s46,s32,s65
s_add_u32 s46,s46,20480
buffer_load_dwordx4 v[128:131],v1,s[4:7],s46 offen sc1
v_mfma_f32_32x32x16_bf16 v[32:47],a[136:139],v[64:67],v[32:47]
s_waitcnt vmcnt(15)
v_mfma_f32_32x32x16_bf16 v[16:31],a[20:23],v[68:71],v[16:31]
s_cmp_lt_u32 s41,9216
s_cselect_b32 s46,s32,s65
s_add_u32 s46,s46,20480
buffer_load_dwordx4 v[132:135],v1,s[4:7],s46 offen offset:1024 sc1
v_mfma_f32_32x32x16_bf16 v[32:47],a[140:143],v[68:71],v[32:47]
s_waitcnt vmcnt(15)
v_mfma_f32_32x32x16_bf16 v[16:31],a[24:27],v[72:75],v[16:31]
s_cmp_lt_u32 s41,8192
s_cselect_b32 s46,s32,s65
s_add_u32 s46,s46,20480
buffer_load_dwordx4 v[136:139],v1,s[4:7],s46 offen offset:2048 sc1
v_mfma_f32_32x32x16_bf16 v[32:47],a[144:147],v[72:75],v[32:47]
s_waitcnt vmcnt(15)
v_mfma_f32_32x32x16_bf16 v[16:31],a[28:31],v[76:79],v[16:31]
s_cmp_lt_u32 s41,7168
s_cselect_b32 s46,s32,s65
s_add_u32 s46,s46,20480
buffer_load_dwordx4 v[140:143],v1,s[4:7],s46 offen offset:3072 sc1
v_mfma_f32_32x32x16_bf16 v[32:47],a[148:151],v[76:79],v[32:47]
s_waitcnt vmcnt(15)
v_mfma_f32_32x32x16_bf16 v[16:31],a[32:35],v[80:83],v[16:31]
s_cmp_lt_u32 s41,6144
s_cselect_b32 s46,s32,s65
s_add_u32 s46,s46,24576
buffer_load_dwordx4 v[144:147],v1,s[4:7],s46 offen sc1
v_mfma_f32_32x32x16_bf16 v[32:47],a[152:155],v[80:83],v[32:47]
s_cmp_eq_u32 s30,0
s_cbranch_scc1 ks_np_229
s_waitcnt vmcnt(13)
v_mov_b32 v14,s28
s_mov_b64 exec,1
buffer_store_dword v14,off,s[4:7],s37 sc1
s_mov_b64 exec,-1
s_mov_b32 s30,0
ks_np_229:
s_waitcnt vmcnt(15)
v_mfma_f32_32x32x16_bf16 v[16:31],a[36:39],v[84:87],v[16:31]
s_cmp_lt_u32 s41,5120
s_cselect_b32 s46,s32,s65
s_add_u32 s46,s46,24576
buffer_load_dwordx4 v[148:151],v1,s[4:7],s46 offen offset:1024 sc1
v_mfma_f32_32x32x16_bf16 v[32:47],a[156:159],v[84:87],v[32:47]
s_waitcnt vmcnt(15)
v_mfma_f32_32x32x16_bf16 v[16:31],a[40:43],v[88:91],v[16:31]
s_cmp_lt_u32 s41,4096
s_cselect_b32 s46,s32,s65
s_add_u32 s46,s46,24576
buffer_load_dwordx4 v[152:155],v1,s[4:7],s46 offen offset:2048 sc1
v_mfma_f32_32x32x16_bf16 v[32:47],a[160:163],v[88:91],v[32:47]
s_waitcnt vmcnt(15)
v_mfma_f32_32x32x16_bf16 v[16:31],a[44:47],v[92:95],v[16:31]
s_cmp_lt_u32 s41,3072
s_cselect_b32 s46,s32,s65
s_add_u32 s46,s46,24576
buffer_load_dwordx4 v[156:159],v1,s[4:7],s46 offen offset:3072 sc1
v_mfma_f32_32x32x16_bf16 v[32:47],a[164:167],v[92:95],v[32:47]
s_waitcnt vmcnt(15)
v_mfma_f32_32x32x16_bf16 v[16:31],a[48:51],v[96:99],v[16:31]
s_cmp_lt_u32 s41,2048
s_cselect_b32 s46,s32,s65
s_add_u32 s46,s46,28672
buffer_load_dwordx4 v[160:163],v1,s[4:7],s46 offen sc1
v_mfma_f32_32x32x16_bf16 v[32:47],a[168:171],v[96:99],v[32:47]
s_waitcnt vmcnt(15)
v_mfma_f32_32x32x16_bf16 v[16:31],a[52:55],v[100:103],v[16:31]
s_cmp_lt_u32 s41,1024
s_cselect_b32 s46,s32,s65
s_add_u32 s46,s46,28672
buffer_load_dwordx4 v[164:167],v1,s[4:7],s46 offen offset:1024 sc1
v_mfma_f32_32x32x16_bf16 v[32:47],a[172:175],v[100:103],v[32:47]
s_waitcnt vmcnt(12)
s_bitcmp0_b32 s31,0
s_cselect_b64 vcc,s[22:23],0
v_cndmask_b32 v4,v6,v7,vcc
v_add_u32 v4,v3,v4
v_cmp_le_u32 vcc,s31,v4
s_nop 0
s_cmp_eq_u64 vcc,-1
s_cbranch_scc0 ks_n_226
s_mov_b32 s29,1
buffer_load_dwordx4 v[184:187],v1,s[24:27],s68 offen sc1
buffer_load_dwordx4 v[188:191],v1,s[24:27],s68 offen offset:1024 sc1
buffer_load_dwordx4 v[192:195],v1,s[24:27],s68 offen offset:2048 sc1
buffer_load_dwordx4 v[196:199],v1,s[24:27],s68 offen offset:3072 sc1
s_waitcnt vmcnt(15)
v_mfma_f32_32x32x16_bf16 v[16:31],a[56:59],v[104:107],v[16:31]
s_cmp_lt_u32 s41,30720
s_cselect_b32 s46,s32,s65
s_add_u32 s46,s46,262144
buffer_load_dwordx4 v[48:51],v1,s[4:7],s46 offen sc1
v_mfma_f32_32x32x16_bf16 v[32:47],a[176:179],v[104:107],v[32:47]
s_waitcnt vmcnt(15)
v_mfma_f32_32x32x16_bf16 v[16:31],a[60:63],v[108:111],v[16:31]
s_cmp_lt_u32 s41,29696
s_cselect_b32 s46,s32,s65
s_add_u32 s46,s46,262144
buffer_load_dwordx4 v[52:55],v1,s[4:7],s46 offen offset:1024 sc1
v_mfma_f32_32x32x16_bf16 v[32:47],a[180:183],v[108:111],v[32:47]
s_waitcnt vmcnt(15)
v_mfma_f32_32x32x16_bf16 v[16:31],a[64:67],v[112:115],v[16:31]
s_cmp_lt_u32 s41,28672
s_cselect_b32 s46,s32,s65
s_add_u32 s46,s46,262144
buffer_load_dwordx4 v[56:59],v1,s[4:7],s46 offen offset:2048 sc1
v_mfma_f32_32x32x16_bf16 v[32:47],a[184:187],v[112:115],v[32:47]
s_waitcnt vmcnt(15)
v_mfma_f32_32x32x16_bf16 v[16:31],a[68:71],v[116:119],v[16:31]
s_cmp_lt_u32 s41,27648
s_cselect_b32 s46,s32,s65
s_add_u32 s46,s46,262144
buffer_load_dwordx4 v[60:63],v1,s[4:7],s46 offen offset:3072 sc1
v_mfma_f32_32x32x16_bf16 v[32:47],a[188:191],v[116:119],v[32:47]
s_waitcnt vmcnt(15)
v_mfma_f32_32x32x16_bf16 v[16:31],a[72:75],v[120:123],v[16:31]
s_cmp_lt_u32 s41,26624
s_cselect_b32 s46,s32,s65
s_add_u32 s46,s46,266240
buffer_load_dwordx4 v[64:67],v1,s[4:7],s46 offen sc1
v_mfma_f32_32x32x16_bf16 v[32:47],a[192:195],v[120:123],v[32:47]
s_waitcnt vmcnt(15)
v_mfma_f32_32x32x16_bf16 v[16:31],a[76:79],v[124:127],v[16:31]
s_cmp_lt_u32 s41,25600
s_cselect_b32 s46,s32,s65
s_add_u32 s46,s46,266240
buffer_load_dwordx4 v[68:71],v1,s[4:7],s46 offen offset:1024 sc1
v_mfma_f32_32x32x16_bf16 v[32:47],a[196:199],v[124:127],v[32:47]
s_waitcnt vmcnt(15)
v_mfma_f32_32x32x16_bf16 v[16:31],a[80:83],v[128:131],v[16:31]
s_cmp_lt_u32 s41,24576
s_cselect_b32 s46,s32,s65
s_add_u32 s46,s46,266240
buffer_load_dwordx4 v[72:75],v1,s[4:7],s46 offen offset:2048 sc1
v_lshlrev_b32 v200,16,v168
v_mfma_f32_32x32x16_bf16 v[32:47],a[200:203],v[128:131],v[32:47]
v_and_b32 v201,0xffff0000,v168
v_lshlrev_b32 v202,16,v169
v_and_b32 v203,0xffff0000,v169
v_lshlrev_b32 v204,16,v170
s_waitcnt vmcnt(15)
v_mfma_f32_32x32x16_bf16 v[16:31],a[84:87],v[132:135],v[16:31]
s_cmp_lt_u32 s41,23552
s_cselect_b32 s46,s32,s65
s_add_u32 s46,s46,266240
buffer_load_dwordx4 v[76:79],v1,s[4:7],s46 offen offset:3072 sc1
v_and_b32 v205,0xffff0000,v170
v_mfma_f32_32x32x16_bf16 v[32:47],a[204:207],v[132:135],v[32:47]
v_lshlrev_b32 v206,16,v171
v_and_b32 v207,0xffff0000,v171
v_lshlrev_b32 v208,16,v172
v_and_b32 v209,0xffff0000,v172
s_waitcnt vmcnt(15)
v_mfma_f32_32x32x16_bf16 v[16:31],a[88:91],v[136:139],v[16:31]
s_cmp_lt_u32 s41,22528
s_cselect_b32 s46,s32,s65
s_add_u32 s46,s46,270336
buffer_load_dwordx4 v[80:83],v1,s[4:7],s46 offen sc1
v_lshlrev_b32 v210,16,v173
v_mfma_f32_32x32x16_bf16 v[32:47],a[208:211],v[136:139],v[32:47]
v_and_b32 v211,0xffff0000,v173
v_lshlrev_b32 v212,16,v174
v_and_b32 v213,0xffff0000,v174
v_lshlrev_b32 v214,16,v175
s_waitcnt vmcnt(15)
v_mfma_f32_32x32x16_bf16 v[16:31],a[92:95],v[140:143],v[16:31]
s_cmp_lt_u32 s41,21504
s_cselect_b32 s46,s32,s65
s_add_u32 s46,s46,270336
buffer_load_dwordx4 v[84:87],v1,s[4:7],s46 offen offset:1024 sc1
v_and_b32 v215,0xffff0000,v175
v_mfma_f32_32x32x16_bf16 v[32:47],a[212:215],v[140:143],v[32:47]
s_waitcnt vmcnt(15)
v_mfma_f32_32x32x16_bf16 v[16:31],a[96:99],v[144:147],v[16:31]
s_cmp_lt_u32 s41,20480
s_cselect_b32 s46,s32,s65
s_add_u32 s46,s46,270336
buffer_load_dwordx4 v[88:91],v1,s[4:7],s46 offen offset:2048 sc1
v_mfma_f32_32x32x16_bf16 v[32:47],a[216:219],v[144:147],v[32:47]
s_waitcnt vmcnt(15)
v_mfma_f32_32x32x16_bf16 v[16:31],a[100:103],v[148:151],v[16:31]
s_cmp_lt_u32 s41,19456
s_cselect_b32 s46,s32,s65
s_add_u32 s46,s46,270336
buffer_load_dwordx4 v[92:95],v1,s[4:7],s46 offen offset:3072 sc1
v_mfma_f32_32x32x16_bf16 v[32:47],a[220:223],v[148:151],v[32:47]
s_waitcnt vmcnt(15)
v_mfma_f32_32x32x16_bf16 v[16:31],a[104:107],v[152:155],v[16:31]
s_cmp_lt_u32 s41,18432
s_cselect_b32 s46,s32,s65
s_add_u32 s46,s46,274432
buffer_load_dwordx4 v[96:99],v1,s[4:7],s46 offen sc1
v_mfma_f32_32x32x16_bf16 v[32:47],a[224:227],v[152:155],v[32:47]
s_waitcnt vmcnt(15)
v_mfma_f32_32x32x16_bf16 v[16:31],a[108:111],v[156:159],v[16:31]
s_cmp_lt_u32 s41,17408
s_cselect_b32 s46,s32,s65
s_add_u32 s46,s46,274432
buffer_load_dwordx4 v[100:103],v1,s[4:7],s46 offen offset:1024 sc1
v_mfma_f32_32x32x16_bf16 v[32:47],a[228:231],v[156:159],v[32:47]
s_waitcnt vmcnt(15)
v_mfma_f32_32x32x16_bf16 v[16:31],a[112:115],v[160:163],v[16:31]
s_cmp_lt_u32 s41,16384
s_cselect_b32 s46,s32,s65
s_add_u32 s46,s46,274432
buffer_load_dwordx4 v[104:107],v1,s[4:7],s46 offen offset:2048 sc1
v_mfma_f32_32x32x16_bf16 v[32:47],a[232:235],v[160:163],v[32:47]
s_waitcnt vmcnt(15)
v_mfma_f32_32x32x16_bf16 v[32:47],a[236:239],v[164:167],v[32:47]
v_mfma_f32_32x32x16_bf16 v[16:31],a[116:119],v[164:167],v[16:31]
s_cmp_lt_u32 s41,15360
s_cselect_b32 s46,s32,s65
s_add_u32 s46,s46,274432
buffer_load_dwordx4 v[108:111],v1,s[4:7],s46 offen offset:3072 sc1
s_branch ks_j_227
ks_n_226:
s_waitcnt vmcnt(15)
v_mfma_f32_32x32x16_bf16 v[16:31],a[56:59],v[104:107],v[16:31]
v_mfma_f32_32x32x16_bf16 v[32:47],a[176:179],v[104:107],v[32:47]
s_waitcnt vmcnt(14)
v_mfma_f32_32x32x16_bf16 v[16:31],a[60:63],v[108:111],v[16:31]
v_mfma_f32_32x32x16_bf16 v[32:47],a[180:183],v[108:111],v[32:47]
s_waitcnt vmcnt(13)
v_mfma_f32_32x32x16_bf16 v[16:31],a[64:67],v[112:115],v[16:31]
v_mfma_f32_32x32x16_bf16 v[32:47],a[184:187],v[112:115],v[32:47]
s_waitcnt vmcnt(12)
v_mfma_f32_32x32x16_bf16 v[16:31],a[68:71],v[116:119],v[16:31]
v_mfma_f32_32x32x16_bf16 v[32:47],a[188:191],v[116:119],v[32:47]
s_waitcnt vmcnt(11)
v_mfma_f32_32x32x16_bf16 v[16:31],a[72:75],v[120:123],v[16:31]
v_mfma_f32_32x32x16_bf16 v[32:47],a[192:195],v[120:123],v[32:47]
s_waitcnt vmcnt(10)
v_mfma_f32_32x32x16_bf16 v[16:31],a[76:79],v[124:127],v[16:31]
v_mfma_f32_32x32x16_bf16 v[32:47],a[196:199],v[124:127],v[32:47]
s_waitcnt vmcnt(9)
v_mfma_f32_32x32x16_bf16 v[16:31],a[80:83],v[128:131],v[16:31]
v_lshlrev_b32 v200,16,v168
v_and_b32 v201,0xffff0000,v168
v_lshlrev_b32 v202,16,v169
v_and_b32 v203,0xffff0000,v169
v_mfma_f32_32x32x16_bf16 v[32:47],a[200:203],v[128:131],v[32:47]
v_lshlrev_b32 v204,16,v170
v_and_b32 v205,0xffff0000,v170
v_lshlrev_b32 v206,16,v171
v_and_b32 v207,0xffff0000,v171
s_waitcnt vmcnt(8)
v_mfma_f32_32x32x16_bf16 v[16:31],a[84:87],v[132:135],v[16:31]
v_lshlrev_b32 v208,16,v172
v_and_b32 v209,0xffff0000,v172
v_lshlrev_b32 v210,16,v173
v_and_b32 v211,0xffff0000,v173
v_mfma_f32_32x32x16_bf16 v[32:47],a[204:207],v[132:135],v[32:47]
v_lshlrev_b32 v212,16,v174
v_and_b32 v213,0xffff0000,v174
v_lshlrev_b32 v214,16,v175
v_and_b32 v215,0xffff0000,v175
s_waitcnt vmcnt(7)
v_mfma_f32_32x32x16_bf16 v[16:31],a[88:91],v[136:139],v[16:31]
v_mfma_f32_32x32x16_bf16 v[32:47],a[208:211],v[136:139],v[32:47]
s_waitcnt vmcnt(6)
v_mfma_f32_32x32x16_bf16 v[16:31],a[92:95],v[140:143],v[16:31]
v_mfma_f32_32x32x16_bf16 v[32:47],a[212:215],v[140:143],v[32:47]
s_waitcnt vmcnt(5)
v_mfma_f32_32x32x16_bf16 v[16:31],a[96:99],v[144:147],v[16:31]
v_mfma_f32_32x32x16_bf16 v[32:47],a[216:219],v[144:147],v[32:47]
s_waitcnt vmcnt(4)
v_mfma_f32_32x32x16_bf16 v[16:31],a[100:103],v[148:151],v[16:31]
v_mfma_f32_32x32x16_bf16 v[32:47],a[220:223],v[148:151],v[32:47]
s_waitcnt vmcnt(3)
v_mfma_f32_32x32x16_bf16 v[16:31],a[104:107],v[152:155],v[16:31]
v_mfma_f32_32x32x16_bf16 v[32:47],a[224:227],v[152:155],v[32:47]
s_waitcnt vmcnt(2)
v_mfma_f32_32x32x16_bf16 v[16:31],a[108:111],v[156:159],v[16:31]
v_mfma_f32_32x32x16_bf16 v[32:47],a[228:231],v[156:159],v[32:47]
s_waitcnt vmcnt(1)
v_mfma_f32_32x32x16_bf16 v[16:31],a[112:115],v[160:163],v[16:31]
v_mfma_f32_32x32x16_bf16 v[32:47],a[232:235],v[160:163],v[32:47]
s_waitcnt vmcnt(0)
v_mfma_f32_32x32x16_bf16 v[32:47],a[236:239],v[164:167],v[32:47]
v_mfma_f32_32x32x16_bf16 v[16:31],a[116:119],v[164:167],v[16:31]
buffer_load_dwordx4 v[184:187],v1,s[24:27],s68 offen sc1
buffer_load_dwordx4 v[188:191],v1,s[24:27],s68 offen offset:1024 sc1
buffer_load_dwordx4 v[192:195],v1,s[24:27],s68 offen offset:2048 sc1
buffer_load_dwordx4 v[196:199],v1,s[24:27],s68 offen offset:3072 sc1
s_nop 7
ks_j_227:
s_nop 7
s_nop 1
s_add_u32 s32,s32,262144
s_add_u32 s65,s65,262144
v_xor_b32 v12,0x4000,v8
ds_write_b128 v12,v[32:35]
ds_write_b128 v12,v[36:39] offset:1024
ds_write_b128 v12,v[40:43] offset:2048
ds_write_b128 v12,v[44:47] offset:3072
v_pk_add_f32 v[16:17],v[16:17],v[200:201]
v_pk_add_f32 v[18:19],v[18:19],v[202:203]
v_pk_add_f32 v[20:21],v[20:21],v[204:205]
v_pk_add_f32 v[22:23],v[22:23],v[206:207]
v_pk_add_f32 v[24:25],v[24:25],v[208:209]
v_pk_add_f32 v[26:27],v[26:27],v[210:211]
v_pk_add_f32 v[28:29],v[28:29],v[212:213]
v_pk_add_f32 v[30:31],v[30:31],v[214:215]
v_xor_b32 v12,0x1000,v8
s_waitcnt lgkmcnt(0)
s_barrier
ds_read_b128 v[32:35],v12
ds_read_b128 v[36:39],v12 offset:1024
ds_read_b128 v[40:43],v12 offset:2048
ds_read_b128 v[44:47],v12 offset:3072
ds_read_b128 v[200:203],v9 offset:8192
ds_read_b128 v[204:207],v9 offset:9216
ds_read_b128 v[208:211],v9 offset:10240
ds_read_b128 v[212:215],v9 offset:11264
ds_read_b128 v[216:219],v9 offset:12288
ds_read_b128 v[220:223],v9 offset:13312
ds_read_b128 v[224:227],v9 offset:14336
ds_read_b128 v[228:231],v9 offset:15360
s_cmp_lg_u32 s29,0
s_cbranch_scc1 ks_cp_231
buffer_load_dwordx2 v[6:7],v2,s[4:7],0 offen sc1
ks_cp_231:
s_waitcnt lgkmcnt(8)
v_pk_add_f32 v[16:17],v[16:17],v[32:33]
v_pk_add_f32 v[18:19],v[18:19],v[34:35]
v_pk_add_f32 v[20:21],v[20:21],v[36:37]
v_pk_add_f32 v[22:23],v[22:23],v[38:39]
v_pk_add_f32 v[24:25],v[24:25],v[40:41]
v_pk_add_f32 v[26:27],v[26:27],v[42:43]
v_pk_add_f32 v[28:29],v[28:29],v[44:45]
v_pk_add_f32 v[30:31],v[30:31],v[46:47]
s_waitcnt lgkmcnt(4)
v_pk_add_f32 v[16:17],v[16:17],v[200:201]
v_pk_add_f32 v[18:19],v[18:19],v[202:203]
v_pk_add_f32 v[20:21],v[20:21],v[204:205]
v_pk_add_f32 v[22:23],v[22:23],v[206:207]
v_pk_add_f32 v[24:25],v[24:25],v[208:209]
v_pk_add_f32 v[26:27],v[26:27],v[210:211]
v_pk_add_f32 v[28:29],v[28:29],v[212:213]
v_pk_add_f32 v[30:31],v[30:31],v[214:215]
s_waitcnt lgkmcnt(0)
v_pk_add_f32 v[16:17],v[16:17],v[216:217]
v_pk_add_f32 v[18:19],v[18:19],v[218:219]
v_pk_add_f32 v[20:21],v[20:21],v[220:221]
v_pk_add_f32 v[22:23],v[22:23],v[222:223]
v_pk_add_f32 v[24:25],v[24:25],v[224:225]
v_pk_add_f32 v[26:27],v[26:27],v[226:227]
v_pk_add_f32 v[28:29],v[28:29],v[228:229]
v_pk_add_f32 v[30:31],v[30:31],v[230:231]
s_cmp_eq_u32 s44,0
s_cbranch_scc1 ks_fz_232
v_bfi_b32 v16,1,s66,v16
v_bfi_b32 v17,1,s66,v17
v_bfi_b32 v18,1,s66,v18
v_bfi_b32 v19,1,s66,v19
s_cmp_eq_u32 s21,0
s_cbranch_scc1 ls_233
buffer_store_dwordx4 v[16:19],v1,s[4:7],s68 offen
ls_234:
v_bfi_b32 v20,1,s66,v20
v_bfi_b32 v21,1,s66,v21
v_bfi_b32 v22,1,s66,v22
v_bfi_b32 v23,1,s66,v23
s_cmp_eq_u32 s21,0
s_cbranch_scc1 ls_235
buffer_store_dwordx4 v[20:23],v1,s[4:7],s68 offen offset:1024
ls_236:
v_bfi_b32 v24,1,s66,v24
v_bfi_b32 v25,1,s66,v25
v_bfi_b32 v26,1,s66,v26
v_bfi_b32 v27,1,s66,v27
s_cmp_eq_u32 s21,0
s_cbranch_scc1 ls_237
buffer_store_dwordx4 v[24:27],v1,s[4:7],s68 offen offset:2048
ls_238:
v_bfi_b32 v28,1,s66,v28
v_bfi_b32 v29,1,s66,v29
v_bfi_b32 v30,1,s66,v30
v_bfi_b32 v31,1,s66,v31
s_cmp_eq_u32 s21,0
s_cbranch_scc1 ls_239
buffer_store_dwordx4 v[28:31],v1,s[4:7],s68 offen offset:3072
ls_240:
s_cmp_lg_u32 s29,0
s_cbranch_scc1 ks_nf_230
s_waitcnt vmcnt(4)
s_branch ks_nf_230
ks_fz_232:
s_mov_b32 s38,0
s_waitcnt vmcnt(16)
s_cmp_lg_u32 s29,0
s_cbranch_scc1 ks_px_241
s_waitcnt vmcnt(1)
ks_px_241:
v_bitop3_b32 v32,v184,v185,s66 bitop3:0x7e
v_bitop3_b32 v33,v186,v187,s66 bitop3:0x7e
v_bitop3_b32 v34,v188,v189,s66 bitop3:0x7e
v_bitop3_b32 v35,v190,v191,s66 bitop3:0x7e
v_bitop3_b32 v36,v192,v193,s66 bitop3:0x7e
v_bitop3_b32 v37,v194,v195,s66 bitop3:0x7e
v_bitop3_b32 v38,v196,v197,s66 bitop3:0x7e
v_bitop3_b32 v39,v198,v199,s66 bitop3:0x7e
v_or3_b32 v32,v32,v33,v34
v_or3_b32 v35,v35,v36,v37
v_or3_b32 v32,v32,v38,v39
v_or_b32 v32,v32,v35
v_and_b32 v32,1,v32
v_cmp_eq_u32 vcc,1,v32
s_cbranch_vccz ks_pxd_242
buffer_load_dwordx4 v[184:187],v1,s[24:27],s68 offen sc1
buffer_load_dwordx4 v[188:191],v1,s[24:27],s68 offen offset:1024 sc1
buffer_load_dwordx4 v[192:195],v1,s[24:27],s68 offen offset:2048 sc1
buffer_load_dwordx4 v[196:199],v1,s[24:27],s68 offen offset:3072 sc1
s_waitcnt vmcnt(0)
s_add_u32 s38,s38,1
s_cmp_lt_u32 s38,100000
s_cbranch_scc1 ks_px_241
s_mov_b32 s40,13
s_branch L_fail
ks_pxd_242:
v_pk_add_f32 v[16:17],v[16:17],v[184:185]
v_pk_add_f32 v[18:19],v[18:19],v[186:187]
v_pk_add_f32 v[20:21],v[20:21],v[188:189]
v_pk_add_f32 v[22:23],v[22:23],v[190:191]
v_pk_add_f32 v[24:25],v[24:25],v[192:193]
v_pk_add_f32 v[26:27],v[26:27],v[194:195]
v_pk_add_f32 v[28:29],v[28:29],v[196:197]
v_pk_add_f32 v[30:31],v[30:31],v[198:199]
v_cvt_pk_bf16_f32 v32,v16,v17
v_cvt_pk_bf16_f32 v33,v18,v19
v_cvt_pk_bf16_f32 v34,v20,v21
v_cvt_pk_bf16_f32 v35,v22,v23
v_cvt_pk_bf16_f32 v36,v24,v25
v_cvt_pk_bf16_f32 v37,v26,v27
v_cvt_pk_bf16_f32 v38,v28,v29
v_cvt_pk_bf16_f32 v39,v30,v31
buffer_store_dwordx4 v[32:35],v1,s[4:7],s36 offen sc1
buffer_store_dwordx4 v[36:39],v1,s[4:7],s36 offen offset:1024 sc1
v_pk_add_f32 v[216:217],v[16:17],v[24:25]
v_pk_add_f32 v[218:219],v[18:19],v[26:27]
v_pk_add_f32 v[220:221],v[20:21],v[28:29]
v_pk_add_f32 v[222:223],v[22:23],v[30:31]
v_pk_add_f32 v[216:217],v[216:217],v[218:219]
v_pk_add_f32 v[220:221],v[220:221],v[222:223]
v_pk_mul_f32 v[218:219],v[16:17],v[16:17]
v_pk_mul_f32 v[222:223],v[18:19],v[18:19]
v_pk_add_f32 v[216:217],v[216:217],v[220:221]
v_pk_fma_f32 v[218:219],v[20:21],v[20:21],v[218:219]
v_pk_fma_f32 v[222:223],v[22:23],v[22:23],v[222:223]
v_pk_fma_f32 v[218:219],v[24:25],v[24:25],v[218:219]
v_pk_fma_f32 v[222:223],v[26:27],v[26:27],v[222:223]
v_pk_fma_f32 v[218:219],v[28:29],v[28:29],v[218:219]
v_pk_fma_f32 v[222:223],v[30:31],v[30:31],v[222:223]
v_add_f32 v12,v216,v217
v_pk_add_f32 v[218:219],v[218:219],v[222:223]
v_mov_b32 v216,v12
v_add_f32 v13,v218,v219
v_mov_b32 v217,v13
v_permlane32_swap_b32 v12,v216
s_nop 0
v_permlane32_swap_b32 v13,v217
s_nop 0
v_pk_add_f32 v[12:13],v[12:13],v[216:217]
buffer_store_dwordx2 v[12:13],v10,s[4:7],s63 offen sc1
s_mov_b32 s30,1
s_cmp_lg_u32 s29,0
s_cbranch_scc1 ks_nf_230
s_waitcnt vmcnt(3)
ks_nf_230:
s_add_u32 s33,s33,49152
s_add_u32 s36,s36,49152
s_add_u32 s63,s63,49152
s_add_u32 s28,s28,1
v_xor_b32 v8,32768,v8
v_xor_b32 v9,32768,v9
buffer_load_dwordx4 v[168:171],v1,s[24:27],s33 offen sc1
buffer_load_dwordx4 v[172:175],v1,s[24:27],s33 offen offset:1024 sc1
s_cmp_lg_u32 s29,0
s_cbranch_scc1 ks_top_221
s_bitcmp0_b32 s31,0
s_cselect_b64 vcc,s[22:23],0
v_cndmask_b32 v4,v6,v7,vcc
v_add_u32 v4,v3,v4
v_cmp_le_u32 vcc,s31,v4
s_nop 0
s_cmp_eq_u64 vcc,-1
s_nop 1
s_cbranch_scc0 ks_np2_245
s_cmp_lt_u32 s41,30720
s_cselect_b32 s46,s32,s65
s_add_u32 s46,s46,0
buffer_load_dwordx4 v[48:51],v1,s[4:7],s46 offen sc1
s_cmp_lt_u32 s41,29696
s_cselect_b32 s46,s32,s65
s_add_u32 s46,s46,0
buffer_load_dwordx4 v[52:55],v1,s[4:7],s46 offen offset:1024 sc1
s_cmp_lt_u32 s41,28672
s_cselect_b32 s46,s32,s65
s_add_u32 s46,s46,0
buffer_load_dwordx4 v[56:59],v1,s[4:7],s46 offen offset:2048 sc1
s_cmp_lt_u32 s41,27648
s_cselect_b32 s46,s32,s65
s_add_u32 s46,s46,0
buffer_load_dwordx4 v[60:63],v1,s[4:7],s46 offen offset:3072 sc1
s_cmp_lt_u32 s41,26624
s_cselect_b32 s46,s32,s65
s_add_u32 s46,s46,4096
buffer_load_dwordx4 v[64:67],v1,s[4:7],s46 offen sc1
s_cmp_lt_u32 s41,25600
s_cselect_b32 s46,s32,s65
s_add_u32 s46,s46,4096
buffer_load_dwordx4 v[68:71],v1,s[4:7],s46 offen offset:1024 sc1
s_cmp_eq_u32 s30,0
s_cbranch_scc1 ks_pb_246
s_waitcnt vmcnt(8)
v_mov_b32 v14,s28
s_mov_b64 exec,1
buffer_store_dword v14,off,s[4:7],s37 sc1
s_mov_b64 exec,-1
s_mov_b32 s30,0
ks_pb_246:
s_cmp_lt_u32 s41,24576
s_cselect_b32 s46,s32,s65
s_add_u32 s46,s46,4096
buffer_load_dwordx4 v[72:75],v1,s[4:7],s46 offen offset:2048 sc1
s_cmp_lt_u32 s41,23552
s_cselect_b32 s46,s32,s65
s_add_u32 s46,s46,4096
buffer_load_dwordx4 v[76:79],v1,s[4:7],s46 offen offset:3072 sc1
s_cmp_lt_u32 s41,22528
s_cselect_b32 s46,s32,s65
s_add_u32 s46,s46,8192
buffer_load_dwordx4 v[80:83],v1,s[4:7],s46 offen sc1
s_cmp_lt_u32 s41,21504
s_cselect_b32 s46,s32,s65
s_add_u32 s46,s46,8192
buffer_load_dwordx4 v[84:87],v1,s[4:7],s46 offen offset:1024 sc1
s_cmp_lt_u32 s41,20480
s_cselect_b32 s46,s32,s65
s_add_u32 s46,s46,8192
buffer_load_dwordx4 v[88:91],v1,s[4:7],s46 offen offset:2048 sc1
s_cmp_lt_u32 s41,19456
s_cselect_b32 s46,s32,s65
s_add_u32 s46,s46,8192
buffer_load_dwordx4 v[92:95],v1,s[4:7],s46 offen offset:3072 sc1
s_cmp_lt_u32 s41,18432
s_cselect_b32 s46,s32,s65
s_add_u32 s46,s46,12288
buffer_load_dwordx4 v[96:99],v1,s[4:7],s46 offen sc1
s_cmp_lt_u32 s41,17408
s_cselect_b32 s46,s32,s65
s_add_u32 s46,s46,12288
buffer_load_dwordx4 v[100:103],v1,s[4:7],s46 offen offset:1024 sc1
s_cmp_lt_u32 s41,16384
s_cselect_b32 s46,s32,s65
s_add_u32 s46,s46,12288
buffer_load_dwordx4 v[104:107],v1,s[4:7],s46 offen offset:2048 sc1
s_cmp_lt_u32 s41,15360
s_cselect_b32 s46,s32,s65
s_add_u32 s46,s46,12288
buffer_load_dwordx4 v[108:111],v1,s[4:7],s46 offen offset:3072 sc1
s_branch ks_top_221
ks_np2_245:
s_cmp_eq_u32 s30,0
s_cbranch_scc1 ks_nop_248
buffer_load_dwordx2 v[6:7],v2,s[4:7],0 offen sc1
s_cmp_eq_u32 s30,0
s_cbranch_scc1 ks_pb_249
s_waitcnt vmcnt(3)
v_mov_b32 v14,s28
s_mov_b64 exec,1
buffer_store_dword v14,off,s[4:7],s37 sc1
s_mov_b64 exec,-1
s_mov_b32 s30,0
ks_pb_249:
s_waitcnt vmcnt(1)
s_bitcmp0_b32 s31,0
s_cselect_b64 vcc,s[22:23],0
v_cndmask_b32 v4,v6,v7,vcc
v_add_u32 v4,v3,v4
v_cmp_le_u32 vcc,s31,v4
s_nop 0
s_cmp_eq_u64 vcc,-1
s_nop 1
s_cbranch_scc1 ks_rdy_247
ks_nop_248:
s_cmp_ge_u32 s28,s67
s_cbranch_scc1 ks_fin_222
s_mov_b32 s38,0
poll_250:
buffer_load_dwordx2 v[6:7],v2,s[4:7],0 offen sc1
s_waitcnt vmcnt(0)
s_bitcmp0_b32 s31,0
s_cselect_b64 vcc,s[22:23],0
v_cndmask_b32 v4,v6,v7,vcc
v_add_u32 v4,v3,v4
v_cmp_le_u32 vcc,s31,v4
s_nop 0
s_cmp_eq_u64 vcc,-1
s_nop 1
s_cbranch_scc1 polld_251
s_sleep 2
s_add_u32 s38,s38,1
s_cmp_lt_u32 s38,100000
s_cbranch_scc1 poll_250
s_mov_b32 s40,11
s_branch L_fail
polld_251:
ks_rdy_247:
s_cmp_lt_u32 s41,30720
s_cselect_b32 s46,s32,s65
s_add_u32 s46,s46,0
buffer_load_dwordx4 v[48:51],v1,s[4:7],s46 offen sc1
s_cmp_lt_u32 s41,29696
s_cselect_b32 s46,s32,s65
s_add_u32 s46,s46,0
buffer_load_dwordx4 v[52:55],v1,s[4:7],s46 offen offset:1024 sc1
s_cmp_lt_u32 s41,28672
s_cselect_b32 s46,s32,s65
s_add_u32 s46,s46,0
buffer_load_dwordx4 v[56:59],v1,s[4:7],s46 offen offset:2048 sc1
s_cmp_lt_u32 s41,27648
s_cselect_b32 s46,s32,s65
s_add_u32 s46,s46,0
buffer_load_dwordx4 v[60:63],v1,s[4:7],s46 offen offset:3072 sc1
s_cmp_lt_u32 s41,26624
s_cselect_b32 s46,s32,s65
s_add_u32 s46,s46,4096
buffer_load_dwordx4 v[64:67],v1,s[4:7],s46 offen sc1
s_cmp_lt_u32 s41,25600
s_cselect_b32 s46,s32,s65
s_add_u32 s46,s46,4096
buffer_load_dwordx4 v[68:71],v1,s[4:7],s46 offen offset:1024 sc1
s_cmp_lt_u32 s41,24576
s_cselect_b32 s46,s32,s65
s_add_u32 s46,s46,4096
buffer_load_dwordx4 v[72:75],v1,s[4:7],s46 offen offset:2048 sc1
s_cmp_lt_u32 s41,23552
s_cselect_b32 s46,s32,s65
s_add_u32 s46,s46,4096
buffer_load_dwordx4 v[76:79],v1,s[4:7],s46 offen offset:3072 sc1
s_cmp_lt_u32 s41,22528
s_cselect_b32 s46,s32,s65
s_add_u32 s46,s46,8192
buffer_load_dwordx4 v[80:83],v1,s[4:7],s46 offen sc1
s_cmp_lt_u32 s41,21504
s_cselect_b32 s46,s32,s65
s_add_u32 s46,s46,8192
buffer_load_dwordx4 v[84:87],v1,s[4:7],s46 offen offset:1024 sc1
s_cmp_lt_u32 s41,20480
s_cselect_b32 s46,s32,s65
s_add_u32 s46,s46,8192
buffer_load_dwordx4 v[88:91],v1,s[4:7],s46 offen offset:2048 sc1
s_cmp_lt_u32 s41,19456
s_cselect_b32 s46,s32,s65
s_add_u32 s46,s46,8192
buffer_load_dwordx4 v[92:95],v1,s[4:7],s46 offen offset:3072 sc1
s_cmp_lt_u32 s41,18432
s_cselect_b32 s46,s32,s65
s_add_u32 s46,s46,12288
buffer_load_dwordx4 v[96:99],v1,s[4:7],s46 offen sc1
s_cmp_lt_u32 s41,17408
s_cselect_b32 s46,s32,s65
s_add_u32 s46,s46,12288
buffer_load_dwordx4 v[100:103],v1,s[4:7],s46 offen offset:1024 sc1
s_cmp_lt_u32 s41,16384
s_cselect_b32 s46,s32,s65
s_add_u32 s46,s46,12288
buffer_load_dwordx4 v[104:107],v1,s[4:7],s46 offen offset:2048 sc1
s_cmp_lt_u32 s41,15360
s_cselect_b32 s46,s32,s65
s_add_u32 s46,s46,12288
buffer_load_dwordx4 v[108:111],v1,s[4:7],s46 offen offset:3072 sc1
s_branch ks_top_221
ks_fin_222:
s_branch L_end
ks_hi_216:
v_lshlrev_b32 v1,4,v0
s_mov_b32 s24,s4
s_mov_b32 s25,s5
s_mov_b32 s26,s6
s_mov_b32 s27,0x20000
s_cmp_ge_u32 s42,10
s_cselect_b32 s44,1,0
s_cselect_b32 s43,10,0
s_sub_u32 s43,s42,s43
s_lshl_b32 s43,s43,1
s_and_b32 s45,s3,1
s_mul_i32 s45,s45,34
s_lshl_b32 s46,s44,7
s_add_u32 s45,s45,s46
s_add_u32 s45,s45,60
s_and_b32 s48,s3,1
s_add_u32 s49,s43,s48
s_load_dwordx2 s[20:21],s[0:1],40
s_waitcnt lgkmcnt(0)
s_mov_b32 s16,s20
s_and_b32 s17,s21,0xffff
s_mov_b32 s18,0x500000
s_mov_b32 s19,0x20000
s_lshl_b32 s46,s43,6
s_mul_i32 s64,s45,20480
s_add_u32 s64,s64,s46
s_mul_i32 s41,s42,13
s_mul_hi_u32 s46,s41,0x7878788
s_mul_i32 s47,s46,34
s_sub_u32 s41,s41,s47
v_lshrrev_b32 v18,3,v0
v_mul_u32_u24 v16,1280,v18
v_and_b32 v18,7,v0
v_lshl_add_u32 v16,v18,4,v16
v_and_b32 v18,3,v0
v_lshlrev_b32 v17,3,v18
v_bfe_u32 v18,v0,4,1
v_lshl_add_u32 v17,v18,5,v17
v_bfe_u32 v18,v0,2,2
v_lshl_add_u32 v17,v18,7,v17
v_lshrrev_b32 v18,5,v0
v_lshl_add_u32 v17,v18,9,v17
s_mul_i32 s22,s3,40960
v_add_u32 v17,s22,v17
s_lshl_b32 s23,s48,6
v_add_u32 v17,s23,v17
v_xor_b32 v18,64,v17
s_add_u32 s20,s41,-34
s_cselect_b32 s47,0,34
s_add_u32 s20,s20,s47
s_mul_i32 s20,s20,20480
s_add_u32 s20,s20,s64
s_add_u32 s23,s22,0
s_mov_b32 m0,s23
s_nop 0
buffer_load_dwordx4 v16,s[16:19],s20 offen lds
s_add_u32 s23,s22,1024
s_mov_b32 m0,s23
s_add_u32 s20,s20,10240
buffer_load_dwordx4 v16,s[16:19],s20 offen lds
s_add_u32 s20,s41,-33
s_cselect_b32 s47,0,34
s_add_u32 s20,s20,s47
s_mul_i32 s20,s20,20480
s_add_u32 s20,s20,s64
s_add_u32 s23,s22,2048
s_mov_b32 m0,s23
s_nop 0
buffer_load_dwordx4 v16,s[16:19],s20 offen lds
s_add_u32 s23,s22,3072
s_mov_b32 m0,s23
s_add_u32 s20,s20,10240
buffer_load_dwordx4 v16,s[16:19],s20 offen lds
s_add_u32 s20,s41,-32
s_cselect_b32 s47,0,34
s_add_u32 s20,s20,s47
s_mul_i32 s20,s20,20480
s_add_u32 s20,s20,s64
s_add_u32 s23,s22,4096
s_mov_b32 m0,s23
s_nop 0
buffer_load_dwordx4 v16,s[16:19],s20 offen lds
s_add_u32 s23,s22,5120
s_mov_b32 m0,s23
s_add_u32 s20,s20,10240
buffer_load_dwordx4 v16,s[16:19],s20 offen lds
s_add_u32 s20,s41,-31
s_cselect_b32 s47,0,34
s_add_u32 s20,s20,s47
s_mul_i32 s20,s20,20480
s_add_u32 s20,s20,s64
s_add_u32 s23,s22,6144
s_mov_b32 m0,s23
s_nop 0
buffer_load_dwordx4 v16,s[16:19],s20 offen lds
s_add_u32 s23,s22,7168
s_mov_b32 m0,s23
s_add_u32 s20,s20,10240
buffer_load_dwordx4 v16,s[16:19],s20 offen lds
s_add_u32 s20,s41,-30
s_cselect_b32 s47,0,34
s_add_u32 s20,s20,s47
s_mul_i32 s20,s20,20480
s_add_u32 s20,s20,s64
s_add_u32 s23,s22,8192
s_mov_b32 m0,s23
s_nop 0
buffer_load_dwordx4 v16,s[16:19],s20 offen lds
s_add_u32 s23,s22,9216
s_mov_b32 m0,s23
s_add_u32 s20,s20,10240
buffer_load_dwordx4 v16,s[16:19],s20 offen lds
s_add_u32 s20,s41,-29
s_cselect_b32 s47,0,34
s_add_u32 s20,s20,s47
s_mul_i32 s20,s20,20480
s_add_u32 s20,s20,s64
s_add_u32 s23,s22,10240
s_mov_b32 m0,s23
s_nop 0
buffer_load_dwordx4 v16,s[16:19],s20 offen lds
s_add_u32 s23,s22,11264
s_mov_b32 m0,s23
s_add_u32 s20,s20,10240
buffer_load_dwordx4 v16,s[16:19],s20 offen lds
s_add_u32 s20,s41,-28
s_cselect_b32 s47,0,34
s_add_u32 s20,s20,s47
s_mul_i32 s20,s20,20480
s_add_u32 s20,s20,s64
s_add_u32 s23,s22,12288
s_mov_b32 m0,s23
s_nop 0
buffer_load_dwordx4 v16,s[16:19],s20 offen lds
s_add_u32 s23,s22,13312
s_mov_b32 m0,s23
s_add_u32 s20,s20,10240
buffer_load_dwordx4 v16,s[16:19],s20 offen lds
s_add_u32 s20,s41,-27
s_cselect_b32 s47,0,34
s_add_u32 s20,s20,s47
s_mul_i32 s20,s20,20480
s_add_u32 s20,s20,s64
s_add_u32 s23,s22,14336
s_mov_b32 m0,s23
s_nop 0
buffer_load_dwordx4 v16,s[16:19],s20 offen lds
s_add_u32 s23,s22,15360
s_mov_b32 m0,s23
s_add_u32 s20,s20,10240
buffer_load_dwordx4 v16,s[16:19],s20 offen lds
s_add_u32 s20,s41,-26
s_cselect_b32 s47,0,34
s_add_u32 s20,s20,s47
s_mul_i32 s20,s20,20480
s_add_u32 s20,s20,s64
s_add_u32 s23,s22,16384
s_mov_b32 m0,s23
s_nop 0
buffer_load_dwordx4 v16,s[16:19],s20 offen lds
s_add_u32 s23,s22,17408
s_mov_b32 m0,s23
s_add_u32 s20,s20,10240
buffer_load_dwordx4 v16,s[16:19],s20 offen lds
s_add_u32 s20,s41,-25
s_cselect_b32 s47,0,34
s_add_u32 s20,s20,s47
s_mul_i32 s20,s20,20480
s_add_u32 s20,s20,s64
s_add_u32 s23,s22,18432
s_mov_b32 m0,s23
s_nop 0
buffer_load_dwordx4 v16,s[16:19],s20 offen lds
s_add_u32 s23,s22,19456
s_mov_b32 m0,s23
s_add_u32 s20,s20,10240
buffer_load_dwordx4 v16,s[16:19],s20 offen lds
s_add_u32 s20,s41,-24
s_cselect_b32 s47,0,34
s_add_u32 s20,s20,s47
s_mul_i32 s20,s20,20480
s_add_u32 s20,s20,s64
s_add_u32 s23,s22,20480
s_mov_b32 m0,s23
s_nop 0
buffer_load_dwordx4 v16,s[16:19],s20 offen lds
s_add_u32 s23,s22,21504
s_mov_b32 m0,s23
s_add_u32 s20,s20,10240
buffer_load_dwordx4 v16,s[16:19],s20 offen lds
s_add_u32 s20,s41,-23
s_cselect_b32 s47,0,34
s_add_u32 s20,s20,s47
s_mul_i32 s20,s20,20480
s_add_u32 s20,s20,s64
s_add_u32 s23,s22,22528
s_mov_b32 m0,s23
s_nop 0
buffer_load_dwordx4 v16,s[16:19],s20 offen lds
s_add_u32 s23,s22,23552
s_mov_b32 m0,s23
s_add_u32 s20,s20,10240
buffer_load_dwordx4 v16,s[16:19],s20 offen lds
s_add_u32 s20,s41,-22
s_cselect_b32 s47,0,34
s_add_u32 s20,s20,s47
s_mul_i32 s20,s20,20480
s_add_u32 s20,s20,s64
s_add_u32 s23,s22,24576
s_mov_b32 m0,s23
s_nop 0
buffer_load_dwordx4 v16,s[16:19],s20 offen lds
s_add_u32 s23,s22,25600
s_mov_b32 m0,s23
s_add_u32 s20,s20,10240
buffer_load_dwordx4 v16,s[16:19],s20 offen lds
s_add_u32 s20,s41,-21
s_cselect_b32 s47,0,34
s_add_u32 s20,s20,s47
s_mul_i32 s20,s20,20480
s_add_u32 s20,s20,s64
s_add_u32 s23,s22,26624
s_mov_b32 m0,s23
s_nop 0
buffer_load_dwordx4 v16,s[16:19],s20 offen lds
s_add_u32 s23,s22,27648
s_mov_b32 m0,s23
s_add_u32 s20,s20,10240
buffer_load_dwordx4 v16,s[16:19],s20 offen lds
s_add_u32 s20,s41,-20
s_cselect_b32 s47,0,34
s_add_u32 s20,s20,s47
s_mul_i32 s20,s20,20480
s_add_u32 s20,s20,s64
s_add_u32 s23,s22,28672
s_mov_b32 m0,s23
s_nop 0
buffer_load_dwordx4 v16,s[16:19],s20 offen lds
s_add_u32 s23,s22,29696
s_mov_b32 m0,s23
s_add_u32 s20,s20,10240
buffer_load_dwordx4 v16,s[16:19],s20 offen lds
s_add_u32 s20,s41,-19
s_cselect_b32 s47,0,34
s_add_u32 s20,s20,s47
s_mul_i32 s20,s20,20480
s_add_u32 s20,s20,s64
s_add_u32 s23,s22,30720
s_mov_b32 m0,s23
s_nop 0
buffer_load_dwordx4 v16,s[16:19],s20 offen lds
s_add_u32 s23,s22,31744
s_mov_b32 m0,s23
s_add_u32 s20,s20,10240
buffer_load_dwordx4 v16,s[16:19],s20 offen lds
s_add_u32 s20,s41,-18
s_cselect_b32 s47,0,34
s_add_u32 s20,s20,s47
s_mul_i32 s20,s20,20480
s_add_u32 s20,s20,s64
s_add_u32 s23,s22,32768
s_mov_b32 m0,s23
s_nop 0
buffer_load_dwordx4 v16,s[16:19],s20 offen lds
s_add_u32 s23,s22,33792
s_mov_b32 m0,s23
s_add_u32 s20,s20,10240
buffer_load_dwordx4 v16,s[16:19],s20 offen lds
s_add_u32 s20,s41,-17
s_cselect_b32 s47,0,34
s_add_u32 s20,s20,s47
s_mul_i32 s20,s20,20480
s_add_u32 s20,s20,s64
s_add_u32 s23,s22,34816
s_mov_b32 m0,s23
s_nop 0
buffer_load_dwordx4 v16,s[16:19],s20 offen lds
s_add_u32 s23,s22,35840
s_mov_b32 m0,s23
s_add_u32 s20,s20,10240
buffer_load_dwordx4 v16,s[16:19],s20 offen lds
s_waitcnt vmcnt(34)
ds_read_b64_tr_b16 a[0:1],v17
ds_read_b64_tr_b16 a[2:3],v17 offset:1024
ds_read_b64_tr_b16 a[136:137],v18
ds_read_b64_tr_b16 a[138:139],v18 offset:1024
s_waitcnt vmcnt(32)
ds_read_b64_tr_b16 a[4:5],v17 offset:2048
ds_read_b64_tr_b16 a[6:7],v17 offset:3072
ds_read_b64_tr_b16 a[140:141],v18 offset:2048
ds_read_b64_tr_b16 a[142:143],v18 offset:3072
s_waitcnt vmcnt(30)
ds_read_b64_tr_b16 a[8:9],v17 offset:4096
ds_read_b64_tr_b16 a[10:11],v17 offset:5120
ds_read_b64_tr_b16 a[144:145],v18 offset:4096
ds_read_b64_tr_b16 a[146:147],v18 offset:5120
s_waitcnt lgkmcnt(8)
s_add_u32 s20,s41,-16
s_cselect_b32 s47,0,34
s_add_u32 s20,s20,s47
s_mul_i32 s20,s20,20480
s_add_u32 s20,s20,s64
s_add_u32 s23,s22,0
s_mov_b32 m0,s23
s_nop 0
buffer_load_dwordx4 v16,s[16:19],s20 offen lds
s_add_u32 s23,s22,1024
s_mov_b32 m0,s23
s_add_u32 s20,s20,10240
buffer_load_dwordx4 v16,s[16:19],s20 offen lds
s_waitcnt vmcnt(30)
ds_read_b64_tr_b16 a[12:13],v17 offset:6144
ds_read_b64_tr_b16 a[14:15],v17 offset:7168
ds_read_b64_tr_b16 a[148:149],v18 offset:6144
ds_read_b64_tr_b16 a[150:151],v18 offset:7168
s_waitcnt lgkmcnt(8)
s_add_u32 s20,s41,-15
s_cselect_b32 s47,0,34
s_add_u32 s20,s20,s47
s_mul_i32 s20,s20,20480
s_add_u32 s20,s20,s64
s_add_u32 s23,s22,2048
s_mov_b32 m0,s23
s_nop 0
buffer_load_dwordx4 v16,s[16:19],s20 offen lds
s_add_u32 s23,s22,3072
s_mov_b32 m0,s23
s_add_u32 s20,s20,10240
buffer_load_dwordx4 v16,s[16:19],s20 offen lds
s_waitcnt vmcnt(30)
ds_read_b64_tr_b16 a[16:17],v17 offset:8192
ds_read_b64_tr_b16 a[18:19],v17 offset:9216
ds_read_b64_tr_b16 a[152:153],v18 offset:8192
ds_read_b64_tr_b16 a[154:155],v18 offset:9216
s_waitcnt lgkmcnt(8)
s_add_u32 s20,s41,-14
s_cselect_b32 s47,0,34
s_add_u32 s20,s20,s47
s_mul_i32 s20,s20,20480
s_add_u32 s20,s20,s64
s_add_u32 s23,s22,4096
s_mov_b32 m0,s23
s_nop 0
buffer_load_dwordx4 v16,s[16:19],s20 offen lds
s_add_u32 s23,s22,5120
s_mov_b32 m0,s23
s_add_u32 s20,s20,10240
buffer_load_dwordx4 v16,s[16:19],s20 offen lds
s_waitcnt vmcnt(30)
ds_read_b64_tr_b16 a[20:21],v17 offset:10240
ds_read_b64_tr_b16 a[22:23],v17 offset:11264
ds_read_b64_tr_b16 a[156:157],v18 offset:10240
ds_read_b64_tr_b16 a[158:159],v18 offset:11264
s_waitcnt lgkmcnt(8)
s_add_u32 s20,s41,-13
s_cselect_b32 s47,0,34
s_add_u32 s20,s20,s47
s_mul_i32 s20,s20,20480
s_add_u32 s20,s20,s64
s_add_u32 s23,s22,6144
s_mov_b32 m0,s23
s_nop 0
buffer_load_dwordx4 v16,s[16:19],s20 offen lds
s_add_u32 s23,s22,7168
s_mov_b32 m0,s23
s_add_u32 s20,s20,10240
buffer_load_dwordx4 v16,s[16:19],s20 offen lds
s_waitcnt vmcnt(30)
ds_read_b64_tr_b16 a[24:25],v17 offset:12288
ds_read_b64_tr_b16 a[26:27],v17 offset:13312
ds_read_b64_tr_b16 a[160:161],v18 offset:12288
ds_read_b64_tr_b16 a[162:163],v18 offset:13312
s_waitcnt lgkmcnt(8)
s_add_u32 s20,s41,-12
s_cselect_b32 s47,0,34
s_add_u32 s20,s20,s47
s_mul_i32 s20,s20,20480
s_add_u32 s20,s20,s64
s_add_u32 s23,s22,8192
s_mov_b32 m0,s23
s_nop 0
buffer_load_dwordx4 v16,s[16:19],s20 offen lds
s_add_u32 s23,s22,9216
s_mov_b32 m0,s23
s_add_u32 s20,s20,10240
buffer_load_dwordx4 v16,s[16:19],s20 offen lds
s_waitcnt vmcnt(30)
ds_read_b64_tr_b16 a[28:29],v17 offset:14336
ds_read_b64_tr_b16 a[30:31],v17 offset:15360
ds_read_b64_tr_b16 a[164:165],v18 offset:14336
ds_read_b64_tr_b16 a[166:167],v18 offset:15360
s_waitcnt lgkmcnt(8)
s_add_u32 s20,s41,-11
s_cselect_b32 s47,0,34
s_add_u32 s20,s20,s47
s_mul_i32 s20,s20,20480
s_add_u32 s20,s20,s64
s_add_u32 s23,s22,10240
s_mov_b32 m0,s23
s_nop 0
buffer_load_dwordx4 v16,s[16:19],s20 offen lds
s_add_u32 s23,s22,11264
s_mov_b32 m0,s23
s_add_u32 s20,s20,10240
buffer_load_dwordx4 v16,s[16:19],s20 offen lds
s_waitcnt vmcnt(30)
ds_read_b64_tr_b16 a[32:33],v17 offset:16384
ds_read_b64_tr_b16 a[34:35],v17 offset:17408
ds_read_b64_tr_b16 a[168:169],v18 offset:16384
ds_read_b64_tr_b16 a[170:171],v18 offset:17408
s_waitcnt lgkmcnt(8)
s_add_u32 s20,s41,-10
s_cselect_b32 s47,0,34
s_add_u32 s20,s20,s47
s_mul_i32 s20,s20,20480
s_add_u32 s20,s20,s64
s_add_u32 s23,s22,12288
s_mov_b32 m0,s23
s_nop 0
buffer_load_dwordx4 v16,s[16:19],s20 offen lds
s_add_u32 s23,s22,13312
s_mov_b32 m0,s23
s_add_u32 s20,s20,10240
buffer_load_dwordx4 v16,s[16:19],s20 offen lds
s_waitcnt vmcnt(30)
ds_read_b64_tr_b16 a[36:37],v17 offset:18432
ds_read_b64_tr_b16 a[38:39],v17 offset:19456
ds_read_b64_tr_b16 a[172:173],v18 offset:18432
ds_read_b64_tr_b16 a[174:175],v18 offset:19456
s_waitcnt lgkmcnt(8)
s_add_u32 s20,s41,-9
s_cselect_b32 s47,0,34
s_add_u32 s20,s20,s47
s_mul_i32 s20,s20,20480
s_add_u32 s20,s20,s64
s_add_u32 s23,s22,14336
s_mov_b32 m0,s23
s_nop 0
buffer_load_dwordx4 v16,s[16:19],s20 offen lds
s_add_u32 s23,s22,15360
s_mov_b32 m0,s23
s_add_u32 s20,s20,10240
buffer_load_dwordx4 v16,s[16:19],s20 offen lds
s_waitcnt vmcnt(30)
ds_read_b64_tr_b16 a[40:41],v17 offset:20480
ds_read_b64_tr_b16 a[42:43],v17 offset:21504
ds_read_b64_tr_b16 a[176:177],v18 offset:20480
ds_read_b64_tr_b16 a[178:179],v18 offset:21504
s_waitcnt lgkmcnt(8)
s_add_u32 s20,s41,-8
s_cselect_b32 s47,0,34
s_add_u32 s20,s20,s47
s_mul_i32 s20,s20,20480
s_add_u32 s20,s20,s64
s_add_u32 s23,s22,16384
s_mov_b32 m0,s23
s_nop 0
buffer_load_dwordx4 v16,s[16:19],s20 offen lds
s_add_u32 s23,s22,17408
s_mov_b32 m0,s23
s_add_u32 s20,s20,10240
buffer_load_dwordx4 v16,s[16:19],s20 offen lds
s_waitcnt vmcnt(30)
ds_read_b64_tr_b16 a[44:45],v17 offset:22528
ds_read_b64_tr_b16 a[46:47],v17 offset:23552
ds_read_b64_tr_b16 a[180:181],v18 offset:22528
ds_read_b64_tr_b16 a[182:183],v18 offset:23552
s_waitcnt lgkmcnt(8)
s_add_u32 s20,s41,-7
s_cselect_b32 s47,0,34
s_add_u32 s20,s20,s47
s_mul_i32 s20,s20,20480
s_add_u32 s20,s20,s64
s_add_u32 s23,s22,18432
s_mov_b32 m0,s23
s_nop 0
buffer_load_dwordx4 v16,s[16:19],s20 offen lds
s_add_u32 s23,s22,19456
s_mov_b32 m0,s23
s_add_u32 s20,s20,10240
buffer_load_dwordx4 v16,s[16:19],s20 offen lds
s_waitcnt vmcnt(30)
ds_read_b64_tr_b16 a[48:49],v17 offset:24576
ds_read_b64_tr_b16 a[50:51],v17 offset:25600
ds_read_b64_tr_b16 a[184:185],v18 offset:24576
ds_read_b64_tr_b16 a[186:187],v18 offset:25600
s_waitcnt lgkmcnt(8)
s_add_u32 s20,s41,-6
s_cselect_b32 s47,0,34
s_add_u32 s20,s20,s47
s_mul_i32 s20,s20,20480
s_add_u32 s20,s20,s64
s_add_u32 s23,s22,20480
s_mov_b32 m0,s23
s_nop 0
buffer_load_dwordx4 v16,s[16:19],s20 offen lds
s_add_u32 s23,s22,21504
s_mov_b32 m0,s23
s_add_u32 s20,s20,10240
buffer_load_dwordx4 v16,s[16:19],s20 offen lds
s_waitcnt vmcnt(30)
ds_read_b64_tr_b16 a[52:53],v17 offset:26624
ds_read_b64_tr_b16 a[54:55],v17 offset:27648
ds_read_b64_tr_b16 a[188:189],v18 offset:26624
ds_read_b64_tr_b16 a[190:191],v18 offset:27648
s_waitcnt lgkmcnt(8)
s_add_u32 s20,s41,-5
s_cselect_b32 s47,0,34
s_add_u32 s20,s20,s47
s_mul_i32 s20,s20,20480
s_add_u32 s20,s20,s64
s_add_u32 s23,s22,22528
s_mov_b32 m0,s23
s_nop 0
buffer_load_dwordx4 v16,s[16:19],s20 offen lds
s_add_u32 s23,s22,23552
s_mov_b32 m0,s23
s_add_u32 s20,s20,10240
buffer_load_dwordx4 v16,s[16:19],s20 offen lds
s_waitcnt vmcnt(30)
ds_read_b64_tr_b16 a[56:57],v17 offset:28672
ds_read_b64_tr_b16 a[58:59],v17 offset:29696
ds_read_b64_tr_b16 a[192:193],v18 offset:28672
ds_read_b64_tr_b16 a[194:195],v18 offset:29696
s_waitcnt lgkmcnt(8)
s_add_u32 s20,s41,-4
s_cselect_b32 s47,0,34
s_add_u32 s20,s20,s47
s_mul_i32 s20,s20,20480
s_add_u32 s20,s20,s64
s_add_u32 s23,s22,24576
s_mov_b32 m0,s23
s_nop 0
buffer_load_dwordx4 v16,s[16:19],s20 offen lds
s_add_u32 s23,s22,25600
s_mov_b32 m0,s23
s_add_u32 s20,s20,10240
buffer_load_dwordx4 v16,s[16:19],s20 offen lds
s_waitcnt vmcnt(30)
ds_read_b64_tr_b16 a[60:61],v17 offset:30720
ds_read_b64_tr_b16 a[62:63],v17 offset:31744
ds_read_b64_tr_b16 a[196:197],v18 offset:30720
ds_read_b64_tr_b16 a[198:199],v18 offset:31744
s_waitcnt lgkmcnt(8)
s_add_u32 s20,s41,-3
s_cselect_b32 s47,0,34
s_add_u32 s20,s20,s47
s_mul_i32 s20,s20,20480
s_add_u32 s20,s20,s64
s_add_u32 s23,s22,26624
s_mov_b32 m0,s23
s_nop 0
buffer_load_dwordx4 v16,s[16:19],s20 offen lds
s_add_u32 s23,s22,27648
s_mov_b32 m0,s23
s_add_u32 s20,s20,10240
buffer_load_dwordx4 v16,s[16:19],s20 offen lds
s_waitcnt vmcnt(30)
ds_read_b64_tr_b16 a[64:65],v17 offset:32768
ds_read_b64_tr_b16 a[66:67],v17 offset:33792
ds_read_b64_tr_b16 a[200:201],v18 offset:32768
ds_read_b64_tr_b16 a[202:203],v18 offset:33792
s_waitcnt lgkmcnt(8)
s_add_u32 s20,s41,-2
s_cselect_b32 s47,0,34
s_add_u32 s20,s20,s47
s_mul_i32 s20,s20,20480
s_add_u32 s20,s20,s64
s_add_u32 s23,s22,28672
s_mov_b32 m0,s23
s_nop 0
buffer_load_dwordx4 v16,s[16:19],s20 offen lds
s_add_u32 s23,s22,29696
s_mov_b32 m0,s23
s_add_u32 s20,s20,10240
buffer_load_dwordx4 v16,s[16:19],s20 offen lds
s_waitcnt vmcnt(30)
ds_read_b64_tr_b16 a[68:69],v17 offset:34816
ds_read_b64_tr_b16 a[70:71],v17 offset:35840
ds_read_b64_tr_b16 a[204:205],v18 offset:34816
ds_read_b64_tr_b16 a[206:207],v18 offset:35840
s_waitcnt lgkmcnt(8)
s_add_u32 s20,s41,-1
s_cselect_b32 s47,0,34
s_add_u32 s20,s20,s47
s_mul_i32 s20,s20,20480
s_add_u32 s20,s20,s64
s_add_u32 s23,s22,30720
s_mov_b32 m0,s23
s_nop 0
buffer_load_dwordx4 v16,s[16:19],s20 offen lds
s_add_u32 s23,s22,31744
s_mov_b32 m0,s23
s_add_u32 s20,s20,10240
buffer_load_dwordx4 v16,s[16:19],s20 offen lds
s_waitcnt vmcnt(30)
ds_read_b64_tr_b16 a[72:73],v17
ds_read_b64_tr_b16 a[74:75],v17 offset:1024
ds_read_b64_tr_b16 a[208:209],v18
ds_read_b64_tr_b16 a[210:211],v18 offset:1024
s_waitcnt vmcnt(28)
ds_read_b64_tr_b16 a[76:77],v17 offset:2048
ds_read_b64_tr_b16 a[78:79],v17 offset:3072
ds_read_b64_tr_b16 a[212:213],v18 offset:2048
ds_read_b64_tr_b16 a[214:215],v18 offset:3072
s_waitcnt vmcnt(26)
ds_read_b64_tr_b16 a[80:81],v17 offset:4096
ds_read_b64_tr_b16 a[82:83],v17 offset:5120
ds_read_b64_tr_b16 a[216:217],v18 offset:4096
ds_read_b64_tr_b16 a[218:219],v18 offset:5120
s_waitcnt vmcnt(24)
ds_read_b64_tr_b16 a[84:85],v17 offset:6144
ds_read_b64_tr_b16 a[86:87],v17 offset:7168
ds_read_b64_tr_b16 a[220:221],v18 offset:6144
ds_read_b64_tr_b16 a[222:223],v18 offset:7168
s_waitcnt vmcnt(22)
ds_read_b64_tr_b16 a[88:89],v17 offset:8192
ds_read_b64_tr_b16 a[90:91],v17 offset:9216
ds_read_b64_tr_b16 a[224:225],v18 offset:8192
ds_read_b64_tr_b16 a[226:227],v18 offset:9216
s_waitcnt vmcnt(20)
ds_read_b64_tr_b16 a[92:93],v17 offset:10240
ds_read_b64_tr_b16 a[94:95],v17 offset:11264
ds_read_b64_tr_b16 a[228:229],v18 offset:10240
ds_read_b64_tr_b16 a[230:231],v18 offset:11264
s_waitcnt vmcnt(18)
ds_read_b64_tr_b16 a[96:97],v17 offset:12288
ds_read_b64_tr_b16 a[98:99],v17 offset:13312
ds_read_b64_tr_b16 a[232:233],v18 offset:12288
ds_read_b64_tr_b16 a[234:235],v18 offset:13312
s_waitcnt vmcnt(16)
ds_read_b64_tr_b16 a[100:101],v17 offset:14336
ds_read_b64_tr_b16 a[102:103],v17 offset:15360
ds_read_b64_tr_b16 a[236:237],v18 offset:14336
ds_read_b64_tr_b16 a[238:239],v18 offset:15360
s_waitcnt vmcnt(14)
ds_read_b64_tr_b16 a[104:105],v17 offset:16384
ds_read_b64_tr_b16 a[106:107],v17 offset:17408
ds_read_b64_tr_b16 a[240:241],v18 offset:16384
ds_read_b64_tr_b16 a[242:243],v18 offset:17408
s_waitcnt vmcnt(12)
ds_read_b64_tr_b16 a[108:109],v17 offset:18432
ds_read_b64_tr_b16 a[110:111],v17 offset:19456
ds_read_b64_tr_b16 a[244:245],v18 offset:18432
ds_read_b64_tr_b16 a[246:247],v18 offset:19456
s_waitcnt vmcnt(10)
ds_read_b64_tr_b16 a[112:113],v17 offset:20480
ds_read_b64_tr_b16 a[114:115],v17 offset:21504
ds_read_b64_tr_b16 a[248:249],v18 offset:20480
ds_read_b64_tr_b16 a[250:251],v18 offset:21504
s_waitcnt vmcnt(8)
ds_read_b64_tr_b16 a[116:117],v17 offset:22528
ds_read_b64_tr_b16 a[118:119],v17 offset:23552
ds_read_b64_tr_b16 a[252:253],v18 offset:22528
ds_read_b64_tr_b16 a[254:255],v18 offset:23552
s_waitcnt vmcnt(6)
ds_read_b64_tr_b16 a[120:121],v17 offset:24576
ds_read_b64_tr_b16 a[122:123],v17 offset:25600
ds_read_b64_tr_b16 v[240:241],v18 offset:24576
ds_read_b64_tr_b16 v[242:243],v18 offset:25600
s_waitcnt vmcnt(4)
ds_read_b64_tr_b16 a[124:125],v17 offset:26624
ds_read_b64_tr_b16 a[126:127],v17 offset:27648
ds_read_b64_tr_b16 v[244:245],v18 offset:26624
ds_read_b64_tr_b16 v[246:247],v18 offset:27648
s_waitcnt vmcnt(2)
ds_read_b64_tr_b16 a[128:129],v17 offset:28672
ds_read_b64_tr_b16 a[130:131],v17 offset:29696
ds_read_b64_tr_b16 v[248:249],v18 offset:28672
ds_read_b64_tr_b16 v[250:251],v18 offset:29696
s_waitcnt vmcnt(0)
ds_read_b64_tr_b16 a[132:133],v17 offset:30720
ds_read_b64_tr_b16 a[134:135],v17 offset:31744
ds_read_b64_tr_b16 v[252:253],v18 offset:30720
ds_read_b64_tr_b16 v[254:255],v18 offset:31744
s_waitcnt lgkmcnt(0)
s_barrier
s_lshl_b32 s41,s41,10
s_lshr_b32 s20,s2,5
v_and_b32 v17,7,v0
v_min_u32 v16,1,v17
v_lshl_add_u32 v17,v16,3,v17
v_lshlrev_b32 v17,4,v17
s_mov_b32 s38,0
s_nop 0
reg_252:
buffer_load_dword v16,v17,s[12:15],0 offen sc1
s_waitcnt vmcnt(0)
v_readlane_b32 s50,v16,0
v_readlane_b32 s51,v16,1
v_readlane_b32 s52,v16,2
v_readlane_b32 s53,v16,3
v_readlane_b32 s54,v16,4
v_readlane_b32 s55,v16,5
v_readlane_b32 s56,v16,6
v_readlane_b32 s57,v16,7
v_readlane_b32 s58,v16,s20
s_nop 0
s_cmp_ge_u32 s58,32
s_nop 1
s_cbranch_scc1 regd_253
s_add_u32 s59,s50,s51
s_add_u32 s59,s59,s52
s_add_u32 s59,s59,s53
s_add_u32 s59,s59,s54
s_add_u32 s59,s59,s55
s_add_u32 s59,s59,s56
s_add_u32 s59,s59,s57
s_cmp_ge_u32 s59,256
s_cbranch_scc1 regd_253
s_sleep 2
s_add_u32 s38,s38,1
s_cmp_lt_u32 s38,100000
s_cbranch_scc1 reg_252
s_mov_b32 s40,15
s_branch L_fail
regd_253:
s_cmp_ge_u32 s58,32
s_cselect_b32 s21,1,0
v_mov_b32 v16,72
s_mov_b32 s99,128
s_mov_b32 s38,0
poll_254:
buffer_load_dword v17,v16,s[12:15],0 offen sc1
s_waitcnt vmcnt(0)
v_cmp_le_u32 vcc,s99,v17
s_nop 0
s_cmp_eq_u64 vcc,-1
s_nop 1
s_cbranch_scc1 polld_255
s_sleep 8
s_add_u32 s38,s38,1
s_cmp_lt_u32 s38,100000
s_cbranch_scc1 poll_254
s_mov_b32 s40,14
s_branch L_fail
polld_255:
v_readfirstlane_b32 s99,v17
s_nop 0
s_and_b32 s99,s99,1
s_lshl_b32 s99,s99,13
s_mul_i32 s32,s39,0x1000000
s_add_u32 s32,s32,0x5ab0000
s_lshl_b32 s46,s45,10
s_add_u32 s32,s32,s46
s_mul_i32 s46,s39,0x48000
s_add_u32 s46,s46,0x28000
s_lshl_b32 s101,s39,13
s_xor_b32 s101,s101,s99
s_xor_b32 s101,s101,8192
s_add_u32 s46,s46,s101
s_lshr_b32 s47,s45,3
v_add_u32 v2,s47,v0
s_add_u32 s47,s45,33
s_lshr_b32 s47,s47,3
v_min_u32 v2,s47,v2
v_lshlrev_b32 v2,7,v2
v_add_u32 v2,s46,v2
s_mul_i32 s46,s39,0x48000
s_add_u32 s46,s46,0x38000
s_lshl_b32 s101,s39,13
s_xor_b32 s101,s101,s99
s_xor_b32 s101,s101,8192
s_add_u32 s46,s46,s101
s_lshl_b32 s47,s43,7
s_add_u32 s46,s46,s47
v_and_b32 v12,1,v0
v_lshlrev_b32 v12,7,v12
v_add_u32 v12,s46,v12
v_cmp_lt_u32 vcc,31,v0
s_cmp_eq_u32 s44,0
s_cselect_b64 vcc,0,vcc
v_cndmask_b32 v2,v2,v12,vcc
v_cndmask_b32 v3,0,8,vcc
s_not_b64 s[22:23],vcc
s_lshl_b32 s60,s49,11
s_mul_i32 s33,s39,0x300000
s_add_u32 s33,s33,0x3500000
s_add_u32 s33,s33,s60
s_mul_i32 s36,s39,0x300000
s_add_u32 s36,s36,0x3b00000
s_mul_i32 s34,s39,0xa0000
s_add_u32 s34,s34,0x1c0000
s_lshl_b32 s46,s49,12
s_add_u32 s34,s34,s46
s_mul_i32 s37,s39,0x48000
s_add_u32 s37,s37,0x38000
s_lshl_b32 s101,s39,13
s_xor_b32 s101,s101,s99
s_xor_b32 s101,s101,8192
s_add_u32 s37,s37,s101
s_lshl_b32 s61,s49,7
s_add_u32 s37,s37,s61
s_lshl_b32 s61,s49,8
s_add_u32 s63,s36,s61
s_add_u32 s63,s63,40960
s_add_u32 s36,s36,s60
v_and_b32 v10,31,v0
v_lshlrev_b32 v10,3,v10
s_cmp_eq_u32 s44,0
s_cselect_b32 s26,s6,0
s_add_u32 s32,s32,s41
s_sub_u32 s65,s32,34816
s_lshl_b32 s46,s48,14
v_add_u32 v9,s46,v1
s_lshl_b32 s46,s3,12
v_add_u32 v8,s46,v9
s_mov_b32 s58,s60
s_waitcnt vmcnt(0) lgkmcnt(0)
s_getpc_b64 s[60:61]
pc_258:
s_add_u32 s60,s60,ks_top_256-pc_258
s_addc_u32 s61,s61,0
s_mov_b32 s59,ks_fin_257-ks_top_256-4
v_lshlrev_b32 v18,7,v0
v_add_u32 v18,0,v18
v_min_u32 v18,s59,v18
v_mov_b32 v17,s61
v_add_co_u32 v16,vcc,s60,v18
s_nop 1
v_addc_co_u32 v17,vcc,0,v17,vcc
global_load_dword v19,v[16:17],off
s_waitcnt vmcnt(0)
s_mov_b32 s28,0
s_mov_b32 s31,1
s_mov_b32 s30,0
s_mov_b32 s67,64
s_mov_b32 s38,0
poll_259:
buffer_load_dwordx2 v[6:7],v2,s[4:7],0 offen sc1
s_waitcnt vmcnt(0)
s_bitcmp0_b32 s31,0
s_cselect_b64 vcc,s[22:23],0
v_cndmask_b32 v4,v6,v7,vcc
v_add_u32 v4,v3,v4
v_cmp_le_u32 vcc,s31,v4
s_nop 0
s_cmp_eq_u64 vcc,-1
s_nop 1
s_cbranch_scc1 polld_260
s_sleep 2
s_add_u32 s38,s38,1
s_cmp_lt_u32 s38,100000
s_cbranch_scc1 poll_259
s_mov_b32 s40,11
s_branch L_fail
polld_260:
s_cmp_lt_u32 s41,34816
s_cselect_b32 s46,s32,s65
s_add_u32 s46,s46,0
buffer_load_dwordx4 v[48:51],v1,s[4:7],s46 offen sc1
s_cmp_lt_u32 s41,33792
s_cselect_b32 s46,s32,s65
s_add_u32 s46,s46,0
buffer_load_dwordx4 v[52:55],v1,s[4:7],s46 offen offset:1024 sc1
s_cmp_lt_u32 s41,32768
s_cselect_b32 s46,s32,s65
s_add_u32 s46,s46,0
buffer_load_dwordx4 v[56:59],v1,s[4:7],s46 offen offset:2048 sc1
s_cmp_lt_u32 s41,31744
s_cselect_b32 s46,s32,s65
s_add_u32 s46,s46,0
buffer_load_dwordx4 v[60:63],v1,s[4:7],s46 offen offset:3072 sc1
s_cmp_lt_u32 s41,30720
s_cselect_b32 s46,s32,s65
s_add_u32 s46,s46,4096
buffer_load_dwordx4 v[64:67],v1,s[4:7],s46 offen sc1
s_cmp_lt_u32 s41,29696
s_cselect_b32 s46,s32,s65
s_add_u32 s46,s46,4096
buffer_load_dwordx4 v[68:71],v1,s[4:7],s46 offen offset:1024 sc1
s_cmp_lt_u32 s41,28672
s_cselect_b32 s46,s32,s65
s_add_u32 s46,s46,4096
buffer_load_dwordx4 v[72:75],v1,s[4:7],s46 offen offset:2048 sc1
s_cmp_lt_u32 s41,27648
s_cselect_b32 s46,s32,s65
s_add_u32 s46,s46,4096
buffer_load_dwordx4 v[76:79],v1,s[4:7],s46 offen offset:3072 sc1
s_cmp_lt_u32 s41,26624
s_cselect_b32 s46,s32,s65
s_add_u32 s46,s46,8192
buffer_load_dwordx4 v[80:83],v1,s[4:7],s46 offen sc1
s_cmp_lt_u32 s41,25600
s_cselect_b32 s46,s32,s65
s_add_u32 s46,s46,8192
buffer_load_dwordx4 v[84:87],v1,s[4:7],s46 offen offset:1024 sc1
s_cmp_lt_u32 s41,24576
s_cselect_b32 s46,s32,s65
s_add_u32 s46,s46,8192
buffer_load_dwordx4 v[88:91],v1,s[4:7],s46 offen offset:2048 sc1
s_cmp_lt_u32 s41,23552
s_cselect_b32 s46,s32,s65
s_add_u32 s46,s46,8192
buffer_load_dwordx4 v[92:95],v1,s[4:7],s46 offen offset:3072 sc1
s_cmp_lt_u32 s41,22528
s_cselect_b32 s46,s32,s65
s_add_u32 s46,s46,12288
buffer_load_dwordx4 v[96:99],v1,s[4:7],s46 offen sc1
s_cmp_lt_u32 s41,21504
s_cselect_b32 s46,s32,s65
s_add_u32 s46,s46,12288
buffer_load_dwordx4 v[100:103],v1,s[4:7],s46 offen offset:1024 sc1
s_cmp_lt_u32 s41,20480
s_cselect_b32 s46,s32,s65
s_add_u32 s46,s46,12288
buffer_load_dwordx4 v[104:107],v1,s[4:7],s46 offen offset:2048 sc1
s_cmp_lt_u32 s41,19456
s_cselect_b32 s46,s32,s65
s_add_u32 s46,s46,12288
buffer_load_dwordx4 v[108:111],v1,s[4:7],s46 offen offset:3072 sc1
s_cmp_lt_u32 s41,18432
s_cselect_b32 s46,s32,s65
s_add_u32 s46,s46,16384
buffer_load_dwordx4 v[112:115],v1,s[4:7],s46 offen sc1
s_cmp_lt_u32 s41,17408
s_cselect_b32 s46,s32,s65
s_add_u32 s46,s46,16384
buffer_load_dwordx4 v[116:119],v1,s[4:7],s46 offen offset:1024 sc1
ks_top_256:
s_cmp_ge_u32 s28,s67
s_cbranch_scc1 L_end
s_add_u32 s31,s28,2
s_mov_b32 s29,0
s_and_b32 s68,s28,7
s_mul_i32 s68,s68,81920
s_add_u32 s68,s68,s34
s_bfe_u32 s66,s28,0x10003
s_bitcmp0_b32 s31,0
s_cselect_b64 vcc,s[22:23],0
v_cndmask_b32 v4,v6,v7,vcc
v_add_u32 v4,v3,v4
v_cmp_le_u32 vcc,s31,v4
s_nop 0
s_cmp_eq_u64 vcc,-1
s_cselect_b32 s35,1,0
s_waitcnt vmcnt(17)
v_mfma_f32_32x32x16_bf16 v[16:31],a[0:3],v[48:51],0
s_cmp_lt_u32 s41,16384
s_cselect_b32 s46,s32,s65
s_add_u32 s46,s46,16384
buffer_load_dwordx4 v[120:123],v1,s[4:7],s46 offen offset:2048 sc1
v_mfma_f32_32x32x16_bf16 v[32:47],a[136:139],v[48:51],0
s_waitcnt vmcnt(17)
v_mfma_f32_32x32x16_bf16 v[16:31],a[4:7],v[52:55],v[16:31]
s_cmp_lt_u32 s41,15360
s_cselect_b32 s46,s32,s65
s_add_u32 s46,s46,16384
buffer_load_dwordx4 v[124:127],v1,s[4:7],s46 offen offset:3072 sc1
v_mfma_f32_32x32x16_bf16 v[32:47],a[140:143],v[52:55],v[32:47]
s_waitcnt vmcnt(17)
v_mfma_f32_32x32x16_bf16 v[16:31],a[8:11],v[56:59],v[16:31]
s_cmp_lt_u32 s41,14336
s_cselect_b32 s46,s32,s65
s_add_u32 s46,s46,20480
buffer_load_dwordx4 v[128:131],v1,s[4:7],s46 offen sc1
v_mfma_f32_32x32x16_bf16 v[32:47],a[144:147],v[56:59],v[32:47]
s_waitcnt vmcnt(17)
v_mfma_f32_32x32x16_bf16 v[16:31],a[12:15],v[60:63],v[16:31]
s_cmp_lt_u32 s41,13312
s_cselect_b32 s46,s32,s65
s_add_u32 s46,s46,20480
buffer_load_dwordx4 v[132:135],v1,s[4:7],s46 offen offset:1024 sc1
v_mfma_f32_32x32x16_bf16 v[32:47],a[148:151],v[60:63],v[32:47]
s_waitcnt vmcnt(17)
v_mfma_f32_32x32x16_bf16 v[16:31],a[16:19],v[64:67],v[16:31]
s_cmp_lt_u32 s41,12288
s_cselect_b32 s46,s32,s65
s_add_u32 s46,s46,20480
buffer_load_dwordx4 v[136:139],v1,s[4:7],s46 offen offset:2048 sc1
v_mfma_f32_32x32x16_bf16 v[32:47],a[152:155],v[64:67],v[32:47]
s_waitcnt vmcnt(17)
v_mfma_f32_32x32x16_bf16 v[16:31],a[20:23],v[68:71],v[16:31]
s_cmp_lt_u32 s41,11264
s_cselect_b32 s46,s32,s65
s_add_u32 s46,s46,20480
buffer_load_dwordx4 v[140:143],v1,s[4:7],s46 offen offset:3072 sc1
v_mfma_f32_32x32x16_bf16 v[32:47],a[156:159],v[68:71],v[32:47]
s_cmp_lg_u32 s35,0
s_cbranch_scc1 ks_cp_263
buffer_load_dwordx2 v[6:7],v2,s[4:7],0 offen sc1
ks_cp_263:
s_waitcnt vmcnt(17)
v_mfma_f32_32x32x16_bf16 v[16:31],a[24:27],v[72:75],v[16:31]
s_cmp_lt_u32 s41,10240
s_cselect_b32 s46,s32,s65
s_add_u32 s46,s46,24576
buffer_load_dwordx4 v[144:147],v1,s[4:7],s46 offen sc1
v_mfma_f32_32x32x16_bf16 v[32:47],a[160:163],v[72:75],v[32:47]
s_waitcnt vmcnt(17)
v_mfma_f32_32x32x16_bf16 v[16:31],a[28:31],v[76:79],v[16:31]
s_cmp_lt_u32 s41,9216
s_cselect_b32 s46,s32,s65
s_add_u32 s46,s46,24576
buffer_load_dwordx4 v[148:151],v1,s[4:7],s46 offen offset:1024 sc1
v_mfma_f32_32x32x16_bf16 v[32:47],a[164:167],v[76:79],v[32:47]
s_waitcnt vmcnt(17)
v_mfma_f32_32x32x16_bf16 v[16:31],a[32:35],v[80:83],v[16:31]
s_cmp_lt_u32 s41,8192
s_cselect_b32 s46,s32,s65
s_add_u32 s46,s46,24576
buffer_load_dwordx4 v[152:155],v1,s[4:7],s46 offen offset:2048 sc1
v_mfma_f32_32x32x16_bf16 v[32:47],a[168:171],v[80:83],v[32:47]
s_waitcnt vmcnt(17)
v_mfma_f32_32x32x16_bf16 v[16:31],a[36:39],v[84:87],v[16:31]
s_cmp_lt_u32 s41,7168
s_cselect_b32 s46,s32,s65
s_add_u32 s46,s46,24576
buffer_load_dwordx4 v[156:159],v1,s[4:7],s46 offen offset:3072 sc1
v_mfma_f32_32x32x16_bf16 v[32:47],a[172:175],v[84:87],v[32:47]
s_waitcnt vmcnt(17)
v_mfma_f32_32x32x16_bf16 v[16:31],a[40:43],v[88:91],v[16:31]
s_cmp_lt_u32 s41,6144
s_cselect_b32 s46,s32,s65
s_add_u32 s46,s46,28672
buffer_load_dwordx4 v[160:163],v1,s[4:7],s46 offen sc1
v_mfma_f32_32x32x16_bf16 v[32:47],a[176:179],v[88:91],v[32:47]
s_waitcnt vmcnt(17)
v_mfma_f32_32x32x16_bf16 v[16:31],a[44:47],v[92:95],v[16:31]
s_cmp_lt_u32 s41,5120
s_cselect_b32 s46,s32,s65
s_add_u32 s46,s46,28672
buffer_load_dwordx4 v[164:167],v1,s[4:7],s46 offen offset:1024 sc1
v_mfma_f32_32x32x16_bf16 v[32:47],a[180:183],v[92:95],v[32:47]
s_waitcnt vmcnt(17)
v_mfma_f32_32x32x16_bf16 v[16:31],a[48:51],v[96:99],v[16:31]
s_cmp_lt_u32 s41,4096
s_cselect_b32 s46,s32,s65
s_add_u32 s46,s46,28672
buffer_load_dwordx4 v[168:171],v1,s[4:7],s46 offen offset:2048 sc1
v_mfma_f32_32x32x16_bf16 v[32:47],a[184:187],v[96:99],v[32:47]
s_waitcnt vmcnt(17)
v_mfma_f32_32x32x16_bf16 v[16:31],a[52:55],v[100:103],v[16:31]
s_cmp_lt_u32 s41,3072
s_cselect_b32 s46,s32,s65
s_add_u32 s46,s46,28672
buffer_load_dwordx4 v[172:175],v1,s[4:7],s46 offen offset:3072 sc1
v_mfma_f32_32x32x16_bf16 v[32:47],a[188:191],v[100:103],v[32:47]
s_waitcnt vmcnt(17)
v_mfma_f32_32x32x16_bf16 v[16:31],a[56:59],v[104:107],v[16:31]
s_cmp_lt_u32 s41,2048
s_cselect_b32 s46,s32,s65
s_add_u32 s46,s46,32768
buffer_load_dwordx4 v[176:179],v1,s[4:7],s46 offen sc1
v_mfma_f32_32x32x16_bf16 v[32:47],a[192:195],v[104:107],v[32:47]
s_waitcnt vmcnt(17)
v_mfma_f32_32x32x16_bf16 v[16:31],a[60:63],v[108:111],v[16:31]
s_cmp_lt_u32 s41,1024
s_cselect_b32 s46,s32,s65
s_add_u32 s46,s46,32768
buffer_load_dwordx4 v[180:183],v1,s[4:7],s46 offen offset:1024 sc1
v_mfma_f32_32x32x16_bf16 v[32:47],a[196:199],v[108:111],v[32:47]
s_waitcnt vmcnt(10)
s_bitcmp0_b32 s31,0
s_cselect_b64 vcc,s[22:23],0
v_cndmask_b32 v4,v6,v7,vcc
v_add_u32 v4,v3,v4
v_cmp_le_u32 vcc,s31,v4
s_nop 0
s_cmp_eq_u64 vcc,-1
s_cbranch_scc0 ks_n_261
s_mov_b32 s29,1
s_waitcnt vmcnt(17)
v_mfma_f32_32x32x16_bf16 v[16:31],a[64:67],v[112:115],v[16:31]
s_cmp_lt_u32 s41,34816
s_cselect_b32 s46,s32,s65
s_add_u32 s46,s46,262144
buffer_load_dwordx4 v[48:51],v1,s[4:7],s46 offen sc1
v_mfma_f32_32x32x16_bf16 v[32:47],a[200:203],v[112:115],v[32:47]
s_waitcnt vmcnt(17)
v_mfma_f32_32x32x16_bf16 v[16:31],a[68:71],v[116:119],v[16:31]
s_cmp_lt_u32 s41,33792
s_cselect_b32 s46,s32,s65
s_add_u32 s46,s46,262144
buffer_load_dwordx4 v[52:55],v1,s[4:7],s46 offen offset:1024 sc1
v_mfma_f32_32x32x16_bf16 v[32:47],a[204:207],v[116:119],v[32:47]
s_waitcnt vmcnt(17)
v_mfma_f32_32x32x16_bf16 v[16:31],a[72:75],v[120:123],v[16:31]
s_cmp_lt_u32 s41,32768
s_cselect_b32 s46,s32,s65
s_add_u32 s46,s46,262144
buffer_load_dwordx4 v[56:59],v1,s[4:7],s46 offen offset:2048 sc1
v_mfma_f32_32x32x16_bf16 v[32:47],a[208:211],v[120:123],v[32:47]
s_waitcnt vmcnt(17)
v_mfma_f32_32x32x16_bf16 v[16:31],a[76:79],v[124:127],v[16:31]
s_cmp_lt_u32 s41,31744
s_cselect_b32 s46,s32,s65
s_add_u32 s46,s46,262144
buffer_load_dwordx4 v[60:63],v1,s[4:7],s46 offen offset:3072 sc1
v_mfma_f32_32x32x16_bf16 v[32:47],a[212:215],v[124:127],v[32:47]
s_waitcnt vmcnt(17)
v_mfma_f32_32x32x16_bf16 v[16:31],a[80:83],v[128:131],v[16:31]
s_cmp_lt_u32 s41,30720
s_cselect_b32 s46,s32,s65
s_add_u32 s46,s46,266240
buffer_load_dwordx4 v[64:67],v1,s[4:7],s46 offen sc1
v_mfma_f32_32x32x16_bf16 v[32:47],a[216:219],v[128:131],v[32:47]
s_waitcnt vmcnt(17)
v_mfma_f32_32x32x16_bf16 v[16:31],a[84:87],v[132:135],v[16:31]
s_cmp_lt_u32 s41,29696
s_cselect_b32 s46,s32,s65
s_add_u32 s46,s46,266240
buffer_load_dwordx4 v[68:71],v1,s[4:7],s46 offen offset:1024 sc1
v_mfma_f32_32x32x16_bf16 v[32:47],a[220:223],v[132:135],v[32:47]
s_waitcnt vmcnt(17)
v_mfma_f32_32x32x16_bf16 v[16:31],a[88:91],v[136:139],v[16:31]
s_cmp_lt_u32 s41,28672
s_cselect_b32 s46,s32,s65
s_add_u32 s46,s46,266240
buffer_load_dwordx4 v[72:75],v1,s[4:7],s46 offen offset:2048 sc1
v_mfma_f32_32x32x16_bf16 v[32:47],a[224:227],v[136:139],v[32:47]
s_waitcnt vmcnt(17)
v_mfma_f32_32x32x16_bf16 v[16:31],a[92:95],v[140:143],v[16:31]
s_cmp_lt_u32 s41,27648
s_cselect_b32 s46,s32,s65
s_add_u32 s46,s46,266240
buffer_load_dwordx4 v[76:79],v1,s[4:7],s46 offen offset:3072 sc1
v_mfma_f32_32x32x16_bf16 v[32:47],a[228:231],v[140:143],v[32:47]
s_waitcnt vmcnt(17)
v_mfma_f32_32x32x16_bf16 v[16:31],a[96:99],v[144:147],v[16:31]
s_cmp_lt_u32 s41,26624
s_cselect_b32 s46,s32,s65
s_add_u32 s46,s46,270336
buffer_load_dwordx4 v[80:83],v1,s[4:7],s46 offen sc1
v_mfma_f32_32x32x16_bf16 v[32:47],a[232:235],v[144:147],v[32:47]
s_waitcnt vmcnt(17)
v_mfma_f32_32x32x16_bf16 v[16:31],a[100:103],v[148:151],v[16:31]
s_cmp_lt_u32 s41,25600
s_cselect_b32 s46,s32,s65
s_add_u32 s46,s46,270336
buffer_load_dwordx4 v[84:87],v1,s[4:7],s46 offen offset:1024 sc1
v_mfma_f32_32x32x16_bf16 v[32:47],a[236:239],v[148:151],v[32:47]
s_waitcnt vmcnt(17)
v_mfma_f32_32x32x16_bf16 v[16:31],a[104:107],v[152:155],v[16:31]
s_cmp_lt_u32 s41,24576
s_cselect_b32 s46,s32,s65
s_add_u32 s46,s46,270336
buffer_load_dwordx4 v[88:91],v1,s[4:7],s46 offen offset:2048 sc1
v_mfma_f32_32x32x16_bf16 v[32:47],a[240:243],v[152:155],v[32:47]
s_waitcnt vmcnt(17)
v_mfma_f32_32x32x16_bf16 v[16:31],a[108:111],v[156:159],v[16:31]
s_cmp_lt_u32 s41,23552
s_cselect_b32 s46,s32,s65
s_add_u32 s46,s46,270336
buffer_load_dwordx4 v[92:95],v1,s[4:7],s46 offen offset:3072 sc1
v_mfma_f32_32x32x16_bf16 v[32:47],a[244:247],v[156:159],v[32:47]
s_waitcnt vmcnt(17)
v_mfma_f32_32x32x16_bf16 v[16:31],a[112:115],v[160:163],v[16:31]
s_cmp_lt_u32 s41,22528
s_cselect_b32 s46,s32,s65
s_add_u32 s46,s46,274432
buffer_load_dwordx4 v[96:99],v1,s[4:7],s46 offen sc1
v_mfma_f32_32x32x16_bf16 v[32:47],a[248:251],v[160:163],v[32:47]
s_waitcnt vmcnt(17)
v_mfma_f32_32x32x16_bf16 v[16:31],a[116:119],v[164:167],v[16:31]
s_cmp_lt_u32 s41,21504
s_cselect_b32 s46,s32,s65
s_add_u32 s46,s46,274432
buffer_load_dwordx4 v[100:103],v1,s[4:7],s46 offen offset:1024 sc1
v_mfma_f32_32x32x16_bf16 v[32:47],a[252:255],v[164:167],v[32:47]
s_waitcnt vmcnt(17)
v_mfma_f32_32x32x16_bf16 v[16:31],a[120:123],v[168:171],v[16:31]
s_cmp_lt_u32 s41,20480
s_cselect_b32 s46,s32,s65
s_add_u32 s46,s46,274432
buffer_load_dwordx4 v[104:107],v1,s[4:7],s46 offen offset:2048 sc1
v_mfma_f32_32x32x16_bf16 v[32:47],v[240:243],v[168:171],v[32:47]
s_waitcnt vmcnt(17)
v_mfma_f32_32x32x16_bf16 v[16:31],a[124:127],v[172:175],v[16:31]
s_cmp_lt_u32 s41,19456
s_cselect_b32 s46,s32,s65
s_add_u32 s46,s46,274432
buffer_load_dwordx4 v[108:111],v1,s[4:7],s46 offen offset:3072 sc1
v_mfma_f32_32x32x16_bf16 v[32:47],v[244:247],v[172:175],v[32:47]
s_waitcnt vmcnt(17)
v_mfma_f32_32x32x16_bf16 v[16:31],a[128:131],v[176:179],v[16:31]
s_cmp_lt_u32 s41,18432
s_cselect_b32 s46,s32,s65
s_add_u32 s46,s46,278528
buffer_load_dwordx4 v[112:115],v1,s[4:7],s46 offen sc1
v_mfma_f32_32x32x16_bf16 v[32:47],v[248:251],v[176:179],v[32:47]
s_waitcnt vmcnt(17)
v_mfma_f32_32x32x16_bf16 v[32:47],v[252:255],v[180:183],v[32:47]
v_mfma_f32_32x32x16_bf16 v[16:31],a[132:135],v[180:183],v[16:31]
s_cmp_lt_u32 s41,17408
s_cselect_b32 s46,s32,s65
s_add_u32 s46,s46,278528
buffer_load_dwordx4 v[116:119],v1,s[4:7],s46 offen offset:1024 sc1
s_branch ks_j_262
ks_n_261:
s_waitcnt vmcnt(17)
v_mfma_f32_32x32x16_bf16 v[16:31],a[64:67],v[112:115],v[16:31]
v_mfma_f32_32x32x16_bf16 v[32:47],a[200:203],v[112:115],v[32:47]
s_waitcnt vmcnt(16)
v_mfma_f32_32x32x16_bf16 v[16:31],a[68:71],v[116:119],v[16:31]
v_mfma_f32_32x32x16_bf16 v[32:47],a[204:207],v[116:119],v[32:47]
s_waitcnt vmcnt(15)
v_mfma_f32_32x32x16_bf16 v[16:31],a[72:75],v[120:123],v[16:31]
v_mfma_f32_32x32x16_bf16 v[32:47],a[208:211],v[120:123],v[32:47]
s_waitcnt vmcnt(14)
v_mfma_f32_32x32x16_bf16 v[16:31],a[76:79],v[124:127],v[16:31]
v_mfma_f32_32x32x16_bf16 v[32:47],a[212:215],v[124:127],v[32:47]
s_waitcnt vmcnt(13)
v_mfma_f32_32x32x16_bf16 v[16:31],a[80:83],v[128:131],v[16:31]
v_mfma_f32_32x32x16_bf16 v[32:47],a[216:219],v[128:131],v[32:47]
s_waitcnt vmcnt(12)
v_mfma_f32_32x32x16_bf16 v[16:31],a[84:87],v[132:135],v[16:31]
v_mfma_f32_32x32x16_bf16 v[32:47],a[220:223],v[132:135],v[32:47]
s_waitcnt vmcnt(11)
v_mfma_f32_32x32x16_bf16 v[16:31],a[88:91],v[136:139],v[16:31]
v_mfma_f32_32x32x16_bf16 v[32:47],a[224:227],v[136:139],v[32:47]
s_waitcnt vmcnt(10)
v_mfma_f32_32x32x16_bf16 v[16:31],a[92:95],v[140:143],v[16:31]
v_mfma_f32_32x32x16_bf16 v[32:47],a[228:231],v[140:143],v[32:47]
s_waitcnt vmcnt(9)
v_mfma_f32_32x32x16_bf16 v[16:31],a[96:99],v[144:147],v[16:31]
v_mfma_f32_32x32x16_bf16 v[32:47],a[232:235],v[144:147],v[32:47]
s_waitcnt vmcnt(8)
v_mfma_f32_32x32x16_bf16 v[16:31],a[100:103],v[148:151],v[16:31]
v_mfma_f32_32x32x16_bf16 v[32:47],a[236:239],v[148:151],v[32:47]
s_waitcnt vmcnt(7)
v_mfma_f32_32x32x16_bf16 v[16:31],a[104:107],v[152:155],v[16:31]
v_mfma_f32_32x32x16_bf16 v[32:47],a[240:243],v[152:155],v[32:47]
s_waitcnt vmcnt(6)
v_mfma_f32_32x32x16_bf16 v[16:31],a[108:111],v[156:159],v[16:31]
v_mfma_f32_32x32x16_bf16 v[32:47],a[244:247],v[156:159],v[32:47]
s_waitcnt vmcnt(5)
v_mfma_f32_32x32x16_bf16 v[16:31],a[112:115],v[160:163],v[16:31]
v_mfma_f32_32x32x16_bf16 v[32:47],a[248:251],v[160:163],v[32:47]
s_waitcnt vmcnt(4)
v_mfma_f32_32x32x16_bf16 v[16:31],a[116:119],v[164:167],v[16:31]
v_mfma_f32_32x32x16_bf16 v[32:47],a[252:255],v[164:167],v[32:47]
s_waitcnt vmcnt(3)
v_mfma_f32_32x32x16_bf16 v[16:31],a[120:123],v[168:171],v[16:31]
v_mfma_f32_32x32x16_bf16 v[32:47],v[240:243],v[168:171],v[32:47]
s_waitcnt vmcnt(2)
v_mfma_f32_32x32x16_bf16 v[16:31],a[124:127],v[172:175],v[16:31]
v_mfma_f32_32x32x16_bf16 v[32:47],v[244:247],v[172:175],v[32:47]
s_waitcnt vmcnt(1)
v_mfma_f32_32x32x16_bf16 v[16:31],a[128:131],v[176:179],v[16:31]
v_mfma_f32_32x32x16_bf16 v[32:47],v[248:251],v[176:179],v[32:47]
s_waitcnt vmcnt(0)
v_mfma_f32_32x32x16_bf16 v[32:47],v[252:255],v[180:183],v[32:47]
v_mfma_f32_32x32x16_bf16 v[16:31],a[132:135],v[180:183],v[16:31]
s_nop 11
ks_j_262:
s_nop 7
s_nop 1
s_add_u32 s32,s32,262144
s_add_u32 s65,s65,262144
v_xor_b32 v12,0x4000,v8
ds_write_b128 v12,v[32:35]
ds_write_b128 v12,v[36:39] offset:1024
ds_write_b128 v12,v[40:43] offset:2048
ds_write_b128 v12,v[44:47] offset:3072
ds_write_b128 v8,v[16:19]
ds_write_b128 v8,v[20:23] offset:1024
ds_write_b128 v8,v[24:27] offset:2048
ds_write_b128 v8,v[28:31] offset:3072
s_cmp_lg_u32 s29,0
s_cbranch_scc1 ks_cp_265
buffer_load_dwordx2 v[6:7],v2,s[4:7],0 offen sc1
ks_cp_265:
s_waitcnt lgkmcnt(0)
s_barrier
s_cmp_lg_u32 s29,0
s_cbranch_scc1 ks_nf_264
s_waitcnt vmcnt(0)
ks_nf_264:
s_add_u32 s33,s33,49152
s_add_u32 s36,s36,49152
s_add_u32 s63,s63,49152
s_add_u32 s28,s28,1
v_xor_b32 v8,32768,v8
v_xor_b32 v9,32768,v9
s_cmp_lg_u32 s29,0
s_cbranch_scc1 ks_top_256
s_bitcmp0_b32 s31,0
s_cselect_b64 vcc,s[22:23],0
v_cndmask_b32 v4,v6,v7,vcc
v_add_u32 v4,v3,v4
v_cmp_le_u32 vcc,s31,v4
s_nop 0
s_cmp_eq_u64 vcc,-1
s_nop 1
s_cbranch_scc0 ks_np2_267
s_cmp_lt_u32 s41,34816
s_cselect_b32 s46,s32,s65
s_add_u32 s46,s46,0
buffer_load_dwordx4 v[48:51],v1,s[4:7],s46 offen sc1
s_cmp_lt_u32 s41,33792
s_cselect_b32 s46,s32,s65
s_add_u32 s46,s46,0
buffer_load_dwordx4 v[52:55],v1,s[4:7],s46 offen offset:1024 sc1
s_cmp_lt_u32 s41,32768
s_cselect_b32 s46,s32,s65
s_add_u32 s46,s46,0
buffer_load_dwordx4 v[56:59],v1,s[4:7],s46 offen offset:2048 sc1
s_cmp_lt_u32 s41,31744
s_cselect_b32 s46,s32,s65
s_add_u32 s46,s46,0
buffer_load_dwordx4 v[60:63],v1,s[4:7],s46 offen offset:3072 sc1
s_cmp_lt_u32 s41,30720
s_cselect_b32 s46,s32,s65
s_add_u32 s46,s46,4096
buffer_load_dwordx4 v[64:67],v1,s[4:7],s46 offen sc1
s_cmp_lt_u32 s41,29696
s_cselect_b32 s46,s32,s65
s_add_u32 s46,s46,4096
buffer_load_dwordx4 v[68:71],v1,s[4:7],s46 offen offset:1024 sc1
s_cmp_eq_u32 s30,0
s_cbranch_scc1 ks_pb_268
s_waitcnt vmcnt(6)
v_mov_b32 v14,s28
s_mov_b64 exec,1
buffer_store_dword v14,off,s[4:7],s37 sc1
s_mov_b64 exec,-1
s_mov_b32 s30,0
ks_pb_268:
s_cmp_lt_u32 s41,28672
s_cselect_b32 s46,s32,s65
s_add_u32 s46,s46,4096
buffer_load_dwordx4 v[72:75],v1,s[4:7],s46 offen offset:2048 sc1
s_cmp_lt_u32 s41,27648
s_cselect_b32 s46,s32,s65
s_add_u32 s46,s46,4096
buffer_load_dwordx4 v[76:79],v1,s[4:7],s46 offen offset:3072 sc1
s_cmp_lt_u32 s41,26624
s_cselect_b32 s46,s32,s65
s_add_u32 s46,s46,8192
buffer_load_dwordx4 v[80:83],v1,s[4:7],s46 offen sc1
s_cmp_lt_u32 s41,25600
s_cselect_b32 s46,s32,s65
s_add_u32 s46,s46,8192
buffer_load_dwordx4 v[84:87],v1,s[4:7],s46 offen offset:1024 sc1
s_cmp_lt_u32 s41,24576
s_cselect_b32 s46,s32,s65
s_add_u32 s46,s46,8192
buffer_load_dwordx4 v[88:91],v1,s[4:7],s46 offen offset:2048 sc1
s_cmp_lt_u32 s41,23552
s_cselect_b32 s46,s32,s65
s_add_u32 s46,s46,8192
buffer_load_dwordx4 v[92:95],v1,s[4:7],s46 offen offset:3072 sc1
s_cmp_lt_u32 s41,22528
s_cselect_b32 s46,s32,s65
s_add_u32 s46,s46,12288
buffer_load_dwordx4 v[96:99],v1,s[4:7],s46 offen sc1
s_cmp_lt_u32 s41,21504
s_cselect_b32 s46,s32,s65
s_add_u32 s46,s46,12288
buffer_load_dwordx4 v[100:103],v1,s[4:7],s46 offen offset:1024 sc1
s_cmp_lt_u32 s41,20480
s_cselect_b32 s46,s32,s65
s_add_u32 s46,s46,12288
buffer_load_dwordx4 v[104:107],v1,s[4:7],s46 offen offset:2048 sc1
s_cmp_lt_u32 s41,19456
s_cselect_b32 s46,s32,s65
s_add_u32 s46,s46,12288
buffer_load_dwordx4 v[108:111],v1,s[4:7],s46 offen offset:3072 sc1
s_cmp_lt_u32 s41,18432
s_cselect_b32 s46,s32,s65
s_add_u32 s46,s46,16384
buffer_load_dwordx4 v[112:115],v1,s[4:7],s46 offen sc1
s_cmp_lt_u32 s41,17408
s_cselect_b32 s46,s32,s65
s_add_u32 s46,s46,16384
buffer_load_dwordx4 v[116:119],v1,s[4:7],s46 offen offset:1024 sc1
s_branch ks_top_256
ks_np2_267:
s_cmp_eq_u32 s30,0
s_cbranch_scc1 ks_nop_270
buffer_load_dwordx2 v[6:7],v2,s[4:7],0 offen sc1
s_cmp_eq_u32 s30,0
s_cbranch_scc1 ks_pb_271
s_waitcnt vmcnt(1)
v_mov_b32 v14,s28
s_mov_b64 exec,1
buffer_store_dword v14,off,s[4:7],s37 sc1
s_mov_b64 exec,-1
s_mov_b32 s30,0
ks_pb_271:
s_waitcnt vmcnt(1)
s_bitcmp0_b32 s31,0
s_cselect_b64 vcc,s[22:23],0
v_cndmask_b32 v4,v6,v7,vcc
v_add_u32 v4,v3,v4
v_cmp_le_u32 vcc,s31,v4
s_nop 0
s_cmp_eq_u64 vcc,-1
s_nop 1
s_cbranch_scc1 ks_rdy_269
ks_nop_270:
s_cmp_ge_u32 s28,s67
s_cbranch_scc1 ks_fin_257
s_mov_b32 s38,0
poll_272:
buffer_load_dwordx2 v[6:7],v2,s[4:7],0 offen sc1
s_waitcnt vmcnt(0)
s_bitcmp0_b32 s31,0
s_cselect_b64 vcc,s[22:23],0
v_cndmask_b32 v4,v6,v7,vcc
v_add_u32 v4,v3,v4
v_cmp_le_u32 vcc,s31,v4
s_nop 0
s_cmp_eq_u64 vcc,-1
s_nop 1
s_cbranch_scc1 polld_273
s_sleep 2
s_add_u32 s38,s38,1
s_cmp_lt_u32 s38,100000
s_cbranch_scc1 poll_272
s_mov_b32 s40,11
s_branch L_fail
polld_273:
ks_rdy_269:
s_cmp_lt_u32 s41,34816
s_cselect_b32 s46,s32,s65
s_add_u32 s46,s46,0
buffer_load_dwordx4 v[48:51],v1,s[4:7],s46 offen sc1
s_cmp_lt_u32 s41,33792
s_cselect_b32 s46,s32,s65
s_add_u32 s46,s46,0
buffer_load_dwordx4 v[52:55],v1,s[4:7],s46 offen offset:1024 sc1
s_cmp_lt_u32 s41,32768
s_cselect_b32 s46,s32,s65
s_add_u32 s46,s46,0
buffer_load_dwordx4 v[56:59],v1,s[4:7],s46 offen offset:2048 sc1
s_cmp_lt_u32 s41,31744
s_cselect_b32 s46,s32,s65
s_add_u32 s46,s46,0
buffer_load_dwordx4 v[60:63],v1,s[4:7],s46 offen offset:3072 sc1
s_cmp_lt_u32 s41,30720
s_cselect_b32 s46,s32,s65
s_add_u32 s46,s46,4096
buffer_load_dwordx4 v[64:67],v1,s[4:7],s46 offen sc1
s_cmp_lt_u32 s41,29696
s_cselect_b32 s46,s32,s65
s_add_u32 s46,s46,4096
buffer_load_dwordx4 v[68:71],v1,s[4:7],s46 offen offset:1024 sc1
s_cmp_lt_u32 s41,28672
s_cselect_b32 s46,s32,s65
s_add_u32 s46,s46,4096
buffer_load_dwordx4 v[72:75],v1,s[4:7],s46 offen offset:2048 sc1
s_cmp_lt_u32 s41,27648
s_cselect_b32 s46,s32,s65
s_add_u32 s46,s46,4096
buffer_load_dwordx4 v[76:79],v1,s[4:7],s46 offen offset:3072 sc1
s_cmp_lt_u32 s41,26624
s_cselect_b32 s46,s32,s65
s_add_u32 s46,s46,8192
buffer_load_dwordx4 v[80:83],v1,s[4:7],s46 offen sc1
s_cmp_lt_u32 s41,25600
s_cselect_b32 s46,s32,s65
s_add_u32 s46,s46,8192
buffer_load_dwordx4 v[84:87],v1,s[4:7],s46 offen offset:1024 sc1
s_cmp_lt_u32 s41,24576
s_cselect_b32 s46,s32,s65
s_add_u32 s46,s46,8192
buffer_load_dwordx4 v[88:91],v1,s[4:7],s46 offen offset:2048 sc1
s_cmp_lt_u32 s41,23552
s_cselect_b32 s46,s32,s65
s_add_u32 s46,s46,8192
buffer_load_dwordx4 v[92:95],v1,s[4:7],s46 offen offset:3072 sc1
s_cmp_lt_u32 s41,22528
s_cselect_b32 s46,s32,s65
s_add_u32 s46,s46,12288
buffer_load_dwordx4 v[96:99],v1,s[4:7],s46 offen sc1
s_cmp_lt_u32 s41,21504
s_cselect_b32 s46,s32,s65
s_add_u32 s46,s46,12288
buffer_load_dwordx4 v[100:103],v1,s[4:7],s46 offen offset:1024 sc1
s_cmp_lt_u32 s41,20480
s_cselect_b32 s46,s32,s65
s_add_u32 s46,s46,12288
buffer_load_dwordx4 v[104:107],v1,s[4:7],s46 offen offset:2048 sc1
s_cmp_lt_u32 s41,19456
s_cselect_b32 s46,s32,s65
s_add_u32 s46,s46,12288
buffer_load_dwordx4 v[108:111],v1,s[4:7],s46 offen offset:3072 sc1
s_cmp_lt_u32 s41,18432
s_cselect_b32 s46,s32,s65
s_add_u32 s46,s46,16384
buffer_load_dwordx4 v[112:115],v1,s[4:7],s46 offen sc1
s_cmp_lt_u32 s41,17408
s_cselect_b32 s46,s32,s65
s_add_u32 s46,s46,16384
buffer_load_dwordx4 v[116:119],v1,s[4:7],s46 offen offset:1024 sc1
s_branch ks_top_256
ks_fin_257:
s_branch L_end
ls_233:
buffer_store_dwordx4 v[16:19],v1,s[4:7],s68 offen sc1
s_nop 1
s_branch ls_234
ls_235:
buffer_store_dwordx4 v[20:23],v1,s[4:7],s68 offen offset:1024 sc1
s_nop 1
s_branch ls_236
ls_237:
buffer_store_dwordx4 v[24:27],v1,s[4:7],s68 offen offset:2048 sc1
s_nop 1
s_branch ls_238
ls_239:
buffer_store_dwordx4 v[28:31],v1,s[4:7],s68 offen offset:3072 sc1
s_nop 1
s_branch ls_240
R_att:
s_add_u32 s42,s42,s43
s_and_b32 s47,s3,1
s_lshr_b32 s48,s3,1
s_lshl_b32 s41,s42,1
s_add_u32 s41,s41,s47
v_mov_b32 v8,72
s_mov_b32 s99,128
s_mov_b32 s38,0
poll_274:
buffer_load_dword v9,v8,s[12:15],0 offen sc1
s_waitcnt vmcnt(0)
v_cmp_le_u32 vcc,s99,v9
s_nop 0
s_cmp_eq_u64 vcc,-1
s_nop 1
s_cbranch_scc1 polld_275
s_sleep 8
s_add_u32 s38,s38,1
s_cmp_lt_u32 s38,100000
s_cbranch_scc1 poll_274
s_mov_b32 s40,14
s_branch L_fail
polld_275:
v_readfirstlane_b32 s99,v9
s_nop 0
s_and_b32 s99,s99,1
s_lshl_b32 s99,s99,13
v_lshlrev_b32 v1,4,v0
v_mov_b32 v2,0
v_lshlrev_b32 v7,3,v0
v_and_b32 v8,7,v0
v_min_u32 v8,5,v8
v_and_b32 v9,1,v8
v_lshrrev_b32 v8,1,v8
v_lshlrev_b32 v3,4,v8
v_lshl_add_u32 v3,v9,7,v3
s_mul_i32 s43,s39,0x48000
s_add_u32 s43,s43,0x18000
s_lshl_b32 s101,s39,13
s_xor_b32 s101,s101,s99
s_xor_b32 s101,s101,8192
s_add_u32 s43,s43,s101
s_lshl_b32 s44,s41,8
s_add_u32 s43,s43,s44
v_add_u32 v3,s43,v3
s_mul_i32 s43,s39,0x48000
s_add_u32 s43,s43,0x20000
s_lshl_b32 s101,s39,13
s_xor_b32 s101,s101,s99
s_xor_b32 s101,s101,8192
s_add_u32 s43,s43,s101
s_lshl_b32 s44,s41,7
s_add_u32 s43,s43,s44
v_mov_b32 v4,s43
s_mul_i32 s37,s39,0x48000
s_add_u32 s37,s37,0x28000
s_lshl_b32 s101,s39,13
s_xor_b32 s101,s101,s99
s_xor_b32 s101,s101,8192
s_add_u32 s37,s37,s101
s_lshl_b32 s44,s41,7
s_add_u32 s37,s37,s44
s_mul_i32 s32,s39,0x3000000
s_add_u32 s32,s32,0x7ab0000
s_lshr_b32 s44,s41,4
s_lshl_b32 s44,s44,18
s_add_u32 s32,s32,s44
s_lshl_b32 s44,s41,13
s_add_u32 s32,s32,s44
s_mul_i32 s36,s39,0x1000000
s_add_u32 s36,s36,0x5ab0000
s_add_u32 s36,s36,s44
s_mul_i32 s33,s39,0x0
s_add_u32 s33,s33,0x400000
s_lshl_b32 s101,s39,13
s_xor_b32 s101,s101,s99
s_xor_b32 s101,s101,8192
s_add_u32 s33,s33,s101
s_lshl_b32 s44,s42,14
s_add_u32 s33,s33,s44
s_lshl_b32 s44,s47,12
s_add_u32 s33,s33,s44
v_lshrrev_b32 v8,5,v0
v_and_b32 v6,7,v0
v_lshlrev_b32 v6,4,v6
v_lshl_add_u32 v6,v8,7,v6
v_and_b32 v9,31,v0
v_lshlrev_b32 v8,2,v8
v_sub_u32 v8,v9,v8
v_mov_b32 v9,0xff800000
v_cmp_le_i32 vcc,0,v8
s_nop 1
v_cndmask_b32 v60,v9,v2,vcc
v_cmp_le_i32 vcc,1,v8
s_nop 1
v_cndmask_b32 v61,v9,v2,vcc
v_cmp_le_i32 vcc,2,v8
s_nop 1
v_cndmask_b32 v62,v9,v2,vcc
v_cmp_le_i32 vcc,3,v8
s_nop 1
v_cndmask_b32 v63,v9,v2,vcc
v_cmp_le_i32 vcc,8,v8
s_nop 1
v_cndmask_b32 v64,v9,v2,vcc
v_cmp_le_i32 vcc,9,v8
s_nop 1
v_cndmask_b32 v65,v9,v2,vcc
v_cmp_le_i32 vcc,10,v8
s_nop 1
v_cndmask_b32 v66,v9,v2,vcc
v_cmp_le_i32 vcc,11,v8
s_nop 1
v_cndmask_b32 v67,v9,v2,vcc
v_cmp_le_i32 vcc,16,v8
s_nop 1
v_cndmask_b32 v68,v9,v2,vcc
v_cmp_le_i32 vcc,17,v8
s_nop 1
v_cndmask_b32 v69,v9,v2,vcc
v_cmp_le_i32 vcc,18,v8
s_nop 1
v_cndmask_b32 v70,v9,v2,vcc
v_cmp_le_i32 vcc,19,v8
s_nop 1
v_cndmask_b32 v71,v9,v2,vcc
v_cmp_le_i32 vcc,24,v8
s_nop 1
v_cndmask_b32 v72,v9,v2,vcc
v_cmp_le_i32 vcc,25,v8
s_nop 1
v_cndmask_b32 v73,v9,v2,vcc
v_cmp_le_i32 vcc,26,v8
s_nop 1
v_cndmask_b32 v74,v9,v2,vcc
v_cmp_le_i32 vcc,27,v8
s_nop 1
v_cndmask_b32 v75,v9,v2,vcc
s_mov_b32 s35,0x3e0293ee
s_mov_b32 s28,s48
s_mul_i32 s44,s48,786432
s_add_u32 s32,s32,s44
s_mul_i32 s44,s48,262144
s_add_u32 s36,s36,s44
s_lshl_b32 s44,s48,2
s_add_u32 s37,s37,s44
s_waitcnt vmcnt(0) lgkmcnt(0)
s_getpc_b64 s[60:61]
pc_277:
s_add_u32 s60,s60,att_top_276-pc_277
s_addc_u32 s61,s61,0
s_mov_b32 s59,att_fin-att_top_276-4
v_lshlrev_b32 v18,7,v0
v_add_u32 v18,0,v18
v_min_u32 v18,s59,v18
v_mov_b32 v17,s61
v_add_co_u32 v16,vcc,s60,v18
s_nop 1
v_addc_co_u32 v17,vcc,0,v17,vcc
global_load_dword v19,v[16:17],off
s_waitcnt vmcnt(0)
s_add_u32 s49,s28,1
s_add_u32 s46,s28,0
s_mul_i32 s59,s46,43
s_lshr_b32 s59,s59,7
s_mul_i32 s59,s59,3
s_sub_u32 s59,s46,s59
s_min_u32 s101,s46,42
s_sub_u32 s101,s101,33
s_and_b32 s101,s101,1
s_cmp_lt_u32 s46,33
s_cselect_b32 s46,s59,s101
s_cmp_eq_u32 s39,0
s_cselect_b32 s46,s46,0
s_lshl_b32 s46,s46,2
s_mov_b32 s38,0
poll_278:
buffer_load_dword v5,v3,s[4:7],s46 offen sc1
s_waitcnt vmcnt(0)
v_cmp_le_u32 vcc,s49,v5
s_nop 0
s_cmp_eq_u64 vcc,-1
s_nop 1
s_cbranch_scc1 polld_279
s_sleep 2
s_add_u32 s38,s38,1
s_cmp_lt_u32 s38,100000
s_cbranch_scc1 poll_278
s_mov_b32 s40,6
s_branch L_fail
polld_279:
s_add_u32 s44,s32,0
buffer_load_dwordx4 a[0:3],v1,s[4:7],s44 offen sc1
buffer_load_dwordx4 a[4:7],v1,s[4:7],s44 offen offset:1024 sc1
buffer_load_dwordx4 a[8:11],v1,s[4:7],s44 offen offset:2048 sc1
buffer_load_dwordx4 a[12:15],v1,s[4:7],s44 offen offset:3072 sc1
s_add_u32 s44,s32,4096
buffer_load_dwordx4 a[16:19],v1,s[4:7],s44 offen sc1
buffer_load_dwordx4 a[20:23],v1,s[4:7],s44 offen offset:1024 sc1
buffer_load_dwordx4 a[24:27],v1,s[4:7],s44 offen offset:2048 sc1
buffer_load_dwordx4 a[28:31],v1,s[4:7],s44 offen offset:3072 sc1
s_add_u32 s44,s32,131072
buffer_load_dwordx4 a[32:35],v1,s[4:7],s44 offen sc1
buffer_load_dwordx4 a[36:39],v1,s[4:7],s44 offen offset:1024 sc1
buffer_load_dwordx4 a[40:43],v1,s[4:7],s44 offen offset:2048 sc1
buffer_load_dwordx4 a[44:47],v1,s[4:7],s44 offen offset:3072 sc1
s_add_u32 s44,s32,135168
buffer_load_dwordx4 a[48:51],v1,s[4:7],s44 offen sc1
buffer_load_dwordx4 a[52:55],v1,s[4:7],s44 offen offset:1024 sc1
buffer_load_dwordx4 a[56:59],v1,s[4:7],s44 offen offset:2048 sc1
buffer_load_dwordx4 a[60:63],v1,s[4:7],s44 offen offset:3072 sc1
s_add_u32 s44,s32,262144
buffer_load_dwordx4 a[64:67],v1,s[4:7],s44 offen sc1
buffer_load_dwordx4 a[68:71],v1,s[4:7],s44 offen offset:1024 sc1
buffer_load_dwordx4 a[72:75],v1,s[4:7],s44 offen offset:2048 sc1
buffer_load_dwordx4 a[76:79],v1,s[4:7],s44 offen offset:3072 sc1
s_add_u32 s44,s32,266240
buffer_load_dwordx4 a[80:83],v1,s[4:7],s44 offen sc1
buffer_load_dwordx4 a[84:87],v1,s[4:7],s44 offen offset:1024 sc1
buffer_load_dwordx4 a[88:91],v1,s[4:7],s44 offen offset:2048 sc1
buffer_load_dwordx4 a[92:95],v1,s[4:7],s44 offen offset:3072 sc1
s_add_u32 s32,s32,1572864
att_top_276:
s_cmp_ge_u32 s28,64
s_cbranch_scc1 L_end
s_add_u32 s31,s28,1
s_add_u32 s49,s28,3
s_add_u32 s46,s28,2
s_mul_i32 s59,s46,43
s_lshr_b32 s59,s59,7
s_mul_i32 s59,s59,3
s_sub_u32 s59,s46,s59
s_min_u32 s101,s46,42
s_sub_u32 s101,s101,33
s_and_b32 s101,s101,1
s_cmp_lt_u32 s46,33
s_cselect_b32 s46,s59,s101
s_cmp_eq_u32 s39,0
s_cselect_b32 s46,s46,0
s_lshl_b32 s46,s46,2
s_waitcnt vmcnt(8)
v_mfma_f32_32x32x16_bf16 v[76:91],a[32:35],a[0:3],v[60:75]
v_mfma_f32_32x32x16_bf16 v[76:91],a[36:39],a[4:7],v[76:91]
v_mfma_f32_32x32x16_bf16 v[76:91],a[40:43],a[8:11],v[76:91]
v_mfma_f32_32x32x16_bf16 v[76:91],a[44:47],a[12:15],v[76:91]
v_mfma_f32_32x32x16_bf16 v[76:91],a[48:51],a[16:19],v[76:91]
v_mfma_f32_32x32x16_bf16 v[76:91],a[52:55],a[20:23],v[76:91]
v_mfma_f32_32x32x16_bf16 v[76:91],a[56:59],a[24:27],v[76:91]
v_mfma_f32_32x32x16_bf16 v[76:91],a[60:63],a[28:31],v[76:91]
s_nop 11
v_max3_f32 v8,v76,v77,v78
v_max3_f32 v8,v8,v79,v80
v_max3_f32 v8,v8,v81,v82
v_max3_f32 v8,v8,v83,v84
v_max3_f32 v8,v8,v85,v86
v_max3_f32 v8,v8,v87,v88
v_max3_f32 v8,v8,v89,v90
v_max_f32 v8,v8,v91
v_mov_b32 v9,v8
s_nop 1
v_permlane32_swap_b32 v8,v9
s_nop 0
v_max_f32 v12,v8,v9
v_pk_add_f32 v[76:77],v[76:77],v[12:13] op_sel_hi:[1,0] neg_lo:[0,1] neg_hi:[0,1]
v_pk_add_f32 v[78:79],v[78:79],v[12:13] op_sel_hi:[1,0] neg_lo:[0,1] neg_hi:[0,1]
v_pk_add_f32 v[80:81],v[80:81],v[12:13] op_sel_hi:[1,0] neg_lo:[0,1] neg_hi:[0,1]
v_pk_add_f32 v[82:83],v[82:83],v[12:13] op_sel_hi:[1,0] neg_lo:[0,1] neg_hi:[0,1]
v_pk_add_f32 v[84:85],v[84:85],v[12:13] op_sel_hi:[1,0] neg_lo:[0,1] neg_hi:[0,1]
v_pk_add_f32 v[86:87],v[86:87],v[12:13] op_sel_hi:[1,0] neg_lo:[0,1] neg_hi:[0,1]
v_pk_add_f32 v[88:89],v[88:89],v[12:13] op_sel_hi:[1,0] neg_lo:[0,1] neg_hi:[0,1]
v_pk_add_f32 v[90:91],v[90:91],v[12:13] op_sel_hi:[1,0] neg_lo:[0,1] neg_hi:[0,1]
v_exp_f32 v76,v76
v_exp_f32 v77,v77
v_exp_f32 v78,v78
v_exp_f32 v79,v79
v_exp_f32 v80,v80
v_exp_f32 v81,v81
v_exp_f32 v82,v82
v_exp_f32 v83,v83
v_exp_f32 v84,v84
v_exp_f32 v85,v85
v_exp_f32 v86,v86
v_exp_f32 v87,v87
v_exp_f32 v88,v88
v_exp_f32 v89,v89
v_exp_f32 v90,v90
v_exp_f32 v91,v91
v_cvt_pk_bf16_f32 v108,v76,v77
v_cvt_pk_bf16_f32 v109,v78,v79
v_cvt_pk_bf16_f32 v110,v80,v81
v_cvt_pk_bf16_f32 v111,v82,v83
v_cvt_pk_bf16_f32 v112,v84,v85
v_cvt_pk_bf16_f32 v113,v86,v87
v_cvt_pk_bf16_f32 v114,v88,v89
v_cvt_pk_bf16_f32 v115,v90,v91
s_waitcnt vmcnt(0)
v_mfma_f32_32x32x16_bf16 v[120:135],a[64:67],v[108:111],0
v_mfma_f32_32x32x16_bf16 v[120:135],a[68:71],v[112:115],v[120:135]
v_mfma_f32_32x32x16_bf16 v[136:151],a[72:75],v[108:111],0
v_mfma_f32_32x32x16_bf16 v[136:151],a[76:79],v[112:115],v[136:151]
v_mfma_f32_32x32x16_bf16 v[152:167],a[80:83],v[108:111],0
v_mfma_f32_32x32x16_bf16 v[152:167],a[84:87],v[112:115],v[152:167]
v_mfma_f32_32x32x16_bf16 v[168:183],a[88:91],v[108:111],0
v_mfma_f32_32x32x16_bf16 v[168:183],a[92:95],v[112:115],v[168:183]
v_add_f32 v76,v76,v84
v_add_f32 v77,v77,v85
v_add_f32 v78,v78,v86
v_add_f32 v79,v79,v87
v_add_f32 v80,v80,v88
v_add_f32 v81,v81,v89
v_add_f32 v82,v82,v90
v_add_f32 v83,v83,v91
v_add_f32 v76,v76,v80
v_add_f32 v77,v77,v81
v_add_f32 v78,v78,v82
v_add_f32 v79,v79,v83
v_add_f32 v76,v76,v78
v_add_f32 v77,v77,v79
v_add_f32 v76,v76,v77
v_mov_b32 v13,v76
s_mov_b32 s45,s28
s_mov_b32 s38,0
poll_280:
buffer_load_dword v5,v4,s[4:7],0 offen sc1
s_waitcnt vmcnt(0)
v_cmp_le_u32 vcc,s45,v5
s_nop 0
s_cmp_eq_u64 vcc,-1
s_nop 1
s_cbranch_scc1 polld_281
s_sleep 8
s_add_u32 s38,s38,1
s_cmp_lt_u32 s38,100000
s_cbranch_scc1 poll_280
s_mov_b32 s40,7
s_branch L_fail
polld_281:
s_mov_b32 s38,0
poll_282:
buffer_load_dword v5,v4,s[4:7],0 offen sc1
s_waitcnt vmcnt(0)
v_cmp_le_u32 vcc,s31,v5
s_nop 0
s_cmp_eq_u64 vcc,-1
s_nop 1
s_cbranch_scc1 polld_283
s_add_u32 s38,s38,1
s_cmp_lt_u32 s38,100000
s_cbranch_scc1 poll_282
s_mov_b32 s40,7
s_branch L_fail
polld_283:
s_and_b32 s34,s28,7
s_mul_i32 s34,s34,262144
s_add_u32 s34,s34,s33
s_mov_b32 s38,0
att_r_284:
buffer_load_dwordx4 v[16:19],v6,s[4:7],s34 offen sc1
buffer_load_dwordx4 v[20:23],v6,s[4:7],s34 offen offset:256 sc1
buffer_load_dwordx4 v[24:27],v6,s[4:7],s34 offen offset:512 sc1
buffer_load_dwordx4 v[28:31],v6,s[4:7],s34 offen offset:768 sc1
buffer_load_dwordx4 v[32:35],v6,s[4:7],s34 offen offset:1024 sc1
buffer_load_dwordx4 v[36:39],v6,s[4:7],s34 offen offset:1280 sc1
buffer_load_dwordx4 v[40:43],v6,s[4:7],s34 offen offset:1536 sc1
buffer_load_dwordx4 v[44:47],v6,s[4:7],s34 offen offset:1792 sc1
buffer_load_dwordx2 v[48:49],v7,s[4:7],s34 offen offset:2048 sc1
buffer_load_dwordx2 v[50:51],v7,s[4:7],s34 offen offset:2560 sc1
buffer_load_dwordx2 v[52:53],v7,s[4:7],s34 offen offset:3072 sc1
buffer_load_dwordx2 v[54:55],v7,s[4:7],s34 offen offset:3584 sc1
buffer_load_dword v56,v3,s[4:7],s46 offen sc1
s_waitcnt vmcnt(12)
v_mfma_f32_32x32x16_bf16 v[92:107],v[16:19],a[0:3],0
v_max3_u32 v10,v16,v17,v18
v_max_u32 v10,v10,v19
s_waitcnt vmcnt(11)
v_mfma_f32_32x32x16_bf16 v[92:107],v[20:23],a[4:7],v[92:107]
v_max3_u32 v10,v10,v20,v21
v_max3_u32 v10,v10,v22,v23
s_waitcnt vmcnt(10)
v_mfma_f32_32x32x16_bf16 v[92:107],v[24:27],a[8:11],v[92:107]
v_max3_u32 v10,v10,v24,v25
v_max3_u32 v10,v10,v26,v27
s_waitcnt vmcnt(9)
v_mfma_f32_32x32x16_bf16 v[92:107],v[28:31],a[12:15],v[92:107]
v_max3_u32 v10,v10,v28,v29
v_max3_u32 v10,v10,v30,v31
s_waitcnt vmcnt(8)
v_mfma_f32_32x32x16_bf16 v[92:107],v[32:35],a[16:19],v[92:107]
v_max3_u32 v10,v10,v32,v33
v_max3_u32 v10,v10,v34,v35
s_waitcnt vmcnt(7)
v_mfma_f32_32x32x16_bf16 v[92:107],v[36:39],a[20:23],v[92:107]
v_max3_u32 v10,v10,v36,v37
v_max3_u32 v10,v10,v38,v39
s_waitcnt vmcnt(6)
v_mfma_f32_32x32x16_bf16 v[92:107],v[40:43],a[24:27],v[92:107]
v_max3_u32 v10,v10,v40,v41
v_max3_u32 v10,v10,v42,v43
s_waitcnt vmcnt(5)
v_mfma_f32_32x32x16_bf16 v[92:107],v[44:47],a[28:31],v[92:107]
v_max3_u32 v10,v10,v44,v45
v_max3_u32 v10,v10,v46,v47
s_waitcnt vmcnt(1)
v_max3_u32 v10,v10,v48,v49
v_max3_u32 v10,v10,v50,v51
v_max3_u32 v10,v10,v52,v53
v_max3_u32 v10,v10,v54,v55
v_cmp_eq_u32 vcc,-1,v10
s_cbranch_vccnz att_rf_285
s_nop 2
v_max3_f32 v8,v12,v92,v93
v_max3_f32 v9,v8,v94,v95
v_max3_f32 v8,v8,v94,v95
s_nop 1
v_permlane32_swap_b32 v8,v9
s_nop 0
v_max_f32 v8,v8,v9
v_sub_f32 v96,v12,v8
v_pk_add_f32 v[92:93],v[92:93],v[8:9] op_sel_hi:[1,0] neg_lo:[0,1] neg_hi:[0,1]
v_pk_add_f32 v[94:95],v[94:95],v[8:9] op_sel_hi:[1,0] neg_lo:[0,1] neg_hi:[0,1]
v_exp_f32 v96,v96
v_exp_f32 v92,v92
v_exp_f32 v93,v93
v_exp_f32 v94,v94
v_exp_f32 v95,v95
v_fma_f32 v8,v13,v96,v92
v_add_f32 v9,v93,v94
v_add_f32 v8,v8,v95
v_add_f32 v10,v8,v9
v_add_f32 v8,v8,v9
s_nop 1
v_permlane32_swap_b32 v8,v10
s_nop 0
v_add_f32 v8,v8,v10
v_rcp_f32 v8,v8
s_nop 0
v_mul_f32 v10,v96,v8
v_pk_mul_f32 v[92:93],v[92:93],v[8:9] op_sel_hi:[1,0]
v_pk_mul_f32 v[94:95],v[94:95],v[8:9] op_sel_hi:[1,0]
v_cvt_pk_bf16_f32 v116,v92,v93
v_cvt_pk_bf16_f32 v117,v94,v95
s_add_u32 s45,s36,4096
v_pk_mul_f32 v[120:121],v[120:121],v[10:11] op_sel_hi:[1,0]
v_pk_mul_f32 v[122:123],v[122:123],v[10:11] op_sel_hi:[1,0]
v_pk_mul_f32 v[124:125],v[124:125],v[10:11] op_sel_hi:[1,0]
v_pk_mul_f32 v[126:127],v[126:127],v[10:11] op_sel_hi:[1,0]
v_pk_mul_f32 v[128:129],v[128:129],v[10:11] op_sel_hi:[1,0]
v_pk_mul_f32 v[130:131],v[130:131],v[10:11] op_sel_hi:[1,0]
v_pk_mul_f32 v[132:133],v[132:133],v[10:11] op_sel_hi:[1,0]
v_pk_mul_f32 v[134:135],v[134:135],v[10:11] op_sel_hi:[1,0]
s_nop 1
v_mfma_f32_32x32x8_bf16 v[120:135],v[48:49],v[116:117],v[120:135]
v_pk_mul_f32 v[136:137],v[136:137],v[10:11] op_sel_hi:[1,0]
v_pk_mul_f32 v[138:139],v[138:139],v[10:11] op_sel_hi:[1,0]
v_pk_mul_f32 v[140:141],v[140:141],v[10:11] op_sel_hi:[1,0]
v_pk_mul_f32 v[142:143],v[142:143],v[10:11] op_sel_hi:[1,0]
v_pk_mul_f32 v[144:145],v[144:145],v[10:11] op_sel_hi:[1,0]
v_pk_mul_f32 v[146:147],v[146:147],v[10:11] op_sel_hi:[1,0]
v_pk_mul_f32 v[148:149],v[148:149],v[10:11] op_sel_hi:[1,0]
v_pk_mul_f32 v[150:151],v[150:151],v[10:11] op_sel_hi:[1,0]
s_nop 1
v_mfma_f32_32x32x8_bf16 v[136:151],v[50:51],v[116:117],v[136:151]
v_pk_mul_f32 v[152:153],v[152:153],v[10:11] op_sel_hi:[1,0]
v_pk_mul_f32 v[154:155],v[154:155],v[10:11] op_sel_hi:[1,0]
v_pk_mul_f32 v[156:157],v[156:157],v[10:11] op_sel_hi:[1,0]
v_pk_mul_f32 v[158:159],v[158:159],v[10:11] op_sel_hi:[1,0]
v_pk_mul_f32 v[160:161],v[160:161],v[10:11] op_sel_hi:[1,0]
v_pk_mul_f32 v[162:163],v[162:163],v[10:11] op_sel_hi:[1,0]
v_pk_mul_f32 v[164:165],v[164:165],v[10:11] op_sel_hi:[1,0]
v_pk_mul_f32 v[166:167],v[166:167],v[10:11] op_sel_hi:[1,0]
v_cvt_pk_bf16_f32 v16,v120,v121
v_cvt_pk_bf16_f32 v17,v122,v123
v_cvt_pk_bf16_f32 v18,v124,v125
v_cvt_pk_bf16_f32 v19,v126,v127
buffer_store_dwordx4 v[16:19],v1,s[4:7],s36 offen sc1
v_cvt_pk_bf16_f32 v20,v128,v129
v_cvt_pk_bf16_f32 v21,v130,v131
v_cvt_pk_bf16_f32 v22,v132,v133
v_cvt_pk_bf16_f32 v23,v134,v135
buffer_store_dwordx4 v[20:23],v1,s[4:7],s36 offen offset:1024 sc1
v_mfma_f32_32x32x8_bf16 v[152:167],v[52:53],v[116:117],v[152:167]
v_pk_mul_f32 v[168:169],v[168:169],v[10:11] op_sel_hi:[1,0]
v_pk_mul_f32 v[170:171],v[170:171],v[10:11] op_sel_hi:[1,0]
v_pk_mul_f32 v[172:173],v[172:173],v[10:11] op_sel_hi:[1,0]
v_pk_mul_f32 v[174:175],v[174:175],v[10:11] op_sel_hi:[1,0]
v_pk_mul_f32 v[176:177],v[176:177],v[10:11] op_sel_hi:[1,0]
v_pk_mul_f32 v[178:179],v[178:179],v[10:11] op_sel_hi:[1,0]
v_pk_mul_f32 v[180:181],v[180:181],v[10:11] op_sel_hi:[1,0]
v_pk_mul_f32 v[182:183],v[182:183],v[10:11] op_sel_hi:[1,0]
v_cvt_pk_bf16_f32 v24,v136,v137
v_cvt_pk_bf16_f32 v25,v138,v139
v_cvt_pk_bf16_f32 v26,v140,v141
v_cvt_pk_bf16_f32 v27,v142,v143
buffer_store_dwordx4 v[24:27],v1,s[4:7],s36 offen offset:2048 sc1
v_cvt_pk_bf16_f32 v28,v144,v145
v_cvt_pk_bf16_f32 v29,v146,v147
v_cvt_pk_bf16_f32 v30,v148,v149
v_cvt_pk_bf16_f32 v31,v150,v151
buffer_store_dwordx4 v[28:31],v1,s[4:7],s36 offen offset:3072 sc1
v_mfma_f32_32x32x8_bf16 v[168:183],v[54:55],v[116:117],v[168:183]
v_cvt_pk_bf16_f32 v32,v152,v153
v_cvt_pk_bf16_f32 v33,v154,v155
v_cvt_pk_bf16_f32 v34,v156,v157
v_cvt_pk_bf16_f32 v35,v158,v159
buffer_store_dwordx4 v[32:35],v1,s[4:7],s45 offen sc1
v_cvt_pk_bf16_f32 v36,v160,v161
v_cvt_pk_bf16_f32 v37,v162,v163
v_cvt_pk_bf16_f32 v38,v164,v165
v_cvt_pk_bf16_f32 v39,v166,v167
buffer_store_dwordx4 v[36:39],v1,s[4:7],s45 offen offset:1024 sc1
s_nop 1
v_cvt_pk_bf16_f32 v40,v168,v169
v_cvt_pk_bf16_f32 v41,v170,v171
v_cvt_pk_bf16_f32 v42,v172,v173
v_cvt_pk_bf16_f32 v43,v174,v175
buffer_store_dwordx4 v[40:43],v1,s[4:7],s45 offen offset:2048 sc1
v_cvt_pk_bf16_f32 v44,v176,v177
v_cvt_pk_bf16_f32 v45,v178,v179
v_cvt_pk_bf16_f32 v46,v180,v181
v_cvt_pk_bf16_f32 v47,v182,v183
buffer_store_dwordx4 v[44:47],v1,s[4:7],s45 offen offset:3072 sc1
v_mov_b64 v[108:109],-1
v_mov_b64 v[110:111],-1
buffer_store_dwordx4 v[108:111],v1,s[4:7],s34 offen sc1
buffer_store_dwordx4 v[108:111],v1,s[4:7],s34 offen offset:1024 sc1
buffer_store_dwordx4 v[108:111],v1,s[4:7],s34 offen offset:2048 sc1
buffer_store_dwordx4 v[108:111],v1,s[4:7],s34 offen offset:3072 sc1
s_add_u32 s36,s36,524288
s_add_u32 s28,s28,2
s_waitcnt vmcnt(12)
v_cmp_le_u32 vcc,s49,v56
s_nop 0
s_cmp_eq_u64 vcc,-1
s_nop 1
s_cbranch_scc0 att_b_286
s_add_u32 s44,s32,0
buffer_load_dwordx4 a[0:3],v1,s[4:7],s44 offen sc1
buffer_load_dwordx4 a[4:7],v1,s[4:7],s44 offen offset:1024 sc1
buffer_load_dwordx4 a[8:11],v1,s[4:7],s44 offen offset:2048 sc1
buffer_load_dwordx4 a[12:15],v1,s[4:7],s44 offen offset:3072 sc1
s_add_u32 s44,s32,4096
buffer_load_dwordx4 a[16:19],v1,s[4:7],s44 offen sc1
buffer_load_dwordx4 a[20:23],v1,s[4:7],s44 offen offset:1024 sc1
buffer_load_dwordx4 a[24:27],v1,s[4:7],s44 offen offset:2048 sc1
buffer_load_dwordx4 a[28:31],v1,s[4:7],s44 offen offset:3072 sc1
s_waitcnt vmcnt(12)
v_mov_b32 v8,s31
s_mov_b64 exec,1
buffer_store_dword v8,off,s[4:7],s37 sc1
s_mov_b64 exec,-1
s_add_u32 s44,s32,131072
buffer_load_dwordx4 a[32:35],v1,s[4:7],s44 offen sc1
buffer_load_dwordx4 a[36:39],v1,s[4:7],s44 offen offset:1024 sc1
buffer_load_dwordx4 a[40:43],v1,s[4:7],s44 offen offset:2048 sc1
buffer_load_dwordx4 a[44:47],v1,s[4:7],s44 offen offset:3072 sc1
s_add_u32 s44,s32,135168
buffer_load_dwordx4 a[48:51],v1,s[4:7],s44 offen sc1
buffer_load_dwordx4 a[52:55],v1,s[4:7],s44 offen offset:1024 sc1
buffer_load_dwordx4 a[56:59],v1,s[4:7],s44 offen offset:2048 sc1
buffer_load_dwordx4 a[60:63],v1,s[4:7],s44 offen offset:3072 sc1
s_add_u32 s44,s32,262144
buffer_load_dwordx4 a[64:67],v1,s[4:7],s44 offen sc1
buffer_load_dwordx4 a[68:71],v1,s[4:7],s44 offen offset:1024 sc1
buffer_load_dwordx4 a[72:75],v1,s[4:7],s44 offen offset:2048 sc1
buffer_load_dwordx4 a[76:79],v1,s[4:7],s44 offen offset:3072 sc1
s_add_u32 s44,s32,266240
buffer_load_dwordx4 a[80:83],v1,s[4:7],s44 offen sc1
buffer_load_dwordx4 a[84:87],v1,s[4:7],s44 offen offset:1024 sc1
buffer_load_dwordx4 a[88:91],v1,s[4:7],s44 offen offset:2048 sc1
buffer_load_dwordx4 a[92:95],v1,s[4:7],s44 offen offset:3072 sc1
s_add_u32 s32,s32,1572864
s_branch att_n_287
att_b_286:
s_waitcnt vmcnt(4)
v_mov_b32 v8,s31
s_mov_b64 exec,1
buffer_store_dword v8,off,s[4:7],s37 sc1
s_mov_b64 exec,-1
s_cmp_ge_u32 s28,64
s_cbranch_scc1 att_fin
s_mov_b32 s38,0
poll_288:
buffer_load_dword v5,v3,s[4:7],s46 offen sc1
s_waitcnt vmcnt(0)
v_cmp_le_u32 vcc,s49,v5
s_nop 0
s_cmp_eq_u64 vcc,-1
s_nop 1
s_cbranch_scc1 polld_289
s_sleep 2
s_add_u32 s38,s38,1
s_cmp_lt_u32 s38,100000
s_cbranch_scc1 poll_288
s_mov_b32 s40,6
s_branch L_fail
polld_289:
s_add_u32 s44,s32,0
buffer_load_dwordx4 a[0:3],v1,s[4:7],s44 offen sc1
buffer_load_dwordx4 a[4:7],v1,s[4:7],s44 offen offset:1024 sc1
buffer_load_dwordx4 a[8:11],v1,s[4:7],s44 offen offset:2048 sc1
buffer_load_dwordx4 a[12:15],v1,s[4:7],s44 offen offset:3072 sc1
s_add_u32 s44,s32,4096
buffer_load_dwordx4 a[16:19],v1,s[4:7],s44 offen sc1
buffer_load_dwordx4 a[20:23],v1,s[4:7],s44 offen offset:1024 sc1
buffer_load_dwordx4 a[24:27],v1,s[4:7],s44 offen offset:2048 sc1
buffer_load_dwordx4 a[28:31],v1,s[4:7],s44 offen offset:3072 sc1
s_add_u32 s44,s32,131072
buffer_load_dwordx4 a[32:35],v1,s[4:7],s44 offen sc1
buffer_load_dwordx4 a[36:39],v1,s[4:7],s44 offen offset:1024 sc1
buffer_load_dwordx4 a[40:43],v1,s[4:7],s44 offen offset:2048 sc1
buffer_load_dwordx4 a[44:47],v1,s[4:7],s44 offen offset:3072 sc1
s_add_u32 s44,s32,135168
buffer_load_dwordx4 a[48:51],v1,s[4:7],s44 offen sc1
buffer_load_dwordx4 a[52:55],v1,s[4:7],s44 offen offset:1024 sc1
buffer_load_dwordx4 a[56:59],v1,s[4:7],s44 offen offset:2048 sc1
buffer_load_dwordx4 a[60:63],v1,s[4:7],s44 offen offset:3072 sc1
s_add_u32 s44,s32,262144
buffer_load_dwordx4 a[64:67],v1,s[4:7],s44 offen sc1
buffer_load_dwordx4 a[68:71],v1,s[4:7],s44 offen offset:1024 sc1
buffer_load_dwordx4 a[72:75],v1,s[4:7],s44 offen offset:2048 sc1
buffer_load_dwordx4 a[76:79],v1,s[4:7],s44 offen offset:3072 sc1
s_add_u32 s44,s32,266240
buffer_load_dwordx4 a[80:83],v1,s[4:7],s44 offen sc1
buffer_load_dwordx4 a[84:87],v1,s[4:7],s44 offen offset:1024 sc1
buffer_load_dwordx4 a[88:91],v1,s[4:7],s44 offen offset:2048 sc1
buffer_load_dwordx4 a[92:95],v1,s[4:7],s44 offen offset:3072 sc1
s_add_u32 s32,s32,1572864
att_n_287:
s_branch att_top_276
att_rf_285:
s_add_u32 s38,s38,1
s_cmp_lt_u32 s38,100000
s_cbranch_scc1 att_r_284
s_mov_b32 s40,7
s_branch L_fail
att_fin:
s_branch L_end
R_w1:
s_add_u32 s42,s42,s43
s_lshl_b32 s41,s42,2
s_add_u32 s41,s41,s3
s_mov_b32 s24,s4
s_mov_b32 s25,s5
s_mov_b32 s27,0x20000
s_cmp_lt_u32 s41,20
s_cselect_b32 s26,s6,0
s_min_u32 s41,s41,19
v_lshlrev_b32 v1,4,v0
s_load_dwordx2 s[20:21],s[0:1],64
s_waitcnt lgkmcnt(0)
s_mov_b32 s16,s20
s_and_b32 s17,s21,0xffff
s_mov_b32 s18,0xc8000
s_mov_b32 s19,0x20000
s_lshl_b32 s42,s41,6
v_lshrrev_b32 v82,2,v0
v_mul_u32_u24 v80,1280,v82
v_and_b32 v82,3,v0
v_lshl_add_u32 v80,v82,4,v80
v_lshlrev_b32 v81,3,v82
v_bfe_u32 v82,v0,4,1
v_lshl_add_u32 v81,v82,5,v81
v_bfe_u32 v82,v0,2,2
v_lshl_add_u32 v81,v82,6,v81
v_lshrrev_b32 v82,5,v0
v_lshl_add_u32 v81,v82,8,v81
s_mul_i32 s22,s3,40960
v_add_u32 v81,s22,v81
s_add_u32 s23,s22,0
s_mov_b32 m0,s23
s_add_u32 s23,s42,0
buffer_load_dwordx4 v80,s[16:19],s23 offen lds
s_add_u32 s23,s22,1024
s_mov_b32 m0,s23
s_add_u32 s23,s42,20480
buffer_load_dwordx4 v80,s[16:19],s23 offen lds
s_add_u32 s23,s22,2048
s_mov_b32 m0,s23
s_add_u32 s23,s42,40960
buffer_load_dwordx4 v80,s[16:19],s23 offen lds
s_add_u32 s23,s22,3072
s_mov_b32 m0,s23
s_add_u32 s23,s42,61440
buffer_load_dwordx4 v80,s[16:19],s23 offen lds
s_add_u32 s23,s22,4096
s_mov_b32 m0,s23
s_add_u32 s23,s42,81920
buffer_load_dwordx4 v80,s[16:19],s23 offen lds
s_add_u32 s23,s22,5120
s_mov_b32 m0,s23
s_add_u32 s23,s42,102400
buffer_load_dwordx4 v80,s[16:19],s23 offen lds
s_add_u32 s23,s22,6144
s_mov_b32 m0,s23
s_add_u32 s23,s42,122880
buffer_load_dwordx4 v80,s[16:19],s23 offen lds
s_add_u32 s23,s22,7168
s_mov_b32 m0,s23
s_add_u32 s23,s42,143360
buffer_load_dwordx4 v80,s[16:19],s23 offen lds
s_add_u32 s23,s22,8192
s_mov_b32 m0,s23
s_add_u32 s23,s42,163840
buffer_load_dwordx4 v80,s[16:19],s23 offen lds
s_add_u32 s23,s22,9216
s_mov_b32 m0,s23
s_add_u32 s23,s42,184320
buffer_load_dwordx4 v80,s[16:19],s23 offen lds
s_add_u32 s23,s22,10240
s_mov_b32 m0,s23
s_add_u32 s23,s42,204800
buffer_load_dwordx4 v80,s[16:19],s23 offen lds
s_add_u32 s23,s22,11264
s_mov_b32 m0,s23
s_add_u32 s23,s42,225280
buffer_load_dwordx4 v80,s[16:19],s23 offen lds
s_add_u32 s23,s22,12288
s_mov_b32 m0,s23
s_add_u32 s23,s42,245760
buffer_load_dwordx4 v80,s[16:19],s23 offen lds
s_add_u32 s23,s22,13312
s_mov_b32 m0,s23
s_add_u32 s23,s42,266240
buffer_load_dwordx4 v80,s[16:19],s23 offen lds
s_add_u32 s23,s22,14336
s_mov_b32 m0,s23
s_add_u32 s23,s42,286720
buffer_load_dwordx4 v80,s[16:19],s23 offen lds
s_add_u32 s23,s22,15360
s_mov_b32 m0,s23
s_add_u32 s23,s42,307200
buffer_load_dwordx4 v80,s[16:19],s23 offen lds
s_add_u32 s23,s22,16384
s_mov_b32 m0,s23
s_add_u32 s23,s42,327680
buffer_load_dwordx4 v80,s[16:19],s23 offen lds
s_add_u32 s23,s22,17408
s_mov_b32 m0,s23
s_add_u32 s23,s42,348160
buffer_load_dwordx4 v80,s[16:19],s23 offen lds
s_add_u32 s23,s22,18432
s_mov_b32 m0,s23
s_add_u32 s23,s42,368640
buffer_load_dwordx4 v80,s[16:19],s23 offen lds
s_add_u32 s23,s22,19456
s_mov_b32 m0,s23
s_add_u32 s23,s42,389120
buffer_load_dwordx4 v80,s[16:19],s23 offen lds
s_add_u32 s23,s22,20480
s_mov_b32 m0,s23
s_add_u32 s23,s42,409600
buffer_load_dwordx4 v80,s[16:19],s23 offen lds
s_add_u32 s23,s22,21504
s_mov_b32 m0,s23
s_add_u32 s23,s42,430080
buffer_load_dwordx4 v80,s[16:19],s23 offen lds
s_add_u32 s23,s22,22528
s_mov_b32 m0,s23
s_add_u32 s23,s42,450560
buffer_load_dwordx4 v80,s[16:19],s23 offen lds
s_add_u32 s23,s22,23552
s_mov_b32 m0,s23
s_add_u32 s23,s42,471040
buffer_load_dwordx4 v80,s[16:19],s23 offen lds
s_add_u32 s23,s22,24576
s_mov_b32 m0,s23
s_add_u32 s23,s42,491520
buffer_load_dwordx4 v80,s[16:19],s23 offen lds
s_add_u32 s23,s22,25600
s_mov_b32 m0,s23
s_add_u32 s23,s42,512000
buffer_load_dwordx4 v80,s[16:19],s23 offen lds
s_add_u32 s23,s22,26624
s_mov_b32 m0,s23
s_add_u32 s23,s42,532480
buffer_load_dwordx4 v80,s[16:19],s23 offen lds
s_add_u32 s23,s22,27648
s_mov_b32 m0,s23
s_add_u32 s23,s42,552960
buffer_load_dwordx4 v80,s[16:19],s23 offen lds
s_add_u32 s23,s22,28672
s_mov_b32 m0,s23
s_add_u32 s23,s42,573440
buffer_load_dwordx4 v80,s[16:19],s23 offen lds
s_add_u32 s23,s22,29696
s_mov_b32 m0,s23
s_add_u32 s23,s42,593920
buffer_load_dwordx4 v80,s[16:19],s23 offen lds
s_add_u32 s23,s22,30720
s_mov_b32 m0,s23
s_add_u32 s23,s42,614400
buffer_load_dwordx4 v80,s[16:19],s23 offen lds
s_add_u32 s23,s22,31744
s_mov_b32 m0,s23
s_add_u32 s23,s42,634880
buffer_load_dwordx4 v80,s[16:19],s23 offen lds
s_add_u32 s23,s22,32768
s_mov_b32 m0,s23
s_add_u32 s23,s42,655360
buffer_load_dwordx4 v80,s[16:19],s23 offen lds
s_add_u32 s23,s22,33792
s_mov_b32 m0,s23
s_add_u32 s23,s42,675840
buffer_load_dwordx4 v80,s[16:19],s23 offen lds
s_add_u32 s23,s22,34816
s_mov_b32 m0,s23
s_add_u32 s23,s42,696320
buffer_load_dwordx4 v80,s[16:19],s23 offen lds
s_add_u32 s23,s22,35840
s_mov_b32 m0,s23
s_add_u32 s23,s42,716800
buffer_load_dwordx4 v80,s[16:19],s23 offen lds
s_waitcnt vmcnt(35)
ds_read_b64_tr_b16 a[0:1],v81
ds_read_b64_tr_b16 a[2:3],v81 offset:512
s_waitcnt vmcnt(34)
ds_read_b64_tr_b16 a[4:5],v81 offset:1024
ds_read_b64_tr_b16 a[6:7],v81 offset:1536
s_waitcnt vmcnt(33)
ds_read_b64_tr_b16 a[8:9],v81 offset:2048
ds_read_b64_tr_b16 a[10:11],v81 offset:2560
s_waitcnt vmcnt(32)
ds_read_b64_tr_b16 a[12:13],v81 offset:3072
ds_read_b64_tr_b16 a[14:15],v81 offset:3584
s_waitcnt lgkmcnt(6)
s_add_u32 s23,s22,0
s_mov_b32 m0,s23
s_add_u32 s23,s42,737280
buffer_load_dwordx4 v80,s[16:19],s23 offen lds
s_waitcnt vmcnt(32)
ds_read_b64_tr_b16 a[16:17],v81 offset:4096
ds_read_b64_tr_b16 a[18:19],v81 offset:4608
s_waitcnt lgkmcnt(6)
s_add_u32 s23,s22,1024
s_mov_b32 m0,s23
s_add_u32 s23,s42,757760
buffer_load_dwordx4 v80,s[16:19],s23 offen lds
s_waitcnt vmcnt(32)
ds_read_b64_tr_b16 a[20:21],v81 offset:5120
ds_read_b64_tr_b16 a[22:23],v81 offset:5632
s_waitcnt lgkmcnt(6)
s_add_u32 s23,s22,2048
s_mov_b32 m0,s23
s_add_u32 s23,s42,778240
buffer_load_dwordx4 v80,s[16:19],s23 offen lds
s_waitcnt vmcnt(32)
ds_read_b64_tr_b16 a[24:25],v81 offset:6144
ds_read_b64_tr_b16 a[26:27],v81 offset:6656
s_waitcnt lgkmcnt(6)
s_add_u32 s23,s22,3072
s_mov_b32 m0,s23
s_add_u32 s23,s42,798720
buffer_load_dwordx4 v80,s[16:19],s23 offen lds
s_waitcnt vmcnt(32)
ds_read_b64_tr_b16 a[28:29],v81 offset:7168
ds_read_b64_tr_b16 a[30:31],v81 offset:7680
s_waitcnt vmcnt(31)
ds_read_b64_tr_b16 a[32:33],v81 offset:8192
ds_read_b64_tr_b16 a[34:35],v81 offset:8704
s_waitcnt vmcnt(30)
ds_read_b64_tr_b16 a[36:37],v81 offset:9216
ds_read_b64_tr_b16 a[38:39],v81 offset:9728
s_waitcnt vmcnt(29)
ds_read_b64_tr_b16 a[40:41],v81 offset:10240
ds_read_b64_tr_b16 a[42:43],v81 offset:10752
s_waitcnt vmcnt(28)
ds_read_b64_tr_b16 a[44:45],v81 offset:11264
ds_read_b64_tr_b16 a[46:47],v81 offset:11776
s_waitcnt vmcnt(27)
ds_read_b64_tr_b16 a[48:49],v81 offset:12288
ds_read_b64_tr_b16 a[50:51],v81 offset:12800
s_waitcnt vmcnt(26)
ds_read_b64_tr_b16 a[52:53],v81 offset:13312
ds_read_b64_tr_b16 a[54:55],v81 offset:13824
s_waitcnt vmcnt(25)
ds_read_b64_tr_b16 a[56:57],v81 offset:14336
ds_read_b64_tr_b16 a[58:59],v81 offset:14848
s_waitcnt vmcnt(24)
ds_read_b64_tr_b16 a[60:61],v81 offset:15360
ds_read_b64_tr_b16 a[62:63],v81 offset:15872
s_waitcnt vmcnt(23)
ds_read_b64_tr_b16 a[64:65],v81 offset:16384
ds_read_b64_tr_b16 a[66:67],v81 offset:16896
s_waitcnt vmcnt(22)
ds_read_b64_tr_b16 a[68:69],v81 offset:17408
ds_read_b64_tr_b16 a[70:71],v81 offset:17920
s_waitcnt vmcnt(21)
ds_read_b64_tr_b16 a[72:73],v81 offset:18432
ds_read_b64_tr_b16 a[74:75],v81 offset:18944
s_waitcnt vmcnt(20)
ds_read_b64_tr_b16 a[76:77],v81 offset:19456
ds_read_b64_tr_b16 a[78:79],v81 offset:19968
s_waitcnt vmcnt(19)
ds_read_b64_tr_b16 a[80:81],v81 offset:20480
ds_read_b64_tr_b16 a[82:83],v81 offset:20992
s_waitcnt vmcnt(18)
ds_read_b64_tr_b16 a[84:85],v81 offset:21504
ds_read_b64_tr_b16 a[86:87],v81 offset:22016
s_waitcnt vmcnt(17)
ds_read_b64_tr_b16 a[88:89],v81 offset:22528
ds_read_b64_tr_b16 a[90:91],v81 offset:23040
s_waitcnt vmcnt(16)
ds_read_b64_tr_b16 a[92:93],v81 offset:23552
ds_read_b64_tr_b16 a[94:95],v81 offset:24064
s_waitcnt vmcnt(15)
ds_read_b64_tr_b16 a[96:97],v81 offset:24576
ds_read_b64_tr_b16 a[98:99],v81 offset:25088
s_waitcnt vmcnt(14)
ds_read_b64_tr_b16 a[100:101],v81 offset:25600
ds_read_b64_tr_b16 a[102:103],v81 offset:26112
s_waitcnt vmcnt(13)
ds_read_b64_tr_b16 a[104:105],v81 offset:26624
ds_read_b64_tr_b16 a[106:107],v81 offset:27136
s_waitcnt vmcnt(12)
ds_read_b64_tr_b16 a[108:109],v81 offset:27648
ds_read_b64_tr_b16 a[110:111],v81 offset:28160
s_waitcnt vmcnt(11)
ds_read_b64_tr_b16 a[112:113],v81 offset:28672
ds_read_b64_tr_b16 a[114:115],v81 offset:29184
s_waitcnt vmcnt(10)
ds_read_b64_tr_b16 a[116:117],v81 offset:29696
ds_read_b64_tr_b16 a[118:119],v81 offset:30208
s_waitcnt vmcnt(9)
ds_read_b64_tr_b16 a[120:121],v81 offset:30720
ds_read_b64_tr_b16 a[122:123],v81 offset:31232
s_waitcnt vmcnt(8)
ds_read_b64_tr_b16 a[124:125],v81 offset:31744
ds_read_b64_tr_b16 a[126:127],v81 offset:32256
s_waitcnt vmcnt(7)
ds_read_b64_tr_b16 a[128:129],v81 offset:32768
ds_read_b64_tr_b16 a[130:131],v81 offset:33280
s_waitcnt vmcnt(6)
ds_read_b64_tr_b16 a[132:133],v81 offset:33792
ds_read_b64_tr_b16 a[134:135],v81 offset:34304
s_waitcnt vmcnt(5)
ds_read_b64_tr_b16 a[136:137],v81 offset:34816
ds_read_b64_tr_b16 a[138:139],v81 offset:35328
s_waitcnt vmcnt(4)
ds_read_b64_tr_b16 a[140:141],v81 offset:35840
ds_read_b64_tr_b16 a[142:143],v81 offset:36352
s_waitcnt vmcnt(3)
ds_read_b64_tr_b16 a[144:145],v81
ds_read_b64_tr_b16 a[146:147],v81 offset:512
s_waitcnt vmcnt(2)
ds_read_b64_tr_b16 a[148:149],v81 offset:1024
ds_read_b64_tr_b16 a[150:151],v81 offset:1536
s_waitcnt vmcnt(1)
ds_read_b64_tr_b16 a[152:153],v81 offset:2048
ds_read_b64_tr_b16 a[154:155],v81 offset:2560
s_waitcnt vmcnt(0)
ds_read_b64_tr_b16 a[156:157],v81 offset:3072
ds_read_b64_tr_b16 a[158:159],v81 offset:3584
s_waitcnt lgkmcnt(0)
s_barrier
v_mov_b32 v80,68
s_mov_b32 s99,128
s_mov_b32 s38,0
poll_290:
buffer_load_dword v81,v80,s[12:15],0 offen sc1
s_waitcnt vmcnt(0)
v_cmp_le_u32 vcc,s99,v81
s_nop 0
s_cmp_eq_u64 vcc,-1
s_nop 1
s_cbranch_scc1 polld_291
s_sleep 8
s_add_u32 s38,s38,1
s_cmp_lt_u32 s38,100000
s_cbranch_scc1 poll_290
s_mov_b32 s40,14
s_branch L_fail
polld_291:
v_readfirstlane_b32 s99,v81
s_nop 0
s_and_b32 s99,s99,1
s_lshl_b32 s99,s99,13
v_and_b32 v9,31,v0
v_lshrrev_b32 v5,5,v0
v_mul_u32_u24 v7,2560,v5
v_lshl_add_u32 v7,v9,3,v7
s_lshl_b32 s43,s3,10
v_mov_b32 v48,0x3f803f80
v_mov_b32 v49,0x3f803f80
v_mov_b32 v50,0x3f803f80
v_mov_b32 v51,0x3f803f80
s_nop 1
v_mfma_f32_32x32x16_bf16 v[32:47],a[0:3],v[48:51],0
v_mfma_f32_32x32x16_bf16 v[32:47],a[4:7],v[48:51],v[32:47]
v_mfma_f32_32x32x16_bf16 v[32:47],a[8:11],v[48:51],v[32:47]
v_mfma_f32_32x32x16_bf16 v[32:47],a[12:15],v[48:51],v[32:47]
v_mfma_f32_32x32x16_bf16 v[32:47],a[16:19],v[48:51],v[32:47]
v_mfma_f32_32x32x16_bf16 v[32:47],a[20:23],v[48:51],v[32:47]
v_mfma_f32_32x32x16_bf16 v[32:47],a[24:27],v[48:51],v[32:47]
v_mfma_f32_32x32x16_bf16 v[32:47],a[28:31],v[48:51],v[32:47]
v_mfma_f32_32x32x16_bf16 v[32:47],a[32:35],v[48:51],v[32:47]
v_mfma_f32_32x32x16_bf16 v[32:47],a[36:39],v[48:51],v[32:47]
v_mfma_f32_32x32x16_bf16 v[32:47],a[40:43],v[48:51],v[32:47]
v_mfma_f32_32x32x16_bf16 v[32:47],a[44:47],v[48:51],v[32:47]
v_mfma_f32_32x32x16_bf16 v[32:47],a[48:51],v[48:51],v[32:47]
v_mfma_f32_32x32x16_bf16 v[32:47],a[52:55],v[48:51],v[32:47]
v_mfma_f32_32x32x16_bf16 v[32:47],a[56:59],v[48:51],v[32:47]
v_mfma_f32_32x32x16_bf16 v[32:47],a[60:63],v[48:51],v[32:47]
v_mfma_f32_32x32x16_bf16 v[32:47],a[64:67],v[48:51],v[32:47]
v_mfma_f32_32x32x16_bf16 v[32:47],a[68:71],v[48:51],v[32:47]
v_mfma_f32_32x32x16_bf16 v[32:47],a[72:75],v[48:51],v[32:47]
v_mfma_f32_32x32x16_bf16 v[32:47],a[76:79],v[48:51],v[32:47]
v_mfma_f32_32x32x16_bf16 v[32:47],a[80:83],v[48:51],v[32:47]
v_mfma_f32_32x32x16_bf16 v[32:47],a[84:87],v[48:51],v[32:47]
v_mfma_f32_32x32x16_bf16 v[32:47],a[88:91],v[48:51],v[32:47]
v_mfma_f32_32x32x16_bf16 v[32:47],a[92:95],v[48:51],v[32:47]
v_mfma_f32_32x32x16_bf16 v[32:47],a[96:99],v[48:51],v[32:47]
v_mfma_f32_32x32x16_bf16 v[32:47],a[100:103],v[48:51],v[32:47]
v_mfma_f32_32x32x16_bf16 v[32:47],a[104:107],v[48:51],v[32:47]
v_mfma_f32_32x32x16_bf16 v[32:47],a[108:111],v[48:51],v[32:47]
v_mfma_f32_32x32x16_bf16 v[32:47],a[112:115],v[48:51],v[32:47]
v_mfma_f32_32x32x16_bf16 v[32:47],a[116:119],v[48:51],v[32:47]
v_mfma_f32_32x32x16_bf16 v[32:47],a[120:123],v[48:51],v[32:47]
v_mfma_f32_32x32x16_bf16 v[32:47],a[124:127],v[48:51],v[32:47]
v_mfma_f32_32x32x16_bf16 v[32:47],a[128:131],v[48:51],v[32:47]
v_mfma_f32_32x32x16_bf16 v[32:47],a[132:135],v[48:51],v[32:47]
v_mfma_f32_32x32x16_bf16 v[32:47],a[136:139],v[48:51],v[32:47]
v_mfma_f32_32x32x16_bf16 v[32:47],a[140:143],v[48:51],v[32:47]
v_mfma_f32_32x32x16_bf16 v[32:47],a[144:147],v[48:51],v[32:47]
v_mfma_f32_32x32x16_bf16 v[32:47],a[148:151],v[48:51],v[32:47]
v_mfma_f32_32x32x16_bf16 v[32:47],a[152:155],v[48:51],v[32:47]
v_mfma_f32_32x32x16_bf16 v[32:47],a[156:159],v[48:51],v[32:47]
v_mov_b32 v144,0xc0135761
v_mov_b32 v145,0xc0135761
v_mov_b32 v146,0xbdd2d3e8
v_mov_b32 v147,0xbdd2d3e8
s_mov_b32 s48,0x3acccccd
s_mov_b32 s49,0x3727c5ac
s_mov_b32 s35,0
s_mov_b32 s28,0
s_mov_b32 s63,64
s_nop 2
ns_init_292:
v_min_u32 v3,19,v0
v_lshlrev_b32 v3,7,v3
s_mul_i32 s42,s39,0x48000
s_add_u32 s42,s42,0x38000
s_lshl_b32 s101,s39,13
s_xor_b32 s101,s101,s99
s_xor_b32 s101,s101,8192
s_add_u32 s42,s42,s101
v_add_u32 v3,s42,v3
s_mul_i32 s37,s39,0x48000
s_add_u32 s37,s37,0x40000
s_lshl_b32 s101,s39,13
s_xor_b32 s101,s101,s99
s_xor_b32 s101,s101,8192
s_add_u32 s37,s37,s101
s_and_b32 s42,s41,63
s_lshl_b32 s42,s42,7
s_add_u32 s37,s37,s42
s_lshr_b32 s42,s41,6
s_lshl_b32 s42,s42,4
s_add_u32 s37,s37,s42
s_mul_i32 s66,s39,0x300000
s_add_u32 s66,s66,0x3b00000
s_add_u32 s66,s66,s43
s_mov_b32 s67,s66
s_mul_i32 s68,s39,0x318000
s_add_u32 s68,s68,0x410c000
s_lshl_b32 s42,s41,11
s_add_u32 s68,s68,s42
v_mov_b32 v84,0
v_mov_b32 v85,0
v_mov_b32 v86,0
v_mov_b32 v87,0
s_add_u32 s46,s68,-49152
buffer_store_dwordx4 v[84:87],v1,s[24:27],s46 offen sc1
buffer_store_dwordx4 v[84:87],v1,s[24:27],s46 offen offset:1024 sc1
s_add_u32 s46,s68,3145728
buffer_store_dwordx4 v[84:87],v1,s[24:27],s46 offen sc1
buffer_store_dwordx4 v[84:87],v1,s[24:27],s46 offen offset:1024 sc1
v_lshlrev_b32 v9,3,v9
s_waitcnt vmcnt(0) lgkmcnt(0)
s_getpc_b64 s[60:61]
pc_296:
s_add_u32 s60,s60,ns_top_294-pc_296
s_addc_u32 s61,s61,0
s_mov_b32 s59,ns_fin_295-ns_top_294-4
v_lshlrev_b32 v82,7,v0
v_add_u32 v82,0,v82
v_min_u32 v82,s59,v82
v_mov_b32 v81,s61
v_add_co_u32 v80,vcc,s60,v82
s_nop 1
v_addc_co_u32 v81,vcc,0,v81,vcc
global_load_dword v83,v[80:81],off
s_waitcnt vmcnt(0)
s_mov_b32 s30,0
s_add_u32 s31,s28,1
s_mul_i32 s42,s28,49152
s_add_u32 s32,s66,s42
s_add_u32 s33,s67,s42
s_mov_b32 s38,0
poll_297:
buffer_load_dword v4,v3,s[4:7],0 offen sc1
s_waitcnt vmcnt(0)
v_cmp_le_u32 vcc,s31,v4
s_nop 0
s_cmp_eq_u64 vcc,-1
s_nop 1
s_cbranch_scc1 polld_298
s_sleep 2
s_add_u32 s38,s38,1
s_cmp_lt_u32 s38,100000
s_cbranch_scc1 poll_297
s_mov_b32 s40,3
s_branch L_fail
polld_298:
s_add_u32 s44,s35,s43
s_add_u32 s46,s44,0
s_mov_b32 m0,s46
s_add_u32 s46,s32,0
buffer_load_dwordx4 v1,s[4:7],s46 offen sc1 lds
s_add_u32 s46,s44,4096
s_mov_b32 m0,s46
s_add_u32 s46,s32,4096
buffer_load_dwordx4 v1,s[4:7],s46 offen sc1 lds
s_add_u32 s46,s44,8192
s_mov_b32 m0,s46
s_add_u32 s46,s32,8192
buffer_load_dwordx4 v1,s[4:7],s46 offen sc1 lds
s_add_u32 s46,s44,40960
s_mov_b32 m0,s46
s_add_u32 s46,s33,40960
buffer_load_dwordx4 v1,s[4:7],s46 offen sc1 lds
s_add_u32 s46,s44,45056
s_mov_b32 m0,s46
s_add_u32 s46,s33,45056
buffer_load_dwordx4 v1,s[4:7],s46 offen sc1 lds
s_add_u32 s46,s44,12288
s_mov_b32 m0,s46
s_add_u32 s46,s32,12288
buffer_load_dwordx4 v1,s[4:7],s46 offen sc1 lds
s_add_u32 s46,s44,16384
s_mov_b32 m0,s46
s_add_u32 s46,s32,16384
buffer_load_dwordx4 v1,s[4:7],s46 offen sc1 lds
s_add_u32 s46,s44,20480
s_mov_b32 m0,s46
s_add_u32 s46,s32,20480
buffer_load_dwordx4 v1,s[4:7],s46 offen sc1 lds
s_add_u32 s46,s44,24576
s_mov_b32 m0,s46
s_add_u32 s46,s32,24576
buffer_load_dwordx4 v1,s[4:7],s46 offen sc1 lds
s_add_u32 s46,s44,28672
s_mov_b32 m0,s46
s_add_u32 s46,s32,28672
buffer_load_dwordx4 v1,s[4:7],s46 offen sc1 lds
s_add_u32 s46,s44,32768
s_mov_b32 m0,s46
s_add_u32 s46,s32,32768
buffer_load_dwordx4 v1,s[4:7],s46 offen sc1 lds
s_add_u32 s46,s44,36864
s_mov_b32 m0,s46
s_add_u32 s46,s32,36864
buffer_load_dwordx4 v1,s[4:7],s46 offen sc1 lds
s_mov_b32 s34,1
ns_top_294:
v_add_u32 v6,s35,v1
s_add_u32 s62,s28,1
s_mul_i32 s36,s28,49152
s_add_u32 s36,s36,s68
s_add_u32 s31,s62,1
s_mul_i32 s42,s62,49152
s_add_u32 s32,s66,s42
s_add_u32 s33,s67,s42
s_xor_b32 s44,s35,49152
s_add_u32 s44,s44,s43
s_cmp_eq_u32 s34,0
s_cbranch_scc1 ns_s_299
s_waitcnt vmcnt(9)
ns_s_299:
s_barrier
ds_read_b128 v[48:51],v6
ds_read_b128 v[52:55],v6 offset:1024
ds_read_b128 v[56:59],v6 offset:2048
ds_read_b128 v[60:63],v6 offset:3072
ds_read_b128 v[64:67],v6 offset:4096
ds_read_b128 v[68:71],v6 offset:5120
ds_read_b128 v[72:75],v6 offset:6144
v_cmp_le_u32 vcc,s31,v4
s_nop 0
s_cmp_eq_u64 vcc,-1
s_cselect_b64 vcc,-1,0
s_cmp_lt_u32 s62,s63
s_cselect_b64 vcc,vcc,0
s_cmp_eq_u32 s34,0
s_cselect_b64 vcc,vcc,0
s_and_b32 s29,vcc_lo,1
ds_read_b128 v[76:79],v6 offset:7168
s_waitcnt lgkmcnt(6)
v_mfma_f32_32x32x16_bf16 v[16:31],a[0:3],v[48:51],0
s_cbranch_vccnz ns_o_300
ns_o_300r:
ds_read_b128 v[48:51],v6 offset:8192
v_mfma_f32_32x32x16_bf16 v[16:31],a[4:7],v[52:55],v[16:31]
ds_read_b128 v[52:55],v6 offset:9216
s_waitcnt lgkmcnt(6)
v_mfma_f32_32x32x16_bf16 v[16:31],a[8:11],v[56:59],v[16:31]
s_cbranch_vccnz ns_o_301
ns_o_301r:
ds_read_b128 v[56:59],v6 offset:10240
v_mfma_f32_32x32x16_bf16 v[16:31],a[12:15],v[60:63],v[16:31]
ds_read_b128 v[60:63],v6 offset:11264
s_waitcnt lgkmcnt(6)
v_mfma_f32_32x32x16_bf16 v[16:31],a[16:19],v[64:67],v[16:31]
s_cbranch_vccnz ns_o_302
ns_o_302r:
s_cmp_eq_u32 s34,0
s_cbranch_scc1 ns_s_303
s_waitcnt vmcnt(3)
ns_s_303:
s_barrier
ds_read_b128 v[64:67],v6 offset:12288
v_mfma_f32_32x32x16_bf16 v[16:31],a[20:23],v[68:71],v[16:31]
v_add_u32 v5,s35,v7
ds_read_b64 v[80:81],v5 offset:40960
ds_read_b64 v[82:83],v5 offset:41216
ds_read_b128 v[68:71],v6 offset:13312
s_waitcnt lgkmcnt(8)
v_mfma_f32_32x32x16_bf16 v[16:31],a[24:27],v[72:75],v[16:31]
s_cbranch_vccnz ns_o_304
ns_o_304r:
ds_read_b64 v[84:85],v5 offset:41472
ds_read_b64 v[86:87],v5 offset:41728
ds_read_b128 v[72:75],v6 offset:14336
v_mfma_f32_32x32x16_bf16 v[16:31],a[28:31],v[76:79],v[16:31]
ds_read_b64 v[88:89],v5 offset:41984
ds_read_b64 v[90:91],v5 offset:42240
ds_read_b64 v[92:93],v5 offset:42496
ds_read_b128 v[76:79],v6 offset:15360
s_waitcnt lgkmcnt(13)
v_mfma_f32_32x32x16_bf16 v[16:31],a[32:35],v[48:51],v[16:31]
s_cbranch_vccnz ns_o_305
ns_o_305r:
ds_read_b64 v[94:95],v5 offset:42752
ds_read_b64 v[96:97],v5 offset:43008
ds_read_b128 v[48:51],v6 offset:16384
v_mfma_f32_32x32x16_bf16 v[16:31],a[36:39],v[52:55],v[16:31]
ds_read_b64 v[98:99],v5 offset:43264
ds_read_b128 v[52:55],v6 offset:17408
s_waitcnt lgkmcnt(15)
v_mfma_f32_32x32x16_bf16 v[16:31],a[40:43],v[56:59],v[16:31]
s_cbranch_vccnz ns_o_306
ns_o_306r:
ds_read_b128 v[56:59],v6 offset:18432
v_mfma_f32_32x32x16_bf16 v[16:31],a[44:47],v[60:63],v[16:31]
ds_read_b128 v[60:63],v6 offset:19456
s_waitcnt lgkmcnt(14)
v_mfma_f32_32x32x16_bf16 v[16:31],a[48:51],v[64:67],v[16:31]
s_cbranch_vccnz ns_o_307
ns_o_307r:
s_waitcnt lgkmcnt(3)
v_add_f32 v80,v80,v90
ds_read_b128 v[64:67],v6 offset:20480
v_mfma_f32_32x32x16_bf16 v[16:31],a[52:55],v[68:71],v[16:31]
v_add_f32 v81,v81,v91
v_add_f32 v82,v82,v92
v_add_f32 v83,v83,v93
ds_read_b128 v[68:71],v6 offset:21504
v_mfma_f32_32x32x16_bf16 v[16:31],a[56:59],v[72:75],v[16:31]
s_cbranch_vccnz ns_o_308
ns_o_308r:
v_add_f32 v84,v84,v94
v_add_f32 v85,v85,v95
ds_read_b128 v[72:75],v6 offset:22528
v_mfma_f32_32x32x16_bf16 v[16:31],a[60:63],v[76:79],v[16:31]
v_add_f32 v86,v86,v96
v_add_f32 v87,v87,v97
v_add_f32 v88,v88,v98
ds_read_b128 v[76:79],v6 offset:23552
s_waitcnt lgkmcnt(6)
v_mfma_f32_32x32x16_bf16 v[16:31],a[64:67],v[48:51],v[16:31]
s_cbranch_vccnz ns_o_309
ns_o_309r:
v_add_f32 v89,v89,v99
v_add_f32 v80,v80,v84
ds_read_b128 v[48:51],v6 offset:24576
v_mfma_f32_32x32x16_bf16 v[16:31],a[68:71],v[52:55],v[16:31]
v_add_f32 v81,v81,v85
v_add_f32 v82,v82,v86
v_add_f32 v83,v83,v87
ds_read_b128 v[52:55],v6 offset:25600
s_waitcnt lgkmcnt(6)
v_mfma_f32_32x32x16_bf16 v[16:31],a[72:75],v[56:59],v[16:31]
s_cbranch_vccnz ns_o_310
ns_o_310r:
v_add_f32 v88,v88,v80
v_add_f32 v89,v89,v81
ds_read_b128 v[56:59],v6 offset:26624
v_mfma_f32_32x32x16_bf16 v[16:31],a[76:79],v[60:63],v[16:31]
v_add_f32 v12,v88,v82
v_add_f32 v13,v89,v83
v_mov_b32 v80,v12
ds_read_b128 v[60:63],v6 offset:27648
s_waitcnt lgkmcnt(6)
v_mfma_f32_32x32x16_bf16 v[16:31],a[80:83],v[64:67],v[16:31]
s_cbranch_vccnz ns_o_311
ns_o_311r:
v_mov_b32 v81,v13
s_cmp_eq_u32 s34,0
s_cbranch_scc1 ns_s_312
s_waitcnt vmcnt(0)
ns_s_312:
s_barrier
ds_read_b128 v[64:67],v6 offset:28672
v_mfma_f32_32x32x16_bf16 v[16:31],a[84:87],v[68:71],v[16:31]
v_permlane32_swap_b32 v12,v80
v_permlane32_swap_b32 v13,v81
ds_read_b128 v[68:71],v6 offset:29696
s_waitcnt lgkmcnt(6)
v_mfma_f32_32x32x16_bf16 v[16:31],a[88:91],v[72:75],v[16:31]
s_cbranch_vccnz ns_o_313
ns_o_313r:
v_add_f32 v12,v12,v80
v_add_f32 v13,v13,v81
ds_read_b128 v[72:75],v6 offset:30720
v_mfma_f32_32x32x16_bf16 v[16:31],a[92:95],v[76:79],v[16:31]
v_mul_f32 v12,s48,v12
v_mul_f32 v13,s48,v13
v_fma_f32 v13,-v12,v12,v13
buffer_load_dword v4,v3,s[4:7],0 offen sc1
ds_read_b128 v[76:79],v6 offset:31744
s_waitcnt lgkmcnt(6)
v_mfma_f32_32x32x16_bf16 v[16:31],a[96:99],v[48:51],v[16:31]
v_max_f32 v13,0,v13
v_add_f32 v80,s49,v13
v_rsq_f32 v10,v80
ds_read_b128 v[48:51],v6 offset:32768
v_mfma_f32_32x32x16_bf16 v[16:31],a[100:103],v[52:55],v[16:31]
ds_read_b128 v[52:55],v6 offset:33792
s_waitcnt lgkmcnt(6)
v_mfma_f32_32x32x16_bf16 v[16:31],a[104:107],v[56:59],v[16:31]
v_mul_f32 v80,v10,v10
v_mul_f32 v80,v80,v13
v_add_f32 v80,s49,v80
ds_read_b128 v[56:59],v6 offset:34816
v_mfma_f32_32x32x16_bf16 v[16:31],a[108:111],v[60:63],v[16:31]
v_rsq_f32 v80,v80
ds_read_b128 v[60:63],v6 offset:35840
s_waitcnt lgkmcnt(6)
v_mfma_f32_32x32x16_bf16 v[16:31],a[112:115],v[64:67],v[16:31]
v_mul_f32 v10,v10,v80
v_mul_f32 v11,v12,v10
v_mov_b32 v148,v10
ds_read_b128 v[64:67],v6 offset:36864
v_mfma_f32_32x32x16_bf16 v[16:31],a[116:119],v[68:71],v[16:31]
v_mov_b32 v149,v10
v_mul_f32_e64 v80,-v11,v32
v_mul_f32_e64 v81,-v11,v33
ds_read_b128 v[68:71],v6 offset:37888
s_waitcnt lgkmcnt(6)
v_mfma_f32_32x32x16_bf16 v[16:31],a[120:123],v[72:75],v[16:31]
v_mul_f32_e64 v82,-v11,v34
v_mul_f32_e64 v83,-v11,v35
v_mul_f32_e64 v84,-v11,v36
ds_read_b128 v[72:75],v6 offset:38912
v_mfma_f32_32x32x16_bf16 v[16:31],a[124:127],v[76:79],v[16:31]
v_mul_f32_e64 v85,-v11,v37
v_mul_f32_e64 v86,-v11,v38
v_mul_f32_e64 v87,-v11,v39
ds_read_b128 v[76:79],v6 offset:39936
s_waitcnt lgkmcnt(6)
v_mfma_f32_32x32x16_bf16 v[16:31],a[128:131],v[48:51],v[16:31]
v_mul_f32_e64 v88,-v11,v40
v_mul_f32_e64 v89,-v11,v41
v_mul_f32_e64 v90,-v11,v42
v_mfma_f32_32x32x16_bf16 v[16:31],a[132:135],v[52:55],v[16:31]
v_mul_f32_e64 v91,-v11,v43
v_mul_f32_e64 v92,-v11,v44
v_mul_f32_e64 v93,-v11,v45
s_waitcnt lgkmcnt(4)
v_mfma_f32_32x32x16_bf16 v[16:31],a[136:139],v[56:59],v[16:31]
v_mul_f32_e64 v94,-v11,v46
v_mul_f32_e64 v95,-v11,v47
v_mfma_f32_32x32x16_bf16 v[16:31],a[140:143],v[60:63],v[16:31]
s_waitcnt lgkmcnt(2)
v_mfma_f32_32x32x16_bf16 v[16:31],a[144:147],v[64:67],v[16:31]
v_mfma_f32_32x32x16_bf16 v[16:31],a[148:151],v[68:71],v[16:31]
s_waitcnt lgkmcnt(0)
v_mfma_f32_32x32x16_bf16 v[16:31],a[152:155],v[72:75],v[16:31]
v_mfma_f32_32x32x16_bf16 v[16:31],a[156:159],v[76:79],v[16:31]
s_nop 10
s_cbranch_vccnz ns_npf_314
s_waitcnt vmcnt(0)
v_cmp_le_u32 vcc,s31,v4
s_nop 0
s_cmp_eq_u64 vcc,-1
s_cselect_b64 vcc,-1,0
s_cmp_lt_u32 s62,s63
s_cselect_b64 vcc,vcc,0
s_cbranch_vccz ns_npf_314
s_add_u32 s46,s44,0
s_mov_b32 m0,s46
s_add_u32 s46,s32,0
buffer_load_dwordx4 v1,s[4:7],s46 offen sc1 lds
s_add_u32 s46,s44,4096
s_mov_b32 m0,s46
s_add_u32 s46,s32,4096
buffer_load_dwordx4 v1,s[4:7],s46 offen sc1 lds
s_add_u32 s46,s44,8192
s_mov_b32 m0,s46
s_add_u32 s46,s32,8192
buffer_load_dwordx4 v1,s[4:7],s46 offen sc1 lds
s_add_u32 s46,s44,40960
s_mov_b32 m0,s46
s_add_u32 s46,s33,40960
buffer_load_dwordx4 v1,s[4:7],s46 offen sc1 lds
s_add_u32 s46,s44,45056
s_mov_b32 m0,s46
s_add_u32 s46,s33,45056
buffer_load_dwordx4 v1,s[4:7],s46 offen sc1 lds
s_add_u32 s46,s44,12288
s_mov_b32 m0,s46
s_add_u32 s46,s32,12288
buffer_load_dwordx4 v1,s[4:7],s46 offen sc1 lds
s_add_u32 s46,s44,16384
s_mov_b32 m0,s46
s_add_u32 s46,s32,16384
buffer_load_dwordx4 v1,s[4:7],s46 offen sc1 lds
s_add_u32 s46,s44,20480
s_mov_b32 m0,s46
s_add_u32 s46,s32,20480
buffer_load_dwordx4 v1,s[4:7],s46 offen sc1 lds
s_add_u32 s46,s44,24576
s_mov_b32 m0,s46
s_add_u32 s46,s32,24576
buffer_load_dwordx4 v1,s[4:7],s46 offen sc1 lds
s_add_u32 s46,s44,28672
s_mov_b32 m0,s46
s_add_u32 s46,s32,28672
buffer_load_dwordx4 v1,s[4:7],s46 offen sc1 lds
s_add_u32 s46,s44,32768
s_mov_b32 m0,s46
s_add_u32 s46,s32,32768
buffer_load_dwordx4 v1,s[4:7],s46 offen sc1 lds
s_add_u32 s46,s44,36864
s_mov_b32 m0,s46
s_add_u32 s46,s32,36864
buffer_load_dwordx4 v1,s[4:7],s46 offen sc1 lds
ns_npf_314:
v_pk_fma_f32 v[16:17],v[16:17],v[148:149],v[80:81]
v_pk_fma_f32 v[18:19],v[18:19],v[148:149],v[82:83]
v_pk_fma_f32 v[20:21],v[20:21],v[148:149],v[84:85]
v_pk_fma_f32 v[22:23],v[22:23],v[148:149],v[86:87]
v_pk_mul_f32 v[80:81],v[16:17],v[16:17]
v_pk_mul_f32 v[82:83],v[18:19],v[18:19]
v_pk_mul_f32 v[84:85],v[20:21],v[20:21]
v_pk_mul_f32 v[86:87],v[22:23],v[22:23]
v_pk_fma_f32 v[80:81],v[80:81],v[146:147],v[144:145]
v_pk_fma_f32 v[82:83],v[82:83],v[146:147],v[144:145]
v_pk_fma_f32 v[84:85],v[84:85],v[146:147],v[144:145]
v_pk_fma_f32 v[86:87],v[86:87],v[146:147],v[144:145]
v_pk_mul_f32 v[80:81],v[80:81],v[16:17]
v_pk_mul_f32 v[82:83],v[82:83],v[18:19]
v_pk_mul_f32 v[84:85],v[84:85],v[20:21]
v_pk_mul_f32 v[86:87],v[86:87],v[22:23]
v_exp_f32 v80,v80
v_exp_f32 v81,v81
v_exp_f32 v82,v82
v_exp_f32 v83,v83
v_exp_f32 v84,v84
v_exp_f32 v85,v85
v_exp_f32 v86,v86
v_exp_f32 v87,v87
v_pk_add_f32 v[80:81],v[80:81],1.0 op_sel_hi:[1,0]
v_pk_add_f32 v[82:83],v[82:83],1.0 op_sel_hi:[1,0]
v_pk_add_f32 v[84:85],v[84:85],1.0 op_sel_hi:[1,0]
v_pk_add_f32 v[86:87],v[86:87],1.0 op_sel_hi:[1,0]
v_rcp_f32 v80,v80
v_rcp_f32 v81,v81
v_rcp_f32 v82,v82
v_rcp_f32 v83,v83
v_rcp_f32 v84,v84
v_rcp_f32 v85,v85
v_rcp_f32 v86,v86
v_rcp_f32 v87,v87
v_pk_mul_f32 v[16:17],v[16:17],v[80:81]
v_pk_mul_f32 v[18:19],v[18:19],v[82:83]
v_pk_mul_f32 v[20:21],v[20:21],v[84:85]
v_pk_mul_f32 v[22:23],v[22:23],v[86:87]
v_cvt_pk_bf16_f32 v128,v16,v17
v_cvt_pk_bf16_f32 v129,v18,v19
v_cvt_pk_bf16_f32 v130,v20,v21
v_cvt_pk_bf16_f32 v131,v22,v23
buffer_store_dwordx4 v[128:131],v1,s[24:27],s36 offen sc1
v_pk_fma_f32 v[24:25],v[24:25],v[148:149],v[88:89]
v_pk_fma_f32 v[26:27],v[26:27],v[148:149],v[90:91]
v_pk_fma_f32 v[28:29],v[28:29],v[148:149],v[92:93]
v_pk_fma_f32 v[30:31],v[30:31],v[148:149],v[94:95]
v_pk_mul_f32 v[88:89],v[24:25],v[24:25]
v_pk_mul_f32 v[90:91],v[26:27],v[26:27]
v_pk_mul_f32 v[92:93],v[28:29],v[28:29]
v_pk_mul_f32 v[94:95],v[30:31],v[30:31]
v_pk_fma_f32 v[88:89],v[88:89],v[146:147],v[144:145]
v_pk_fma_f32 v[90:91],v[90:91],v[146:147],v[144:145]
v_pk_fma_f32 v[92:93],v[92:93],v[146:147],v[144:145]
v_pk_fma_f32 v[94:95],v[94:95],v[146:147],v[144:145]
v_pk_mul_f32 v[88:89],v[88:89],v[24:25]
v_pk_mul_f32 v[90:91],v[90:91],v[26:27]
v_pk_mul_f32 v[92:93],v[92:93],v[28:29]
v_pk_mul_f32 v[94:95],v[94:95],v[30:31]
v_exp_f32 v88,v88
v_exp_f32 v89,v89
v_exp_f32 v90,v90
v_exp_f32 v91,v91
v_exp_f32 v92,v92
v_exp_f32 v93,v93
v_exp_f32 v94,v94
v_exp_f32 v95,v95
v_pk_add_f32 v[88:89],v[88:89],1.0 op_sel_hi:[1,0]
v_pk_add_f32 v[90:91],v[90:91],1.0 op_sel_hi:[1,0]
v_pk_add_f32 v[92:93],v[92:93],1.0 op_sel_hi:[1,0]
v_pk_add_f32 v[94:95],v[94:95],1.0 op_sel_hi:[1,0]
v_rcp_f32 v88,v88
v_rcp_f32 v89,v89
v_rcp_f32 v90,v90
v_rcp_f32 v91,v91
v_rcp_f32 v92,v92
v_rcp_f32 v93,v93
v_rcp_f32 v94,v94
v_rcp_f32 v95,v95
v_pk_mul_f32 v[24:25],v[24:25],v[88:89]
v_pk_mul_f32 v[26:27],v[26:27],v[90:91]
v_pk_mul_f32 v[28:29],v[28:29],v[92:93]
v_pk_mul_f32 v[30:31],v[30:31],v[94:95]
v_cvt_pk_bf16_f32 v132,v24,v25
v_cvt_pk_bf16_f32 v133,v26,v27
v_cvt_pk_bf16_f32 v134,v28,v29
v_cvt_pk_bf16_f32 v135,v30,v31
buffer_store_dwordx4 v[132:135],v1,s[24:27],s36 offen offset:1024 sc1
s_add_u32 s64,s28,1
s_mov_b32 s28,s62
s_mov_b32 s69,s36
s_xor_b32 s35,s35,49152
s_mov_b32 s30,1
s_mov_b32 s34,0
s_cbranch_vccz ns_blk_315
s_waitcnt vmcnt(0)
v_mov_b32 v2,s64
s_mov_b64 exec,1
buffer_store_dword v2,off,s[24:27],s37 sc1
s_mov_b64 exec,-1
s_mov_b32 s30,0
s_branch ns_top_294
ns_blk_315:
s_mov_b32 s34,1
buffer_load_dword v4,v3,s[4:7],0 offen sc1
s_waitcnt vmcnt(1)
v_mov_b32 v2,s64
s_mov_b64 exec,1
buffer_store_dword v2,off,s[24:27],s37 sc1
s_mov_b64 exec,-1
s_mov_b32 s30,0
s_cmp_ge_u32 s28,s63
s_cbranch_scc1 ns_fin_295
s_waitcnt vmcnt(1)
v_cmp_le_u32 vcc,s31,v4
s_nop 0
s_cmp_eq_u64 vcc,-1
s_nop 1
s_cbranch_scc1 ns_rdy_316
s_mov_b32 s38,0
poll_317:
buffer_load_dword v4,v3,s[4:7],0 offen sc1
s_waitcnt vmcnt(0)
v_cmp_le_u32 vcc,s31,v4
s_nop 0
s_cmp_eq_u64 vcc,-1
s_nop 1
s_cbranch_scc1 polld_318
s_sleep 2
s_add_u32 s38,s38,1
s_cmp_lt_u32 s38,100000
s_cbranch_scc1 poll_317
s_mov_b32 s40,3
s_branch L_fail
polld_318:
ns_rdy_316:
s_add_u32 s46,s44,0
s_mov_b32 m0,s46
s_add_u32 s46,s32,0
buffer_load_dwordx4 v1,s[4:7],s46 offen sc1 lds
s_add_u32 s46,s44,4096
s_mov_b32 m0,s46
s_add_u32 s46,s32,4096
buffer_load_dwordx4 v1,s[4:7],s46 offen sc1 lds
s_add_u32 s46,s44,8192
s_mov_b32 m0,s46
s_add_u32 s46,s32,8192
buffer_load_dwordx4 v1,s[4:7],s46 offen sc1 lds
s_add_u32 s46,s44,40960
s_mov_b32 m0,s46
s_add_u32 s46,s33,40960
buffer_load_dwordx4 v1,s[4:7],s46 offen sc1 lds
s_add_u32 s46,s44,45056
s_mov_b32 m0,s46
s_add_u32 s46,s33,45056
buffer_load_dwordx4 v1,s[4:7],s46 offen sc1 lds
s_add_u32 s46,s44,12288
s_mov_b32 m0,s46
s_add_u32 s46,s32,12288
buffer_load_dwordx4 v1,s[4:7],s46 offen sc1 lds
s_add_u32 s46,s44,16384
s_mov_b32 m0,s46
s_add_u32 s46,s32,16384
buffer_load_dwordx4 v1,s[4:7],s46 offen sc1 lds
s_add_u32 s46,s44,20480
s_mov_b32 m0,s46
s_add_u32 s46,s32,20480
buffer_load_dwordx4 v1,s[4:7],s46 offen sc1 lds
s_add_u32 s46,s44,24576
s_mov_b32 m0,s46
s_add_u32 s46,s32,24576
buffer_load_dwordx4 v1,s[4:7],s46 offen sc1 lds
s_add_u32 s46,s44,28672
s_mov_b32 m0,s46
s_add_u32 s46,s32,28672
buffer_load_dwordx4 v1,s[4:7],s46 offen sc1 lds
s_add_u32 s46,s44,32768
s_mov_b32 m0,s46
s_add_u32 s46,s32,32768
buffer_load_dwordx4 v1,s[4:7],s46 offen sc1 lds
s_add_u32 s46,s44,36864
s_mov_b32 m0,s46
s_add_u32 s46,s32,36864
buffer_load_dwordx4 v1,s[4:7],s46 offen sc1 lds
s_branch ns_top_294
ns_o_300:
s_add_u32 s46,s44,0
s_mov_b32 m0,s46
s_add_u32 s46,s32,0
buffer_load_dwordx4 v1,s[4:7],s46 offen sc1 lds
s_branch ns_o_300r
ns_o_301:
s_add_u32 s46,s44,4096
s_mov_b32 m0,s46
s_add_u32 s46,s32,4096
buffer_load_dwordx4 v1,s[4:7],s46 offen sc1 lds
s_branch ns_o_301r
ns_o_302:
s_add_u32 s46,s44,8192
s_mov_b32 m0,s46
s_add_u32 s46,s32,8192
buffer_load_dwordx4 v1,s[4:7],s46 offen sc1 lds
s_branch ns_o_302r
ns_o_304:
s_add_u32 s46,s44,40960
s_mov_b32 m0,s46
s_add_u32 s46,s33,40960
buffer_load_dwordx4 v1,s[4:7],s46 offen sc1 lds
s_branch ns_o_304r
ns_o_305:
s_add_u32 s46,s44,45056
s_mov_b32 m0,s46
s_add_u32 s46,s33,45056
buffer_load_dwordx4 v1,s[4:7],s46 offen sc1 lds
s_branch ns_o_305r
ns_o_306:
s_add_u32 s46,s44,12288
s_mov_b32 m0,s46
s_add_u32 s46,s32,12288
buffer_load_dwordx4 v1,s[4:7],s46 offen sc1 lds
s_branch ns_o_306r
ns_o_307:
s_add_u32 s46,s44,16384
s_mov_b32 m0,s46
s_add_u32 s46,s32,16384
buffer_load_dwordx4 v1,s[4:7],s46 offen sc1 lds
s_branch ns_o_307r
ns_o_308:
s_add_u32 s46,s44,20480
s_mov_b32 m0,s46
s_add_u32 s46,s32,20480
buffer_load_dwordx4 v1,s[4:7],s46 offen sc1 lds
s_branch ns_o_308r
ns_o_309:
s_add_u32 s46,s44,24576
s_mov_b32 m0,s46
s_add_u32 s46,s32,24576
buffer_load_dwordx4 v1,s[4:7],s46 offen sc1 lds
s_branch ns_o_309r
ns_o_310:
s_add_u32 s46,s44,28672
s_mov_b32 m0,s46
s_add_u32 s46,s32,28672
buffer_load_dwordx4 v1,s[4:7],s46 offen sc1 lds
s_branch ns_o_310r
ns_o_311:
s_add_u32 s46,s44,32768
s_mov_b32 m0,s46
s_add_u32 s46,s32,32768
buffer_load_dwordx4 v1,s[4:7],s46 offen sc1 lds
s_branch ns_o_311r
ns_o_313:
s_add_u32 s46,s44,36864
s_mov_b32 m0,s46
s_add_u32 s46,s32,36864
buffer_load_dwordx4 v1,s[4:7],s46 offen sc1 lds
s_branch ns_o_313r
ns_fin_295:
s_branch L_end
R_w2:
s_add_u32 s42,s42,s43
s_lshl_b32 s41,s42,2
s_add_u32 s41,s41,s3
s_mov_b32 s24,s4
s_mov_b32 s25,s5
s_mov_b32 s27,0x20000
s_cmp_lt_u32 s41,20
s_cselect_b32 s26,s6,0
s_min_u32 s41,s41,19
v_lshlrev_b32 v1,4,v0
s_load_dwordx2 s[20:21],s[0:1],72
s_waitcnt lgkmcnt(0)
s_mov_b32 s16,s20
s_and_b32 s17,s21,0xffff
s_mov_b32 s18,0xc8000
s_mov_b32 s19,0x20000
s_lshl_b32 s42,s41,6
v_lshrrev_b32 v82,2,v0
v_mul_u32_u24 v80,1280,v82
v_and_b32 v82,3,v0
v_lshl_add_u32 v80,v82,4,v80
v_lshlrev_b32 v81,3,v82
v_bfe_u32 v82,v0,4,1
v_lshl_add_u32 v81,v82,5,v81
v_bfe_u32 v82,v0,2,2
v_lshl_add_u32 v81,v82,6,v81
v_lshrrev_b32 v82,5,v0
v_lshl_add_u32 v81,v82,8,v81
s_mul_i32 s22,s3,40960
v_add_u32 v81,s22,v81
s_add_u32 s23,s22,0
s_mov_b32 m0,s23
s_add_u32 s23,s42,0
buffer_load_dwordx4 v80,s[16:19],s23 offen lds
s_add_u32 s23,s22,1024
s_mov_b32 m0,s23
s_add_u32 s23,s42,20480
buffer_load_dwordx4 v80,s[16:19],s23 offen lds
s_add_u32 s23,s22,2048
s_mov_b32 m0,s23
s_add_u32 s23,s42,40960
buffer_load_dwordx4 v80,s[16:19],s23 offen lds
s_add_u32 s23,s22,3072
s_mov_b32 m0,s23
s_add_u32 s23,s42,61440
buffer_load_dwordx4 v80,s[16:19],s23 offen lds
s_add_u32 s23,s22,4096
s_mov_b32 m0,s23
s_add_u32 s23,s42,81920
buffer_load_dwordx4 v80,s[16:19],s23 offen lds
s_add_u32 s23,s22,5120
s_mov_b32 m0,s23
s_add_u32 s23,s42,102400
buffer_load_dwordx4 v80,s[16:19],s23 offen lds
s_add_u32 s23,s22,6144
s_mov_b32 m0,s23
s_add_u32 s23,s42,122880
buffer_load_dwordx4 v80,s[16:19],s23 offen lds
s_add_u32 s23,s22,7168
s_mov_b32 m0,s23
s_add_u32 s23,s42,143360
buffer_load_dwordx4 v80,s[16:19],s23 offen lds
s_add_u32 s23,s22,8192
s_mov_b32 m0,s23
s_add_u32 s23,s42,163840
buffer_load_dwordx4 v80,s[16:19],s23 offen lds
s_add_u32 s23,s22,9216
s_mov_b32 m0,s23
s_add_u32 s23,s42,184320
buffer_load_dwordx4 v80,s[16:19],s23 offen lds
s_add_u32 s23,s22,10240
s_mov_b32 m0,s23
s_add_u32 s23,s42,204800
buffer_load_dwordx4 v80,s[16:19],s23 offen lds
s_add_u32 s23,s22,11264
s_mov_b32 m0,s23
s_add_u32 s23,s42,225280
buffer_load_dwordx4 v80,s[16:19],s23 offen lds
s_add_u32 s23,s22,12288
s_mov_b32 m0,s23
s_add_u32 s23,s42,245760
buffer_load_dwordx4 v80,s[16:19],s23 offen lds
s_add_u32 s23,s22,13312
s_mov_b32 m0,s23
s_add_u32 s23,s42,266240
buffer_load_dwordx4 v80,s[16:19],s23 offen lds
s_add_u32 s23,s22,14336
s_mov_b32 m0,s23
s_add_u32 s23,s42,286720
buffer_load_dwordx4 v80,s[16:19],s23 offen lds
s_add_u32 s23,s22,15360
s_mov_b32 m0,s23
s_add_u32 s23,s42,307200
buffer_load_dwordx4 v80,s[16:19],s23 offen lds
s_add_u32 s23,s22,16384
s_mov_b32 m0,s23
s_add_u32 s23,s42,327680
buffer_load_dwordx4 v80,s[16:19],s23 offen lds
s_add_u32 s23,s22,17408
s_mov_b32 m0,s23
s_add_u32 s23,s42,348160
buffer_load_dwordx4 v80,s[16:19],s23 offen lds
s_add_u32 s23,s22,18432
s_mov_b32 m0,s23
s_add_u32 s23,s42,368640
buffer_load_dwordx4 v80,s[16:19],s23 offen lds
s_add_u32 s23,s22,19456
s_mov_b32 m0,s23
s_add_u32 s23,s42,389120
buffer_load_dwordx4 v80,s[16:19],s23 offen lds
s_add_u32 s23,s22,20480
s_mov_b32 m0,s23
s_add_u32 s23,s42,409600
buffer_load_dwordx4 v80,s[16:19],s23 offen lds
s_add_u32 s23,s22,21504
s_mov_b32 m0,s23
s_add_u32 s23,s42,430080
buffer_load_dwordx4 v80,s[16:19],s23 offen lds
s_add_u32 s23,s22,22528
s_mov_b32 m0,s23
s_add_u32 s23,s42,450560
buffer_load_dwordx4 v80,s[16:19],s23 offen lds
s_add_u32 s23,s22,23552
s_mov_b32 m0,s23
s_add_u32 s23,s42,471040
buffer_load_dwordx4 v80,s[16:19],s23 offen lds
s_add_u32 s23,s22,24576
s_mov_b32 m0,s23
s_add_u32 s23,s42,491520
buffer_load_dwordx4 v80,s[16:19],s23 offen lds
s_add_u32 s23,s22,25600
s_mov_b32 m0,s23
s_add_u32 s23,s42,512000
buffer_load_dwordx4 v80,s[16:19],s23 offen lds
s_add_u32 s23,s22,26624
s_mov_b32 m0,s23
s_add_u32 s23,s42,532480
buffer_load_dwordx4 v80,s[16:19],s23 offen lds
s_add_u32 s23,s22,27648
s_mov_b32 m0,s23
s_add_u32 s23,s42,552960
buffer_load_dwordx4 v80,s[16:19],s23 offen lds
s_add_u32 s23,s22,28672
s_mov_b32 m0,s23
s_add_u32 s23,s42,573440
buffer_load_dwordx4 v80,s[16:19],s23 offen lds
s_add_u32 s23,s22,29696
s_mov_b32 m0,s23
s_add_u32 s23,s42,593920
buffer_load_dwordx4 v80,s[16:19],s23 offen lds
s_add_u32 s23,s22,30720
s_mov_b32 m0,s23
s_add_u32 s23,s42,614400
buffer_load_dwordx4 v80,s[16:19],s23 offen lds
s_add_u32 s23,s22,31744
s_mov_b32 m0,s23
s_add_u32 s23,s42,634880
buffer_load_dwordx4 v80,s[16:19],s23 offen lds
s_add_u32 s23,s22,32768
s_mov_b32 m0,s23
s_add_u32 s23,s42,655360
buffer_load_dwordx4 v80,s[16:19],s23 offen lds
s_add_u32 s23,s22,33792
s_mov_b32 m0,s23
s_add_u32 s23,s42,675840
buffer_load_dwordx4 v80,s[16:19],s23 offen lds
s_add_u32 s23,s22,34816
s_mov_b32 m0,s23
s_add_u32 s23,s42,696320
buffer_load_dwordx4 v80,s[16:19],s23 offen lds
s_add_u32 s23,s22,35840
s_mov_b32 m0,s23
s_add_u32 s23,s42,716800
buffer_load_dwordx4 v80,s[16:19],s23 offen lds
s_waitcnt vmcnt(35)
ds_read_b64_tr_b16 a[0:1],v81
ds_read_b64_tr_b16 a[2:3],v81 offset:512
s_waitcnt vmcnt(34)
ds_read_b64_tr_b16 a[4:5],v81 offset:1024
ds_read_b64_tr_b16 a[6:7],v81 offset:1536
s_waitcnt vmcnt(33)
ds_read_b64_tr_b16 a[8:9],v81 offset:2048
ds_read_b64_tr_b16 a[10:11],v81 offset:2560
s_waitcnt vmcnt(32)
ds_read_b64_tr_b16 a[12:13],v81 offset:3072
ds_read_b64_tr_b16 a[14:15],v81 offset:3584
s_waitcnt lgkmcnt(6)
s_add_u32 s23,s22,0
s_mov_b32 m0,s23
s_add_u32 s23,s42,737280
buffer_load_dwordx4 v80,s[16:19],s23 offen lds
s_waitcnt vmcnt(32)
ds_read_b64_tr_b16 a[16:17],v81 offset:4096
ds_read_b64_tr_b16 a[18:19],v81 offset:4608
s_waitcnt lgkmcnt(6)
s_add_u32 s23,s22,1024
s_mov_b32 m0,s23
s_add_u32 s23,s42,757760
buffer_load_dwordx4 v80,s[16:19],s23 offen lds
s_waitcnt vmcnt(32)
ds_read_b64_tr_b16 a[20:21],v81 offset:5120
ds_read_b64_tr_b16 a[22:23],v81 offset:5632
s_waitcnt lgkmcnt(6)
s_add_u32 s23,s22,2048
s_mov_b32 m0,s23
s_add_u32 s23,s42,778240
buffer_load_dwordx4 v80,s[16:19],s23 offen lds
s_waitcnt vmcnt(32)
ds_read_b64_tr_b16 a[24:25],v81 offset:6144
ds_read_b64_tr_b16 a[26:27],v81 offset:6656
s_waitcnt lgkmcnt(6)
s_add_u32 s23,s22,3072
s_mov_b32 m0,s23
s_add_u32 s23,s42,798720
buffer_load_dwordx4 v80,s[16:19],s23 offen lds
s_waitcnt vmcnt(32)
ds_read_b64_tr_b16 a[28:29],v81 offset:7168
ds_read_b64_tr_b16 a[30:31],v81 offset:7680
s_waitcnt vmcnt(31)
ds_read_b64_tr_b16 a[32:33],v81 offset:8192
ds_read_b64_tr_b16 a[34:35],v81 offset:8704
s_waitcnt vmcnt(30)
ds_read_b64_tr_b16 a[36:37],v81 offset:9216
ds_read_b64_tr_b16 a[38:39],v81 offset:9728
s_waitcnt vmcnt(29)
ds_read_b64_tr_b16 a[40:41],v81 offset:10240
ds_read_b64_tr_b16 a[42:43],v81 offset:10752
s_waitcnt vmcnt(28)
ds_read_b64_tr_b16 a[44:45],v81 offset:11264
ds_read_b64_tr_b16 a[46:47],v81 offset:11776
s_waitcnt vmcnt(27)
ds_read_b64_tr_b16 a[48:49],v81 offset:12288
ds_read_b64_tr_b16 a[50:51],v81 offset:12800
s_waitcnt vmcnt(26)
ds_read_b64_tr_b16 a[52:53],v81 offset:13312
ds_read_b64_tr_b16 a[54:55],v81 offset:13824
s_waitcnt vmcnt(25)
ds_read_b64_tr_b16 a[56:57],v81 offset:14336
ds_read_b64_tr_b16 a[58:59],v81 offset:14848
s_waitcnt vmcnt(24)
ds_read_b64_tr_b16 a[60:61],v81 offset:15360
ds_read_b64_tr_b16 a[62:63],v81 offset:15872
s_waitcnt vmcnt(23)
ds_read_b64_tr_b16 a[64:65],v81 offset:16384
ds_read_b64_tr_b16 a[66:67],v81 offset:16896
s_waitcnt vmcnt(22)
ds_read_b64_tr_b16 a[68:69],v81 offset:17408
ds_read_b64_tr_b16 a[70:71],v81 offset:17920
s_waitcnt vmcnt(21)
ds_read_b64_tr_b16 a[72:73],v81 offset:18432
ds_read_b64_tr_b16 a[74:75],v81 offset:18944
s_waitcnt vmcnt(20)
ds_read_b64_tr_b16 a[76:77],v81 offset:19456
ds_read_b64_tr_b16 a[78:79],v81 offset:19968
s_waitcnt vmcnt(19)
ds_read_b64_tr_b16 a[80:81],v81 offset:20480
ds_read_b64_tr_b16 a[82:83],v81 offset:20992
s_waitcnt vmcnt(18)
ds_read_b64_tr_b16 a[84:85],v81 offset:21504
ds_read_b64_tr_b16 a[86:87],v81 offset:22016
s_waitcnt vmcnt(17)
ds_read_b64_tr_b16 a[88:89],v81 offset:22528
ds_read_b64_tr_b16 a[90:91],v81 offset:23040
s_waitcnt vmcnt(16)
ds_read_b64_tr_b16 a[92:93],v81 offset:23552
ds_read_b64_tr_b16 a[94:95],v81 offset:24064
s_waitcnt vmcnt(15)
ds_read_b64_tr_b16 a[96:97],v81 offset:24576
ds_read_b64_tr_b16 a[98:99],v81 offset:25088
s_waitcnt vmcnt(14)
ds_read_b64_tr_b16 a[100:101],v81 offset:25600
ds_read_b64_tr_b16 a[102:103],v81 offset:26112
s_waitcnt vmcnt(13)
ds_read_b64_tr_b16 a[104:105],v81 offset:26624
ds_read_b64_tr_b16 a[106:107],v81 offset:27136
s_waitcnt vmcnt(12)
ds_read_b64_tr_b16 a[108:109],v81 offset:27648
ds_read_b64_tr_b16 a[110:111],v81 offset:28160
s_waitcnt vmcnt(11)
ds_read_b64_tr_b16 a[112:113],v81 offset:28672
ds_read_b64_tr_b16 a[114:115],v81 offset:29184
s_waitcnt vmcnt(10)
ds_read_b64_tr_b16 a[116:117],v81 offset:29696
ds_read_b64_tr_b16 a[118:119],v81 offset:30208
s_waitcnt vmcnt(9)
ds_read_b64_tr_b16 a[120:121],v81 offset:30720
ds_read_b64_tr_b16 a[122:123],v81 offset:31232
s_waitcnt vmcnt(8)
ds_read_b64_tr_b16 a[124:125],v81 offset:31744
ds_read_b64_tr_b16 a[126:127],v81 offset:32256
s_waitcnt vmcnt(7)
ds_read_b64_tr_b16 a[128:129],v81 offset:32768
ds_read_b64_tr_b16 a[130:131],v81 offset:33280
s_waitcnt vmcnt(6)
ds_read_b64_tr_b16 a[132:133],v81 offset:33792
ds_read_b64_tr_b16 a[134:135],v81 offset:34304
s_waitcnt vmcnt(5)
ds_read_b64_tr_b16 a[136:137],v81 offset:34816
ds_read_b64_tr_b16 a[138:139],v81 offset:35328
s_waitcnt vmcnt(4)
ds_read_b64_tr_b16 a[140:141],v81 offset:35840
ds_read_b64_tr_b16 a[142:143],v81 offset:36352
s_waitcnt vmcnt(3)
ds_read_b64_tr_b16 a[144:145],v81
ds_read_b64_tr_b16 a[146:147],v81 offset:512
s_waitcnt vmcnt(2)
ds_read_b64_tr_b16 a[148:149],v81 offset:1024
ds_read_b64_tr_b16 a[150:151],v81 offset:1536
s_waitcnt vmcnt(1)
ds_read_b64_tr_b16 a[152:153],v81 offset:2048
ds_read_b64_tr_b16 a[154:155],v81 offset:2560
s_waitcnt vmcnt(0)
ds_read_b64_tr_b16 a[156:157],v81 offset:3072
ds_read_b64_tr_b16 a[158:159],v81 offset:3584
s_waitcnt lgkmcnt(0)
s_barrier
s_lshr_b32 s20,s2,5
v_and_b32 v81,7,v0
v_min_u32 v80,1,v81
v_lshl_add_u32 v81,v80,3,v81
v_lshlrev_b32 v81,4,v81
s_mov_b32 s38,0
s_nop 0
reg_319:
buffer_load_dword v80,v81,s[12:15],0 offen sc1
s_waitcnt vmcnt(0)
v_readlane_b32 s50,v80,0
v_readlane_b32 s51,v80,1
v_readlane_b32 s52,v80,2
v_readlane_b32 s53,v80,3
v_readlane_b32 s54,v80,4
v_readlane_b32 s55,v80,5
v_readlane_b32 s56,v80,6
v_readlane_b32 s57,v80,7
v_readlane_b32 s58,v80,s20
s_nop 0
s_cmp_ge_u32 s58,32
s_nop 1
s_cbranch_scc1 regd_320
s_add_u32 s59,s50,s51
s_add_u32 s59,s59,s52
s_add_u32 s59,s59,s53
s_add_u32 s59,s59,s54
s_add_u32 s59,s59,s55
s_add_u32 s59,s59,s56
s_add_u32 s59,s59,s57
s_cmp_ge_u32 s59,256
s_cbranch_scc1 regd_320
s_sleep 2
s_add_u32 s38,s38,1
s_cmp_lt_u32 s38,100000
s_cbranch_scc1 reg_319
s_mov_b32 s40,15
s_branch L_fail
regd_320:
s_cmp_ge_u32 s58,32
s_cselect_b32 s21,1,0
v_mov_b32 v80,68
s_mov_b32 s99,128
s_mov_b32 s38,0
poll_321:
buffer_load_dword v81,v80,s[12:15],0 offen sc1
s_waitcnt vmcnt(0)
v_cmp_le_u32 vcc,s99,v81
s_nop 0
s_cmp_eq_u64 vcc,-1
s_nop 1
s_cbranch_scc1 polld_322
s_sleep 8
s_add_u32 s38,s38,1
s_cmp_lt_u32 s38,100000
s_cbranch_scc1 poll_321
s_mov_b32 s40,14
s_branch L_fail
polld_322:
v_readfirstlane_b32 s99,v81
s_nop 0
s_and_b32 s99,s99,1
s_lshl_b32 s99,s99,13
v_and_b32 v9,31,v0
v_lshrrev_b32 v5,5,v0
v_mul_u32_u24 v7,2560,v5
v_lshl_add_u32 v7,v9,3,v7
s_lshl_b32 s43,s3,10
v_mov_b32 v144,0xc0135761
v_mov_b32 v145,0xc0135761
v_mov_b32 v146,0xbdd2d3e8
v_mov_b32 v147,0xbdd2d3e8
s_mov_b32 s48,0x3acccccd
s_mov_b32 s49,0x3727c5ac
s_mov_b32 s35,0
s_mov_b32 s28,0
s_mov_b32 s63,64
s_lshl_b32 s42,s39,1
s_sub_u32 s63,65,s42
ns_init_323:
v_min_u32 v3,19,v0
v_lshlrev_b32 v3,7,v3
s_mul_i32 s42,s39,0x48000
s_add_u32 s42,s42,0x40000
s_lshl_b32 s101,s39,13
s_xor_b32 s101,s101,s99
s_xor_b32 s101,s101,8192
s_add_u32 s42,s42,s101
v_add_u32 v3,s42,v3
s_mul_i32 s42,s39,0x48000
s_add_u32 s42,s42,0x31000
s_lshl_b32 s101,s39,13
s_xor_b32 s101,s101,s99
s_xor_b32 s101,s101,8192
s_add_u32 s42,s42,s101
s_lshl_b32 s46,s41,7
s_add_u32 s42,s42,s46
v_mov_b32 v80,s42
v_cmp_lt_u32 vcc,31,v0
s_nop 1
v_cndmask_b32 v3,v3,v80,vcc
v_cndmask_b32 v156,0,8,vcc
s_mul_i32 s37,s39,0x48000
s_add_u32 s37,s37,0x48000
s_lshl_b32 s101,s39,13
s_xor_b32 s101,s101,s99
s_xor_b32 s101,s101,8192
s_add_u32 s37,s37,s101
s_and_b32 s42,s41,63
s_lshl_b32 s42,s42,7
s_add_u32 s37,s37,s42
s_lshr_b32 s42,s41,6
s_lshl_b32 s42,s42,4
s_add_u32 s37,s37,s42
s_mul_i32 s66,s39,0x318000
s_add_u32 s66,s66,0x410c000
s_add_u32 s66,s66,s43
s_mul_i32 s67,s39,0x300000
s_add_u32 s67,s67,0x3b00000
s_lshl_b32 s42,s41,11
s_add_u32 s45,s67,s42
s_add_u32 s67,s67,s43
s_mul_i32 s68,s39,0x300000
s_add_u32 s68,s68,0x4730000
s_lshl_b32 s42,s41,11
s_add_u32 s68,s68,s42
v_add_u32 v80,31,v9
v_lshrrev_b32 v81,5,v80
v_and_b32 v82,31,v80
v_mul_u32_u24 v81,49152,v81
v_lshl_add_u32 v81,v82,4,v81
v_lshl_add_u32 v158,v5,9,v81
v_add_u32 v80,33,v9
v_lshrrev_b32 v81,5,v80
v_and_b32 v82,31,v80
v_mul_u32_u24 v81,49152,v81
v_lshl_add_u32 v81,v82,4,v81
v_lshl_add_u32 v159,v5,9,v81
v_add_u32 v80,30,v9
v_lshrrev_b32 v81,5,v80
v_and_b32 v82,31,v80
v_mul_u32_u24 v81,49152,v81
v_lshl_add_u32 v81,v82,4,v81
v_lshl_add_u32 v160,v5,9,v81
v_add_u32 v80,34,v9
v_lshrrev_b32 v81,5,v80
v_and_b32 v82,31,v80
v_mul_u32_u24 v81,49152,v81
v_lshl_add_u32 v81,v82,4,v81
v_lshl_add_u32 v161,v5,9,v81
s_cmp_ge_u32 s3,2
s_cselect_b64 vcc,-1,0
v_cndmask_b32 v162,v158,v159,vcc
v_cndmask_b32 v163,v160,v161,vcc
s_sub_u32 s66,s66,49152
v_lshlrev_b32 v9,3,v9
s_mul_i32 s42,s39,0x48000
s_add_u32 s42,s42,0x38000
s_lshl_b32 s101,s39,13
s_xor_b32 s101,s101,s99
s_xor_b32 s101,s101,8192
s_add_u32 s42,s42,s101
v_mov_b32 v80,s42
s_mov_b32 s38,0
s_nop 0
poll_327:
buffer_load_dword v4,v80,s[4:7],0 offen sc1
s_waitcnt vmcnt(0)
v_cmp_le_u32 vcc,1,v4
s_nop 0
s_cmp_eq_u64 vcc,-1
s_nop 1
s_cbranch_scc1 polld_328
s_sleep 8
s_add_u32 s38,s38,1
s_cmp_lt_u32 s38,100000
s_cbranch_scc1 poll_327
s_mov_b32 s40,4
s_branch L_fail
polld_328:
s_add_u32 s46,s28,0
s_mul_i32 s46,s46,49152
s_add_u32 s46,s46,s68
buffer_load_dwordx4 v[152:155],v1,s[24:27],s46 offen sc1
buffer_load_dwordx4 v[152:155],v1,s[24:27],s46 offen offset:1024 sc1
s_mul_i32 s42,s41,1792
s_sub_u32 s46,s46,s42
s_add_u32 s46,s46,40960
buffer_load_dwordx2 v[152:153],v9,s[24:27],s46 offen sc1
s_add_u32 s46,s28,1
s_mul_i32 s46,s46,49152
s_add_u32 s46,s46,s68
buffer_load_dwordx4 v[152:155],v1,s[24:27],s46 offen sc1
buffer_load_dwordx4 v[152:155],v1,s[24:27],s46 offen offset:1024 sc1
s_mul_i32 s42,s41,1792
s_sub_u32 s46,s46,s42
s_add_u32 s46,s46,40960
buffer_load_dwordx2 v[152:153],v9,s[24:27],s46 offen sc1
s_add_u32 s46,s28,2
s_mul_i32 s46,s46,49152
s_add_u32 s46,s46,s68
buffer_load_dwordx4 v[152:155],v1,s[24:27],s46 offen sc1
buffer_load_dwordx4 v[152:155],v1,s[24:27],s46 offen offset:1024 sc1
s_mul_i32 s42,s41,1792
s_sub_u32 s46,s46,s42
s_add_u32 s46,s46,40960
buffer_load_dwordx2 v[152:153],v9,s[24:27],s46 offen sc1
s_add_u32 s46,s28,3
s_mul_i32 s46,s46,49152
s_add_u32 s46,s46,s68
buffer_load_dwordx4 v[152:155],v1,s[24:27],s46 offen sc1
buffer_load_dwordx4 v[152:155],v1,s[24:27],s46 offen offset:1024 sc1
s_mul_i32 s42,s41,1792
s_sub_u32 s46,s46,s42
s_add_u32 s46,s46,40960
buffer_load_dwordx2 v[152:153],v9,s[24:27],s46 offen sc1
s_add_u32 s46,s28,4
s_mul_i32 s46,s46,49152
s_add_u32 s46,s46,s68
buffer_load_dwordx4 v[152:155],v1,s[24:27],s46 offen sc1
buffer_load_dwordx4 v[152:155],v1,s[24:27],s46 offen offset:1024 sc1
s_mul_i32 s42,s41,1792
s_sub_u32 s46,s46,s42
s_add_u32 s46,s46,40960
buffer_load_dwordx2 v[152:153],v9,s[24:27],s46 offen sc1
s_add_u32 s46,s28,5
s_mul_i32 s46,s46,49152
s_add_u32 s46,s46,s68
buffer_load_dwordx4 v[152:155],v1,s[24:27],s46 offen sc1
buffer_load_dwordx4 v[152:155],v1,s[24:27],s46 offen offset:1024 sc1
s_mul_i32 s42,s41,1792
s_sub_u32 s46,s46,s42
s_add_u32 s46,s46,40960
buffer_load_dwordx2 v[152:153],v9,s[24:27],s46 offen sc1
s_add_u32 s46,s28,6
s_mul_i32 s46,s46,49152
s_add_u32 s46,s46,s68
buffer_load_dwordx4 v[152:155],v1,s[24:27],s46 offen sc1
buffer_load_dwordx4 v[152:155],v1,s[24:27],s46 offen offset:1024 sc1
s_mul_i32 s42,s41,1792
s_sub_u32 s46,s46,s42
s_add_u32 s46,s46,40960
buffer_load_dwordx2 v[152:153],v9,s[24:27],s46 offen sc1
s_add_u32 s46,s28,7
s_mul_i32 s46,s46,49152
s_add_u32 s46,s46,s68
buffer_load_dwordx4 v[152:155],v1,s[24:27],s46 offen sc1
buffer_load_dwordx4 v[152:155],v1,s[24:27],s46 offen offset:1024 sc1
s_mul_i32 s42,s41,1792
s_sub_u32 s46,s46,s42
s_add_u32 s46,s46,40960
buffer_load_dwordx2 v[152:153],v9,s[24:27],s46 offen sc1
s_waitcnt vmcnt(0) lgkmcnt(0)
s_getpc_b64 s[60:61]
pc_329:
s_add_u32 s60,s60,ns_top_325-pc_329
s_addc_u32 s61,s61,0
s_mov_b32 s59,ns_fin_326-ns_top_325-4
v_lshlrev_b32 v82,7,v0
v_add_u32 v82,0,v82
v_min_u32 v82,s59,v82
v_mov_b32 v81,s61
v_add_co_u32 v80,vcc,s60,v82
s_nop 1
v_addc_co_u32 v81,vcc,0,v81,vcc
global_load_dword v83,v[80:81],off
s_waitcnt vmcnt(0)
s_mov_b32 s30,0
s_add_u32 s31,s28,2
s_min_u32 s31,s31,64
s_mul_i32 s42,s28,49152
s_add_u32 s32,s66,s42
s_add_u32 s33,s67,s42
s_mov_b32 s38,0
poll_330:
buffer_load_dword v4,v3,s[4:7],0 offen sc1
s_waitcnt vmcnt(0)
v_add_u32 v157,v156,v4
v_cmp_le_u32 vcc,s31,v157
s_nop 0
s_cmp_eq_u64 vcc,-1
s_nop 1
s_cbranch_scc1 polld_331
s_sleep 2
s_add_u32 s38,s38,1
s_cmp_lt_u32 s38,100000
s_cbranch_scc1 poll_330
s_mov_b32 s40,4
s_branch L_fail
polld_331:
s_add_u32 s44,s35,s43
s_add_u32 s46,s44,0
s_mov_b32 m0,s46
s_add_u32 s46,s32,0
buffer_load_dwordx4 v158,s[4:7],s46 offen sc1 lds
s_add_u32 s46,s44,4096
s_mov_b32 m0,s46
s_add_u32 s46,s32,4096
buffer_load_dwordx4 v158,s[4:7],s46 offen sc1 lds
s_add_u32 s46,s44,8192
s_mov_b32 m0,s46
s_add_u32 s46,s32,8192
buffer_load_dwordx4 v162,s[4:7],s46 offen sc1 lds
s_add_u32 s46,s44,40960
s_mov_b32 m0,s46
s_add_u32 s46,s33,40960
buffer_load_dwordx4 v1,s[4:7],s46 offen sc1 lds
s_add_u32 s46,s44,45056
s_mov_b32 m0,s46
s_add_u32 s46,s33,45056
buffer_load_dwordx4 v1,s[4:7],s46 offen sc1 lds
s_add_u32 s46,s44,12288
s_mov_b32 m0,s46
s_add_u32 s46,s32,12288
buffer_load_dwordx4 v159,s[4:7],s46 offen sc1 lds
s_add_u32 s46,s44,16384
s_mov_b32 m0,s46
s_add_u32 s46,s32,16384
buffer_load_dwordx4 v159,s[4:7],s46 offen sc1 lds
s_add_u32 s46,s44,20480
s_mov_b32 m0,s46
s_add_u32 s46,s32,20480
buffer_load_dwordx4 v160,s[4:7],s46 offen sc1 lds
s_add_u32 s46,s44,24576
s_mov_b32 m0,s46
s_add_u32 s46,s32,24576
buffer_load_dwordx4 v160,s[4:7],s46 offen sc1 lds
s_add_u32 s46,s44,28672
s_mov_b32 m0,s46
s_add_u32 s46,s32,28672
buffer_load_dwordx4 v163,s[4:7],s46 offen sc1 lds
s_add_u32 s46,s44,32768
s_mov_b32 m0,s46
s_add_u32 s46,s32,32768
buffer_load_dwordx4 v161,s[4:7],s46 offen sc1 lds
s_add_u32 s46,s44,36864
s_mov_b32 m0,s46
s_add_u32 s46,s32,36864
buffer_load_dwordx4 v161,s[4:7],s46 offen sc1 lds
s_mov_b32 s34,1
ns_top_325:
v_add_u32 v6,s35,v1
s_add_u32 s62,s28,1
s_mul_i32 s36,s28,49152
s_add_u32 s46,s45,s36
buffer_load_dwordx4 v[112:115],v1,s[4:7],s46 offen sc1
buffer_load_dwordx4 v[116:119],v1,s[4:7],s46 offen offset:1024 sc1
s_cmp_lg_u32 s62,64
s_cbranch_scc1 ns_tt_332
s_add_u32 s66,s66,3194880
s_add_u32 s67,s67,3096576
s_add_u32 s45,s45,3096576
v_mov_b32 v4,0
s_mov_b32 exec_hi,0
v_add_u32 v3,294912,v3
v_xor_b32 v3,8192,v3
s_mov_b64 exec,-1
v_min_u32 v156,7,v156
s_nop 1
ns_tt_332:
s_and_b32 s36,s28,7
s_mul_i32 s36,s36,49152
s_add_u32 s36,s36,s68
s_add_u32 s31,s62,2
s_min_u32 s31,s31,64
s_mul_i32 s42,s62,49152
s_add_u32 s32,s66,s42
s_add_u32 s33,s67,s42
s_xor_b32 s44,s35,49152
s_add_u32 s44,s44,s43
s_cmp_eq_u32 s34,0
s_cbranch_scc1 ns_s_333
s_waitcnt vmcnt(11)
ns_s_333:
s_barrier
ds_read_b128 v[48:51],v6
ds_read_b128 v[52:55],v6 offset:1024
ds_read_b128 v[56:59],v6 offset:2048
ds_read_b128 v[60:63],v6 offset:3072
ds_read_b128 v[64:67],v6 offset:4096
ds_read_b128 v[68:71],v6 offset:5120
ds_read_b128 v[72:75],v6 offset:6144
v_add_u32 v157,v156,v4
v_cmp_le_u32 vcc,s31,v157
s_nop 0
s_cmp_eq_u64 vcc,-1
s_cselect_b64 vcc,-1,0
s_cmp_lt_u32 s62,s63
s_cselect_b64 vcc,vcc,0
s_cmp_eq_u32 s34,0
s_cselect_b64 vcc,vcc,0
s_and_b32 s29,vcc_lo,1
ds_read_b128 v[76:79],v6 offset:7168
s_waitcnt lgkmcnt(6)
v_mfma_f32_32x32x16_bf16 v[16:31],a[0:3],v[48:51],0
s_cbranch_vccnz ns_o_334
ns_o_334r:
ds_read_b128 v[48:51],v6 offset:8192
v_mfma_f32_32x32x16_bf16 v[16:31],a[4:7],v[52:55],v[16:31]
ds_read_b128 v[52:55],v6 offset:9216
s_waitcnt lgkmcnt(6)
v_mfma_f32_32x32x16_bf16 v[16:31],a[8:11],v[56:59],v[16:31]
s_cbranch_vccnz ns_o_335
ns_o_335r:
ds_read_b128 v[56:59],v6 offset:10240
v_mfma_f32_32x32x16_bf16 v[16:31],a[12:15],v[60:63],v[16:31]
ds_read_b128 v[60:63],v6 offset:11264
s_waitcnt lgkmcnt(6)
v_mfma_f32_32x32x16_bf16 v[16:31],a[16:19],v[64:67],v[16:31]
s_cbranch_vccnz ns_o_336
ns_o_336r:
s_cmp_eq_u32 s34,0
s_cbranch_scc1 ns_s_337
s_waitcnt vmcnt(5)
ns_s_337:
s_barrier
ds_read_b128 v[64:67],v6 offset:12288
v_mfma_f32_32x32x16_bf16 v[16:31],a[20:23],v[68:71],v[16:31]
v_add_u32 v5,s35,v7
ds_read_b64 v[80:81],v5 offset:40960
ds_read_b64 v[82:83],v5 offset:41216
ds_read_b128 v[68:71],v6 offset:13312
s_waitcnt lgkmcnt(8)
v_mfma_f32_32x32x16_bf16 v[16:31],a[24:27],v[72:75],v[16:31]
s_cbranch_vccnz ns_o_338
ns_o_338r:
ds_read_b64 v[84:85],v5 offset:41472
ds_read_b64 v[86:87],v5 offset:41728
ds_read_b128 v[72:75],v6 offset:14336
v_mfma_f32_32x32x16_bf16 v[16:31],a[28:31],v[76:79],v[16:31]
ds_read_b64 v[88:89],v5 offset:41984
ds_read_b64 v[90:91],v5 offset:42240
ds_read_b64 v[92:93],v5 offset:42496
ds_read_b128 v[76:79],v6 offset:15360
s_waitcnt lgkmcnt(13)
v_mfma_f32_32x32x16_bf16 v[16:31],a[32:35],v[48:51],v[16:31]
s_cbranch_vccnz ns_o_339
ns_o_339r:
ds_read_b64 v[94:95],v5 offset:42752
ds_read_b64 v[96:97],v5 offset:43008
ds_read_b128 v[48:51],v6 offset:16384
v_mfma_f32_32x32x16_bf16 v[16:31],a[36:39],v[52:55],v[16:31]
ds_read_b64 v[98:99],v5 offset:43264
ds_read_b128 v[52:55],v6 offset:17408
s_waitcnt lgkmcnt(15)
v_mfma_f32_32x32x16_bf16 v[16:31],a[40:43],v[56:59],v[16:31]
s_cbranch_vccnz ns_o_340
ns_o_340r:
ds_read_b128 v[56:59],v6 offset:18432
v_mfma_f32_32x32x16_bf16 v[16:31],a[44:47],v[60:63],v[16:31]
ds_read_b128 v[60:63],v6 offset:19456
s_waitcnt lgkmcnt(14)
v_mfma_f32_32x32x16_bf16 v[16:31],a[48:51],v[64:67],v[16:31]
s_cbranch_vccnz ns_o_341
ns_o_341r:
s_waitcnt lgkmcnt(3)
v_add_f32 v80,v80,v90
ds_read_b128 v[64:67],v6 offset:20480
v_mfma_f32_32x32x16_bf16 v[16:31],a[52:55],v[68:71],v[16:31]
v_add_f32 v81,v81,v91
v_add_f32 v82,v82,v92
v_add_f32 v83,v83,v93
ds_read_b128 v[68:71],v6 offset:21504
v_mfma_f32_32x32x16_bf16 v[16:31],a[56:59],v[72:75],v[16:31]
s_cbranch_vccnz ns_o_342
ns_o_342r:
v_add_f32 v84,v84,v94
v_add_f32 v85,v85,v95
ds_read_b128 v[72:75],v6 offset:22528
v_mfma_f32_32x32x16_bf16 v[16:31],a[60:63],v[76:79],v[16:31]
v_add_f32 v86,v86,v96
v_add_f32 v87,v87,v97
v_add_f32 v88,v88,v98
ds_read_b128 v[76:79],v6 offset:23552
s_waitcnt lgkmcnt(6)
v_mfma_f32_32x32x16_bf16 v[16:31],a[64:67],v[48:51],v[16:31]
s_cbranch_vccnz ns_o_343
ns_o_343r:
v_add_f32 v89,v89,v99
v_add_f32 v80,v80,v84
ds_read_b128 v[48:51],v6 offset:24576
v_mfma_f32_32x32x16_bf16 v[16:31],a[68:71],v[52:55],v[16:31]
v_add_f32 v81,v81,v85
v_add_f32 v82,v82,v86
v_add_f32 v83,v83,v87
ds_read_b128 v[52:55],v6 offset:25600
s_waitcnt lgkmcnt(6)
v_mfma_f32_32x32x16_bf16 v[16:31],a[72:75],v[56:59],v[16:31]
s_cbranch_vccnz ns_o_344
ns_o_344r:
v_add_f32 v88,v88,v80
v_add_f32 v89,v89,v81
ds_read_b128 v[56:59],v6 offset:26624
v_mfma_f32_32x32x16_bf16 v[16:31],a[76:79],v[60:63],v[16:31]
v_add_f32 v12,v88,v82
v_add_f32 v13,v89,v83
v_mov_b32 v80,v12
ds_read_b128 v[60:63],v6 offset:27648
s_waitcnt lgkmcnt(6)
v_mfma_f32_32x32x16_bf16 v[16:31],a[80:83],v[64:67],v[16:31]
s_cbranch_vccnz ns_o_345
ns_o_345r:
v_mov_b32 v81,v13
s_cmp_eq_u32 s34,0
s_cbranch_scc1 ns_s_346
s_waitcnt vmcnt(0)
ns_s_346:
s_barrier
s_waitcnt vmcnt(11)
s_cbranch_vccnz ns_rw_347
s_waitcnt vmcnt(0)
ns_rw_347:
ds_read_b128 v[64:67],v6 offset:28672
v_mfma_f32_32x32x16_bf16 v[16:31],a[84:87],v[68:71],v[16:31]
v_permlane32_swap_b32 v12,v80
v_permlane32_swap_b32 v13,v81
ds_read_b128 v[68:71],v6 offset:29696
s_waitcnt lgkmcnt(6)
v_mfma_f32_32x32x16_bf16 v[16:31],a[88:91],v[72:75],v[16:31]
s_cbranch_vccnz ns_o_348
ns_o_348r:
v_add_f32 v12,v12,v80
v_add_f32 v13,v13,v81
ds_read_b128 v[72:75],v6 offset:30720
v_mfma_f32_32x32x16_bf16 v[16:31],a[92:95],v[76:79],v[16:31]
v_mul_f32 v12,s48,v12
v_mul_f32 v13,s48,v13
v_fma_f32 v13,-v12,v12,v13
buffer_load_dword v4,v3,s[4:7],0 offen sc1
ds_read_b128 v[76:79],v6 offset:31744
s_waitcnt lgkmcnt(6)
v_mfma_f32_32x32x16_bf16 v[16:31],a[96:99],v[48:51],v[16:31]
v_max_f32 v13,0,v13
v_add_f32 v80,s49,v13
v_rsq_f32 v10,v80
ds_read_b128 v[48:51],v6 offset:32768
v_mfma_f32_32x32x16_bf16 v[16:31],a[100:103],v[52:55],v[16:31]
ds_read_b128 v[52:55],v6 offset:33792
s_waitcnt lgkmcnt(6)
v_mfma_f32_32x32x16_bf16 v[16:31],a[104:107],v[56:59],v[16:31]
v_mul_f32 v11,v12,v10
v_mov_b32 v148,v10
v_mov_b32 v149,v10
ds_read_b128 v[56:59],v6 offset:34816
v_mfma_f32_32x32x16_bf16 v[16:31],a[108:111],v[60:63],v[16:31]
v_lshlrev_b32 v80,16,v112
v_and_b32 v81,0xffff0000,v112
v_lshlrev_b32 v82,16,v113
ds_read_b128 v[60:63],v6 offset:35840
s_waitcnt lgkmcnt(6)
v_mfma_f32_32x32x16_bf16 v[16:31],a[112:115],v[64:67],v[16:31]
v_and_b32 v83,0xffff0000,v113
v_lshlrev_b32 v84,16,v114
v_and_b32 v85,0xffff0000,v114
ds_read_b128 v[64:67],v6 offset:36864
v_mfma_f32_32x32x16_bf16 v[16:31],a[116:119],v[68:71],v[16:31]
v_lshlrev_b32 v86,16,v115
v_and_b32 v87,0xffff0000,v115
v_lshlrev_b32 v88,16,v116
ds_read_b128 v[68:71],v6 offset:37888
s_waitcnt lgkmcnt(6)
v_mfma_f32_32x32x16_bf16 v[16:31],a[120:123],v[72:75],v[16:31]
v_and_b32 v89,0xffff0000,v116
v_lshlrev_b32 v90,16,v117
v_and_b32 v91,0xffff0000,v117
ds_read_b128 v[72:75],v6 offset:38912
v_mfma_f32_32x32x16_bf16 v[16:31],a[124:127],v[76:79],v[16:31]
v_lshlrev_b32 v92,16,v118
v_and_b32 v93,0xffff0000,v118
v_lshlrev_b32 v94,16,v119
ds_read_b128 v[76:79],v6 offset:39936
s_waitcnt lgkmcnt(6)
v_mfma_f32_32x32x16_bf16 v[16:31],a[128:131],v[48:51],v[16:31]
v_and_b32 v95,0xffff0000,v119
v_fma_f32 v80,v80,v10,-v11
v_fma_f32 v81,v81,v10,-v11
v_mfma_f32_32x32x16_bf16 v[16:31],a[132:135],v[52:55],v[16:31]
v_fma_f32 v82,v82,v10,-v11
v_fma_f32 v83,v83,v10,-v11
v_fma_f32 v84,v84,v10,-v11
s_waitcnt lgkmcnt(4)
v_mfma_f32_32x32x16_bf16 v[16:31],a[136:139],v[56:59],v[16:31]
v_fma_f32 v85,v85,v10,-v11
v_fma_f32 v86,v86,v10,-v11
v_fma_f32 v87,v87,v10,-v11
v_mfma_f32_32x32x16_bf16 v[16:31],a[140:143],v[60:63],v[16:31]
v_fma_f32 v88,v88,v10,-v11
v_fma_f32 v89,v89,v10,-v11
v_fma_f32 v90,v90,v10,-v11
s_waitcnt lgkmcnt(2)
v_mfma_f32_32x32x16_bf16 v[16:31],a[144:147],v[64:67],v[16:31]
v_fma_f32 v91,v91,v10,-v11
v_fma_f32 v92,v92,v10,-v11
v_fma_f32 v93,v93,v10,-v11
v_mfma_f32_32x32x16_bf16 v[16:31],a[148:151],v[68:71],v[16:31]
v_fma_f32 v94,v94,v10,-v11
v_fma_f32 v95,v95,v10,-v11
s_waitcnt lgkmcnt(0)
v_mfma_f32_32x32x16_bf16 v[16:31],a[152:155],v[72:75],v[16:31]
v_mfma_f32_32x32x16_bf16 v[16:31],a[156:159],v[76:79],v[16:31]
s_nop 10
s_cbranch_vccnz ns_npf_349
s_waitcnt vmcnt(0)
v_add_u32 v157,v156,v4
v_cmp_le_u32 vcc,s31,v157
s_nop 0
s_cmp_eq_u64 vcc,-1
s_cselect_b64 vcc,-1,0
s_cmp_lt_u32 s62,s63
s_cselect_b64 vcc,vcc,0
s_cbranch_vccz ns_npf_349
s_add_u32 s46,s44,0
s_mov_b32 m0,s46
s_add_u32 s46,s32,0
buffer_load_dwordx4 v158,s[4:7],s46 offen sc1 lds
s_add_u32 s46,s44,4096
s_mov_b32 m0,s46
s_add_u32 s46,s32,4096
buffer_load_dwordx4 v158,s[4:7],s46 offen sc1 lds
s_add_u32 s46,s44,8192
s_mov_b32 m0,s46
s_add_u32 s46,s32,8192
buffer_load_dwordx4 v162,s[4:7],s46 offen sc1 lds
s_add_u32 s46,s44,40960
s_mov_b32 m0,s46
s_add_u32 s46,s33,40960
buffer_load_dwordx4 v1,s[4:7],s46 offen sc1 lds
s_add_u32 s46,s44,45056
s_mov_b32 m0,s46
s_add_u32 s46,s33,45056
buffer_load_dwordx4 v1,s[4:7],s46 offen sc1 lds
s_add_u32 s46,s44,12288
s_mov_b32 m0,s46
s_add_u32 s46,s32,12288
buffer_load_dwordx4 v159,s[4:7],s46 offen sc1 lds
s_add_u32 s46,s44,16384
s_mov_b32 m0,s46
s_add_u32 s46,s32,16384
buffer_load_dwordx4 v159,s[4:7],s46 offen sc1 lds
s_add_u32 s46,s44,20480
s_mov_b32 m0,s46
s_add_u32 s46,s32,20480
buffer_load_dwordx4 v160,s[4:7],s46 offen sc1 lds
s_add_u32 s46,s44,24576
s_mov_b32 m0,s46
s_add_u32 s46,s32,24576
buffer_load_dwordx4 v160,s[4:7],s46 offen sc1 lds
s_add_u32 s46,s44,28672
s_mov_b32 m0,s46
s_add_u32 s46,s32,28672
buffer_load_dwordx4 v163,s[4:7],s46 offen sc1 lds
s_add_u32 s46,s44,32768
s_mov_b32 m0,s46
s_add_u32 s46,s32,32768
buffer_load_dwordx4 v161,s[4:7],s46 offen sc1 lds
s_add_u32 s46,s44,36864
s_mov_b32 m0,s46
s_add_u32 s46,s32,36864
buffer_load_dwordx4 v161,s[4:7],s46 offen sc1 lds
ns_npf_349:
v_pk_add_f32 v[16:17],v[16:17],v[80:81]
v_pk_add_f32 v[18:19],v[18:19],v[82:83]
v_pk_add_f32 v[20:21],v[20:21],v[84:85]
v_pk_add_f32 v[22:23],v[22:23],v[86:87]
v_cvt_pk_bf16_f32 v128,v16,v17
v_cvt_pk_bf16_f32 v129,v18,v19
v_cvt_pk_bf16_f32 v130,v20,v21
v_cvt_pk_bf16_f32 v131,v22,v23
s_cmp_eq_u32 s21,0
s_cbranch_scc1 ls_350
buffer_store_dwordx4 v[128:131],v1,s[24:27],s36 offen
ls_351:
v_pk_add_f32 v[24:25],v[24:25],v[88:89]
v_pk_add_f32 v[26:27],v[26:27],v[90:91]
v_pk_add_f32 v[28:29],v[28:29],v[92:93]
v_pk_add_f32 v[30:31],v[30:31],v[94:95]
v_cvt_pk_bf16_f32 v132,v24,v25
v_cvt_pk_bf16_f32 v133,v26,v27
v_cvt_pk_bf16_f32 v134,v28,v29
v_cvt_pk_bf16_f32 v135,v30,v31
s_cmp_eq_u32 s21,0
s_cbranch_scc1 ls_352
buffer_store_dwordx4 v[132:135],v1,s[24:27],s36 offen offset:1024
ls_353:
v_pk_add_f32 v[82:83],v[16:17],v[24:25]
v_pk_add_f32 v[84:85],v[18:19],v[26:27]
v_pk_add_f32 v[86:87],v[20:21],v[28:29]
v_pk_add_f32 v[88:89],v[22:23],v[30:31]
v_pk_add_f32 v[82:83],v[82:83],v[84:85]
v_pk_add_f32 v[86:87],v[86:87],v[88:89]
v_pk_mul_f32 v[84:85],v[16:17],v[16:17]
v_pk_mul_f32 v[88:89],v[18:19],v[18:19]
v_pk_add_f32 v[82:83],v[82:83],v[86:87]
v_pk_fma_f32 v[84:85],v[20:21],v[20:21],v[84:85]
v_pk_fma_f32 v[88:89],v[22:23],v[22:23],v[88:89]
v_pk_fma_f32 v[84:85],v[24:25],v[24:25],v[84:85]
v_pk_fma_f32 v[88:89],v[26:27],v[26:27],v[88:89]
v_pk_fma_f32 v[84:85],v[28:29],v[28:29],v[84:85]
v_pk_fma_f32 v[88:89],v[30:31],v[30:31],v[88:89]
v_add_f32 v80,v82,v83
v_pk_add_f32 v[84:85],v[84:85],v[88:89]
v_mov_b32 v82,v80
v_add_f32 v81,v84,v85
v_mov_b32 v83,v81
v_permlane32_swap_b32 v80,v82
s_nop 0
v_permlane32_swap_b32 v81,v83
s_nop 0
v_pk_add_f32 v[80:81],v[80:81],v[82:83]
s_mul_i32 s42,s41,1792
s_sub_u32 s42,s36,s42
s_add_u32 s42,s42,40960
s_cmp_eq_u32 s21,0
s_cbranch_scc1 ls_354
buffer_store_dwordx2 v[80:81],v9,s[24:27],s42 offen
ls_355:
s_add_u32 s64,s28,1
s_mov_b32 s28,s62
s_mov_b32 s69,s36
s_xor_b32 s35,s35,49152
s_mov_b32 s30,1
s_mov_b32 s34,0
s_cbranch_vccz ns_blk_356
s_waitcnt vmcnt(0)
v_mov_b32 v2,s64
s_mov_b64 exec,1
s_cmp_eq_u32 s21,0
s_cbranch_scc1 ls_357
buffer_store_dword v2,off,s[24:27],s37
ls_358:
s_mov_b64 exec,-1
s_mov_b32 s30,0
s_branch ns_top_325
ns_blk_356:
s_mov_b32 s34,1
buffer_load_dword v4,v3,s[4:7],0 offen sc1
s_waitcnt vmcnt(1)
v_mov_b32 v2,s64
s_mov_b64 exec,1
s_cmp_eq_u32 s21,0
s_cbranch_scc1 ls_359
buffer_store_dword v2,off,s[24:27],s37
ls_360:
s_mov_b64 exec,-1
s_mov_b32 s30,0
s_cmp_ge_u32 s28,s63
s_cbranch_scc1 ns_fin_326
s_waitcnt vmcnt(1)
v_add_u32 v157,v156,v4
v_cmp_le_u32 vcc,s31,v157
s_nop 0
s_cmp_eq_u64 vcc,-1
s_nop 1
s_cbranch_scc1 ns_rdy_361
s_mov_b32 s38,0
poll_362:
buffer_load_dword v4,v3,s[4:7],0 offen sc1
s_waitcnt vmcnt(0)
v_add_u32 v157,v156,v4
v_cmp_le_u32 vcc,s31,v157
s_nop 0
s_cmp_eq_u64 vcc,-1
s_nop 1
s_cbranch_scc1 polld_363
s_sleep 2
s_add_u32 s38,s38,1
s_cmp_lt_u32 s38,100000
s_cbranch_scc1 poll_362
s_mov_b32 s40,4
s_branch L_fail
polld_363:
ns_rdy_361:
s_add_u32 s46,s44,0
s_mov_b32 m0,s46
s_add_u32 s46,s32,0
buffer_load_dwordx4 v158,s[4:7],s46 offen sc1 lds
s_add_u32 s46,s44,4096
s_mov_b32 m0,s46
s_add_u32 s46,s32,4096
buffer_load_dwordx4 v158,s[4:7],s46 offen sc1 lds
s_add_u32 s46,s44,8192
s_mov_b32 m0,s46
s_add_u32 s46,s32,8192
buffer_load_dwordx4 v162,s[4:7],s46 offen sc1 lds
s_add_u32 s46,s44,40960
s_mov_b32 m0,s46
s_add_u32 s46,s33,40960
buffer_load_dwordx4 v1,s[4:7],s46 offen sc1 lds
s_add_u32 s46,s44,45056
s_mov_b32 m0,s46
s_add_u32 s46,s33,45056
buffer_load_dwordx4 v1,s[4:7],s46 offen sc1 lds
s_add_u32 s46,s44,12288
s_mov_b32 m0,s46
s_add_u32 s46,s32,12288
buffer_load_dwordx4 v159,s[4:7],s46 offen sc1 lds
s_add_u32 s46,s44,16384
s_mov_b32 m0,s46
s_add_u32 s46,s32,16384
buffer_load_dwordx4 v159,s[4:7],s46 offen sc1 lds
s_add_u32 s46,s44,20480
s_mov_b32 m0,s46
s_add_u32 s46,s32,20480
buffer_load_dwordx4 v160,s[4:7],s46 offen sc1 lds
s_add_u32 s46,s44,24576
s_mov_b32 m0,s46
s_add_u32 s46,s32,24576
buffer_load_dwordx4 v160,s[4:7],s46 offen sc1 lds
s_add_u32 s46,s44,28672
s_mov_b32 m0,s46
s_add_u32 s46,s32,28672
buffer_load_dwordx4 v163,s[4:7],s46 offen sc1 lds
s_add_u32 s46,s44,32768
s_mov_b32 m0,s46
s_add_u32 s46,s32,32768
buffer_load_dwordx4 v161,s[4:7],s46 offen sc1 lds
s_add_u32 s46,s44,36864
s_mov_b32 m0,s46
s_add_u32 s46,s32,36864
buffer_load_dwordx4 v161,s[4:7],s46 offen sc1 lds
s_branch ns_top_325
ns_o_334:
s_add_u32 s46,s44,0
s_mov_b32 m0,s46
s_add_u32 s46,s32,0
buffer_load_dwordx4 v158,s[4:7],s46 offen sc1 lds
s_branch ns_o_334r
ns_o_335:
s_add_u32 s46,s44,4096
s_mov_b32 m0,s46
s_add_u32 s46,s32,4096
buffer_load_dwordx4 v158,s[4:7],s46 offen sc1 lds
s_branch ns_o_335r
ns_o_336:
s_add_u32 s46,s44,8192
s_mov_b32 m0,s46
s_add_u32 s46,s32,8192
buffer_load_dwordx4 v162,s[4:7],s46 offen sc1 lds
s_branch ns_o_336r
ns_o_338:
s_add_u32 s46,s44,40960
s_mov_b32 m0,s46
s_add_u32 s46,s33,40960
buffer_load_dwordx4 v1,s[4:7],s46 offen sc1 lds
s_branch ns_o_338r
ns_o_339:
s_add_u32 s46,s44,45056
s_mov_b32 m0,s46
s_add_u32 s46,s33,45056
buffer_load_dwordx4 v1,s[4:7],s46 offen sc1 lds
s_branch ns_o_339r
ns_o_340:
s_add_u32 s46,s44,12288
s_mov_b32 m0,s46
s_add_u32 s46,s32,12288
buffer_load_dwordx4 v159,s[4:7],s46 offen sc1 lds
s_branch ns_o_340r
ns_o_341:
s_add_u32 s46,s44,16384
s_mov_b32 m0,s46
s_add_u32 s46,s32,16384
buffer_load_dwordx4 v159,s[4:7],s46 offen sc1 lds
s_branch ns_o_341r
ns_o_342:
s_add_u32 s46,s44,20480
s_mov_b32 m0,s46
s_add_u32 s46,s32,20480
buffer_load_dwordx4 v160,s[4:7],s46 offen sc1 lds
s_branch ns_o_342r
ns_o_343:
s_add_u32 s46,s44,24576
s_mov_b32 m0,s46
s_add_u32 s46,s32,24576
buffer_load_dwordx4 v160,s[4:7],s46 offen sc1 lds
s_branch ns_o_343r
ns_o_344:
s_add_u32 s46,s44,28672
s_mov_b32 m0,s46
s_add_u32 s46,s32,28672
buffer_load_dwordx4 v163,s[4:7],s46 offen sc1 lds
s_branch ns_o_344r
ns_o_345:
s_add_u32 s46,s44,32768
s_mov_b32 m0,s46
s_add_u32 s46,s32,32768
buffer_load_dwordx4 v161,s[4:7],s46 offen sc1 lds
s_branch ns_o_345r
ns_o_348:
s_add_u32 s46,s44,36864
s_mov_b32 m0,s46
s_add_u32 s46,s32,36864
buffer_load_dwordx4 v161,s[4:7],s46 offen sc1 lds
s_branch ns_o_348r
ns_fin_326:
s_branch L_end
ls_350:
buffer_store_dwordx4 v[128:131],v1,s[24:27],s36 offen sc1
s_nop 1
s_branch ls_351
ls_352:
buffer_store_dwordx4 v[132:135],v1,s[24:27],s36 offen offset:1024 sc1
s_nop 1
s_branch ls_353
ls_354:
buffer_store_dwordx2 v[80:81],v9,s[24:27],s42 offen sc1
s_nop 1
s_branch ls_355
ls_357:
buffer_store_dword v2,off,s[24:27],s37 sc1
s_nop 1
s_branch ls_358
ls_359:
buffer_store_dword v2,off,s[24:27],s37 sc1
s_nop 1
s_branch ls_360
R_w3:
s_add_u32 s42,s42,s43
s_lshl_b32 s41,s42,2
s_add_u32 s41,s41,s3
s_mov_b32 s24,s4
s_mov_b32 s25,s5
s_mov_b32 s27,0x20000
s_cmp_lt_u32 s41,54
s_cselect_b32 s26,s6,0
s_min_u32 s41,s41,53
v_lshlrev_b32 v1,4,v0
s_load_dwordx2 s[20:21],s[0:1],80
s_waitcnt lgkmcnt(0)
s_mov_b32 s16,s20
s_and_b32 s17,s21,0xffff
s_mov_b32 s18,0x21c000
s_mov_b32 s19,0x20000
s_lshl_b32 s42,s41,6
v_lshrrev_b32 v82,2,v0
v_mul_u32_u24 v80,3456,v82
v_and_b32 v82,3,v0
v_lshl_add_u32 v80,v82,4,v80
v_lshlrev_b32 v81,3,v82
v_bfe_u32 v82,v0,4,1
v_lshl_add_u32 v81,v82,5,v81
v_bfe_u32 v82,v0,2,2
v_lshl_add_u32 v81,v82,6,v81
v_lshrrev_b32 v82,5,v0
v_lshl_add_u32 v81,v82,8,v81
s_mul_i32 s22,s3,40960
v_add_u32 v81,s22,v81
s_add_u32 s23,s22,0
s_mov_b32 m0,s23
s_add_u32 s23,s42,0
buffer_load_dwordx4 v80,s[16:19],s23 offen lds
s_add_u32 s23,s22,1024
s_mov_b32 m0,s23
s_add_u32 s23,s42,55296
buffer_load_dwordx4 v80,s[16:19],s23 offen lds
s_add_u32 s23,s22,2048
s_mov_b32 m0,s23
s_add_u32 s23,s42,110592
buffer_load_dwordx4 v80,s[16:19],s23 offen lds
s_add_u32 s23,s22,3072
s_mov_b32 m0,s23
s_add_u32 s23,s42,165888
buffer_load_dwordx4 v80,s[16:19],s23 offen lds
s_add_u32 s23,s22,4096
s_mov_b32 m0,s23
s_add_u32 s23,s42,221184
buffer_load_dwordx4 v80,s[16:19],s23 offen lds
s_add_u32 s23,s22,5120
s_mov_b32 m0,s23
s_add_u32 s23,s42,276480
buffer_load_dwordx4 v80,s[16:19],s23 offen lds
s_add_u32 s23,s22,6144
s_mov_b32 m0,s23
s_add_u32 s23,s42,331776
buffer_load_dwordx4 v80,s[16:19],s23 offen lds
s_add_u32 s23,s22,7168
s_mov_b32 m0,s23
s_add_u32 s23,s42,387072
buffer_load_dwordx4 v80,s[16:19],s23 offen lds
s_add_u32 s23,s22,8192
s_mov_b32 m0,s23
s_add_u32 s23,s42,442368
buffer_load_dwordx4 v80,s[16:19],s23 offen lds
s_add_u32 s23,s22,9216
s_mov_b32 m0,s23
s_add_u32 s23,s42,497664
buffer_load_dwordx4 v80,s[16:19],s23 offen lds
s_add_u32 s23,s22,10240
s_mov_b32 m0,s23
s_add_u32 s23,s42,552960
buffer_load_dwordx4 v80,s[16:19],s23 offen lds
s_add_u32 s23,s22,11264
s_mov_b32 m0,s23
s_add_u32 s23,s42,608256
buffer_load_dwordx4 v80,s[16:19],s23 offen lds
s_add_u32 s23,s22,12288
s_mov_b32 m0,s23
s_add_u32 s23,s42,663552
buffer_load_dwordx4 v80,s[16:19],s23 offen lds
s_add_u32 s23,s22,13312
s_mov_b32 m0,s23
s_add_u32 s23,s42,718848
buffer_load_dwordx4 v80,s[16:19],s23 offen lds
s_add_u32 s23,s22,14336
s_mov_b32 m0,s23
s_add_u32 s23,s42,774144
buffer_load_dwordx4 v80,s[16:19],s23 offen lds
s_add_u32 s23,s22,15360
s_mov_b32 m0,s23
s_add_u32 s23,s42,829440
buffer_load_dwordx4 v80,s[16:19],s23 offen lds
s_add_u32 s23,s22,16384
s_mov_b32 m0,s23
s_add_u32 s23,s42,884736
buffer_load_dwordx4 v80,s[16:19],s23 offen lds
s_add_u32 s23,s22,17408
s_mov_b32 m0,s23
s_add_u32 s23,s42,940032
buffer_load_dwordx4 v80,s[16:19],s23 offen lds
s_add_u32 s23,s22,18432
s_mov_b32 m0,s23
s_add_u32 s23,s42,995328
buffer_load_dwordx4 v80,s[16:19],s23 offen lds
s_add_u32 s23,s22,19456
s_mov_b32 m0,s23
s_add_u32 s23,s42,1050624
buffer_load_dwordx4 v80,s[16:19],s23 offen lds
s_add_u32 s23,s22,20480
s_mov_b32 m0,s23
s_add_u32 s23,s42,1105920
buffer_load_dwordx4 v80,s[16:19],s23 offen lds
s_add_u32 s23,s22,21504
s_mov_b32 m0,s23
s_add_u32 s23,s42,1161216
buffer_load_dwordx4 v80,s[16:19],s23 offen lds
s_add_u32 s23,s22,22528
s_mov_b32 m0,s23
s_add_u32 s23,s42,1216512
buffer_load_dwordx4 v80,s[16:19],s23 offen lds
s_add_u32 s23,s22,23552
s_mov_b32 m0,s23
s_add_u32 s23,s42,1271808
buffer_load_dwordx4 v80,s[16:19],s23 offen lds
s_add_u32 s23,s22,24576
s_mov_b32 m0,s23
s_add_u32 s23,s42,1327104
buffer_load_dwordx4 v80,s[16:19],s23 offen lds
s_add_u32 s23,s22,25600
s_mov_b32 m0,s23
s_add_u32 s23,s42,1382400
buffer_load_dwordx4 v80,s[16:19],s23 offen lds
s_add_u32 s23,s22,26624
s_mov_b32 m0,s23
s_add_u32 s23,s42,1437696
buffer_load_dwordx4 v80,s[16:19],s23 offen lds
s_add_u32 s23,s22,27648
s_mov_b32 m0,s23
s_add_u32 s23,s42,1492992
buffer_load_dwordx4 v80,s[16:19],s23 offen lds
s_add_u32 s23,s22,28672
s_mov_b32 m0,s23
s_add_u32 s23,s42,1548288
buffer_load_dwordx4 v80,s[16:19],s23 offen lds
s_add_u32 s23,s22,29696
s_mov_b32 m0,s23
s_add_u32 s23,s42,1603584
buffer_load_dwordx4 v80,s[16:19],s23 offen lds
s_add_u32 s23,s22,30720
s_mov_b32 m0,s23
s_add_u32 s23,s42,1658880
buffer_load_dwordx4 v80,s[16:19],s23 offen lds
s_add_u32 s23,s22,31744
s_mov_b32 m0,s23
s_add_u32 s23,s42,1714176
buffer_load_dwordx4 v80,s[16:19],s23 offen lds
s_add_u32 s23,s22,32768
s_mov_b32 m0,s23
s_add_u32 s23,s42,1769472
buffer_load_dwordx4 v80,s[16:19],s23 offen lds
s_add_u32 s23,s22,33792
s_mov_b32 m0,s23
s_add_u32 s23,s42,1824768
buffer_load_dwordx4 v80,s[16:19],s23 offen lds
s_add_u32 s23,s22,34816
s_mov_b32 m0,s23
s_add_u32 s23,s42,1880064
buffer_load_dwordx4 v80,s[16:19],s23 offen lds
s_add_u32 s23,s22,35840
s_mov_b32 m0,s23
s_add_u32 s23,s42,1935360
buffer_load_dwordx4 v80,s[16:19],s23 offen lds
s_waitcnt vmcnt(35)
ds_read_b64_tr_b16 a[0:1],v81
ds_read_b64_tr_b16 a[2:3],v81 offset:512
s_waitcnt vmcnt(34)
ds_read_b64_tr_b16 a[4:5],v81 offset:1024
ds_read_b64_tr_b16 a[6:7],v81 offset:1536
s_waitcnt vmcnt(33)
ds_read_b64_tr_b16 a[8:9],v81 offset:2048
ds_read_b64_tr_b16 a[10:11],v81 offset:2560
s_waitcnt vmcnt(32)
ds_read_b64_tr_b16 a[12:13],v81 offset:3072
ds_read_b64_tr_b16 a[14:15],v81 offset:3584
s_waitcnt lgkmcnt(6)
s_add_u32 s23,s22,0
s_mov_b32 m0,s23
s_add_u32 s23,s42,1990656
buffer_load_dwordx4 v80,s[16:19],s23 offen lds
s_waitcnt vmcnt(32)
ds_read_b64_tr_b16 a[16:17],v81 offset:4096
ds_read_b64_tr_b16 a[18:19],v81 offset:4608
s_waitcnt lgkmcnt(6)
s_add_u32 s23,s22,1024
s_mov_b32 m0,s23
s_add_u32 s23,s42,2045952
buffer_load_dwordx4 v80,s[16:19],s23 offen lds
s_waitcnt vmcnt(32)
ds_read_b64_tr_b16 a[20:21],v81 offset:5120
ds_read_b64_tr_b16 a[22:23],v81 offset:5632
s_waitcnt lgkmcnt(6)
s_add_u32 s23,s22,2048
s_mov_b32 m0,s23
s_add_u32 s23,s42,2101248
buffer_load_dwordx4 v80,s[16:19],s23 offen lds
s_waitcnt vmcnt(32)
ds_read_b64_tr_b16 a[24:25],v81 offset:6144
ds_read_b64_tr_b16 a[26:27],v81 offset:6656
s_waitcnt lgkmcnt(6)
s_add_u32 s23,s22,3072
s_mov_b32 m0,s23
s_add_u32 s23,s42,2156544
buffer_load_dwordx4 v80,s[16:19],s23 offen lds
s_waitcnt vmcnt(32)
ds_read_b64_tr_b16 a[28:29],v81 offset:7168
ds_read_b64_tr_b16 a[30:31],v81 offset:7680
s_waitcnt vmcnt(31)
ds_read_b64_tr_b16 a[32:33],v81 offset:8192
ds_read_b64_tr_b16 a[34:35],v81 offset:8704
s_waitcnt vmcnt(30)
ds_read_b64_tr_b16 a[36:37],v81 offset:9216
ds_read_b64_tr_b16 a[38:39],v81 offset:9728
s_waitcnt vmcnt(29)
ds_read_b64_tr_b16 a[40:41],v81 offset:10240
ds_read_b64_tr_b16 a[42:43],v81 offset:10752
s_waitcnt vmcnt(28)
ds_read_b64_tr_b16 a[44:45],v81 offset:11264
ds_read_b64_tr_b16 a[46:47],v81 offset:11776
s_waitcnt vmcnt(27)
ds_read_b64_tr_b16 a[48:49],v81 offset:12288
ds_read_b64_tr_b16 a[50:51],v81 offset:12800
s_waitcnt vmcnt(26)
ds_read_b64_tr_b16 a[52:53],v81 offset:13312
ds_read_b64_tr_b16 a[54:55],v81 offset:13824
s_waitcnt vmcnt(25)
ds_read_b64_tr_b16 a[56:57],v81 offset:14336
ds_read_b64_tr_b16 a[58:59],v81 offset:14848
s_waitcnt vmcnt(24)
ds_read_b64_tr_b16 a[60:61],v81 offset:15360
ds_read_b64_tr_b16 a[62:63],v81 offset:15872
s_waitcnt vmcnt(23)
ds_read_b64_tr_b16 a[64:65],v81 offset:16384
ds_read_b64_tr_b16 a[66:67],v81 offset:16896
s_waitcnt vmcnt(22)
ds_read_b64_tr_b16 a[68:69],v81 offset:17408
ds_read_b64_tr_b16 a[70:71],v81 offset:17920
s_waitcnt vmcnt(21)
ds_read_b64_tr_b16 a[72:73],v81 offset:18432
ds_read_b64_tr_b16 a[74:75],v81 offset:18944
s_waitcnt vmcnt(20)
ds_read_b64_tr_b16 a[76:77],v81 offset:19456
ds_read_b64_tr_b16 a[78:79],v81 offset:19968
s_waitcnt vmcnt(19)
ds_read_b64_tr_b16 a[80:81],v81 offset:20480
ds_read_b64_tr_b16 a[82:83],v81 offset:20992
s_waitcnt vmcnt(18)
ds_read_b64_tr_b16 a[84:85],v81 offset:21504
ds_read_b64_tr_b16 a[86:87],v81 offset:22016
s_waitcnt vmcnt(17)
ds_read_b64_tr_b16 a[88:89],v81 offset:22528
ds_read_b64_tr_b16 a[90:91],v81 offset:23040
s_waitcnt vmcnt(16)
ds_read_b64_tr_b16 a[92:93],v81 offset:23552
ds_read_b64_tr_b16 a[94:95],v81 offset:24064
s_waitcnt vmcnt(15)
ds_read_b64_tr_b16 a[96:97],v81 offset:24576
ds_read_b64_tr_b16 a[98:99],v81 offset:25088
s_waitcnt vmcnt(14)
ds_read_b64_tr_b16 a[100:101],v81 offset:25600
ds_read_b64_tr_b16 a[102:103],v81 offset:26112
s_waitcnt vmcnt(13)
ds_read_b64_tr_b16 a[104:105],v81 offset:26624
ds_read_b64_tr_b16 a[106:107],v81 offset:27136
s_waitcnt vmcnt(12)
ds_read_b64_tr_b16 a[108:109],v81 offset:27648
ds_read_b64_tr_b16 a[110:111],v81 offset:28160
s_waitcnt vmcnt(11)
ds_read_b64_tr_b16 a[112:113],v81 offset:28672
ds_read_b64_tr_b16 a[114:115],v81 offset:29184
s_waitcnt vmcnt(10)
ds_read_b64_tr_b16 a[116:117],v81 offset:29696
ds_read_b64_tr_b16 a[118:119],v81 offset:30208
s_waitcnt vmcnt(9)
ds_read_b64_tr_b16 a[120:121],v81 offset:30720
ds_read_b64_tr_b16 a[122:123],v81 offset:31232
s_waitcnt vmcnt(8)
ds_read_b64_tr_b16 a[124:125],v81 offset:31744
ds_read_b64_tr_b16 a[126:127],v81 offset:32256
s_waitcnt vmcnt(7)
ds_read_b64_tr_b16 a[128:129],v81 offset:32768
ds_read_b64_tr_b16 a[130:131],v81 offset:33280
s_waitcnt vmcnt(6)
ds_read_b64_tr_b16 a[132:133],v81 offset:33792
ds_read_b64_tr_b16 a[134:135],v81 offset:34304
s_waitcnt vmcnt(5)
ds_read_b64_tr_b16 a[136:137],v81 offset:34816
ds_read_b64_tr_b16 a[138:139],v81 offset:35328
s_waitcnt vmcnt(4)
ds_read_b64_tr_b16 a[140:141],v81 offset:35840
ds_read_b64_tr_b16 a[142:143],v81 offset:36352
s_waitcnt vmcnt(3)
ds_read_b64_tr_b16 a[144:145],v81
ds_read_b64_tr_b16 a[146:147],v81 offset:512
s_waitcnt vmcnt(2)
ds_read_b64_tr_b16 a[148:149],v81 offset:1024
ds_read_b64_tr_b16 a[150:151],v81 offset:1536
s_waitcnt vmcnt(1)
ds_read_b64_tr_b16 a[152:153],v81 offset:2048
ds_read_b64_tr_b16 a[154:155],v81 offset:2560
s_waitcnt vmcnt(0)
ds_read_b64_tr_b16 a[156:157],v81 offset:3072
ds_read_b64_tr_b16 a[158:159],v81 offset:3584
s_waitcnt lgkmcnt(0)
s_barrier
s_lshr_b32 s20,s2,5
v_and_b32 v81,7,v0
v_min_u32 v80,1,v81
v_lshl_add_u32 v81,v80,3,v81
v_lshlrev_b32 v81,4,v81
s_mov_b32 s38,0
s_nop 0
reg_364:
buffer_load_dword v80,v81,s[12:15],0 offen sc1
s_waitcnt vmcnt(0)
v_readlane_b32 s50,v80,0
v_readlane_b32 s51,v80,1
v_readlane_b32 s52,v80,2
v_readlane_b32 s53,v80,3
v_readlane_b32 s54,v80,4
v_readlane_b32 s55,v80,5
v_readlane_b32 s56,v80,6
v_readlane_b32 s57,v80,7
v_readlane_b32 s58,v80,s20
s_nop 0
s_cmp_ge_u32 s58,32
s_nop 1
s_cbranch_scc1 regd_365
s_add_u32 s59,s50,s51
s_add_u32 s59,s59,s52
s_add_u32 s59,s59,s53
s_add_u32 s59,s59,s54
s_add_u32 s59,s59,s55
s_add_u32 s59,s59,s56
s_add_u32 s59,s59,s57
s_cmp_ge_u32 s59,256
s_cbranch_scc1 regd_365
s_sleep 2
s_add_u32 s38,s38,1
s_cmp_lt_u32 s38,100000
s_cbranch_scc1 reg_364
s_mov_b32 s40,15
s_branch L_fail
regd_365:
s_cmp_ge_u32 s58,32
s_cselect_b32 s21,1,0
v_mov_b32 v80,68
s_mov_b32 s99,128
s_mov_b32 s38,0
poll_366:
buffer_load_dword v81,v80,s[12:15],0 offen sc1
s_waitcnt vmcnt(0)
v_cmp_le_u32 vcc,s99,v81
s_nop 0
s_cmp_eq_u64 vcc,-1
s_nop 1
s_cbranch_scc1 polld_367
s_sleep 8
s_add_u32 s38,s38,1
s_cmp_lt_u32 s38,100000
s_cbranch_scc1 poll_366
s_mov_b32 s40,14
s_branch L_fail
polld_367:
v_readfirstlane_b32 s99,v81
s_nop 0
s_and_b32 s99,s99,1
s_lshl_b32 s99,s99,13
v_and_b32 v9,31,v0
v_lshrrev_b32 v5,5,v0
v_mul_u32_u24 v7,2560,v5
v_lshl_add_u32 v7,v9,3,v7
s_lshl_b32 s43,s3,10
v_mov_b32 v48,0x3f803f80
v_mov_b32 v49,0x3f803f80
v_mov_b32 v50,0x3f803f80
v_mov_b32 v51,0x3f803f80
s_nop 1
v_mfma_f32_32x32x16_bf16 v[32:47],a[0:3],v[48:51],0
v_mfma_f32_32x32x16_bf16 v[32:47],a[4:7],v[48:51],v[32:47]
v_mfma_f32_32x32x16_bf16 v[32:47],a[8:11],v[48:51],v[32:47]
v_mfma_f32_32x32x16_bf16 v[32:47],a[12:15],v[48:51],v[32:47]
v_mfma_f32_32x32x16_bf16 v[32:47],a[16:19],v[48:51],v[32:47]
v_mfma_f32_32x32x16_bf16 v[32:47],a[20:23],v[48:51],v[32:47]
v_mfma_f32_32x32x16_bf16 v[32:47],a[24:27],v[48:51],v[32:47]
v_mfma_f32_32x32x16_bf16 v[32:47],a[28:31],v[48:51],v[32:47]
v_mfma_f32_32x32x16_bf16 v[32:47],a[32:35],v[48:51],v[32:47]
v_mfma_f32_32x32x16_bf16 v[32:47],a[36:39],v[48:51],v[32:47]
v_mfma_f32_32x32x16_bf16 v[32:47],a[40:43],v[48:51],v[32:47]
v_mfma_f32_32x32x16_bf16 v[32:47],a[44:47],v[48:51],v[32:47]
v_mfma_f32_32x32x16_bf16 v[32:47],a[48:51],v[48:51],v[32:47]
v_mfma_f32_32x32x16_bf16 v[32:47],a[52:55],v[48:51],v[32:47]
v_mfma_f32_32x32x16_bf16 v[32:47],a[56:59],v[48:51],v[32:47]
v_mfma_f32_32x32x16_bf16 v[32:47],a[60:63],v[48:51],v[32:47]
v_mfma_f32_32x32x16_bf16 v[32:47],a[64:67],v[48:51],v[32:47]
v_mfma_f32_32x32x16_bf16 v[32:47],a[68:71],v[48:51],v[32:47]
v_mfma_f32_32x32x16_bf16 v[32:47],a[72:75],v[48:51],v[32:47]
v_mfma_f32_32x32x16_bf16 v[32:47],a[76:79],v[48:51],v[32:47]
v_mfma_f32_32x32x16_bf16 v[32:47],a[80:83],v[48:51],v[32:47]
v_mfma_f32_32x32x16_bf16 v[32:47],a[84:87],v[48:51],v[32:47]
v_mfma_f32_32x32x16_bf16 v[32:47],a[88:91],v[48:51],v[32:47]
v_mfma_f32_32x32x16_bf16 v[32:47],a[92:95],v[48:51],v[32:47]
v_mfma_f32_32x32x16_bf16 v[32:47],a[96:99],v[48:51],v[32:47]
v_mfma_f32_32x32x16_bf16 v[32:47],a[100:103],v[48:51],v[32:47]
v_mfma_f32_32x32x16_bf16 v[32:47],a[104:107],v[48:51],v[32:47]
v_mfma_f32_32x32x16_bf16 v[32:47],a[108:111],v[48:51],v[32:47]
v_mfma_f32_32x32x16_bf16 v[32:47],a[112:115],v[48:51],v[32:47]
v_mfma_f32_32x32x16_bf16 v[32:47],a[116:119],v[48:51],v[32:47]
v_mfma_f32_32x32x16_bf16 v[32:47],a[120:123],v[48:51],v[32:47]
v_mfma_f32_32x32x16_bf16 v[32:47],a[124:127],v[48:51],v[32:47]
v_mfma_f32_32x32x16_bf16 v[32:47],a[128:131],v[48:51],v[32:47]
v_mfma_f32_32x32x16_bf16 v[32:47],a[132:135],v[48:51],v[32:47]
v_mfma_f32_32x32x16_bf16 v[32:47],a[136:139],v[48:51],v[32:47]
v_mfma_f32_32x32x16_bf16 v[32:47],a[140:143],v[48:51],v[32:47]
v_mfma_f32_32x32x16_bf16 v[32:47],a[144:147],v[48:51],v[32:47]
v_mfma_f32_32x32x16_bf16 v[32:47],a[148:151],v[48:51],v[32:47]
v_mfma_f32_32x32x16_bf16 v[32:47],a[152:155],v[48:51],v[32:47]
v_mfma_f32_32x32x16_bf16 v[32:47],a[156:159],v[48:51],v[32:47]
v_mov_b32 v144,0xc0135761
v_mov_b32 v145,0xc0135761
v_mov_b32 v146,0xbdd2d3e8
v_mov_b32 v147,0xbdd2d3e8
s_mov_b32 s48,0x3acccccd
s_mov_b32 s49,0x3727c5ac
s_mov_b32 s35,0
s_mov_b32 s28,0
s_mov_b32 s63,64
s_lshl_b32 s42,s39,1
s_sub_u32 s63,65,s42
s_nop 0
ns_init_368:
v_min_u32 v3,19,v0
v_lshlrev_b32 v3,7,v3
s_mul_i32 s42,s39,0x48000
s_add_u32 s42,s42,0x48000
s_lshl_b32 s101,s39,13
s_xor_b32 s101,s101,s99
s_xor_b32 s101,s101,8192
s_add_u32 s42,s42,s101
v_add_u32 v3,s42,v3
s_mul_i32 s42,s39,0x48000
s_add_u32 s42,s42,0x31000
s_lshl_b32 s101,s39,13
s_xor_b32 s101,s101,s99
s_xor_b32 s101,s101,8192
s_add_u32 s42,s42,s101
v_subrev_u32 v80,32,v0
v_min_u32 v80,9,v80
v_lshlrev_b32 v80,8,v80
v_add_u32 v80,s42,v80
v_cmp_lt_u32 vcc,31,v0
s_nop 1
v_cndmask_b32 v3,v3,v80,vcc
v_cndmask_b32 v156,0,8,vcc
s_mul_i32 s37,s39,0x48000
s_add_u32 s37,s37,0x50000
s_lshl_b32 s101,s39,13
s_xor_b32 s101,s101,s99
s_xor_b32 s101,s101,8192
s_add_u32 s37,s37,s101
s_and_b32 s42,s41,63
s_lshl_b32 s42,s42,7
s_add_u32 s37,s37,s42
s_lshr_b32 s42,s41,6
s_lshl_b32 s42,s42,4
s_add_u32 s37,s37,s42
s_mul_i32 s66,s39,0x300000
s_add_u32 s66,s66,0x4730000
s_add_u32 s66,s66,s43
s_mov_b32 s67,s66
s_mul_i32 s68,s39,0x6c0000
s_add_u32 s68,s68,0x4d30000
s_lshl_b32 s42,s41,11
s_add_u32 s68,s68,s42
v_lshlrev_b32 v9,3,v9
s_mul_i32 s42,s39,0x48000
s_add_u32 s42,s42,0x38000
s_lshl_b32 s101,s39,13
s_xor_b32 s101,s101,s99
s_xor_b32 s101,s101,8192
s_add_u32 s42,s42,s101
v_mov_b32 v80,s42
s_mov_b32 s38,0
s_nop 0
poll_372:
buffer_load_dword v4,v80,s[4:7],0 offen sc1
s_waitcnt vmcnt(0)
v_cmp_le_u32 vcc,1,v4
s_nop 0
s_cmp_eq_u64 vcc,-1
s_nop 1
s_cbranch_scc1 polld_373
s_sleep 8
s_add_u32 s38,s38,1
s_cmp_lt_u32 s38,100000
s_cbranch_scc1 poll_372
s_mov_b32 s40,5
s_branch L_fail
polld_373:
s_add_u32 s46,s28,0
s_mul_i32 s46,s46,110592
s_add_u32 s46,s46,s68
buffer_load_dwordx4 v[152:155],v1,s[24:27],s46 offen sc1
buffer_load_dwordx4 v[152:155],v1,s[24:27],s46 offen offset:1024 sc1
s_add_u32 s46,s28,1
s_mul_i32 s46,s46,110592
s_add_u32 s46,s46,s68
buffer_load_dwordx4 v[152:155],v1,s[24:27],s46 offen sc1
buffer_load_dwordx4 v[152:155],v1,s[24:27],s46 offen offset:1024 sc1
s_add_u32 s46,s28,2
s_mul_i32 s46,s46,110592
s_add_u32 s46,s46,s68
buffer_load_dwordx4 v[152:155],v1,s[24:27],s46 offen sc1
buffer_load_dwordx4 v[152:155],v1,s[24:27],s46 offen offset:1024 sc1
s_add_u32 s46,s28,3
s_mul_i32 s46,s46,110592
s_add_u32 s46,s46,s68
buffer_load_dwordx4 v[152:155],v1,s[24:27],s46 offen sc1
buffer_load_dwordx4 v[152:155],v1,s[24:27],s46 offen offset:1024 sc1
s_add_u32 s46,s28,4
s_mul_i32 s46,s46,110592
s_add_u32 s46,s46,s68
buffer_load_dwordx4 v[152:155],v1,s[24:27],s46 offen sc1
buffer_load_dwordx4 v[152:155],v1,s[24:27],s46 offen offset:1024 sc1
s_add_u32 s46,s28,5
s_mul_i32 s46,s46,110592
s_add_u32 s46,s46,s68
buffer_load_dwordx4 v[152:155],v1,s[24:27],s46 offen sc1
buffer_load_dwordx4 v[152:155],v1,s[24:27],s46 offen offset:1024 sc1
s_add_u32 s46,s28,6
s_mul_i32 s46,s46,110592
s_add_u32 s46,s46,s68
buffer_load_dwordx4 v[152:155],v1,s[24:27],s46 offen sc1
buffer_load_dwordx4 v[152:155],v1,s[24:27],s46 offen offset:1024 sc1
s_add_u32 s46,s28,7
s_mul_i32 s46,s46,110592
s_add_u32 s46,s46,s68
buffer_load_dwordx4 v[152:155],v1,s[24:27],s46 offen sc1
buffer_load_dwordx4 v[152:155],v1,s[24:27],s46 offen offset:1024 sc1
s_waitcnt vmcnt(0) lgkmcnt(0)
s_getpc_b64 s[60:61]
pc_374:
s_add_u32 s60,s60,ns_top_370-pc_374
s_addc_u32 s61,s61,0
s_mov_b32 s59,ns_fin_371-ns_top_370-4
v_lshlrev_b32 v82,7,v0
v_add_u32 v82,0,v82
v_min_u32 v82,s59,v82
v_mov_b32 v81,s61
v_add_co_u32 v80,vcc,s60,v82
s_nop 1
v_addc_co_u32 v81,vcc,0,v81,vcc
global_load_dword v83,v[80:81],off
s_waitcnt vmcnt(0)
s_mov_b32 s30,0
s_add_u32 s31,s28,1
s_and_b32 s42,s28,7
s_mul_i32 s42,s42,49152
s_add_u32 s32,s66,s42
s_add_u32 s33,s67,s42
s_mov_b32 s38,0
poll_375:
buffer_load_dword v4,v3,s[4:7],0 offen sc1
s_waitcnt vmcnt(0)
v_add_u32 v157,v156,v4
v_cmp_le_u32 vcc,s31,v157
s_nop 0
s_cmp_eq_u64 vcc,-1
s_nop 1
s_cbranch_scc1 polld_376
s_sleep 2
s_add_u32 s38,s38,1
s_cmp_lt_u32 s38,100000
s_cbranch_scc1 poll_375
s_mov_b32 s40,5
s_branch L_fail
polld_376:
s_add_u32 s44,s35,s43
s_add_u32 s46,s44,0
s_mov_b32 m0,s46
s_add_u32 s46,s32,0
buffer_load_dwordx4 v1,s[4:7],s46 offen sc1 lds
s_add_u32 s46,s44,4096
s_mov_b32 m0,s46
s_add_u32 s46,s32,4096
buffer_load_dwordx4 v1,s[4:7],s46 offen sc1 lds
s_add_u32 s46,s44,8192
s_mov_b32 m0,s46
s_add_u32 s46,s32,8192
buffer_load_dwordx4 v1,s[4:7],s46 offen sc1 lds
s_add_u32 s46,s44,40960
s_mov_b32 m0,s46
s_add_u32 s46,s33,40960
buffer_load_dwordx4 v1,s[4:7],s46 offen sc1 lds
s_add_u32 s46,s44,45056
s_mov_b32 m0,s46
s_add_u32 s46,s33,45056
buffer_load_dwordx4 v1,s[4:7],s46 offen sc1 lds
s_add_u32 s46,s44,12288
s_mov_b32 m0,s46
s_add_u32 s46,s32,12288
buffer_load_dwordx4 v1,s[4:7],s46 offen sc1 lds
s_add_u32 s46,s44,16384
s_mov_b32 m0,s46
s_add_u32 s46,s32,16384
buffer_load_dwordx4 v1,s[4:7],s46 offen sc1 lds
s_add_u32 s46,s44,20480
s_mov_b32 m0,s46
s_add_u32 s46,s32,20480
buffer_load_dwordx4 v1,s[4:7],s46 offen sc1 lds
s_add_u32 s46,s44,24576
s_mov_b32 m0,s46
s_add_u32 s46,s32,24576
buffer_load_dwordx4 v1,s[4:7],s46 offen sc1 lds
s_add_u32 s46,s44,28672
s_mov_b32 m0,s46
s_add_u32 s46,s32,28672
buffer_load_dwordx4 v1,s[4:7],s46 offen sc1 lds
s_add_u32 s46,s44,32768
s_mov_b32 m0,s46
s_add_u32 s46,s32,32768
buffer_load_dwordx4 v1,s[4:7],s46 offen sc1 lds
s_add_u32 s46,s44,36864
s_mov_b32 m0,s46
s_add_u32 s46,s32,36864
buffer_load_dwordx4 v1,s[4:7],s46 offen sc1 lds
s_mov_b32 s34,1
ns_top_370:
v_add_u32 v6,s35,v1
s_add_u32 s62,s28,1
s_mul_i32 s36,s28,110592
s_and_b32 s36,s28,7
s_mul_i32 s36,s36,110592
s_add_u32 s36,s36,s68
s_add_u32 s31,s62,1
s_and_b32 s42,s62,7
s_mul_i32 s42,s42,49152
s_add_u32 s32,s66,s42
s_add_u32 s33,s67,s42
s_xor_b32 s44,s35,49152
s_add_u32 s44,s44,s43
s_cmp_eq_u32 s34,0
s_cbranch_scc1 ns_s_377
s_waitcnt vmcnt(9)
ns_s_377:
s_barrier
ds_read_b128 v[48:51],v6
ds_read_b128 v[52:55],v6 offset:1024
ds_read_b128 v[56:59],v6 offset:2048
ds_read_b128 v[60:63],v6 offset:3072
ds_read_b128 v[64:67],v6 offset:4096
ds_read_b128 v[68:71],v6 offset:5120
ds_read_b128 v[72:75],v6 offset:6144
v_add_u32 v157,v156,v4
v_cmp_le_u32 vcc,s31,v157
s_nop 0
s_cmp_eq_u64 vcc,-1
s_cselect_b64 vcc,-1,0
s_cmp_lt_u32 s62,s63
s_cselect_b64 vcc,vcc,0
s_cmp_eq_u32 s34,0
s_cselect_b64 vcc,vcc,0
s_and_b32 s29,vcc_lo,1
ds_read_b128 v[76:79],v6 offset:7168
s_waitcnt lgkmcnt(6)
v_mfma_f32_32x32x16_bf16 v[16:31],a[0:3],v[48:51],0
s_cbranch_vccnz ns_o_378
ns_o_378r:
ds_read_b128 v[48:51],v6 offset:8192
v_mfma_f32_32x32x16_bf16 v[16:31],a[4:7],v[52:55],v[16:31]
ds_read_b128 v[52:55],v6 offset:9216
s_waitcnt lgkmcnt(6)
v_mfma_f32_32x32x16_bf16 v[16:31],a[8:11],v[56:59],v[16:31]
s_cbranch_vccnz ns_o_379
ns_o_379r:
ds_read_b128 v[56:59],v6 offset:10240
v_mfma_f32_32x32x16_bf16 v[16:31],a[12:15],v[60:63],v[16:31]
ds_read_b128 v[60:63],v6 offset:11264
s_waitcnt lgkmcnt(6)
v_mfma_f32_32x32x16_bf16 v[16:31],a[16:19],v[64:67],v[16:31]
s_cbranch_vccnz ns_o_380
ns_o_380r:
s_cmp_eq_u32 s34,0
s_cbranch_scc1 ns_s_381
s_waitcnt vmcnt(3)
ns_s_381:
s_barrier
ds_read_b128 v[64:67],v6 offset:12288
v_mfma_f32_32x32x16_bf16 v[16:31],a[20:23],v[68:71],v[16:31]
v_add_u32 v5,s35,v7
ds_read_b64 v[80:81],v5 offset:40960
ds_read_b64 v[82:83],v5 offset:41216
ds_read_b128 v[68:71],v6 offset:13312
s_waitcnt lgkmcnt(8)
v_mfma_f32_32x32x16_bf16 v[16:31],a[24:27],v[72:75],v[16:31]
s_cbranch_vccnz ns_o_382
ns_o_382r:
ds_read_b64 v[84:85],v5 offset:41472
ds_read_b64 v[86:87],v5 offset:41728
ds_read_b128 v[72:75],v6 offset:14336
v_mfma_f32_32x32x16_bf16 v[16:31],a[28:31],v[76:79],v[16:31]
ds_read_b64 v[88:89],v5 offset:41984
ds_read_b64 v[90:91],v5 offset:42240
ds_read_b64 v[92:93],v5 offset:42496
ds_read_b128 v[76:79],v6 offset:15360
s_waitcnt lgkmcnt(13)
v_mfma_f32_32x32x16_bf16 v[16:31],a[32:35],v[48:51],v[16:31]
s_cbranch_vccnz ns_o_383
ns_o_383r:
ds_read_b64 v[94:95],v5 offset:42752
ds_read_b64 v[96:97],v5 offset:43008
ds_read_b128 v[48:51],v6 offset:16384
v_mfma_f32_32x32x16_bf16 v[16:31],a[36:39],v[52:55],v[16:31]
ds_read_b64 v[98:99],v5 offset:43264
ds_read_b128 v[52:55],v6 offset:17408
s_waitcnt lgkmcnt(15)
v_mfma_f32_32x32x16_bf16 v[16:31],a[40:43],v[56:59],v[16:31]
s_cbranch_vccnz ns_o_384
ns_o_384r:
ds_read_b128 v[56:59],v6 offset:18432
v_mfma_f32_32x32x16_bf16 v[16:31],a[44:47],v[60:63],v[16:31]
ds_read_b128 v[60:63],v6 offset:19456
s_waitcnt lgkmcnt(14)
v_mfma_f32_32x32x16_bf16 v[16:31],a[48:51],v[64:67],v[16:31]
s_cbranch_vccnz ns_o_385
ns_o_385r:
s_waitcnt lgkmcnt(3)
v_add_f32 v80,v80,v90
ds_read_b128 v[64:67],v6 offset:20480
v_mfma_f32_32x32x16_bf16 v[16:31],a[52:55],v[68:71],v[16:31]
v_add_f32 v81,v81,v91
v_add_f32 v82,v82,v92
v_add_f32 v83,v83,v93
ds_read_b128 v[68:71],v6 offset:21504
v_mfma_f32_32x32x16_bf16 v[16:31],a[56:59],v[72:75],v[16:31]
s_cbranch_vccnz ns_o_386
ns_o_386r:
v_add_f32 v84,v84,v94
v_add_f32 v85,v85,v95
ds_read_b128 v[72:75],v6 offset:22528
v_mfma_f32_32x32x16_bf16 v[16:31],a[60:63],v[76:79],v[16:31]
v_add_f32 v86,v86,v96
v_add_f32 v87,v87,v97
v_add_f32 v88,v88,v98
ds_read_b128 v[76:79],v6 offset:23552
s_waitcnt lgkmcnt(6)
v_mfma_f32_32x32x16_bf16 v[16:31],a[64:67],v[48:51],v[16:31]
s_cbranch_vccnz ns_o_387
ns_o_387r:
v_add_f32 v89,v89,v99
v_add_f32 v80,v80,v84
ds_read_b128 v[48:51],v6 offset:24576
v_mfma_f32_32x32x16_bf16 v[16:31],a[68:71],v[52:55],v[16:31]
v_add_f32 v81,v81,v85
v_add_f32 v82,v82,v86
v_add_f32 v83,v83,v87
ds_read_b128 v[52:55],v6 offset:25600
s_waitcnt lgkmcnt(6)
v_mfma_f32_32x32x16_bf16 v[16:31],a[72:75],v[56:59],v[16:31]
s_cbranch_vccnz ns_o_388
ns_o_388r:
v_add_f32 v88,v88,v80
v_add_f32 v89,v89,v81
ds_read_b128 v[56:59],v6 offset:26624
v_mfma_f32_32x32x16_bf16 v[16:31],a[76:79],v[60:63],v[16:31]
v_add_f32 v12,v88,v82
v_add_f32 v13,v89,v83
v_mov_b32 v80,v12
ds_read_b128 v[60:63],v6 offset:27648
s_waitcnt lgkmcnt(6)
v_mfma_f32_32x32x16_bf16 v[16:31],a[80:83],v[64:67],v[16:31]
s_cbranch_vccnz ns_o_389
ns_o_389r:
v_mov_b32 v81,v13
s_cmp_eq_u32 s34,0
s_cbranch_scc1 ns_s_390
s_waitcnt vmcnt(0)
ns_s_390:
s_barrier
ds_read_b128 v[64:67],v6 offset:28672
v_mfma_f32_32x32x16_bf16 v[16:31],a[84:87],v[68:71],v[16:31]
v_permlane32_swap_b32 v12,v80
v_permlane32_swap_b32 v13,v81
ds_read_b128 v[68:71],v6 offset:29696
s_waitcnt lgkmcnt(6)
v_mfma_f32_32x32x16_bf16 v[16:31],a[88:91],v[72:75],v[16:31]
s_cbranch_vccnz ns_o_391
ns_o_391r:
v_add_f32 v12,v12,v80
v_add_f32 v13,v13,v81
ds_read_b128 v[72:75],v6 offset:30720
v_mfma_f32_32x32x16_bf16 v[16:31],a[92:95],v[76:79],v[16:31]
v_mul_f32 v12,s48,v12
v_mul_f32 v13,s48,v13
v_fma_f32 v13,-v12,v12,v13
buffer_load_dword v4,v3,s[4:7],0 offen sc1
ds_read_b128 v[76:79],v6 offset:31744
s_waitcnt lgkmcnt(6)
v_mfma_f32_32x32x16_bf16 v[16:31],a[96:99],v[48:51],v[16:31]
v_max_f32 v13,0,v13
v_add_f32 v80,s49,v13
v_rsq_f32 v10,v80
ds_read_b128 v[48:51],v6 offset:32768
v_mfma_f32_32x32x16_bf16 v[16:31],a[100:103],v[52:55],v[16:31]
ds_read_b128 v[52:55],v6 offset:33792
s_waitcnt lgkmcnt(6)
v_mfma_f32_32x32x16_bf16 v[16:31],a[104:107],v[56:59],v[16:31]
v_mul_f32 v11,v12,v10
v_mov_b32 v148,v10
v_mov_b32 v149,v10
ds_read_b128 v[56:59],v6 offset:34816
v_mfma_f32_32x32x16_bf16 v[16:31],a[108:111],v[60:63],v[16:31]
v_mul_f32_e64 v80,-v11,v32
v_mul_f32_e64 v81,-v11,v33
v_mul_f32_e64 v82,-v11,v34
ds_read_b128 v[60:63],v6 offset:35840
s_waitcnt lgkmcnt(6)
v_mfma_f32_32x32x16_bf16 v[16:31],a[112:115],v[64:67],v[16:31]
v_mul_f32_e64 v83,-v11,v35
v_mul_f32_e64 v84,-v11,v36
v_mul_f32_e64 v85,-v11,v37
ds_read_b128 v[64:67],v6 offset:36864
v_mfma_f32_32x32x16_bf16 v[16:31],a[116:119],v[68:71],v[16:31]
v_mul_f32_e64 v86,-v11,v38
v_mul_f32_e64 v87,-v11,v39
v_mul_f32_e64 v88,-v11,v40
ds_read_b128 v[68:71],v6 offset:37888
s_waitcnt lgkmcnt(6)
v_mfma_f32_32x32x16_bf16 v[16:31],a[120:123],v[72:75],v[16:31]
v_mul_f32_e64 v89,-v11,v41
v_mul_f32_e64 v90,-v11,v42
v_mul_f32_e64 v91,-v11,v43
ds_read_b128 v[72:75],v6 offset:38912
v_mfma_f32_32x32x16_bf16 v[16:31],a[124:127],v[76:79],v[16:31]
v_mul_f32_e64 v92,-v11,v44
v_mul_f32_e64 v93,-v11,v45
v_mul_f32_e64 v94,-v11,v46
ds_read_b128 v[76:79],v6 offset:39936
s_waitcnt lgkmcnt(6)
v_mfma_f32_32x32x16_bf16 v[16:31],a[128:131],v[48:51],v[16:31]
v_mul_f32_e64 v95,-v11,v47
v_mfma_f32_32x32x16_bf16 v[16:31],a[132:135],v[52:55],v[16:31]
s_waitcnt lgkmcnt(4)
v_mfma_f32_32x32x16_bf16 v[16:31],a[136:139],v[56:59],v[16:31]
v_mfma_f32_32x32x16_bf16 v[16:31],a[140:143],v[60:63],v[16:31]
s_waitcnt lgkmcnt(2)
v_mfma_f32_32x32x16_bf16 v[16:31],a[144:147],v[64:67],v[16:31]
v_mfma_f32_32x32x16_bf16 v[16:31],a[148:151],v[68:71],v[16:31]
s_waitcnt lgkmcnt(0)
v_mfma_f32_32x32x16_bf16 v[16:31],a[152:155],v[72:75],v[16:31]
v_mfma_f32_32x32x16_bf16 v[16:31],a[156:159],v[76:79],v[16:31]
s_nop 10
s_cbranch_vccnz ns_npf_392
s_waitcnt vmcnt(0)
v_add_u32 v157,v156,v4
v_cmp_le_u32 vcc,s31,v157
s_nop 0
s_cmp_eq_u64 vcc,-1
s_cselect_b64 vcc,-1,0
s_cmp_lt_u32 s62,s63
s_cselect_b64 vcc,vcc,0
s_cbranch_vccz ns_npf_392
s_add_u32 s46,s44,0
s_mov_b32 m0,s46
s_add_u32 s46,s32,0
buffer_load_dwordx4 v1,s[4:7],s46 offen sc1 lds
s_add_u32 s46,s44,4096
s_mov_b32 m0,s46
s_add_u32 s46,s32,4096
buffer_load_dwordx4 v1,s[4:7],s46 offen sc1 lds
s_add_u32 s46,s44,8192
s_mov_b32 m0,s46
s_add_u32 s46,s32,8192
buffer_load_dwordx4 v1,s[4:7],s46 offen sc1 lds
s_add_u32 s46,s44,40960
s_mov_b32 m0,s46
s_add_u32 s46,s33,40960
buffer_load_dwordx4 v1,s[4:7],s46 offen sc1 lds
s_add_u32 s46,s44,45056
s_mov_b32 m0,s46
s_add_u32 s46,s33,45056
buffer_load_dwordx4 v1,s[4:7],s46 offen sc1 lds
s_add_u32 s46,s44,12288
s_mov_b32 m0,s46
s_add_u32 s46,s32,12288
buffer_load_dwordx4 v1,s[4:7],s46 offen sc1 lds
s_add_u32 s46,s44,16384
s_mov_b32 m0,s46
s_add_u32 s46,s32,16384
buffer_load_dwordx4 v1,s[4:7],s46 offen sc1 lds
s_add_u32 s46,s44,20480
s_mov_b32 m0,s46
s_add_u32 s46,s32,20480
buffer_load_dwordx4 v1,s[4:7],s46 offen sc1 lds
s_add_u32 s46,s44,24576
s_mov_b32 m0,s46
s_add_u32 s46,s32,24576
buffer_load_dwordx4 v1,s[4:7],s46 offen sc1 lds
s_add_u32 s46,s44,28672
s_mov_b32 m0,s46
s_add_u32 s46,s32,28672
buffer_load_dwordx4 v1,s[4:7],s46 offen sc1 lds
s_add_u32 s46,s44,32768
s_mov_b32 m0,s46
s_add_u32 s46,s32,32768
buffer_load_dwordx4 v1,s[4:7],s46 offen sc1 lds
s_add_u32 s46,s44,36864
s_mov_b32 m0,s46
s_add_u32 s46,s32,36864
buffer_load_dwordx4 v1,s[4:7],s46 offen sc1 lds
ns_npf_392:
v_pk_fma_f32 v[16:17],v[16:17],v[148:149],v[80:81]
v_pk_fma_f32 v[18:19],v[18:19],v[148:149],v[82:83]
v_pk_fma_f32 v[20:21],v[20:21],v[148:149],v[84:85]
v_pk_fma_f32 v[22:23],v[22:23],v[148:149],v[86:87]
v_pk_mul_f32 v[80:81],v[16:17],v[16:17]
v_pk_mul_f32 v[82:83],v[18:19],v[18:19]
v_pk_mul_f32 v[84:85],v[20:21],v[20:21]
v_pk_mul_f32 v[86:87],v[22:23],v[22:23]
v_pk_fma_f32 v[80:81],v[80:81],v[146:147],v[144:145]
v_pk_fma_f32 v[82:83],v[82:83],v[146:147],v[144:145]
v_pk_fma_f32 v[84:85],v[84:85],v[146:147],v[144:145]
v_pk_fma_f32 v[86:87],v[86:87],v[146:147],v[144:145]
v_pk_mul_f32 v[80:81],v[80:81],v[16:17]
v_pk_mul_f32 v[82:83],v[82:83],v[18:19]
v_pk_mul_f32 v[84:85],v[84:85],v[20:21]
v_pk_mul_f32 v[86:87],v[86:87],v[22:23]
v_exp_f32 v80,v80
v_exp_f32 v81,v81
v_exp_f32 v82,v82
v_exp_f32 v83,v83
v_exp_f32 v84,v84
v_exp_f32 v85,v85
v_exp_f32 v86,v86
v_exp_f32 v87,v87
v_pk_add_f32 v[80:81],v[80:81],1.0 op_sel_hi:[1,0]
v_pk_add_f32 v[82:83],v[82:83],1.0 op_sel_hi:[1,0]
v_pk_add_f32 v[84:85],v[84:85],1.0 op_sel_hi:[1,0]
v_pk_add_f32 v[86:87],v[86:87],1.0 op_sel_hi:[1,0]
v_rcp_f32 v80,v80
v_rcp_f32 v81,v81
v_rcp_f32 v82,v82
v_rcp_f32 v83,v83
v_rcp_f32 v84,v84
v_rcp_f32 v85,v85
v_rcp_f32 v86,v86
v_rcp_f32 v87,v87
v_pk_mul_f32 v[16:17],v[16:17],v[80:81]
v_pk_mul_f32 v[18:19],v[18:19],v[82:83]
v_pk_mul_f32 v[20:21],v[20:21],v[84:85]
v_pk_mul_f32 v[22:23],v[22:23],v[86:87]
v_cvt_pk_bf16_f32 v128,v16,v17
v_cvt_pk_bf16_f32 v129,v18,v19
v_cvt_pk_bf16_f32 v130,v20,v21
v_cvt_pk_bf16_f32 v131,v22,v23
s_cmp_eq_u32 s21,0
s_cbranch_scc1 ls_393
buffer_store_dwordx4 v[128:131],v1,s[24:27],s36 offen
ls_394:
v_pk_fma_f32 v[24:25],v[24:25],v[148:149],v[88:89]
v_pk_fma_f32 v[26:27],v[26:27],v[148:149],v[90:91]
v_pk_fma_f32 v[28:29],v[28:29],v[148:149],v[92:93]
v_pk_fma_f32 v[30:31],v[30:31],v[148:149],v[94:95]
v_pk_mul_f32 v[88:89],v[24:25],v[24:25]
v_pk_mul_f32 v[90:91],v[26:27],v[26:27]
v_pk_mul_f32 v[92:93],v[28:29],v[28:29]
v_pk_mul_f32 v[94:95],v[30:31],v[30:31]
v_pk_fma_f32 v[88:89],v[88:89],v[146:147],v[144:145]
v_pk_fma_f32 v[90:91],v[90:91],v[146:147],v[144:145]
v_pk_fma_f32 v[92:93],v[92:93],v[146:147],v[144:145]
v_pk_fma_f32 v[94:95],v[94:95],v[146:147],v[144:145]
v_pk_mul_f32 v[88:89],v[88:89],v[24:25]
v_pk_mul_f32 v[90:91],v[90:91],v[26:27]
v_pk_mul_f32 v[92:93],v[92:93],v[28:29]
v_pk_mul_f32 v[94:95],v[94:95],v[30:31]
v_exp_f32 v88,v88
v_exp_f32 v89,v89
v_exp_f32 v90,v90
v_exp_f32 v91,v91
v_exp_f32 v92,v92
v_exp_f32 v93,v93
v_exp_f32 v94,v94
v_exp_f32 v95,v95
v_pk_add_f32 v[88:89],v[88:89],1.0 op_sel_hi:[1,0]
v_pk_add_f32 v[90:91],v[90:91],1.0 op_sel_hi:[1,0]
v_pk_add_f32 v[92:93],v[92:93],1.0 op_sel_hi:[1,0]
v_pk_add_f32 v[94:95],v[94:95],1.0 op_sel_hi:[1,0]
v_rcp_f32 v88,v88
v_rcp_f32 v89,v89
v_rcp_f32 v90,v90
v_rcp_f32 v91,v91
v_rcp_f32 v92,v92
v_rcp_f32 v93,v93
v_rcp_f32 v94,v94
v_rcp_f32 v95,v95
v_pk_mul_f32 v[24:25],v[24:25],v[88:89]
v_pk_mul_f32 v[26:27],v[26:27],v[90:91]
v_pk_mul_f32 v[28:29],v[28:29],v[92:93]
v_pk_mul_f32 v[30:31],v[30:31],v[94:95]
v_cvt_pk_bf16_f32 v132,v24,v25
v_cvt_pk_bf16_f32 v133,v26,v27
v_cvt_pk_bf16_f32 v134,v28,v29
v_cvt_pk_bf16_f32 v135,v30,v31
s_cmp_eq_u32 s21,0
s_cbranch_scc1 ls_395
buffer_store_dwordx4 v[132:135],v1,s[24:27],s36 offen offset:1024
ls_396:
s_add_u32 s64,s28,1
s_mov_b32 s28,s62
s_mov_b32 s69,s36
s_xor_b32 s35,s35,49152
s_mov_b32 s30,1
s_mov_b32 s34,0
s_cbranch_vccz ns_blk_397
s_waitcnt vmcnt(0)
v_mov_b32 v2,s64
s_mov_b64 exec,1
s_cmp_eq_u32 s21,0
s_cbranch_scc1 ls_398
buffer_store_dword v2,off,s[24:27],s37
ls_399:
s_mov_b64 exec,-1
s_mov_b32 s30,0
s_branch ns_top_370
ns_blk_397:
s_mov_b32 s34,1
buffer_load_dword v4,v3,s[4:7],0 offen sc1
s_waitcnt vmcnt(1)
v_mov_b32 v2,s64
s_mov_b64 exec,1
s_cmp_eq_u32 s21,0
s_cbranch_scc1 ls_400
buffer_store_dword v2,off,s[24:27],s37
ls_401:
s_mov_b64 exec,-1
s_mov_b32 s30,0
s_cmp_ge_u32 s28,s63
s_cbranch_scc1 ns_fin_371
s_waitcnt vmcnt(1)
v_add_u32 v157,v156,v4
v_cmp_le_u32 vcc,s31,v157
s_nop 0
s_cmp_eq_u64 vcc,-1
s_nop 1
s_cbranch_scc1 ns_rdy_402
s_mov_b32 s38,0
poll_403:
buffer_load_dword v4,v3,s[4:7],0 offen sc1
s_waitcnt vmcnt(0)
v_add_u32 v157,v156,v4
v_cmp_le_u32 vcc,s31,v157
s_nop 0
s_cmp_eq_u64 vcc,-1
s_nop 1
s_cbranch_scc1 polld_404
s_sleep 2
s_add_u32 s38,s38,1
s_cmp_lt_u32 s38,100000
s_cbranch_scc1 poll_403
s_mov_b32 s40,5
s_branch L_fail
polld_404:
ns_rdy_402:
s_add_u32 s46,s44,0
s_mov_b32 m0,s46
s_add_u32 s46,s32,0
buffer_load_dwordx4 v1,s[4:7],s46 offen sc1 lds
s_add_u32 s46,s44,4096
s_mov_b32 m0,s46
s_add_u32 s46,s32,4096
buffer_load_dwordx4 v1,s[4:7],s46 offen sc1 lds
s_add_u32 s46,s44,8192
s_mov_b32 m0,s46
s_add_u32 s46,s32,8192
buffer_load_dwordx4 v1,s[4:7],s46 offen sc1 lds
s_add_u32 s46,s44,40960
s_mov_b32 m0,s46
s_add_u32 s46,s33,40960
buffer_load_dwordx4 v1,s[4:7],s46 offen sc1 lds
s_add_u32 s46,s44,45056
s_mov_b32 m0,s46
s_add_u32 s46,s33,45056
buffer_load_dwordx4 v1,s[4:7],s46 offen sc1 lds
s_add_u32 s46,s44,12288
s_mov_b32 m0,s46
s_add_u32 s46,s32,12288
buffer_load_dwordx4 v1,s[4:7],s46 offen sc1 lds
s_add_u32 s46,s44,16384
s_mov_b32 m0,s46
s_add_u32 s46,s32,16384
buffer_load_dwordx4 v1,s[4:7],s46 offen sc1 lds
s_add_u32 s46,s44,20480
s_mov_b32 m0,s46
s_add_u32 s46,s32,20480
buffer_load_dwordx4 v1,s[4:7],s46 offen sc1 lds
s_add_u32 s46,s44,24576
s_mov_b32 m0,s46
s_add_u32 s46,s32,24576
buffer_load_dwordx4 v1,s[4:7],s46 offen sc1 lds
s_add_u32 s46,s44,28672
s_mov_b32 m0,s46
s_add_u32 s46,s32,28672
buffer_load_dwordx4 v1,s[4:7],s46 offen sc1 lds
s_add_u32 s46,s44,32768
s_mov_b32 m0,s46
s_add_u32 s46,s32,32768
buffer_load_dwordx4 v1,s[4:7],s46 offen sc1 lds
s_add_u32 s46,s44,36864
s_mov_b32 m0,s46
s_add_u32 s46,s32,36864
buffer_load_dwordx4 v1,s[4:7],s46 offen sc1 lds
s_branch ns_top_370
ns_o_378:
s_add_u32 s46,s44,0
s_mov_b32 m0,s46
s_add_u32 s46,s32,0
buffer_load_dwordx4 v1,s[4:7],s46 offen sc1 lds
s_branch ns_o_378r
ns_o_379:
s_add_u32 s46,s44,4096
s_mov_b32 m0,s46
s_add_u32 s46,s32,4096
buffer_load_dwordx4 v1,s[4:7],s46 offen sc1 lds
s_branch ns_o_379r
ns_o_380:
s_add_u32 s46,s44,8192
s_mov_b32 m0,s46
s_add_u32 s46,s32,8192
buffer_load_dwordx4 v1,s[4:7],s46 offen sc1 lds
s_branch ns_o_380r
ns_o_382:
s_add_u32 s46,s44,40960
s_mov_b32 m0,s46
s_add_u32 s46,s33,40960
buffer_load_dwordx4 v1,s[4:7],s46 offen sc1 lds
s_branch ns_o_382r
ns_o_383:
s_add_u32 s46,s44,45056
s_mov_b32 m0,s46
s_add_u32 s46,s33,45056
buffer_load_dwordx4 v1,s[4:7],s46 offen sc1 lds
s_branch ns_o_383r
ns_o_384:
s_add_u32 s46,s44,12288
s_mov_b32 m0,s46
s_add_u32 s46,s32,12288
buffer_load_dwordx4 v1,s[4:7],s46 offen sc1 lds
s_branch ns_o_384r
ns_o_385:
s_add_u32 s46,s44,16384
s_mov_b32 m0,s46
s_add_u32 s46,s32,16384
buffer_load_dwordx4 v1,s[4:7],s46 offen sc1 lds
s_branch ns_o_385r
ns_o_386:
s_add_u32 s46,s44,20480
s_mov_b32 m0,s46
s_add_u32 s46,s32,20480
buffer_load_dwordx4 v1,s[4:7],s46 offen sc1 lds
s_branch ns_o_386r
ns_o_387:
s_add_u32 s46,s44,24576
s_mov_b32 m0,s46
s_add_u32 s46,s32,24576
buffer_load_dwordx4 v1,s[4:7],s46 offen sc1 lds
s_branch ns_o_387r
ns_o_388:
s_add_u32 s46,s44,28672
s_mov_b32 m0,s46
s_add_u32 s46,s32,28672
buffer_load_dwordx4 v1,s[4:7],s46 offen sc1 lds
s_branch ns_o_388r
ns_o_389:
s_add_u32 s46,s44,32768
s_mov_b32 m0,s46
s_add_u32 s46,s32,32768
buffer_load_dwordx4 v1,s[4:7],s46 offen sc1 lds
s_branch ns_o_389r
ns_o_391:
s_add_u32 s46,s44,36864
s_mov_b32 m0,s46
s_add_u32 s46,s32,36864
buffer_load_dwordx4 v1,s[4:7],s46 offen sc1 lds
s_branch ns_o_391r
ns_fin_371:
s_branch L_end
ls_393:
buffer_store_dwordx4 v[128:131],v1,s[24:27],s36 offen sc1
s_nop 1
s_branch ls_394
ls_395:
buffer_store_dwordx4 v[132:135],v1,s[24:27],s36 offen offset:1024 sc1
s_nop 1
s_branch ls_396
ls_398:
buffer_store_dword v2,off,s[24:27],s37 sc1
s_nop 1
s_branch ls_399
ls_400:
buffer_store_dword v2,off,s[24:27],s37 sc1
s_nop 1
s_branch ls_401
R_w4:
s_add_u32 s42,s42,s43
s_cmp_ge_u32 s3,2
s_cbranch_scc1 ks_hi_405
v_lshlrev_b32 v1,4,v0
s_mov_b32 s24,s4
s_mov_b32 s25,s5
s_mov_b32 s26,s6
s_mov_b32 s27,0x20000
s_lshl_b32 s43,s42,1
s_mov_b32 s44,0
s_and_b32 s45,s3,1
s_mul_i32 s45,s45,25
s_lshl_b32 s46,s44,7
s_add_u32 s45,s45,s46
s_add_u32 s45,s45,0
s_and_b32 s48,s3,1
s_add_u32 s49,s43,s48
s_load_dwordx2 s[20:21],s[0:1],88
s_waitcnt lgkmcnt(0)
s_mov_b32 s16,s20
s_and_b32 s17,s21,0xffff
s_mov_b32 s18,0x21c000
s_mov_b32 s19,0x20000
s_lshl_b32 s46,s43,6
s_mul_i32 s64,s45,20480
s_add_u32 s64,s64,s46
s_mul_i32 s41,s42,11
s_mul_hi_u32 s46,s41,0xa3d70a4
s_mul_i32 s47,s46,25
s_sub_u32 s41,s41,s47
v_lshrrev_b32 v150,3,v0
v_mul_u32_u24 v148,1280,v150
v_and_b32 v150,7,v0
v_lshl_add_u32 v148,v150,4,v148
v_and_b32 v150,3,v0
v_lshlrev_b32 v149,3,v150
v_bfe_u32 v150,v0,4,1
v_lshl_add_u32 v149,v150,5,v149
v_bfe_u32 v150,v0,2,2
v_lshl_add_u32 v149,v150,7,v149
v_lshrrev_b32 v150,5,v0
v_lshl_add_u32 v149,v150,9,v149
s_mul_i32 s22,s3,40960
v_add_u32 v149,s22,v149
s_lshl_b32 s23,s48,6
v_add_u32 v149,s23,v149
v_xor_b32 v150,64,v149
s_add_u32 s20,s41,-25
s_cselect_b32 s47,0,25
s_add_u32 s20,s20,s47
s_mul_i32 s20,s20,20480
s_add_u32 s20,s20,s64
s_add_u32 s23,s22,0
s_mov_b32 m0,s23
s_nop 0
buffer_load_dwordx4 v148,s[16:19],s20 offen lds
s_add_u32 s23,s22,1024
s_mov_b32 m0,s23
s_add_u32 s20,s20,10240
buffer_load_dwordx4 v148,s[16:19],s20 offen lds
s_add_u32 s20,s41,-24
s_cselect_b32 s47,0,25
s_add_u32 s20,s20,s47
s_mul_i32 s20,s20,20480
s_add_u32 s20,s20,s64
s_add_u32 s23,s22,2048
s_mov_b32 m0,s23
s_nop 0
buffer_load_dwordx4 v148,s[16:19],s20 offen lds
s_add_u32 s23,s22,3072
s_mov_b32 m0,s23
s_add_u32 s20,s20,10240
buffer_load_dwordx4 v148,s[16:19],s20 offen lds
s_add_u32 s20,s41,-23
s_cselect_b32 s47,0,25
s_add_u32 s20,s20,s47
s_mul_i32 s20,s20,20480
s_add_u32 s20,s20,s64
s_add_u32 s23,s22,4096
s_mov_b32 m0,s23
s_nop 0
buffer_load_dwordx4 v148,s[16:19],s20 offen lds
s_add_u32 s23,s22,5120
s_mov_b32 m0,s23
s_add_u32 s20,s20,10240
buffer_load_dwordx4 v148,s[16:19],s20 offen lds
s_add_u32 s20,s41,-22
s_cselect_b32 s47,0,25
s_add_u32 s20,s20,s47
s_mul_i32 s20,s20,20480
s_add_u32 s20,s20,s64
s_add_u32 s23,s22,6144
s_mov_b32 m0,s23
s_nop 0
buffer_load_dwordx4 v148,s[16:19],s20 offen lds
s_add_u32 s23,s22,7168
s_mov_b32 m0,s23
s_add_u32 s20,s20,10240
buffer_load_dwordx4 v148,s[16:19],s20 offen lds
s_add_u32 s20,s41,-21
s_cselect_b32 s47,0,25
s_add_u32 s20,s20,s47
s_mul_i32 s20,s20,20480
s_add_u32 s20,s20,s64
s_add_u32 s23,s22,8192
s_mov_b32 m0,s23
s_nop 0
buffer_load_dwordx4 v148,s[16:19],s20 offen lds
s_add_u32 s23,s22,9216
s_mov_b32 m0,s23
s_add_u32 s20,s20,10240
buffer_load_dwordx4 v148,s[16:19],s20 offen lds
s_add_u32 s20,s41,-20
s_cselect_b32 s47,0,25
s_add_u32 s20,s20,s47
s_mul_i32 s20,s20,20480
s_add_u32 s20,s20,s64
s_add_u32 s23,s22,10240
s_mov_b32 m0,s23
s_nop 0
buffer_load_dwordx4 v148,s[16:19],s20 offen lds
s_add_u32 s23,s22,11264
s_mov_b32 m0,s23
s_add_u32 s20,s20,10240
buffer_load_dwordx4 v148,s[16:19],s20 offen lds
s_add_u32 s20,s41,-19
s_cselect_b32 s47,0,25
s_add_u32 s20,s20,s47
s_mul_i32 s20,s20,20480
s_add_u32 s20,s20,s64
s_add_u32 s23,s22,12288
s_mov_b32 m0,s23
s_nop 0
buffer_load_dwordx4 v148,s[16:19],s20 offen lds
s_add_u32 s23,s22,13312
s_mov_b32 m0,s23
s_add_u32 s20,s20,10240
buffer_load_dwordx4 v148,s[16:19],s20 offen lds
s_add_u32 s20,s41,-18
s_cselect_b32 s47,0,25
s_add_u32 s20,s20,s47
s_mul_i32 s20,s20,20480
s_add_u32 s20,s20,s64
s_add_u32 s23,s22,14336
s_mov_b32 m0,s23
s_nop 0
buffer_load_dwordx4 v148,s[16:19],s20 offen lds
s_add_u32 s23,s22,15360
s_mov_b32 m0,s23
s_add_u32 s20,s20,10240
buffer_load_dwordx4 v148,s[16:19],s20 offen lds
s_add_u32 s20,s41,-17
s_cselect_b32 s47,0,25
s_add_u32 s20,s20,s47
s_mul_i32 s20,s20,20480
s_add_u32 s20,s20,s64
s_add_u32 s23,s22,16384
s_mov_b32 m0,s23
s_nop 0
buffer_load_dwordx4 v148,s[16:19],s20 offen lds
s_add_u32 s23,s22,17408
s_mov_b32 m0,s23
s_add_u32 s20,s20,10240
buffer_load_dwordx4 v148,s[16:19],s20 offen lds
s_add_u32 s20,s41,-16
s_cselect_b32 s47,0,25
s_add_u32 s20,s20,s47
s_mul_i32 s20,s20,20480
s_add_u32 s20,s20,s64
s_add_u32 s23,s22,18432
s_mov_b32 m0,s23
s_nop 0
buffer_load_dwordx4 v148,s[16:19],s20 offen lds
s_add_u32 s23,s22,19456
s_mov_b32 m0,s23
s_add_u32 s20,s20,10240
buffer_load_dwordx4 v148,s[16:19],s20 offen lds
s_add_u32 s20,s41,-15
s_cselect_b32 s47,0,25
s_add_u32 s20,s20,s47
s_mul_i32 s20,s20,20480
s_add_u32 s20,s20,s64
s_add_u32 s23,s22,20480
s_mov_b32 m0,s23
s_nop 0
buffer_load_dwordx4 v148,s[16:19],s20 offen lds
s_add_u32 s23,s22,21504
s_mov_b32 m0,s23
s_add_u32 s20,s20,10240
buffer_load_dwordx4 v148,s[16:19],s20 offen lds
s_add_u32 s20,s41,-14
s_cselect_b32 s47,0,25
s_add_u32 s20,s20,s47
s_mul_i32 s20,s20,20480
s_add_u32 s20,s20,s64
s_add_u32 s23,s22,22528
s_mov_b32 m0,s23
s_nop 0
buffer_load_dwordx4 v148,s[16:19],s20 offen lds
s_add_u32 s23,s22,23552
s_mov_b32 m0,s23
s_add_u32 s20,s20,10240
buffer_load_dwordx4 v148,s[16:19],s20 offen lds
s_add_u32 s20,s41,-13
s_cselect_b32 s47,0,25
s_add_u32 s20,s20,s47
s_mul_i32 s20,s20,20480
s_add_u32 s20,s20,s64
s_add_u32 s23,s22,24576
s_mov_b32 m0,s23
s_nop 0
buffer_load_dwordx4 v148,s[16:19],s20 offen lds
s_add_u32 s23,s22,25600
s_mov_b32 m0,s23
s_add_u32 s20,s20,10240
buffer_load_dwordx4 v148,s[16:19],s20 offen lds
s_add_u32 s20,s41,-12
s_cselect_b32 s47,0,25
s_add_u32 s20,s20,s47
s_mul_i32 s20,s20,20480
s_add_u32 s20,s20,s64
s_add_u32 s23,s22,26624
s_mov_b32 m0,s23
s_nop 0
buffer_load_dwordx4 v148,s[16:19],s20 offen lds
s_add_u32 s23,s22,27648
s_mov_b32 m0,s23
s_add_u32 s20,s20,10240
buffer_load_dwordx4 v148,s[16:19],s20 offen lds
s_add_u32 s20,s41,-11
s_cselect_b32 s47,0,25
s_add_u32 s20,s20,s47
s_mul_i32 s20,s20,20480
s_add_u32 s20,s20,s64
s_add_u32 s23,s22,28672
s_mov_b32 m0,s23
s_nop 0
buffer_load_dwordx4 v148,s[16:19],s20 offen lds
s_add_u32 s23,s22,29696
s_mov_b32 m0,s23
s_add_u32 s20,s20,10240
buffer_load_dwordx4 v148,s[16:19],s20 offen lds
s_add_u32 s20,s41,-10
s_cselect_b32 s47,0,25
s_add_u32 s20,s20,s47
s_mul_i32 s20,s20,20480
s_add_u32 s20,s20,s64
s_add_u32 s23,s22,30720
s_mov_b32 m0,s23
s_nop 0
buffer_load_dwordx4 v148,s[16:19],s20 offen lds
s_add_u32 s23,s22,31744
s_mov_b32 m0,s23
s_add_u32 s20,s20,10240
buffer_load_dwordx4 v148,s[16:19],s20 offen lds
s_add_u32 s20,s41,-9
s_cselect_b32 s47,0,25
s_add_u32 s20,s20,s47
s_mul_i32 s20,s20,20480
s_add_u32 s20,s20,s64
s_add_u32 s23,s22,32768
s_mov_b32 m0,s23
s_nop 0
buffer_load_dwordx4 v148,s[16:19],s20 offen lds
s_add_u32 s23,s22,33792
s_mov_b32 m0,s23
s_add_u32 s20,s20,10240
buffer_load_dwordx4 v148,s[16:19],s20 offen lds
s_add_u32 s20,s41,-8
s_cselect_b32 s47,0,25
s_add_u32 s20,s20,s47
s_mul_i32 s20,s20,20480
s_add_u32 s20,s20,s64
s_add_u32 s23,s22,34816
s_mov_b32 m0,s23
s_nop 0
buffer_load_dwordx4 v148,s[16:19],s20 offen lds
s_add_u32 s23,s22,35840
s_mov_b32 m0,s23
s_add_u32 s20,s20,10240
buffer_load_dwordx4 v148,s[16:19],s20 offen lds
s_waitcnt vmcnt(34)
ds_read_b64_tr_b16 a[0:1],v149
ds_read_b64_tr_b16 a[2:3],v149 offset:1024
ds_read_b64_tr_b16 a[100:101],v150
ds_read_b64_tr_b16 a[102:103],v150 offset:1024
s_waitcnt vmcnt(32)
ds_read_b64_tr_b16 a[4:5],v149 offset:2048
ds_read_b64_tr_b16 a[6:7],v149 offset:3072
ds_read_b64_tr_b16 a[104:105],v150 offset:2048
ds_read_b64_tr_b16 a[106:107],v150 offset:3072
s_waitcnt vmcnt(30)
ds_read_b64_tr_b16 a[8:9],v149 offset:4096
ds_read_b64_tr_b16 a[10:11],v149 offset:5120
ds_read_b64_tr_b16 a[108:109],v150 offset:4096
ds_read_b64_tr_b16 a[110:111],v150 offset:5120
s_waitcnt lgkmcnt(8)
s_add_u32 s20,s41,-7
s_cselect_b32 s47,0,25
s_add_u32 s20,s20,s47
s_mul_i32 s20,s20,20480
s_add_u32 s20,s20,s64
s_add_u32 s23,s22,0
s_mov_b32 m0,s23
s_nop 0
buffer_load_dwordx4 v148,s[16:19],s20 offen lds
s_add_u32 s23,s22,1024
s_mov_b32 m0,s23
s_add_u32 s20,s20,10240
buffer_load_dwordx4 v148,s[16:19],s20 offen lds
s_waitcnt vmcnt(30)
ds_read_b64_tr_b16 a[12:13],v149 offset:6144
ds_read_b64_tr_b16 a[14:15],v149 offset:7168
ds_read_b64_tr_b16 a[112:113],v150 offset:6144
ds_read_b64_tr_b16 a[114:115],v150 offset:7168
s_waitcnt lgkmcnt(8)
s_add_u32 s20,s41,-6
s_cselect_b32 s47,0,25
s_add_u32 s20,s20,s47
s_mul_i32 s20,s20,20480
s_add_u32 s20,s20,s64
s_add_u32 s23,s22,2048
s_mov_b32 m0,s23
s_nop 0
buffer_load_dwordx4 v148,s[16:19],s20 offen lds
s_add_u32 s23,s22,3072
s_mov_b32 m0,s23
s_add_u32 s20,s20,10240
buffer_load_dwordx4 v148,s[16:19],s20 offen lds
s_waitcnt vmcnt(30)
ds_read_b64_tr_b16 a[16:17],v149 offset:8192
ds_read_b64_tr_b16 a[18:19],v149 offset:9216
ds_read_b64_tr_b16 a[116:117],v150 offset:8192
ds_read_b64_tr_b16 a[118:119],v150 offset:9216
s_waitcnt lgkmcnt(8)
s_add_u32 s20,s41,-5
s_cselect_b32 s47,0,25
s_add_u32 s20,s20,s47
s_mul_i32 s20,s20,20480
s_add_u32 s20,s20,s64
s_add_u32 s23,s22,4096
s_mov_b32 m0,s23
s_nop 0
buffer_load_dwordx4 v148,s[16:19],s20 offen lds
s_add_u32 s23,s22,5120
s_mov_b32 m0,s23
s_add_u32 s20,s20,10240
buffer_load_dwordx4 v148,s[16:19],s20 offen lds
s_waitcnt vmcnt(30)
ds_read_b64_tr_b16 a[20:21],v149 offset:10240
ds_read_b64_tr_b16 a[22:23],v149 offset:11264
ds_read_b64_tr_b16 a[120:121],v150 offset:10240
ds_read_b64_tr_b16 a[122:123],v150 offset:11264
s_waitcnt lgkmcnt(8)
s_add_u32 s20,s41,-4
s_cselect_b32 s47,0,25
s_add_u32 s20,s20,s47
s_mul_i32 s20,s20,20480
s_add_u32 s20,s20,s64
s_add_u32 s23,s22,6144
s_mov_b32 m0,s23
s_nop 0
buffer_load_dwordx4 v148,s[16:19],s20 offen lds
s_add_u32 s23,s22,7168
s_mov_b32 m0,s23
s_add_u32 s20,s20,10240
buffer_load_dwordx4 v148,s[16:19],s20 offen lds
s_waitcnt vmcnt(30)
ds_read_b64_tr_b16 a[24:25],v149 offset:12288
ds_read_b64_tr_b16 a[26:27],v149 offset:13312
ds_read_b64_tr_b16 a[124:125],v150 offset:12288
ds_read_b64_tr_b16 a[126:127],v150 offset:13312
s_waitcnt lgkmcnt(8)
s_add_u32 s20,s41,-3
s_cselect_b32 s47,0,25
s_add_u32 s20,s20,s47
s_mul_i32 s20,s20,20480
s_add_u32 s20,s20,s64
s_add_u32 s23,s22,8192
s_mov_b32 m0,s23
s_nop 0
buffer_load_dwordx4 v148,s[16:19],s20 offen lds
s_add_u32 s23,s22,9216
s_mov_b32 m0,s23
s_add_u32 s20,s20,10240
buffer_load_dwordx4 v148,s[16:19],s20 offen lds
s_waitcnt vmcnt(30)
ds_read_b64_tr_b16 a[28:29],v149 offset:14336
ds_read_b64_tr_b16 a[30:31],v149 offset:15360
ds_read_b64_tr_b16 a[128:129],v150 offset:14336
ds_read_b64_tr_b16 a[130:131],v150 offset:15360
s_waitcnt lgkmcnt(8)
s_add_u32 s20,s41,-2
s_cselect_b32 s47,0,25
s_add_u32 s20,s20,s47
s_mul_i32 s20,s20,20480
s_add_u32 s20,s20,s64
s_add_u32 s23,s22,10240
s_mov_b32 m0,s23
s_nop 0
buffer_load_dwordx4 v148,s[16:19],s20 offen lds
s_add_u32 s23,s22,11264
s_mov_b32 m0,s23
s_add_u32 s20,s20,10240
buffer_load_dwordx4 v148,s[16:19],s20 offen lds
s_waitcnt vmcnt(30)
ds_read_b64_tr_b16 a[32:33],v149 offset:16384
ds_read_b64_tr_b16 a[34:35],v149 offset:17408
ds_read_b64_tr_b16 a[132:133],v150 offset:16384
ds_read_b64_tr_b16 a[134:135],v150 offset:17408
s_waitcnt lgkmcnt(8)
s_add_u32 s20,s41,-1
s_cselect_b32 s47,0,25
s_add_u32 s20,s20,s47
s_mul_i32 s20,s20,20480
s_add_u32 s20,s20,s64
s_add_u32 s23,s22,12288
s_mov_b32 m0,s23
s_nop 0
buffer_load_dwordx4 v148,s[16:19],s20 offen lds
s_add_u32 s23,s22,13312
s_mov_b32 m0,s23
s_add_u32 s20,s20,10240
buffer_load_dwordx4 v148,s[16:19],s20 offen lds
s_waitcnt vmcnt(30)
ds_read_b64_tr_b16 a[36:37],v149 offset:18432
ds_read_b64_tr_b16 a[38:39],v149 offset:19456
ds_read_b64_tr_b16 a[136:137],v150 offset:18432
ds_read_b64_tr_b16 a[138:139],v150 offset:19456
s_waitcnt vmcnt(28)
ds_read_b64_tr_b16 a[40:41],v149 offset:20480
ds_read_b64_tr_b16 a[42:43],v149 offset:21504
ds_read_b64_tr_b16 a[140:141],v150 offset:20480
ds_read_b64_tr_b16 a[142:143],v150 offset:21504
s_waitcnt vmcnt(26)
ds_read_b64_tr_b16 a[44:45],v149 offset:22528
ds_read_b64_tr_b16 a[46:47],v149 offset:23552
ds_read_b64_tr_b16 a[144:145],v150 offset:22528
ds_read_b64_tr_b16 a[146:147],v150 offset:23552
s_waitcnt vmcnt(24)
ds_read_b64_tr_b16 a[48:49],v149 offset:24576
ds_read_b64_tr_b16 a[50:51],v149 offset:25600
ds_read_b64_tr_b16 a[148:149],v150 offset:24576
ds_read_b64_tr_b16 a[150:151],v150 offset:25600
s_waitcnt vmcnt(22)
ds_read_b64_tr_b16 a[52:53],v149 offset:26624
ds_read_b64_tr_b16 a[54:55],v149 offset:27648
ds_read_b64_tr_b16 a[152:153],v150 offset:26624
ds_read_b64_tr_b16 a[154:155],v150 offset:27648
s_waitcnt vmcnt(20)
ds_read_b64_tr_b16 a[56:57],v149 offset:28672
ds_read_b64_tr_b16 a[58:59],v149 offset:29696
ds_read_b64_tr_b16 a[156:157],v150 offset:28672
ds_read_b64_tr_b16 a[158:159],v150 offset:29696
s_waitcnt vmcnt(18)
ds_read_b64_tr_b16 a[60:61],v149 offset:30720
ds_read_b64_tr_b16 a[62:63],v149 offset:31744
ds_read_b64_tr_b16 a[160:161],v150 offset:30720
ds_read_b64_tr_b16 a[162:163],v150 offset:31744
s_waitcnt vmcnt(16)
ds_read_b64_tr_b16 a[64:65],v149 offset:32768
ds_read_b64_tr_b16 a[66:67],v149 offset:33792
ds_read_b64_tr_b16 a[164:165],v150 offset:32768
ds_read_b64_tr_b16 a[166:167],v150 offset:33792
s_waitcnt vmcnt(14)
ds_read_b64_tr_b16 a[68:69],v149 offset:34816
ds_read_b64_tr_b16 a[70:71],v149 offset:35840
ds_read_b64_tr_b16 a[168:169],v150 offset:34816
ds_read_b64_tr_b16 a[170:171],v150 offset:35840
s_waitcnt vmcnt(12)
ds_read_b64_tr_b16 a[72:73],v149
ds_read_b64_tr_b16 a[74:75],v149 offset:1024
ds_read_b64_tr_b16 a[172:173],v150
ds_read_b64_tr_b16 a[174:175],v150 offset:1024
s_waitcnt vmcnt(10)
ds_read_b64_tr_b16 a[76:77],v149 offset:2048
ds_read_b64_tr_b16 a[78:79],v149 offset:3072
ds_read_b64_tr_b16 a[176:177],v150 offset:2048
ds_read_b64_tr_b16 a[178:179],v150 offset:3072
s_waitcnt vmcnt(8)
ds_read_b64_tr_b16 a[80:81],v149 offset:4096
ds_read_b64_tr_b16 a[82:83],v149 offset:5120
ds_read_b64_tr_b16 a[180:181],v150 offset:4096
ds_read_b64_tr_b16 a[182:183],v150 offset:5120
s_waitcnt vmcnt(6)
ds_read_b64_tr_b16 a[84:85],v149 offset:6144
ds_read_b64_tr_b16 a[86:87],v149 offset:7168
ds_read_b64_tr_b16 a[184:185],v150 offset:6144
ds_read_b64_tr_b16 a[186:187],v150 offset:7168
s_waitcnt vmcnt(4)
ds_read_b64_tr_b16 a[88:89],v149 offset:8192
ds_read_b64_tr_b16 a[90:91],v149 offset:9216
ds_read_b64_tr_b16 a[188:189],v150 offset:8192
ds_read_b64_tr_b16 a[190:191],v150 offset:9216
s_waitcnt vmcnt(2)
ds_read_b64_tr_b16 a[92:93],v149 offset:10240
ds_read_b64_tr_b16 a[94:95],v149 offset:11264
ds_read_b64_tr_b16 a[192:193],v150 offset:10240
ds_read_b64_tr_b16 a[194:195],v150 offset:11264
s_waitcnt vmcnt(0)
ds_read_b64_tr_b16 a[96:97],v149 offset:12288
ds_read_b64_tr_b16 a[98:99],v149 offset:13312
ds_read_b64_tr_b16 a[196:197],v150 offset:12288
ds_read_b64_tr_b16 a[198:199],v150 offset:13312
s_waitcnt lgkmcnt(0)
s_barrier
s_lshl_b32 s41,s41,10
s_lshr_b32 s20,s2,5
v_and_b32 v149,7,v0
v_min_u32 v148,1,v149
v_lshl_add_u32 v149,v148,3,v149
v_lshlrev_b32 v149,4,v149
s_mov_b32 s38,0
s_nop 0
reg_406:
buffer_load_dword v148,v149,s[12:15],0 offen sc1
s_waitcnt vmcnt(0)
v_readlane_b32 s50,v148,0
v_readlane_b32 s51,v148,1
v_readlane_b32 s52,v148,2
v_readlane_b32 s53,v148,3
v_readlane_b32 s54,v148,4
v_readlane_b32 s55,v148,5
v_readlane_b32 s56,v148,6
v_readlane_b32 s57,v148,7
v_readlane_b32 s58,v148,s20
s_nop 0
s_cmp_ge_u32 s58,32
s_nop 1
s_cbranch_scc1 regd_407
s_add_u32 s59,s50,s51
s_add_u32 s59,s59,s52
s_add_u32 s59,s59,s53
s_add_u32 s59,s59,s54
s_add_u32 s59,s59,s55
s_add_u32 s59,s59,s56
s_add_u32 s59,s59,s57
s_cmp_ge_u32 s59,256
s_cbranch_scc1 regd_407
s_sleep 2
s_add_u32 s38,s38,1
s_cmp_lt_u32 s38,100000
s_cbranch_scc1 reg_406
s_mov_b32 s40,15
s_branch L_fail
regd_407:
s_cmp_ge_u32 s58,32
s_cselect_b32 s21,1,0
v_mov_b32 v148,68
s_mov_b32 s99,128
s_mov_b32 s38,0
poll_408:
buffer_load_dword v149,v148,s[12:15],0 offen sc1
s_waitcnt vmcnt(0)
v_cmp_le_u32 vcc,s99,v149
s_nop 0
s_cmp_eq_u64 vcc,-1
s_nop 1
s_cbranch_scc1 polld_409
s_sleep 8
s_add_u32 s38,s38,1
s_cmp_lt_u32 s38,100000
s_cbranch_scc1 poll_408
s_mov_b32 s40,14
s_branch L_fail
polld_409:
v_readfirstlane_b32 s99,v149
s_nop 0
s_and_b32 s99,s99,1
s_lshl_b32 s99,s99,13
s_mul_i32 s32,s39,0x6c0000
s_add_u32 s32,s32,0x4d30000
s_lshl_b32 s46,s45,10
s_add_u32 s32,s32,s46
s_mul_i32 s46,s39,0x48000
s_add_u32 s46,s46,0x50000
s_lshl_b32 s101,s39,13
s_xor_b32 s101,s101,s99
s_xor_b32 s101,s101,8192
s_add_u32 s46,s46,s101
s_lshr_b32 s47,s45,1
v_add_u32 v2,s47,v0
s_add_u32 s47,s45,24
s_lshr_b32 s47,s47,1
v_min_u32 v2,s47,v2
v_lshlrev_b32 v2,7,v2
v_add_u32 v2,s46,v2
s_lshl_b32 s60,s49,11
s_mul_i32 s33,s39,0x300000
s_add_u32 s33,s33,0x3b00000
s_add_u32 s33,s33,s60
s_mul_i32 s34,s39,0x300000
s_add_u32 s34,s34,0x4730000
s_add_u32 s34,s34,s60
s_mov_b32 s36,58720256
s_lshl_b32 s61,s49,7
s_add_u32 s37,s61,360448
s_add_u32 s37,s37,s99
s_lshl_b32 s62,s49,6
s_mul_i32 s66,s39,0x48000
s_add_u32 s66,s66,0x31000
s_lshl_b32 s101,s39,13
s_xor_b32 s101,s101,s99
s_xor_b32 s101,s101,8192
s_add_u32 s66,s66,s101
s_add_u32 s66,s66,s61
v_and_b32 v11,31,v0
v_mul_u32_u24 v11,1280,v11
v_lshrrev_b32 v12,5,v0
v_lshl_add_u32 v11,v12,4,v11
s_lshl_b32 s61,s49,8
s_add_u32 s63,s36,s61
s_add_u32 s63,s63,40960
s_add_u32 s36,s36,s60
v_and_b32 v10,31,v0
v_lshlrev_b32 v10,3,v10
s_cmp_eq_u32 s44,0
s_cselect_b32 s26,s6,0
s_add_u32 s32,s32,s41
s_sub_u32 s65,s32,25600
s_lshl_b32 s46,s48,14
v_add_u32 v9,s46,v1
s_lshl_b32 s46,s3,12
v_add_u32 v8,s46,v9
s_mov_b32 s58,s60
s_waitcnt vmcnt(0) lgkmcnt(0)
s_getpc_b64 s[60:61]
pc_412:
s_add_u32 s60,s60,ks_top_410-pc_412
s_addc_u32 s61,s61,0
s_mov_b32 s59,ks_fin_411-ks_top_410-4
v_lshlrev_b32 v150,7,v0
v_add_u32 v150,0,v150
v_min_u32 v150,s59,v150
v_mov_b32 v149,s61
v_add_co_u32 v148,vcc,s60,v150
s_nop 1
v_addc_co_u32 v149,vcc,0,v149,vcc
global_load_dword v151,v[148:149],off
s_waitcnt vmcnt(0)
s_mov_b32 s28,0
s_mov_b32 s31,1
s_mov_b32 s30,0
s_mov_b32 s67,64
s_lshl_b32 s46,s39,1
s_sub_u32 s67,65,s46
s_mov_b32 s38,0
poll_413:
buffer_load_dword v6,v2,s[4:7],0 offen sc1
s_waitcnt vmcnt(0)
v_cmp_le_u32 vcc,s31,v6
s_nop 0
s_cmp_eq_u64 vcc,-1
s_nop 1
s_cbranch_scc1 polld_414
s_sleep 2
s_add_u32 s38,s38,1
s_cmp_lt_u32 s38,100000
s_cbranch_scc1 poll_413
s_mov_b32 s40,12
s_branch L_fail
polld_414:
buffer_load_dwordx4 v[148:151],v1,s[24:27],s33 offen sc1
buffer_load_dwordx4 v[152:155],v1,s[24:27],s33 offen offset:1024 sc1
s_cmp_lt_u32 s41,25600
s_cselect_b32 s46,s32,s65
s_add_u32 s46,s46,0
buffer_load_dwordx4 v[48:51],v1,s[4:7],s46 offen sc1
s_cmp_lt_u32 s41,24576
s_cselect_b32 s46,s32,s65
s_add_u32 s46,s46,0
buffer_load_dwordx4 v[52:55],v1,s[4:7],s46 offen offset:1024 sc1
s_cmp_lt_u32 s41,23552
s_cselect_b32 s46,s32,s65
s_add_u32 s46,s46,0
buffer_load_dwordx4 v[56:59],v1,s[4:7],s46 offen offset:2048 sc1
s_cmp_lt_u32 s41,22528
s_cselect_b32 s46,s32,s65
s_add_u32 s46,s46,0
buffer_load_dwordx4 v[60:63],v1,s[4:7],s46 offen offset:3072 sc1
s_cmp_lt_u32 s41,21504
s_cselect_b32 s46,s32,s65
s_add_u32 s46,s46,4096
buffer_load_dwordx4 v[64:67],v1,s[4:7],s46 offen sc1
s_cmp_lt_u32 s41,20480
s_cselect_b32 s46,s32,s65
s_add_u32 s46,s46,4096
buffer_load_dwordx4 v[68:71],v1,s[4:7],s46 offen offset:1024 sc1
s_cmp_lt_u32 s41,19456
s_cselect_b32 s46,s32,s65
s_add_u32 s46,s46,4096
buffer_load_dwordx4 v[72:75],v1,s[4:7],s46 offen offset:2048 sc1
s_cmp_lt_u32 s41,18432
s_cselect_b32 s46,s32,s65
s_add_u32 s46,s46,4096
buffer_load_dwordx4 v[76:79],v1,s[4:7],s46 offen offset:3072 sc1
s_cmp_lt_u32 s41,17408
s_cselect_b32 s46,s32,s65
s_add_u32 s46,s46,8192
buffer_load_dwordx4 v[80:83],v1,s[4:7],s46 offen sc1
s_cmp_lt_u32 s41,16384
s_cselect_b32 s46,s32,s65
s_add_u32 s46,s46,8192
buffer_load_dwordx4 v[84:87],v1,s[4:7],s46 offen offset:1024 sc1
s_cmp_lt_u32 s41,15360
s_cselect_b32 s46,s32,s65
s_add_u32 s46,s46,8192
buffer_load_dwordx4 v[88:91],v1,s[4:7],s46 offen offset:2048 sc1
s_cmp_lt_u32 s41,14336
s_cselect_b32 s46,s32,s65
s_add_u32 s46,s46,8192
buffer_load_dwordx4 v[92:95],v1,s[4:7],s46 offen offset:3072 sc1
s_cmp_lt_u32 s41,13312
s_cselect_b32 s46,s32,s65
s_add_u32 s46,s46,12288
buffer_load_dwordx4 v[96:99],v1,s[4:7],s46 offen sc1
s_cmp_lt_u32 s41,12288
s_cselect_b32 s46,s32,s65
s_add_u32 s46,s46,12288
buffer_load_dwordx4 v[100:103],v1,s[4:7],s46 offen offset:1024 sc1
ks_top_410:
s_cmp_ge_u32 s28,s67
s_cbranch_scc1 L_end
s_cmp_eq_u32 s28,64
s_cselect_b32 s39,1,s39
s_cselect_b32 s46,3096576,0
s_add_u32 s33,s33,s46
s_add_u32 s31,s28,2
s_mov_b32 s29,0
s_and_b32 s69,s28,7
s_cmp_eq_u32 s69,7
s_cselect_b32 s69,-7,1
s_mul_i32 s68,s69,110592
s_mul_i32 s69,s69,49152
v_cmp_le_u32 vcc,s31,v6
s_nop 0
s_cmp_eq_u64 vcc,-1
s_cselect_b32 s35,1,0
s_waitcnt vmcnt(13)
v_mfma_f32_32x32x16_bf16 v[16:31],a[0:3],v[48:51],0
s_cmp_lt_u32 s41,11264
s_cselect_b32 s46,s32,s65
s_add_u32 s46,s46,12288
buffer_load_dwordx4 v[104:107],v1,s[4:7],s46 offen offset:2048 sc1
v_mfma_f32_32x32x16_bf16 v[32:47],a[100:103],v[48:51],0
s_cmp_lg_u32 s35,0
s_cbranch_scc1 ks_cp_417
buffer_load_dword v6,v2,s[4:7],0 offen sc1
ks_cp_417:
buffer_load_dwordx4 v[148:151],v1,s[24:27],s33 offen sc1
buffer_load_dwordx4 v[152:155],v1,s[24:27],s33 offen offset:1024 sc1
buffer_load_dwordx4 v[156:159],v1,s[24:27],s34 offen sc1
buffer_load_dwordx4 v[160:163],v1,s[24:27],s34 offen offset:1024 sc1
s_waitcnt vmcnt(13)
v_mfma_f32_32x32x16_bf16 v[16:31],a[4:7],v[52:55],v[16:31]
s_cmp_lt_u32 s41,10240
s_cselect_b32 s46,s32,s65
s_add_u32 s46,s46,12288
buffer_load_dwordx4 v[108:111],v1,s[4:7],s46 offen offset:3072 sc1
v_mfma_f32_32x32x16_bf16 v[32:47],a[104:107],v[52:55],v[32:47]
s_waitcnt vmcnt(13)
v_mfma_f32_32x32x16_bf16 v[16:31],a[8:11],v[56:59],v[16:31]
s_cmp_lt_u32 s41,9216
s_cselect_b32 s46,s32,s65
s_add_u32 s46,s46,16384
buffer_load_dwordx4 v[112:115],v1,s[4:7],s46 offen sc1
v_mfma_f32_32x32x16_bf16 v[32:47],a[108:111],v[56:59],v[32:47]
s_waitcnt vmcnt(13)
v_mfma_f32_32x32x16_bf16 v[16:31],a[12:15],v[60:63],v[16:31]
s_cmp_lt_u32 s41,8192
s_cselect_b32 s46,s32,s65
s_add_u32 s46,s46,16384
buffer_load_dwordx4 v[116:119],v1,s[4:7],s46 offen offset:1024 sc1
v_mfma_f32_32x32x16_bf16 v[32:47],a[112:115],v[60:63],v[32:47]
s_waitcnt vmcnt(13)
v_mfma_f32_32x32x16_bf16 v[16:31],a[16:19],v[64:67],v[16:31]
s_cmp_lt_u32 s41,7168
s_cselect_b32 s46,s32,s65
s_add_u32 s46,s46,16384
buffer_load_dwordx4 v[120:123],v1,s[4:7],s46 offen offset:2048 sc1
v_mfma_f32_32x32x16_bf16 v[32:47],a[116:119],v[64:67],v[32:47]
s_waitcnt vmcnt(13)
v_mfma_f32_32x32x16_bf16 v[16:31],a[20:23],v[68:71],v[16:31]
s_cmp_lt_u32 s41,6144
s_cselect_b32 s46,s32,s65
s_add_u32 s46,s46,16384
buffer_load_dwordx4 v[124:127],v1,s[4:7],s46 offen offset:3072 sc1
v_mfma_f32_32x32x16_bf16 v[32:47],a[120:123],v[68:71],v[32:47]
s_waitcnt vmcnt(13)
v_mfma_f32_32x32x16_bf16 v[16:31],a[24:27],v[72:75],v[16:31]
s_cmp_lt_u32 s41,5120
s_cselect_b32 s46,s32,s65
s_add_u32 s46,s46,20480
buffer_load_dwordx4 v[128:131],v1,s[4:7],s46 offen sc1
v_mfma_f32_32x32x16_bf16 v[32:47],a[124:127],v[72:75],v[32:47]
s_waitcnt vmcnt(13)
v_mfma_f32_32x32x16_bf16 v[16:31],a[28:31],v[76:79],v[16:31]
s_cmp_lt_u32 s41,4096
s_cselect_b32 s46,s32,s65
s_add_u32 s46,s46,20480
buffer_load_dwordx4 v[132:135],v1,s[4:7],s46 offen offset:1024 sc1
v_mfma_f32_32x32x16_bf16 v[32:47],a[128:131],v[76:79],v[32:47]
s_waitcnt vmcnt(13)
v_mfma_f32_32x32x16_bf16 v[16:31],a[32:35],v[80:83],v[16:31]
s_cmp_lt_u32 s41,3072
s_cselect_b32 s46,s32,s65
s_add_u32 s46,s46,20480
buffer_load_dwordx4 v[136:139],v1,s[4:7],s46 offen offset:2048 sc1
v_mfma_f32_32x32x16_bf16 v[32:47],a[132:135],v[80:83],v[32:47]
s_cmp_eq_u32 s30,0
s_cbranch_scc1 ks_np_418
s_waitcnt vmcnt(15)
v_mov_b32 v14,s28
s_mov_b64 exec,1
buffer_store_dword v14,off,s[4:7],s37 sc1
s_mov_b64 exec,-1
s_mov_b32 s30,0
ks_np_418:
s_waitcnt vmcnt(13)
v_mfma_f32_32x32x16_bf16 v[16:31],a[36:39],v[84:87],v[16:31]
s_cmp_lt_u32 s41,2048
s_cselect_b32 s46,s32,s65
s_add_u32 s46,s46,20480
buffer_load_dwordx4 v[140:143],v1,s[4:7],s46 offen offset:3072 sc1
v_mfma_f32_32x32x16_bf16 v[32:47],a[136:139],v[84:87],v[32:47]
s_waitcnt vmcnt(13)
v_mfma_f32_32x32x16_bf16 v[16:31],a[40:43],v[88:91],v[16:31]
s_cmp_lt_u32 s41,1024
s_cselect_b32 s46,s32,s65
s_add_u32 s46,s46,24576
buffer_load_dwordx4 v[144:147],v1,s[4:7],s46 offen sc1
v_mfma_f32_32x32x16_bf16 v[32:47],a[140:143],v[88:91],v[32:47]
s_waitcnt vmcnt(14)
v_cmp_le_u32 vcc,s31,v6
s_nop 0
s_cmp_eq_u64 vcc,-1
s_cbranch_scc0 ks_n_415
s_mov_b32 s29,1
s_waitcnt vmcnt(13)
v_mfma_f32_32x32x16_bf16 v[16:31],a[44:47],v[92:95],v[16:31]
s_cmp_lt_u32 s41,25600
s_cselect_b32 s46,s32,s65
s_add_u32 s46,s46,0
s_add_u32 s46,s46,s68
buffer_load_dwordx4 v[48:51],v1,s[4:7],s46 offen sc1
v_mfma_f32_32x32x16_bf16 v[32:47],a[144:147],v[92:95],v[32:47]
s_waitcnt vmcnt(13)
v_mfma_f32_32x32x16_bf16 v[16:31],a[48:51],v[96:99],v[16:31]
s_cmp_lt_u32 s41,24576
s_cselect_b32 s46,s32,s65
s_add_u32 s46,s46,0
s_add_u32 s46,s46,s68
buffer_load_dwordx4 v[52:55],v1,s[4:7],s46 offen offset:1024 sc1
v_mfma_f32_32x32x16_bf16 v[32:47],a[148:151],v[96:99],v[32:47]
s_waitcnt vmcnt(13)
v_mfma_f32_32x32x16_bf16 v[16:31],a[52:55],v[100:103],v[16:31]
s_cmp_lt_u32 s41,23552
s_cselect_b32 s46,s32,s65
s_add_u32 s46,s46,0
s_add_u32 s46,s46,s68
buffer_load_dwordx4 v[56:59],v1,s[4:7],s46 offen offset:2048 sc1
v_mfma_f32_32x32x16_bf16 v[32:47],a[152:155],v[100:103],v[32:47]
s_waitcnt vmcnt(13)
v_mfma_f32_32x32x16_bf16 v[16:31],a[56:59],v[104:107],v[16:31]
s_cmp_lt_u32 s41,22528
s_cselect_b32 s46,s32,s65
s_add_u32 s46,s46,0
s_add_u32 s46,s46,s68
buffer_load_dwordx4 v[60:63],v1,s[4:7],s46 offen offset:3072 sc1
v_mfma_f32_32x32x16_bf16 v[32:47],a[156:159],v[104:107],v[32:47]
s_waitcnt vmcnt(13)
v_mfma_f32_32x32x16_bf16 v[16:31],a[60:63],v[108:111],v[16:31]
s_cmp_lt_u32 s41,21504
s_cselect_b32 s46,s32,s65
s_add_u32 s46,s46,4096
s_add_u32 s46,s46,s68
buffer_load_dwordx4 v[64:67],v1,s[4:7],s46 offen sc1
v_lshlrev_b32 v180,16,v148
v_mfma_f32_32x32x16_bf16 v[32:47],a[160:163],v[108:111],v[32:47]
v_and_b32 v181,0xffff0000,v148
v_lshlrev_b32 v182,16,v149
v_and_b32 v183,0xffff0000,v149
v_lshlrev_b32 v184,16,v150
s_waitcnt vmcnt(13)
v_mfma_f32_32x32x16_bf16 v[16:31],a[64:67],v[112:115],v[16:31]
s_cmp_lt_u32 s41,20480
s_cselect_b32 s46,s32,s65
s_add_u32 s46,s46,4096
s_add_u32 s46,s46,s68
buffer_load_dwordx4 v[68:71],v1,s[4:7],s46 offen offset:1024 sc1
v_and_b32 v185,0xffff0000,v150
v_mfma_f32_32x32x16_bf16 v[32:47],a[164:167],v[112:115],v[32:47]
v_lshlrev_b32 v186,16,v151
v_and_b32 v187,0xffff0000,v151
v_lshlrev_b32 v188,16,v152
v_and_b32 v189,0xffff0000,v152
s_waitcnt vmcnt(13)
v_mfma_f32_32x32x16_bf16 v[16:31],a[68:71],v[116:119],v[16:31]
s_cmp_lt_u32 s41,19456
s_cselect_b32 s46,s32,s65
s_add_u32 s46,s46,4096
s_add_u32 s46,s46,s68
buffer_load_dwordx4 v[72:75],v1,s[4:7],s46 offen offset:2048 sc1
v_lshlrev_b32 v190,16,v153
v_mfma_f32_32x32x16_bf16 v[32:47],a[168:171],v[116:119],v[32:47]
v_and_b32 v191,0xffff0000,v153
v_lshlrev_b32 v192,16,v154
v_and_b32 v193,0xffff0000,v154
v_lshlrev_b32 v194,16,v155
s_waitcnt vmcnt(13)
v_mfma_f32_32x32x16_bf16 v[16:31],a[72:75],v[120:123],v[16:31]
s_cmp_lt_u32 s41,18432
s_cselect_b32 s46,s32,s65
s_add_u32 s46,s46,4096
s_add_u32 s46,s46,s68
buffer_load_dwordx4 v[76:79],v1,s[4:7],s46 offen offset:3072 sc1
v_and_b32 v195,0xffff0000,v155
v_mfma_f32_32x32x16_bf16 v[32:47],a[172:175],v[120:123],v[32:47]
v_lshlrev_b32 v12,16,v156
v_and_b32 v13,0xffff0000,v156
v_add_f32 v180,v180,v12
v_add_f32 v181,v181,v13
s_waitcnt vmcnt(13)
v_mfma_f32_32x32x16_bf16 v[16:31],a[76:79],v[124:127],v[16:31]
s_cmp_lt_u32 s41,17408
s_cselect_b32 s46,s32,s65
s_add_u32 s46,s46,8192
s_add_u32 s46,s46,s68
buffer_load_dwordx4 v[80:83],v1,s[4:7],s46 offen sc1
v_lshlrev_b32 v12,16,v157
v_mfma_f32_32x32x16_bf16 v[32:47],a[176:179],v[124:127],v[32:47]
v_and_b32 v13,0xffff0000,v157
v_add_f32 v182,v182,v12
v_add_f32 v183,v183,v13
v_lshlrev_b32 v12,16,v158
s_waitcnt vmcnt(13)
v_mfma_f32_32x32x16_bf16 v[16:31],a[80:83],v[128:131],v[16:31]
s_cmp_lt_u32 s41,16384
s_cselect_b32 s46,s32,s65
s_add_u32 s46,s46,8192
s_add_u32 s46,s46,s68
buffer_load_dwordx4 v[84:87],v1,s[4:7],s46 offen offset:1024 sc1
v_and_b32 v13,0xffff0000,v158
v_mfma_f32_32x32x16_bf16 v[32:47],a[180:183],v[128:131],v[32:47]
v_add_f32 v184,v184,v12
v_add_f32 v185,v185,v13
v_lshlrev_b32 v12,16,v159
v_and_b32 v13,0xffff0000,v159
s_waitcnt vmcnt(13)
v_mfma_f32_32x32x16_bf16 v[16:31],a[84:87],v[132:135],v[16:31]
s_cmp_lt_u32 s41,15360
s_cselect_b32 s46,s32,s65
s_add_u32 s46,s46,8192
s_add_u32 s46,s46,s68
buffer_load_dwordx4 v[88:91],v1,s[4:7],s46 offen offset:2048 sc1
v_add_f32 v186,v186,v12
v_mfma_f32_32x32x16_bf16 v[32:47],a[184:187],v[132:135],v[32:47]
v_add_f32 v187,v187,v13
v_lshlrev_b32 v12,16,v160
v_and_b32 v13,0xffff0000,v160
v_add_f32 v188,v188,v12
s_waitcnt vmcnt(13)
v_mfma_f32_32x32x16_bf16 v[16:31],a[88:91],v[136:139],v[16:31]
s_cmp_lt_u32 s41,14336
s_cselect_b32 s46,s32,s65
s_add_u32 s46,s46,8192
s_add_u32 s46,s46,s68
buffer_load_dwordx4 v[92:95],v1,s[4:7],s46 offen offset:3072 sc1
v_add_f32 v189,v189,v13
v_mfma_f32_32x32x16_bf16 v[32:47],a[188:191],v[136:139],v[32:47]
v_lshlrev_b32 v12,16,v161
v_and_b32 v13,0xffff0000,v161
v_add_f32 v190,v190,v12
v_add_f32 v191,v191,v13
s_waitcnt vmcnt(13)
v_mfma_f32_32x32x16_bf16 v[16:31],a[92:95],v[140:143],v[16:31]
s_cmp_lt_u32 s41,13312
s_cselect_b32 s46,s32,s65
s_add_u32 s46,s46,12288
s_add_u32 s46,s46,s68
buffer_load_dwordx4 v[96:99],v1,s[4:7],s46 offen sc1
v_lshlrev_b32 v12,16,v162
v_mfma_f32_32x32x16_bf16 v[32:47],a[192:195],v[140:143],v[32:47]
v_and_b32 v13,0xffff0000,v162
v_add_f32 v192,v192,v12
v_add_f32 v193,v193,v13
v_lshlrev_b32 v12,16,v163
s_waitcnt vmcnt(13)
v_mfma_f32_32x32x16_bf16 v[32:47],a[196:199],v[144:147],v[32:47]
v_and_b32 v13,0xffff0000,v163
v_add_f32 v194,v194,v12
v_add_f32 v195,v195,v13
v_mfma_f32_32x32x16_bf16 v[16:31],a[96:99],v[144:147],v[16:31]
s_cmp_lt_u32 s41,12288
s_cselect_b32 s46,s32,s65
s_add_u32 s46,s46,12288
s_add_u32 s46,s46,s68
buffer_load_dwordx4 v[100:103],v1,s[4:7],s46 offen offset:1024 sc1
s_branch ks_j_416
ks_n_415:
s_waitcnt vmcnt(13)
v_mfma_f32_32x32x16_bf16 v[16:31],a[44:47],v[92:95],v[16:31]
v_mfma_f32_32x32x16_bf16 v[32:47],a[144:147],v[92:95],v[32:47]
s_waitcnt vmcnt(12)
v_mfma_f32_32x32x16_bf16 v[16:31],a[48:51],v[96:99],v[16:31]
v_mfma_f32_32x32x16_bf16 v[32:47],a[148:151],v[96:99],v[32:47]
s_waitcnt vmcnt(11)
v_mfma_f32_32x32x16_bf16 v[16:31],a[52:55],v[100:103],v[16:31]
v_mfma_f32_32x32x16_bf16 v[32:47],a[152:155],v[100:103],v[32:47]
s_waitcnt vmcnt(10)
v_mfma_f32_32x32x16_bf16 v[16:31],a[56:59],v[104:107],v[16:31]
v_mfma_f32_32x32x16_bf16 v[32:47],a[156:159],v[104:107],v[32:47]
s_waitcnt vmcnt(9)
v_mfma_f32_32x32x16_bf16 v[16:31],a[60:63],v[108:111],v[16:31]
v_lshlrev_b32 v180,16,v148
v_and_b32 v181,0xffff0000,v148
v_lshlrev_b32 v182,16,v149
v_and_b32 v183,0xffff0000,v149
v_mfma_f32_32x32x16_bf16 v[32:47],a[160:163],v[108:111],v[32:47]
v_lshlrev_b32 v184,16,v150
v_and_b32 v185,0xffff0000,v150
v_lshlrev_b32 v186,16,v151
v_and_b32 v187,0xffff0000,v151
s_waitcnt vmcnt(8)
v_mfma_f32_32x32x16_bf16 v[16:31],a[64:67],v[112:115],v[16:31]
v_lshlrev_b32 v188,16,v152
v_and_b32 v189,0xffff0000,v152
v_lshlrev_b32 v190,16,v153
v_and_b32 v191,0xffff0000,v153
v_mfma_f32_32x32x16_bf16 v[32:47],a[164:167],v[112:115],v[32:47]
v_lshlrev_b32 v192,16,v154
v_and_b32 v193,0xffff0000,v154
v_lshlrev_b32 v194,16,v155
v_and_b32 v195,0xffff0000,v155
s_waitcnt vmcnt(7)
v_mfma_f32_32x32x16_bf16 v[16:31],a[68:71],v[116:119],v[16:31]
v_lshlrev_b32 v12,16,v156
v_and_b32 v13,0xffff0000,v156
v_add_f32 v180,v180,v12
v_add_f32 v181,v181,v13
v_mfma_f32_32x32x16_bf16 v[32:47],a[168:171],v[116:119],v[32:47]
v_lshlrev_b32 v12,16,v157
v_and_b32 v13,0xffff0000,v157
v_add_f32 v182,v182,v12
v_add_f32 v183,v183,v13
s_waitcnt vmcnt(6)
v_mfma_f32_32x32x16_bf16 v[16:31],a[72:75],v[120:123],v[16:31]
v_lshlrev_b32 v12,16,v158
v_and_b32 v13,0xffff0000,v158
v_add_f32 v184,v184,v12
v_add_f32 v185,v185,v13
v_mfma_f32_32x32x16_bf16 v[32:47],a[172:175],v[120:123],v[32:47]
v_lshlrev_b32 v12,16,v159
v_and_b32 v13,0xffff0000,v159
v_add_f32 v186,v186,v12
v_add_f32 v187,v187,v13
s_waitcnt vmcnt(5)
v_mfma_f32_32x32x16_bf16 v[16:31],a[76:79],v[124:127],v[16:31]
v_lshlrev_b32 v12,16,v160
v_and_b32 v13,0xffff0000,v160
v_add_f32 v188,v188,v12
v_add_f32 v189,v189,v13
v_mfma_f32_32x32x16_bf16 v[32:47],a[176:179],v[124:127],v[32:47]
v_lshlrev_b32 v12,16,v161
v_and_b32 v13,0xffff0000,v161
v_add_f32 v190,v190,v12
v_add_f32 v191,v191,v13
s_waitcnt vmcnt(4)
v_mfma_f32_32x32x16_bf16 v[16:31],a[80:83],v[128:131],v[16:31]
v_lshlrev_b32 v12,16,v162
v_and_b32 v13,0xffff0000,v162
v_add_f32 v192,v192,v12
v_add_f32 v193,v193,v13
v_mfma_f32_32x32x16_bf16 v[32:47],a[180:183],v[128:131],v[32:47]
v_lshlrev_b32 v12,16,v163
v_and_b32 v13,0xffff0000,v163
v_add_f32 v194,v194,v12
v_add_f32 v195,v195,v13
s_waitcnt vmcnt(3)
v_mfma_f32_32x32x16_bf16 v[16:31],a[84:87],v[132:135],v[16:31]
v_mfma_f32_32x32x16_bf16 v[32:47],a[184:187],v[132:135],v[32:47]
s_waitcnt vmcnt(2)
v_mfma_f32_32x32x16_bf16 v[16:31],a[88:91],v[136:139],v[16:31]
v_mfma_f32_32x32x16_bf16 v[32:47],a[188:191],v[136:139],v[32:47]
s_waitcnt vmcnt(1)
v_mfma_f32_32x32x16_bf16 v[16:31],a[92:95],v[140:143],v[16:31]
v_mfma_f32_32x32x16_bf16 v[32:47],a[192:195],v[140:143],v[32:47]
s_waitcnt vmcnt(0)
v_mfma_f32_32x32x16_bf16 v[32:47],a[196:199],v[144:147],v[32:47]
v_mfma_f32_32x32x16_bf16 v[16:31],a[96:99],v[144:147],v[16:31]
s_nop 11
ks_j_416:
s_nop 7
s_nop 1
s_add_u32 s32,s32,s68
s_add_u32 s65,s65,s68
v_xor_b32 v12,0x4000,v8
ds_write_b128 v12,v[32:35]
ds_write_b128 v12,v[36:39] offset:1024
ds_write_b128 v12,v[40:43] offset:2048
ds_write_b128 v12,v[44:47] offset:3072
v_pk_add_f32 v[16:17],v[16:17],v[180:181]
v_pk_add_f32 v[18:19],v[18:19],v[182:183]
v_pk_add_f32 v[20:21],v[20:21],v[184:185]
v_pk_add_f32 v[22:23],v[22:23],v[186:187]
v_pk_add_f32 v[24:25],v[24:25],v[188:189]
v_pk_add_f32 v[26:27],v[26:27],v[190:191]
v_pk_add_f32 v[28:29],v[28:29],v[192:193]
v_pk_add_f32 v[30:31],v[30:31],v[194:195]
v_xor_b32 v12,0x1000,v8
s_waitcnt lgkmcnt(0)
s_barrier
ds_read_b128 v[32:35],v12
ds_read_b128 v[36:39],v12 offset:1024
ds_read_b128 v[40:43],v12 offset:2048
ds_read_b128 v[44:47],v12 offset:3072
ds_read_b128 v[180:183],v9 offset:8192
ds_read_b128 v[184:187],v9 offset:9216
ds_read_b128 v[188:191],v9 offset:10240
ds_read_b128 v[192:195],v9 offset:11264
ds_read_b128 v[196:199],v9 offset:12288
ds_read_b128 v[200:203],v9 offset:13312
ds_read_b128 v[204:207],v9 offset:14336
ds_read_b128 v[208:211],v9 offset:15360
s_add_u32 s46,s28,1
v_mov_b32 v14,s46
s_mov_b64 exec,1
s_cmp_eq_u32 s21,0
s_cbranch_scc1 ls_420
buffer_store_dword v14,off,s[4:7],s66
ls_421:
s_mov_b64 exec,-1
s_cmp_lg_u32 s29,0
s_cbranch_scc1 ks_cp_422
buffer_load_dword v6,v2,s[4:7],0 offen sc1
ks_cp_422:
s_waitcnt lgkmcnt(8)
v_pk_add_f32 v[16:17],v[16:17],v[32:33]
v_pk_add_f32 v[18:19],v[18:19],v[34:35]
v_pk_add_f32 v[20:21],v[20:21],v[36:37]
v_pk_add_f32 v[22:23],v[22:23],v[38:39]
v_pk_add_f32 v[24:25],v[24:25],v[40:41]
v_pk_add_f32 v[26:27],v[26:27],v[42:43]
v_pk_add_f32 v[28:29],v[28:29],v[44:45]
v_pk_add_f32 v[30:31],v[30:31],v[46:47]
s_waitcnt lgkmcnt(4)
v_pk_add_f32 v[16:17],v[16:17],v[180:181]
v_pk_add_f32 v[18:19],v[18:19],v[182:183]
v_pk_add_f32 v[20:21],v[20:21],v[184:185]
v_pk_add_f32 v[22:23],v[22:23],v[186:187]
v_pk_add_f32 v[24:25],v[24:25],v[188:189]
v_pk_add_f32 v[26:27],v[26:27],v[190:191]
v_pk_add_f32 v[28:29],v[28:29],v[192:193]
v_pk_add_f32 v[30:31],v[30:31],v[194:195]
s_waitcnt lgkmcnt(0)
v_pk_add_f32 v[16:17],v[16:17],v[196:197]
v_pk_add_f32 v[18:19],v[18:19],v[198:199]
v_pk_add_f32 v[20:21],v[20:21],v[200:201]
v_pk_add_f32 v[22:23],v[22:23],v[202:203]
v_pk_add_f32 v[24:25],v[24:25],v[204:205]
v_pk_add_f32 v[26:27],v[26:27],v[206:207]
v_pk_add_f32 v[28:29],v[28:29],v[208:209]
v_pk_add_f32 v[30:31],v[30:31],v[210:211]
v_cvt_pk_bf16_f32 v32,v16,v17
v_cvt_pk_bf16_f32 v33,v18,v19
v_cvt_pk_bf16_f32 v34,v20,v21
v_cvt_pk_bf16_f32 v35,v22,v23
v_cvt_pk_bf16_f32 v36,v24,v25
v_cvt_pk_bf16_f32 v37,v26,v27
v_cvt_pk_bf16_f32 v38,v28,v29
v_cvt_pk_bf16_f32 v39,v30,v31
s_cmp_eq_u32 s39,0
s_cbranch_scc1 ks_l0_423
s_min_u32 s46,s28,63
s_mul_i32 s46,s46,40960
s_add_u32 s46,s46,s62
v_permlane32_swap_b32 v32,v34
v_permlane32_swap_b32 v33,v35
buffer_store_dwordx4 v[32:35],v11,s[8:11],s46 offen
v_permlane32_swap_b32 v36,v38
v_permlane32_swap_b32 v37,v39
buffer_store_dwordx4 v[36:39],v11,s[8:11],s46 offen offset:32
s_cmp_lg_u32 s29,0
s_cbranch_scc1 ks_nf_419
s_waitcnt vmcnt(2)
s_branch ks_nf_419
ks_l0_423:
buffer_store_dwordx4 v[32:35],v1,s[4:7],s36 offen sc1
buffer_store_dwordx4 v[36:39],v1,s[4:7],s36 offen offset:1024 sc1
v_pk_add_f32 v[196:197],v[16:17],v[24:25]
v_pk_add_f32 v[198:199],v[18:19],v[26:27]
v_pk_add_f32 v[200:201],v[20:21],v[28:29]
v_pk_add_f32 v[202:203],v[22:23],v[30:31]
v_pk_add_f32 v[196:197],v[196:197],v[198:199]
v_pk_add_f32 v[200:201],v[200:201],v[202:203]
v_pk_mul_f32 v[198:199],v[16:17],v[16:17]
v_pk_mul_f32 v[202:203],v[18:19],v[18:19]
v_pk_add_f32 v[196:197],v[196:197],v[200:201]
v_pk_fma_f32 v[198:199],v[20:21],v[20:21],v[198:199]
v_pk_fma_f32 v[202:203],v[22:23],v[22:23],v[202:203]
v_pk_fma_f32 v[198:199],v[24:25],v[24:25],v[198:199]
v_pk_fma_f32 v[202:203],v[26:27],v[26:27],v[202:203]
v_pk_fma_f32 v[198:199],v[28:29],v[28:29],v[198:199]
v_pk_fma_f32 v[202:203],v[30:31],v[30:31],v[202:203]
v_add_f32 v12,v196,v197
v_pk_add_f32 v[198:199],v[198:199],v[202:203]
v_mov_b32 v196,v12
v_add_f32 v13,v198,v199
v_mov_b32 v197,v13
v_permlane32_swap_b32 v12,v196
s_nop 0
v_permlane32_swap_b32 v13,v197
s_nop 0
v_pk_add_f32 v[12:13],v[12:13],v[196:197]
buffer_store_dwordx2 v[12:13],v10,s[4:7],s63 offen sc1
s_mov_b32 s30,1
s_cmp_lg_u32 s29,0
s_cbranch_scc1 ks_nf_419
s_waitcnt vmcnt(3)
ks_nf_419:
s_add_u32 s33,s33,49152
s_add_u32 s36,s36,49152
s_add_u32 s63,s63,49152
s_add_u32 s34,s34,s69
s_add_u32 s28,s28,1
v_xor_b32 v8,32768,v8
v_xor_b32 v9,32768,v9
buffer_load_dwordx4 v[148:151],v1,s[24:27],s33 offen sc1
buffer_load_dwordx4 v[152:155],v1,s[24:27],s33 offen offset:1024 sc1
s_cmp_lg_u32 s29,0
s_cbranch_scc1 ks_top_410
v_cmp_le_u32 vcc,s31,v6
s_nop 0
s_cmp_eq_u64 vcc,-1
s_nop 1
s_cbranch_scc0 ks_np2_425
s_cmp_lt_u32 s41,25600
s_cselect_b32 s46,s32,s65
s_add_u32 s46,s46,0
buffer_load_dwordx4 v[48:51],v1,s[4:7],s46 offen sc1
s_cmp_lt_u32 s41,24576
s_cselect_b32 s46,s32,s65
s_add_u32 s46,s46,0
buffer_load_dwordx4 v[52:55],v1,s[4:7],s46 offen offset:1024 sc1
s_cmp_lt_u32 s41,23552
s_cselect_b32 s46,s32,s65
s_add_u32 s46,s46,0
buffer_load_dwordx4 v[56:59],v1,s[4:7],s46 offen offset:2048 sc1
s_cmp_lt_u32 s41,22528
s_cselect_b32 s46,s32,s65
s_add_u32 s46,s46,0
buffer_load_dwordx4 v[60:63],v1,s[4:7],s46 offen offset:3072 sc1
s_cmp_lt_u32 s41,21504
s_cselect_b32 s46,s32,s65
s_add_u32 s46,s46,4096
buffer_load_dwordx4 v[64:67],v1,s[4:7],s46 offen sc1
s_cmp_lt_u32 s41,20480
s_cselect_b32 s46,s32,s65
s_add_u32 s46,s46,4096
buffer_load_dwordx4 v[68:71],v1,s[4:7],s46 offen offset:1024 sc1
s_cmp_eq_u32 s30,0
s_cbranch_scc1 ks_pb_426
s_waitcnt vmcnt(8)
v_mov_b32 v14,s28
s_mov_b64 exec,1
buffer_store_dword v14,off,s[4:7],s37 sc1
s_mov_b64 exec,-1
s_mov_b32 s30,0
ks_pb_426:
s_cmp_lt_u32 s41,19456
s_cselect_b32 s46,s32,s65
s_add_u32 s46,s46,4096
buffer_load_dwordx4 v[72:75],v1,s[4:7],s46 offen offset:2048 sc1
s_cmp_lt_u32 s41,18432
s_cselect_b32 s46,s32,s65
s_add_u32 s46,s46,4096
buffer_load_dwordx4 v[76:79],v1,s[4:7],s46 offen offset:3072 sc1
s_cmp_lt_u32 s41,17408
s_cselect_b32 s46,s32,s65
s_add_u32 s46,s46,8192
buffer_load_dwordx4 v[80:83],v1,s[4:7],s46 offen sc1
s_cmp_lt_u32 s41,16384
s_cselect_b32 s46,s32,s65
s_add_u32 s46,s46,8192
buffer_load_dwordx4 v[84:87],v1,s[4:7],s46 offen offset:1024 sc1
s_cmp_lt_u32 s41,15360
s_cselect_b32 s46,s32,s65
s_add_u32 s46,s46,8192
buffer_load_dwordx4 v[88:91],v1,s[4:7],s46 offen offset:2048 sc1
s_cmp_lt_u32 s41,14336
s_cselect_b32 s46,s32,s65
s_add_u32 s46,s46,8192
buffer_load_dwordx4 v[92:95],v1,s[4:7],s46 offen offset:3072 sc1
s_cmp_lt_u32 s41,13312
s_cselect_b32 s46,s32,s65
s_add_u32 s46,s46,12288
buffer_load_dwordx4 v[96:99],v1,s[4:7],s46 offen sc1
s_cmp_lt_u32 s41,12288
s_cselect_b32 s46,s32,s65
s_add_u32 s46,s46,12288
buffer_load_dwordx4 v[100:103],v1,s[4:7],s46 offen offset:1024 sc1
s_branch ks_top_410
ks_np2_425:
s_cmp_eq_u32 s30,0
s_cbranch_scc1 ks_nop_428
buffer_load_dword v6,v2,s[4:7],0 offen sc1
s_cmp_eq_u32 s30,0
s_cbranch_scc1 ks_pb_429
s_waitcnt vmcnt(3)
v_mov_b32 v14,s28
s_mov_b64 exec,1
buffer_store_dword v14,off,s[4:7],s37 sc1
s_mov_b64 exec,-1
s_mov_b32 s30,0
ks_pb_429:
s_waitcnt vmcnt(1)
v_cmp_le_u32 vcc,s31,v6
s_nop 0
s_cmp_eq_u64 vcc,-1
s_nop 1
s_cbranch_scc1 ks_rdy_427
ks_nop_428:
s_cmp_ge_u32 s28,s67
s_cbranch_scc1 ks_fin_411
s_mov_b32 s38,0
poll_430:
buffer_load_dword v6,v2,s[4:7],0 offen sc1
s_waitcnt vmcnt(0)
v_cmp_le_u32 vcc,s31,v6
s_nop 0
s_cmp_eq_u64 vcc,-1
s_nop 1
s_cbranch_scc1 polld_431
s_sleep 2
s_add_u32 s38,s38,1
s_cmp_lt_u32 s38,100000
s_cbranch_scc1 poll_430
s_mov_b32 s40,12
s_branch L_fail
polld_431:
ks_rdy_427:
s_cmp_lt_u32 s41,25600
s_cselect_b32 s46,s32,s65
s_add_u32 s46,s46,0
buffer_load_dwordx4 v[48:51],v1,s[4:7],s46 offen sc1
s_cmp_lt_u32 s41,24576
s_cselect_b32 s46,s32,s65
s_add_u32 s46,s46,0
buffer_load_dwordx4 v[52:55],v1,s[4:7],s46 offen offset:1024 sc1
s_cmp_lt_u32 s41,23552
s_cselect_b32 s46,s32,s65
s_add_u32 s46,s46,0
buffer_load_dwordx4 v[56:59],v1,s[4:7],s46 offen offset:2048 sc1
s_cmp_lt_u32 s41,22528
s_cselect_b32 s46,s32,s65
s_add_u32 s46,s46,0
buffer_load_dwordx4 v[60:63],v1,s[4:7],s46 offen offset:3072 sc1
s_cmp_lt_u32 s41,21504
s_cselect_b32 s46,s32,s65
s_add_u32 s46,s46,4096
buffer_load_dwordx4 v[64:67],v1,s[4:7],s46 offen sc1
s_cmp_lt_u32 s41,20480
s_cselect_b32 s46,s32,s65
s_add_u32 s46,s46,4096
buffer_load_dwordx4 v[68:71],v1,s[4:7],s46 offen offset:1024 sc1
s_cmp_lt_u32 s41,19456
s_cselect_b32 s46,s32,s65
s_add_u32 s46,s46,4096
buffer_load_dwordx4 v[72:75],v1,s[4:7],s46 offen offset:2048 sc1
s_cmp_lt_u32 s41,18432
s_cselect_b32 s46,s32,s65
s_add_u32 s46,s46,4096
buffer_load_dwordx4 v[76:79],v1,s[4:7],s46 offen offset:3072 sc1
s_cmp_lt_u32 s41,17408
s_cselect_b32 s46,s32,s65
s_add_u32 s46,s46,8192
buffer_load_dwordx4 v[80:83],v1,s[4:7],s46 offen sc1
s_cmp_lt_u32 s41,16384
s_cselect_b32 s46,s32,s65
s_add_u32 s46,s46,8192
buffer_load_dwordx4 v[84:87],v1,s[4:7],s46 offen offset:1024 sc1
s_cmp_lt_u32 s41,15360
s_cselect_b32 s46,s32,s65
s_add_u32 s46,s46,8192
buffer_load_dwordx4 v[88:91],v1,s[4:7],s46 offen offset:2048 sc1
s_cmp_lt_u32 s41,14336
s_cselect_b32 s46,s32,s65
s_add_u32 s46,s46,8192
buffer_load_dwordx4 v[92:95],v1,s[4:7],s46 offen offset:3072 sc1
s_cmp_lt_u32 s41,13312
s_cselect_b32 s46,s32,s65
s_add_u32 s46,s46,12288
buffer_load_dwordx4 v[96:99],v1,s[4:7],s46 offen sc1
s_cmp_lt_u32 s41,12288
s_cselect_b32 s46,s32,s65
s_add_u32 s46,s46,12288
buffer_load_dwordx4 v[100:103],v1,s[4:7],s46 offen offset:1024 sc1
s_branch ks_top_410
ks_fin_411:
s_branch L_end
ks_hi_405:
v_lshlrev_b32 v1,4,v0
s_mov_b32 s24,s4
s_mov_b32 s25,s5
s_mov_b32 s26,s6
s_mov_b32 s27,0x20000
s_lshl_b32 s43,s42,1
s_mov_b32 s44,0
s_and_b32 s45,s3,1
s_mul_i32 s45,s45,29
s_lshl_b32 s46,s44,7
s_add_u32 s45,s45,s46
s_add_u32 s45,s45,50
s_and_b32 s48,s3,1
s_add_u32 s49,s43,s48
s_load_dwordx2 s[20:21],s[0:1],88
s_waitcnt lgkmcnt(0)
s_mov_b32 s16,s20
s_and_b32 s17,s21,0xffff
s_mov_b32 s18,0x21c000
s_mov_b32 s19,0x20000
s_lshl_b32 s46,s43,6
s_mul_i32 s64,s45,20480
s_add_u32 s64,s64,s46
s_mul_i32 s41,s42,11
s_mul_hi_u32 s46,s41,0x8d3dcb1
s_mul_i32 s47,s46,29
s_sub_u32 s41,s41,s47
v_lshrrev_b32 v18,3,v0
v_mul_u32_u24 v16,1280,v18
v_and_b32 v18,7,v0
v_lshl_add_u32 v16,v18,4,v16
v_and_b32 v18,3,v0
v_lshlrev_b32 v17,3,v18
v_bfe_u32 v18,v0,4,1
v_lshl_add_u32 v17,v18,5,v17
v_bfe_u32 v18,v0,2,2
v_lshl_add_u32 v17,v18,7,v17
v_lshrrev_b32 v18,5,v0
v_lshl_add_u32 v17,v18,9,v17
s_mul_i32 s22,s3,40960
v_add_u32 v17,s22,v17
s_lshl_b32 s23,s48,6
v_add_u32 v17,s23,v17
v_xor_b32 v18,64,v17
s_add_u32 s20,s41,-29
s_cselect_b32 s47,0,29
s_add_u32 s20,s20,s47
s_mul_i32 s20,s20,20480
s_add_u32 s20,s20,s64
s_add_u32 s23,s22,0
s_mov_b32 m0,s23
s_nop 0
buffer_load_dwordx4 v16,s[16:19],s20 offen lds
s_add_u32 s23,s22,1024
s_mov_b32 m0,s23
s_add_u32 s20,s20,10240
buffer_load_dwordx4 v16,s[16:19],s20 offen lds
s_add_u32 s20,s41,-28
s_cselect_b32 s47,0,29
s_add_u32 s20,s20,s47
s_mul_i32 s20,s20,20480
s_add_u32 s20,s20,s64
s_add_u32 s23,s22,2048
s_mov_b32 m0,s23
s_nop 0
buffer_load_dwordx4 v16,s[16:19],s20 offen lds
s_add_u32 s23,s22,3072
s_mov_b32 m0,s23
s_add_u32 s20,s20,10240
buffer_load_dwordx4 v16,s[16:19],s20 offen lds
s_add_u32 s20,s41,-27
s_cselect_b32 s47,0,29
s_add_u32 s20,s20,s47
s_mul_i32 s20,s20,20480
s_add_u32 s20,s20,s64
s_add_u32 s23,s22,4096
s_mov_b32 m0,s23
s_nop 0
buffer_load_dwordx4 v16,s[16:19],s20 offen lds
s_add_u32 s23,s22,5120
s_mov_b32 m0,s23
s_add_u32 s20,s20,10240
buffer_load_dwordx4 v16,s[16:19],s20 offen lds
s_add_u32 s20,s41,-26
s_cselect_b32 s47,0,29
s_add_u32 s20,s20,s47
s_mul_i32 s20,s20,20480
s_add_u32 s20,s20,s64
s_add_u32 s23,s22,6144
s_mov_b32 m0,s23
s_nop 0
buffer_load_dwordx4 v16,s[16:19],s20 offen lds
s_add_u32 s23,s22,7168
s_mov_b32 m0,s23
s_add_u32 s20,s20,10240
buffer_load_dwordx4 v16,s[16:19],s20 offen lds
s_add_u32 s20,s41,-25
s_cselect_b32 s47,0,29
s_add_u32 s20,s20,s47
s_mul_i32 s20,s20,20480
s_add_u32 s20,s20,s64
s_add_u32 s23,s22,8192
s_mov_b32 m0,s23
s_nop 0
buffer_load_dwordx4 v16,s[16:19],s20 offen lds
s_add_u32 s23,s22,9216
s_mov_b32 m0,s23
s_add_u32 s20,s20,10240
buffer_load_dwordx4 v16,s[16:19],s20 offen lds
s_add_u32 s20,s41,-24
s_cselect_b32 s47,0,29
s_add_u32 s20,s20,s47
s_mul_i32 s20,s20,20480
s_add_u32 s20,s20,s64
s_add_u32 s23,s22,10240
s_mov_b32 m0,s23
s_nop 0
buffer_load_dwordx4 v16,s[16:19],s20 offen lds
s_add_u32 s23,s22,11264
s_mov_b32 m0,s23
s_add_u32 s20,s20,10240
buffer_load_dwordx4 v16,s[16:19],s20 offen lds
s_add_u32 s20,s41,-23
s_cselect_b32 s47,0,29
s_add_u32 s20,s20,s47
s_mul_i32 s20,s20,20480
s_add_u32 s20,s20,s64
s_add_u32 s23,s22,12288
s_mov_b32 m0,s23
s_nop 0
buffer_load_dwordx4 v16,s[16:19],s20 offen lds
s_add_u32 s23,s22,13312
s_mov_b32 m0,s23
s_add_u32 s20,s20,10240
buffer_load_dwordx4 v16,s[16:19],s20 offen lds
s_add_u32 s20,s41,-22
s_cselect_b32 s47,0,29
s_add_u32 s20,s20,s47
s_mul_i32 s20,s20,20480
s_add_u32 s20,s20,s64
s_add_u32 s23,s22,14336
s_mov_b32 m0,s23
s_nop 0
buffer_load_dwordx4 v16,s[16:19],s20 offen lds
s_add_u32 s23,s22,15360
s_mov_b32 m0,s23
s_add_u32 s20,s20,10240
buffer_load_dwordx4 v16,s[16:19],s20 offen lds
s_add_u32 s20,s41,-21
s_cselect_b32 s47,0,29
s_add_u32 s20,s20,s47
s_mul_i32 s20,s20,20480
s_add_u32 s20,s20,s64
s_add_u32 s23,s22,16384
s_mov_b32 m0,s23
s_nop 0
buffer_load_dwordx4 v16,s[16:19],s20 offen lds
s_add_u32 s23,s22,17408
s_mov_b32 m0,s23
s_add_u32 s20,s20,10240
buffer_load_dwordx4 v16,s[16:19],s20 offen lds
s_add_u32 s20,s41,-20
s_cselect_b32 s47,0,29
s_add_u32 s20,s20,s47
s_mul_i32 s20,s20,20480
s_add_u32 s20,s20,s64
s_add_u32 s23,s22,18432
s_mov_b32 m0,s23
s_nop 0
buffer_load_dwordx4 v16,s[16:19],s20 offen lds
s_add_u32 s23,s22,19456
s_mov_b32 m0,s23
s_add_u32 s20,s20,10240
buffer_load_dwordx4 v16,s[16:19],s20 offen lds
s_add_u32 s20,s41,-19
s_cselect_b32 s47,0,29
s_add_u32 s20,s20,s47
s_mul_i32 s20,s20,20480
s_add_u32 s20,s20,s64
s_add_u32 s23,s22,20480
s_mov_b32 m0,s23
s_nop 0
buffer_load_dwordx4 v16,s[16:19],s20 offen lds
s_add_u32 s23,s22,21504
s_mov_b32 m0,s23
s_add_u32 s20,s20,10240
buffer_load_dwordx4 v16,s[16:19],s20 offen lds
s_add_u32 s20,s41,-18
s_cselect_b32 s47,0,29
s_add_u32 s20,s20,s47
s_mul_i32 s20,s20,20480
s_add_u32 s20,s20,s64
s_add_u32 s23,s22,22528
s_mov_b32 m0,s23
s_nop 0
buffer_load_dwordx4 v16,s[16:19],s20 offen lds
s_add_u32 s23,s22,23552
s_mov_b32 m0,s23
s_add_u32 s20,s20,10240
buffer_load_dwordx4 v16,s[16:19],s20 offen lds
s_add_u32 s20,s41,-17
s_cselect_b32 s47,0,29
s_add_u32 s20,s20,s47
s_mul_i32 s20,s20,20480
s_add_u32 s20,s20,s64
s_add_u32 s23,s22,24576
s_mov_b32 m0,s23
s_nop 0
buffer_load_dwordx4 v16,s[16:19],s20 offen lds
s_add_u32 s23,s22,25600
s_mov_b32 m0,s23
s_add_u32 s20,s20,10240
buffer_load_dwordx4 v16,s[16:19],s20 offen lds
s_add_u32 s20,s41,-16
s_cselect_b32 s47,0,29
s_add_u32 s20,s20,s47
s_mul_i32 s20,s20,20480
s_add_u32 s20,s20,s64
s_add_u32 s23,s22,26624
s_mov_b32 m0,s23
s_nop 0
buffer_load_dwordx4 v16,s[16:19],s20 offen lds
s_add_u32 s23,s22,27648
s_mov_b32 m0,s23
s_add_u32 s20,s20,10240
buffer_load_dwordx4 v16,s[16:19],s20 offen lds
s_add_u32 s20,s41,-15
s_cselect_b32 s47,0,29
s_add_u32 s20,s20,s47
s_mul_i32 s20,s20,20480
s_add_u32 s20,s20,s64
s_add_u32 s23,s22,28672
s_mov_b32 m0,s23
s_nop 0
buffer_load_dwordx4 v16,s[16:19],s20 offen lds
s_add_u32 s23,s22,29696
s_mov_b32 m0,s23
s_add_u32 s20,s20,10240
buffer_load_dwordx4 v16,s[16:19],s20 offen lds
s_add_u32 s20,s41,-14
s_cselect_b32 s47,0,29
s_add_u32 s20,s20,s47
s_mul_i32 s20,s20,20480
s_add_u32 s20,s20,s64
s_add_u32 s23,s22,30720
s_mov_b32 m0,s23
s_nop 0
buffer_load_dwordx4 v16,s[16:19],s20 offen lds
s_add_u32 s23,s22,31744
s_mov_b32 m0,s23
s_add_u32 s20,s20,10240
buffer_load_dwordx4 v16,s[16:19],s20 offen lds
s_add_u32 s20,s41,-13
s_cselect_b32 s47,0,29
s_add_u32 s20,s20,s47
s_mul_i32 s20,s20,20480
s_add_u32 s20,s20,s64
s_add_u32 s23,s22,32768
s_mov_b32 m0,s23
s_nop 0
buffer_load_dwordx4 v16,s[16:19],s20 offen lds
s_add_u32 s23,s22,33792
s_mov_b32 m0,s23
s_add_u32 s20,s20,10240
buffer_load_dwordx4 v16,s[16:19],s20 offen lds
s_add_u32 s20,s41,-12
s_cselect_b32 s47,0,29
s_add_u32 s20,s20,s47
s_mul_i32 s20,s20,20480
s_add_u32 s20,s20,s64
s_add_u32 s23,s22,34816
s_mov_b32 m0,s23
s_nop 0
buffer_load_dwordx4 v16,s[16:19],s20 offen lds
s_add_u32 s23,s22,35840
s_mov_b32 m0,s23
s_add_u32 s20,s20,10240
buffer_load_dwordx4 v16,s[16:19],s20 offen lds
s_waitcnt vmcnt(34)
ds_read_b64_tr_b16 a[0:1],v17
ds_read_b64_tr_b16 a[2:3],v17 offset:1024
ds_read_b64_tr_b16 a[116:117],v18
ds_read_b64_tr_b16 a[118:119],v18 offset:1024
s_waitcnt vmcnt(32)
ds_read_b64_tr_b16 a[4:5],v17 offset:2048
ds_read_b64_tr_b16 a[6:7],v17 offset:3072
ds_read_b64_tr_b16 a[120:121],v18 offset:2048
ds_read_b64_tr_b16 a[122:123],v18 offset:3072
s_waitcnt vmcnt(30)
ds_read_b64_tr_b16 a[8:9],v17 offset:4096
ds_read_b64_tr_b16 a[10:11],v17 offset:5120
ds_read_b64_tr_b16 a[124:125],v18 offset:4096
ds_read_b64_tr_b16 a[126:127],v18 offset:5120
s_waitcnt lgkmcnt(8)
s_add_u32 s20,s41,-11
s_cselect_b32 s47,0,29
s_add_u32 s20,s20,s47
s_mul_i32 s20,s20,20480
s_add_u32 s20,s20,s64
s_add_u32 s23,s22,0
s_mov_b32 m0,s23
s_nop 0
buffer_load_dwordx4 v16,s[16:19],s20 offen lds
s_add_u32 s23,s22,1024
s_mov_b32 m0,s23
s_add_u32 s20,s20,10240
buffer_load_dwordx4 v16,s[16:19],s20 offen lds
s_waitcnt vmcnt(30)
ds_read_b64_tr_b16 a[12:13],v17 offset:6144
ds_read_b64_tr_b16 a[14:15],v17 offset:7168
ds_read_b64_tr_b16 a[128:129],v18 offset:6144
ds_read_b64_tr_b16 a[130:131],v18 offset:7168
s_waitcnt lgkmcnt(8)
s_add_u32 s20,s41,-10
s_cselect_b32 s47,0,29
s_add_u32 s20,s20,s47
s_mul_i32 s20,s20,20480
s_add_u32 s20,s20,s64
s_add_u32 s23,s22,2048
s_mov_b32 m0,s23
s_nop 0
buffer_load_dwordx4 v16,s[16:19],s20 offen lds
s_add_u32 s23,s22,3072
s_mov_b32 m0,s23
s_add_u32 s20,s20,10240
buffer_load_dwordx4 v16,s[16:19],s20 offen lds
s_waitcnt vmcnt(30)
ds_read_b64_tr_b16 a[16:17],v17 offset:8192
ds_read_b64_tr_b16 a[18:19],v17 offset:9216
ds_read_b64_tr_b16 a[132:133],v18 offset:8192
ds_read_b64_tr_b16 a[134:135],v18 offset:9216
s_waitcnt lgkmcnt(8)
s_add_u32 s20,s41,-9
s_cselect_b32 s47,0,29
s_add_u32 s20,s20,s47
s_mul_i32 s20,s20,20480
s_add_u32 s20,s20,s64
s_add_u32 s23,s22,4096
s_mov_b32 m0,s23
s_nop 0
buffer_load_dwordx4 v16,s[16:19],s20 offen lds
s_add_u32 s23,s22,5120
s_mov_b32 m0,s23
s_add_u32 s20,s20,10240
buffer_load_dwordx4 v16,s[16:19],s20 offen lds
s_waitcnt vmcnt(30)
ds_read_b64_tr_b16 a[20:21],v17 offset:10240
ds_read_b64_tr_b16 a[22:23],v17 offset:11264
ds_read_b64_tr_b16 a[136:137],v18 offset:10240
ds_read_b64_tr_b16 a[138:139],v18 offset:11264
s_waitcnt lgkmcnt(8)
s_add_u32 s20,s41,-8
s_cselect_b32 s47,0,29
s_add_u32 s20,s20,s47
s_mul_i32 s20,s20,20480
s_add_u32 s20,s20,s64
s_add_u32 s23,s22,6144
s_mov_b32 m0,s23
s_nop 0
buffer_load_dwordx4 v16,s[16:19],s20 offen lds
s_add_u32 s23,s22,7168
s_mov_b32 m0,s23
s_add_u32 s20,s20,10240
buffer_load_dwordx4 v16,s[16:19],s20 offen lds
s_waitcnt vmcnt(30)
ds_read_b64_tr_b16 a[24:25],v17 offset:12288
ds_read_b64_tr_b16 a[26:27],v17 offset:13312
ds_read_b64_tr_b16 a[140:141],v18 offset:12288
ds_read_b64_tr_b16 a[142:143],v18 offset:13312
s_waitcnt lgkmcnt(8)
s_add_u32 s20,s41,-7
s_cselect_b32 s47,0,29
s_add_u32 s20,s20,s47
s_mul_i32 s20,s20,20480
s_add_u32 s20,s20,s64
s_add_u32 s23,s22,8192
s_mov_b32 m0,s23
s_nop 0
buffer_load_dwordx4 v16,s[16:19],s20 offen lds
s_add_u32 s23,s22,9216
s_mov_b32 m0,s23
s_add_u32 s20,s20,10240
buffer_load_dwordx4 v16,s[16:19],s20 offen lds
s_waitcnt vmcnt(30)
ds_read_b64_tr_b16 a[28:29],v17 offset:14336
ds_read_b64_tr_b16 a[30:31],v17 offset:15360
ds_read_b64_tr_b16 a[144:145],v18 offset:14336
ds_read_b64_tr_b16 a[146:147],v18 offset:15360
s_waitcnt lgkmcnt(8)
s_add_u32 s20,s41,-6
s_cselect_b32 s47,0,29
s_add_u32 s20,s20,s47
s_mul_i32 s20,s20,20480
s_add_u32 s20,s20,s64
s_add_u32 s23,s22,10240
s_mov_b32 m0,s23
s_nop 0
buffer_load_dwordx4 v16,s[16:19],s20 offen lds
s_add_u32 s23,s22,11264
s_mov_b32 m0,s23
s_add_u32 s20,s20,10240
buffer_load_dwordx4 v16,s[16:19],s20 offen lds
s_waitcnt vmcnt(30)
ds_read_b64_tr_b16 a[32:33],v17 offset:16384
ds_read_b64_tr_b16 a[34:35],v17 offset:17408
ds_read_b64_tr_b16 a[148:149],v18 offset:16384
ds_read_b64_tr_b16 a[150:151],v18 offset:17408
s_waitcnt lgkmcnt(8)
s_add_u32 s20,s41,-5
s_cselect_b32 s47,0,29
s_add_u32 s20,s20,s47
s_mul_i32 s20,s20,20480
s_add_u32 s20,s20,s64
s_add_u32 s23,s22,12288
s_mov_b32 m0,s23
s_nop 0
buffer_load_dwordx4 v16,s[16:19],s20 offen lds
s_add_u32 s23,s22,13312
s_mov_b32 m0,s23
s_add_u32 s20,s20,10240
buffer_load_dwordx4 v16,s[16:19],s20 offen lds
s_waitcnt vmcnt(30)
ds_read_b64_tr_b16 a[36:37],v17 offset:18432
ds_read_b64_tr_b16 a[38:39],v17 offset:19456
ds_read_b64_tr_b16 a[152:153],v18 offset:18432
ds_read_b64_tr_b16 a[154:155],v18 offset:19456
s_waitcnt lgkmcnt(8)
s_add_u32 s20,s41,-4
s_cselect_b32 s47,0,29
s_add_u32 s20,s20,s47
s_mul_i32 s20,s20,20480
s_add_u32 s20,s20,s64
s_add_u32 s23,s22,14336
s_mov_b32 m0,s23
s_nop 0
buffer_load_dwordx4 v16,s[16:19],s20 offen lds
s_add_u32 s23,s22,15360
s_mov_b32 m0,s23
s_add_u32 s20,s20,10240
buffer_load_dwordx4 v16,s[16:19],s20 offen lds
s_waitcnt vmcnt(30)
ds_read_b64_tr_b16 a[40:41],v17 offset:20480
ds_read_b64_tr_b16 a[42:43],v17 offset:21504
ds_read_b64_tr_b16 a[156:157],v18 offset:20480
ds_read_b64_tr_b16 a[158:159],v18 offset:21504
s_waitcnt lgkmcnt(8)
s_add_u32 s20,s41,-3
s_cselect_b32 s47,0,29
s_add_u32 s20,s20,s47
s_mul_i32 s20,s20,20480
s_add_u32 s20,s20,s64
s_add_u32 s23,s22,16384
s_mov_b32 m0,s23
s_nop 0
buffer_load_dwordx4 v16,s[16:19],s20 offen lds
s_add_u32 s23,s22,17408
s_mov_b32 m0,s23
s_add_u32 s20,s20,10240
buffer_load_dwordx4 v16,s[16:19],s20 offen lds
s_waitcnt vmcnt(30)
ds_read_b64_tr_b16 a[44:45],v17 offset:22528
ds_read_b64_tr_b16 a[46:47],v17 offset:23552
ds_read_b64_tr_b16 a[160:161],v18 offset:22528
ds_read_b64_tr_b16 a[162:163],v18 offset:23552
s_waitcnt lgkmcnt(8)
s_add_u32 s20,s41,-2
s_cselect_b32 s47,0,29
s_add_u32 s20,s20,s47
s_mul_i32 s20,s20,20480
s_add_u32 s20,s20,s64
s_add_u32 s23,s22,18432
s_mov_b32 m0,s23
s_nop 0
buffer_load_dwordx4 v16,s[16:19],s20 offen lds
s_add_u32 s23,s22,19456
s_mov_b32 m0,s23
s_add_u32 s20,s20,10240
buffer_load_dwordx4 v16,s[16:19],s20 offen lds
s_waitcnt vmcnt(30)
ds_read_b64_tr_b16 a[48:49],v17 offset:24576
ds_read_b64_tr_b16 a[50:51],v17 offset:25600
ds_read_b64_tr_b16 a[164:165],v18 offset:24576
ds_read_b64_tr_b16 a[166:167],v18 offset:25600
s_waitcnt lgkmcnt(8)
s_add_u32 s20,s41,-1
s_cselect_b32 s47,0,29
s_add_u32 s20,s20,s47
s_mul_i32 s20,s20,20480
s_add_u32 s20,s20,s64
s_add_u32 s23,s22,20480
s_mov_b32 m0,s23
s_nop 0
buffer_load_dwordx4 v16,s[16:19],s20 offen lds
s_add_u32 s23,s22,21504
s_mov_b32 m0,s23
s_add_u32 s20,s20,10240
buffer_load_dwordx4 v16,s[16:19],s20 offen lds
s_waitcnt vmcnt(30)
ds_read_b64_tr_b16 a[52:53],v17 offset:26624
ds_read_b64_tr_b16 a[54:55],v17 offset:27648
ds_read_b64_tr_b16 a[168:169],v18 offset:26624
ds_read_b64_tr_b16 a[170:171],v18 offset:27648
s_waitcnt vmcnt(28)
ds_read_b64_tr_b16 a[56:57],v17 offset:28672
ds_read_b64_tr_b16 a[58:59],v17 offset:29696
ds_read_b64_tr_b16 a[172:173],v18 offset:28672
ds_read_b64_tr_b16 a[174:175],v18 offset:29696
s_waitcnt vmcnt(26)
ds_read_b64_tr_b16 a[60:61],v17 offset:30720
ds_read_b64_tr_b16 a[62:63],v17 offset:31744
ds_read_b64_tr_b16 a[176:177],v18 offset:30720
ds_read_b64_tr_b16 a[178:179],v18 offset:31744
s_waitcnt vmcnt(24)
ds_read_b64_tr_b16 a[64:65],v17 offset:32768
ds_read_b64_tr_b16 a[66:67],v17 offset:33792
ds_read_b64_tr_b16 a[180:181],v18 offset:32768
ds_read_b64_tr_b16 a[182:183],v18 offset:33792
s_waitcnt vmcnt(22)
ds_read_b64_tr_b16 a[68:69],v17 offset:34816
ds_read_b64_tr_b16 a[70:71],v17 offset:35840
ds_read_b64_tr_b16 a[184:185],v18 offset:34816
ds_read_b64_tr_b16 a[186:187],v18 offset:35840
s_waitcnt vmcnt(20)
ds_read_b64_tr_b16 a[72:73],v17
ds_read_b64_tr_b16 a[74:75],v17 offset:1024
ds_read_b64_tr_b16 a[188:189],v18
ds_read_b64_tr_b16 a[190:191],v18 offset:1024
s_waitcnt vmcnt(18)
ds_read_b64_tr_b16 a[76:77],v17 offset:2048
ds_read_b64_tr_b16 a[78:79],v17 offset:3072
ds_read_b64_tr_b16 a[192:193],v18 offset:2048
ds_read_b64_tr_b16 a[194:195],v18 offset:3072
s_waitcnt vmcnt(16)
ds_read_b64_tr_b16 a[80:81],v17 offset:4096
ds_read_b64_tr_b16 a[82:83],v17 offset:5120
ds_read_b64_tr_b16 a[196:197],v18 offset:4096
ds_read_b64_tr_b16 a[198:199],v18 offset:5120
s_waitcnt vmcnt(14)
ds_read_b64_tr_b16 a[84:85],v17 offset:6144
ds_read_b64_tr_b16 a[86:87],v17 offset:7168
ds_read_b64_tr_b16 a[200:201],v18 offset:6144
ds_read_b64_tr_b16 a[202:203],v18 offset:7168
s_waitcnt vmcnt(12)
ds_read_b64_tr_b16 a[88:89],v17 offset:8192
ds_read_b64_tr_b16 a[90:91],v17 offset:9216
ds_read_b64_tr_b16 a[204:205],v18 offset:8192
ds_read_b64_tr_b16 a[206:207],v18 offset:9216
s_waitcnt vmcnt(10)
ds_read_b64_tr_b16 a[92:93],v17 offset:10240
ds_read_b64_tr_b16 a[94:95],v17 offset:11264
ds_read_b64_tr_b16 a[208:209],v18 offset:10240
ds_read_b64_tr_b16 a[210:211],v18 offset:11264
s_waitcnt vmcnt(8)
ds_read_b64_tr_b16 a[96:97],v17 offset:12288
ds_read_b64_tr_b16 a[98:99],v17 offset:13312
ds_read_b64_tr_b16 a[212:213],v18 offset:12288
ds_read_b64_tr_b16 a[214:215],v18 offset:13312
s_waitcnt vmcnt(6)
ds_read_b64_tr_b16 a[100:101],v17 offset:14336
ds_read_b64_tr_b16 a[102:103],v17 offset:15360
ds_read_b64_tr_b16 a[216:217],v18 offset:14336
ds_read_b64_tr_b16 a[218:219],v18 offset:15360
s_waitcnt vmcnt(4)
ds_read_b64_tr_b16 a[104:105],v17 offset:16384
ds_read_b64_tr_b16 a[106:107],v17 offset:17408
ds_read_b64_tr_b16 a[220:221],v18 offset:16384
ds_read_b64_tr_b16 a[222:223],v18 offset:17408
s_waitcnt vmcnt(2)
ds_read_b64_tr_b16 a[108:109],v17 offset:18432
ds_read_b64_tr_b16 a[110:111],v17 offset:19456
ds_read_b64_tr_b16 a[224:225],v18 offset:18432
ds_read_b64_tr_b16 a[226:227],v18 offset:19456
s_waitcnt vmcnt(0)
ds_read_b64_tr_b16 a[112:113],v17 offset:20480
ds_read_b64_tr_b16 a[114:115],v17 offset:21504
ds_read_b64_tr_b16 a[228:229],v18 offset:20480
ds_read_b64_tr_b16 a[230:231],v18 offset:21504
s_waitcnt lgkmcnt(0)
s_barrier
s_lshl_b32 s41,s41,10
s_lshr_b32 s20,s2,5
v_and_b32 v17,7,v0
v_min_u32 v16,1,v17
v_lshl_add_u32 v17,v16,3,v17
v_lshlrev_b32 v17,4,v17
s_mov_b32 s38,0
s_nop 0
reg_432:
buffer_load_dword v16,v17,s[12:15],0 offen sc1
s_waitcnt vmcnt(0)
v_readlane_b32 s50,v16,0
v_readlane_b32 s51,v16,1
v_readlane_b32 s52,v16,2
v_readlane_b32 s53,v16,3
v_readlane_b32 s54,v16,4
v_readlane_b32 s55,v16,5
v_readlane_b32 s56,v16,6
v_readlane_b32 s57,v16,7
v_readlane_b32 s58,v16,s20
s_nop 0
s_cmp_ge_u32 s58,32
s_nop 1
s_cbranch_scc1 regd_433
s_add_u32 s59,s50,s51
s_add_u32 s59,s59,s52
s_add_u32 s59,s59,s53
s_add_u32 s59,s59,s54
s_add_u32 s59,s59,s55
s_add_u32 s59,s59,s56
s_add_u32 s59,s59,s57
s_cmp_ge_u32 s59,256
s_cbranch_scc1 regd_433
s_sleep 2
s_add_u32 s38,s38,1
s_cmp_lt_u32 s38,100000
s_cbranch_scc1 reg_432
s_mov_b32 s40,15
s_branch L_fail
regd_433:
s_cmp_ge_u32 s58,32
s_cselect_b32 s21,1,0
v_mov_b32 v16,68
s_mov_b32 s99,128
s_mov_b32 s38,0
poll_434:
buffer_load_dword v17,v16,s[12:15],0 offen sc1
s_waitcnt vmcnt(0)
v_cmp_le_u32 vcc,s99,v17
s_nop 0
s_cmp_eq_u64 vcc,-1
s_nop 1
s_cbranch_scc1 polld_435
s_sleep 8
s_add_u32 s38,s38,1
s_cmp_lt_u32 s38,100000
s_cbranch_scc1 poll_434
s_mov_b32 s40,14
s_branch L_fail
polld_435:
v_readfirstlane_b32 s99,v17
s_nop 0
s_and_b32 s99,s99,1
s_lshl_b32 s99,s99,13
s_mul_i32 s32,s39,0x6c0000
s_add_u32 s32,s32,0x4d30000
s_lshl_b32 s46,s45,10
s_add_u32 s32,s32,s46
s_mul_i32 s46,s39,0x48000
s_add_u32 s46,s46,0x50000
s_lshl_b32 s101,s39,13
s_xor_b32 s101,s101,s99
s_xor_b32 s101,s101,8192
s_add_u32 s46,s46,s101
s_lshr_b32 s47,s45,1
v_add_u32 v2,s47,v0
s_add_u32 s47,s45,28
s_lshr_b32 s47,s47,1
v_min_u32 v2,s47,v2
v_lshlrev_b32 v2,7,v2
v_add_u32 v2,s46,v2
s_lshl_b32 s60,s49,11
s_mul_i32 s33,s39,0x300000
s_add_u32 s33,s33,0x3b00000
s_add_u32 s33,s33,s60
s_mul_i32 s34,s39,0x300000
s_add_u32 s34,s34,0x4730000
s_add_u32 s34,s34,s60
s_mov_b32 s36,58720256
s_lshl_b32 s61,s49,7
s_add_u32 s37,s61,360448
s_add_u32 s37,s37,s99
s_lshl_b32 s62,s49,6
s_mul_i32 s66,s39,0x48000
s_add_u32 s66,s66,0x31000
s_lshl_b32 s101,s39,13
s_xor_b32 s101,s101,s99
s_xor_b32 s101,s101,8192
s_add_u32 s66,s66,s101
s_add_u32 s66,s66,s61
v_and_b32 v11,31,v0
v_mul_u32_u24 v11,1280,v11
v_lshrrev_b32 v12,5,v0
v_lshl_add_u32 v11,v12,4,v11
s_lshl_b32 s61,s49,8
s_add_u32 s63,s36,s61
s_add_u32 s63,s63,40960
s_add_u32 s36,s36,s60
v_and_b32 v10,31,v0
v_lshlrev_b32 v10,3,v10
s_cmp_eq_u32 s44,0
s_cselect_b32 s26,s6,0
s_add_u32 s32,s32,s41
s_sub_u32 s65,s32,29696
s_lshl_b32 s46,s48,14
v_add_u32 v9,s46,v1
s_lshl_b32 s46,s3,12
v_add_u32 v8,s46,v9
s_mov_b32 s58,s60
s_waitcnt vmcnt(0) lgkmcnt(0)
s_getpc_b64 s[60:61]
pc_438:
s_add_u32 s60,s60,ks_top_436-pc_438
s_addc_u32 s61,s61,0
s_mov_b32 s59,ks_fin_437-ks_top_436-4
v_lshlrev_b32 v18,7,v0
v_add_u32 v18,0,v18
v_min_u32 v18,s59,v18
v_mov_b32 v17,s61
v_add_co_u32 v16,vcc,s60,v18
s_nop 1
v_addc_co_u32 v17,vcc,0,v17,vcc
global_load_dword v19,v[16:17],off
s_waitcnt vmcnt(0)
s_mov_b32 s28,0
s_mov_b32 s31,1
s_mov_b32 s30,0
s_mov_b32 s67,64
s_lshl_b32 s46,s39,1
s_sub_u32 s67,65,s46
s_mov_b32 s38,0
poll_439:
buffer_load_dword v6,v2,s[4:7],0 offen sc1
s_waitcnt vmcnt(0)
v_cmp_le_u32 vcc,s31,v6
s_nop 0
s_cmp_eq_u64 vcc,-1
s_nop 1
s_cbranch_scc1 polld_440
s_sleep 2
s_add_u32 s38,s38,1
s_cmp_lt_u32 s38,100000
s_cbranch_scc1 poll_439
s_mov_b32 s40,12
s_branch L_fail
polld_440:
s_cmp_lt_u32 s41,29696
s_cselect_b32 s46,s32,s65
s_add_u32 s46,s46,0
buffer_load_dwordx4 v[48:51],v1,s[4:7],s46 offen sc1
s_cmp_lt_u32 s41,28672
s_cselect_b32 s46,s32,s65
s_add_u32 s46,s46,0
buffer_load_dwordx4 v[52:55],v1,s[4:7],s46 offen offset:1024 sc1
s_cmp_lt_u32 s41,27648
s_cselect_b32 s46,s32,s65
s_add_u32 s46,s46,0
buffer_load_dwordx4 v[56:59],v1,s[4:7],s46 offen offset:2048 sc1
s_cmp_lt_u32 s41,26624
s_cselect_b32 s46,s32,s65
s_add_u32 s46,s46,0
buffer_load_dwordx4 v[60:63],v1,s[4:7],s46 offen offset:3072 sc1
s_cmp_lt_u32 s41,25600
s_cselect_b32 s46,s32,s65
s_add_u32 s46,s46,4096
buffer_load_dwordx4 v[64:67],v1,s[4:7],s46 offen sc1
s_cmp_lt_u32 s41,24576
s_cselect_b32 s46,s32,s65
s_add_u32 s46,s46,4096
buffer_load_dwordx4 v[68:71],v1,s[4:7],s46 offen offset:1024 sc1
s_cmp_lt_u32 s41,23552
s_cselect_b32 s46,s32,s65
s_add_u32 s46,s46,4096
buffer_load_dwordx4 v[72:75],v1,s[4:7],s46 offen offset:2048 sc1
s_cmp_lt_u32 s41,22528
s_cselect_b32 s46,s32,s65
s_add_u32 s46,s46,4096
buffer_load_dwordx4 v[76:79],v1,s[4:7],s46 offen offset:3072 sc1
s_cmp_lt_u32 s41,21504
s_cselect_b32 s46,s32,s65
s_add_u32 s46,s46,8192
buffer_load_dwordx4 v[80:83],v1,s[4:7],s46 offen sc1
s_cmp_lt_u32 s41,20480
s_cselect_b32 s46,s32,s65
s_add_u32 s46,s46,8192
buffer_load_dwordx4 v[84:87],v1,s[4:7],s46 offen offset:1024 sc1
s_cmp_lt_u32 s41,19456
s_cselect_b32 s46,s32,s65
s_add_u32 s46,s46,8192
buffer_load_dwordx4 v[88:91],v1,s[4:7],s46 offen offset:2048 sc1
s_cmp_lt_u32 s41,18432
s_cselect_b32 s46,s32,s65
s_add_u32 s46,s46,8192
buffer_load_dwordx4 v[92:95],v1,s[4:7],s46 offen offset:3072 sc1
s_cmp_lt_u32 s41,17408
s_cselect_b32 s46,s32,s65
s_add_u32 s46,s46,12288
buffer_load_dwordx4 v[96:99],v1,s[4:7],s46 offen sc1
s_cmp_lt_u32 s41,16384
s_cselect_b32 s46,s32,s65
s_add_u32 s46,s46,12288
buffer_load_dwordx4 v[100:103],v1,s[4:7],s46 offen offset:1024 sc1
ks_top_436:
s_cmp_ge_u32 s28,s67
s_cbranch_scc1 L_end
s_cmp_eq_u32 s28,64
s_cselect_b32 s39,1,s39
s_cselect_b32 s46,3096576,0
s_add_u32 s33,s33,s46
s_add_u32 s31,s28,2
s_mov_b32 s29,0
s_and_b32 s69,s28,7
s_cmp_eq_u32 s69,7
s_cselect_b32 s69,-7,1
s_mul_i32 s68,s69,110592
s_mul_i32 s69,s69,49152
v_cmp_le_u32 vcc,s31,v6
s_nop 0
s_cmp_eq_u64 vcc,-1
s_cselect_b32 s35,1,0
s_waitcnt vmcnt(13)
v_mfma_f32_32x32x16_bf16 v[16:31],a[0:3],v[48:51],0
s_cmp_lt_u32 s41,15360
s_cselect_b32 s46,s32,s65
s_add_u32 s46,s46,12288
buffer_load_dwordx4 v[104:107],v1,s[4:7],s46 offen offset:2048 sc1
v_mfma_f32_32x32x16_bf16 v[32:47],a[116:119],v[48:51],0
s_waitcnt vmcnt(13)
v_mfma_f32_32x32x16_bf16 v[16:31],a[4:7],v[52:55],v[16:31]
s_cmp_lt_u32 s41,14336
s_cselect_b32 s46,s32,s65
s_add_u32 s46,s46,12288
buffer_load_dwordx4 v[108:111],v1,s[4:7],s46 offen offset:3072 sc1
v_mfma_f32_32x32x16_bf16 v[32:47],a[120:123],v[52:55],v[32:47]
s_waitcnt vmcnt(13)
v_mfma_f32_32x32x16_bf16 v[16:31],a[8:11],v[56:59],v[16:31]
s_cmp_lt_u32 s41,13312
s_cselect_b32 s46,s32,s65
s_add_u32 s46,s46,16384
buffer_load_dwordx4 v[112:115],v1,s[4:7],s46 offen sc1
v_mfma_f32_32x32x16_bf16 v[32:47],a[124:127],v[56:59],v[32:47]
s_waitcnt vmcnt(13)
v_mfma_f32_32x32x16_bf16 v[16:31],a[12:15],v[60:63],v[16:31]
s_cmp_lt_u32 s41,12288
s_cselect_b32 s46,s32,s65
s_add_u32 s46,s46,16384
buffer_load_dwordx4 v[116:119],v1,s[4:7],s46 offen offset:1024 sc1
v_mfma_f32_32x32x16_bf16 v[32:47],a[128:131],v[60:63],v[32:47]
s_waitcnt vmcnt(13)
v_mfma_f32_32x32x16_bf16 v[16:31],a[16:19],v[64:67],v[16:31]
s_cmp_lt_u32 s41,11264
s_cselect_b32 s46,s32,s65
s_add_u32 s46,s46,16384
buffer_load_dwordx4 v[120:123],v1,s[4:7],s46 offen offset:2048 sc1
v_mfma_f32_32x32x16_bf16 v[32:47],a[132:135],v[64:67],v[32:47]
s_cmp_lg_u32 s35,0
s_cbranch_scc1 ks_cp_443
buffer_load_dword v6,v2,s[4:7],0 offen sc1
ks_cp_443:
s_waitcnt vmcnt(13)
v_mfma_f32_32x32x16_bf16 v[16:31],a[20:23],v[68:71],v[16:31]
s_cmp_lt_u32 s41,10240
s_cselect_b32 s46,s32,s65
s_add_u32 s46,s46,16384
buffer_load_dwordx4 v[124:127],v1,s[4:7],s46 offen offset:3072 sc1
v_mfma_f32_32x32x16_bf16 v[32:47],a[136:139],v[68:71],v[32:47]
s_waitcnt vmcnt(13)
v_mfma_f32_32x32x16_bf16 v[16:31],a[24:27],v[72:75],v[16:31]
s_cmp_lt_u32 s41,9216
s_cselect_b32 s46,s32,s65
s_add_u32 s46,s46,20480
buffer_load_dwordx4 v[128:131],v1,s[4:7],s46 offen sc1
v_mfma_f32_32x32x16_bf16 v[32:47],a[140:143],v[72:75],v[32:47]
s_waitcnt vmcnt(13)
v_mfma_f32_32x32x16_bf16 v[16:31],a[28:31],v[76:79],v[16:31]
s_cmp_lt_u32 s41,8192
s_cselect_b32 s46,s32,s65
s_add_u32 s46,s46,20480
buffer_load_dwordx4 v[132:135],v1,s[4:7],s46 offen offset:1024 sc1
v_mfma_f32_32x32x16_bf16 v[32:47],a[144:147],v[76:79],v[32:47]
s_waitcnt vmcnt(13)
v_mfma_f32_32x32x16_bf16 v[16:31],a[32:35],v[80:83],v[16:31]
s_cmp_lt_u32 s41,7168
s_cselect_b32 s46,s32,s65
s_add_u32 s46,s46,20480
buffer_load_dwordx4 v[136:139],v1,s[4:7],s46 offen offset:2048 sc1
v_mfma_f32_32x32x16_bf16 v[32:47],a[148:151],v[80:83],v[32:47]
s_waitcnt vmcnt(13)
v_mfma_f32_32x32x16_bf16 v[16:31],a[36:39],v[84:87],v[16:31]
s_cmp_lt_u32 s41,6144
s_cselect_b32 s46,s32,s65
s_add_u32 s46,s46,20480
buffer_load_dwordx4 v[140:143],v1,s[4:7],s46 offen offset:3072 sc1
v_mfma_f32_32x32x16_bf16 v[32:47],a[152:155],v[84:87],v[32:47]
s_waitcnt vmcnt(13)
v_mfma_f32_32x32x16_bf16 v[16:31],a[40:43],v[88:91],v[16:31]
s_cmp_lt_u32 s41,5120
s_cselect_b32 s46,s32,s65
s_add_u32 s46,s46,24576
buffer_load_dwordx4 v[144:147],v1,s[4:7],s46 offen sc1
v_mfma_f32_32x32x16_bf16 v[32:47],a[156:159],v[88:91],v[32:47]
s_waitcnt vmcnt(13)
v_mfma_f32_32x32x16_bf16 v[16:31],a[44:47],v[92:95],v[16:31]
s_cmp_lt_u32 s41,4096
s_cselect_b32 s46,s32,s65
s_add_u32 s46,s46,24576
buffer_load_dwordx4 v[148:151],v1,s[4:7],s46 offen offset:1024 sc1
v_mfma_f32_32x32x16_bf16 v[32:47],a[160:163],v[92:95],v[32:47]
s_waitcnt vmcnt(13)
v_mfma_f32_32x32x16_bf16 v[16:31],a[48:51],v[96:99],v[16:31]
s_cmp_lt_u32 s41,3072
s_cselect_b32 s46,s32,s65
s_add_u32 s46,s46,24576
buffer_load_dwordx4 v[152:155],v1,s[4:7],s46 offen offset:2048 sc1
v_mfma_f32_32x32x16_bf16 v[32:47],a[164:167],v[96:99],v[32:47]
s_waitcnt vmcnt(13)
v_mfma_f32_32x32x16_bf16 v[16:31],a[52:55],v[100:103],v[16:31]
s_cmp_lt_u32 s41,2048
s_cselect_b32 s46,s32,s65
s_add_u32 s46,s46,24576
buffer_load_dwordx4 v[156:159],v1,s[4:7],s46 offen offset:3072 sc1
v_mfma_f32_32x32x16_bf16 v[32:47],a[168:171],v[100:103],v[32:47]
s_waitcnt vmcnt(13)
v_mfma_f32_32x32x16_bf16 v[16:31],a[56:59],v[104:107],v[16:31]
s_cmp_lt_u32 s41,1024
s_cselect_b32 s46,s32,s65
s_add_u32 s46,s46,28672
buffer_load_dwordx4 v[160:163],v1,s[4:7],s46 offen sc1
v_mfma_f32_32x32x16_bf16 v[32:47],a[172:175],v[104:107],v[32:47]
s_waitcnt vmcnt(10)
v_cmp_le_u32 vcc,s31,v6
s_nop 0
s_cmp_eq_u64 vcc,-1
s_cbranch_scc0 ks_n_441
s_mov_b32 s29,1
s_waitcnt vmcnt(13)
v_mfma_f32_32x32x16_bf16 v[16:31],a[60:63],v[108:111],v[16:31]
s_cmp_lt_u32 s41,29696
s_cselect_b32 s46,s32,s65
s_add_u32 s46,s46,0
s_add_u32 s46,s46,s68
buffer_load_dwordx4 v[48:51],v1,s[4:7],s46 offen sc1
v_mfma_f32_32x32x16_bf16 v[32:47],a[176:179],v[108:111],v[32:47]
s_waitcnt vmcnt(13)
v_mfma_f32_32x32x16_bf16 v[16:31],a[64:67],v[112:115],v[16:31]
s_cmp_lt_u32 s41,28672
s_cselect_b32 s46,s32,s65
s_add_u32 s46,s46,0
s_add_u32 s46,s46,s68
buffer_load_dwordx4 v[52:55],v1,s[4:7],s46 offen offset:1024 sc1
v_mfma_f32_32x32x16_bf16 v[32:47],a[180:183],v[112:115],v[32:47]
s_waitcnt vmcnt(13)
v_mfma_f32_32x32x16_bf16 v[16:31],a[68:71],v[116:119],v[16:31]
s_cmp_lt_u32 s41,27648
s_cselect_b32 s46,s32,s65
s_add_u32 s46,s46,0
s_add_u32 s46,s46,s68
buffer_load_dwordx4 v[56:59],v1,s[4:7],s46 offen offset:2048 sc1
v_mfma_f32_32x32x16_bf16 v[32:47],a[184:187],v[116:119],v[32:47]
s_waitcnt vmcnt(13)
v_mfma_f32_32x32x16_bf16 v[16:31],a[72:75],v[120:123],v[16:31]
s_cmp_lt_u32 s41,26624
s_cselect_b32 s46,s32,s65
s_add_u32 s46,s46,0
s_add_u32 s46,s46,s68
buffer_load_dwordx4 v[60:63],v1,s[4:7],s46 offen offset:3072 sc1
v_mfma_f32_32x32x16_bf16 v[32:47],a[188:191],v[120:123],v[32:47]
s_waitcnt vmcnt(13)
v_mfma_f32_32x32x16_bf16 v[16:31],a[76:79],v[124:127],v[16:31]
s_cmp_lt_u32 s41,25600
s_cselect_b32 s46,s32,s65
s_add_u32 s46,s46,4096
s_add_u32 s46,s46,s68
buffer_load_dwordx4 v[64:67],v1,s[4:7],s46 offen sc1
v_mfma_f32_32x32x16_bf16 v[32:47],a[192:195],v[124:127],v[32:47]
s_waitcnt vmcnt(13)
v_mfma_f32_32x32x16_bf16 v[16:31],a[80:83],v[128:131],v[16:31]
s_cmp_lt_u32 s41,24576
s_cselect_b32 s46,s32,s65
s_add_u32 s46,s46,4096
s_add_u32 s46,s46,s68
buffer_load_dwordx4 v[68:71],v1,s[4:7],s46 offen offset:1024 sc1
v_mfma_f32_32x32x16_bf16 v[32:47],a[196:199],v[128:131],v[32:47]
s_waitcnt vmcnt(13)
v_mfma_f32_32x32x16_bf16 v[16:31],a[84:87],v[132:135],v[16:31]
s_cmp_lt_u32 s41,23552
s_cselect_b32 s46,s32,s65
s_add_u32 s46,s46,4096
s_add_u32 s46,s46,s68
buffer_load_dwordx4 v[72:75],v1,s[4:7],s46 offen offset:2048 sc1
v_mfma_f32_32x32x16_bf16 v[32:47],a[200:203],v[132:135],v[32:47]
s_waitcnt vmcnt(13)
v_mfma_f32_32x32x16_bf16 v[16:31],a[88:91],v[136:139],v[16:31]
s_cmp_lt_u32 s41,22528
s_cselect_b32 s46,s32,s65
s_add_u32 s46,s46,4096
s_add_u32 s46,s46,s68
buffer_load_dwordx4 v[76:79],v1,s[4:7],s46 offen offset:3072 sc1
v_mfma_f32_32x32x16_bf16 v[32:47],a[204:207],v[136:139],v[32:47]
s_waitcnt vmcnt(13)
v_mfma_f32_32x32x16_bf16 v[16:31],a[92:95],v[140:143],v[16:31]
s_cmp_lt_u32 s41,21504
s_cselect_b32 s46,s32,s65
s_add_u32 s46,s46,8192
s_add_u32 s46,s46,s68
buffer_load_dwordx4 v[80:83],v1,s[4:7],s46 offen sc1
v_mfma_f32_32x32x16_bf16 v[32:47],a[208:211],v[140:143],v[32:47]
s_waitcnt vmcnt(13)
v_mfma_f32_32x32x16_bf16 v[16:31],a[96:99],v[144:147],v[16:31]
s_cmp_lt_u32 s41,20480
s_cselect_b32 s46,s32,s65
s_add_u32 s46,s46,8192
s_add_u32 s46,s46,s68
buffer_load_dwordx4 v[84:87],v1,s[4:7],s46 offen offset:1024 sc1
v_mfma_f32_32x32x16_bf16 v[32:47],a[212:215],v[144:147],v[32:47]
s_waitcnt vmcnt(13)
v_mfma_f32_32x32x16_bf16 v[16:31],a[100:103],v[148:151],v[16:31]
s_cmp_lt_u32 s41,19456
s_cselect_b32 s46,s32,s65
s_add_u32 s46,s46,8192
s_add_u32 s46,s46,s68
buffer_load_dwordx4 v[88:91],v1,s[4:7],s46 offen offset:2048 sc1
v_mfma_f32_32x32x16_bf16 v[32:47],a[216:219],v[148:151],v[32:47]
s_waitcnt vmcnt(13)
v_mfma_f32_32x32x16_bf16 v[16:31],a[104:107],v[152:155],v[16:31]
s_cmp_lt_u32 s41,18432
s_cselect_b32 s46,s32,s65
s_add_u32 s46,s46,8192
s_add_u32 s46,s46,s68
buffer_load_dwordx4 v[92:95],v1,s[4:7],s46 offen offset:3072 sc1
v_mfma_f32_32x32x16_bf16 v[32:47],a[220:223],v[152:155],v[32:47]
s_waitcnt vmcnt(13)
v_mfma_f32_32x32x16_bf16 v[16:31],a[108:111],v[156:159],v[16:31]
s_cmp_lt_u32 s41,17408
s_cselect_b32 s46,s32,s65
s_add_u32 s46,s46,12288
s_add_u32 s46,s46,s68
buffer_load_dwordx4 v[96:99],v1,s[4:7],s46 offen sc1
v_mfma_f32_32x32x16_bf16 v[32:47],a[224:227],v[156:159],v[32:47]
s_waitcnt vmcnt(13)
v_mfma_f32_32x32x16_bf16 v[32:47],a[228:231],v[160:163],v[32:47]
v_mfma_f32_32x32x16_bf16 v[16:31],a[112:115],v[160:163],v[16:31]
s_cmp_lt_u32 s41,16384
s_cselect_b32 s46,s32,s65
s_add_u32 s46,s46,12288
s_add_u32 s46,s46,s68
buffer_load_dwordx4 v[100:103],v1,s[4:7],s46 offen offset:1024 sc1
s_branch ks_j_442
ks_n_441:
s_waitcnt vmcnt(13)
v_mfma_f32_32x32x16_bf16 v[16:31],a[60:63],v[108:111],v[16:31]
v_mfma_f32_32x32x16_bf16 v[32:47],a[176:179],v[108:111],v[32:47]
s_waitcnt vmcnt(12)
v_mfma_f32_32x32x16_bf16 v[16:31],a[64:67],v[112:115],v[16:31]
v_mfma_f32_32x32x16_bf16 v[32:47],a[180:183],v[112:115],v[32:47]
s_waitcnt vmcnt(11)
v_mfma_f32_32x32x16_bf16 v[16:31],a[68:71],v[116:119],v[16:31]
v_mfma_f32_32x32x16_bf16 v[32:47],a[184:187],v[116:119],v[32:47]
s_waitcnt vmcnt(10)
v_mfma_f32_32x32x16_bf16 v[16:31],a[72:75],v[120:123],v[16:31]
v_mfma_f32_32x32x16_bf16 v[32:47],a[188:191],v[120:123],v[32:47]
s_waitcnt vmcnt(9)
v_mfma_f32_32x32x16_bf16 v[16:31],a[76:79],v[124:127],v[16:31]
v_mfma_f32_32x32x16_bf16 v[32:47],a[192:195],v[124:127],v[32:47]
s_waitcnt vmcnt(8)
v_mfma_f32_32x32x16_bf16 v[16:31],a[80:83],v[128:131],v[16:31]
v_mfma_f32_32x32x16_bf16 v[32:47],a[196:199],v[128:131],v[32:47]
s_waitcnt vmcnt(7)
v_mfma_f32_32x32x16_bf16 v[16:31],a[84:87],v[132:135],v[16:31]
v_mfma_f32_32x32x16_bf16 v[32:47],a[200:203],v[132:135],v[32:47]
s_waitcnt vmcnt(6)
v_mfma_f32_32x32x16_bf16 v[16:31],a[88:91],v[136:139],v[16:31]
v_mfma_f32_32x32x16_bf16 v[32:47],a[204:207],v[136:139],v[32:47]
s_waitcnt vmcnt(5)
v_mfma_f32_32x32x16_bf16 v[16:31],a[92:95],v[140:143],v[16:31]
v_mfma_f32_32x32x16_bf16 v[32:47],a[208:211],v[140:143],v[32:47]
s_waitcnt vmcnt(4)
v_mfma_f32_32x32x16_bf16 v[16:31],a[96:99],v[144:147],v[16:31]
v_mfma_f32_32x32x16_bf16 v[32:47],a[212:215],v[144:147],v[32:47]
s_waitcnt vmcnt(3)
v_mfma_f32_32x32x16_bf16 v[16:31],a[100:103],v[148:151],v[16:31]
v_mfma_f32_32x32x16_bf16 v[32:47],a[216:219],v[148:151],v[32:47]
s_waitcnt vmcnt(2)
v_mfma_f32_32x32x16_bf16 v[16:31],a[104:107],v[152:155],v[16:31]
v_mfma_f32_32x32x16_bf16 v[32:47],a[220:223],v[152:155],v[32:47]
s_waitcnt vmcnt(1)
v_mfma_f32_32x32x16_bf16 v[16:31],a[108:111],v[156:159],v[16:31]
v_mfma_f32_32x32x16_bf16 v[32:47],a[224:227],v[156:159],v[32:47]
s_waitcnt vmcnt(0)
v_mfma_f32_32x32x16_bf16 v[32:47],a[228:231],v[160:163],v[32:47]
v_mfma_f32_32x32x16_bf16 v[16:31],a[112:115],v[160:163],v[16:31]
s_nop 11
ks_j_442:
s_nop 7
s_nop 1
s_add_u32 s32,s32,s68
s_add_u32 s65,s65,s68
v_xor_b32 v12,0x4000,v8
ds_write_b128 v12,v[32:35]
ds_write_b128 v12,v[36:39] offset:1024
ds_write_b128 v12,v[40:43] offset:2048
ds_write_b128 v12,v[44:47] offset:3072
ds_write_b128 v8,v[16:19]
ds_write_b128 v8,v[20:23] offset:1024
ds_write_b128 v8,v[24:27] offset:2048
ds_write_b128 v8,v[28:31] offset:3072
s_cmp_lg_u32 s29,0
s_cbranch_scc1 ks_cp_445
buffer_load_dword v6,v2,s[4:7],0 offen sc1
ks_cp_445:
s_waitcnt lgkmcnt(0)
s_barrier
s_cmp_lg_u32 s29,0
s_cbranch_scc1 ks_nf_444
s_waitcnt vmcnt(0)
ks_nf_444:
s_add_u32 s33,s33,49152
s_add_u32 s36,s36,49152
s_add_u32 s63,s63,49152
s_add_u32 s34,s34,s69
s_add_u32 s28,s28,1
v_xor_b32 v8,32768,v8
v_xor_b32 v9,32768,v9
s_cmp_lg_u32 s29,0
s_cbranch_scc1 ks_top_436
v_cmp_le_u32 vcc,s31,v6
s_nop 0
s_cmp_eq_u64 vcc,-1
s_nop 1
s_cbranch_scc0 ks_np2_447
s_cmp_lt_u32 s41,29696
s_cselect_b32 s46,s32,s65
s_add_u32 s46,s46,0
buffer_load_dwordx4 v[48:51],v1,s[4:7],s46 offen sc1
s_cmp_lt_u32 s41,28672
s_cselect_b32 s46,s32,s65
s_add_u32 s46,s46,0
buffer_load_dwordx4 v[52:55],v1,s[4:7],s46 offen offset:1024 sc1
s_cmp_lt_u32 s41,27648
s_cselect_b32 s46,s32,s65
s_add_u32 s46,s46,0
buffer_load_dwordx4 v[56:59],v1,s[4:7],s46 offen offset:2048 sc1
s_cmp_lt_u32 s41,26624
s_cselect_b32 s46,s32,s65
s_add_u32 s46,s46,0
buffer_load_dwordx4 v[60:63],v1,s[4:7],s46 offen offset:3072 sc1
s_cmp_lt_u32 s41,25600
s_cselect_b32 s46,s32,s65
s_add_u32 s46,s46,4096
buffer_load_dwordx4 v[64:67],v1,s[4:7],s46 offen sc1
s_cmp_lt_u32 s41,24576
s_cselect_b32 s46,s32,s65
s_add_u32 s46,s46,4096
buffer_load_dwordx4 v[68:71],v1,s[4:7],s46 offen offset:1024 sc1
s_cmp_eq_u32 s30,0
s_cbranch_scc1 ks_pb_448
s_waitcnt vmcnt(6)
v_mov_b32 v14,s28
s_mov_b64 exec,1
buffer_store_dword v14,off,s[4:7],s37 sc1
s_mov_b64 exec,-1
s_mov_b32 s30,0
ks_pb_448:
s_cmp_lt_u32 s41,23552
s_cselect_b32 s46,s32,s65
s_add_u32 s46,s46,4096
buffer_load_dwordx4 v[72:75],v1,s[4:7],s46 offen offset:2048 sc1
s_cmp_lt_u32 s41,22528
s_cselect_b32 s46,s32,s65
s_add_u32 s46,s46,4096
buffer_load_dwordx4 v[76:79],v1,s[4:7],s46 offen offset:3072 sc1
s_cmp_lt_u32 s41,21504
s_cselect_b32 s46,s32,s65
s_add_u32 s46,s46,8192
buffer_load_dwordx4 v[80:83],v1,s[4:7],s46 offen sc1
s_cmp_lt_u32 s41,20480
s_cselect_b32 s46,s32,s65
s_add_u32 s46,s46,8192
buffer_load_dwordx4 v[84:87],v1,s[4:7],s46 offen offset:1024 sc1
s_cmp_lt_u32 s41,19456
s_cselect_b32 s46,s32,s65
s_add_u32 s46,s46,8192
buffer_load_dwordx4 v[88:91],v1,s[4:7],s46 offen offset:2048 sc1
s_cmp_lt_u32 s41,18432
s_cselect_b32 s46,s32,s65
s_add_u32 s46,s46,8192
buffer_load_dwordx4 v[92:95],v1,s[4:7],s46 offen offset:3072 sc1
s_cmp_lt_u32 s41,17408
s_cselect_b32 s46,s32,s65
s_add_u32 s46,s46,12288
buffer_load_dwordx4 v[96:99],v1,s[4:7],s46 offen sc1
s_cmp_lt_u32 s41,16384
s_cselect_b32 s46,s32,s65
s_add_u32 s46,s46,12288
buffer_load_dwordx4 v[100:103],v1,s[4:7],s46 offen offset:1024 sc1
s_branch ks_top_436
ks_np2_447:
s_cmp_eq_u32 s30,0
s_cbranch_scc1 ks_nop_450
buffer_load_dword v6,v2,s[4:7],0 offen sc1
s_cmp_eq_u32 s30,0
s_cbranch_scc1 ks_pb_451
s_waitcnt vmcnt(1)
v_mov_b32 v14,s28
s_mov_b64 exec,1
buffer_store_dword v14,off,s[4:7],s37 sc1
s_mov_b64 exec,-1
s_mov_b32 s30,0
ks_pb_451:
s_waitcnt vmcnt(1)
v_cmp_le_u32 vcc,s31,v6
s_nop 0
s_cmp_eq_u64 vcc,-1
s_nop 1
s_cbranch_scc1 ks_rdy_449
ks_nop_450:
s_cmp_ge_u32 s28,s67
s_cbranch_scc1 ks_fin_437
s_mov_b32 s38,0
poll_452:
buffer_load_dword v6,v2,s[4:7],0 offen sc1
s_waitcnt vmcnt(0)
v_cmp_le_u32 vcc,s31,v6
s_nop 0
s_cmp_eq_u64 vcc,-1
s_nop 1
s_cbranch_scc1 polld_453
s_sleep 2
s_add_u32 s38,s38,1
s_cmp_lt_u32 s38,100000
s_cbranch_scc1 poll_452
s_mov_b32 s40,12
s_branch L_fail
polld_453:
ks_rdy_449:
s_cmp_lt_u32 s41,29696
s_cselect_b32 s46,s32,s65
s_add_u32 s46,s46,0
buffer_load_dwordx4 v[48:51],v1,s[4:7],s46 offen sc1
s_cmp_lt_u32 s41,28672
s_cselect_b32 s46,s32,s65
s_add_u32 s46,s46,0
buffer_load_dwordx4 v[52:55],v1,s[4:7],s46 offen offset:1024 sc1
s_cmp_lt_u32 s41,27648
s_cselect_b32 s46,s32,s65
s_add_u32 s46,s46,0
buffer_load_dwordx4 v[56:59],v1,s[4:7],s46 offen offset:2048 sc1
s_cmp_lt_u32 s41,26624
s_cselect_b32 s46,s32,s65
s_add_u32 s46,s46,0
buffer_load_dwordx4 v[60:63],v1,s[4:7],s46 offen offset:3072 sc1
s_cmp_lt_u32 s41,25600
s_cselect_b32 s46,s32,s65
s_add_u32 s46,s46,4096
buffer_load_dwordx4 v[64:67],v1,s[4:7],s46 offen sc1
s_cmp_lt_u32 s41,24576
s_cselect_b32 s46,s32,s65
s_add_u32 s46,s46,4096
buffer_load_dwordx4 v[68:71],v1,s[4:7],s46 offen offset:1024 sc1
s_cmp_lt_u32 s41,23552
s_cselect_b32 s46,s32,s65
s_add_u32 s46,s46,4096
buffer_load_dwordx4 v[72:75],v1,s[4:7],s46 offen offset:2048 sc1
s_cmp_lt_u32 s41,22528
s_cselect_b32 s46,s32,s65
s_add_u32 s46,s46,4096
buffer_load_dwordx4 v[76:79],v1,s[4:7],s46 offen offset:3072 sc1
s_cmp_lt_u32 s41,21504
s_cselect_b32 s46,s32,s65
s_add_u32 s46,s46,8192
buffer_load_dwordx4 v[80:83],v1,s[4:7],s46 offen sc1
s_cmp_lt_u32 s41,20480
s_cselect_b32 s46,s32,s65
s_add_u32 s46,s46,8192
buffer_load_dwordx4 v[84:87],v1,s[4:7],s46 offen offset:1024 sc1
s_cmp_lt_u32 s41,19456
s_cselect_b32 s46,s32,s65
s_add_u32 s46,s46,8192
buffer_load_dwordx4 v[88:91],v1,s[4:7],s46 offen offset:2048 sc1
s_cmp_lt_u32 s41,18432
s_cselect_b32 s46,s32,s65
s_add_u32 s46,s46,8192
buffer_load_dwordx4 v[92:95],v1,s[4:7],s46 offen offset:3072 sc1
s_cmp_lt_u32 s41,17408
s_cselect_b32 s46,s32,s65
s_add_u32 s46,s46,12288
buffer_load_dwordx4 v[96:99],v1,s[4:7],s46 offen sc1
s_cmp_lt_u32 s41,16384
s_cselect_b32 s46,s32,s65
s_add_u32 s46,s46,12288
buffer_load_dwordx4 v[100:103],v1,s[4:7],s46 offen offset:1024 sc1
s_branch ks_top_436
ks_fin_437:
s_branch L_end
ls_420:
buffer_store_dword v14,off,s[4:7],s66 sc1
s_nop 1
s_branch ls_421
.section .rodata,"a"
.p2align 6
.amdhsa_kernel interleave_layers__memory_aug_recurrent_mem_tr__mixer_s_mlp__prompt_kernel
  .amdhsa_next_free_vgpr 512
  .amdhsa_next_free_sgpr 102
  .amdhsa_accum_offset 256
  .amdhsa_group_segment_fixed_size 0
  .amdhsa_kernarg_size 120
  .amdhsa_user_sgpr_count 2
  .amdhsa_user_sgpr_kernarg_segment_ptr 1
  .amdhsa_system_sgpr_workgroup_id_x 1
  .amdhsa_float_denorm_mode_32 3
.end_amdhsa_kernel
```
